```python
import torch

def _softmax(x, axis=-1):
    return torch.softmax(x, dim=axis)
def _gelu(x):
    return torch.nn.functional.gelu(x, approximate="tanh")
def _silu(x):
    return torch.nn.functional.silu(x)
def _sigmoid(x):
    return torch.sigmoid(x)
def _layernorm(x, axis=-1, eps=1e-5):
    m = x.mean(dim=axis, keepdim=True)
    v = x.var(dim=axis, keepdim=True, unbiased=False)
    return (x - m) / torch.sqrt(v + eps)
def _scatter_add(tgt, idx, src, axis=0):
    return tgt.clone().index_add_(axis, idx, src)
def _segment_sum(src, seg, n):
    out = torch.zeros((n,) + src.shape[1:], dtype=src.dtype)
    return out.index_add_(0, seg, src)
def _pad(x, pw):
    flat = tuple(v for pair in reversed(pw) for v in pair)
    return torch.nn.functional.pad(x, flat)

kernel_name = 'standalone__deformable_dcnv1__vision'

def setup_inputs():

    _w = (lambda a: (lambda t: t.to(torch.bfloat16) if t.is_floating_point() else t)(torch.as_tensor(a)))
    H = W = 224
    C = 96
    K = 3
    return {
        "x": _w((lambda *s: torch.randn(*s, dtype=torch.bfloat16) * 0.05)(1, H, W, C)),
        "offset": _w((lambda *s: torch.randn(*s, dtype=torch.bfloat16) * 0.05)(1, H, W, 2 * K * K) * 0.5),
        "w": _w((lambda *s: torch.randn(*s, dtype=torch.bfloat16) * 0.05)(K, K, C, C) * (K * K * C) ** -0.5),
    }

def reference(x, offset, w):
    B, H, W, C = x.shape
    K = 3
    hh = (lambda x, dt: x.to(dt))(torch.arange(H), x.dtype).reshape(1, H, 1)
    ww = (lambda x, dt: x.to(dt))(torch.arange(W), x.dtype).reshape(1, 1, W)
    xf = x.reshape(B, H * W, C)
    def _gather(yi, xi):
        lin = (yi * W + xi).reshape(B, H * W)
        idx = (lambda x, n, axis: torch.repeat_interleave(x, n, dim=axis))(lin[..., None], C, axis=-1)
        return (lambda x, i, axis: torch.take_along_dim(x, i, dim=axis))(xf, idx, axis=1).reshape(B, H, W, C)
    taps = []
    for ki in range(K):
        for kj in range(K):
            t = ki * K + kj
            dy = offset[..., 2 * t]
            dx = offset[..., 2 * t + 1]
            py = torch.clip(hh + (ki - 0.5 * (K - 1)) + dy, 0.0, H - 1.0)
            px = torch.clip(ww + (kj - 0.5 * (K - 1)) + dx, 0.0, W - 1.0)
            y0 = torch.floor(py)
            x0 = torch.floor(px)
            y1 = torch.clip(y0 + 1.0, 0.0, H - 1.0)
            x1 = torch.clip(x0 + 1.0, 0.0, W - 1.0)
            wy = (py - y0)[..., None]
            wx = (px - x0)[..., None]
            y0i = (lambda x, dt: x.to(dt))(y0, torch.int64)
            y1i = (lambda x, dt: x.to(dt))(y1, torch.int64)
            x0i = (lambda x, dt: x.to(dt))(x0, torch.int64)
            x1i = (lambda x, dt: x.to(dt))(x1, torch.int64)
            v = (1 - wy) * (1 - wx) * _gather(y0i, x0i) + (1 - wy) * wx * _gather(y0i, x1i) + wy * (1 - wx) * _gather(y1i, x0i) + wy * wx * _gather(y1i, x1i)
            taps.append(v)
    samp = torch.stack(taps, 3)
    return torch.einsum("bhwkc,kco->bhwo", samp, w.reshape(K * K, C, C))
```

```asm
; @launch grid=(256,1,1) block=(512,1,1) lds=163840
.amdgcn_target "amdgcn-amd-amdhsa--gfx950"
.text
.globl standalone__deformable_dcnv1__vision_kernel
.p2align 12
.p2align 8
.type standalone__deformable_dcnv1__vision_kernel,@function
standalone__deformable_dcnv1__vision_kernel:
    s_cmp_ge_u32 s2, 256
    s_cbranch_scc1 L_end
    s_getpc_b64 s[40:41]
L_pc:
    s_lshl_b32 s96, s2, 5
    s_add_u32 s96, s96, L_runtab-L_pc
    s_add_u32 s42, s40, s96
    s_addc_u32 s43, s41, 0
    s_load_dwordx8 s[20:27], s[42:43], 0
    s_load_dwordx2 s[12:13], s[0:1], 16
    s_load_dwordx2 s[4:5], s[0:1], 0
    s_load_dwordx2 s[8:9], s[0:1], 8
    s_load_dwordx2 s[16:17], s[0:1], 24
    v_lshrrev_b32 v73, 6, v0
    v_and_b32 v72, 63, v0
    v_readfirstlane_b32 s28, v73
    v_lshlrev_b32 v14, 4, v72
    v_mul_u32_u24 v224, 12, v72
    s_mov_b32 s6, 9633792
    s_mov_b32 s7, 0x00020000
    s_mov_b32 s10, 1806336
    s_mov_b32 s11, s7
    s_mov_b32 s14, 165888
    s_mov_b32 s15, s7
    s_mov_b32 s18, s6
    s_mov_b32 s19, s7
    s_and_b32 s29, s28, 1
    s_lshr_b32 s30, s28, 1
    s_lshl_b32 s30, s30, 3
    s_and_b32 s97, s28, 3
    s_lshl_b32 s96, s28, 12
    v_lshlrev_b32 v22, 3, v14
    v_add_u32 v22, s96, v22
    v_min_u32 v22, L_cold-L_pc, v22
    s_lshr_b32 s96, s2, 3
    s_lshl_b64 exec, 1, s96
    global_load_dword v22, v22, s[40:41]
    s_mov_b64 exec, -1
    s_lshl_b32 s96, s97, 10
    v_add_u32 v19, s96, v14
    s_add_u32 s96, s96, 89280
    s_cmp_ge_u32 s97, 3
    s_cselect_b32 s88, 32, 0
    s_add_u32 s88, s88, s96
    s_cmp_ge_u32 s97, 2
    s_cselect_b32 s89, 32, 0
    s_add_u32 s89, s89, s96
    s_cmp_ge_u32 s97, 1
    s_cselect_b32 s90, 32, 0
    s_add_u32 s90, s90, s96
    s_mul_i32 s94, s97, 960
    s_mul_i32 s98, s97, 5
    v_mul_u32_u24 v76, 5462, v72
    v_lshrrev_b32 v76, 16, v76
    v_mul_u32_u24 v73, 12, v76
    v_add_u32 v76, s98, v76
    v_sub_u32 v73, v72, v73
    v_bfe_u32 v74, v76, 2, 2
    v_xor_b32 v73, v73, v74
    v_lshlrev_b32 v20, 4, v73
    v_cmp_gt_u32 s[92:93], 60, v72
    s_cmp_lt_u32 s28, 4
    s_cselect_b32 s39, 0, 0x3e
    s_cselect_b32 s99, 0, 768
    s_mov_b32 s95, 73728
    s_waitcnt lgkmcnt(0)
    s_lshr_b32 s96, s22, s30
    s_and_b32 s32, s23, 0xff
    s_and_b32 s31, s96, 15
    s_bfe_u32 s30, s96, 0x30004
    s_bfe_u32 s33, s23, 0x80008
    s_add_u32 s0, s33, s31
    s_mul_i32 s3, s0, 224
    s_add_u32 s3, s3, s32
    s_mul_i32 s3, s3, 36
    s_bitcmp1_b32 s23, 18
    s_cbranch_scc1 L_startD
    s_cmp_gt_u32 s30, 0
    s_cselect_b32 s96, s3, 2130706432
    s_addk_i32 s3, 8064
    buffer_load_dwordx3 v[204:206], v224, s[8:11], s96 offen
    s_cmp_gt_u32 s30, 1
    s_cselect_b32 s96, s3, 2130706432
    s_addk_i32 s3, 8064
    buffer_load_dwordx3 v[208:210], v224, s[8:11], s96 offen
    s_cmp_gt_u32 s30, 2
    s_cselect_b32 s96, s3, 2130706432
    s_addk_i32 s3, 8064
    buffer_load_dwordx3 v[212:214], v224, s[8:11], s96 offen
    s_cmp_gt_u32 s30, 3
    s_cselect_b32 s96, s3, 2130706432
    s_addk_i32 s3, 8064
    buffer_load_dwordx3 v[216:218], v224, s[8:11], s96 offen
    s_sub_u32 s34, s32, 2
    s_bfe_u32 s100, s23, 0x10011
    s_lshl_b32 s101, s100, 1
    s_sub_u32 s101, 19, s101
    s_cmp_lt_u32 s28, 4
    s_cbranch_scc1 L_startA
    s_add_u32 m0, s88, 0
    s_mov_b32 s96, 0
    buffer_load_dwordx4 v19, s[12:15], s96 offen lds
    s_add_u32 m0, s89, 4128
    s_mov_b32 s96, 4096
    buffer_load_dwordx4 v19, s[12:15], s96 offen lds
    s_movk_i32 s97, 223
    v_add_u32 v74, s34, v76
    v_subrev_u32 v75, s100, v76
    v_med3_i32 v74, v74, 0, s97
    v_cmp_ge_u32 vcc, s101, v75
    v_mul_u32_u24 v74, 192, v74
    s_and_b64 s[92:93], s[92:93], vcc
    v_add_u32 v20, v74, v20
    s_add_u32 m0, s90, 8256
    s_mov_b32 s96, 8192
    buffer_load_dwordx4 v19, s[12:15], s96 offen lds
    s_add_u32 m0, s88, 12416
    s_mov_b32 s96, 12288
    buffer_load_dwordx4 v19, s[12:15], s96 offen lds
    s_add_u32 m0, s89, 16544
    s_mov_b32 s96, 16384
    buffer_load_dwordx4 v19, s[12:15], s96 offen lds
    s_max_i32 s96, s20, 0
    s_add_u32 m0, s94, 0
    s_mov_b64 exec, s[92:93]
    s_add_u32 s20, s20, 43008
    buffer_load_dwordx4 v20, s[4:7], s96 offen lds
    s_max_i32 s96, s20, 0
    s_addk_i32 m0, 3904
    s_add_u32 s20, s20, 43008
    buffer_load_dwordx4 v20, s[4:7], s96 offen lds
    s_mov_b64 exec, -1
    s_call_b64 s[76:77], L_setup1
    s_min_i32 s96, s20, s21
    s_add_u32 m0, s94, 7808
    s_mov_b64 exec, s[92:93]
    s_add_u32 s20, s20, 43008
    buffer_load_dwordx4 v20, s[4:7], s96 offen lds
    s_min_i32 s96, s20, s21
    s_addk_i32 m0, 3904
    s_add_u32 s20, s20, 43008
    buffer_load_dwordx4 v20, s[4:7], s96 offen lds
    s_min_i32 s96, s20, s21
    s_addk_i32 m0, 3904
    s_add_u32 s20, s20, 43008
    buffer_load_dwordx4 v20, s[4:7], s96 offen lds
    s_min_i32 s96, s20, s21
    s_addk_i32 m0, 3904
    s_add_u32 s20, s20, 43008
    buffer_load_dwordx4 v20, s[4:7], s96 offen lds
    s_min_i32 s96, s20, s21
    s_addk_i32 m0, 3904
    s_add_u32 s20, s20, 43008
    buffer_load_dwordx4 v20, s[4:7], s96 offen lds
    s_min_i32 s96, s20, s21
    s_addk_i32 m0, 3904
    s_add_u32 s20, s20, 43008
    buffer_load_dwordx4 v20, s[4:7], s96 offen lds
    s_mov_b64 exec, -1
    s_waitcnt vmcnt(13)
    s_call_b64 s[76:77], L_pos
    s_add_u32 m0, s90, 20672
    s_mov_b32 s96, 20480
    buffer_load_dwordx4 v19, s[12:15], s96 offen lds
    s_add_u32 m0, s88, 24832
    s_mov_b32 s96, 24576
    buffer_load_dwordx4 v19, s[12:15], s96 offen lds
    s_add_u32 m0, s89, 28960
    s_mov_b32 s96, 28672
    buffer_load_dwordx4 v19, s[12:15], s96 offen lds
    s_add_u32 m0, s90, 33088
    s_mov_b32 s96, 32768
    buffer_load_dwordx4 v19, s[12:15], s96 offen lds
    s_min_i32 s96, s20, s21
    s_add_u32 m0, s94, 31232
    s_mov_b64 exec, s[92:93]
    s_add_u32 s20, s20, 43008
    buffer_load_dwordx4 v20, s[4:7], s96 offen lds
    s_min_i32 s96, s20, s21
    s_addk_i32 m0, 3904
    s_add_u32 s20, s20, 43008
    buffer_load_dwordx4 v20, s[4:7], s96 offen lds
    s_min_i32 s96, s20, s21
    s_addk_i32 m0, 3904
    s_add_u32 s20, s20, 43008
    buffer_load_dwordx4 v20, s[4:7], s96 offen lds
    s_min_i32 s96, s20, s21
    s_addk_i32 m0, 3904
    s_add_u32 s20, s20, 43008
    buffer_load_dwordx4 v20, s[4:7], s96 offen lds
    s_mov_b64 exec, -1
    s_waitcnt vmcnt(8)
    s_waitcnt lgkmcnt(0)
    s_barrier
    s_min_i32 s96, s20, s21
    s_add_u32 m0, s94, 46848
    s_mov_b64 exec, s[92:93]
    s_add_u32 s20, s20, 43008
    buffer_load_dwordx4 v20, s[4:7], s96 offen lds
    s_min_i32 s96, s20, s21
    s_addk_i32 m0, 3904
    s_add_u32 s20, s20, 43008
    buffer_load_dwordx4 v20, s[4:7], s96 offen lds
    s_min_i32 s96, s20, s21
    s_addk_i32 m0, 3904
    s_add_u32 s20, s20, 43008
    buffer_load_dwordx4 v20, s[4:7], s96 offen lds
    s_mov_b64 exec, -1
    s_add_u32 m0, s88, 37248
    s_mov_b32 s96, 36864
    buffer_load_dwordx4 v19, s[12:15], s96 offen lds
    s_call_b64 s[76:77], L_list2
    s_waitcnt vmcnt(8)
    s_waitcnt lgkmcnt(0)
    s_barrier
    s_add_u32 m0, s89, 41376
    s_mov_b32 s96, 40960
    buffer_load_dwordx4 v19, s[12:15], s96 offen lds
    s_add_u32 m0, s90, 45504
    s_mov_b32 s96, 45056
    buffer_load_dwordx4 v19, s[12:15], s96 offen lds
    s_add_u32 m0, s88, 49664
    s_mov_b32 s96, 49152
    buffer_load_dwordx4 v19, s[12:15], s96 offen lds
    s_add_u32 m0, s89, 53792
    s_mov_b32 s96, 53248
    buffer_load_dwordx4 v19, s[12:15], s96 offen lds
    s_add_u32 m0, s90, 57920
    s_mov_b32 s96, 57344
    buffer_load_dwordx4 v19, s[12:15], s96 offen lds
    s_add_u32 m0, s88, 62080
    s_mov_b32 s96, 61440
    buffer_load_dwordx4 v19, s[12:15], s96 offen lds
    s_add_u32 m0, s89, 66208
    s_mov_b32 s96, 65536
    buffer_load_dwordx4 v19, s[12:15], s96 offen lds
    s_add_u32 m0, s90, 70336
    s_mov_b32 s96, 69632
    buffer_load_dwordx4 v19, s[12:15], s96 offen lds
    s_call_b64 s[76:77], L_setup2
    s_waitcnt vmcnt(4)
    s_branch L_first
L_startA:
    s_lshr_b32 s96, s2, 3
    s_and_b32 s96, s96, 31
    s_lshl_b32 s96, s96, 2
    s_add_u32 s96, s96, s28
    s_mul_i32 s96, s96, 1152
    s_add_u32 s96, s96, 18432
    v_lshlrev_b32 v23, 3, v14
    s_mov_b64 exec, 0x1ff
    buffer_load_dword v23, v23, s[12:15], s96 offen
    s_mov_b64 exec, -1
    s_call_b64 s[76:77], L_setup1
    s_call_b64 s[76:77], L_setup2
    s_waitcnt vmcnt(1)
    s_call_b64 s[76:77], L_pos
    s_call_b64 s[76:77], L_list2
    s_branch L_first
L_list2:
    s_cmp_eq_u32 s38, 1
    s_cbranch_scc1 L_list3
    s_setpc_b64 s[76:77]
L_setup1:
    v_mul_u32_u24 v231, 3641, v224
    v_lshrrev_b32 v161, 4, v14
    s_bfe_u32 s96, s23, 0x10010
    v_lshrrev_b32 v231, 17, v231
    s_sub_u32 s33, s33, s96
    v_mul_u32_u24 v160, 3, v231
    v_add_u32 v159, s32, v231
    s_sub_u32 s33, s33, 1
    v_sub_u32 v230, v161, v160
    v_cvt_f32_u32 v222, v159
    v_add_u32 v160, s0, v230
    s_mov_b32 s35, 0
    v_cvt_f32_u32 v220, v160
    v_add_f32 v221, -1.0, v222
    v_add_f32 v223, 1.0, v222
    s_mov_b32 s37, 0
    v_add_f32 v220, -1.0, v220
    s_mov_b32 s38, 0
    s_setpc_b64 s[76:77]
L_setup2:
    v_mov_b32 v108, 0
    v_mov_b32 v109, 0
    v_mov_b32 v110, 0
    v_mov_b32 v111, 0
    s_sub_u32 s96, s0, s33
    s_sub_u32 s96, s96, 1
    s_mul_i32 s96, s96, 3904
    v_bfe_u32 v157, v14, 6, 2
    v_bfe_u32 v158, v14, 4, 2
    v_lshrrev_b32 v156, 8, v14
    v_lshrrev_b32 v160, 9, v14
    v_mfma_f32_32x32x16_bf16 v[24:39], v[108:111], v[108:111], 0
    v_mfma_f32_32x32x16_bf16 v[40:55], v[108:111], v[108:111], 0
    v_mfma_f32_32x32x16_bf16 v[56:71], v[108:111], v[108:111], 0
    v_lshl_add_u32 v15, v158, 2, v157
    v_and_b32 v159, 1, v156
    s_mul_i32 s97, s29, 96
    v_lshl_or_b32 v0, v159, 1, v160
    v_mul_u32_u24 v159, 3104, v159
    v_lshl_add_u32 v160, v160, 3, v157
    s_add_u32 s98, s97, 89280
    v_mul_u32_u24 v160, 192, v160
    v_lshl_add_u32 v159, v158, 3, v159
    v_lshlrev_b32 v162, 4, v0
    v_add3_u32 v4, v159, v160, s98
    v_lshrrev_b32 v161, 4, v14
    v_add_u32 v180, 1, v15
    v_add_u32 v182, 2, v15
    v_add_u32 v184, 3, v15
    v_and_b32 v181, 12, v180
    v_and_b32 v183, 12, v182
    v_and_b32 v185, 12, v184
    v_mul_u32_u24 v180, 48, v180
    v_mul_u32_u24 v182, 48, v182
    v_mul_u32_u24 v184, 48, v184
    v_add_lshl_u32 v180, v180, v181, 2
    v_add_lshl_u32 v182, v182, v183, 2
    v_add_lshl_u32 v184, v184, v185, 2
    v_xor_b32 v180, v180, v162
    v_xor_b32 v182, v182, v162
    v_xor_b32 v184, v184, v162
    v_add_u32 v1, s96, v180
    v_add_u32 v2, s96, v182
    v_add_u32 v3, s96, v184
    v_mov_b32 v5, v4
    s_bfe_u32 s98, s23, 0x40014
    s_mul_i32 s98, s98, 3904
    s_sub_u32 s98, 107904, s98
    s_cmp_lt_u32 s28, 4
    s_cselect_b32 s98, 0, s98
    v_mul_u32_u24 v21, 208, v15
    s_mul_i32 s96, s31, 3904
    s_add_u32 s96, s96, s98
    s_add_u32 s97, s97, s96
    v_lshl_add_u32 v21, v156, 3, v21
    v_mul_u32_u24 v0, 0x10001, v0
    v_add_u32 v21, s97, v21
    s_mul_i32 s97, s29, 3904
    s_add_u32 s97, s97, s96
    s_lshl_b32 s96, s28, 2
    s_add_u32 s96, s96, 163776
    v_mov_b32 v254, s96
    v_add_u32 v180, 0, v161
    v_add_u32 v182, 64, v161
    v_add_u32 v184, 128, v161
    v_mul_u32_u24 v181, 5462, v180
    v_mul_u32_u24 v183, 5462, v182
    v_mul_u32_u24 v185, 5462, v184
    v_lshrrev_b32 v181, 16, v181
    v_lshrrev_b32 v183, 16, v183
    v_lshrrev_b32 v185, 16, v185
    v_add_lshl_u32 v180, v180, v181, 4
    v_add_lshl_u32 v182, v182, v183, 4
    v_add_lshl_u32 v184, v184, v185, 4
    v_add_u32 v248, s97, v180
    v_add_u32 v249, s97, v182
    v_add_u32 v250, s97, v184
    v_xor_b32 v255, 4, v254
    ds_write_b32 v254, v108
    s_setpc_b64 s[76:77]
L_pos:
    s_bitcmp1_b32 s23, 19
    s_cbranch_scc1 L_exact
    v_add_f32 v72, -0.5, v220
    v_add_f32 v73, -0.5, v221
    s_mov_b32 s96, 0x3b800000
    v_max_f32 v72, 0, v72
    v_max_f32 v73, 0, v73
    v_mul_f32 v72, s96, v72
    v_mul_f32 v73, s96, v73
    s_mov_b32 s97, 0x7fff7fff
    v_alignbit_b32 v73, 0, v73, 16
    v_alignbit_b32 v76, v73, v72, 16
    v_and_b32 v76, 0x7f807f80, v76
    v_pk_sub_u16 v76, v76, 1 op_sel_hi:[1,0] clamp
    s_mov_b32 exec_hi, 0xffff
    v_and_b32 v74, s97, v204
    v_and_b32 v75, s97, v205
    v_pk_max_u16 v72, v74, v76
    v_pk_max_u16 v73, v75, v76
    v_and_b32 v74, s97, v206
    v_and_b32 v75, s97, v208
    v_pk_max_u16 v72, v74, v72
    v_pk_max_u16 v73, v75, v73
    v_and_b32 v74, s97, v209
    v_and_b32 v75, s97, v210
    v_pk_max_u16 v72, v74, v72
    v_pk_max_u16 v73, v75, v73
    v_and_b32 v74, s97, v212
    v_and_b32 v75, s97, v213
    v_pk_max_u16 v72, v74, v72
    v_pk_max_u16 v73, v75, v73
    v_and_b32 v74, s97, v214
    v_and_b32 v75, s97, v216
    v_pk_max_u16 v72, v74, v72
    v_pk_max_u16 v73, v75, v73
    v_and_b32 v74, s97, v217
    v_and_b32 v75, s97, v218
    v_pk_max_u16 v72, v74, v72
    v_pk_max_u16 v73, v75, v73
    v_pk_max_u16 v72, v72, v73
    v_cmp_ne_u32 vcc, v72, v76
    s_cbranch_vccnz L_exact
    s_mov_b32 exec_hi, -1
    s_setpc_b64 s[76:77]
.p2align 12
L_first:
    s_waitcnt lgkmcnt(0)
    s_or_b32 s3, s37, s39
    s_or_b32 s3, s3, s99
    s_or_b32 s3, s3, 512
    s_cmp_lg_u32 s38, 0
    s_cbranch_scc1 L_first2
    s_barrier
L_nfirst:
    ds_read_b128 v[108:111], v1 offset:0
    ds_read_b64_tr_b16 v[72:73], v5 offset:0
    ds_read_b64_tr_b16 v[74:75], v5 offset:768
    ds_read_b64_tr_b16 v[76:77], v5 offset:32
    ds_read_b64_tr_b16 v[78:79], v5 offset:800
    ds_read_b64_tr_b16 v[80:81], v5 offset:64
    ds_read_b64_tr_b16 v[82:83], v5 offset:832
    ds_read_b128 v[112:115], v1 offset:3904
    ds_read_b128 v[116:119], v1 offset:7808
    ds_read_b128 v[120:123], v1 offset:11712
    s_cmp_eq_u32 s30, 4
    s_cbranch_scc0 L_nf3
    s_waitcnt lgkmcnt(7)
    v_mfma_f32_16x16x32_bf16 v[24:27], v[72:75], v[108:111], v[24:27]
    ds_read_b64_tr_b16 v[84:85], v5 offset:6208
    ds_read_b64_tr_b16 v[86:87], v5 offset:6976
    s_waitcnt lgkmcnt(7)
    v_mfma_f32_16x16x32_bf16 v[28:31], v[76:79], v[108:111], v[28:31]
    ds_read_b64_tr_b16 v[88:89], v5 offset:6240
    ds_read_b64_tr_b16 v[90:91], v5 offset:7008
    s_waitcnt lgkmcnt(7)
    v_mfma_f32_16x16x32_bf16 v[32:35], v[80:83], v[108:111], v[32:35]
    ds_read_b64_tr_b16 v[92:93], v5 offset:6272
    ds_read_b64_tr_b16 v[94:95], v5 offset:7040
    s_waitcnt lgkmcnt(8)
    v_mfma_f32_16x16x32_bf16 v[44:47], v[80:83], v[112:115], v[44:47]
    ds_read_b128 v[124:127], v1 offset:64
    ds_read_b128 v[128:131], v1 offset:3968
    v_mfma_f32_16x16x32_bf16 v[40:43], v[76:79], v[112:115], v[40:43]
    ds_read_b128 v[132:135], v1 offset:7872
    ds_read_b128 v[136:139], v1 offset:11776
    v_mfma_f32_16x16x32_bf16 v[36:39], v[72:75], v[112:115], v[36:39]
    ds_read_b128 v[140:143], v1 offset:128
    ds_read_b128 v[144:147], v1 offset:4032
    s_waitcnt lgkmcnt(13)
    v_mfma_f32_16x16x32_bf16 v[48:51], v[72:75], v[116:119], v[48:51]
    ds_read_b128 v[148:151], v1 offset:7936
    ds_read_b128 v[152:155], v1 offset:11840
    v_mfma_f32_16x16x32_bf16 v[52:55], v[76:79], v[116:119], v[52:55]
    ds_read_b64_tr_b16 v[96:97], v5 offset:12416
    ds_read_b64_tr_b16 v[98:99], v5 offset:13184
    v_mfma_f32_16x16x32_bf16 v[56:59], v[80:83], v[116:119], v[56:59]
    ds_read_b64_tr_b16 v[100:101], v5 offset:12448
    ds_read_b64_tr_b16 v[102:103], v5 offset:13216
    s_waitcnt lgkmcnt(15)
    v_mfma_f32_16x16x32_bf16 v[68:71], v[80:83], v[120:123], v[68:71]
    ds_read_b64_tr_b16 v[104:105], v5 offset:12480
    ds_read_b64_tr_b16 v[106:107], v5 offset:13248
    v_mfma_f32_16x16x32_bf16 v[64:67], v[76:79], v[120:123], v[64:67]
    v_mfma_f32_16x16x32_bf16 v[60:63], v[72:75], v[120:123], v[60:63]
    s_add_u32 s35, s35, 1
    v_add_u32 v17, 3904, v1
    s_and_b32 s36, s35, 3
    v_mov_b32 v1, v2
    s_mul_i32 s36, s36, 18624
    v_mov_b32 v2, v3
    v_mov_b32 v3, v17
    v_add_u32 v5, s36, v4
    s_branch L_end4
L_nf3:
    s_cmp_eq_u32 s30, 3
    s_cbranch_scc0 L_nf2
    s_waitcnt lgkmcnt(7)
    v_mfma_f32_16x16x32_bf16 v[24:27], v[72:75], v[108:111], v[24:27]
    ds_read_b64_tr_b16 v[84:85], v5 offset:6208
    ds_read_b64_tr_b16 v[86:87], v5 offset:6976
    s_waitcnt lgkmcnt(7)
    v_mfma_f32_16x16x32_bf16 v[28:31], v[76:79], v[108:111], v[28:31]
    ds_read_b64_tr_b16 v[88:89], v5 offset:6240
    ds_read_b64_tr_b16 v[90:91], v5 offset:7008
    s_waitcnt lgkmcnt(7)
    v_mfma_f32_16x16x32_bf16 v[32:35], v[80:83], v[108:111], v[32:35]
    ds_read_b64_tr_b16 v[92:93], v5 offset:6272
    ds_read_b64_tr_b16 v[94:95], v5 offset:7040
    s_waitcnt lgkmcnt(8)
    v_mfma_f32_16x16x32_bf16 v[44:47], v[80:83], v[112:115], v[44:47]
    ds_read_b128 v[124:127], v1 offset:64
    ds_read_b128 v[128:131], v1 offset:3968
    v_mfma_f32_16x16x32_bf16 v[40:43], v[76:79], v[112:115], v[40:43]
    ds_read_b128 v[132:135], v1 offset:7872
    ds_read_b128 v[140:143], v1 offset:128
    v_mfma_f32_16x16x32_bf16 v[36:39], v[72:75], v[112:115], v[36:39]
    ds_read_b128 v[144:147], v1 offset:4032
    ds_read_b128 v[148:151], v1 offset:7936
    s_waitcnt lgkmcnt(13)
    v_mfma_f32_16x16x32_bf16 v[48:51], v[72:75], v[116:119], v[48:51]
    ds_read_b64_tr_b16 v[96:97], v5 offset:12416
    ds_read_b64_tr_b16 v[98:99], v5 offset:13184
    v_mfma_f32_16x16x32_bf16 v[52:55], v[76:79], v[116:119], v[52:55]
    ds_read_b64_tr_b16 v[100:101], v5 offset:12448
    ds_read_b64_tr_b16 v[102:103], v5 offset:13216
    v_mfma_f32_16x16x32_bf16 v[56:59], v[80:83], v[116:119], v[56:59]
    ds_read_b64_tr_b16 v[104:105], v5 offset:12480
    ds_read_b64_tr_b16 v[106:107], v5 offset:13248
    s_add_u32 s35, s35, 1
    v_add_u32 v17, 3904, v1
    s_and_b32 s36, s35, 3
    v_mov_b32 v1, v2
    s_mul_i32 s36, s36, 18624
    v_mov_b32 v2, v3
    v_mov_b32 v3, v17
    v_add_u32 v5, s36, v4
    s_branch L_end3
.p2align 3
L_top4:
    s_barrier
L_body4:
    s_setprio 2
.p2align 3
    v_mfma_f32_16x16x32_bf16 v[24:27], v[84:87], v[124:127], v[24:27]
    ds_read_b128 v[108:111], v1 offset:0
    v_mfma_f32_16x16x32_bf16 v[28:31], v[88:91], v[124:127], v[28:31]
    ds_read_b64_tr_b16 v[72:73], v5 offset:0
    v_mfma_f32_16x16x32_bf16 v[32:35], v[92:95], v[124:127], v[32:35]
    ds_read_b64_tr_b16 v[74:75], v5 offset:768
    v_mfma_f32_16x16x32_bf16 v[44:47], v[92:95], v[128:131], v[44:47]
    ds_read_b64_tr_b16 v[76:77], v5 offset:32
    v_mfma_f32_16x16x32_bf16 v[40:43], v[88:91], v[128:131], v[40:43]
    ds_read_b64_tr_b16 v[78:79], v5 offset:800
    v_mfma_f32_16x16x32_bf16 v[36:39], v[84:87], v[128:131], v[36:39]
    ds_read_b64_tr_b16 v[80:81], v5 offset:64
    v_mfma_f32_16x16x32_bf16 v[48:51], v[84:87], v[132:135], v[48:51]
    ds_read_b64_tr_b16 v[82:83], v5 offset:832
    v_mfma_f32_16x16x32_bf16 v[52:55], v[88:91], v[132:135], v[52:55]
    ds_read_b128 v[112:115], v1 offset:3904
    v_mfma_f32_16x16x32_bf16 v[56:59], v[92:95], v[132:135], v[56:59]
    ds_read_b128 v[116:119], v1 offset:7808
    v_mfma_f32_16x16x32_bf16 v[68:71], v[92:95], v[136:139], v[68:71]
    ds_read_b128 v[120:123], v1 offset:11712
    v_mfma_f32_16x16x32_bf16 v[64:67], v[88:91], v[136:139], v[64:67]
    v_mfma_f32_16x16x32_bf16 v[60:63], v[84:87], v[136:139], v[60:63]
    s_setprio 1
.p2align 3
    v_mfma_f32_16x16x32_bf16 v[24:27], v[96:99], v[140:143], v[24:27]
    ds_read_b64_tr_b16 v[84:85], v5 offset:6208
    v_mfma_f32_16x16x32_bf16 v[28:31], v[100:103], v[140:143], v[28:31]
    ds_read_b64_tr_b16 v[86:87], v5 offset:6976
    v_mfma_f32_16x16x32_bf16 v[32:35], v[104:107], v[140:143], v[32:35]
    ds_read_b64_tr_b16 v[88:89], v5 offset:6240
    v_mfma_f32_16x16x32_bf16 v[44:47], v[104:107], v[144:147], v[44:47]
    ds_read_b128 v[140:143], v1 offset:128
    v_mfma_f32_16x16x32_bf16 v[40:43], v[100:103], v[144:147], v[40:43]
    ds_read_b64_tr_b16 v[90:91], v5 offset:7008
    v_mfma_f32_16x16x32_bf16 v[36:39], v[96:99], v[144:147], v[36:39]
    ds_read_b64_tr_b16 v[92:93], v5 offset:6272
    v_mfma_f32_16x16x32_bf16 v[48:51], v[96:99], v[148:151], v[48:51]
    ds_read_b128 v[144:147], v1 offset:4032
    v_mfma_f32_16x16x32_bf16 v[52:55], v[100:103], v[148:151], v[52:55]
    ds_read_b64_tr_b16 v[94:95], v5 offset:7040
    v_mfma_f32_16x16x32_bf16 v[56:59], v[104:107], v[148:151], v[56:59]
    ds_read_b128 v[124:127], v1 offset:64
    v_mfma_f32_16x16x32_bf16 v[68:71], v[104:107], v[152:155], v[68:71]
    ds_read_b128 v[148:151], v1 offset:7936
    ds_read_b128 v[128:131], v1 offset:3968
    v_mfma_f32_16x16x32_bf16 v[64:67], v[100:103], v[152:155], v[64:67]
    ds_read_b128 v[132:135], v1 offset:7872
    v_mfma_f32_16x16x32_bf16 v[60:63], v[96:99], v[152:155], v[60:63]
    ds_read_b128 v[136:139], v1 offset:11776
    ds_read_b128 v[152:155], v1 offset:11840
L_mid4:
    s_waitcnt lgkmcnt(14)
    s_setprio 0
.p2align 3
    v_mfma_f32_16x16x32_bf16 v[24:27], v[72:75], v[108:111], v[24:27]
    ds_read_b64_tr_b16 v[96:97], v5 offset:12416
    v_mfma_f32_16x16x32_bf16 v[28:31], v[76:79], v[108:111], v[28:31]
    ds_read_b64_tr_b16 v[98:99], v5 offset:13184
    v_mfma_f32_16x16x32_bf16 v[32:35], v[80:83], v[108:111], v[32:35]
    ds_read_b64_tr_b16 v[100:101], v5 offset:12448
    v_mfma_f32_16x16x32_bf16 v[44:47], v[80:83], v[112:115], v[44:47]
    ds_read_b64_tr_b16 v[102:103], v5 offset:13216
    v_mfma_f32_16x16x32_bf16 v[40:43], v[76:79], v[112:115], v[40:43]
    ds_read_b64_tr_b16 v[104:105], v5 offset:12480
    v_mfma_f32_16x16x32_bf16 v[36:39], v[72:75], v[112:115], v[36:39]
    ds_read_b64_tr_b16 v[106:107], v5 offset:13248
    v_mfma_f32_16x16x32_bf16 v[48:51], v[72:75], v[116:119], v[48:51]
    s_add_u32 s35, s35, 1
    v_add_u32 v17, 3904, v1
    v_mfma_f32_16x16x32_bf16 v[52:55], v[76:79], v[116:119], v[52:55]
    s_and_b32 s36, s35, 3
    v_mov_b32 v1, v2
    v_mfma_f32_16x16x32_bf16 v[56:59], v[80:83], v[116:119], v[56:59]
    s_mul_i32 s36, s36, 18624
    v_mov_b32 v2, v3
    v_mfma_f32_16x16x32_bf16 v[68:71], v[80:83], v[120:123], v[68:71]
    v_mov_b32 v3, v17
    v_add_u32 v5, s36, v4
    v_mfma_f32_16x16x32_bf16 v[64:67], v[76:79], v[120:123], v[64:67]
    v_mfma_f32_16x16x32_bf16 v[60:63], v[72:75], v[120:123], v[60:63]
L_end4:
    s_bitcmp1_b32 s3, s35
    s_waitcnt vmcnt(0) lgkmcnt(0)
    s_cbranch_scc0 L_top4
    s_bitcmp1_b32 s99, s35
    s_cbranch_scc1 L_sp4
    s_barrier
    s_bitcmp1_b32 s39, s35
    s_cbranch_scc0 L_sp4
    s_call_b64 s[76:77], L_dma
L_sp4:
    s_bitcmp1_b32 s37, s35
    s_cbranch_scc1 L_g4
    s_cmp_lg_u32 s35, 9
    s_cbranch_scc1 L_body4
L_last4:
    s_setprio 3
    v_mfma_f32_16x16x32_bf16 v[24:27], v[84:87], v[124:127], v[24:27]
    s_add_u32 s96, s0, s29
    s_mul_i32 s96, s96, 224
    s_add_u32 s96, s96, s32
    v_mfma_f32_16x16x32_bf16 v[28:31], v[88:91], v[124:127], v[28:31]
    s_mul_i32 s96, s96, 192
    s_add_u32 s97, s96, 86016
    s_add_u32 s98, s29, 2
    v_mfma_f32_16x16x32_bf16 v[32:35], v[92:95], v[124:127], v[32:35]
    v_mfma_f32_16x16x32_bf16 v[24:27], v[96:99], v[140:143], v[24:27]
    v_mfma_f32_16x16x32_bf16 v[28:31], v[100:103], v[140:143], v[28:31]
    v_mfma_f32_16x16x32_bf16 v[32:35], v[104:107], v[140:143], v[32:35]
    v_mfma_f32_16x16x32_bf16 v[36:39], v[84:87], v[128:131], v[36:39]
    v_mfma_f32_16x16x32_bf16 v[40:43], v[88:91], v[128:131], v[40:43]
    v_mfma_f32_16x16x32_bf16 v[44:47], v[92:95], v[128:131], v[44:47]
    s_nop 2
    v_cvt_pk_bf16_f32 v156, v24, v25
    v_cvt_pk_bf16_f32 v157, v26, v27
    ds_write_b64 v21, v[156:157] offset:0
    v_mfma_f32_16x16x32_bf16 v[36:39], v[96:99], v[144:147], v[36:39]
    v_cvt_pk_bf16_f32 v158, v28, v29
    v_cvt_pk_bf16_f32 v159, v30, v31
    ds_write_b64 v21, v[158:159] offset:32
    v_mfma_f32_16x16x32_bf16 v[40:43], v[100:103], v[144:147], v[40:43]
    v_cvt_pk_bf16_f32 v160, v32, v33
    v_cvt_pk_bf16_f32 v161, v34, v35
    ds_write_b64 v21, v[160:161] offset:64
    v_mfma_f32_16x16x32_bf16 v[44:47], v[104:107], v[144:147], v[44:47]
    v_mfma_f32_16x16x32_bf16 v[48:51], v[84:87], v[132:135], v[48:51]
    v_mfma_f32_16x16x32_bf16 v[52:55], v[88:91], v[132:135], v[52:55]
    v_mfma_f32_16x16x32_bf16 v[56:59], v[92:95], v[132:135], v[56:59]
    v_cvt_pk_bf16_f32 v162, v36, v37
    v_cvt_pk_bf16_f32 v163, v38, v39
    ds_write_b64 v21, v[162:163] offset:3904
    v_mfma_f32_16x16x32_bf16 v[48:51], v[96:99], v[148:151], v[48:51]
    v_cvt_pk_bf16_f32 v164, v40, v41
    v_cvt_pk_bf16_f32 v165, v42, v43
    ds_write_b64 v21, v[164:165] offset:3936
    v_mfma_f32_16x16x32_bf16 v[52:55], v[100:103], v[148:151], v[52:55]
    v_cvt_pk_bf16_f32 v166, v44, v45
    v_cvt_pk_bf16_f32 v167, v46, v47
    ds_write_b64 v21, v[166:167] offset:3968
    v_mfma_f32_16x16x32_bf16 v[56:59], v[104:107], v[148:151], v[56:59]
    v_mov_b32 v17, 1
    ds_write_b32 v254, v17
    v_mfma_f32_16x16x32_bf16 v[60:63], v[84:87], v[136:139], v[60:63]
    v_mfma_f32_16x16x32_bf16 v[64:67], v[88:91], v[136:139], v[64:67]
    v_mfma_f32_16x16x32_bf16 v[68:71], v[92:95], v[136:139], v[68:71]
    v_cvt_pk_bf16_f32 v168, v48, v49
    v_cvt_pk_bf16_f32 v169, v50, v51
    ds_write_b64 v21, v[168:169] offset:7808
    v_mfma_f32_16x16x32_bf16 v[60:63], v[96:99], v[152:155], v[60:63]
    v_cvt_pk_bf16_f32 v170, v52, v53
    v_cvt_pk_bf16_f32 v171, v54, v55
    ds_write_b64 v21, v[170:171] offset:7840
    v_mfma_f32_16x16x32_bf16 v[64:67], v[100:103], v[152:155], v[64:67]
    v_cvt_pk_bf16_f32 v172, v56, v57
    v_cvt_pk_bf16_f32 v173, v58, v59
    ds_write_b64 v21, v[172:173] offset:7872
    v_mfma_f32_16x16x32_bf16 v[68:71], v[104:107], v[152:155], v[68:71]
    v_cvt_pk_bf16_f32 v174, v60, v61
    v_cvt_pk_bf16_f32 v175, v62, v63
    ds_write_b64 v21, v[174:175] offset:11712
    s_nop 0
    v_cvt_pk_bf16_f32 v176, v64, v65
    v_cvt_pk_bf16_f32 v177, v66, v67
    ds_write_b64 v21, v[176:177] offset:11744
    s_nop 0
    v_cvt_pk_bf16_f32 v178, v68, v69
    v_cvt_pk_bf16_f32 v179, v70, v71
    ds_write_b64 v21, v[178:179] offset:11776
    s_branch L_epi
.p2align 3
L_top3:
    s_barrier
L_body3:
    s_setprio 2
.p2align 3
    v_mfma_f32_16x16x32_bf16 v[24:27], v[84:87], v[124:127], v[24:27]
    ds_read_b128 v[108:111], v1 offset:0
    v_mfma_f32_16x16x32_bf16 v[28:31], v[88:91], v[124:127], v[28:31]
    ds_read_b64_tr_b16 v[72:73], v5 offset:0
    v_mfma_f32_16x16x32_bf16 v[32:35], v[92:95], v[124:127], v[32:35]
    ds_read_b64_tr_b16 v[74:75], v5 offset:768
    v_mfma_f32_16x16x32_bf16 v[44:47], v[92:95], v[128:131], v[44:47]
    ds_read_b64_tr_b16 v[76:77], v5 offset:32
    v_mfma_f32_16x16x32_bf16 v[40:43], v[88:91], v[128:131], v[40:43]
    ds_read_b64_tr_b16 v[78:79], v5 offset:800
    v_mfma_f32_16x16x32_bf16 v[36:39], v[84:87], v[128:131], v[36:39]
    ds_read_b64_tr_b16 v[80:81], v5 offset:64
    v_mfma_f32_16x16x32_bf16 v[48:51], v[84:87], v[132:135], v[48:51]
    ds_read_b64_tr_b16 v[82:83], v5 offset:832
    v_mfma_f32_16x16x32_bf16 v[52:55], v[88:91], v[132:135], v[52:55]
    ds_read_b128 v[112:115], v1 offset:3904
    v_mfma_f32_16x16x32_bf16 v[56:59], v[92:95], v[132:135], v[56:59]
    ds_read_b128 v[116:119], v1 offset:7808
    s_setprio 1
.p2align 3
    v_mfma_f32_16x16x32_bf16 v[24:27], v[96:99], v[140:143], v[24:27]
    ds_read_b64_tr_b16 v[84:85], v5 offset:6208
    v_mfma_f32_16x16x32_bf16 v[28:31], v[100:103], v[140:143], v[28:31]
    ds_read_b64_tr_b16 v[86:87], v5 offset:6976
    v_mfma_f32_16x16x32_bf16 v[32:35], v[104:107], v[140:143], v[32:35]
    ds_read_b64_tr_b16 v[88:89], v5 offset:6240
    v_mfma_f32_16x16x32_bf16 v[44:47], v[104:107], v[144:147], v[44:47]
    ds_read_b128 v[140:143], v1 offset:128
    ds_read_b64_tr_b16 v[90:91], v5 offset:7008
    v_mfma_f32_16x16x32_bf16 v[40:43], v[100:103], v[144:147], v[40:43]
    ds_read_b64_tr_b16 v[92:93], v5 offset:6272
    v_mfma_f32_16x16x32_bf16 v[36:39], v[96:99], v[144:147], v[36:39]
    ds_read_b64_tr_b16 v[94:95], v5 offset:7040
    v_mfma_f32_16x16x32_bf16 v[48:51], v[96:99], v[148:151], v[48:51]
    ds_read_b128 v[144:147], v1 offset:4032
    ds_read_b128 v[124:127], v1 offset:64
    v_mfma_f32_16x16x32_bf16 v[52:55], v[100:103], v[148:151], v[52:55]
    ds_read_b128 v[128:131], v1 offset:3968
    v_mfma_f32_16x16x32_bf16 v[56:59], v[104:107], v[148:151], v[56:59]
    ds_read_b128 v[132:135], v1 offset:7872
    ds_read_b128 v[148:151], v1 offset:7936
L_mid3:
    s_waitcnt lgkmcnt(12)
    s_setprio 0
.p2align 3
    v_mfma_f32_16x16x32_bf16 v[24:27], v[72:75], v[108:111], v[24:27]
    ds_read_b64_tr_b16 v[96:97], v5 offset:12416
    v_mfma_f32_16x16x32_bf16 v[28:31], v[76:79], v[108:111], v[28:31]
    ds_read_b64_tr_b16 v[98:99], v5 offset:13184
    v_mfma_f32_16x16x32_bf16 v[32:35], v[80:83], v[108:111], v[32:35]
    ds_read_b64_tr_b16 v[100:101], v5 offset:12448
    v_mfma_f32_16x16x32_bf16 v[44:47], v[80:83], v[112:115], v[44:47]
    ds_read_b64_tr_b16 v[102:103], v5 offset:13216
    v_mfma_f32_16x16x32_bf16 v[40:43], v[76:79], v[112:115], v[40:43]
    ds_read_b64_tr_b16 v[104:105], v5 offset:12480
    v_mfma_f32_16x16x32_bf16 v[36:39], v[72:75], v[112:115], v[36:39]
    ds_read_b64_tr_b16 v[106:107], v5 offset:13248
    v_mfma_f32_16x16x32_bf16 v[48:51], v[72:75], v[116:119], v[48:51]
    s_add_u32 s35, s35, 1
    v_add_u32 v17, 3904, v1
    v_mfma_f32_16x16x32_bf16 v[52:55], v[76:79], v[116:119], v[52:55]
    s_and_b32 s36, s35, 3
    v_mov_b32 v1, v2
    v_mfma_f32_16x16x32_bf16 v[56:59], v[80:83], v[116:119], v[56:59]
    s_mul_i32 s36, s36, 18624
    v_mov_b32 v2, v3
    v_mov_b32 v3, v17
    v_add_u32 v5, s36, v4
L_end3:
    s_bitcmp1_b32 s3, s35
    s_waitcnt vmcnt(0) lgkmcnt(0)
    s_cbranch_scc0 L_top3
    s_bitcmp1_b32 s99, s35
    s_cbranch_scc1 L_sp3
    s_barrier
    s_bitcmp1_b32 s39, s35
    s_cbranch_scc0 L_sp3
    s_call_b64 s[76:77], L_dma
L_sp3:
    s_bitcmp1_b32 s37, s35
    s_cbranch_scc1 L_g3
    s_cmp_lg_u32 s35, 9
    s_cbranch_scc1 L_body3
L_last3:
    s_setprio 3
    v_mfma_f32_16x16x32_bf16 v[24:27], v[84:87], v[124:127], v[24:27]
    s_add_u32 s96, s0, s29
    s_mul_i32 s96, s96, 224
    s_add_u32 s96, s96, s32
    v_mfma_f32_16x16x32_bf16 v[28:31], v[88:91], v[124:127], v[28:31]
    s_mul_i32 s96, s96, 192
    s_add_u32 s97, s96, 86016
    s_add_u32 s98, s29, 2
    v_mfma_f32_16x16x32_bf16 v[32:35], v[92:95], v[124:127], v[32:35]
    v_mfma_f32_16x16x32_bf16 v[24:27], v[96:99], v[140:143], v[24:27]
    v_mfma_f32_16x16x32_bf16 v[28:31], v[100:103], v[140:143], v[28:31]
    v_mfma_f32_16x16x32_bf16 v[32:35], v[104:107], v[140:143], v[32:35]
    v_mfma_f32_16x16x32_bf16 v[36:39], v[84:87], v[128:131], v[36:39]
    v_mfma_f32_16x16x32_bf16 v[40:43], v[88:91], v[128:131], v[40:43]
    v_mfma_f32_16x16x32_bf16 v[44:47], v[92:95], v[128:131], v[44:47]
    s_nop 2
    v_cvt_pk_bf16_f32 v156, v24, v25
    v_cvt_pk_bf16_f32 v157, v26, v27
    ds_write_b64 v21, v[156:157] offset:0
    v_mfma_f32_16x16x32_bf16 v[36:39], v[96:99], v[144:147], v[36:39]
    v_cvt_pk_bf16_f32 v158, v28, v29
    v_cvt_pk_bf16_f32 v159, v30, v31
    ds_write_b64 v21, v[158:159] offset:32
    v_mfma_f32_16x16x32_bf16 v[40:43], v[100:103], v[144:147], v[40:43]
    v_cvt_pk_bf16_f32 v160, v32, v33
    v_cvt_pk_bf16_f32 v161, v34, v35
    ds_write_b64 v21, v[160:161] offset:64
    v_mfma_f32_16x16x32_bf16 v[44:47], v[104:107], v[144:147], v[44:47]
    v_mfma_f32_16x16x32_bf16 v[48:51], v[84:87], v[132:135], v[48:51]
    v_mfma_f32_16x16x32_bf16 v[52:55], v[88:91], v[132:135], v[52:55]
    v_mfma_f32_16x16x32_bf16 v[56:59], v[92:95], v[132:135], v[56:59]
    v_cvt_pk_bf16_f32 v162, v36, v37
    v_cvt_pk_bf16_f32 v163, v38, v39
    ds_write_b64 v21, v[162:163] offset:3904
    v_mfma_f32_16x16x32_bf16 v[48:51], v[96:99], v[148:151], v[48:51]
    v_cvt_pk_bf16_f32 v164, v40, v41
    v_cvt_pk_bf16_f32 v165, v42, v43
    ds_write_b64 v21, v[164:165] offset:3936
    v_mfma_f32_16x16x32_bf16 v[52:55], v[100:103], v[148:151], v[52:55]
    v_cvt_pk_bf16_f32 v166, v44, v45
    v_cvt_pk_bf16_f32 v167, v46, v47
    ds_write_b64 v21, v[166:167] offset:3968
    v_mfma_f32_16x16x32_bf16 v[56:59], v[104:107], v[148:151], v[56:59]
    v_mov_b32 v17, 1
    ds_write_b32 v254, v17
    v_cvt_pk_bf16_f32 v168, v48, v49
    v_cvt_pk_bf16_f32 v169, v50, v51
    ds_write_b64 v21, v[168:169] offset:7808
    v_cvt_pk_bf16_f32 v170, v52, v53
    v_cvt_pk_bf16_f32 v171, v54, v55
    ds_write_b64 v21, v[170:171] offset:7840
    v_cvt_pk_bf16_f32 v172, v56, v57
    v_cvt_pk_bf16_f32 v173, v58, v59
    ds_write_b64 v21, v[172:173] offset:7872
L_epi:
    v_mov_b32 v17, 2
    ds_write_b32 v254, v17
    s_setprio 0
    s_cmp_ge_u32 s29, s30
    s_cbranch_scc1 L_fin
L_t1:
    ds_read_b32 v236, v255
    ds_read_b128 v[180:183], v248 offset:0
    ds_read_b128 v[184:187], v249 offset:0
    ds_read_b128 v[188:191], v250 offset:0
    s_waitcnt lgkmcnt(3)
    v_cmp_eq_u32 vcc, 0, v236
    s_cbranch_vccnz L_t1
    s_cmp_ge_u32 s98, s30
    s_cbranch_scc1 L_t3
    ds_read_b32 v237, v255
    ds_read_b128 v[192:195], v248 offset:7808
    ds_read_b128 v[196:199], v249 offset:7808
    ds_read_b128 v[200:203], v250 offset:7808
    s_waitcnt lgkmcnt(6)
    buffer_store_dwordx4 v[180:183], v14, s[16:19], s96 offen offset:0 sc1
    s_waitcnt lgkmcnt(5)
    buffer_store_dwordx4 v[184:187], v14, s[16:19], s96 offen offset:1024 sc1
    s_waitcnt lgkmcnt(4)
    buffer_store_dwordx4 v[188:191], v14, s[16:19], s96 offen offset:2048 sc1
L_t2:
    s_waitcnt lgkmcnt(3)
    v_cmp_ne_u32 vcc, 2, v237
    s_cbranch_vccnz L_t4
    s_waitcnt lgkmcnt(2)
    buffer_store_dwordx4 v[192:195], v14, s[16:19], s97 offen offset:0 sc1
    s_waitcnt lgkmcnt(1)
    buffer_store_dwordx4 v[196:199], v14, s[16:19], s97 offen offset:1024 sc1
    s_waitcnt lgkmcnt(0)
    buffer_store_dwordx4 v[200:203], v14, s[16:19], s97 offen offset:2048 sc1
    s_branch L_fin
L_t4:
    ds_read_b32 v237, v255
    ds_read_b128 v[192:195], v248 offset:7808
    ds_read_b128 v[196:199], v249 offset:7808
    ds_read_b128 v[200:203], v250 offset:7808
    s_branch L_t2
L_t3:
    s_waitcnt lgkmcnt(2)
    buffer_store_dwordx4 v[180:183], v14, s[16:19], s96 offen offset:0 sc1
    s_waitcnt lgkmcnt(1)
    buffer_store_dwordx4 v[184:187], v14, s[16:19], s96 offen offset:1024 sc1
    s_waitcnt lgkmcnt(0)
    buffer_store_dwordx4 v[188:191], v14, s[16:19], s96 offen offset:2048 sc1
L_fin:
L_end:
    s_endpgm
L_dma:
    s_add_u32 s98, s35, 3
    s_and_b32 s98, s98, 3
    s_mul_i32 s98, s98, 18624
L_dma2:
    s_add_u32 s97, s88, s98
    s_add_u32 m0, s97, 0
    s_add_u32 s96, s95, 0
    buffer_load_dwordx4 v19, s[12:15], s96 offen lds
    s_add_u32 s97, s89, s98
    s_add_u32 m0, s97, 4128
    s_add_u32 s96, s95, 4096
    buffer_load_dwordx4 v19, s[12:15], s96 offen lds
    s_add_u32 s97, s90, s98
    s_add_u32 m0, s97, 8256
    s_add_u32 s96, s95, 8192
    buffer_load_dwordx4 v19, s[12:15], s96 offen lds
    s_add_u32 s97, s88, s98
    s_add_u32 m0, s97, 12416
    s_add_u32 s96, s95, 12288
    buffer_load_dwordx4 v19, s[12:15], s96 offen lds
    s_bitcmp1_b32 s28, 1
    s_cbranch_scc1 L_nd2
    s_add_u32 s97, s89, s98
    s_add_u32 m0, s97, 16544
    s_add_u32 s96, s95, 16384
    buffer_load_dwordx4 v19, s[12:15], s96 offen lds
L_nd2:
    s_add_u32 s95, s95, 18432
    s_cmp_eq_u32 s35, 1
    s_cbranch_scc0 L_nd3
    s_cmp_lt_u32 s23, 268435456
    s_cbranch_scc1 L_nd3
    s_min_i32 s96, s20, s21
    s_add_u32 m0, s94, 58560
    s_mov_b64 exec, s[92:93]
    s_add_u32 s20, s20, 43008
    buffer_load_dwordx4 v20, s[4:7], s96 offen lds
    s_mov_b64 exec, -1
    s_cmp_lt_u32 s23, 285212672
    s_cbranch_scc1 L_nd3
    s_min_i32 s96, s20, s21
    s_add_u32 m0, s94, 62464
    s_mov_b64 exec, s[92:93]
    s_add_u32 s20, s20, 43008
    buffer_load_dwordx4 v20, s[4:7], s96 offen lds
    s_mov_b64 exec, -1
L_nd3:
    s_setpc_b64 s[76:77]
.p2align 3
L_top0:
    s_barrier
L_body0:
L_mid0:
    s_add_u32 s35, s35, 1
    s_and_b32 s36, s35, 3
    s_mul_i32 s36, s36, 18624
L_end0:
    s_bitcmp1_b32 s3, s35
    s_waitcnt vmcnt(0) lgkmcnt(0)
    s_cbranch_scc0 L_top0
    s_bitcmp1_b32 s99, s35
    s_cbranch_scc1 L_sp0
    s_barrier
    s_bitcmp1_b32 s39, s35
    s_cbranch_scc0 L_sp0
    s_call_b64 s[76:77], L_dma
L_sp0:
    s_cmp_lg_u32 s35, 9
    s_cbranch_scc1 L_body0
L_last0:
    s_setprio 3
    s_add_u32 s96, s0, s29
    s_mul_i32 s96, s96, 224
    s_add_u32 s96, s96, s32
    s_mul_i32 s96, s96, 192
    s_add_u32 s97, s96, 86016
    s_add_u32 s98, s29, 2
    s_branch L_epi
L_nf2:
    ds_read_b64_tr_b16 v[84:85], v5 offset:6208
    ds_read_b64_tr_b16 v[86:87], v5 offset:6976
    ds_read_b64_tr_b16 v[88:89], v5 offset:6240
    ds_read_b64_tr_b16 v[90:91], v5 offset:7008
    ds_read_b64_tr_b16 v[92:93], v5 offset:6272
    ds_read_b64_tr_b16 v[94:95], v5 offset:7040
    ds_read_b128 v[124:127], v1 offset:64
    ds_read_b128 v[128:131], v1 offset:3968
    ds_read_b128 v[132:135], v1 offset:7872
    ds_read_b128 v[136:139], v1 offset:11776
    ds_read_b128 v[140:143], v1 offset:128
    ds_read_b128 v[144:147], v1 offset:4032
    ds_read_b128 v[148:151], v1 offset:7936
    ds_read_b128 v[152:155], v1 offset:11840
L_fdisp:
    s_cmp_eq_u32 s30, 3
    s_cbranch_scc1 L_mid3
    s_cmp_eq_u32 s30, 2
    s_cbranch_scc1 L_mid2
    s_cmp_eq_u32 s30, 1
    s_cbranch_scc1 L_mid1
    s_cmp_eq_u32 s30, 0
    s_cbranch_scc1 L_mid0
    s_branch L_mid4
.p2align 12
L_exact:
    s_mov_b32 exec_hi, 0xffff
    v_mov_b32 v229, v220
    v_lshlrev_b32 v72, 16, v204
    v_lshlrev_b32 v156, 16, v205
    v_lshlrev_b32 v180, 16, v206
    v_and_b32 v73, 0xffff0000, v204
    v_and_b32 v157, 0xffff0000, v205
    v_and_b32 v181, 0xffff0000, v206
    v_cvt_pk_bf16_f32 v74, v229, v221
    v_cvt_pk_bf16_f32 v158, v229, v222
    v_cvt_pk_bf16_f32 v182, v229, v223
    v_add_f32 v72, v72, v229
    v_add_f32 v156, v156, v229
    v_add_f32 v180, v180, v229
    v_add_f32 v73, v73, v221
    v_add_f32 v157, v157, v222
    v_add_f32 v181, v181, v223
    v_cvt_pk_bf16_f32 v72, v72, v73
    v_cvt_pk_bf16_f32 v156, v156, v157
    v_cvt_pk_bf16_f32 v180, v180, v181
    v_cmp_ne_u32 s[40:41], v72, v74
    v_cmp_ne_u32 s[42:43], v156, v158
    v_cmp_ne_u32 s[44:45], v180, v182
    v_add_f32 v229, 1.0, v229
    v_lshlrev_b32 v72, 16, v208
    v_lshlrev_b32 v156, 16, v209
    v_lshlrev_b32 v180, 16, v210
    v_and_b32 v73, 0xffff0000, v208
    v_and_b32 v157, 0xffff0000, v209
    v_and_b32 v181, 0xffff0000, v210
    v_cvt_pk_bf16_f32 v74, v229, v221
    v_cvt_pk_bf16_f32 v158, v229, v222
    v_cvt_pk_bf16_f32 v182, v229, v223
    v_add_f32 v72, v72, v229
    v_add_f32 v156, v156, v229
    v_add_f32 v180, v180, v229
    v_add_f32 v73, v73, v221
    v_add_f32 v157, v157, v222
    v_add_f32 v181, v181, v223
    v_cvt_pk_bf16_f32 v72, v72, v73
    v_cvt_pk_bf16_f32 v156, v156, v157
    v_cvt_pk_bf16_f32 v180, v180, v181
    v_cmp_ne_u32 s[46:47], v72, v74
    v_cmp_ne_u32 s[48:49], v156, v158
    v_cmp_ne_u32 s[50:51], v180, v182
    v_add_f32 v229, 1.0, v229
    v_lshlrev_b32 v72, 16, v212
    v_lshlrev_b32 v156, 16, v213
    v_lshlrev_b32 v180, 16, v214
    v_and_b32 v73, 0xffff0000, v212
    v_and_b32 v157, 0xffff0000, v213
    v_and_b32 v181, 0xffff0000, v214
    v_cvt_pk_bf16_f32 v74, v229, v221
    v_cvt_pk_bf16_f32 v158, v229, v222
    v_cvt_pk_bf16_f32 v182, v229, v223
    v_add_f32 v72, v72, v229
    v_add_f32 v156, v156, v229
    v_add_f32 v180, v180, v229
    v_add_f32 v73, v73, v221
    v_add_f32 v157, v157, v222
    v_add_f32 v181, v181, v223
    v_cvt_pk_bf16_f32 v72, v72, v73
    v_cvt_pk_bf16_f32 v156, v156, v157
    v_cvt_pk_bf16_f32 v180, v180, v181
    v_cmp_ne_u32 s[52:53], v72, v74
    v_cmp_ne_u32 s[54:55], v156, v158
    v_cmp_ne_u32 s[56:57], v180, v182
    v_add_f32 v229, 1.0, v229
    v_lshlrev_b32 v72, 16, v216
    v_lshlrev_b32 v156, 16, v217
    v_lshlrev_b32 v180, 16, v218
    v_and_b32 v73, 0xffff0000, v216
    v_and_b32 v157, 0xffff0000, v217
    v_and_b32 v181, 0xffff0000, v218
    v_cvt_pk_bf16_f32 v74, v229, v221
    v_cvt_pk_bf16_f32 v158, v229, v222
    v_cvt_pk_bf16_f32 v182, v229, v223
    v_add_f32 v72, v72, v229
    v_add_f32 v156, v156, v229
    v_add_f32 v180, v180, v229
    v_add_f32 v73, v73, v221
    v_add_f32 v157, v157, v222
    v_add_f32 v181, v181, v223
    v_cvt_pk_bf16_f32 v72, v72, v73
    v_cvt_pk_bf16_f32 v156, v156, v157
    v_cvt_pk_bf16_f32 v180, v180, v181
    v_cmp_ne_u32 s[58:59], v72, v74
    v_cmp_ne_u32 s[60:61], v156, v158
    v_cmp_ne_u32 s[62:63], v180, v182
    s_mov_b32 exec_hi, -1
    v_mov_b32 v73, 0
    v_mov_b32 v72, 0
    v_addc_co_u32 v73, s[64:65], 0, v73, s[40:41]
    v_bfe_u32 v156, v14, 6, 2
    v_addc_co_u32 v72, s[64:65], 0, v72, s[42:43]
    v_bfe_u32 v157, v14, 4, 2
    v_addc_co_u32 v73, s[64:65], 0, v73, s[44:45]
    v_lshrrev_b32 v158, 8, v14
    v_addc_co_u32 v72, s[64:65], 0, v72, s[46:47]
    v_mov_b32 v159, 0x0c0c0100
    v_addc_co_u32 v73, s[64:65], 0, v73, s[48:49]
    v_mov_b32 v160, 0x01000c0c
    v_addc_co_u32 v72, s[64:65], 0, v72, s[50:51]
    v_and_b32 v161, 1, v156
    v_addc_co_u32 v73, s[64:65], 0, v73, s[52:53]
    v_cmp_eq_u32 vcc, 1, v161
    v_addc_co_u32 v72, s[64:65], 0, v72, s[54:55]
    v_cmp_eq_u32 s[70:71], v157, v158
    v_addc_co_u32 v73, s[64:65], 0, v73, s[56:57]
    v_cmp_gt_u32 s[72:73], 2, v156
    v_addc_co_u32 v72, s[64:65], 0, v72, s[58:59]
    v_and_b32 v161, 1, v157
    v_addc_co_u32 v73, s[64:65], 0, v73, s[60:61]
    v_lshrrev_b32 v157, 1, v157
    v_addc_co_u32 v72, s[64:65], 0, v72, s[62:63]
    v_lshl_add_u32 v157, v161, 2, v157
    v_add_u32 v73, v73, v72
    v_lshlrev_b32 v6, 3, v157
    v_cmp_ne_u32 s[64:65], 0, v73
    v_cndmask_b32 v159, v159, v160, vcc
    v_mov_b32 v160, 0x0202
    v_mov_b32 v157, 0x02020000
    v_add_u32 v7, 16, v6
    v_cndmask_b32 v160, v160, v157, vcc
    s_andn2_b64 s[74:75], s[70:71], s[72:73]
    s_and_b64 s[72:73], s[70:71], s[72:73]
    v_add_u32 v160, v159, v160
    v_mov_b32 v157, 0x0c0c0c0c
    v_cndmask_b32 v8, v157, v159, s[72:73]
    v_cndmask_b32 v9, v157, v159, s[74:75]
    v_cndmask_b32 v10, v157, v160, s[72:73]
    v_cndmask_b32 v11, v157, v160, s[74:75]
    v_and_b32 v159, 1, v158
    v_lshrrev_b32 v160, 1, v158
    v_lshl_add_u32 v159, v159, 2, v160
    v_lshlrev_b32 v16, 3, v159
    v_lshl_add_u32 v251, v158, 2, v156
    v_mov_b32 v228, 0xf400f40
    s_mov_b32 s91, 0x435f435f
    s_cmp_eq_u64 s[64:65], 0
    s_cbranch_scc1 L_gpr
    s_lshr_b32 s97, s28, 1
    s_mul_i32 s36, s97, 576
    s_lshl_b32 s97, s97, 4
    s_lshr_b64 s[70:71], s[24:25], s97
    s_bfe_u32 s69, s70, 0x5000b
    s_and_b32 s68, s70, 0x7ff
    s_lshl_b32 s69, s69, 2
    s_lshl_b32 s68, s68, 6
    s_add_u32 s36, s36, 149248
    s_mov_b32 s66, s68
    s_add_u32 s67, s68, 1152
    s_lshl_b32 s96, s69, 4
    s_add_u32 s68, s67, s96
    v_cmp_eq_u32 s[64:65], 0, v230
    v_lshlrev_b32 v74, 16, v73
    s_nop 0
    v_cndmask_b32 v73, v74, v73, s[64:65]
    v_mov_b32 v74, v73
    s_sub_u32 s96, s0, s33
    s_sub_u32 s96, s96, 1
    v_add_u32 v76, s96, v230
    v_mul_u32_u24 v76, 244, v76
    v_mul_u32_u24 v77, 48, v230
    v_add_u32 v77, v77, v231
    v_lshl_add_u32 v77, v77, 3, s66
    v_add_u32_dpp v74, v74, v74 row_shr:1 row_mask:0xf bank_mask:0xf bound_ctrl:0
    v_add_u32 v180, 1, v231
    v_bfe_u32 v181, v180, 2, 2
    v_mad_u32_u24 v180, v180, 12, v76
    v_add_u32_dpp v74, v74, v74 row_shr:2 row_mask:0xf bank_mask:0xf bound_ctrl:0
    v_add_u32 v180, v180, v181
    v_mul_u32_u24 v180, 0x10001, v180
    v_add_u32 v180, 0xf40000, v180
    v_add_u32_dpp v74, v74, v74 row_shr:4 row_mask:0xf bank_mask:0xf bound_ctrl:0
    v_add_u32 v181, 0x1e801e8, v180
    v_add_u32 v184, 2, v231
    v_bfe_u32 v185, v184, 2, 2
    v_add_u32_dpp v74, v74, v74 row_shr:8 row_mask:0xf bank_mask:0xf bound_ctrl:0
    v_mad_u32_u24 v184, v184, 12, v76
    v_add_u32 v184, v184, v185
    v_mul_u32_u24 v184, 0x10001, v184
    v_add_u32_dpp v74, v74, v74 row_bcast:15 row_mask:0xa bank_mask:0xf
    v_add_u32 v184, 0xf40000, v184
    v_add_u32 v185, 0x1e801e8, v184
    v_add_u32 v188, 3, v231
    v_add_u32_dpp v74, v74, v74 row_bcast:31 row_mask:0xc bank_mask:0xf
    v_bfe_u32 v189, v188, 2, 2
    v_mad_u32_u24 v188, v188, 12, v76
    v_add_u32 v188, v188, v189
    v_mul_u32_u24 v188, 0x10001, v188
    v_add_u32 v188, 0xf40000, v188
    v_add_u32 v189, 0x1e801e8, v188
    v_readlane_b32 s27, v74, 63
    v_sub_u32 v74, v74, v73
    s_and_b32 s26, s27, 0xffff
    s_lshr_b32 s27, s27, 16
    s_add_u32 s27, s27, s26
    s_cmp_gt_u32 s27, s69
    s_cbranch_scc1 L_table
    s_mov_b32 exec_hi, 0xffff
    v_lshrrev_b32 v79, 16, v74
    v_and_b32 v74, 0xffff, v74
    v_add_u32 v79, s26, v79
    v_cndmask_b32 v74, v79, v74, s[64:65]
    v_lshl_or_b32 v75, v230, 8, v231
    v_lshl_add_u32 v79, v74, 3, s36
    ds_write_b64 v77, v[180:181] offset:0
    ds_write_b64 v77, v[184:185] offset:128
    ds_write_b64 v77, v[188:189] offset:256
    s_mov_b32 s38, 1
    s_mov_b32 exec_hi, -1
    s_setpc_b64 s[76:77]
L_list3:
    s_mov_b64 exec, s[40:41]
    s_cbranch_execz L_lb00
    v_add_u32 v78, 0x0, v75
    v_add_u32 v79, 8, v79
    ds_write2_b32 v79, v204, v78 offset1:1
L_lb00:
    s_mov_b64 exec, s[42:43]
    s_cbranch_execz L_lb01
    v_add_u32 v78, 0x1000000, v75
    v_add_u32 v79, 8, v79
    ds_write2_b32 v79, v205, v78 offset1:1
L_lb01:
    s_mov_b64 exec, s[44:45]
    s_cbranch_execz L_lb02
    v_add_u32 v78, 0x2000000, v75
    v_add_u32 v79, 8, v79
    ds_write2_b32 v79, v206, v78 offset1:1
L_lb02:
    s_mov_b64 exec, s[46:47]
    s_cbranch_execz L_lb10
    v_add_u32 v78, 0x10000, v75
    v_add_u32 v79, 8, v79
    ds_write2_b32 v79, v208, v78 offset1:1
L_lb10:
    s_mov_b64 exec, s[48:49]
    s_cbranch_execz L_lb11
    v_add_u32 v78, 0x1010000, v75
    v_add_u32 v79, 8, v79
    ds_write2_b32 v79, v209, v78 offset1:1
L_lb11:
    s_mov_b64 exec, s[50:51]
    s_cbranch_execz L_lb12
    v_add_u32 v78, 0x2010000, v75
    v_add_u32 v79, 8, v79
    ds_write2_b32 v79, v210, v78 offset1:1
L_lb12:
    s_mov_b64 exec, s[52:53]
    s_cbranch_execz L_lb20
    v_add_u32 v78, 0x20000, v75
    v_add_u32 v79, 8, v79
    ds_write2_b32 v79, v212, v78 offset1:1
L_lb20:
    s_mov_b64 exec, s[54:55]
    s_cbranch_execz L_lb21
    v_add_u32 v78, 0x1020000, v75
    v_add_u32 v79, 8, v79
    ds_write2_b32 v79, v213, v78 offset1:1
L_lb21:
    s_mov_b64 exec, s[56:57]
    s_cbranch_execz L_lb22
    v_add_u32 v78, 0x2020000, v75
    v_add_u32 v79, 8, v79
    ds_write2_b32 v79, v214, v78 offset1:1
L_lb22:
    s_mov_b64 exec, s[58:59]
    s_cbranch_execz L_lb30
    v_add_u32 v78, 0x30000, v75
    v_add_u32 v79, 8, v79
    ds_write2_b32 v79, v216, v78 offset1:1
L_lb30:
    s_mov_b64 exec, s[60:61]
    s_cbranch_execz L_lb31
    v_add_u32 v78, 0x1030000, v75
    v_add_u32 v79, 8, v79
    ds_write2_b32 v79, v217, v78 offset1:1
L_lb31:
    s_mov_b64 exec, s[62:63]
    s_cbranch_execz L_lb32
    v_add_u32 v78, 0x2030000, v75
    v_add_u32 v79, 8, v79
    ds_write2_b32 v79, v218, v78 offset1:1
L_lb32:
    s_mov_b64 exec, -1
    s_sub_u32 s96, s27, 1
    v_lshrrev_b32 v78, 4, v14
    v_min_u32 v78, s96, v78
    v_lshl_add_u32 v79, v78, 3, s36
    ds_read_b64 v[158:159], v79 offset:8
    v_lshl_add_u32 v227, v78, 4, s67
    s_lshr_b32 s96, s68, 4
    v_bfe_u32 v161, v78, 1, 2
    v_mad_u32_u24 v78, v78, 12, s96
    v_add_u32 v161, v161, v78
    s_sub_u32 s97, s32, 1
    s_sub_u32 s98, s0, 1
    s_bfe_u32 s96, s23, 0x50018
    s_sub_u32 s96, s96, 1
    s_bfe_u32 s73, s23, 0x40014
    s_cmp_lt_u32 s28, 4
    s_cselect_b32 s70, 7, 14
    s_cselect_b32 s71, 14, 16
    s_cselect_b32 s72, 14, 16
    s_cselect_b32 s73, 0, s73
    s_min_u32 s70, s70, s96
    s_min_u32 s71, s71, s96
    s_min_u32 s72, s72, s96
    s_mov_b32 s64, s70
    s_waitcnt lgkmcnt(0)
    v_bfe_u32 v156, v159, 8, 8
    v_and_b32 v78, 0xff, v159
    v_bfe_u32 v79, v159, 16, 8
    v_lshrrev_b32 v159, 24, v159
    v_mad_u32_u24 v160, v156, 3, v159
    v_lshl_add_u32 v74, v78, 2, v79
    v_add3_u32 v78, v78, v159, s97
    v_add3_u32 v79, v79, v156, s98
    v_lshl_add_u32 v160, v160, 6, v74
    v_cvt_f32_i32 v157, v78
    v_cvt_f32_i32 v229, v79
    v_lshl_add_u32 v160, v160, 1, s66
    v_mov_b32 v226, s70
    v_mov_b32 v225, s71
    v_cmp_eq_u32 vcc, 1, v156
    v_mov_b32 v17, s72
    s_nop 0
    v_cndmask_b32 v226, v226, v225, vcc
    v_cmp_eq_u32 vcc, 2, v156
    v_mov_b32 v225, 0
    s_nop 0
    v_cndmask_b32 v226, v226, v17, vcc
    s_mov_b64 s[70:71], s[44:45]
    s_mov_b64 s[72:73], s[46:47]
    s_mov_b64 s[74:75], s[48:49]
    v_lshlrev_b32 v77, 16, v158
    v_and_b32 v78, 0xffff0000, v158
    v_add_f32 v77, v77, v229
    v_add_f32 v78, v78, v157
    v_cvt_pk_bf16_f32 v76, v77, v78
    v_pk_max_i16 v76, v76, 0
    v_pk_min_i16 v76, v76, s91
    v_lshlrev_b32 v77, 16, v76
    v_and_b32 v78, 0xffff0000, v76
    v_fract_f32 v79, v77
    v_fract_f32 v80, v78
    v_cvt_u32_f32 v81, v77
    v_cvt_u32_f32 v82, v78
    v_cmp_neq_f32 s[44:45], 0, v80
    v_cmp_neq_f32 s[46:47], 0, v79
    v_sub_f32 v83, 1.0, v79
    v_sub_f32 v84, 1.0, v80
    v_subrev_u32 v81, s33, v81
    v_subrev_u32 v82, s34, v82
    v_cvt_pk_bf16_f32 v77, v83, v84
    v_sub_u32 v89, v81, v225
    v_addc_co_u32 v91, vcc, 0, v82, s[44:45]
    v_lshlrev_b32 v83, 16, v77
    v_and_b32 v84, 0xffff0000, v77
    v_addc_co_u32 v90, vcc, 0, v89, s[46:47]
    v_mul_u32_u24 v92, 976, v81
    v_mul_f32 v85, v83, v84
    v_mul_f32 v86, v83, v80
    v_mul_f32 v87, v79, v84
    v_mul_f32 v88, v79, v80
    v_max_u32 v89, v89, v90
    v_subrev_u32 v77, s100, v82
    v_subrev_u32 v78, s100, v91
    v_mad_u32_u24 v83, v82, 48, v92
    v_mad_u32_u24 v84, v91, 48, v92
    v_and_b32 v82, 12, v82
    v_and_b32 v91, 12, v91
    v_max_u32 v77, v77, v78
    s_andn2_b64 s[48:49], s[46:47], s[44:45]
    v_add_lshl_u32 v83, v83, v82, 2
    v_add_lshl_u32 v84, v84, v91, 2
    v_cndmask_b32 v86, v87, v86, s[44:45]
    v_cndmask_b32 v78, 0, v228, s[48:49]
    s_and_b64 s[48:49], s[46:47], s[44:45]
    v_cndmask_b32 v87, 0, v87, s[44:45]
    v_cndmask_b32 v90, 0, v228, s[46:47]
    v_cmp_lt_u32 s[46:47], v226, v89
    v_cmp_lt_u32 s[44:45], s101, v77
    v_lshl_or_b32 v74, v84, 16, v83
    v_cvt_pk_bf16_f32 v73, v85, v86
    v_cvt_pk_bf16_f32 v75, v87, v88
    v_and_b32 v78, 0xffff0000, v78
    v_cndmask_b32 v77, 0, v228, s[48:49]
    s_or_b64 s[44:45], s[44:45], s[46:47]
    v_add_u32_sdwa v90, v90, v84 dst_sel:DWORD dst_unused:UNUSED_PAD src0_sel:WORD_1 src1_sel:DWORD
    v_cmp_lt_u32 vcc, 0xffff, v90
    s_or_b64 s[44:45], s[44:45], vcc
    v_add_u32 v72, v74, v78
    v_add_u32 v74, v74, v77
    v_cmp_lt_u32 vcc, s64, v89
    ds_write_b128 v227, v[72:75]
    ds_write_b16 v160, v161
    s_cmp_lg_u64 s[44:45], 0
    s_cbranch_scc1 L_table0
    s_cmp_eq_u64 vcc, 0
    s_cselect_b32 s26, s27, s26
    s_cselect_b32 s37, 0, 8
    s_mov_b32 s52, 0
    s_mov_b32 s53, s26
    s_mov_b32 s54, 16
    s_setpc_b64 s[76:77]
L_first2:
    s_cmp_eq_u32 s38, 2
    s_cbranch_scc1 L_gfirst0
    v_lshl_add_u32 v13, v15, 3, s66
    s_cmp_eq_u32 s26, 0
    s_cbranch_scc1 L_pf0
    s_sub_u32 s97, s53, 1
    v_add_u32 v17, s52, v251
    v_add_u32 v252, s52, v15
    v_min_u32 v17, s97, v17
    v_min_u32 v252, s97, v252
    v_lshl_add_u32 v17, v17, 4, s67
    v_bfe_u32 v253, v252, 1, 2
    ds_read_b128 v[236:239], v17
    v_mad_u32_u24 v252, v252, 12, v253
    v_and_b32 v253, 3, v0
    s_add_u32 s52, s52, s54
    v_xor_b32 v252, v252, v253
    v_lshl_add_u32 v252, v252, 4, s68
    s_waitcnt lgkmcnt(0)
    v_xor_b32_sdwa v244, v236, v6 dst_sel:DWORD dst_unused:UNUSED_PAD src0_sel:WORD_0 src1_sel:DWORD
    v_xor_b32_sdwa v246, v236, v6 dst_sel:DWORD dst_unused:UNUSED_PAD src0_sel:WORD_1 src1_sel:DWORD
    v_xor_b32_sdwa v245, v236, v7 dst_sel:DWORD dst_unused:UNUSED_PAD src0_sel:WORD_0 src1_sel:DWORD
    v_xor_b32_sdwa v247, v236, v7 dst_sel:DWORD dst_unused:UNUSED_PAD src0_sel:WORD_1 src1_sel:DWORD
    v_cmp_ne_u32 vcc, 0, v239
    v_perm_b32 v228, v237, v237, v8
    v_perm_b32 v229, v237, v237, v9
    v_perm_b32 v230, v237, v237, v10
    v_perm_b32 v231, v237, v237, v11
    s_setprio 3
    s_barrier
    s_call_b64 s[76:77], L_gpb
    s_branch L_pf1
L_pf0:
    s_barrier
L_pf1:
    ds_read_b64 v[236:237], v13
    ds_read_b64_tr_b16 v[72:73], v5 offset:0
    ds_read_b64_tr_b16 v[74:75], v5 offset:768
    ds_read_b64_tr_b16 v[76:77], v5 offset:32
    ds_read_b64_tr_b16 v[78:79], v5 offset:800
    ds_read_b64_tr_b16 v[80:81], v5 offset:64
    ds_read_b64_tr_b16 v[82:83], v5 offset:832
    s_mov_b32 s52, s26
    s_mov_b32 s53, s27
    s_waitcnt lgkmcnt(6)
    v_xor_b32 v236, v236, v0
    v_xor_b32 v237, v237, v0
    v_lshlrev_b32_sdwa v240, 4, v236 dst_sel:DWORD dst_unused:UNUSED_PAD src0_sel:DWORD src1_sel:WORD_0
    v_lshlrev_b32_sdwa v241, 4, v236 dst_sel:DWORD dst_unused:UNUSED_PAD src0_sel:DWORD src1_sel:WORD_1
    v_lshlrev_b32_sdwa v242, 4, v237 dst_sel:DWORD dst_unused:UNUSED_PAD src0_sel:DWORD src1_sel:WORD_0
    v_lshlrev_b32_sdwa v243, 4, v237 dst_sel:DWORD dst_unused:UNUSED_PAD src0_sel:DWORD src1_sel:WORD_1
    ds_read_b128 v[108:111], v240 offset:0
    ds_read_b128 v[112:115], v241 offset:0
    ds_read_b128 v[116:119], v242 offset:0
    ds_read_b128 v[120:123], v243 offset:0
    s_cmp_eq_u32 s30, 3
    s_cbranch_scc0 L_pf4
    s_waitcnt lgkmcnt(3)
    v_mfma_f32_16x16x32_bf16 v[24:27], v[72:75], v[108:111], v[24:27]
    ds_read_b64_tr_b16 v[84:85], v5 offset:6208
    ds_read_b64_tr_b16 v[86:87], v5 offset:6976
    v_mfma_f32_16x16x32_bf16 v[28:31], v[76:79], v[108:111], v[28:31]
    ds_read_b64_tr_b16 v[88:89], v5 offset:6240
    ds_read_b64_tr_b16 v[90:91], v5 offset:7008
    v_mfma_f32_16x16x32_bf16 v[32:35], v[80:83], v[108:111], v[32:35]
    ds_read_b64_tr_b16 v[92:93], v5 offset:6272
    ds_read_b64_tr_b16 v[94:95], v5 offset:7040
    s_waitcnt lgkmcnt(8)
    v_mfma_f32_16x16x32_bf16 v[44:47], v[80:83], v[112:115], v[44:47]
    ds_read_b128 v[124:127], v240 offset:64
    ds_read_b128 v[128:131], v241 offset:64
    v_mfma_f32_16x16x32_bf16 v[40:43], v[76:79], v[112:115], v[40:43]
    ds_read_b128 v[132:135], v242 offset:64
    ds_read_b128 v[140:143], v240 offset:128
    v_mfma_f32_16x16x32_bf16 v[36:39], v[72:75], v[112:115], v[36:39]
    ds_read_b128 v[144:147], v241 offset:128
    ds_read_b128 v[148:151], v242 offset:128
    s_waitcnt lgkmcnt(13)
    v_mfma_f32_16x16x32_bf16 v[48:51], v[72:75], v[116:119], v[48:51]
    ds_read_b64 v[236:237], v13 offset:128
    ds_read_b64_tr_b16 v[96:97], v5 offset:12416
    v_mfma_f32_16x16x32_bf16 v[52:55], v[76:79], v[116:119], v[52:55]
    ds_read_b64_tr_b16 v[98:99], v5 offset:13184
    ds_read_b64_tr_b16 v[100:101], v5 offset:12448
    v_mfma_f32_16x16x32_bf16 v[56:59], v[80:83], v[116:119], v[56:59]
    ds_read_b64_tr_b16 v[102:103], v5 offset:13216
    ds_read_b64_tr_b16 v[104:105], v5 offset:12480
    ds_read_b64_tr_b16 v[106:107], v5 offset:13248
    s_add_u32 s35, s35, 1
    s_and_b32 s36, s35, 3
    s_mul_i32 s36, s36, 18624
    v_add_u32 v13, 128, v13
    v_add_u32 v5, s36, v4
    s_waitcnt lgkmcnt(6)
    v_xor_b32 v236, v236, v0
    v_xor_b32 v237, v237, v0
    v_lshlrev_b32_sdwa v240, 4, v236 dst_sel:DWORD dst_unused:UNUSED_PAD src0_sel:DWORD src1_sel:WORD_0
    v_lshlrev_b32_sdwa v241, 4, v236 dst_sel:DWORD dst_unused:UNUSED_PAD src0_sel:DWORD src1_sel:WORD_1
    v_lshlrev_b32_sdwa v242, 4, v237 dst_sel:DWORD dst_unused:UNUSED_PAD src0_sel:DWORD src1_sel:WORD_0
    s_branch L_endp3
L_pf4:
    s_cmp_eq_u32 s30, 4
    s_cbranch_scc0 L_pf2
    s_waitcnt lgkmcnt(3)
    v_mfma_f32_16x16x32_bf16 v[24:27], v[72:75], v[108:111], v[24:27]
    ds_read_b64_tr_b16 v[84:85], v5 offset:6208
    ds_read_b64_tr_b16 v[86:87], v5 offset:6976
    v_mfma_f32_16x16x32_bf16 v[28:31], v[76:79], v[108:111], v[28:31]
    ds_read_b64_tr_b16 v[88:89], v5 offset:6240
    ds_read_b64_tr_b16 v[90:91], v5 offset:7008
    v_mfma_f32_16x16x32_bf16 v[32:35], v[80:83], v[108:111], v[32:35]
    ds_read_b64_tr_b16 v[92:93], v5 offset:6272
    ds_read_b64_tr_b16 v[94:95], v5 offset:7040
    s_waitcnt lgkmcnt(8)
    v_mfma_f32_16x16x32_bf16 v[44:47], v[80:83], v[112:115], v[44:47]
    ds_read_b128 v[124:127], v240 offset:64
    ds_read_b128 v[128:131], v241 offset:64
    v_mfma_f32_16x16x32_bf16 v[40:43], v[76:79], v[112:115], v[40:43]
    ds_read_b128 v[132:135], v242 offset:64
    ds_read_b128 v[136:139], v243 offset:64
    v_mfma_f32_16x16x32_bf16 v[36:39], v[72:75], v[112:115], v[36:39]
    ds_read_b128 v[140:143], v240 offset:128
    ds_read_b128 v[144:147], v241 offset:128
    s_waitcnt lgkmcnt(13)
    v_mfma_f32_16x16x32_bf16 v[48:51], v[72:75], v[116:119], v[48:51]
    ds_read_b128 v[148:151], v242 offset:128
    ds_read_b128 v[152:155], v243 offset:128
    v_mfma_f32_16x16x32_bf16 v[52:55], v[76:79], v[116:119], v[52:55]
    ds_read_b64 v[236:237], v13 offset:128
    ds_read_b64_tr_b16 v[96:97], v5 offset:12416
    v_mfma_f32_16x16x32_bf16 v[56:59], v[80:83], v[116:119], v[56:59]
    ds_read_b64_tr_b16 v[98:99], v5 offset:13184
    ds_read_b64_tr_b16 v[100:101], v5 offset:12448
    s_waitcnt lgkmcnt(15)
    v_mfma_f32_16x16x32_bf16 v[68:71], v[80:83], v[120:123], v[68:71]
    ds_read_b64_tr_b16 v[102:103], v5 offset:13216
    ds_read_b64_tr_b16 v[104:105], v5 offset:12480
    v_mfma_f32_16x16x32_bf16 v[64:67], v[76:79], v[120:123], v[64:67]
    ds_read_b64_tr_b16 v[106:107], v5 offset:13248
    v_mfma_f32_16x16x32_bf16 v[60:63], v[72:75], v[120:123], v[60:63]
    s_add_u32 s35, s35, 1
    s_and_b32 s36, s35, 3
    s_mul_i32 s36, s36, 18624
    v_add_u32 v13, 128, v13
    v_add_u32 v5, s36, v4
    s_waitcnt lgkmcnt(6)
    v_xor_b32 v236, v236, v0
    v_xor_b32 v237, v237, v0
    v_lshlrev_b32_sdwa v240, 4, v236 dst_sel:DWORD dst_unused:UNUSED_PAD src0_sel:DWORD src1_sel:WORD_0
    v_lshlrev_b32_sdwa v241, 4, v236 dst_sel:DWORD dst_unused:UNUSED_PAD src0_sel:DWORD src1_sel:WORD_1
    v_lshlrev_b32_sdwa v242, 4, v237 dst_sel:DWORD dst_unused:UNUSED_PAD src0_sel:DWORD src1_sel:WORD_0
    v_lshlrev_b32_sdwa v243, 4, v237 dst_sel:DWORD dst_unused:UNUSED_PAD src0_sel:DWORD src1_sel:WORD_1
    s_branch L_endp4
L_gp:
    s_cmp_ge_u32 s52, s53
    s_cbranch_scc1 L_gpr
    s_setprio 3
L_gpl:
    s_sub_u32 s97, s53, 1
    v_add_u32 v17, s52, v251
    v_add_u32 v252, s52, v15
    v_min_u32 v17, s97, v17
    v_min_u32 v252, s97, v252
    v_lshl_add_u32 v17, v17, 4, s67
    v_bfe_u32 v253, v252, 1, 2
    ds_read_b128 v[236:239], v17
    v_mad_u32_u24 v252, v252, 12, v253
    v_and_b32 v253, 3, v0
    s_add_u32 s52, s52, s54
    v_xor_b32 v252, v252, v253
    v_lshl_add_u32 v252, v252, 4, s68
    s_waitcnt lgkmcnt(0)
    v_xor_b32_sdwa v244, v236, v6 dst_sel:DWORD dst_unused:UNUSED_PAD src0_sel:WORD_0 src1_sel:DWORD
    v_xor_b32_sdwa v246, v236, v6 dst_sel:DWORD dst_unused:UNUSED_PAD src0_sel:WORD_1 src1_sel:DWORD
    v_xor_b32_sdwa v245, v236, v7 dst_sel:DWORD dst_unused:UNUSED_PAD src0_sel:WORD_0 src1_sel:DWORD
    v_xor_b32_sdwa v247, v236, v7 dst_sel:DWORD dst_unused:UNUSED_PAD src0_sel:WORD_1 src1_sel:DWORD
    v_cmp_ne_u32 vcc, 0, v239
    v_perm_b32 v228, v237, v237, v8
    v_perm_b32 v229, v237, v237, v9
    v_perm_b32 v230, v237, v237, v10
    v_perm_b32 v231, v237, v237, v11
L_gpb:
    ds_read_b64_tr_b16 v[156:157], v244 offset:0
    ds_read_b64_tr_b16 v[158:159], v246 offset:0
    ds_read_b64_tr_b16 v[160:161], v245 offset:0
    ds_read_b64_tr_b16 v[162:163], v247 offset:0
    ds_read_b64_tr_b16 v[164:165], v244 offset:64
    ds_read_b64_tr_b16 v[166:167], v246 offset:64
    ds_read_b64_tr_b16 v[168:169], v245 offset:64
    ds_read_b64_tr_b16 v[170:171], v247 offset:64
    ds_read_b64_tr_b16 v[172:173], v244 offset:128
    ds_read_b64_tr_b16 v[174:175], v246 offset:128
    ds_read_b64_tr_b16 v[176:177], v245 offset:128
    ds_read_b64_tr_b16 v[178:179], v247 offset:128
    s_cbranch_vccnz L_gp4
    s_waitcnt lgkmcnt(8)
    v_mfma_f32_16x16x32_bf16 v[204:207], v[156:159], v[228:231], 0
    v_mfma_f32_16x16x32_bf16 v[208:211], v[160:163], v[228:231], 0
    s_waitcnt lgkmcnt(4)
    v_mfma_f32_16x16x32_bf16 v[212:215], v[164:167], v[228:231], 0
    v_mfma_f32_16x16x32_bf16 v[216:219], v[168:171], v[228:231], 0
    s_waitcnt lgkmcnt(0)
    v_mfma_f32_16x16x32_bf16 v[220:223], v[172:175], v[228:231], 0
    v_mfma_f32_16x16x32_bf16 v[224:227], v[176:179], v[228:231], 0
L_gpw:
    s_nop 1
    v_cvt_pk_bf16_f32 v156, v204, v205
    v_cvt_pk_bf16_f32 v157, v206, v207
    v_cvt_pk_bf16_f32 v158, v208, v209
    v_cvt_pk_bf16_f32 v159, v210, v211
    v_cvt_pk_bf16_f32 v160, v212, v213
    v_cvt_pk_bf16_f32 v161, v214, v215
    v_cvt_pk_bf16_f32 v162, v216, v217
    v_cvt_pk_bf16_f32 v163, v218, v219
    v_cvt_pk_bf16_f32 v164, v220, v221
    v_cvt_pk_bf16_f32 v165, v222, v223
    v_cvt_pk_bf16_f32 v166, v224, v225
    v_cvt_pk_bf16_f32 v167, v226, v227
    v_permlane32_swap_b32 v156, v158
    v_permlane32_swap_b32 v157, v159
    v_permlane32_swap_b32 v160, v162
    v_permlane32_swap_b32 v161, v163
    v_permlane32_swap_b32 v164, v166
    v_permlane32_swap_b32 v165, v167
    ds_write_b128 v252, v[156:159] offset:0
    ds_write_b128 v252, v[160:163] offset:64
    ds_write_b128 v252, v[164:167] offset:128
    s_cmp_lt_u32 s52, s53
    s_cbranch_scc1 L_gpl
L_gpr:
    s_setpc_b64 s[76:77]
L_gp4:
    v_xor_b32_sdwa v244, v238, v6 dst_sel:DWORD dst_unused:UNUSED_PAD src0_sel:WORD_0 src1_sel:DWORD
    v_xor_b32_sdwa v246, v238, v6 dst_sel:DWORD dst_unused:UNUSED_PAD src0_sel:WORD_1 src1_sel:DWORD
    v_xor_b32_sdwa v245, v238, v7 dst_sel:DWORD dst_unused:UNUSED_PAD src0_sel:WORD_0 src1_sel:DWORD
    v_xor_b32_sdwa v247, v238, v7 dst_sel:DWORD dst_unused:UNUSED_PAD src0_sel:WORD_1 src1_sel:DWORD
    ds_read_b64_tr_b16 v[180:181], v244 offset:0
    ds_read_b64_tr_b16 v[182:183], v246 offset:0
    ds_read_b64_tr_b16 v[184:185], v245 offset:0
    ds_read_b64_tr_b16 v[186:187], v247 offset:0
    ds_read_b64_tr_b16 v[188:189], v244 offset:64
    ds_read_b64_tr_b16 v[190:191], v246 offset:64
    ds_read_b64_tr_b16 v[192:193], v245 offset:64
    ds_read_b64_tr_b16 v[194:195], v247 offset:64
    ds_read_b64_tr_b16 v[196:197], v244 offset:128
    ds_read_b64_tr_b16 v[198:199], v246 offset:128
    ds_read_b64_tr_b16 v[200:201], v245 offset:128
    ds_read_b64_tr_b16 v[202:203], v247 offset:128
    v_perm_b32 v232, v239, v239, v8
    v_perm_b32 v233, v239, v239, v9
    v_perm_b32 v234, v239, v239, v10
    v_perm_b32 v235, v239, v239, v11
    s_waitcnt lgkmcnt(12)
    v_mfma_f32_16x16x32_bf16 v[204:207], v[156:159], v[228:231], 0
    v_mfma_f32_16x16x32_bf16 v[208:211], v[160:163], v[228:231], 0
    v_mfma_f32_16x16x32_bf16 v[212:215], v[164:167], v[228:231], 0
    v_mfma_f32_16x16x32_bf16 v[216:219], v[168:171], v[228:231], 0
    v_mfma_f32_16x16x32_bf16 v[220:223], v[172:175], v[228:231], 0
    v_mfma_f32_16x16x32_bf16 v[224:227], v[176:179], v[228:231], 0
    s_waitcnt lgkmcnt(0)
    v_mfma_f32_16x16x32_bf16 v[204:207], v[180:183], v[232:235], v[204:207]
    v_mfma_f32_16x16x32_bf16 v[208:211], v[184:187], v[232:235], v[208:211]
    v_mfma_f32_16x16x32_bf16 v[212:215], v[188:191], v[232:235], v[212:215]
    v_mfma_f32_16x16x32_bf16 v[216:219], v[192:195], v[232:235], v[216:219]
    v_mfma_f32_16x16x32_bf16 v[220:223], v[196:199], v[232:235], v[220:223]
    v_mfma_f32_16x16x32_bf16 v[224:227], v[200:203], v[232:235], v[224:227]
    s_branch L_gpw
.p2align 12
.p2align 3
L_topp3:
    s_barrier
L_bodyp3:
    s_setprio 2
.p2align 3
    v_mfma_f32_16x16x32_bf16 v[24:27], v[84:87], v[124:127], v[24:27]
    ds_read_b128 v[108:111], v240 offset:0
    v_mfma_f32_16x16x32_bf16 v[28:31], v[88:91], v[124:127], v[28:31]
    ds_read_b64_tr_b16 v[72:73], v5 offset:0
    v_mfma_f32_16x16x32_bf16 v[32:35], v[92:95], v[124:127], v[32:35]
    ds_read_b64_tr_b16 v[74:75], v5 offset:768
    v_mfma_f32_16x16x32_bf16 v[44:47], v[92:95], v[128:131], v[44:47]
    ds_read_b64_tr_b16 v[76:77], v5 offset:32
    v_mfma_f32_16x16x32_bf16 v[40:43], v[88:91], v[128:131], v[40:43]
    ds_read_b64_tr_b16 v[78:79], v5 offset:800
    v_mfma_f32_16x16x32_bf16 v[36:39], v[84:87], v[128:131], v[36:39]
    ds_read_b64_tr_b16 v[80:81], v5 offset:64
    v_mfma_f32_16x16x32_bf16 v[48:51], v[84:87], v[132:135], v[48:51]
    ds_read_b64_tr_b16 v[82:83], v5 offset:832
    v_mfma_f32_16x16x32_bf16 v[52:55], v[88:91], v[132:135], v[52:55]
    ds_read_b128 v[112:115], v241 offset:0
    v_mfma_f32_16x16x32_bf16 v[56:59], v[92:95], v[132:135], v[56:59]
    ds_read_b128 v[116:119], v242 offset:0
    s_setprio 1
.p2align 3
    v_mfma_f32_16x16x32_bf16 v[24:27], v[96:99], v[140:143], v[24:27]
    ds_read_b64_tr_b16 v[84:85], v5 offset:6208
    v_mfma_f32_16x16x32_bf16 v[28:31], v[100:103], v[140:143], v[28:31]
    ds_read_b64_tr_b16 v[86:87], v5 offset:6976
    v_mfma_f32_16x16x32_bf16 v[32:35], v[104:107], v[140:143], v[32:35]
    ds_read_b64_tr_b16 v[88:89], v5 offset:6240
    v_mfma_f32_16x16x32_bf16 v[44:47], v[104:107], v[144:147], v[44:47]
    ds_read_b128 v[140:143], v240 offset:128
    ds_read_b64_tr_b16 v[90:91], v5 offset:7008
    v_mfma_f32_16x16x32_bf16 v[40:43], v[100:103], v[144:147], v[40:43]
    ds_read_b64_tr_b16 v[92:93], v5 offset:6272
    v_mfma_f32_16x16x32_bf16 v[36:39], v[96:99], v[144:147], v[36:39]
    ds_read_b64_tr_b16 v[94:95], v5 offset:7040
    v_mfma_f32_16x16x32_bf16 v[48:51], v[96:99], v[148:151], v[48:51]
    ds_read_b128 v[144:147], v241 offset:128
    ds_read_b128 v[124:127], v240 offset:64
    v_mfma_f32_16x16x32_bf16 v[52:55], v[100:103], v[148:151], v[52:55]
    ds_read_b128 v[128:131], v241 offset:64
    v_mfma_f32_16x16x32_bf16 v[56:59], v[104:107], v[148:151], v[56:59]
    ds_read_b128 v[132:135], v242 offset:64
    ds_read_b128 v[148:151], v242 offset:128
L_midp3:
    s_waitcnt lgkmcnt(12)
    s_setprio 0
.p2align 3
    v_mfma_f32_16x16x32_bf16 v[24:27], v[72:75], v[108:111], v[24:27]
    ds_read_b64 v[236:237], v13 offset:128
    v_mfma_f32_16x16x32_bf16 v[28:31], v[76:79], v[108:111], v[28:31]
    ds_read_b64_tr_b16 v[96:97], v5 offset:12416
    v_mfma_f32_16x16x32_bf16 v[32:35], v[80:83], v[108:111], v[32:35]
    ds_read_b64_tr_b16 v[98:99], v5 offset:13184
    v_mfma_f32_16x16x32_bf16 v[44:47], v[80:83], v[112:115], v[44:47]
    ds_read_b64_tr_b16 v[100:101], v5 offset:12448
    v_mfma_f32_16x16x32_bf16 v[40:43], v[76:79], v[112:115], v[40:43]
    ds_read_b64_tr_b16 v[102:103], v5 offset:13216
    v_mfma_f32_16x16x32_bf16 v[36:39], v[72:75], v[112:115], v[36:39]
    s_add_u32 s35, s35, 1
    s_and_b32 s36, s35, 3
    v_mfma_f32_16x16x32_bf16 v[48:51], v[72:75], v[116:119], v[48:51]
    s_mul_i32 s36, s36, 18624
    ds_read_b64_tr_b16 v[104:105], v5 offset:12480
    v_mfma_f32_16x16x32_bf16 v[52:55], v[76:79], v[116:119], v[52:55]
    ds_read_b64_tr_b16 v[106:107], v5 offset:13248
    v_mfma_f32_16x16x32_bf16 v[56:59], v[80:83], v[116:119], v[56:59]
    v_add_u32 v13, 128, v13
    v_add_u32 v5, s36, v4
    s_waitcnt lgkmcnt(6)
    v_xor_b32 v236, v236, v0
    v_xor_b32 v237, v237, v0
    v_lshlrev_b32_sdwa v240, 4, v236 dst_sel:DWORD dst_unused:UNUSED_PAD src0_sel:DWORD src1_sel:WORD_0
    v_lshlrev_b32_sdwa v241, 4, v236 dst_sel:DWORD dst_unused:UNUSED_PAD src0_sel:DWORD src1_sel:WORD_1
    v_lshlrev_b32_sdwa v242, 4, v237 dst_sel:DWORD dst_unused:UNUSED_PAD src0_sel:DWORD src1_sel:WORD_0
L_endp3:
    s_bitcmp1_b32 s3, s35
    s_waitcnt vmcnt(0) lgkmcnt(0)
    s_cbranch_scc0 L_topp3
    s_bitcmp1_b32 s99, s35
    s_cbranch_scc1 L_spp3
    s_barrier
    s_bitcmp1_b32 s39, s35
    s_cbranch_scc0 L_spp3
    s_call_b64 s[76:77], L_dma
L_spp3:
    s_bitcmp1_b32 s37, s35
    s_cbranch_scc0 L_pn3
    s_call_b64 s[76:77], L_gp
L_pn3:
    s_cmp_lg_u32 s35, 9
    s_cbranch_scc1 L_bodyp3
    s_branch L_last3
.p2align 3
L_topp4:
    s_barrier
L_bodyp4:
    s_setprio 2
.p2align 3
    v_mfma_f32_16x16x32_bf16 v[24:27], v[84:87], v[124:127], v[24:27]
    ds_read_b128 v[108:111], v240 offset:0
    v_mfma_f32_16x16x32_bf16 v[28:31], v[88:91], v[124:127], v[28:31]
    ds_read_b64_tr_b16 v[72:73], v5 offset:0
    v_mfma_f32_16x16x32_bf16 v[32:35], v[92:95], v[124:127], v[32:35]
    ds_read_b64_tr_b16 v[74:75], v5 offset:768
    v_mfma_f32_16x16x32_bf16 v[44:47], v[92:95], v[128:131], v[44:47]
    ds_read_b64_tr_b16 v[76:77], v5 offset:32
    v_mfma_f32_16x16x32_bf16 v[40:43], v[88:91], v[128:131], v[40:43]
    ds_read_b64_tr_b16 v[78:79], v5 offset:800
    v_mfma_f32_16x16x32_bf16 v[36:39], v[84:87], v[128:131], v[36:39]
    ds_read_b64_tr_b16 v[80:81], v5 offset:64
    v_mfma_f32_16x16x32_bf16 v[48:51], v[84:87], v[132:135], v[48:51]
    ds_read_b64_tr_b16 v[82:83], v5 offset:832
    v_mfma_f32_16x16x32_bf16 v[52:55], v[88:91], v[132:135], v[52:55]
    ds_read_b128 v[112:115], v241 offset:0
    v_mfma_f32_16x16x32_bf16 v[56:59], v[92:95], v[132:135], v[56:59]
    ds_read_b128 v[116:119], v242 offset:0
    v_mfma_f32_16x16x32_bf16 v[68:71], v[92:95], v[136:139], v[68:71]
    ds_read_b128 v[120:123], v243 offset:0
    v_mfma_f32_16x16x32_bf16 v[64:67], v[88:91], v[136:139], v[64:67]
    v_mfma_f32_16x16x32_bf16 v[60:63], v[84:87], v[136:139], v[60:63]
    s_setprio 1
.p2align 3
    v_mfma_f32_16x16x32_bf16 v[24:27], v[96:99], v[140:143], v[24:27]
    ds_read_b64_tr_b16 v[84:85], v5 offset:6208
    v_mfma_f32_16x16x32_bf16 v[28:31], v[100:103], v[140:143], v[28:31]
    ds_read_b64_tr_b16 v[86:87], v5 offset:6976
    v_mfma_f32_16x16x32_bf16 v[32:35], v[104:107], v[140:143], v[32:35]
    ds_read_b64_tr_b16 v[88:89], v5 offset:6240
    v_mfma_f32_16x16x32_bf16 v[44:47], v[104:107], v[144:147], v[44:47]
    ds_read_b128 v[140:143], v240 offset:128
    v_mfma_f32_16x16x32_bf16 v[40:43], v[100:103], v[144:147], v[40:43]
    ds_read_b64_tr_b16 v[90:91], v5 offset:7008
    v_mfma_f32_16x16x32_bf16 v[36:39], v[96:99], v[144:147], v[36:39]
    ds_read_b64_tr_b16 v[92:93], v5 offset:6272
    v_mfma_f32_16x16x32_bf16 v[48:51], v[96:99], v[148:151], v[48:51]
    ds_read_b128 v[144:147], v241 offset:128
    v_mfma_f32_16x16x32_bf16 v[52:55], v[100:103], v[148:151], v[52:55]
    ds_read_b64_tr_b16 v[94:95], v5 offset:7040
    v_mfma_f32_16x16x32_bf16 v[56:59], v[104:107], v[148:151], v[56:59]
    ds_read_b128 v[124:127], v240 offset:64
    v_mfma_f32_16x16x32_bf16 v[68:71], v[104:107], v[152:155], v[68:71]
    ds_read_b128 v[148:151], v242 offset:128
    ds_read_b128 v[128:131], v241 offset:64
    v_mfma_f32_16x16x32_bf16 v[64:67], v[100:103], v[152:155], v[64:67]
    ds_read_b128 v[132:135], v242 offset:64
    v_mfma_f32_16x16x32_bf16 v[60:63], v[96:99], v[152:155], v[60:63]
    ds_read_b128 v[136:139], v243 offset:64
    ds_read_b128 v[152:155], v243 offset:128
L_midp4:
    s_waitcnt lgkmcnt(14)
    s_setprio 0
.p2align 3
    v_mfma_f32_16x16x32_bf16 v[24:27], v[72:75], v[108:111], v[24:27]
    ds_read_b64 v[236:237], v13 offset:128
    v_mfma_f32_16x16x32_bf16 v[28:31], v[76:79], v[108:111], v[28:31]
    ds_read_b64_tr_b16 v[96:97], v5 offset:12416
    v_mfma_f32_16x16x32_bf16 v[32:35], v[80:83], v[108:111], v[32:35]
    ds_read_b64_tr_b16 v[98:99], v5 offset:13184
    v_mfma_f32_16x16x32_bf16 v[44:47], v[80:83], v[112:115], v[44:47]
    ds_read_b64_tr_b16 v[100:101], v5 offset:12448
    v_mfma_f32_16x16x32_bf16 v[40:43], v[76:79], v[112:115], v[40:43]
    ds_read_b64_tr_b16 v[102:103], v5 offset:13216
    v_mfma_f32_16x16x32_bf16 v[36:39], v[72:75], v[112:115], v[36:39]
    s_add_u32 s35, s35, 1
    s_and_b32 s36, s35, 3
    v_mfma_f32_16x16x32_bf16 v[48:51], v[72:75], v[116:119], v[48:51]
    s_mul_i32 s36, s36, 18624
    ds_read_b64_tr_b16 v[104:105], v5 offset:12480
    v_mfma_f32_16x16x32_bf16 v[52:55], v[76:79], v[116:119], v[52:55]
    ds_read_b64_tr_b16 v[106:107], v5 offset:13248
    v_mfma_f32_16x16x32_bf16 v[56:59], v[80:83], v[116:119], v[56:59]
    v_add_u32 v13, 128, v13
    v_add_u32 v5, s36, v4
    v_mfma_f32_16x16x32_bf16 v[68:71], v[80:83], v[120:123], v[68:71]
    s_waitcnt lgkmcnt(6)
    v_xor_b32 v236, v236, v0
    v_mfma_f32_16x16x32_bf16 v[64:67], v[76:79], v[120:123], v[64:67]
    v_xor_b32 v237, v237, v0
    v_lshlrev_b32_sdwa v240, 4, v236 dst_sel:DWORD dst_unused:UNUSED_PAD src0_sel:DWORD src1_sel:WORD_0
    v_mfma_f32_16x16x32_bf16 v[60:63], v[72:75], v[120:123], v[60:63]
    v_lshlrev_b32_sdwa v241, 4, v236 dst_sel:DWORD dst_unused:UNUSED_PAD src0_sel:DWORD src1_sel:WORD_1
    v_lshlrev_b32_sdwa v242, 4, v237 dst_sel:DWORD dst_unused:UNUSED_PAD src0_sel:DWORD src1_sel:WORD_0
    v_lshlrev_b32_sdwa v243, 4, v237 dst_sel:DWORD dst_unused:UNUSED_PAD src0_sel:DWORD src1_sel:WORD_1
L_endp4:
    s_bitcmp1_b32 s3, s35
    s_waitcnt vmcnt(0) lgkmcnt(0)
    s_cbranch_scc0 L_topp4
    s_bitcmp1_b32 s99, s35
    s_cbranch_scc1 L_spp4
    s_barrier
    s_bitcmp1_b32 s39, s35
    s_cbranch_scc0 L_spp4
    s_call_b64 s[76:77], L_dma
L_spp4:
    s_bitcmp1_b32 s37, s35
    s_cbranch_scc0 L_pn4
    s_call_b64 s[76:77], L_gp
L_pn4:
    s_cmp_lg_u32 s35, 9
    s_cbranch_scc1 L_bodyp4
    s_branch L_last4
L_pf2:
    s_cmp_eq_u32 s30, 2
    s_cbranch_scc0 L_pf5
    s_waitcnt lgkmcnt(3)
    v_mfma_f32_16x16x32_bf16 v[24:27], v[72:75], v[108:111], v[24:27]
    ds_read_b64_tr_b16 v[84:85], v5 offset:6208
    ds_read_b64_tr_b16 v[86:87], v5 offset:6976
    v_mfma_f32_16x16x32_bf16 v[28:31], v[76:79], v[108:111], v[28:31]
    ds_read_b64_tr_b16 v[88:89], v5 offset:6240
    ds_read_b64_tr_b16 v[90:91], v5 offset:7008
    v_mfma_f32_16x16x32_bf16 v[32:35], v[80:83], v[108:111], v[32:35]
    ds_read_b64_tr_b16 v[92:93], v5 offset:6272
    ds_read_b64_tr_b16 v[94:95], v5 offset:7040
    s_waitcnt lgkmcnt(8)
    v_mfma_f32_16x16x32_bf16 v[44:47], v[80:83], v[112:115], v[44:47]
    ds_read_b128 v[124:127], v240 offset:64
    ds_read_b128 v[128:131], v241 offset:64
    v_mfma_f32_16x16x32_bf16 v[40:43], v[76:79], v[112:115], v[40:43]
    ds_read_b128 v[140:143], v240 offset:128
    ds_read_b128 v[144:147], v241 offset:128
    v_mfma_f32_16x16x32_bf16 v[36:39], v[72:75], v[112:115], v[36:39]
    ds_read_b64 v[236:237], v13 offset:128
    ds_read_b64_tr_b16 v[96:97], v5 offset:12416
    ds_read_b64_tr_b16 v[98:99], v5 offset:13184
    ds_read_b64_tr_b16 v[100:101], v5 offset:12448
    ds_read_b64_tr_b16 v[102:103], v5 offset:13216
    ds_read_b64_tr_b16 v[104:105], v5 offset:12480
    ds_read_b64_tr_b16 v[106:107], v5 offset:13248
    s_add_u32 s35, s35, 1
    s_and_b32 s36, s35, 3
    s_mul_i32 s36, s36, 18624
    v_add_u32 v13, 128, v13
    v_add_u32 v5, s36, v4
    s_waitcnt lgkmcnt(6)
    v_xor_b32 v236, v236, v0
    v_lshlrev_b32_sdwa v240, 4, v236 dst_sel:DWORD dst_unused:UNUSED_PAD src0_sel:DWORD src1_sel:WORD_0
    v_lshlrev_b32_sdwa v241, 4, v236 dst_sel:DWORD dst_unused:UNUSED_PAD src0_sel:DWORD src1_sel:WORD_1
    s_branch L_endp2
L_pf5:
    s_waitcnt lgkmcnt(3)
    v_mfma_f32_16x16x32_bf16 v[24:27], v[72:75], v[108:111], v[24:27]
    ds_read_b64_tr_b16 v[84:85], v5 offset:6208
    ds_read_b64_tr_b16 v[86:87], v5 offset:6976
    v_mfma_f32_16x16x32_bf16 v[28:31], v[76:79], v[108:111], v[28:31]
    ds_read_b64_tr_b16 v[88:89], v5 offset:6240
    ds_read_b64_tr_b16 v[90:91], v5 offset:7008
    v_mfma_f32_16x16x32_bf16 v[32:35], v[80:83], v[108:111], v[32:35]
    ds_read_b64_tr_b16 v[92:93], v5 offset:6272
    ds_read_b64_tr_b16 v[94:95], v5 offset:7040
    ds_read_b128 v[124:127], v240 offset:64
    ds_read_b128 v[140:143], v240 offset:128
    ds_read_b64 v[236:237], v13 offset:128
    ds_read_b64_tr_b16 v[96:97], v5 offset:12416
    ds_read_b64_tr_b16 v[98:99], v5 offset:13184
    ds_read_b64_tr_b16 v[100:101], v5 offset:12448
    ds_read_b64_tr_b16 v[102:103], v5 offset:13216
    ds_read_b64_tr_b16 v[104:105], v5 offset:12480
    ds_read_b64_tr_b16 v[106:107], v5 offset:13248
    s_add_u32 s35, s35, 1
    s_and_b32 s36, s35, 3
    s_mul_i32 s36, s36, 18624
    v_add_u32 v13, 128, v13
    v_add_u32 v5, s36, v4
    s_waitcnt lgkmcnt(6)
    v_xor_b32 v236, v236, v0
    v_lshlrev_b32_sdwa v240, 4, v236 dst_sel:DWORD dst_unused:UNUSED_PAD src0_sel:DWORD src1_sel:WORD_0
    s_branch L_endp1
.p2align 3
L_topp2:
    s_barrier
L_bodyp2:
    s_setprio 2
.p2align 3
    v_mfma_f32_16x16x32_bf16 v[24:27], v[84:87], v[124:127], v[24:27]
    ds_read_b128 v[108:111], v240 offset:0
    v_mfma_f32_16x16x32_bf16 v[28:31], v[88:91], v[124:127], v[28:31]
    ds_read_b64_tr_b16 v[72:73], v5 offset:0
    v_mfma_f32_16x16x32_bf16 v[32:35], v[92:95], v[124:127], v[32:35]
    ds_read_b64_tr_b16 v[74:75], v5 offset:768
    v_mfma_f32_16x16x32_bf16 v[44:47], v[92:95], v[128:131], v[44:47]
    ds_read_b64_tr_b16 v[76:77], v5 offset:32
    v_mfma_f32_16x16x32_bf16 v[40:43], v[88:91], v[128:131], v[40:43]
    ds_read_b64_tr_b16 v[78:79], v5 offset:800
    v_mfma_f32_16x16x32_bf16 v[36:39], v[84:87], v[128:131], v[36:39]
    ds_read_b64_tr_b16 v[80:81], v5 offset:64
    ds_read_b64_tr_b16 v[82:83], v5 offset:832
    ds_read_b128 v[112:115], v241 offset:0
    s_setprio 1
.p2align 3
    v_mfma_f32_16x16x32_bf16 v[24:27], v[96:99], v[140:143], v[24:27]
    ds_read_b64_tr_b16 v[84:85], v5 offset:6208
    ds_read_b64_tr_b16 v[86:87], v5 offset:6976
    v_mfma_f32_16x16x32_bf16 v[28:31], v[100:103], v[140:143], v[28:31]
    ds_read_b64_tr_b16 v[88:89], v5 offset:6240
    ds_read_b64_tr_b16 v[90:91], v5 offset:7008
    v_mfma_f32_16x16x32_bf16 v[32:35], v[104:107], v[140:143], v[32:35]
    ds_read_b64_tr_b16 v[92:93], v5 offset:6272
    ds_read_b64_tr_b16 v[94:95], v5 offset:7040
    v_mfma_f32_16x16x32_bf16 v[44:47], v[104:107], v[144:147], v[44:47]
    ds_read_b128 v[140:143], v240 offset:128
    ds_read_b128 v[124:127], v240 offset:64
    v_mfma_f32_16x16x32_bf16 v[40:43], v[100:103], v[144:147], v[40:43]
    ds_read_b128 v[128:131], v241 offset:64
    v_mfma_f32_16x16x32_bf16 v[36:39], v[96:99], v[144:147], v[36:39]
    ds_read_b128 v[144:147], v241 offset:128
L_midp2:
    s_waitcnt lgkmcnt(10)
    s_setprio 0
.p2align 3
    v_mfma_f32_16x16x32_bf16 v[24:27], v[72:75], v[108:111], v[24:27]
    ds_read_b64 v[236:237], v13 offset:128
    v_mfma_f32_16x16x32_bf16 v[28:31], v[76:79], v[108:111], v[28:31]
    ds_read_b64_tr_b16 v[96:97], v5 offset:12416
    v_mfma_f32_16x16x32_bf16 v[32:35], v[80:83], v[108:111], v[32:35]
    ds_read_b64_tr_b16 v[98:99], v5 offset:13184
    v_mfma_f32_16x16x32_bf16 v[44:47], v[80:83], v[112:115], v[44:47]
    ds_read_b64_tr_b16 v[100:101], v5 offset:12448
    v_mfma_f32_16x16x32_bf16 v[40:43], v[76:79], v[112:115], v[40:43]
    ds_read_b64_tr_b16 v[102:103], v5 offset:13216
    v_mfma_f32_16x16x32_bf16 v[36:39], v[72:75], v[112:115], v[36:39]
    s_add_u32 s35, s35, 1
    s_and_b32 s36, s35, 3
    s_mul_i32 s36, s36, 18624
    ds_read_b64_tr_b16 v[104:105], v5 offset:12480
    ds_read_b64_tr_b16 v[106:107], v5 offset:13248
    v_add_u32 v13, 128, v13
    v_add_u32 v5, s36, v4
    s_waitcnt lgkmcnt(6)
    v_xor_b32 v236, v236, v0
    v_lshlrev_b32_sdwa v240, 4, v236 dst_sel:DWORD dst_unused:UNUSED_PAD src0_sel:DWORD src1_sel:WORD_0
    v_lshlrev_b32_sdwa v241, 4, v236 dst_sel:DWORD dst_unused:UNUSED_PAD src0_sel:DWORD src1_sel:WORD_1
L_endp2:
    s_bitcmp1_b32 s3, s35
    s_waitcnt vmcnt(0) lgkmcnt(0)
    s_cbranch_scc0 L_topp2
    s_bitcmp1_b32 s99, s35
    s_cbranch_scc1 L_spp2
    s_barrier
    s_bitcmp1_b32 s39, s35
    s_cbranch_scc0 L_spp2
    s_call_b64 s[76:77], L_dma
L_spp2:
    s_bitcmp1_b32 s37, s35
    s_cbranch_scc0 L_pn2
    s_call_b64 s[76:77], L_gp
L_pn2:
    s_cmp_lg_u32 s35, 9
    s_cbranch_scc1 L_bodyp2
    s_branch L_last2
.p2align 3
L_topp1:
    s_barrier
L_bodyp1:
    s_setprio 2
.p2align 3
    v_mfma_f32_16x16x32_bf16 v[24:27], v[84:87], v[124:127], v[24:27]
    ds_read_b128 v[108:111], v240 offset:0
    v_mfma_f32_16x16x32_bf16 v[28:31], v[88:91], v[124:127], v[28:31]
    ds_read_b64_tr_b16 v[72:73], v5 offset:0
    v_mfma_f32_16x16x32_bf16 v[32:35], v[92:95], v[124:127], v[32:35]
    ds_read_b64_tr_b16 v[74:75], v5 offset:768
    ds_read_b64_tr_b16 v[76:77], v5 offset:32
    ds_read_b64_tr_b16 v[78:79], v5 offset:800
    ds_read_b64_tr_b16 v[80:81], v5 offset:64
    ds_read_b64_tr_b16 v[82:83], v5 offset:832
    s_setprio 1
.p2align 3
    v_mfma_f32_16x16x32_bf16 v[24:27], v[96:99], v[140:143], v[24:27]
    ds_read_b64_tr_b16 v[84:85], v5 offset:6208
    ds_read_b64_tr_b16 v[86:87], v5 offset:6976
    ds_read_b64_tr_b16 v[88:89], v5 offset:6240
    v_mfma_f32_16x16x32_bf16 v[28:31], v[100:103], v[140:143], v[28:31]
    ds_read_b64_tr_b16 v[90:91], v5 offset:7008
    ds_read_b64_tr_b16 v[92:93], v5 offset:6272
    ds_read_b64_tr_b16 v[94:95], v5 offset:7040
    v_mfma_f32_16x16x32_bf16 v[32:35], v[104:107], v[140:143], v[32:35]
    ds_read_b128 v[124:127], v240 offset:64
    ds_read_b128 v[140:143], v240 offset:128
L_midp1:
    s_waitcnt lgkmcnt(8)
    s_setprio 0
.p2align 3
    v_mfma_f32_16x16x32_bf16 v[24:27], v[72:75], v[108:111], v[24:27]
    ds_read_b64 v[236:237], v13 offset:128
    v_mfma_f32_16x16x32_bf16 v[28:31], v[76:79], v[108:111], v[28:31]
    ds_read_b64_tr_b16 v[96:97], v5 offset:12416
    v_mfma_f32_16x16x32_bf16 v[32:35], v[80:83], v[108:111], v[32:35]
    ds_read_b64_tr_b16 v[98:99], v5 offset:13184
    ds_read_b64_tr_b16 v[100:101], v5 offset:12448
    ds_read_b64_tr_b16 v[102:103], v5 offset:13216
    s_add_u32 s35, s35, 1
    s_and_b32 s36, s35, 3
    s_mul_i32 s36, s36, 18624
    ds_read_b64_tr_b16 v[104:105], v5 offset:12480
    ds_read_b64_tr_b16 v[106:107], v5 offset:13248
    v_add_u32 v13, 128, v13
    v_add_u32 v5, s36, v4
    s_waitcnt lgkmcnt(6)
    v_xor_b32 v236, v236, v0
    v_lshlrev_b32_sdwa v240, 4, v236 dst_sel:DWORD dst_unused:UNUSED_PAD src0_sel:DWORD src1_sel:WORD_0
L_endp1:
    s_bitcmp1_b32 s3, s35
    s_waitcnt vmcnt(0) lgkmcnt(0)
    s_cbranch_scc0 L_topp1
    s_bitcmp1_b32 s99, s35
    s_cbranch_scc1 L_spp1
    s_barrier
    s_bitcmp1_b32 s39, s35
    s_cbranch_scc0 L_spp1
    s_call_b64 s[76:77], L_dma
L_spp1:
    s_bitcmp1_b32 s37, s35
    s_cbranch_scc0 L_pn1
    s_call_b64 s[76:77], L_gp
L_pn1:
    s_cmp_lg_u32 s35, 9
    s_cbranch_scc1 L_bodyp1
    s_branch L_last1
.p2align 12
L_startD:
    s_lshr_b32 s26, s28, 2
    s_lshl_b32 s26, s26, 1
    s_add_u32 s26, s26, s29
    s_mul_i32 s96, s26, 8064
    s_add_u32 s96, s96, s3
    buffer_load_dwordx3 v[204:206], v224, s[8:11], s96 offen
    s_sub_u32 s34, s32, 2
    s_bfe_u32 s100, s23, 0x10011
    s_lshl_b32 s101, s100, 1
    s_sub_u32 s101, 19, s101
    s_movk_i32 s97, 223
    v_add_u32 v74, s34, v76
    v_subrev_u32 v75, s100, v76
    v_med3_i32 v74, v74, 0, s97
    v_cmp_ge_u32 vcc, s101, v75
    v_mul_u32_u24 v74, 192, v74
    s_and_b64 s[92:93], s[92:93], vcc
    v_add_u32 v20, v74, v20
    s_cmp_lt_u32 s28, 4
    s_cbranch_scc1 L_startAD
    s_max_i32 s96, s20, 0
    s_add_u32 m0, s94, 0
    s_mov_b64 exec, s[92:93]
    s_add_u32 s20, s20, 43008
    buffer_load_dwordx4 v20, s[4:7], s96 offen lds
    s_max_i32 s96, s20, 0
    s_addk_i32 m0, 3904
    s_add_u32 s20, s20, 43008
    buffer_load_dwordx4 v20, s[4:7], s96 offen lds
    s_min_i32 s96, s20, s21
    s_addk_i32 m0, 3904
    s_add_u32 s20, s20, 43008
    buffer_load_dwordx4 v20, s[4:7], s96 offen lds
    s_min_i32 s96, s20, s21
    s_addk_i32 m0, 3904
    s_add_u32 s20, s20, 43008
    buffer_load_dwordx4 v20, s[4:7], s96 offen lds
    s_min_i32 s96, s20, s21
    s_addk_i32 m0, 3904
    s_add_u32 s20, s20, 43008
    buffer_load_dwordx4 v20, s[4:7], s96 offen lds
    s_min_i32 s96, s20, s21
    s_addk_i32 m0, 3904
    s_add_u32 s20, s20, 43008
    buffer_load_dwordx4 v20, s[4:7], s96 offen lds
    s_mov_b64 exec, -1
    s_call_b64 s[76:77], L_setup1
    s_call_b64 s[76:77], L_dsetup
    s_min_i32 s96, s20, s21
    s_add_u32 m0, s94, 23424
    s_mov_b64 exec, s[92:93]
    s_add_u32 s20, s20, 43008
    buffer_load_dwordx4 v20, s[4:7], s96 offen lds
    s_min_i32 s96, s20, s21
    s_addk_i32 m0, 3904
    s_add_u32 s20, s20, 43008
    buffer_load_dwordx4 v20, s[4:7], s96 offen lds
    s_mov_b64 exec, -1
    s_add_u32 m0, s88, 0
    s_mov_b32 s96, 0
    buffer_load_dwordx4 v19, s[12:15], s96 offen lds
    s_waitcnt vmcnt(9)
    s_call_b64 s[76:77], L_tables1
    s_add_u32 m0, s89, 4128
    s_mov_b32 s96, 4096
    buffer_load_dwordx4 v19, s[12:15], s96 offen lds
    s_add_u32 m0, s90, 8256
    s_mov_b32 s96, 8192
    buffer_load_dwordx4 v19, s[12:15], s96 offen lds
    s_add_u32 m0, s88, 12416
    s_mov_b32 s96, 12288
    buffer_load_dwordx4 v19, s[12:15], s96 offen lds
    s_add_u32 m0, s89, 16544
    s_mov_b32 s96, 16384
    buffer_load_dwordx4 v19, s[12:15], s96 offen lds
    s_add_u32 m0, s90, 20672
    s_mov_b32 s96, 20480
    buffer_load_dwordx4 v19, s[12:15], s96 offen lds
    s_call_b64 s[76:77], L_setup2
    s_add_u32 m0, s88, 24832
    s_mov_b32 s96, 24576
    buffer_load_dwordx4 v19, s[12:15], s96 offen lds
    s_add_u32 m0, s89, 28960
    s_mov_b32 s96, 28672
    buffer_load_dwordx4 v19, s[12:15], s96 offen lds
    s_add_u32 m0, s90, 33088
    s_mov_b32 s96, 32768
    buffer_load_dwordx4 v19, s[12:15], s96 offen lds
    s_waitcnt vmcnt(9)
    s_branch L_dfirst
L_startAD:
    s_add_u32 s20, s20, 344064
    s_add_u32 m0, s94, 31232
    s_mov_b64 exec, s[92:93]
    s_cmp_lt_u32 s23, 150994944
    s_cbranch_scc1 L_ad1
    s_min_i32 s96, s20, s21
    s_add_u32 s20, s20, 43008
    buffer_load_dwordx4 v20, s[4:7], s96 offen lds
    s_addk_i32 m0, 3904
    s_cmp_lt_u32 s23, 167772160
    s_cbranch_scc1 L_ad1
    s_min_i32 s96, s20, s21
    s_add_u32 s20, s20, 43008
    buffer_load_dwordx4 v20, s[4:7], s96 offen lds
    s_addk_i32 m0, 3904
    s_cmp_lt_u32 s23, 184549376
    s_cbranch_scc1 L_ad1
    s_min_i32 s96, s20, s21
    s_add_u32 s20, s20, 43008
    buffer_load_dwordx4 v20, s[4:7], s96 offen lds
    s_addk_i32 m0, 3904
    s_cmp_lt_u32 s23, 201326592
    s_cbranch_scc1 L_ad1
    s_min_i32 s96, s20, s21
    s_add_u32 s20, s20, 43008
    buffer_load_dwordx4 v20, s[4:7], s96 offen lds
    s_addk_i32 m0, 3904
L_ad1:
    s_mov_b64 exec, -1
    s_lshr_b32 s96, s2, 3
    s_and_b32 s96, s96, 31
    s_lshl_b32 s96, s96, 2
    s_add_u32 s96, s96, s28
    s_mul_i32 s96, s96, 1152
    s_add_u32 s96, s96, 18432
    v_lshlrev_b32 v23, 3, v14
    s_mov_b64 exec, 0x1ff
    buffer_load_dword v23, v23, s[12:15], s96 offen
    s_mov_b64 exec, -1
    s_call_b64 s[76:77], L_setup1
    s_call_b64 s[76:77], L_dsetup
    s_cmp_lt_u32 s23, 167772160
    s_cbranch_scc1 L_ad2
    s_cmp_lt_u32 s23, 201326592
    s_cbranch_scc1 L_ad4
    s_waitcnt vmcnt(5)
    s_branch L_ad3
L_ad2:
    s_waitcnt vmcnt(1)
L_ad4:
    s_waitcnt vmcnt(3)
L_ad3:
    s_call_b64 s[76:77], L_tables1
    s_call_b64 s[76:77], L_setup2
    s_waitcnt vmcnt(0)
    s_branch L_dfirst
L_dsetup:
    v_bfe_u32 v156, v14, 6, 2
    v_bfe_u32 v157, v14, 4, 2
    v_lshrrev_b32 v158, 8, v14
    v_mov_b32 v159, 0x0c0c0100
    v_mov_b32 v160, 0x01000c0c
    v_and_b32 v161, 1, v156
    v_cmp_eq_u32 vcc, 1, v161
    v_cmp_eq_u32 s[70:71], v157, v158
    v_cmp_gt_u32 s[72:73], 2, v156
    v_and_b32 v161, 1, v157
    v_lshrrev_b32 v157, 1, v157
    v_lshl_add_u32 v157, v161, 2, v157
    v_lshlrev_b32 v6, 3, v157
    v_cndmask_b32 v159, v159, v160, vcc
    v_mov_b32 v160, 0x0202
    v_mov_b32 v157, 0x02020000
    v_add_u32 v7, 16, v6
    v_cndmask_b32 v160, v160, v157, vcc
    s_andn2_b64 s[74:75], s[70:71], s[72:73]
    s_and_b64 s[72:73], s[70:71], s[72:73]
    v_add_u32 v160, v159, v160
    v_mov_b32 v157, 0x0c0c0c0c
    v_cndmask_b32 v8, v157, v159, s[72:73]
    v_cndmask_b32 v9, v157, v159, s[74:75]
    v_cndmask_b32 v10, v157, v160, s[72:73]
    v_cndmask_b32 v11, v157, v160, s[74:75]
    v_and_b32 v159, 1, v158
    v_lshrrev_b32 v160, 1, v158
    v_lshl_add_u32 v159, v159, 2, v160
    v_lshlrev_b32 v16, 3, v159
    v_lshl_add_u32 v251, v158, 2, v156
    v_mov_b32 v228, 0xf400f40
    s_mov_b32 s91, 0x435f435f
    s_mov_b32 s97, 0
    s_lshr_b64 s[70:71], s[24:25], s97
    s_bfe_u32 s69, s70, 0x5000b
    s_and_b32 s68, s70, 0x7ff
    s_lshl_b32 s69, s69, 2
    s_lshl_b32 s68, s68, 6
    s_mov_b32 s25, s68
    s_bfe_u32 s66, s28, 0x10001
    s_mul_i32 s66, s66, 4608
    s_add_u32 s66, s66, 65536
    s_add_u32 s96, s26, s31
    s_mul_i32 s67, s96, 1792
    s_add_u32 s67, s67, 74752
    s_mul_i32 s96, s96, s69
    s_mul_i32 s96, s96, 192
    s_add_u32 s68, s96, s25
    s_cmp_lt_u32 s26, s30
    s_cselect_b32 s40, 1, 0
    s_mov_b32 s42, s26
    s_bfe_u32 s96, s23, 0x50018
    s_sub_u32 s96, s96, 1
    v_mov_b32 v225, 0
    v_mov_b32 v226, s96
    s_setpc_b64 s[76:77]
L_tables:
    s_mov_b32 s42, 0
L_tables1:
    s_mov_b32 exec_hi, 0xffff
    s_mov_b32 s43, 0
    s_mov_b32 s27, 0
    v_mul_u32_u24 v12, 48, v230
    v_add_lshl_u32 v12, v12, v231, 3
L_tl:
    s_bitcmp1_b32 s40, 0
    s_cbranch_scc0 L_tn
    s_mul_i32 s96, s42, 1152
    v_cvt_f32_u32 v229, s42
    s_add_u32 s96, s96, s66
    v_add_f32 v229, v229, v220
    v_add_u32 v227, s96, v12
    v_lshlrev_b32 v77, 16, v204
    v_lshlrev_b32 v161, 16, v205
    v_lshlrev_b32 v185, 16, v206
    v_and_b32 v78, 0xffff0000, v204
    v_and_b32 v162, 0xffff0000, v205
    v_and_b32 v186, 0xffff0000, v206
    v_add_f32 v77, v77, v229
    v_add_f32 v161, v161, v229
    v_add_f32 v185, v185, v229
    v_add_f32 v78, v78, v221
    v_add_f32 v162, v162, v222
    v_add_f32 v186, v186, v223
    v_cvt_pk_bf16_f32 v76, v77, v78
    v_cvt_pk_bf16_f32 v160, v161, v162
    v_cvt_pk_bf16_f32 v184, v185, v186
    v_pk_max_i16 v76, v76, 0
    v_pk_max_i16 v160, v160, 0
    v_pk_max_i16 v184, v184, 0
    v_pk_min_i16 v76, v76, s91
    v_pk_min_i16 v160, v160, s91
    v_pk_min_i16 v184, v184, s91
    v_lshlrev_b32 v77, 16, v76
    v_lshlrev_b32 v161, 16, v160
    v_lshlrev_b32 v185, 16, v184
    v_and_b32 v78, 0xffff0000, v76
    v_and_b32 v162, 0xffff0000, v160
    v_and_b32 v186, 0xffff0000, v184
    v_fract_f32 v79, v77
    v_fract_f32 v163, v161
    v_fract_f32 v187, v185
    v_fract_f32 v80, v78
    v_fract_f32 v164, v162
    v_fract_f32 v188, v186
    v_cvt_u32_f32 v81, v77
    v_cvt_u32_f32 v165, v161
    v_cvt_u32_f32 v189, v185
    v_cvt_u32_f32 v82, v78
    v_cvt_u32_f32 v166, v162
    v_cvt_u32_f32 v190, v186
    v_cmp_neq_f32 s[44:45], 0, v80
    v_cmp_neq_f32 s[50:51], 0, v164
    v_cmp_neq_f32 s[56:57], 0, v188
    v_cmp_neq_f32 s[46:47], 0, v79
    v_cmp_neq_f32 s[52:53], 0, v163
    v_cmp_neq_f32 s[58:59], 0, v187
    v_sub_f32 v83, 1.0, v79
    v_sub_f32 v167, 1.0, v163
    v_sub_f32 v191, 1.0, v187
    v_sub_f32 v84, 1.0, v80
    v_sub_f32 v168, 1.0, v164
    v_sub_f32 v192, 1.0, v188
    v_subrev_u32 v81, s33, v81
    v_subrev_u32 v165, s33, v165
    v_subrev_u32 v189, s33, v189
    v_subrev_u32 v82, s34, v82
    v_subrev_u32 v166, s34, v166
    v_subrev_u32 v190, s34, v190
    v_cvt_pk_bf16_f32 v77, v83, v84
    v_cvt_pk_bf16_f32 v161, v167, v168
    v_cvt_pk_bf16_f32 v185, v191, v192
    v_sub_u32 v89, v81, v225
    v_sub_u32 v173, v165, v225
    v_sub_u32 v197, v189, v225
    v_addc_co_u32 v91, vcc, 0, v82, s[44:45]
    v_addc_co_u32 v175, vcc, 0, v166, s[50:51]
    v_addc_co_u32 v199, vcc, 0, v190, s[56:57]
    v_lshlrev_b32 v83, 16, v77
    v_lshlrev_b32 v167, 16, v161
    v_lshlrev_b32 v191, 16, v185
    v_and_b32 v84, 0xffff0000, v77
    v_and_b32 v168, 0xffff0000, v161
    v_and_b32 v192, 0xffff0000, v185
    v_addc_co_u32 v90, vcc, 0, v89, s[46:47]
    v_addc_co_u32 v174, vcc, 0, v173, s[52:53]
    v_addc_co_u32 v198, vcc, 0, v197, s[58:59]
    v_mul_u32_u24 v92, 976, v81
    v_mul_u32_u24 v176, 976, v165
    v_mul_u32_u24 v200, 976, v189
    v_mul_f32 v85, v83, v84
    v_mul_f32 v169, v167, v168
    v_mul_f32 v193, v191, v192
    v_mul_f32 v86, v83, v80
    v_mul_f32 v170, v167, v164
    v_mul_f32 v194, v191, v188
    v_mul_f32 v87, v79, v84
    v_mul_f32 v171, v163, v168
    v_mul_f32 v195, v187, v192
    v_mul_f32 v88, v79, v80
    v_mul_f32 v172, v163, v164
    v_mul_f32 v196, v187, v188
    v_max_u32 v89, v89, v90
    v_max_u32 v173, v173, v174
    v_max_u32 v197, v197, v198
    v_subrev_u32 v77, s100, v82
    v_subrev_u32 v161, s100, v166
    v_subrev_u32 v185, s100, v190
    v_subrev_u32 v78, s100, v91
    v_subrev_u32 v162, s100, v175
    v_subrev_u32 v186, s100, v199
    v_mad_u32_u24 v83, v82, 48, v92
    v_mad_u32_u24 v167, v166, 48, v176
    v_mad_u32_u24 v191, v190, 48, v200
    v_mad_u32_u24 v84, v91, 48, v92
    v_mad_u32_u24 v168, v175, 48, v176
    v_mad_u32_u24 v192, v199, 48, v200
    v_and_b32 v82, 12, v82
    v_and_b32 v166, 12, v166
    v_and_b32 v190, 12, v190
    v_and_b32 v91, 12, v91
    v_and_b32 v175, 12, v175
    v_and_b32 v199, 12, v199
    v_max_u32 v77, v77, v78
    v_max_u32 v161, v161, v162
    v_max_u32 v185, v185, v186
    s_andn2_b64 s[48:49], s[46:47], s[44:45]
    s_andn2_b64 s[54:55], s[52:53], s[50:51]
    s_andn2_b64 s[60:61], s[58:59], s[56:57]
    v_add_lshl_u32 v83, v83, v82, 2
    v_add_lshl_u32 v167, v167, v166, 2
    v_add_lshl_u32 v191, v191, v190, 2
    v_add_lshl_u32 v84, v84, v91, 2
    v_add_lshl_u32 v168, v168, v175, 2
    v_add_lshl_u32 v192, v192, v199, 2
    v_cndmask_b32 v86, v87, v86, s[44:45]
    v_cndmask_b32 v170, v171, v170, s[50:51]
    v_cndmask_b32 v194, v195, v194, s[56:57]
    v_cndmask_b32 v78, 0, v228, s[48:49]
    v_cndmask_b32 v162, 0, v228, s[54:55]
    v_cndmask_b32 v186, 0, v228, s[60:61]
    s_and_b64 s[48:49], s[46:47], s[44:45]
    s_and_b64 s[54:55], s[52:53], s[50:51]
    s_and_b64 s[60:61], s[58:59], s[56:57]
    v_cndmask_b32 v87, 0, v87, s[44:45]
    v_cndmask_b32 v171, 0, v171, s[50:51]
    v_cndmask_b32 v195, 0, v195, s[56:57]
    v_cmp_lt_u32 s[46:47], v226, v89
    v_cmp_lt_u32 s[52:53], v226, v173
    v_cmp_lt_u32 s[58:59], v226, v197
    v_cmp_lt_u32 s[44:45], s101, v77
    v_cmp_lt_u32 s[50:51], s101, v161
    v_cmp_lt_u32 s[56:57], s101, v185
    v_lshl_or_b32 v74, v84, 16, v83
    v_lshl_or_b32 v158, v168, 16, v167
    v_lshl_or_b32 v182, v192, 16, v191
    v_cvt_pk_bf16_f32 v73, v85, v86
    v_cvt_pk_bf16_f32 v157, v169, v170
    v_cvt_pk_bf16_f32 v181, v193, v194
    v_cvt_pk_bf16_f32 v75, v87, v88
    v_cvt_pk_bf16_f32 v159, v171, v172
    v_cvt_pk_bf16_f32 v183, v195, v196
    v_and_b32 v78, 0xffff0000, v78
    v_and_b32 v162, 0xffff0000, v162
    v_and_b32 v186, 0xffff0000, v186
    v_cndmask_b32 v77, 0, v228, s[48:49]
    v_cndmask_b32 v161, 0, v228, s[54:55]
    v_cndmask_b32 v185, 0, v228, s[60:61]
    s_or_b64 s[44:45], s[44:45], s[46:47]
    s_or_b64 s[50:51], s[50:51], s[52:53]
    s_or_b64 s[56:57], s[56:57], s[58:59]
    v_add_u32 v72, v74, v78
    v_add_u32 v156, v158, v162
    v_add_u32 v180, v182, v186
    v_add_u32 v74, v74, v77
    v_add_u32 v158, v158, v161
    v_add_u32 v182, v182, v185
    s_or_b64 s[70:71], s[44:45], s[48:49]
    s_cbranch_scc1 L_tx0
L_tw0:
    ds_write_b64 v227, v[72:73] offset:0
    s_or_b64 s[70:71], s[50:51], s[54:55]
    s_cbranch_scc1 L_tx1
L_tw1:
    ds_write_b64 v227, v[156:157] offset:128
    s_or_b64 s[70:71], s[56:57], s[60:61]
    s_cbranch_scc1 L_tx2
L_tw2:
    ds_write_b64 v227, v[180:181] offset:256
L_tn:
    s_lshr_b32 s40, s40, 1
    s_cbranch_scc1 L_tm
    s_mov_b32 exec_hi, -1
    v_lshl_add_u32 v12, v251, 3, s66
    s_setpc_b64 s[76:77]
L_tm:
    v_mov_b32 v204, v208
    v_mov_b32 v205, v209
    v_mov_b32 v206, v210
    v_mov_b32 v208, v212
    v_mov_b32 v209, v213
    v_mov_b32 v210, v214
    v_mov_b32 v212, v216
    v_mov_b32 v213, v217
    v_mov_b32 v214, v218
    s_add_u32 s42, s42, 1
    s_branch L_tl
L_tx0:
    s_andn2_b64 s[48:49], s[48:49], s[44:45]
    s_bcnt1_i32_b64 s96, s[48:49]
    s_add_u32 s96, s96, s27
    s_cmp_gt_u32 s96, s69
    s_cselect_b64 s[44:45], s[70:71], s[44:45]
    s_cselect_b64 s[48:49], 0, s[48:49]
    s_cselect_b32 s96, s27, s96
    v_mbcnt_lo_u32_b32 v76, s48, 0
    v_mbcnt_hi_u32_b32 v76, s49, v76
    v_add_u32 v76, s27, v76
    s_mov_b32 s27, s96
    v_lshl_add_u32 v77, v76, 4, s67
    v_bfe_u32 v78, v76, 1, 2
    v_mad_u32_u24 v76, v76, 12, v78
    s_mov_b64 exec, s[48:49]
    v_lshl_add_u32 v76, v76, 4, s68
    ds_write_b128 v77, v[72:75]
    v_mul_u32_u24 v72, 0x10001, v76
    v_mov_b32 v73, 0x3f80
    s_mov_b64 exec, s[44:45]
    v_mov_b32 v72, 2
    s_or_b32 s43, s43, s44
    s_or_b32 s43, s43, s45
    s_mov_b32 exec_lo, -1
    s_mov_b32 exec_hi, 0xffff
    s_branch L_tw0
L_tx1:
    s_andn2_b64 s[54:55], s[54:55], s[50:51]
    s_bcnt1_i32_b64 s96, s[54:55]
    s_add_u32 s96, s96, s27
    s_cmp_gt_u32 s96, s69
    s_cselect_b64 s[50:51], s[70:71], s[50:51]
    s_cselect_b64 s[54:55], 0, s[54:55]
    s_cselect_b32 s96, s27, s96
    v_mbcnt_lo_u32_b32 v160, s54, 0
    v_mbcnt_hi_u32_b32 v160, s55, v160
    v_add_u32 v160, s27, v160
    s_mov_b32 s27, s96
    v_lshl_add_u32 v161, v160, 4, s67
    v_bfe_u32 v162, v160, 1, 2
    v_mad_u32_u24 v160, v160, 12, v162
    s_mov_b64 exec, s[54:55]
    v_lshl_add_u32 v160, v160, 4, s68
    ds_write_b128 v161, v[156:159]
    v_mul_u32_u24 v156, 0x10001, v160
    v_mov_b32 v157, 0x3f80
    s_mov_b64 exec, s[50:51]
    v_mov_b32 v156, 2
    s_or_b32 s43, s43, s50
    s_or_b32 s43, s43, s51
    s_mov_b32 exec_lo, -1
    s_mov_b32 exec_hi, 0xffff
    s_branch L_tw1
L_tx2:
    s_andn2_b64 s[60:61], s[60:61], s[56:57]
    s_bcnt1_i32_b64 s96, s[60:61]
    s_add_u32 s96, s96, s27
    s_cmp_gt_u32 s96, s69
    s_cselect_b64 s[56:57], s[70:71], s[56:57]
    s_cselect_b64 s[60:61], 0, s[60:61]
    s_cselect_b32 s96, s27, s96
    v_mbcnt_lo_u32_b32 v184, s60, 0
    v_mbcnt_hi_u32_b32 v184, s61, v184
    v_add_u32 v184, s27, v184
    s_mov_b32 s27, s96
    v_lshl_add_u32 v185, v184, 4, s67
    v_bfe_u32 v186, v184, 1, 2
    v_mad_u32_u24 v184, v184, 12, v186
    s_mov_b64 exec, s[60:61]
    v_lshl_add_u32 v184, v184, 4, s68
    ds_write_b128 v185, v[180:183]
    v_mul_u32_u24 v180, 0x10001, v184
    v_mov_b32 v181, 0x3f80
    s_mov_b64 exec, s[56:57]
    v_mov_b32 v180, 2
    s_or_b32 s43, s43, s56
    s_or_b32 s43, s43, s57
    s_mov_b32 exec_lo, -1
    s_mov_b32 exec_hi, 0xffff
    s_branch L_tw2
.p2align 12
L_dfirst:
    s_cmp_lg_u32 s43, 0
    s_cselect_b32 s96, 0x10000, 0
    s_or_b32 s96, s96, s27
    v_mov_b32 v17, s96
    ds_write_b32 v254, v17 offset:32
    v_mov_b32 v17, 163808
    v_xor_b32 v255, 16, v254
    v_mfma_f32_32x32x16_bf16 v[72:87], v[108:111], v[108:111], 0
    v_mfma_f32_32x32x16_bf16 v[80:95], v[108:111], v[108:111], 0
    v_mov_b32 v112, 0
    v_mov_b32 v113, 0
    v_mov_b32 v114, 0
    v_mov_b32 v115, 0
    v_mov_b32 v116, 0
    v_mov_b32 v117, 0
    v_mov_b32 v118, 0
    v_mov_b32 v119, 0
    s_add_u32 s97, s29, 2
    s_cmp_lt_u32 s97, s30
    s_cselect_b32 s96, s26, s29
    s_cselect_b32 s40, 2304, 0
    s_mul_i32 s96, s96, 1152
    s_lshr_b32 s35, s28, 2
    s_lshl_b32 s97, s35, 7
    s_add_u32 s96, s96, s97
    s_sub_u32 s98, 0, s40
    s_cmp_eq_u32 s35, 0
    s_cselect_b32 s40, s40, s98
    v_add_u32 v13, s96, v12
    v_add_u32 v252, s40, v13
    s_waitcnt lgkmcnt(0)
    s_barrier
    ds_read_b128 v[156:159], v17
    ds_read_b128 v[160:163], v17 offset:16
    ds_read_b32 v164, v255 offset:32
    ds_read_b64 v[236:237], v13
    ds_read_b64 v[238:239], v252
    s_waitcnt lgkmcnt(3)
    v_or3_b32 v156, v156, v157, v158
    v_or3_b32 v159, v159, v160, v161
    v_or3_b32 v156, v156, v162, v163
    v_or_b32 v156, v156, v159
    v_cmp_ne_u32 vcc, 0, v156
    s_cbranch_vccnz L_dpatch
L_dgo:
    s_cmp_ge_u32 s29, s30
    s_cbranch_scc1 L_dnone0
    v_lshrrev_b32 v17, 9, v14
    s_mul_i32 s96, s29, 96
    s_mul_i32 s36, s35, 18624
    v_mul_u32_u24 v17, 768, v17
    v_sub_u32 v4, v4, v17
    v_subrev_u32 v4, s96, v4
    s_waitcnt lgkmcnt(0)
    v_xor_b32_sdwa v244, v236, v6 dst_sel:DWORD dst_unused:UNUSED_PAD src0_sel:WORD_0 src1_sel:DWORD
    v_xor_b32_sdwa v246, v236, v6 dst_sel:DWORD dst_unused:UNUSED_PAD src0_sel:WORD_1 src1_sel:DWORD
    v_xor_b32_sdwa v245, v236, v7 dst_sel:DWORD dst_unused:UNUSED_PAD src0_sel:WORD_0 src1_sel:DWORD
    v_xor_b32_sdwa v247, v236, v7 dst_sel:DWORD dst_unused:UNUSED_PAD src0_sel:WORD_1 src1_sel:DWORD
    v_xor_b32_sdwa v152, v238, v6 dst_sel:DWORD dst_unused:UNUSED_PAD src0_sel:WORD_0 src1_sel:DWORD
    v_xor_b32_sdwa v154, v238, v6 dst_sel:DWORD dst_unused:UNUSED_PAD src0_sel:WORD_1 src1_sel:DWORD
    v_xor_b32_sdwa v153, v238, v7 dst_sel:DWORD dst_unused:UNUSED_PAD src0_sel:WORD_0 src1_sel:DWORD
    v_xor_b32_sdwa v155, v238, v7 dst_sel:DWORD dst_unused:UNUSED_PAD src0_sel:WORD_1 src1_sel:DWORD
    ds_read_b64_tr_b16 v[120:121], v244 offset:0
    ds_read_b64_tr_b16 v[122:123], v246 offset:0
    ds_read_b64_tr_b16 v[124:125], v245 offset:0
    ds_read_b64_tr_b16 v[126:127], v247 offset:0
    ds_read_b64_tr_b16 v[128:129], v152 offset:0
    ds_read_b64_tr_b16 v[130:131], v154 offset:0
    ds_read_b64_tr_b16 v[132:133], v153 offset:0
    ds_read_b64_tr_b16 v[134:135], v155 offset:0
    v_perm_b32 v228, v237, v237, v8
    v_perm_b32 v229, v237, v237, v9
    v_perm_b32 v230, v237, v237, v10
    v_perm_b32 v231, v237, v237, v11
    v_perm_b32 v232, v239, v239, v8
    v_perm_b32 v233, v239, v239, v9
    v_perm_b32 v234, v239, v239, v10
    v_perm_b32 v235, v239, v239, v11
    v_add_u32 v5, s36, v4
    v_add_u32 v13, 256, v13
    v_add_u32 v252, 256, v252
    s_waitcnt lgkmcnt(0)
    v_mfma_f32_16x16x32_bf16 v[136:139], v[120:123], v[228:231], 0
    v_mfma_f32_16x16x32_bf16 v[140:143], v[124:127], v[228:231], 0
    v_mfma_f32_16x16x32_bf16 v[144:147], v[128:131], v[232:235], 0
    v_mfma_f32_16x16x32_bf16 v[148:151], v[132:135], v[232:235], 0
    ds_read_b64_tr_b16 v[120:121], v244 offset:64
    ds_read_b64_tr_b16 v[122:123], v246 offset:64
    ds_read_b64_tr_b16 v[124:125], v245 offset:64
    ds_read_b64_tr_b16 v[126:127], v247 offset:64
    ds_read_b64_tr_b16 v[128:129], v152 offset:64
    ds_read_b64_tr_b16 v[130:131], v154 offset:64
    ds_read_b64_tr_b16 v[132:133], v153 offset:64
    ds_read_b64_tr_b16 v[134:135], v155 offset:64
    ds_read_b64 v[236:237], v13
    ds_read_b64 v[238:239], v252
    v_cvt_pk_bf16_f32 v96, v136, v137
    v_cvt_pk_bf16_f32 v97, v138, v139
    v_cvt_pk_bf16_f32 v98, v140, v141
    v_cvt_pk_bf16_f32 v99, v142, v143
    v_cvt_pk_bf16_f32 v100, v144, v145
    v_cvt_pk_bf16_f32 v101, v146, v147
    v_cvt_pk_bf16_f32 v102, v148, v149
    v_cvt_pk_bf16_f32 v103, v150, v151
    s_waitcnt lgkmcnt(2)
    v_mfma_f32_16x16x32_bf16 v[136:139], v[120:123], v[228:231], 0
    v_mfma_f32_16x16x32_bf16 v[140:143], v[124:127], v[228:231], 0
    v_mfma_f32_16x16x32_bf16 v[144:147], v[128:131], v[232:235], 0
    v_mfma_f32_16x16x32_bf16 v[148:151], v[132:135], v[232:235], 0
    s_waitcnt vmcnt(0) lgkmcnt(0)
    s_barrier
    s_cmp_lt_u32 s28, 4
    s_cbranch_scc1 L_dbody
    s_call_b64 s[76:77], L_dw23
.p2align 3
L_dbody:
    s_setprio 2
    v_mfma_f32_16x16x32_bf16 v[24:27], v[72:75], v[112:115], v[24:27]
    ds_read_b64_tr_b16 v[120:121], v244 offset:128
    ds_read_b64_tr_b16 v[122:123], v246 offset:128
    v_mfma_f32_16x16x32_bf16 v[48:51], v[72:75], v[116:119], v[48:51]
    ds_read_b64_tr_b16 v[124:125], v245 offset:128
    ds_read_b64_tr_b16 v[126:127], v247 offset:128
    v_mfma_f32_16x16x32_bf16 v[52:55], v[76:79], v[116:119], v[52:55]
    ds_read_b64_tr_b16 v[128:129], v152 offset:128
    v_cvt_pk_bf16_f32 v104, v136, v137
    v_mfma_f32_16x16x32_bf16 v[28:31], v[76:79], v[112:115], v[28:31]
    ds_read_b64_tr_b16 v[130:131], v154 offset:128
    v_cvt_pk_bf16_f32 v105, v138, v139
    v_mfma_f32_16x16x32_bf16 v[32:35], v[80:83], v[112:115], v[32:35]
    ds_read_b64_tr_b16 v[132:133], v153 offset:128
    v_cvt_pk_bf16_f32 v106, v140, v141
    v_mfma_f32_16x16x32_bf16 v[56:59], v[80:83], v[116:119], v[56:59]
    ds_read_b64_tr_b16 v[134:135], v155 offset:128
    v_cvt_pk_bf16_f32 v107, v142, v143
    ds_read_b64_tr_b16 v[72:73], v5 offset:0
    v_mfma_f32_16x16x32_bf16 v[60:63], v[84:87], v[116:119], v[60:63]
    ds_read_b64_tr_b16 v[74:75], v5 offset:1536
    v_cvt_pk_bf16_f32 v108, v144, v145
    v_mfma_f32_16x16x32_bf16 v[36:39], v[84:87], v[112:115], v[36:39]
    ds_read_b64_tr_b16 v[76:77], v5 offset:32
    v_cvt_pk_bf16_f32 v109, v146, v147
    v_mfma_f32_16x16x32_bf16 v[40:43], v[88:91], v[112:115], v[40:43]
    ds_read_b64_tr_b16 v[78:79], v5 offset:1568
    v_cvt_pk_bf16_f32 v110, v148, v149
    v_mfma_f32_16x16x32_bf16 v[64:67], v[88:91], v[116:119], v[64:67]
    ds_read_b64_tr_b16 v[80:81], v5 offset:64
    v_cvt_pk_bf16_f32 v111, v150, v151
    ds_read_b64_tr_b16 v[82:83], v5 offset:1600
    v_mfma_f32_16x16x32_bf16 v[68:71], v[92:95], v[116:119], v[68:71]
    ds_read_b64_tr_b16 v[84:85], v5 offset:96
    v_xor_b32_sdwa v244, v236, v6 dst_sel:DWORD dst_unused:UNUSED_PAD src0_sel:WORD_0 src1_sel:DWORD
    v_mfma_f32_16x16x32_bf16 v[44:47], v[92:95], v[112:115], v[44:47]
    ds_read_b64_tr_b16 v[86:87], v5 offset:1632
    v_xor_b32_sdwa v246, v236, v6 dst_sel:DWORD dst_unused:UNUSED_PAD src0_sel:WORD_1 src1_sel:DWORD
    s_waitcnt lgkmcnt(8)
    v_mfma_f32_16x16x32_bf16 v[136:139], v[120:123], v[228:231], 0
    ds_read_b64_tr_b16 v[88:89], v5 offset:128
    v_xor_b32_sdwa v245, v236, v7 dst_sel:DWORD dst_unused:UNUSED_PAD src0_sel:WORD_0 src1_sel:DWORD
    v_mfma_f32_16x16x32_bf16 v[140:143], v[124:127], v[228:231], 0
    ds_read_b64_tr_b16 v[90:91], v5 offset:1664
    v_xor_b32_sdwa v247, v236, v7 dst_sel:DWORD dst_unused:UNUSED_PAD src0_sel:WORD_1 src1_sel:DWORD
    ds_read_b64_tr_b16 v[92:93], v5 offset:160
    v_mfma_f32_16x16x32_bf16 v[144:147], v[128:131], v[232:235], 0
    ds_read_b64_tr_b16 v[94:95], v5 offset:1696
    v_xor_b32_sdwa v152, v238, v6 dst_sel:DWORD dst_unused:UNUSED_PAD src0_sel:WORD_0 src1_sel:DWORD
    v_mfma_f32_16x16x32_bf16 v[148:151], v[132:135], v[232:235], 0
    v_xor_b32_sdwa v154, v238, v6 dst_sel:DWORD dst_unused:UNUSED_PAD src0_sel:WORD_1 src1_sel:DWORD
    v_xor_b32_sdwa v153, v238, v7 dst_sel:DWORD dst_unused:UNUSED_PAD src0_sel:WORD_0 src1_sel:DWORD
    v_xor_b32_sdwa v155, v238, v7 dst_sel:DWORD dst_unused:UNUSED_PAD src0_sel:WORD_1 src1_sel:DWORD
    s_setprio 1
    s_bitcmp1_b32 0x54, s35
    s_cbranch_scc1 L_dra
L_drb:
    s_waitcnt lgkmcnt(8)
    v_mfma_f32_16x16x32_bf16 v[24:27], v[72:75], v[96:99], v[24:27]
    ds_read_b64_tr_b16 v[120:121], v244 offset:0
    v_perm_b32 v228, v237, v237, v8
    v_mfma_f32_16x16x32_bf16 v[48:51], v[72:75], v[100:103], v[48:51]
    ds_read_b64_tr_b16 v[122:123], v246 offset:0
    v_perm_b32 v229, v237, v237, v9
    v_mfma_f32_16x16x32_bf16 v[52:55], v[76:79], v[100:103], v[52:55]
    ds_read_b64_tr_b16 v[124:125], v245 offset:0
    v_perm_b32 v230, v237, v237, v10
    v_mfma_f32_16x16x32_bf16 v[28:31], v[76:79], v[96:99], v[28:31]
    ds_read_b64_tr_b16 v[126:127], v247 offset:0
    v_perm_b32 v231, v237, v237, v11
    ds_read_b64_tr_b16 v[128:129], v152 offset:0
    s_waitcnt lgkmcnt(9)
    v_mfma_f32_16x16x32_bf16 v[32:35], v[80:83], v[96:99], v[32:35]
    ds_read_b64_tr_b16 v[130:131], v154 offset:0
    v_perm_b32 v232, v239, v239, v8
    v_mfma_f32_16x16x32_bf16 v[56:59], v[80:83], v[100:103], v[56:59]
    ds_read_b64_tr_b16 v[132:133], v153 offset:0
    v_perm_b32 v233, v239, v239, v9
    v_mfma_f32_16x16x32_bf16 v[60:63], v[84:87], v[100:103], v[60:63]
    ds_read_b64_tr_b16 v[134:135], v155 offset:0
    v_perm_b32 v234, v239, v239, v10
    v_mfma_f32_16x16x32_bf16 v[36:39], v[84:87], v[96:99], v[36:39]
    ds_read_b64_tr_b16 v[72:73], v5 offset:6208
    v_perm_b32 v235, v239, v239, v11
    ds_read_b64_tr_b16 v[74:75], v5 offset:7744
    s_waitcnt lgkmcnt(10)
    v_mfma_f32_16x16x32_bf16 v[40:43], v[88:91], v[96:99], v[40:43]
    ds_read_b64_tr_b16 v[76:77], v5 offset:6240
    v_cvt_pk_bf16_f32 v112, v136, v137
    v_mfma_f32_16x16x32_bf16 v[64:67], v[88:91], v[100:103], v[64:67]
    ds_read_b64_tr_b16 v[78:79], v5 offset:7776
    v_cvt_pk_bf16_f32 v113, v138, v139
    v_mfma_f32_16x16x32_bf16 v[68:71], v[92:95], v[100:103], v[68:71]
    v_cvt_pk_bf16_f32 v114, v140, v141
    v_cvt_pk_bf16_f32 v115, v142, v143
    v_cvt_pk_bf16_f32 v116, v144, v145
    v_cvt_pk_bf16_f32 v117, v146, v147
    v_cvt_pk_bf16_f32 v118, v148, v149
    v_cvt_pk_bf16_f32 v119, v150, v151
    v_mfma_f32_16x16x32_bf16 v[44:47], v[92:95], v[96:99], v[44:47]
    s_waitcnt lgkmcnt(4)
    v_mfma_f32_16x16x32_bf16 v[136:139], v[120:123], v[228:231], 0
    ds_read_b64_tr_b16 v[80:81], v5 offset:6272
    ds_read_b64_tr_b16 v[82:83], v5 offset:7808
    v_mfma_f32_16x16x32_bf16 v[140:143], v[124:127], v[228:231], 0
    ds_read_b64_tr_b16 v[84:85], v5 offset:6304
    ds_read_b64_tr_b16 v[86:87], v5 offset:7840
    v_mfma_f32_16x16x32_bf16 v[144:147], v[128:131], v[232:235], 0
    ds_read_b64_tr_b16 v[88:89], v5 offset:6336
    ds_read_b64_tr_b16 v[90:91], v5 offset:7872
    v_mfma_f32_16x16x32_bf16 v[148:151], v[132:135], v[232:235], 0
    ds_read_b64_tr_b16 v[92:93], v5 offset:6368
    ds_read_b64_tr_b16 v[94:95], v5 offset:7904
    s_setprio 0
    s_waitcnt lgkmcnt(8)
    v_mfma_f32_16x16x32_bf16 v[24:27], v[72:75], v[104:107], v[24:27]
    ds_read_b64_tr_b16 v[120:121], v244 offset:64
    ds_read_b64_tr_b16 v[122:123], v246 offset:64
    v_mfma_f32_16x16x32_bf16 v[48:51], v[72:75], v[108:111], v[48:51]
    ds_read_b64_tr_b16 v[124:125], v245 offset:64
    ds_read_b64_tr_b16 v[126:127], v247 offset:64
    v_mfma_f32_16x16x32_bf16 v[52:55], v[76:79], v[108:111], v[52:55]
    ds_read_b64_tr_b16 v[128:129], v152 offset:64
    v_cvt_pk_bf16_f32 v96, v136, v137
    v_mfma_f32_16x16x32_bf16 v[28:31], v[76:79], v[104:107], v[28:31]
    ds_read_b64_tr_b16 v[130:131], v154 offset:64
    v_cvt_pk_bf16_f32 v97, v138, v139
    s_waitcnt lgkmcnt(10)
    v_mfma_f32_16x16x32_bf16 v[32:35], v[80:83], v[104:107], v[32:35]
    ds_read_b64_tr_b16 v[132:133], v153 offset:64
    v_cvt_pk_bf16_f32 v98, v140, v141
    v_mfma_f32_16x16x32_bf16 v[56:59], v[80:83], v[108:111], v[56:59]
    ds_read_b64_tr_b16 v[134:135], v155 offset:64
    v_cvt_pk_bf16_f32 v99, v142, v143
    ds_read_b64_tr_b16 v[72:73], v5 offset:12416
    v_mfma_f32_16x16x32_bf16 v[60:63], v[84:87], v[108:111], v[60:63]
    ds_read_b64_tr_b16 v[74:75], v5 offset:13952
    v_cvt_pk_bf16_f32 v100, v144, v145
    v_mfma_f32_16x16x32_bf16 v[36:39], v[84:87], v[104:107], v[36:39]
    ds_read_b64_tr_b16 v[76:77], v5 offset:12448
    v_cvt_pk_bf16_f32 v101, v146, v147
    s_waitcnt lgkmcnt(11)
    v_mfma_f32_16x16x32_bf16 v[40:43], v[88:91], v[104:107], v[40:43]
    ds_read_b64_tr_b16 v[78:79], v5 offset:13984
    v_cvt_pk_bf16_f32 v102, v148, v149
    v_mfma_f32_16x16x32_bf16 v[64:67], v[88:91], v[108:111], v[64:67]
    ds_read_b64_tr_b16 v[80:81], v5 offset:12480
    v_cvt_pk_bf16_f32 v103, v150, v151
    ds_read_b64_tr_b16 v[82:83], v5 offset:14016
    v_mfma_f32_16x16x32_bf16 v[68:71], v[92:95], v[108:111], v[68:71]
    ds_read_b64_tr_b16 v[84:85], v5 offset:12512
    s_sub_u32 s96, 6, s35
    v_mfma_f32_16x16x32_bf16 v[44:47], v[92:95], v[104:107], v[44:47]
    ds_read_b64_tr_b16 v[86:87], v5 offset:14048
    s_max_i32 s96, s96, 0
    s_waitcnt lgkmcnt(8)
    v_mfma_f32_16x16x32_bf16 v[136:139], v[120:123], v[228:231], 0
    ds_read_b64_tr_b16 v[88:89], v5 offset:12544
    s_min_u32 s96, s96, 2
    v_mfma_f32_16x16x32_bf16 v[140:143], v[124:127], v[228:231], 0
    ds_read_b64_tr_b16 v[90:91], v5 offset:14080
    s_lshl_b32 s96, s96, 7
    ds_read_b64_tr_b16 v[92:93], v5 offset:12576
    v_mfma_f32_16x16x32_bf16 v[144:147], v[128:131], v[232:235], 0
    ds_read_b64_tr_b16 v[94:95], v5 offset:14112
    v_add_u32 v13, s96, v13
    v_mfma_f32_16x16x32_bf16 v[148:151], v[132:135], v[232:235], 0
    v_add_u32 v252, s96, v252
    ds_read_b64 v[236:237], v13
    ds_read_b64 v[238:239], v252
    s_add_u32 s35, s35, 2
    s_and_b32 s36, s35, 3
    s_mul_i32 s36, s36, 18624
    v_add_u32 v5, s36, v4
    s_cmp_ge_u32 s35, 8
    s_waitcnt vmcnt(0) lgkmcnt(0)
    s_barrier
    s_cbranch_scc1 L_dbodyL
    s_bitcmp1_b32 0x28, s35
    s_cbranch_scc0 L_dbody
    s_add_u32 s95, s35, 2
    s_and_b32 s98, s95, 3
    s_mul_i32 s95, s95, 18432
    s_mul_i32 s98, s98, 18624
    s_call_b64 s[76:77], L_dma2
    s_branch L_dbody
L_dra:
    s_add_u32 s95, s35, 2
    s_and_b32 s98, s95, 3
    s_mul_i32 s95, s95, 18432
    s_mul_i32 s98, s98, 18624
    s_call_b64 s[76:77], L_dma2
    s_branch L_drb
L_dbodyL:
    v_mov_b32 v5, v4
    v_mfma_f32_16x16x32_bf16 v[48:51], v[72:75], v[116:119], v[48:51]
    ds_read_b64_tr_b16 v[120:121], v244 offset:128
    ds_read_b64_tr_b16 v[122:123], v246 offset:128
    v_mfma_f32_16x16x32_bf16 v[52:55], v[76:79], v[116:119], v[52:55]
    ds_read_b64_tr_b16 v[124:125], v245 offset:128
    ds_read_b64_tr_b16 v[126:127], v247 offset:128
    v_mfma_f32_16x16x32_bf16 v[56:59], v[80:83], v[116:119], v[56:59]
    s_mul_i32 s96, s28, 6144
    s_add_u32 s96, s96, 107904
    s_xor_b32 s97, s28, 4
    s_mul_i32 s97, s97, 6144
    v_mfma_f32_16x16x32_bf16 v[60:63], v[84:87], v[116:119], v[60:63]
    s_add_u32 s97, s97, 107904
    v_add_u32 v152, s96, v14
    v_add_u32 v153, s97, v14
    v_cvt_pk_bf16_f32 v104, v136, v137
    v_mfma_f32_16x16x32_bf16 v[64:67], v[88:91], v[116:119], v[64:67]
    v_cvt_pk_bf16_f32 v105, v138, v139
    v_cvt_pk_bf16_f32 v106, v140, v141
    v_cvt_pk_bf16_f32 v107, v142, v143
    v_mfma_f32_16x16x32_bf16 v[68:71], v[92:95], v[116:119], v[68:71]
    v_mfma_f32_16x16x32_bf16 v[24:27], v[72:75], v[112:115], v[24:27]
    ds_read_b64_tr_b16 v[72:73], v5 offset:0
    ds_read_b64_tr_b16 v[74:75], v5 offset:1536
    ds_write_b128 v152, v[48:51] offset:0
    v_mfma_f32_16x16x32_bf16 v[28:31], v[76:79], v[112:115], v[28:31]
    ds_read_b64_tr_b16 v[76:77], v5 offset:32
    ds_read_b64_tr_b16 v[78:79], v5 offset:1568
    ds_write_b128 v152, v[52:55] offset:1024
    v_mfma_f32_16x16x32_bf16 v[32:35], v[80:83], v[112:115], v[32:35]
    ds_read_b64_tr_b16 v[80:81], v5 offset:64
    ds_read_b64_tr_b16 v[82:83], v5 offset:1600
    ds_write_b128 v152, v[56:59] offset:2048
    v_mfma_f32_16x16x32_bf16 v[36:39], v[84:87], v[112:115], v[36:39]
    ds_read_b64_tr_b16 v[84:85], v5 offset:96
    ds_read_b64_tr_b16 v[86:87], v5 offset:1632
    ds_write_b128 v152, v[60:63] offset:3072
    v_mfma_f32_16x16x32_bf16 v[40:43], v[88:91], v[112:115], v[40:43]
    ds_read_b64_tr_b16 v[88:89], v5 offset:128
    ds_read_b64_tr_b16 v[90:91], v5 offset:1664
    ds_write_b128 v152, v[64:67] offset:4096
    v_mfma_f32_16x16x32_bf16 v[44:47], v[92:95], v[112:115], v[44:47]
    ds_read_b64_tr_b16 v[92:93], v5 offset:160
    ds_read_b64_tr_b16 v[94:95], v5 offset:1696
    ds_write_b128 v152, v[68:71] offset:5120
    v_mov_b32 v17, 1
    ds_write_b32 v254, v17
    s_waitcnt lgkmcnt(15)
    v_mfma_f32_16x16x32_bf16 v[136:139], v[120:123], v[228:231], 0
    v_mfma_f32_16x16x32_bf16 v[140:143], v[124:127], v[228:231], 0
    s_waitcnt lgkmcnt(14)
    v_mfma_f32_16x16x32_bf16 v[24:27], v[72:75], v[96:99], v[24:27]
    ds_read_b64_tr_b16 v[72:73], v5 offset:6208
    ds_read_b64_tr_b16 v[74:75], v5 offset:7744
    v_readfirstlane_b32 s98, v248
    v_readfirstlane_b32 s96, v21
    v_mfma_f32_16x16x32_bf16 v[28:31], v[76:79], v[96:99], v[28:31]
    ds_read_b64_tr_b16 v[76:77], v5 offset:6240
    ds_read_b64_tr_b16 v[78:79], v5 offset:7776
    v_cvt_pk_bf16_f32 v112, v136, v137
    v_cvt_pk_bf16_f32 v113, v138, v139
    s_waitcnt lgkmcnt(12)
    v_mfma_f32_16x16x32_bf16 v[32:35], v[80:83], v[96:99], v[32:35]
    ds_read_b64_tr_b16 v[80:81], v5 offset:6272
    ds_read_b64_tr_b16 v[82:83], v5 offset:7808
    v_cvt_pk_bf16_f32 v114, v140, v141
    v_cvt_pk_bf16_f32 v115, v142, v143
    v_mfma_f32_16x16x32_bf16 v[36:39], v[84:87], v[96:99], v[36:39]
    ds_read_b64_tr_b16 v[84:85], v5 offset:6304
    ds_read_b64_tr_b16 v[86:87], v5 offset:7840
    s_sub_u32 s98, s97, s98
    s_sub_u32 s96, s97, s96
    s_waitcnt lgkmcnt(10)
    v_mfma_f32_16x16x32_bf16 v[40:43], v[88:91], v[96:99], v[40:43]
    ds_read_b64_tr_b16 v[88:89], v5 offset:6336
    ds_read_b64_tr_b16 v[90:91], v5 offset:7872
    v_add_u32 v248, s98, v248
    v_add_u32 v249, s98, v249
    v_mfma_f32_16x16x32_bf16 v[44:47], v[92:95], v[96:99], v[44:47]
    ds_read_b64_tr_b16 v[92:93], v5 offset:6368
    ds_read_b64_tr_b16 v[94:95], v5 offset:7904
    v_add_u32 v250, s98, v250
    v_add_u32 v21, s96, v21
    s_waitcnt lgkmcnt(8)
    v_mfma_f32_16x16x32_bf16 v[24:27], v[72:75], v[104:107], v[24:27]
    ds_read_b64_tr_b16 v[72:73], v5 offset:12416
    ds_read_b64_tr_b16 v[74:75], v5 offset:13952
    s_mov_b32 s29, s26
    s_add_u32 s96, s0, s29
    v_mfma_f32_16x16x32_bf16 v[28:31], v[76:79], v[104:107], v[28:31]
    ds_read_b64_tr_b16 v[76:77], v5 offset:12448
    ds_read_b64_tr_b16 v[78:79], v5 offset:13984
    s_mul_i32 s96, s96, 224
    s_add_u32 s96, s96, s32
    s_waitcnt lgkmcnt(8)
    v_mfma_f32_16x16x32_bf16 v[32:35], v[80:83], v[104:107], v[32:35]
    ds_read_b64_tr_b16 v[80:81], v5 offset:12480
    ds_read_b64_tr_b16 v[82:83], v5 offset:14016
    s_mul_i32 s96, s96, 192
    s_mov_b32 s98, 9
    v_mfma_f32_16x16x32_bf16 v[36:39], v[84:87], v[104:107], v[36:39]
    ds_read_b64_tr_b16 v[84:85], v5 offset:12512
    ds_read_b64_tr_b16 v[86:87], v5 offset:14048
    s_waitcnt lgkmcnt(8)
    v_mfma_f32_16x16x32_bf16 v[40:43], v[88:91], v[104:107], v[40:43]
    ds_read_b64_tr_b16 v[88:89], v5 offset:12544
    ds_read_b64_tr_b16 v[90:91], v5 offset:14080
    v_mfma_f32_16x16x32_bf16 v[44:47], v[92:95], v[104:107], v[44:47]
    ds_read_b64_tr_b16 v[92:93], v5 offset:12576
    ds_read_b64_tr_b16 v[94:95], v5 offset:14112
L_dr1:
    ds_read_b32 v236, v255
    ds_read_b128 v[156:159], v153 offset:0
    ds_read_b128 v[160:163], v153 offset:1024
    ds_read_b128 v[164:167], v153 offset:2048
    ds_read_b128 v[168:171], v153 offset:3072
    ds_read_b128 v[172:175], v153 offset:4096
    ds_read_b128 v[176:179], v153 offset:5120
    s_waitcnt lgkmcnt(6)
    v_cmp_eq_u32 vcc, 0, v236
    s_cbranch_vccnz L_dr1
    v_mfma_f32_16x16x32_bf16 v[24:27], v[72:75], v[112:115], v[24:27]
    v_mfma_f32_16x16x32_bf16 v[28:31], v[76:79], v[112:115], v[28:31]
    v_mfma_f32_16x16x32_bf16 v[32:35], v[80:83], v[112:115], v[32:35]
    v_mfma_f32_16x16x32_bf16 v[36:39], v[84:87], v[112:115], v[36:39]
    v_mfma_f32_16x16x32_bf16 v[40:43], v[88:91], v[112:115], v[40:43]
    v_mfma_f32_16x16x32_bf16 v[44:47], v[92:95], v[112:115], v[44:47]
    s_waitcnt lgkmcnt(0)
    s_nop 1
    v_add_f32 v156, v156, v24
    v_add_f32 v157, v157, v25
    v_add_f32 v158, v158, v26
    v_add_f32 v159, v159, v27
    v_cvt_pk_bf16_f32 v156, v156, v157
    v_cvt_pk_bf16_f32 v157, v158, v159
    ds_write_b64 v21, v[156:157] offset:0
    v_add_f32 v160, v160, v28
    v_add_f32 v161, v161, v29
    v_add_f32 v162, v162, v30
    v_add_f32 v163, v163, v31
    v_cvt_pk_bf16_f32 v160, v160, v161
    v_cvt_pk_bf16_f32 v161, v162, v163
    ds_write_b64 v21, v[160:161] offset:32
    v_add_f32 v164, v164, v32
    v_add_f32 v165, v165, v33
    v_add_f32 v166, v166, v34
    v_add_f32 v167, v167, v35
    v_cvt_pk_bf16_f32 v164, v164, v165
    v_cvt_pk_bf16_f32 v165, v166, v167
    ds_write_b64 v21, v[164:165] offset:64
    v_add_f32 v168, v168, v36
    v_add_f32 v169, v169, v37
    v_add_f32 v170, v170, v38
    v_add_f32 v171, v171, v39
    v_cvt_pk_bf16_f32 v168, v168, v169
    v_cvt_pk_bf16_f32 v169, v170, v171
    ds_write_b64 v21, v[168:169] offset:96
    v_add_f32 v172, v172, v40
    v_add_f32 v173, v173, v41
    v_add_f32 v174, v174, v42
    v_add_f32 v175, v175, v43
    v_cvt_pk_bf16_f32 v172, v172, v173
    v_cvt_pk_bf16_f32 v173, v174, v175
    ds_write_b64 v21, v[172:173] offset:128
    v_add_f32 v176, v176, v44
    v_add_f32 v177, v177, v45
    v_add_f32 v178, v178, v46
    v_add_f32 v179, v179, v47
    v_cvt_pk_bf16_f32 v176, v176, v177
    v_cvt_pk_bf16_f32 v177, v178, v179
    ds_write_b64 v21, v[176:177] offset:160
    s_branch L_epi
L_dw23:
    s_add_u32 m0, s88, 37248
    s_mov_b32 s96, 36864
    buffer_load_dwordx4 v19, s[12:15], s96 offen lds
    s_add_u32 m0, s89, 41376
    s_mov_b32 s96, 40960
    buffer_load_dwordx4 v19, s[12:15], s96 offen lds
    s_add_u32 m0, s90, 45504
    s_mov_b32 s96, 45056
    buffer_load_dwordx4 v19, s[12:15], s96 offen lds
    s_add_u32 m0, s88, 49664
    s_mov_b32 s96, 49152
    buffer_load_dwordx4 v19, s[12:15], s96 offen lds
    s_add_u32 m0, s89, 53792
    s_mov_b32 s96, 53248
    buffer_load_dwordx4 v19, s[12:15], s96 offen lds
    s_add_u32 m0, s90, 57920
    s_mov_b32 s96, 57344
    buffer_load_dwordx4 v19, s[12:15], s96 offen lds
    s_add_u32 m0, s88, 62080
    s_mov_b32 s96, 61440
    buffer_load_dwordx4 v19, s[12:15], s96 offen lds
    s_add_u32 m0, s89, 66208
    s_mov_b32 s96, 65536
    buffer_load_dwordx4 v19, s[12:15], s96 offen lds
    s_add_u32 m0, s90, 70336
    s_mov_b32 s96, 69632
    buffer_load_dwordx4 v19, s[12:15], s96 offen lds
    s_setpc_b64 s[76:77]
L_dnone0:
    s_waitcnt vmcnt(0)
    s_barrier
    s_cmp_lt_u32 s28, 4
    s_cbranch_scc1 L_dnone
    s_call_b64 s[76:77], L_dw23
L_dnone:
    s_bitcmp1_b32 0x54, s35
    s_cbranch_scc0 L_dn1
    s_add_u32 s95, s35, 2
    s_and_b32 s98, s95, 3
    s_mul_i32 s95, s95, 18432
    s_mul_i32 s98, s98, 18624
    s_call_b64 s[76:77], L_dma2
L_dn1:
    s_add_u32 s35, s35, 2
    s_cmp_ge_u32 s35, 8
    s_waitcnt vmcnt(0) lgkmcnt(0)
    s_barrier
    s_cbranch_scc1 L_dnoneL
    s_bitcmp1_b32 0x28, s35
    s_cbranch_scc0 L_dnone
    s_add_u32 s95, s35, 2
    s_and_b32 s98, s95, 3
    s_mul_i32 s95, s95, 18432
    s_mul_i32 s98, s98, 18624
    s_call_b64 s[76:77], L_dma2
    s_branch L_dnone
L_dnoneL:
    s_branch L_fin
L_dpatch:
    v_readfirstlane_b32 s41, v156
    s_waitcnt lgkmcnt(0)
    v_readfirstlane_b32 s42, v164
    s_mov_b32 s52, 0
    s_mov_b32 s53, s27
    s_mov_b32 s54, 32
    s_call_b64 s[76:77], L_gp
    s_xor_b32 s97, s26, 2
    s_add_u32 s96, s97, s31
    s_mul_i32 s67, s96, 1792
    s_add_u32 s67, s67, 74752
    s_mul_i32 s96, s96, s69
    s_mul_i32 s96, s96, 192
    s_add_u32 s68, s96, s25
    s_mov_b32 s52, 16
    s_and_b32 s53, s42, 0xffff
    s_call_b64 s[76:77], L_gp
    v_add_u32 v252, s40, v13
    ds_read_b64 v[236:237], v13
    ds_read_b64 v[238:239], v252
    s_waitcnt vmcnt(0) lgkmcnt(0)
    s_barrier
    s_cmp_lt_u32 s41, 0x10000
    s_cbranch_scc1 L_dgo
    s_branch L_dfall
.p2align 3
L_top2:
    s_barrier
L_body2:
    s_setprio 2
.p2align 3
    v_mfma_f32_16x16x32_bf16 v[24:27], v[84:87], v[124:127], v[24:27]
    ds_read_b128 v[108:111], v1 offset:0
    v_mfma_f32_16x16x32_bf16 v[28:31], v[88:91], v[124:127], v[28:31]
    ds_read_b64_tr_b16 v[72:73], v5 offset:0
    v_mfma_f32_16x16x32_bf16 v[32:35], v[92:95], v[124:127], v[32:35]
    ds_read_b64_tr_b16 v[74:75], v5 offset:768
    v_mfma_f32_16x16x32_bf16 v[44:47], v[92:95], v[128:131], v[44:47]
    ds_read_b64_tr_b16 v[76:77], v5 offset:32
    v_mfma_f32_16x16x32_bf16 v[40:43], v[88:91], v[128:131], v[40:43]
    ds_read_b64_tr_b16 v[78:79], v5 offset:800
    v_mfma_f32_16x16x32_bf16 v[36:39], v[84:87], v[128:131], v[36:39]
    ds_read_b64_tr_b16 v[80:81], v5 offset:64
    ds_read_b64_tr_b16 v[82:83], v5 offset:832
    ds_read_b128 v[112:115], v1 offset:3904
    s_setprio 1
.p2align 3
    v_mfma_f32_16x16x32_bf16 v[24:27], v[96:99], v[140:143], v[24:27]
    ds_read_b64_tr_b16 v[84:85], v5 offset:6208
    ds_read_b64_tr_b16 v[86:87], v5 offset:6976
    v_mfma_f32_16x16x32_bf16 v[28:31], v[100:103], v[140:143], v[28:31]
    ds_read_b64_tr_b16 v[88:89], v5 offset:6240
    ds_read_b64_tr_b16 v[90:91], v5 offset:7008
    v_mfma_f32_16x16x32_bf16 v[32:35], v[104:107], v[140:143], v[32:35]
    ds_read_b64_tr_b16 v[92:93], v5 offset:6272
    ds_read_b64_tr_b16 v[94:95], v5 offset:7040
    v_mfma_f32_16x16x32_bf16 v[44:47], v[104:107], v[144:147], v[44:47]
    ds_read_b128 v[140:143], v1 offset:128
    ds_read_b128 v[124:127], v1 offset:64
    v_mfma_f32_16x16x32_bf16 v[40:43], v[100:103], v[144:147], v[40:43]
    ds_read_b128 v[128:131], v1 offset:3968
    v_mfma_f32_16x16x32_bf16 v[36:39], v[96:99], v[144:147], v[36:39]
    ds_read_b128 v[144:147], v1 offset:4032
L_mid2:
    s_waitcnt lgkmcnt(10)
    s_setprio 0
.p2align 3
    v_mfma_f32_16x16x32_bf16 v[24:27], v[72:75], v[108:111], v[24:27]
    ds_read_b64_tr_b16 v[96:97], v5 offset:12416
    v_mfma_f32_16x16x32_bf16 v[28:31], v[76:79], v[108:111], v[28:31]
    ds_read_b64_tr_b16 v[98:99], v5 offset:13184
    v_mfma_f32_16x16x32_bf16 v[32:35], v[80:83], v[108:111], v[32:35]
    ds_read_b64_tr_b16 v[100:101], v5 offset:12448
    v_mfma_f32_16x16x32_bf16 v[44:47], v[80:83], v[112:115], v[44:47]
    ds_read_b64_tr_b16 v[102:103], v5 offset:13216
    v_mfma_f32_16x16x32_bf16 v[40:43], v[76:79], v[112:115], v[40:43]
    ds_read_b64_tr_b16 v[104:105], v5 offset:12480
    v_mfma_f32_16x16x32_bf16 v[36:39], v[72:75], v[112:115], v[36:39]
    ds_read_b64_tr_b16 v[106:107], v5 offset:13248
    s_add_u32 s35, s35, 1
    v_add_u32 v17, 3904, v1
    s_and_b32 s36, s35, 3
    v_mov_b32 v1, v2
    s_mul_i32 s36, s36, 18624
    v_mov_b32 v2, v3
    v_mov_b32 v3, v17
    v_add_u32 v5, s36, v4
L_end2:
    s_bitcmp1_b32 s3, s35
    s_waitcnt vmcnt(0) lgkmcnt(0)
    s_cbranch_scc0 L_top2
    s_bitcmp1_b32 s99, s35
    s_cbranch_scc1 L_sp2
    s_barrier
    s_bitcmp1_b32 s39, s35
    s_cbranch_scc0 L_sp2
    s_call_b64 s[76:77], L_dma
L_sp2:
    s_bitcmp1_b32 s37, s35
    s_cbranch_scc1 L_g2
    s_cmp_lg_u32 s35, 9
    s_cbranch_scc1 L_body2
L_last2:
    s_setprio 3
    v_mfma_f32_16x16x32_bf16 v[24:27], v[84:87], v[124:127], v[24:27]
    s_add_u32 s96, s0, s29
    s_mul_i32 s96, s96, 224
    s_add_u32 s96, s96, s32
    v_mfma_f32_16x16x32_bf16 v[28:31], v[88:91], v[124:127], v[28:31]
    s_mul_i32 s96, s96, 192
    s_add_u32 s97, s96, 86016
    s_add_u32 s98, s29, 2
    v_mfma_f32_16x16x32_bf16 v[32:35], v[92:95], v[124:127], v[32:35]
    v_mfma_f32_16x16x32_bf16 v[24:27], v[96:99], v[140:143], v[24:27]
    v_mfma_f32_16x16x32_bf16 v[28:31], v[100:103], v[140:143], v[28:31]
    v_mfma_f32_16x16x32_bf16 v[32:35], v[104:107], v[140:143], v[32:35]
    v_mfma_f32_16x16x32_bf16 v[36:39], v[84:87], v[128:131], v[36:39]
    v_mfma_f32_16x16x32_bf16 v[40:43], v[88:91], v[128:131], v[40:43]
    v_mfma_f32_16x16x32_bf16 v[44:47], v[92:95], v[128:131], v[44:47]
    s_nop 2
    v_cvt_pk_bf16_f32 v156, v24, v25
    v_cvt_pk_bf16_f32 v157, v26, v27
    ds_write_b64 v21, v[156:157] offset:0
    v_mfma_f32_16x16x32_bf16 v[36:39], v[96:99], v[144:147], v[36:39]
    v_cvt_pk_bf16_f32 v158, v28, v29
    v_cvt_pk_bf16_f32 v159, v30, v31
    ds_write_b64 v21, v[158:159] offset:32
    v_mfma_f32_16x16x32_bf16 v[40:43], v[100:103], v[144:147], v[40:43]
    v_cvt_pk_bf16_f32 v160, v32, v33
    v_cvt_pk_bf16_f32 v161, v34, v35
    ds_write_b64 v21, v[160:161] offset:64
    v_mfma_f32_16x16x32_bf16 v[44:47], v[104:107], v[144:147], v[44:47]
    v_cvt_pk_bf16_f32 v162, v36, v37
    v_cvt_pk_bf16_f32 v163, v38, v39
    ds_write_b64 v21, v[162:163] offset:3904
    s_nop 0
    v_cvt_pk_bf16_f32 v164, v40, v41
    v_cvt_pk_bf16_f32 v165, v42, v43
    ds_write_b64 v21, v[164:165] offset:3936
    s_nop 0
    v_cvt_pk_bf16_f32 v166, v44, v45
    v_cvt_pk_bf16_f32 v167, v46, v47
    ds_write_b64 v21, v[166:167] offset:3968
    s_branch L_epi
.p2align 3
L_top1:
    s_barrier
L_body1:
    s_setprio 2
.p2align 3
    v_mfma_f32_16x16x32_bf16 v[24:27], v[84:87], v[124:127], v[24:27]
    ds_read_b128 v[108:111], v1 offset:0
    v_mfma_f32_16x16x32_bf16 v[28:31], v[88:91], v[124:127], v[28:31]
    ds_read_b64_tr_b16 v[72:73], v5 offset:0
    v_mfma_f32_16x16x32_bf16 v[32:35], v[92:95], v[124:127], v[32:35]
    ds_read_b64_tr_b16 v[74:75], v5 offset:768
    ds_read_b64_tr_b16 v[76:77], v5 offset:32
    ds_read_b64_tr_b16 v[78:79], v5 offset:800
    ds_read_b64_tr_b16 v[80:81], v5 offset:64
    ds_read_b64_tr_b16 v[82:83], v5 offset:832
    s_setprio 1
.p2align 3
    v_mfma_f32_16x16x32_bf16 v[24:27], v[96:99], v[140:143], v[24:27]
    ds_read_b64_tr_b16 v[84:85], v5 offset:6208
    ds_read_b64_tr_b16 v[86:87], v5 offset:6976
    ds_read_b64_tr_b16 v[88:89], v5 offset:6240
    v_mfma_f32_16x16x32_bf16 v[28:31], v[100:103], v[140:143], v[28:31]
    ds_read_b64_tr_b16 v[90:91], v5 offset:7008
    ds_read_b64_tr_b16 v[92:93], v5 offset:6272
    ds_read_b64_tr_b16 v[94:95], v5 offset:7040
    v_mfma_f32_16x16x32_bf16 v[32:35], v[104:107], v[140:143], v[32:35]
    ds_read_b128 v[124:127], v1 offset:64
    ds_read_b128 v[140:143], v1 offset:128
L_mid1:
    s_waitcnt lgkmcnt(8)
    s_setprio 0
.p2align 3
    v_mfma_f32_16x16x32_bf16 v[24:27], v[72:75], v[108:111], v[24:27]
    ds_read_b64_tr_b16 v[96:97], v5 offset:12416
    v_mfma_f32_16x16x32_bf16 v[28:31], v[76:79], v[108:111], v[28:31]
    ds_read_b64_tr_b16 v[98:99], v5 offset:13184
    v_mfma_f32_16x16x32_bf16 v[32:35], v[80:83], v[108:111], v[32:35]
    ds_read_b64_tr_b16 v[100:101], v5 offset:12448
    ds_read_b64_tr_b16 v[102:103], v5 offset:13216
    ds_read_b64_tr_b16 v[104:105], v5 offset:12480
    ds_read_b64_tr_b16 v[106:107], v5 offset:13248
    s_add_u32 s35, s35, 1
    v_add_u32 v17, 3904, v1
    s_and_b32 s36, s35, 3
    v_mov_b32 v1, v2
    s_mul_i32 s36, s36, 18624
    v_mov_b32 v2, v3
    v_mov_b32 v3, v17
    v_add_u32 v5, s36, v4
L_end1:
    s_bitcmp1_b32 s3, s35
    s_waitcnt vmcnt(0) lgkmcnt(0)
    s_cbranch_scc0 L_top1
    s_bitcmp1_b32 s99, s35
    s_cbranch_scc1 L_sp1
    s_barrier
    s_bitcmp1_b32 s39, s35
    s_cbranch_scc0 L_sp1
    s_call_b64 s[76:77], L_dma
L_sp1:
    s_bitcmp1_b32 s37, s35
    s_cbranch_scc1 L_g1
    s_cmp_lg_u32 s35, 9
    s_cbranch_scc1 L_body1
L_last1:
    s_setprio 3
    v_mfma_f32_16x16x32_bf16 v[24:27], v[84:87], v[124:127], v[24:27]
    s_add_u32 s96, s0, s29
    s_mul_i32 s96, s96, 224
    s_add_u32 s96, s96, s32
    v_mfma_f32_16x16x32_bf16 v[28:31], v[88:91], v[124:127], v[28:31]
    s_mul_i32 s96, s96, 192
    s_add_u32 s97, s96, 86016
    s_add_u32 s98, s29, 2
    v_mfma_f32_16x16x32_bf16 v[32:35], v[92:95], v[124:127], v[32:35]
    v_mfma_f32_16x16x32_bf16 v[24:27], v[96:99], v[140:143], v[24:27]
    v_mfma_f32_16x16x32_bf16 v[28:31], v[100:103], v[140:143], v[28:31]
    v_mfma_f32_16x16x32_bf16 v[32:35], v[104:107], v[140:143], v[32:35]
    s_nop 5
    v_cvt_pk_bf16_f32 v156, v24, v25
    v_cvt_pk_bf16_f32 v157, v26, v27
    ds_write_b64 v21, v[156:157] offset:0
    v_cvt_pk_bf16_f32 v158, v28, v29
    v_cvt_pk_bf16_f32 v159, v30, v31
    ds_write_b64 v21, v[158:159] offset:32
    v_cvt_pk_bf16_f32 v160, v32, v33
    v_cvt_pk_bf16_f32 v161, v34, v35
    ds_write_b64 v21, v[160:161] offset:64
    s_branch L_epi
L_cold:
L_dfall:
    s_mov_b32 s35, 0
    v_xor_b32 v255, 4, v254
    s_or_b32 s3, s39, s99
    s_or_b32 s3, s3, 512
    s_cmp_lt_u32 s28, 4
    s_cbranch_scc1 L_df1
    s_mov_b32 s30, 0
    s_call_b64 s[76:77], L_dw23
    s_waitcnt vmcnt(0)
    s_barrier
    s_barrier
    s_branch L_mid0
L_df1:
    s_cmp_eq_u32 s30, 0
    s_cbranch_scc1 L_mid0
    s_movk_i32 s37, 0x1ff
    s_or_b32 s3, s3, s37
    s_bfm_b32 s63, s30, 0
    s_mul_i32 s62, s63, 0x11111111
    s_branch L_gfirst
L_table0:
    s_mov_b64 s[44:45], s[70:71]
    s_mov_b64 s[46:47], s[72:73]
    s_mov_b64 s[48:49], s[74:75]
L_table:
    s_mov_b32 s37, 0
    s_mov_b32 s97, 0
    s_mov_b32 s98, 0
    s_mov_b32 s38, 2
    s_mov_b32 s69, 0
    s_mov_b32 s64, 0x24924924
    s_mov_b32 s65, 0x9249
    s_and_b64 s[70:71], s[62:63], s[64:65]
    s_addc_u32 s98, s98, s98
    s_and_b64 s[70:71], s[56:57], s[64:65]
    s_addc_u32 s98, s98, s98
    s_and_b64 s[70:71], s[50:51], s[64:65]
    s_addc_u32 s98, s98, s98
    s_and_b64 s[70:71], s[44:45], s[64:65]
    s_addc_u32 s98, s98, s98
    s_and_b32 s96, s98, 15
    s_addc_u32 s37, s37, s37
    s_and_b64 s[70:71], s[60:61], s[64:65]
    s_addc_u32 s97, s97, s97
    s_and_b64 s[70:71], s[54:55], s[64:65]
    s_addc_u32 s97, s97, s97
    s_and_b64 s[70:71], s[48:49], s[64:65]
    s_addc_u32 s97, s97, s97
    s_and_b64 s[70:71], s[42:43], s[64:65]
    s_addc_u32 s97, s97, s97
    s_and_b32 s96, s97, 15
    s_addc_u32 s37, s37, s37
    s_and_b64 s[70:71], s[58:59], s[64:65]
    s_addc_u32 s97, s97, s97
    s_and_b64 s[70:71], s[52:53], s[64:65]
    s_addc_u32 s97, s97, s97
    s_and_b64 s[70:71], s[46:47], s[64:65]
    s_addc_u32 s97, s97, s97
    s_and_b64 s[70:71], s[40:41], s[64:65]
    s_addc_u32 s97, s97, s97
    s_and_b32 s96, s97, 15
    s_addc_u32 s37, s37, s37
    s_mov_b32 s64, 0x92492492
    s_mov_b32 s65, 0x4924
    s_and_b64 s[70:71], s[62:63], s[64:65]
    s_addc_u32 s97, s97, s97
    s_and_b64 s[70:71], s[56:57], s[64:65]
    s_addc_u32 s97, s97, s97
    s_and_b64 s[70:71], s[50:51], s[64:65]
    s_addc_u32 s97, s97, s97
    s_and_b64 s[70:71], s[44:45], s[64:65]
    s_addc_u32 s97, s97, s97
    s_and_b32 s96, s97, 15
    s_addc_u32 s37, s37, s37
    s_and_b64 s[70:71], s[60:61], s[64:65]
    s_addc_u32 s97, s97, s97
    s_and_b64 s[70:71], s[54:55], s[64:65]
    s_addc_u32 s97, s97, s97
    s_and_b64 s[70:71], s[48:49], s[64:65]
    s_addc_u32 s97, s97, s97
    s_and_b64 s[70:71], s[42:43], s[64:65]
    s_addc_u32 s97, s97, s97
    s_and_b32 s96, s97, 15
    s_addc_u32 s37, s37, s37
    s_and_b64 s[70:71], s[58:59], s[64:65]
    s_addc_u32 s97, s97, s97
    s_and_b64 s[70:71], s[52:53], s[64:65]
    s_addc_u32 s97, s97, s97
    s_and_b64 s[70:71], s[46:47], s[64:65]
    s_addc_u32 s97, s97, s97
    s_and_b64 s[70:71], s[40:41], s[64:65]
    s_addc_u32 s97, s97, s97
    s_and_b32 s96, s97, 15
    s_addc_u32 s37, s37, s37
    s_mov_b32 s64, 0x49249249
    s_mov_b32 s65, 0x2492
    s_and_b64 s[70:71], s[62:63], s[64:65]
    s_addc_u32 s97, s97, s97
    s_and_b64 s[70:71], s[56:57], s[64:65]
    s_addc_u32 s97, s97, s97
    s_and_b64 s[70:71], s[50:51], s[64:65]
    s_addc_u32 s97, s97, s97
    s_and_b64 s[70:71], s[44:45], s[64:65]
    s_addc_u32 s97, s97, s97
    s_and_b32 s96, s97, 15
    s_addc_u32 s37, s37, s37
    s_and_b64 s[70:71], s[60:61], s[64:65]
    s_addc_u32 s97, s97, s97
    s_and_b64 s[70:71], s[54:55], s[64:65]
    s_addc_u32 s97, s97, s97
    s_and_b64 s[70:71], s[48:49], s[64:65]
    s_addc_u32 s97, s97, s97
    s_and_b64 s[70:71], s[42:43], s[64:65]
    s_addc_u32 s97, s97, s97
    s_and_b32 s96, s97, 15
    s_addc_u32 s37, s37, s37
    s_and_b64 s[70:71], s[58:59], s[64:65]
    s_addc_u32 s97, s97, s97
    s_and_b64 s[70:71], s[52:53], s[64:65]
    s_addc_u32 s97, s97, s97
    s_and_b64 s[70:71], s[46:47], s[64:65]
    s_addc_u32 s97, s97, s97
    s_and_b64 s[70:71], s[40:41], s[64:65]
    s_addc_u32 s97, s97, s97
    s_and_b32 s96, s97, 15
    s_addc_u32 s37, s37, s37
    s_mov_b32 s62, s97
    s_mov_b32 s63, s98
    s_bfm_b32 s40, s30, 0
    s_bfe_u32 s96, s23, 0x50018
    s_sub_u32 s96, s96, 1
    s_bfe_u32 s73, s23, 0x40014
    s_cmp_lt_u32 s28, 4
    s_cselect_b32 s70, 7, 14
    s_cselect_b32 s71, 14, 15
    s_cselect_b32 s72, 15, 15
    s_cselect_b32 s73, 0, s73
    s_min_u32 s70, s70, s96
    s_min_u32 s71, s71, s96
    s_min_u32 s72, s72, s96
    s_sub_u32 s72, s72, s73
    v_mov_b32 v226, s70
    v_mov_b32 v225, s71
    v_cmp_eq_u32 vcc, 1, v230
    v_mov_b32 v17, s72
    s_nop 0
    v_cndmask_b32 v226, v226, v225, vcc
    v_cmp_eq_u32 vcc, 2, v230
    v_mov_b32 v225, s73
    s_nop 0
    v_cndmask_b32 v226, v226, v17, vcc
    v_cndmask_b32 v225, 0, v225, vcc
    s_setpc_b64 s[76:77]
L_gfirst0:
    s_barrier
    s_call_b64 s[76:77], L_tables
L_gfirst:
    s_bitcmp1_b32 s37, 0
    s_cbranch_scc0 L_nfirst
    s_call_b64 s[76:77], L_H0
    ds_read_b128 v[108:111], v1 offset:0
    ds_read_b64_tr_b16 v[72:73], v5 offset:0
    ds_read_b64_tr_b16 v[74:75], v5 offset:768
    ds_read_b64_tr_b16 v[76:77], v5 offset:32
    ds_read_b64_tr_b16 v[78:79], v5 offset:800
    ds_read_b64_tr_b16 v[80:81], v5 offset:64
    ds_read_b64_tr_b16 v[82:83], v5 offset:832
    ds_read_b128 v[112:115], v1 offset:3904
    ds_read_b128 v[116:119], v1 offset:7808
    ds_read_b128 v[120:123], v1 offset:11712
    s_waitcnt lgkmcnt(10)
    s_call_b64 s[76:77], L_H1
    ds_read_b64_tr_b16 v[84:85], v5 offset:6208
    ds_read_b64_tr_b16 v[86:87], v5 offset:6976
    ds_read_b64_tr_b16 v[88:89], v5 offset:6240
    ds_read_b64_tr_b16 v[90:91], v5 offset:7008
    ds_read_b64_tr_b16 v[92:93], v5 offset:6272
    ds_read_b64_tr_b16 v[94:95], v5 offset:7040
    ds_read_b128 v[124:127], v1 offset:64
    ds_read_b128 v[128:131], v1 offset:3968
    ds_read_b128 v[132:135], v1 offset:7872
    ds_read_b128 v[136:139], v1 offset:11776
    ds_read_b128 v[140:143], v1 offset:128
    ds_read_b128 v[144:147], v1 offset:4032
    ds_read_b128 v[148:151], v1 offset:7936
    ds_read_b128 v[152:155], v1 offset:11840
    s_waitcnt lgkmcnt(14)
    s_call_b64 s[76:77], L_H2
    s_branch L_fdisp
L_H0:
    s_lshl_b32 s97, s35, 2
    s_lshr_b64 s[70:71], s[62:63], s97
    s_and_b32 s98, s70, 15
    s_lshl_b32 s97, s35, 7
    s_bcnt1_i32_b32 s48, s98
    s_ff1_i32_b32 s44, s98
    s_mul_i32 s96, s44, 1152
    s_add_u32 s96, s96, s97
    v_add_u32 v13, s96, v12
    s_bitset0_b32 s98, s44
    ds_read_b64 v[236:237], v13
    s_cmp_eq_u32 s98, 0
    s_cbranch_scc1 L_H0r
    s_ff1_i32_b32 s45, s98
    s_mul_i32 s96, s45, 1152
    s_add_u32 s96, s96, s97
    v_add_u32 v13, s96, v12
    s_bitset0_b32 s98, s45
    ds_read_b64 v[238:239], v13
    s_cmp_eq_u32 s98, 0
    s_cbranch_scc1 L_H0r
    s_ff1_i32_b32 s46, s98
    s_mul_i32 s96, s46, 1152
    s_add_u32 s96, s96, s97
    v_add_u32 v13, s96, v12
    s_bitset0_b32 s98, s46
    ds_read_b64 v[240:241], v13
    s_cmp_eq_u32 s98, 0
    s_cbranch_scc1 L_H0r
    s_ff1_i32_b32 s47, s98
    s_mul_i32 s96, s47, 1152
    s_add_u32 s96, s96, s97
    v_add_u32 v13, s96, v12
    s_bitset0_b32 s98, s47
    ds_read_b64 v[242:243], v13
L_H0r:
    s_setpc_b64 s[76:77]
L_H1:
    v_cmp_eq_u32 vcc, 2, v236
    v_and_b32 v236, -4, v236
    s_or_b32 s50, vcc_lo, vcc_hi
    v_xor_b32_sdwa v244, v236, v6 dst_sel:DWORD dst_unused:UNUSED_PAD src0_sel:WORD_0 src1_sel:DWORD
    v_xor_b32_sdwa v246, v236, v6 dst_sel:DWORD dst_unused:UNUSED_PAD src0_sel:WORD_1 src1_sel:DWORD
    v_xor_b32_sdwa v245, v236, v7 dst_sel:DWORD dst_unused:UNUSED_PAD src0_sel:WORD_0 src1_sel:DWORD
    v_xor_b32_sdwa v247, v236, v7 dst_sel:DWORD dst_unused:UNUSED_PAD src0_sel:WORD_1 src1_sel:DWORD
    ds_read_b64_tr_b16 v[156:157], v244 offset:0
    ds_read_b64_tr_b16 v[158:159], v246 offset:0
    ds_read_b64_tr_b16 v[160:161], v245 offset:0
    ds_read_b64_tr_b16 v[162:163], v247 offset:0
    ds_read_b64_tr_b16 v[164:165], v244 offset:64
    ds_read_b64_tr_b16 v[166:167], v246 offset:64
    ds_read_b64_tr_b16 v[168:169], v245 offset:64
    ds_read_b64_tr_b16 v[170:171], v247 offset:64
    ds_read_b64_tr_b16 v[172:173], v244 offset:128
    ds_read_b64_tr_b16 v[174:175], v246 offset:128
    ds_read_b64_tr_b16 v[176:177], v245 offset:128
    ds_read_b64_tr_b16 v[178:179], v247 offset:128
    v_perm_b32 v228, v237, v237, v8
    v_perm_b32 v229, v237, v237, v9
    v_perm_b32 v230, v237, v237, v10
    v_perm_b32 v231, v237, v237, v11
    s_cmp_eq_u32 s48, 1
    s_cbranch_scc1 L_H0r
    v_cmp_eq_u32 vcc, 2, v238
    v_and_b32 v238, -4, v238
    s_or_b32 s51, vcc_lo, vcc_hi
    v_xor_b32_sdwa v244, v238, v6 dst_sel:DWORD dst_unused:UNUSED_PAD src0_sel:WORD_0 src1_sel:DWORD
    v_xor_b32_sdwa v246, v238, v6 dst_sel:DWORD dst_unused:UNUSED_PAD src0_sel:WORD_1 src1_sel:DWORD
    v_xor_b32_sdwa v245, v238, v7 dst_sel:DWORD dst_unused:UNUSED_PAD src0_sel:WORD_0 src1_sel:DWORD
    v_xor_b32_sdwa v247, v238, v7 dst_sel:DWORD dst_unused:UNUSED_PAD src0_sel:WORD_1 src1_sel:DWORD
    ds_read_b64_tr_b16 v[180:181], v244 offset:0
    ds_read_b64_tr_b16 v[182:183], v246 offset:0
    ds_read_b64_tr_b16 v[184:185], v245 offset:0
    ds_read_b64_tr_b16 v[186:187], v247 offset:0
    ds_read_b64_tr_b16 v[188:189], v244 offset:64
    ds_read_b64_tr_b16 v[190:191], v246 offset:64
    ds_read_b64_tr_b16 v[192:193], v245 offset:64
    ds_read_b64_tr_b16 v[194:195], v247 offset:64
    ds_read_b64_tr_b16 v[196:197], v244 offset:128
    ds_read_b64_tr_b16 v[198:199], v246 offset:128
    ds_read_b64_tr_b16 v[200:201], v245 offset:128
    ds_read_b64_tr_b16 v[202:203], v247 offset:128
    v_perm_b32 v232, v239, v239, v8
    v_perm_b32 v233, v239, v239, v9
    v_perm_b32 v234, v239, v239, v10
    v_perm_b32 v235, v239, v239, v11
    s_setpc_b64 s[76:77]
L_H2:
    s_mov_b32 s49, s44
    s_cmp_eq_u32 s50, 0
    s_cbranch_scc1 L_in0
    s_call_b64 s[78:79], L_slow0
    s_branch L_ie0
L_in0:
    v_mfma_f32_16x16x32_bf16 v[204:207], v[156:159], v[228:231], 0
    v_mfma_f32_16x16x32_bf16 v[208:211], v[160:163], v[228:231], 0
    v_mfma_f32_16x16x32_bf16 v[212:215], v[164:167], v[228:231], 0
    v_mfma_f32_16x16x32_bf16 v[216:219], v[168:171], v[228:231], 0
    v_mfma_f32_16x16x32_bf16 v[220:223], v[172:175], v[228:231], 0
    v_mfma_f32_16x16x32_bf16 v[224:227], v[176:179], v[228:231], 0
L_ie0:
    s_cmp_le_u32 s48, 2
    s_cbranch_scc1 L_H2a0
    v_cmp_eq_u32 vcc, 2, v240
    v_and_b32 v240, -4, v240
    s_or_b32 s50, vcc_lo, vcc_hi
    v_xor_b32_sdwa v244, v240, v6 dst_sel:DWORD dst_unused:UNUSED_PAD src0_sel:WORD_0 src1_sel:DWORD
    v_xor_b32_sdwa v246, v240, v6 dst_sel:DWORD dst_unused:UNUSED_PAD src0_sel:WORD_1 src1_sel:DWORD
    v_xor_b32_sdwa v245, v240, v7 dst_sel:DWORD dst_unused:UNUSED_PAD src0_sel:WORD_0 src1_sel:DWORD
    v_xor_b32_sdwa v247, v240, v7 dst_sel:DWORD dst_unused:UNUSED_PAD src0_sel:WORD_1 src1_sel:DWORD
    ds_read_b64_tr_b16 v[156:157], v244 offset:0
    ds_read_b64_tr_b16 v[158:159], v246 offset:0
    ds_read_b64_tr_b16 v[160:161], v245 offset:0
    ds_read_b64_tr_b16 v[162:163], v247 offset:0
    ds_read_b64_tr_b16 v[164:165], v244 offset:64
    ds_read_b64_tr_b16 v[166:167], v246 offset:64
    ds_read_b64_tr_b16 v[168:169], v245 offset:64
    ds_read_b64_tr_b16 v[170:171], v247 offset:64
    ds_read_b64_tr_b16 v[172:173], v244 offset:128
    ds_read_b64_tr_b16 v[174:175], v246 offset:128
    ds_read_b64_tr_b16 v[176:177], v245 offset:128
    ds_read_b64_tr_b16 v[178:179], v247 offset:128
    v_perm_b32 v228, v241, v241, v8
    v_perm_b32 v229, v241, v241, v9
    v_perm_b32 v230, v241, v241, v10
    v_perm_b32 v231, v241, v241, v11
    s_waitcnt lgkmcnt(12)
    s_branch L_H2b0
L_H2a0:
    s_waitcnt lgkmcnt(0)
L_H2b0:
    s_call_b64 s[78:79], L_V
    s_cmp_eq_u32 s48, 1
    s_cbranch_scc1 L_H0r
    s_mov_b32 s49, s45
    s_cmp_eq_u32 s51, 0
    s_cbranch_scc1 L_in1
    s_call_b64 s[78:79], L_slow1
    s_branch L_ie1
L_in1:
    v_mfma_f32_16x16x32_bf16 v[204:207], v[180:183], v[232:235], 0
    v_mfma_f32_16x16x32_bf16 v[208:211], v[184:187], v[232:235], 0
    v_mfma_f32_16x16x32_bf16 v[212:215], v[188:191], v[232:235], 0
    v_mfma_f32_16x16x32_bf16 v[216:219], v[192:195], v[232:235], 0
    v_mfma_f32_16x16x32_bf16 v[220:223], v[196:199], v[232:235], 0
    v_mfma_f32_16x16x32_bf16 v[224:227], v[200:203], v[232:235], 0
L_ie1:
    s_cmp_le_u32 s48, 3
    s_cbranch_scc1 L_H2a1
    v_cmp_eq_u32 vcc, 2, v242
    v_and_b32 v242, -4, v242
    s_or_b32 s51, vcc_lo, vcc_hi
    v_xor_b32_sdwa v244, v242, v6 dst_sel:DWORD dst_unused:UNUSED_PAD src0_sel:WORD_0 src1_sel:DWORD
    v_xor_b32_sdwa v246, v242, v6 dst_sel:DWORD dst_unused:UNUSED_PAD src0_sel:WORD_1 src1_sel:DWORD
    v_xor_b32_sdwa v245, v242, v7 dst_sel:DWORD dst_unused:UNUSED_PAD src0_sel:WORD_0 src1_sel:DWORD
    v_xor_b32_sdwa v247, v242, v7 dst_sel:DWORD dst_unused:UNUSED_PAD src0_sel:WORD_1 src1_sel:DWORD
    ds_read_b64_tr_b16 v[180:181], v244 offset:0
    ds_read_b64_tr_b16 v[182:183], v246 offset:0
    ds_read_b64_tr_b16 v[184:185], v245 offset:0
    ds_read_b64_tr_b16 v[186:187], v247 offset:0
    ds_read_b64_tr_b16 v[188:189], v244 offset:64
    ds_read_b64_tr_b16 v[190:191], v246 offset:64
    ds_read_b64_tr_b16 v[192:193], v245 offset:64
    ds_read_b64_tr_b16 v[194:195], v247 offset:64
    ds_read_b64_tr_b16 v[196:197], v244 offset:128
    ds_read_b64_tr_b16 v[198:199], v246 offset:128
    ds_read_b64_tr_b16 v[200:201], v245 offset:128
    ds_read_b64_tr_b16 v[202:203], v247 offset:128
    v_perm_b32 v232, v243, v243, v8
    v_perm_b32 v233, v243, v243, v9
    v_perm_b32 v234, v243, v243, v10
    v_perm_b32 v235, v243, v243, v11
    s_waitcnt lgkmcnt(12)
    s_branch L_H2b1
L_H2a1:
L_H2b1:
    s_call_b64 s[78:79], L_V
    s_cmp_eq_u32 s48, 2
    s_cbranch_scc1 L_H0r
    s_mov_b32 s49, s46
    s_waitcnt lgkmcnt(0)
    s_cmp_eq_u32 s50, 0
    s_cbranch_scc1 L_in2
    s_call_b64 s[78:79], L_slow0
    s_branch L_ie2
L_in2:
    v_mfma_f32_16x16x32_bf16 v[204:207], v[156:159], v[228:231], 0
    v_mfma_f32_16x16x32_bf16 v[208:211], v[160:163], v[228:231], 0
    v_mfma_f32_16x16x32_bf16 v[212:215], v[164:167], v[228:231], 0
    v_mfma_f32_16x16x32_bf16 v[216:219], v[168:171], v[228:231], 0
    v_mfma_f32_16x16x32_bf16 v[220:223], v[172:175], v[228:231], 0
    v_mfma_f32_16x16x32_bf16 v[224:227], v[176:179], v[228:231], 0
L_ie2:
    s_call_b64 s[78:79], L_V
    s_cmp_eq_u32 s48, 3
    s_cbranch_scc1 L_H0r
    s_mov_b32 s49, s47
    s_waitcnt lgkmcnt(0)
    s_cmp_eq_u32 s51, 0
    s_cbranch_scc1 L_in3
    s_call_b64 s[78:79], L_slow1
    s_branch L_ie3
L_in3:
    v_mfma_f32_16x16x32_bf16 v[204:207], v[180:183], v[232:235], 0
    v_mfma_f32_16x16x32_bf16 v[208:211], v[184:187], v[232:235], 0
    v_mfma_f32_16x16x32_bf16 v[212:215], v[188:191], v[232:235], 0
    v_mfma_f32_16x16x32_bf16 v[216:219], v[192:195], v[232:235], 0
    v_mfma_f32_16x16x32_bf16 v[220:223], v[196:199], v[232:235], 0
    v_mfma_f32_16x16x32_bf16 v[224:227], v[200:203], v[232:235], 0
L_ie3:
    s_call_b64 s[78:79], L_V
    s_setpc_b64 s[76:77]
L_V:
    s_cmp_eq_u32 s49, 1
    s_cbranch_scc1 L_V1
    s_cmp_eq_u32 s49, 2
    s_cbranch_scc1 L_V2
    s_cmp_eq_u32 s49, 3
    s_cbranch_scc1 L_V3
L_V0:
    v_cvt_pk_bf16_f32 v108, v204, v205
    v_cvt_pk_bf16_f32 v109, v206, v207
    v_cvt_pk_bf16_f32 v110, v208, v209
    v_cvt_pk_bf16_f32 v111, v210, v211
    v_cvt_pk_bf16_f32 v124, v212, v213
    v_cvt_pk_bf16_f32 v125, v214, v215
    v_permlane32_swap_b32 v108, v110
    v_permlane32_swap_b32 v109, v111
    v_cvt_pk_bf16_f32 v126, v216, v217
    v_cvt_pk_bf16_f32 v127, v218, v219
    v_cvt_pk_bf16_f32 v140, v220, v221
    v_cvt_pk_bf16_f32 v141, v222, v223
    v_permlane32_swap_b32 v124, v126
    v_permlane32_swap_b32 v125, v127
    v_cvt_pk_bf16_f32 v142, v224, v225
    v_cvt_pk_bf16_f32 v143, v226, v227
    s_nop 0
    v_permlane32_swap_b32 v140, v142
    v_permlane32_swap_b32 v141, v143
    s_setpc_b64 s[78:79]
L_V1:
    v_cvt_pk_bf16_f32 v112, v204, v205
    v_cvt_pk_bf16_f32 v113, v206, v207
    v_cvt_pk_bf16_f32 v114, v208, v209
    v_cvt_pk_bf16_f32 v115, v210, v211
    v_cvt_pk_bf16_f32 v128, v212, v213
    v_cvt_pk_bf16_f32 v129, v214, v215
    v_permlane32_swap_b32 v112, v114
    v_permlane32_swap_b32 v113, v115
    v_cvt_pk_bf16_f32 v130, v216, v217
    v_cvt_pk_bf16_f32 v131, v218, v219
    v_cvt_pk_bf16_f32 v144, v220, v221
    v_cvt_pk_bf16_f32 v145, v222, v223
    v_permlane32_swap_b32 v128, v130
    v_permlane32_swap_b32 v129, v131
    v_cvt_pk_bf16_f32 v146, v224, v225
    v_cvt_pk_bf16_f32 v147, v226, v227
    s_nop 0
    v_permlane32_swap_b32 v144, v146
    v_permlane32_swap_b32 v145, v147
    s_setpc_b64 s[78:79]
L_V2:
    v_cvt_pk_bf16_f32 v116, v204, v205
    v_cvt_pk_bf16_f32 v117, v206, v207
    v_cvt_pk_bf16_f32 v118, v208, v209
    v_cvt_pk_bf16_f32 v119, v210, v211
    v_cvt_pk_bf16_f32 v132, v212, v213
    v_cvt_pk_bf16_f32 v133, v214, v215
    v_permlane32_swap_b32 v116, v118
    v_permlane32_swap_b32 v117, v119
    v_cvt_pk_bf16_f32 v134, v216, v217
    v_cvt_pk_bf16_f32 v135, v218, v219
    v_cvt_pk_bf16_f32 v148, v220, v221
    v_cvt_pk_bf16_f32 v149, v222, v223
    v_permlane32_swap_b32 v132, v134
    v_permlane32_swap_b32 v133, v135
    v_cvt_pk_bf16_f32 v150, v224, v225
    v_cvt_pk_bf16_f32 v151, v226, v227
    s_nop 0
    v_permlane32_swap_b32 v148, v150
    v_permlane32_swap_b32 v149, v151
    s_setpc_b64 s[78:79]
L_V3:
    v_cvt_pk_bf16_f32 v120, v204, v205
    v_cvt_pk_bf16_f32 v121, v206, v207
    v_cvt_pk_bf16_f32 v122, v208, v209
    v_cvt_pk_bf16_f32 v123, v210, v211
    v_cvt_pk_bf16_f32 v136, v212, v213
    v_cvt_pk_bf16_f32 v137, v214, v215
    v_permlane32_swap_b32 v120, v122
    v_permlane32_swap_b32 v121, v123
    v_cvt_pk_bf16_f32 v138, v216, v217
    v_cvt_pk_bf16_f32 v139, v218, v219
    v_cvt_pk_bf16_f32 v152, v220, v221
    v_cvt_pk_bf16_f32 v153, v222, v223
    v_permlane32_swap_b32 v136, v138
    v_permlane32_swap_b32 v137, v139
    v_cvt_pk_bf16_f32 v154, v224, v225
    v_cvt_pk_bf16_f32 v155, v226, v227
    s_nop 0
    v_permlane32_swap_b32 v152, v154
    v_permlane32_swap_b32 v153, v155
    s_setpc_b64 s[78:79]
L_g4:
    s_setprio 2
    s_call_b64 s[76:77], L_H0
.p2align 3
    v_mfma_f32_16x16x32_bf16 v[24:27], v[84:87], v[124:127], v[24:27]
    ds_read_b128 v[108:111], v1 offset:0
    v_mfma_f32_16x16x32_bf16 v[28:31], v[88:91], v[124:127], v[28:31]
    ds_read_b64_tr_b16 v[72:73], v5 offset:0
    v_mfma_f32_16x16x32_bf16 v[32:35], v[92:95], v[124:127], v[32:35]
    ds_read_b64_tr_b16 v[74:75], v5 offset:768
    v_mfma_f32_16x16x32_bf16 v[44:47], v[92:95], v[128:131], v[44:47]
    ds_read_b64_tr_b16 v[76:77], v5 offset:32
    v_mfma_f32_16x16x32_bf16 v[40:43], v[88:91], v[128:131], v[40:43]
    ds_read_b64_tr_b16 v[78:79], v5 offset:800
    v_mfma_f32_16x16x32_bf16 v[36:39], v[84:87], v[128:131], v[36:39]
    ds_read_b64_tr_b16 v[80:81], v5 offset:64
    v_mfma_f32_16x16x32_bf16 v[48:51], v[84:87], v[132:135], v[48:51]
    ds_read_b64_tr_b16 v[82:83], v5 offset:832
    v_mfma_f32_16x16x32_bf16 v[52:55], v[88:91], v[132:135], v[52:55]
    ds_read_b128 v[112:115], v1 offset:3904
    v_mfma_f32_16x16x32_bf16 v[56:59], v[92:95], v[132:135], v[56:59]
    ds_read_b128 v[116:119], v1 offset:7808
    v_mfma_f32_16x16x32_bf16 v[68:71], v[92:95], v[136:139], v[68:71]
    ds_read_b128 v[120:123], v1 offset:11712
    v_mfma_f32_16x16x32_bf16 v[64:67], v[88:91], v[136:139], v[64:67]
    v_mfma_f32_16x16x32_bf16 v[60:63], v[84:87], v[136:139], v[60:63]
    s_waitcnt lgkmcnt(10)
    s_call_b64 s[76:77], L_H1
.p2align 3
    v_mfma_f32_16x16x32_bf16 v[24:27], v[96:99], v[140:143], v[24:27]
    ds_read_b64_tr_b16 v[84:85], v5 offset:6208
    v_mfma_f32_16x16x32_bf16 v[28:31], v[100:103], v[140:143], v[28:31]
    ds_read_b64_tr_b16 v[86:87], v5 offset:6976
    v_mfma_f32_16x16x32_bf16 v[32:35], v[104:107], v[140:143], v[32:35]
    ds_read_b64_tr_b16 v[88:89], v5 offset:6240
    v_mfma_f32_16x16x32_bf16 v[44:47], v[104:107], v[144:147], v[44:47]
    ds_read_b128 v[140:143], v1 offset:128
    v_mfma_f32_16x16x32_bf16 v[40:43], v[100:103], v[144:147], v[40:43]
    ds_read_b64_tr_b16 v[90:91], v5 offset:7008
    v_mfma_f32_16x16x32_bf16 v[36:39], v[96:99], v[144:147], v[36:39]
    ds_read_b64_tr_b16 v[92:93], v5 offset:6272
    v_mfma_f32_16x16x32_bf16 v[48:51], v[96:99], v[148:151], v[48:51]
    ds_read_b128 v[144:147], v1 offset:4032
    v_mfma_f32_16x16x32_bf16 v[52:55], v[100:103], v[148:151], v[52:55]
    ds_read_b64_tr_b16 v[94:95], v5 offset:7040
    v_mfma_f32_16x16x32_bf16 v[56:59], v[104:107], v[148:151], v[56:59]
    ds_read_b128 v[124:127], v1 offset:64
    v_mfma_f32_16x16x32_bf16 v[68:71], v[104:107], v[152:155], v[68:71]
    ds_read_b128 v[148:151], v1 offset:7936
    ds_read_b128 v[128:131], v1 offset:3968
    v_mfma_f32_16x16x32_bf16 v[64:67], v[100:103], v[152:155], v[64:67]
    ds_read_b128 v[132:135], v1 offset:7872
    v_mfma_f32_16x16x32_bf16 v[60:63], v[96:99], v[152:155], v[60:63]
    ds_read_b128 v[136:139], v1 offset:11776
    ds_read_b128 v[152:155], v1 offset:11840
    s_waitcnt lgkmcnt(14)
    s_call_b64 s[76:77], L_H2
    s_branch L_mid4
L_g3:
    s_setprio 2
    s_call_b64 s[76:77], L_H0
.p2align 3
    v_mfma_f32_16x16x32_bf16 v[24:27], v[84:87], v[124:127], v[24:27]
    ds_read_b128 v[108:111], v1 offset:0
    v_mfma_f32_16x16x32_bf16 v[28:31], v[88:91], v[124:127], v[28:31]
    ds_read_b64_tr_b16 v[72:73], v5 offset:0
    v_mfma_f32_16x16x32_bf16 v[32:35], v[92:95], v[124:127], v[32:35]
    ds_read_b64_tr_b16 v[74:75], v5 offset:768
    v_mfma_f32_16x16x32_bf16 v[44:47], v[92:95], v[128:131], v[44:47]
    ds_read_b64_tr_b16 v[76:77], v5 offset:32
    v_mfma_f32_16x16x32_bf16 v[40:43], v[88:91], v[128:131], v[40:43]
    ds_read_b64_tr_b16 v[78:79], v5 offset:800
    v_mfma_f32_16x16x32_bf16 v[36:39], v[84:87], v[128:131], v[36:39]
    ds_read_b64_tr_b16 v[80:81], v5 offset:64
    v_mfma_f32_16x16x32_bf16 v[48:51], v[84:87], v[132:135], v[48:51]
    ds_read_b64_tr_b16 v[82:83], v5 offset:832
    v_mfma_f32_16x16x32_bf16 v[52:55], v[88:91], v[132:135], v[52:55]
    ds_read_b128 v[112:115], v1 offset:3904
    v_mfma_f32_16x16x32_bf16 v[56:59], v[92:95], v[132:135], v[56:59]
    ds_read_b128 v[116:119], v1 offset:7808
    s_waitcnt lgkmcnt(9)
    s_call_b64 s[76:77], L_H1
.p2align 3
    v_mfma_f32_16x16x32_bf16 v[24:27], v[96:99], v[140:143], v[24:27]
    ds_read_b64_tr_b16 v[84:85], v5 offset:6208
    v_mfma_f32_16x16x32_bf16 v[28:31], v[100:103], v[140:143], v[28:31]
    ds_read_b64_tr_b16 v[86:87], v5 offset:6976
    v_mfma_f32_16x16x32_bf16 v[32:35], v[104:107], v[140:143], v[32:35]
    ds_read_b64_tr_b16 v[88:89], v5 offset:6240
    v_mfma_f32_16x16x32_bf16 v[44:47], v[104:107], v[144:147], v[44:47]
    ds_read_b128 v[140:143], v1 offset:128
    ds_read_b64_tr_b16 v[90:91], v5 offset:7008
    v_mfma_f32_16x16x32_bf16 v[40:43], v[100:103], v[144:147], v[40:43]
    ds_read_b64_tr_b16 v[92:93], v5 offset:6272
    v_mfma_f32_16x16x32_bf16 v[36:39], v[96:99], v[144:147], v[36:39]
    ds_read_b64_tr_b16 v[94:95], v5 offset:7040
    v_mfma_f32_16x16x32_bf16 v[48:51], v[96:99], v[148:151], v[48:51]
    ds_read_b128 v[144:147], v1 offset:4032
    ds_read_b128 v[124:127], v1 offset:64
    v_mfma_f32_16x16x32_bf16 v[52:55], v[100:103], v[148:151], v[52:55]
    ds_read_b128 v[128:131], v1 offset:3968
    v_mfma_f32_16x16x32_bf16 v[56:59], v[104:107], v[148:151], v[56:59]
    ds_read_b128 v[132:135], v1 offset:7872
    ds_read_b128 v[148:151], v1 offset:7936
    s_waitcnt lgkmcnt(12)
    s_call_b64 s[76:77], L_H2
    s_branch L_mid3
L_g2:
    s_setprio 2
    s_call_b64 s[76:77], L_H0
.p2align 3
    v_mfma_f32_16x16x32_bf16 v[24:27], v[84:87], v[124:127], v[24:27]
    ds_read_b128 v[108:111], v1 offset:0
    v_mfma_f32_16x16x32_bf16 v[28:31], v[88:91], v[124:127], v[28:31]
    ds_read_b64_tr_b16 v[72:73], v5 offset:0
    v_mfma_f32_16x16x32_bf16 v[32:35], v[92:95], v[124:127], v[32:35]
    ds_read_b64_tr_b16 v[74:75], v5 offset:768
    v_mfma_f32_16x16x32_bf16 v[44:47], v[92:95], v[128:131], v[44:47]
    ds_read_b64_tr_b16 v[76:77], v5 offset:32
    v_mfma_f32_16x16x32_bf16 v[40:43], v[88:91], v[128:131], v[40:43]
    ds_read_b64_tr_b16 v[78:79], v5 offset:800
    v_mfma_f32_16x16x32_bf16 v[36:39], v[84:87], v[128:131], v[36:39]
    ds_read_b64_tr_b16 v[80:81], v5 offset:64
    ds_read_b64_tr_b16 v[82:83], v5 offset:832
    ds_read_b128 v[112:115], v1 offset:3904
    s_waitcnt lgkmcnt(8)
    s_call_b64 s[76:77], L_H1
.p2align 3
    v_mfma_f32_16x16x32_bf16 v[24:27], v[96:99], v[140:143], v[24:27]
    ds_read_b64_tr_b16 v[84:85], v5 offset:6208
    ds_read_b64_tr_b16 v[86:87], v5 offset:6976
    v_mfma_f32_16x16x32_bf16 v[28:31], v[100:103], v[140:143], v[28:31]
    ds_read_b64_tr_b16 v[88:89], v5 offset:6240
    ds_read_b64_tr_b16 v[90:91], v5 offset:7008
    v_mfma_f32_16x16x32_bf16 v[32:35], v[104:107], v[140:143], v[32:35]
    ds_read_b64_tr_b16 v[92:93], v5 offset:6272
    ds_read_b64_tr_b16 v[94:95], v5 offset:7040
    v_mfma_f32_16x16x32_bf16 v[44:47], v[104:107], v[144:147], v[44:47]
    ds_read_b128 v[140:143], v1 offset:128
    ds_read_b128 v[124:127], v1 offset:64
    v_mfma_f32_16x16x32_bf16 v[40:43], v[100:103], v[144:147], v[40:43]
    ds_read_b128 v[128:131], v1 offset:3968
    v_mfma_f32_16x16x32_bf16 v[36:39], v[96:99], v[144:147], v[36:39]
    ds_read_b128 v[144:147], v1 offset:4032
    s_waitcnt lgkmcnt(10)
    s_call_b64 s[76:77], L_H2
    s_branch L_mid2
L_g1:
    s_setprio 2
    s_call_b64 s[76:77], L_H0
.p2align 3
    v_mfma_f32_16x16x32_bf16 v[24:27], v[84:87], v[124:127], v[24:27]
    ds_read_b128 v[108:111], v1 offset:0
    v_mfma_f32_16x16x32_bf16 v[28:31], v[88:91], v[124:127], v[28:31]
    ds_read_b64_tr_b16 v[72:73], v5 offset:0
    v_mfma_f32_16x16x32_bf16 v[32:35], v[92:95], v[124:127], v[32:35]
    ds_read_b64_tr_b16 v[74:75], v5 offset:768
    ds_read_b64_tr_b16 v[76:77], v5 offset:32
    ds_read_b64_tr_b16 v[78:79], v5 offset:800
    ds_read_b64_tr_b16 v[80:81], v5 offset:64
    ds_read_b64_tr_b16 v[82:83], v5 offset:832
    s_waitcnt lgkmcnt(7)
    s_call_b64 s[76:77], L_H1
.p2align 3
    v_mfma_f32_16x16x32_bf16 v[24:27], v[96:99], v[140:143], v[24:27]
    ds_read_b64_tr_b16 v[84:85], v5 offset:6208
    ds_read_b64_tr_b16 v[86:87], v5 offset:6976
    ds_read_b64_tr_b16 v[88:89], v5 offset:6240
    v_mfma_f32_16x16x32_bf16 v[28:31], v[100:103], v[140:143], v[28:31]
    ds_read_b64_tr_b16 v[90:91], v5 offset:7008
    ds_read_b64_tr_b16 v[92:93], v5 offset:6272
    ds_read_b64_tr_b16 v[94:95], v5 offset:7040
    v_mfma_f32_16x16x32_bf16 v[32:35], v[104:107], v[140:143], v[32:35]
    ds_read_b128 v[124:127], v1 offset:64
    ds_read_b128 v[140:143], v1 offset:128
    s_waitcnt lgkmcnt(8)
    s_call_b64 s[76:77], L_H2
    s_branch L_mid1
L_slow0:
    s_mul_i32 s96, s35, 11
    s_lshr_b32 s96, s96, 5
    s_mul_i32 s97, s96, 3
    s_sub_u32 s97, s35, s97
    s_add_u32 s98, s0, s49
    s_add_u32 s96, s96, s98
    s_sub_u32 s96, s96, 1
    s_add_u32 s97, s97, s32
    s_sub_u32 s97, s97, 1
    s_mul_i32 s98, s98, 224
    s_add_u32 s98, s98, s32
    s_mul_i32 s98, s98, 9
    s_add_u32 s98, s98, s35
    s_lshl_b32 s98, s98, 2
    v_mul_u32_u24 v177, 36, v15
    buffer_load_dword v168, v177, s[8:11], s98 offen
    v_cvt_f32_i32 v173, s96
    v_add_u32 v174, s97, v15
    v_cvt_f32_i32 v174, v174
    v_mov_b32 v204, 0
    v_mov_b32 v205, 0
    v_mov_b32 v206, 0
    v_mov_b32 v207, 0
    v_mov_b32 v208, 0
    v_mov_b32 v209, 0
    v_mov_b32 v210, 0
    v_mov_b32 v211, 0
    v_mov_b32 v212, 0
    v_mov_b32 v213, 0
    v_mov_b32 v214, 0
    v_mov_b32 v215, 0
    v_mov_b32 v216, 0
    v_mov_b32 v217, 0
    v_mov_b32 v218, 0
    v_mov_b32 v219, 0
    v_mov_b32 v220, 0
    v_mov_b32 v221, 0
    v_mov_b32 v222, 0
    v_mov_b32 v223, 0
    v_mov_b32 v224, 0
    v_mov_b32 v225, 0
    v_mov_b32 v226, 0
    v_mov_b32 v227, 0
    s_waitcnt vmcnt(0)
    v_lshlrev_b32 v169, 16, v168
    v_and_b32 v170, 0xffff0000, v168
    v_add_f32 v169, v169, v173
    v_add_f32 v170, v170, v174
    v_cvt_pk_bf16_f32 v168, v169, v170
    v_pk_max_i16 v168, v168, 0
    v_pk_min_i16 v168, v168, s91
    v_lshlrev_b32 v169, 16, v168
    v_and_b32 v170, 0xffff0000, v168
    v_fract_f32 v171, v169
    v_fract_f32 v172, v170
    v_cvt_u32_f32 v173, v169
    v_cvt_u32_f32 v174, v170
    v_sub_f32 v175, 1.0, v171
    v_sub_f32 v176, 1.0, v172
    v_cvt_pk_bf16_f32 v169, v175, v176
    v_lshlrev_b32 v175, 16, v169
    v_and_b32 v176, 0xffff0000, v169
    v_mul_f32 v228, v175, v176
    v_mul_f32 v229, v175, v172
    v_mul_f32 v230, v171, v176
    v_mul_f32 v231, v171, v172
    v_cvt_pk_bf16_f32 v169, v228, v229
    v_cvt_pk_bf16_f32 v170, v230, v231
    v_lshlrev_b32 v228, 16, v169
    v_and_b32 v229, 0xffff0000, v169
    v_lshlrev_b32 v230, 16, v170
    v_and_b32 v231, 0xffff0000, v170
    v_cmp_neq_f32 vcc, 0, v172
    v_mul_u32_u24 v177, 224, v173
    v_mov_b32 v169, 192
    v_mov_b32 v170, 43008
    v_cndmask_b32 v179, 0, v169, vcc
    v_cmp_neq_f32 vcc, 0, v171
    v_add_u32 v177, v177, v174
    v_mul_u32_u24 v177, 192, v177
    v_cndmask_b32 v178, 0, v170, vcc
    v_add_u32 v177, v177, v16
    v_sub_u32 v178, v178, v179
    s_mov_b32 s96, 4
L_sl0:
    buffer_load_dwordx2 v[156:157], v177, s[4:7], 0 offen offset:0
    buffer_load_dwordx2 v[158:159], v177, s[4:7], 0 offen offset:16
    buffer_load_dwordx2 v[160:161], v177, s[4:7], 0 offen offset:64
    buffer_load_dwordx2 v[162:163], v177, s[4:7], 0 offen offset:80
    buffer_load_dwordx2 v[164:165], v177, s[4:7], 0 offen offset:128
    buffer_load_dwordx2 v[166:167], v177, s[4:7], 0 offen offset:144
    v_add_u32 v177, v177, v179
    v_swap_b32 v179, v178
    s_waitcnt vmcnt(0)
    v_lshlrev_b32 v169, 16, v156
    v_and_b32 v170, 0xffff0000, v156
    v_fmac_f32 v204, v228, v169
    v_fmac_f32 v205, v228, v170
    v_lshlrev_b32 v169, 16, v157
    v_and_b32 v170, 0xffff0000, v157
    v_fmac_f32 v206, v228, v169
    v_fmac_f32 v207, v228, v170
    v_lshlrev_b32 v169, 16, v158
    v_and_b32 v170, 0xffff0000, v158
    v_fmac_f32 v208, v228, v169
    v_fmac_f32 v209, v228, v170
    v_lshlrev_b32 v169, 16, v159
    v_and_b32 v170, 0xffff0000, v159
    v_fmac_f32 v210, v228, v169
    v_fmac_f32 v211, v228, v170
    v_lshlrev_b32 v169, 16, v160
    v_and_b32 v170, 0xffff0000, v160
    v_fmac_f32 v212, v228, v169
    v_fmac_f32 v213, v228, v170
    v_lshlrev_b32 v169, 16, v161
    v_and_b32 v170, 0xffff0000, v161
    v_fmac_f32 v214, v228, v169
    v_fmac_f32 v215, v228, v170
    v_lshlrev_b32 v169, 16, v162
    v_and_b32 v170, 0xffff0000, v162
    v_fmac_f32 v216, v228, v169
    v_fmac_f32 v217, v228, v170
    v_lshlrev_b32 v169, 16, v163
    v_and_b32 v170, 0xffff0000, v163
    v_fmac_f32 v218, v228, v169
    v_fmac_f32 v219, v228, v170
    v_lshlrev_b32 v169, 16, v164
    v_and_b32 v170, 0xffff0000, v164
    v_fmac_f32 v220, v228, v169
    v_fmac_f32 v221, v228, v170
    v_lshlrev_b32 v169, 16, v165
    v_and_b32 v170, 0xffff0000, v165
    v_fmac_f32 v222, v228, v169
    v_fmac_f32 v223, v228, v170
    v_lshlrev_b32 v169, 16, v166
    v_and_b32 v170, 0xffff0000, v166
    v_fmac_f32 v224, v228, v169
    v_fmac_f32 v225, v228, v170
    v_lshlrev_b32 v169, 16, v167
    v_and_b32 v170, 0xffff0000, v167
    v_fmac_f32 v226, v228, v169
    v_fmac_f32 v227, v228, v170
    v_mov_b32 v228, v229
    v_mov_b32 v229, v230
    v_mov_b32 v230, v231
    s_sub_u32 s96, s96, 1
    s_cmp_lg_u32 s96, 0
    s_cbranch_scc1 L_sl0
    s_setpc_b64 s[78:79]
L_slow1:
    s_mul_i32 s96, s35, 11
    s_lshr_b32 s96, s96, 5
    s_mul_i32 s97, s96, 3
    s_sub_u32 s97, s35, s97
    s_add_u32 s98, s0, s49
    s_add_u32 s96, s96, s98
    s_sub_u32 s96, s96, 1
    s_add_u32 s97, s97, s32
    s_sub_u32 s97, s97, 1
    s_mul_i32 s98, s98, 224
    s_add_u32 s98, s98, s32
    s_mul_i32 s98, s98, 9
    s_add_u32 s98, s98, s35
    s_lshl_b32 s98, s98, 2
    v_mul_u32_u24 v201, 36, v15
    buffer_load_dword v192, v201, s[8:11], s98 offen
    v_cvt_f32_i32 v197, s96
    v_add_u32 v198, s97, v15
    v_cvt_f32_i32 v198, v198
    v_mov_b32 v204, 0
    v_mov_b32 v205, 0
    v_mov_b32 v206, 0
    v_mov_b32 v207, 0
    v_mov_b32 v208, 0
    v_mov_b32 v209, 0
    v_mov_b32 v210, 0
    v_mov_b32 v211, 0
    v_mov_b32 v212, 0
    v_mov_b32 v213, 0
    v_mov_b32 v214, 0
    v_mov_b32 v215, 0
    v_mov_b32 v216, 0
    v_mov_b32 v217, 0
    v_mov_b32 v218, 0
    v_mov_b32 v219, 0
    v_mov_b32 v220, 0
    v_mov_b32 v221, 0
    v_mov_b32 v222, 0
    v_mov_b32 v223, 0
    v_mov_b32 v224, 0
    v_mov_b32 v225, 0
    v_mov_b32 v226, 0
    v_mov_b32 v227, 0
    s_waitcnt vmcnt(0)
    v_lshlrev_b32 v193, 16, v192
    v_and_b32 v194, 0xffff0000, v192
    v_add_f32 v193, v193, v197
    v_add_f32 v194, v194, v198
    v_cvt_pk_bf16_f32 v192, v193, v194
    v_pk_max_i16 v192, v192, 0
    v_pk_min_i16 v192, v192, s91
    v_lshlrev_b32 v193, 16, v192
    v_and_b32 v194, 0xffff0000, v192
    v_fract_f32 v195, v193
    v_fract_f32 v196, v194
    v_cvt_u32_f32 v197, v193
    v_cvt_u32_f32 v198, v194
    v_sub_f32 v199, 1.0, v195
    v_sub_f32 v200, 1.0, v196
    v_cvt_pk_bf16_f32 v193, v199, v200
    v_lshlrev_b32 v199, 16, v193
    v_and_b32 v200, 0xffff0000, v193
    v_mul_f32 v232, v199, v200
    v_mul_f32 v233, v199, v196
    v_mul_f32 v234, v195, v200
    v_mul_f32 v235, v195, v196
    v_cvt_pk_bf16_f32 v193, v232, v233
    v_cvt_pk_bf16_f32 v194, v234, v235
    v_lshlrev_b32 v232, 16, v193
    v_and_b32 v233, 0xffff0000, v193
    v_lshlrev_b32 v234, 16, v194
    v_and_b32 v235, 0xffff0000, v194
    v_cmp_neq_f32 vcc, 0, v196
    v_mul_u32_u24 v201, 224, v197
    v_mov_b32 v193, 192
    v_mov_b32 v194, 43008
    v_cndmask_b32 v203, 0, v193, vcc
    v_cmp_neq_f32 vcc, 0, v195
    v_add_u32 v201, v201, v198
    v_mul_u32_u24 v201, 192, v201
    v_cndmask_b32 v202, 0, v194, vcc
    v_add_u32 v201, v201, v16
    v_sub_u32 v202, v202, v203
    s_mov_b32 s96, 4
L_sl1:
    buffer_load_dwordx2 v[180:181], v201, s[4:7], 0 offen offset:0
    buffer_load_dwordx2 v[182:183], v201, s[4:7], 0 offen offset:16
    buffer_load_dwordx2 v[184:185], v201, s[4:7], 0 offen offset:64
    buffer_load_dwordx2 v[186:187], v201, s[4:7], 0 offen offset:80
    buffer_load_dwordx2 v[188:189], v201, s[4:7], 0 offen offset:128
    buffer_load_dwordx2 v[190:191], v201, s[4:7], 0 offen offset:144
    v_add_u32 v201, v201, v203
    v_swap_b32 v203, v202
    s_waitcnt vmcnt(0)
    v_lshlrev_b32 v193, 16, v180
    v_and_b32 v194, 0xffff0000, v180
    v_fmac_f32 v204, v232, v193
    v_fmac_f32 v205, v232, v194
    v_lshlrev_b32 v193, 16, v181
    v_and_b32 v194, 0xffff0000, v181
    v_fmac_f32 v206, v232, v193
    v_fmac_f32 v207, v232, v194
    v_lshlrev_b32 v193, 16, v182
    v_and_b32 v194, 0xffff0000, v182
    v_fmac_f32 v208, v232, v193
    v_fmac_f32 v209, v232, v194
    v_lshlrev_b32 v193, 16, v183
    v_and_b32 v194, 0xffff0000, v183
    v_fmac_f32 v210, v232, v193
    v_fmac_f32 v211, v232, v194
    v_lshlrev_b32 v193, 16, v184
    v_and_b32 v194, 0xffff0000, v184
    v_fmac_f32 v212, v232, v193
    v_fmac_f32 v213, v232, v194
    v_lshlrev_b32 v193, 16, v185
    v_and_b32 v194, 0xffff0000, v185
    v_fmac_f32 v214, v232, v193
    v_fmac_f32 v215, v232, v194
    v_lshlrev_b32 v193, 16, v186
    v_and_b32 v194, 0xffff0000, v186
    v_fmac_f32 v216, v232, v193
    v_fmac_f32 v217, v232, v194
    v_lshlrev_b32 v193, 16, v187
    v_and_b32 v194, 0xffff0000, v187
    v_fmac_f32 v218, v232, v193
    v_fmac_f32 v219, v232, v194
    v_lshlrev_b32 v193, 16, v188
    v_and_b32 v194, 0xffff0000, v188
    v_fmac_f32 v220, v232, v193
    v_fmac_f32 v221, v232, v194
    v_lshlrev_b32 v193, 16, v189
    v_and_b32 v194, 0xffff0000, v189
    v_fmac_f32 v222, v232, v193
    v_fmac_f32 v223, v232, v194
    v_lshlrev_b32 v193, 16, v190
    v_and_b32 v194, 0xffff0000, v190
    v_fmac_f32 v224, v232, v193
    v_fmac_f32 v225, v232, v194
    v_lshlrev_b32 v193, 16, v191
    v_and_b32 v194, 0xffff0000, v191
    v_fmac_f32 v226, v232, v193
    v_fmac_f32 v227, v232, v194
    v_mov_b32 v232, v233
    v_mov_b32 v233, v234
    v_mov_b32 v234, v235
    s_sub_u32 s96, s96, 1
    s_cmp_lg_u32 s96, 0
    s_cbranch_scc1 L_sl1
    s_setpc_b64 s[78:79]
.p2align 5
L_runtab:
    .long 0xfffeb000, 0x1f800, 0x11101110, 0x6250000, 0xb1e8b1e8, 0xb1e8b1e8, 0x0, 0x0
    .long 0x3e5800, 0x444000, 0x44404440, 0xa846000, 0x22622262, 0x22622262, 0x0, 0x0
    .long 0x83e800, 0x8c7000, 0x39363330, 0xe68ca10, 0x440d4393, 0x44f43c87, 0x0, 0x0
    .long 0x2d4800, 0x372000, 0x3b384440, 0x10824660, 0x3c3d3bd0, 0x350a34aa, 0x0, 0x0
    .long 0x76c800, 0x80a000, 0x3b384440, 0x1082b660, 0x3c3d3bd0, 0x350a34aa, 0x0, 0x0
    .long 0x241800, 0x2df000, 0x3b384440, 0x108238a0, 0x3c3d3bd0, 0x350a34aa, 0x0, 0x0
    .long 0x6d9800, 0x777000, 0x3b384440, 0x1082a8a0, 0x3c3d3bd0, 0x350a34aa, 0x0, 0x0
    .long 0x2d4800, 0x372000, 0x3b384440, 0x108246c0, 0x3c3d3bd0, 0x350a34aa, 0x0, 0x0
    .long 0x0, 0x34800, 0x11101110, 0x6250200, 0xb1e8b1e8, 0xb1e8b1e8, 0x0, 0x0
    .long 0x3d0800, 0x459000, 0x39363330, 0xe685e10, 0x3c0d4393, 0x44f4447a, 0x0, 0x0
    .long 0x7ff800, 0x89d000, 0x3b384440, 0x1080c420, 0x3c3033d0, 0x350a3c9d, 0x0, 0x0
    .long 0x367800, 0x405000, 0x3b384440, 0x10825430, 0x3c3d3bd0, 0x350a34aa, 0x0, 0x0
    .long 0x7ff800, 0x89d000, 0x3b384440, 0x1082c430, 0x3c3d3bd0, 0x350a34aa, 0x0, 0x0
    .long 0x2d4800, 0x372000, 0x3b384440, 0x10824670, 0x3c3d3bd0, 0x350a34aa, 0x0, 0x0
    .long 0x76c800, 0x80a000, 0x3b384440, 0x1082b670, 0x3c3d3bd0, 0x350a34aa, 0x0, 0x0
    .long 0x2d4800, 0x372000, 0x3b384440, 0x108246d0, 0x3c3d3bd0, 0x350a34aa, 0x0, 0x0
    .long 0x15000, 0x54000, 0x12201220, 0x7350400, 0x71e871e8, 0x71e871e8, 0x0, 0x0
    .long 0x367800, 0x405000, 0x3b384440, 0x10805420, 0x343d3bd0, 0x350a3c9d, 0x0, 0x0
    .long 0x8d1800, 0x925800, 0x44404440, 0xa84d800, 0x22622262, 0x22622262, 0x0, 0x0
    .long 0x367800, 0x405000, 0x3b384440, 0x10825440, 0x3c3d3bd0, 0x350a34aa, 0x0, 0x0
    .long 0x7ff800, 0x89d000, 0x3b384440, 0x1082c440, 0x3c3d3bd0, 0x350a34aa, 0x0, 0x0
    .long 0x2d4800, 0x372000, 0x3b384440, 0x10824680, 0x3c3d3bd0, 0x350a34aa, 0x0, 0x0
    .long 0x76c800, 0x80a000, 0x3b384440, 0x1082b680, 0x3c3d3bd0, 0x350a34aa, 0x0, 0x0
    .long 0x367800, 0x405000, 0x3b384440, 0x108254b0, 0x3c3d3bd0, 0x350a34aa, 0x0, 0x0
    .long 0x34800, 0x73800, 0x12201220, 0x7350700, 0x71e871e8, 0x71e871e8, 0x0, 0x0
    .long 0x439800, 0x498000, 0x44404440, 0xa846800, 0x22622262, 0x22622262, 0x0, 0x0
    .long 0x8bc800, 0x925800, 0x28263330, 0xc68d610, 0x4c0d4393, 0x3d013c94, 0x0, 0x0
    .long 0x367800, 0x405000, 0x3b384440, 0x10825450, 0x3c3d3bd0, 0x350a34aa, 0x0, 0x0
    .long 0x7ff800, 0x89d000, 0x3b384440, 0x1082c450, 0x3c3d3bd0, 0x350a34aa, 0x0, 0x0
    .long 0x2d4800, 0x372000, 0x3b384440, 0x10824690, 0x3c3d3bd0, 0x350a34aa, 0x0, 0x0
    .long 0x76c800, 0x80a000, 0x3b384440, 0x1082b690, 0x3c3d3bd0, 0x350a34aa, 0x0, 0x0
    .long 0x367800, 0x405000, 0x3b384440, 0x108254c0, 0x3c3d3bd0, 0x350a34aa, 0x0, 0x0
    .long 0x54000, 0x9d800, 0x22202220, 0x8450a00, 0x59e859e8, 0x59e859e8, 0x0, 0x0
    .long 0x44e800, 0x4d7000, 0x39363330, 0xe686a10, 0x440d4393, 0x44f43c87, 0x0, 0x0
    .long 0x892800, 0x925800, 0x3b384440, 0x1080d220, 0x343d3bd0, 0x350a3c9d, 0x0, 0x0
    .long 0x367800, 0x405000, 0x3b384440, 0x10825460, 0x3c3d3bd0, 0x350a34aa, 0x0, 0x0
    .long 0x7ff800, 0x89d000, 0x3b384440, 0x1082c460, 0x3c3d3bd0, 0x350a34aa, 0x0, 0x0
    .long 0x2d4800, 0x372000, 0x3b384440, 0x108246a0, 0x3c3d3bd0, 0x350a34aa, 0x0, 0x0
    .long 0x76c800, 0x80a000, 0x3b384440, 0x1082b6a0, 0x3c3d3bd0, 0x350a34aa, 0x0, 0x0
    .long 0x367800, 0x405000, 0x3b384440, 0x108254d0, 0x3c3d3bd0, 0x350a34aa, 0x0, 0x0
    .long 0xfffeb000, 0x5e800, 0x44404440, 0xc850010, 0x1adc1adc, 0x1adc1adc, 0x0, 0x0
    .long 0x3fa800, 0x498000, 0x3b384440, 0x10806220, 0x3c3033d0, 0x3cfd349d, 0x0, 0x0
    .long 0xfffeb000, 0x5e800, 0x44404440, 0xc870030, 0x1adc1adc, 0x1adc1adc, 0x0, 0x0
    .long 0x3fa800, 0x498000, 0x3b384440, 0x10826230, 0x3c3d3bd0, 0x350a34aa, 0x0, 0x0
    .long 0x892800, 0x925800, 0x3b384440, 0x1082d230, 0x3c3d3bd0, 0x350a34aa, 0x0, 0x0
    .long 0x367800, 0x405000, 0x3b384440, 0x10825470, 0x3c3d3bd0, 0x350a34aa, 0x0, 0x0
    .long 0x7ff800, 0x89d000, 0x3b384440, 0x1082c470, 0x3c3d3bd0, 0x350a34aa, 0x0, 0x0
    .long 0x3fa800, 0x498000, 0x3b384440, 0x108262b0, 0x3c3d3bd0, 0x350a34aa, 0x0, 0x0
    .long 0x3f000, 0xb2800, 0x44404440, 0xc850810, 0x1adc1adc, 0x1adc1adc, 0x0, 0x0
    .long 0x48d800, 0x4ec000, 0x44404440, 0xa847000, 0x22622262, 0x22622262, 0x0, 0x0
    .long 0x3f000, 0xb2800, 0x44404440, 0xc870830, 0x1adc1adc, 0x1adc1adc, 0x0, 0x0
    .long 0x3fa800, 0x498000, 0x3b384440, 0x10826240, 0x3c3d3bd0, 0x350a34aa, 0x0, 0x0
    .long 0x892800, 0x925800, 0x3b384440, 0x1082d240, 0x3c3d3bd0, 0x350a34aa, 0x0, 0x0
    .long 0x367800, 0x405000, 0x3b384440, 0x10825480, 0x3c3d3bd0, 0x350a34aa, 0x0, 0x0
    .long 0x7ff800, 0x89d000, 0x3b384440, 0x1082c480, 0x3c3d3bd0, 0x350a34aa, 0x0, 0x0
    .long 0x3fa800, 0x498000, 0x3b384440, 0x108262c0, 0x3c3d3bd0, 0x350a34aa, 0x0, 0x0
    .long 0xfffeb000, 0x5e800, 0x44404440, 0xc850020, 0x1adc1adc, 0x1adc1adc, 0x0, 0x0
    .long 0x4e1800, 0x540000, 0x44404440, 0xa847800, 0x22622262, 0x22622262, 0x0, 0x0
    .long 0xfffeb000, 0x5e800, 0x44404440, 0xc870040, 0x1adc1adc, 0x1adc1adc, 0x0, 0x0
    .long 0x3fa800, 0x498000, 0x3b384440, 0x10826250, 0x3c3d3bd0, 0x350a34aa, 0x0, 0x0
    .long 0x892800, 0x925800, 0x3b384440, 0x1082d250, 0x3c3d3bd0, 0x350a34aa, 0x0, 0x0
    .long 0x367800, 0x405000, 0x3b384440, 0x10825490, 0x3c3d3bd0, 0x350a34aa, 0x0, 0x0
    .long 0x7ff800, 0x89d000, 0x3b384440, 0x1082c490, 0x3c3d3bd0, 0x350a34aa, 0x0, 0x0
    .long 0x3fa800, 0x498000, 0x3b384440, 0x108262d0, 0x3c3d3bd0, 0x350a34aa, 0x0, 0x0
    .long 0x3f000, 0xb2800, 0x44404440, 0xc850820, 0x1adc1adc, 0x1adc1adc, 0x0, 0x0
    .long 0x4cc800, 0x555000, 0x39363330, 0xe687610, 0x440d4393, 0x3d014487, 0x0, 0x0
    .long 0x3f000, 0xb2800, 0x44404440, 0xc870840, 0x1adc1adc, 0x1adc1adc, 0x0, 0x0
    .long 0x3fa800, 0x498000, 0x3b384440, 0x10826260, 0x3c3d3bd0, 0x350a34aa, 0x0, 0x0
    .long 0x892800, 0x925800, 0x3b384440, 0x1082d260, 0x3c3d3bd0, 0x350a34aa, 0x0, 0x0
    .long 0x367800, 0x405000, 0x3b384440, 0x108254a0, 0x3c3d3bd0, 0x350a34aa, 0x0, 0x0
    .long 0x7ff800, 0x89d000, 0x3b384440, 0x1082c4a0, 0x3c3d3bd0, 0x350a34aa, 0x0, 0x0
    .long 0x48d800, 0x52b000, 0x3b384440, 0x108270b0, 0x3c3d3bd0, 0x350a34aa, 0x0, 0x0
    .long 0x7e000, 0xc7800, 0x22202220, 0x8450e00, 0x59e859e8, 0x59e859e8, 0x0, 0x0
    .long 0x48d800, 0x52b000, 0x3b384440, 0x10807020, 0x3c3d3bd0, 0x350a34aa, 0x0, 0x0
    .long 0xfffeb000, 0x5e800, 0x44404440, 0xc870050, 0x1adc1adc, 0x1adc1adc, 0x0, 0x0
    .long 0x48d800, 0x52b000, 0x3b384440, 0x10827030, 0x3c3d3bd0, 0x350a34aa, 0x0, 0x0
    .long 0xfffeb000, 0x5e800, 0x44404440, 0xc870070, 0x1adc1adc, 0x1adc1adc, 0x0, 0x0
    .long 0x3fa800, 0x498000, 0x3b384440, 0x10826270, 0x3c3d3bd0, 0x350a34aa, 0x0, 0x0
    .long 0x892800, 0x925800, 0x3b384440, 0x1082d270, 0x3c3d3bd0, 0x350a34aa, 0x0, 0x0
    .long 0x48d800, 0x52b000, 0x3b384440, 0x108270c0, 0x3c3d3bd0, 0x350a34aa, 0x0, 0x0
    .long 0xa8000, 0x106800, 0x33303330, 0xa651200, 0x2a622a62, 0x2a622a62, 0x0, 0x0
    .long 0x535800, 0x594000, 0x44404440, 0xa848000, 0x22622262, 0x22622262, 0x0, 0x0
    .long 0x3f000, 0xb2800, 0x44404440, 0xc870850, 0x1adc1adc, 0x1adc1adc, 0x0, 0x0
    .long 0x48d800, 0x52b000, 0x3b384440, 0x10827040, 0x3c3d3bd0, 0x350a34aa, 0x0, 0x0
    .long 0x3f000, 0xb2800, 0x44404440, 0xc870870, 0x1adc1adc, 0x1adc1adc, 0x0, 0x0
    .long 0x3fa800, 0x498000, 0x3b384440, 0x10826280, 0x3c3d3bd0, 0x350a34aa, 0x0, 0x0
    .long 0x892800, 0x925800, 0x3b384440, 0x1082d280, 0x3c3d3bd0, 0x350a34aa, 0x0, 0x0
    .long 0x48d800, 0x52b000, 0x3b384440, 0x108270d0, 0x3c3d3bd0, 0x350a34aa, 0x0, 0x0
    .long 0xe7000, 0x15a800, 0x44404440, 0xc851800, 0x1adc1adc, 0x1adc1adc, 0x0, 0x0
    .long 0x589800, 0x5e8000, 0x44404440, 0xa848800, 0x22622262, 0x22622262, 0x0, 0x0
    .long 0xfffeb000, 0x5e800, 0x44404440, 0xc870060, 0x1adc1adc, 0x1adc1adc, 0x0, 0x0
    .long 0x48d800, 0x52b000, 0x3b384440, 0x10827050, 0x3c3d3bd0, 0x350a34aa, 0x0, 0x0
    .long 0xfffeb000, 0x5e800, 0x44404440, 0xc870080, 0x1adc1adc, 0x1adc1adc, 0x0, 0x0
    .long 0x3fa800, 0x498000, 0x3b384440, 0x10826290, 0x3c3d3bd0, 0x350a34aa, 0x0, 0x0
    .long 0x892800, 0x925800, 0x3b384440, 0x1082d290, 0x3c3d3bd0, 0x350a34aa, 0x0, 0x0
    .long 0x520800, 0x5be000, 0x3b384440, 0x10827eb0, 0x3c3d3bd0, 0x350a34aa, 0x0, 0x0
    .long 0x93000, 0x106800, 0x26242220, 0xc491010, 0x344e6b93, 0x350e34ae, 0x0, 0x0
    .long 0x54a800, 0x5d3000, 0x39363330, 0xe688210, 0x3c0d4393, 0x44f4447a, 0x0, 0x0
    .long 0x3f000, 0xb2800, 0x44404440, 0xc870860, 0x1adc1adc, 0x1adc1adc, 0x0, 0x0
    .long 0x48d800, 0x52b000, 0x3b384440, 0x10827060, 0x3c3d3bd0, 0x350a34aa, 0x0, 0x0
    .long 0x3f000, 0xb2800, 0x44404440, 0xc870880, 0x1adc1adc, 0x1adc1adc, 0x0, 0x0
    .long 0x3fa800, 0x498000, 0x3b384440, 0x108262a0, 0x3c3d3bd0, 0x350a34aa, 0x0, 0x0
    .long 0x892800, 0x925800, 0x3b384440, 0x1082d2a0, 0x3c3d3bd0, 0x350a34aa, 0x0, 0x0
    .long 0x520800, 0x5be000, 0x3b384440, 0x10827ec0, 0x3c3d3bd0, 0x350a34aa, 0x0, 0x0
    .long 0xe7000, 0x16f800, 0x28263330, 0xe691810, 0x44275393, 0x350e3ca1, 0x0, 0x0
    .long 0x520800, 0x5be000, 0x3b384440, 0x10807e20, 0x3c3d3bd0, 0x350a34aa, 0x0, 0x0
    .long 0x93000, 0x130800, 0x39363330, 0x106b1030, 0x2c7e63d0, 0x2d1724d1, 0x0, 0x0
    .long 0x520800, 0x5be000, 0x3b384440, 0x10827e30, 0x3c3d3bd0, 0x350a34aa, 0x0, 0x0
    .long 0xfffeb000, 0x5e800, 0x44404440, 0xc870090, 0x1adc1adc, 0x1adc1adc, 0x0, 0x0
    .long 0x48d800, 0x52b000, 0x3b384440, 0x10827070, 0x3c3d3bd0, 0x350a34aa, 0x0, 0x0
    .long 0xfffeb000, 0x5e800, 0x44404440, 0xc8700b0, 0x1adc1adc, 0x1adc1adc, 0x0, 0x0
    .long 0x520800, 0x5be000, 0x3b384440, 0x10827ed0, 0x3c3d3bd0, 0x350a34aa, 0x0, 0x0
    .long 0x93000, 0x130800, 0x39363330, 0x10691020, 0x248b6bd0, 0x2d1724d1, 0x0, 0x0
    .long 0x5dd800, 0x63c000, 0x44404440, 0xa849000, 0x22622262, 0x22622262, 0x0, 0x0
    .long 0x93000, 0x130800, 0x39363330, 0x106b1040, 0x2c7e63d0, 0x2d1724d1, 0x0, 0x0
    .long 0x520800, 0x5be000, 0x3b384440, 0x10827e40, 0x3c3d3bd0, 0x350a34aa, 0x0, 0x0
    .long 0x3f000, 0xb2800, 0x44404440, 0xc870890, 0x1adc1adc, 0x1adc1adc, 0x0, 0x0
    .long 0x48d800, 0x52b000, 0x3b384440, 0x10827080, 0x3c3d3bd0, 0x350a34aa, 0x0, 0x0
    .long 0x3f000, 0xb2800, 0x44404440, 0xc8708b0, 0x1adc1adc, 0x1adc1adc, 0x0, 0x0
    .long 0x5b3800, 0x651000, 0x3b384440, 0x10828cb0, 0x3c3d3bd0, 0x350a34aa, 0x0, 0x0
    .long 0x13b000, 0x1ae800, 0x44404440, 0xc852000, 0x1adc1adc, 0x1adc1adc, 0x0, 0x0
    .long 0x631800, 0x690000, 0x44404440, 0xa849800, 0x22622262, 0x22622262, 0x0, 0x0
    .long 0x93000, 0x130800, 0x39363330, 0x106b1050, 0x2c8b6bd0, 0x252424de, 0x0, 0x0
    .long 0x520800, 0x5be000, 0x3b384440, 0x10827e50, 0x3c3d3bd0, 0x350a34aa, 0x0, 0x0
    .long 0xfffeb000, 0x5e800, 0x44404440, 0xc8700a0, 0x1adc1adc, 0x1adc1adc, 0x0, 0x0
    .long 0x48d800, 0x52b000, 0x3b384440, 0x10827090, 0x3c3d3bd0, 0x350a34aa, 0x0, 0x0
    .long 0xfffeb000, 0x5e800, 0x44404440, 0xc8700c0, 0x1adc1adc, 0x1adc1adc, 0x0, 0x0
    .long 0x5b3800, 0x651000, 0x3b384440, 0x10828cc0, 0x3c3d3bd0, 0x350a34aa, 0x0, 0x0
    .long 0x199800, 0x1f8000, 0x44404440, 0xa842800, 0x22622262, 0x22622262, 0x0, 0x0
    .long 0x5c8800, 0x651000, 0x39363330, 0xe688e10, 0x440d4393, 0x44f43c87, 0x0, 0x0
    .long 0x93000, 0x130800, 0x39363330, 0x106b1060, 0x2c7e63d0, 0x25242cd1, 0x0, 0x0
    .long 0x520800, 0x5be000, 0x3b384440, 0x10827e60, 0x3c3d3bd0, 0x350a34aa, 0x0, 0x0
    .long 0x3f000, 0xb2800, 0x44404440, 0xc8708a0, 0x1adc1adc, 0x1adc1adc, 0x0, 0x0
    .long 0x48d800, 0x52b000, 0x3b384440, 0x108270a0, 0x3c3d3bd0, 0x350a34aa, 0x0, 0x0
    .long 0x3f000, 0xb2800, 0x44404440, 0xc8708c0, 0x1adc1adc, 0x1adc1adc, 0x0, 0x0
    .long 0x5b3800, 0x651000, 0x3b384440, 0x10828cd0, 0x3c3d3bd0, 0x350a34aa, 0x0, 0x0
    .long 0x150000, 0x1ed800, 0x39363330, 0x10692210, 0x343033d0, 0x3cfd3c90, 0x0, 0x0
    .long 0x5b3800, 0x651000, 0x3b384440, 0x10808c20, 0x3c3d3bd0, 0x350a34aa, 0x0, 0x0
    .long 0x111000, 0x1b9000, 0x4a463330, 0x11631c30, 0x2c87440d, 0x252224da, 0x0, 0x0
    .long 0x5b3800, 0x651000, 0x3b384440, 0x10828c30, 0x3c3d3bd0, 0x350a34aa, 0x0, 0x0
    .long 0x93000, 0x130800, 0x39363330, 0x106b1070, 0x2c7e63d0, 0x2d1724d1, 0x0, 0x0
    .long 0x520800, 0x5be000, 0x3b384440, 0x10827e70, 0x3c3d3bd0, 0x350a34aa, 0x0, 0x0
    .long 0xfffeb000, 0x5e800, 0x44404440, 0xc8700d0, 0x1adc1adc, 0x1adc1adc, 0x0, 0x0
    .long 0x646800, 0x6e4000, 0x3b384440, 0x10829ab0, 0x3c3d3bd0, 0x350a34aa, 0x0, 0x0
    .long 0x111000, 0x1b9000, 0x4a463330, 0x11611c20, 0x347a3c0d, 0x252224da, 0x0, 0x0
    .long 0x685800, 0x6e4000, 0x44404440, 0xa84a000, 0x22622262, 0x22622262, 0x0, 0x0
    .long 0x111000, 0x1b9000, 0x4a463330, 0x11631c40, 0x347a3c0d, 0x252224da, 0x0, 0x0
    .long 0x5b3800, 0x651000, 0x3b384440, 0x10828c40, 0x3c3d3bd0, 0x350a34aa, 0x0, 0x0
    .long 0x93000, 0x130800, 0x39363330, 0x106b1080, 0x2c7e63d0, 0x2d1724d1, 0x0, 0x0
    .long 0x520800, 0x5be000, 0x3b384440, 0x10827e80, 0x3c3d3bd0, 0x350a34aa, 0x0, 0x0
    .long 0x3f000, 0xb2800, 0x44404440, 0xc8708d0, 0x1adc1adc, 0x1adc1adc, 0x0, 0x0
    .long 0x646800, 0x6e4000, 0x3b384440, 0x10829ac0, 0x3c3d3bd0, 0x350a34aa, 0x0, 0x0
    .long 0x1ed800, 0x24c000, 0x44404440, 0xa843000, 0x22622262, 0x22622262, 0x0, 0x0
    .long 0x646800, 0x6cf000, 0x39363330, 0xe689a10, 0x3c0d4393, 0x44f4447a, 0x0, 0x0
    .long 0x111000, 0x1b9000, 0x4a463330, 0x11631c50, 0x347a3c0d, 0x252224da, 0x0, 0x0
    .long 0x5b3800, 0x651000, 0x3b384440, 0x10828c50, 0x3c3d3bd0, 0x350a34aa, 0x0, 0x0
    .long 0x93000, 0x130800, 0x39363330, 0x106b1090, 0x247e63d0, 0x2d172cc4, 0x0, 0x0
    .long 0x520800, 0x5be000, 0x3b384440, 0x10827e90, 0x3c3d3bd0, 0x350a34aa, 0x0, 0x0
    .long 0x93000, 0x130800, 0x39363330, 0x106b10b0, 0x247e63d0, 0x2d172cc4, 0x0, 0x0
    .long 0x646800, 0x6e4000, 0x3b384440, 0x10829ad0, 0x3c3d3bd0, 0x350a34aa, 0x0, 0x0
    .long 0x1d8800, 0x261000, 0x39363330, 0xe682e10, 0x3c0d4393, 0x44f4447a, 0x0, 0x0
    .long 0x6c4800, 0x74d000, 0x39363330, 0xe68a610, 0x440d4393, 0x3d014487, 0x0, 0x0
    .long 0x111000, 0x1b9000, 0x4a463330, 0x11631c60, 0x347a3c0d, 0x252224da, 0x0, 0x0
    .long 0x5b3800, 0x651000, 0x3b384440, 0x10828c60, 0x3c3d3bd0, 0x350a34aa, 0x0, 0x0
    .long 0x93000, 0x130800, 0x39363330, 0x106b10a0, 0x2c7e63d0, 0x2d1724d1, 0x0, 0x0
    .long 0x520800, 0x5be000, 0x3b384440, 0x10827ea0, 0x3c3d3bd0, 0x350a34aa, 0x0, 0x0
    .long 0x93000, 0x130800, 0x39363330, 0x106b10c0, 0x2c7e63d0, 0x2d1724d1, 0x0, 0x0
    .long 0x6d9800, 0x777000, 0x3b384440, 0x1082a8b0, 0x3c3d3bd0, 0x350a34aa, 0x0, 0x0
    .long 0x1ae800, 0x24c000, 0x3b384440, 0x10802a20, 0x3c3d3bd0, 0x350a34aa, 0x0, 0x0
    .long 0x646800, 0x6e4000, 0x3b384440, 0x10809a20, 0x3c3033d0, 0x350a3c9d, 0x0, 0x0
    .long 0x1ae800, 0x24c000, 0x3b384440, 0x10822a30, 0x3c3d3bd0, 0x350a34aa, 0x0, 0x0
    .long 0x646800, 0x6e4000, 0x3b384440, 0x10829a30, 0x3c3d3bd0, 0x350a34aa, 0x0, 0x0
    .long 0x111000, 0x1b9000, 0x4a463330, 0x11631c70, 0x347a3c0d, 0x252224da, 0x0, 0x0
    .long 0x5b3800, 0x651000, 0x3b384440, 0x10828c70, 0x3c3d3bd0, 0x350a34aa, 0x0, 0x0
    .long 0x93000, 0x130800, 0x39363330, 0x106b10d0, 0x2c7e63d0, 0x2d1724d1, 0x0, 0x0
    .long 0x6d9800, 0x777000, 0x3b384440, 0x1082a8c0, 0x3c3d3bd0, 0x350a34aa, 0x0, 0x0
    .long 0x241800, 0x2a0000, 0x44404440, 0xa843800, 0x22622262, 0x22622262, 0x0, 0x0
    .long 0x6d9800, 0x738000, 0x44404440, 0xa84a800, 0x22622262, 0x22622262, 0x0, 0x0
    .long 0x1ae800, 0x24c000, 0x3b384440, 0x10822a40, 0x3c3d3bd0, 0x350a34aa, 0x0, 0x0
    .long 0x646800, 0x6e4000, 0x3b384440, 0x10829a40, 0x3c3d3bd0, 0x350a34aa, 0x0, 0x0
    .long 0x111000, 0x1b9000, 0x4a463330, 0x11631c80, 0x347a3c0d, 0x252224da, 0x0, 0x0
    .long 0x5b3800, 0x651000, 0x3b384440, 0x10828c80, 0x3c3d3bd0, 0x350a34aa, 0x0, 0x0
    .long 0x111000, 0x1b9000, 0x4a463330, 0x11631cb0, 0x347a3c0d, 0x252224da, 0x0, 0x0
    .long 0x6d9800, 0x777000, 0x3b384440, 0x1082a8d0, 0x3c3d3bd0, 0x350a34aa, 0x0, 0x0
    .long 0x295800, 0x2f4000, 0x44404440, 0xa844000, 0x22622262, 0x22622262, 0x0, 0x0
    .long 0x72d800, 0x78c000, 0x44404440, 0xa84b000, 0x22622262, 0x22622262, 0x0, 0x0
    .long 0x1ae800, 0x24c000, 0x3b384440, 0x10822a50, 0x3c3d3bd0, 0x350a34aa, 0x0, 0x0
    .long 0x646800, 0x6e4000, 0x3b384440, 0x10829a50, 0x3c3d3bd0, 0x350a34aa, 0x0, 0x0
    .long 0x111000, 0x1b9000, 0x4a463330, 0x11631c90, 0x347a3c0d, 0x252224da, 0x0, 0x0
    .long 0x5b3800, 0x651000, 0x3b384440, 0x10828c90, 0x3c3d3bd0, 0x350a34aa, 0x0, 0x0
    .long 0x111000, 0x1b9000, 0x4a463330, 0x11631cc0, 0x347a3c0d, 0x252224da, 0x0, 0x0
    .long 0x76c800, 0x80a000, 0x3b384440, 0x1082b6b0, 0x3c3d3bd0, 0x350a34aa, 0x0, 0x0
    .long 0x256800, 0x2df000, 0x39363330, 0xe683a10, 0x440d4393, 0x44f43c87, 0x0, 0x0
    .long 0x742800, 0x7cb000, 0x39363330, 0xe68b210, 0x44003b93, 0x44f4447a, 0x0, 0x0
    .long 0x1ae800, 0x24c000, 0x3b384440, 0x10822a60, 0x3c3d3bd0, 0x350a34aa, 0x0, 0x0
    .long 0x646800, 0x6e4000, 0x3b384440, 0x10829a60, 0x3c3d3bd0, 0x350a34aa, 0x0, 0x0
    .long 0x111000, 0x1b9000, 0x4a463330, 0x11631ca0, 0x347a3c0d, 0x252224da, 0x0, 0x0
    .long 0x5b3800, 0x651000, 0x3b384440, 0x10828ca0, 0x3c3d3bd0, 0x350a34aa, 0x0, 0x0
    .long 0x111000, 0x1b9000, 0x4a463330, 0x11631cd0, 0x347a3c0d, 0x252224da, 0x0, 0x0
    .long 0x76c800, 0x80a000, 0x3b384440, 0x1082b6c0, 0x3c3d3bd0, 0x350a34aa, 0x0, 0x0
    .long 0x241800, 0x2df000, 0x3b384440, 0x10803820, 0x3c3d3bd0, 0x350a34aa, 0x0, 0x0
    .long 0x6d9800, 0x777000, 0x3b384440, 0x1080a820, 0x3c3d3bd0, 0x350a34aa, 0x0, 0x0
    .long 0x241800, 0x2df000, 0x3b384440, 0x10823830, 0x3c3d3bd0, 0x350a34aa, 0x0, 0x0
    .long 0x6d9800, 0x777000, 0x3b384440, 0x1082a830, 0x3c3d3bd0, 0x350a34aa, 0x0, 0x0
    .long 0x1ae800, 0x24c000, 0x3b384440, 0x10822a70, 0x3c3d3bd0, 0x350a34aa, 0x0, 0x0
    .long 0x646800, 0x6e4000, 0x3b384440, 0x10829a70, 0x3c3d3bd0, 0x350a34aa, 0x0, 0x0
    .long 0x1ae800, 0x24c000, 0x3b384440, 0x10822ab0, 0x3c3d3bd0, 0x350a34aa, 0x0, 0x0
    .long 0x76c800, 0x80a000, 0x3b384440, 0x1082b6d0, 0x3c3d3bd0, 0x350a34aa, 0x0, 0x0
    .long 0x2e9800, 0x348000, 0x44404440, 0xa844800, 0x22622262, 0x22622262, 0x0, 0x0
    .long 0x781800, 0x7e0000, 0x44404440, 0xa84b800, 0x22622262, 0x22622262, 0x0, 0x0
    .long 0x241800, 0x2df000, 0x3b384440, 0x10823840, 0x3c3d3bd0, 0x350a34aa, 0x0, 0x0
    .long 0x6d9800, 0x777000, 0x3b384440, 0x1082a840, 0x3c3d3bd0, 0x350a34aa, 0x0, 0x0
    .long 0x1ae800, 0x24c000, 0x3b384440, 0x10822a80, 0x3c3d3bd0, 0x350a34aa, 0x0, 0x0
    .long 0x646800, 0x6e4000, 0x3b384440, 0x10829a80, 0x3c3d3bd0, 0x350a34aa, 0x0, 0x0
    .long 0x1ae800, 0x24c000, 0x3b384440, 0x10822ac0, 0x3c3d3bd0, 0x350a34aa, 0x0, 0x0
    .long 0x7ff800, 0x89d000, 0x3b384440, 0x1082c4b0, 0x3c3d3bd0, 0x350a34aa, 0x0, 0x0
    .long 0x33d800, 0x39c000, 0x44404440, 0xa845000, 0x22622262, 0x22622262, 0x0, 0x0
    .long 0x7d5800, 0x834000, 0x44404440, 0xa84c000, 0x22622262, 0x22622262, 0x0, 0x0
    .long 0x241800, 0x2df000, 0x3b384440, 0x10823850, 0x3c3d3bd0, 0x350a34aa, 0x0, 0x0
    .long 0x6d9800, 0x777000, 0x3b384440, 0x1082a850, 0x3c3d3bd0, 0x350a34aa, 0x0, 0x0
    .long 0x1ae800, 0x24c000, 0x3b384440, 0x10822a90, 0x3c3d3bd0, 0x350a34aa, 0x0, 0x0
    .long 0x646800, 0x6e4000, 0x3b384440, 0x10829a90, 0x3c3d3bd0, 0x350a34aa, 0x0, 0x0
    .long 0x1ae800, 0x24c000, 0x3b384440, 0x10822ad0, 0x3c3d3bd0, 0x350a34aa, 0x0, 0x0
    .long 0x7ff800, 0x89d000, 0x3b384440, 0x1082c4c0, 0x3c3d3bd0, 0x350a34aa, 0x0, 0x0
    .long 0x2d4800, 0x35d000, 0x39363330, 0xe684610, 0x440d4393, 0x44f43c87, 0x0, 0x0
    .long 0x7c0800, 0x849000, 0x39363330, 0xe68be10, 0x44003b93, 0x44f4447a, 0x0, 0x0
    .long 0x241800, 0x2df000, 0x3b384440, 0x10823860, 0x3c3d3bd0, 0x350a34aa, 0x0, 0x0
    .long 0x6d9800, 0x777000, 0x3b384440, 0x1082a860, 0x3c3d3bd0, 0x350a34aa, 0x0, 0x0
    .long 0x1ae800, 0x24c000, 0x3b384440, 0x10822aa0, 0x3c3d3bd0, 0x350a34aa, 0x0, 0x0
    .long 0x646800, 0x6e4000, 0x3b384440, 0x10829aa0, 0x3c3d3bd0, 0x350a34aa, 0x0, 0x0
    .long 0x241800, 0x2df000, 0x3b384440, 0x108238b0, 0x3c3d3bd0, 0x350a34aa, 0x0, 0x0
    .long 0x7ff800, 0x89d000, 0x3b384440, 0x1082c4d0, 0x3c3d3bd0, 0x350a34aa, 0x0, 0x0
    .long 0x352800, 0x3db000, 0x39363330, 0xe685210, 0x44003b93, 0x44f4447a, 0x0, 0x0
    .long 0x76c800, 0x80a000, 0x3b384440, 0x1080b620, 0x343d3bd0, 0x350a3c9d, 0x0, 0x0
    .long 0x2d4800, 0x372000, 0x3b384440, 0x10824630, 0x3c3d3bd0, 0x350a34aa, 0x0, 0x0
    .long 0x76c800, 0x80a000, 0x3b384440, 0x1082b630, 0x3c3d3bd0, 0x350a34aa, 0x0, 0x0
    .long 0x241800, 0x2df000, 0x3b384440, 0x10823870, 0x3c3d3bd0, 0x350a34aa, 0x0, 0x0
    .long 0x6d9800, 0x777000, 0x3b384440, 0x1082a870, 0x3c3d3bd0, 0x350a34aa, 0x0, 0x0
    .long 0x241800, 0x2df000, 0x3b384440, 0x108238c0, 0x3c3d3bd0, 0x350a34aa, 0x0, 0x0
    .long 0x892800, 0x925800, 0x3b384440, 0x1082d2b0, 0x3c3d3bd0, 0x350a34aa, 0x0, 0x0
    .long 0x2d4800, 0x372000, 0x3b384440, 0x10804620, 0x3c3d3bd0, 0x350a34aa, 0x0, 0x0
    .long 0x829800, 0x888000, 0x44404440, 0xa84c800, 0x22622262, 0x22622262, 0x0, 0x0
    .long 0x2d4800, 0x372000, 0x3b384440, 0x10824640, 0x3c3d3bd0, 0x350a34aa, 0x0, 0x0
    .long 0x76c800, 0x80a000, 0x3b384440, 0x1082b640, 0x3c3d3bd0, 0x350a34aa, 0x0, 0x0
    .long 0x241800, 0x2df000, 0x3b384440, 0x10823880, 0x3c3d3bd0, 0x350a34aa, 0x0, 0x0
    .long 0x6d9800, 0x777000, 0x3b384440, 0x1082a880, 0x3c3d3bd0, 0x350a34aa, 0x0, 0x0
    .long 0x241800, 0x2df000, 0x3b384440, 0x108238d0, 0x3c3d3bd0, 0x350a34aa, 0x0, 0x0
    .long 0x892800, 0x925800, 0x3b384440, 0x1082d2c0, 0x3c3d3bd0, 0x350a34aa, 0x0, 0x0
    .long 0x391800, 0x3f0000, 0x44404440, 0xa845800, 0x22622262, 0x22622262, 0x0, 0x0
    .long 0x87d800, 0x8dc000, 0x44404440, 0xa84d000, 0x22622262, 0x22622262, 0x0, 0x0
    .long 0x2d4800, 0x372000, 0x3b384440, 0x10824650, 0x3c3d3bd0, 0x350a34aa, 0x0, 0x0
    .long 0x76c800, 0x80a000, 0x3b384440, 0x1082b650, 0x3c3d3bd0, 0x350a34aa, 0x0, 0x0
    .long 0x241800, 0x2df000, 0x3b384440, 0x10823890, 0x3c3d3bd0, 0x350a34aa, 0x0, 0x0
    .long 0x6d9800, 0x777000, 0x3b384440, 0x1082a890, 0x3c3d3bd0, 0x350a34aa, 0x0, 0x0
    .long 0x2d4800, 0x372000, 0x3b384440, 0x108246b0, 0x3c3d3bd0, 0x350a34aa, 0x0, 0x0
    .long 0x892800, 0x925800, 0x3b384440, 0x1082d2d0, 0x3c3d3bd0, 0x350a34aa, 0x0, 0x0
.section .rodata,"a"
.p2align 6
.amdhsa_kernel standalone__deformable_dcnv1__vision_kernel
  .amdhsa_next_free_vgpr 256
  .amdhsa_next_free_sgpr 102
  .amdhsa_accum_offset 256
  .amdhsa_group_segment_fixed_size 0
  .amdhsa_kernarg_size 48
  .amdhsa_user_sgpr_count 2
  .amdhsa_user_sgpr_kernarg_segment_ptr 1
  .amdhsa_system_sgpr_workgroup_id_x 1
  .amdhsa_float_denorm_mode_32 3
.end_amdhsa_kernel
```

```asm
; @launch grid=(256,1,1) block=(512,1,1) lds=163840
.amdgcn_target "amdgcn-amd-amdhsa--gfx950"
.text
.globl standalone__deformable_dcnv1__vision_kernel
.p2align 12
.p2align 8
.type standalone__deformable_dcnv1__vision_kernel,@function
standalone__deformable_dcnv1__vision_kernel:
    s_cmp_ge_u32 s2, 256
    s_cbranch_scc1 L_end
    s_getpc_b64 s[40:41]
L_pc:
    s_lshl_b32 s96, s2, 5
    s_add_u32 s96, s96, L_runtab-L_pc
    s_add_u32 s42, s40, s96
    s_addc_u32 s43, s41, 0
    s_load_dwordx8 s[20:27], s[42:43], 0
    s_load_dwordx2 s[12:13], s[0:1], 16
    s_load_dwordx2 s[4:5], s[0:1], 0
    s_load_dwordx2 s[8:9], s[0:1], 8
    s_load_dwordx2 s[16:17], s[0:1], 24
    v_lshrrev_b32 v73, 6, v0
    v_and_b32 v72, 63, v0
    v_readfirstlane_b32 s28, v73
    v_lshlrev_b32 v16, 4, v72
    v_mul_u32_u24 v228, 12, v72
    s_mov_b32 s6, 9633792
    s_mov_b32 s7, 0x00020000
    s_mov_b32 s10, 1806336
    s_mov_b32 s11, s7
    s_mov_b32 s14, 165888
    s_mov_b32 s15, s7
    s_mov_b32 s18, s6
    s_mov_b32 s19, s7
    s_and_b32 s29, s28, 1
    s_lshr_b32 s30, s28, 1
    s_lshl_b32 s30, s30, 3
    s_and_b32 s97, s28, 3
    v_add_u32 v0, L_ctab-L_pc+2048, v16
    s_mov_b32 s70, 0x152020
    s_mov_b32 s71, 0xc0010
    global_load_dwordx4 v[240:243], v0, s[40:41] offset:-2048
    s_lshl_b32 s96, s2, 3
    s_lshr_b64 s[70:71], s[70:71], s96
    s_and_b32 s70, s70, 0xff
    s_lshr_b32 s96, s2, 3
    s_cmp_ge_u32 s96, s70
    s_cbranch_scc1 L_nocl
    global_load_dwordx4 v[224:227], v0, s[40:41] offset:-1024
    global_load_dwordx4 v[232:235], v0, s[40:41] offset:0
    global_load_dwordx4 v[12:15], v0, s[40:41] offset:1024
    global_load_dwordx4 v[8:11], v0, s[40:41] offset:2048
L_nocl:
    s_lshl_b32 s96, s28, 12
    v_lshlrev_b32 v22, 3, v16
    v_add_u32 v22, s96, v22
    v_min_u32 v22, L_cold-L_pc, v22
    s_lshr_b32 s96, s2, 3
    s_lshl_b64 exec, 1, s96
    global_load_dword v22, v22, s[40:41]
    s_mov_b64 exec, -1
    s_lshl_b32 s96, s97, 10
    v_add_u32 v19, s96, v16
    s_add_u32 s96, s96, 89280
    s_cmp_ge_u32 s97, 3
    s_cselect_b32 s88, 32, 0
    s_add_u32 s88, s88, s96
    s_cmp_ge_u32 s97, 2
    s_cselect_b32 s89, 32, 0
    s_add_u32 s89, s89, s96
    s_cmp_ge_u32 s97, 1
    s_cselect_b32 s90, 32, 0
    s_add_u32 s90, s90, s96
    s_mul_i32 s94, s97, 960
    s_mul_i32 s98, s97, 5
    v_mul_u32_u24 v76, 5462, v72
    v_lshrrev_b32 v76, 16, v76
    v_mul_u32_u24 v73, 12, v76
    v_add_u32 v76, s98, v76
    v_sub_u32 v73, v72, v73
    v_bfe_u32 v74, v76, 2, 2
    v_xor_b32 v73, v73, v74
    v_lshlrev_b32 v20, 4, v73
    v_cmp_gt_u32 s[92:93], 60, v72
    s_cmp_lt_u32 s28, 4
    s_cselect_b32 s39, 0, 0x3e
    s_cselect_b32 s99, 0, 768
    s_mov_b32 s95, 73728
    s_mov_b32 s35, 0
    s_mov_b32 s37, 0
    s_mov_b32 s38, 0
    v_mov_b32 v108, 0
    v_mov_b32 v109, 0
    v_mov_b32 v110, 0
    v_mov_b32 v111, 0
    s_lshl_b32 s96, s28, 2
    s_add_u32 s96, s96, 163776
    v_mov_b32 v254, s96
    v_mfma_f32_32x32x16_bf16 v[24:39], v[108:111], v[108:111], 0
    v_mfma_f32_32x32x16_bf16 v[40:55], v[108:111], v[108:111], 0
    v_mfma_f32_32x32x16_bf16 v[56:71], v[108:111], v[108:111], 0
    v_xor_b32 v255, 4, v254
    ds_write_b32 v254, v108
    s_waitcnt lgkmcnt(0)
    s_bfe_u32 s75, s23, 0x1001e
    s_bitset0_b32 s23, 30
    s_lshr_b32 s96, s22, s30
    s_and_b32 s32, s23, 0xff
    s_and_b32 s31, s96, 15
    s_bfe_u32 s30, s96, 0x30004
    s_bfe_u32 s33, s23, 0x80008
    s_add_u32 s0, s33, s31
    s_mul_i32 s3, s0, 224
    s_add_u32 s3, s3, s32
    s_mul_i32 s3, s3, 36
    s_bitcmp1_b32 s23, 18
    s_cbranch_scc1 L_startD
    s_cmp_gt_u32 s30, 0
    s_cselect_b32 s96, s3, 2130706432
    s_addk_i32 s3, 8064
    buffer_load_dwordx3 v[204:206], v228, s[8:11], s96 offen
    s_cmp_gt_u32 s30, 1
    s_cselect_b32 s96, s3, 2130706432
    s_addk_i32 s3, 8064
    buffer_load_dwordx3 v[208:210], v228, s[8:11], s96 offen
    s_cmp_gt_u32 s30, 2
    s_cselect_b32 s96, s3, 2130706432
    s_addk_i32 s3, 8064
    buffer_load_dwordx3 v[212:214], v228, s[8:11], s96 offen
    s_cmp_gt_u32 s30, 3
    s_cselect_b32 s96, s3, 2130706432
    s_addk_i32 s3, 8064
    buffer_load_dwordx3 v[216:218], v228, s[8:11], s96 offen
    s_sub_u32 s34, s32, 2
    s_bfe_u32 s100, s23, 0x10011
    s_lshl_b32 s101, s100, 1
    s_sub_u32 s101, 19, s101
    s_bfe_u32 s96, s23, 0x10010
    s_sub_u32 s33, s33, s96
    s_sub_u32 s33, s33, 1
    s_cmp_lt_u32 s28, 4
    s_cbranch_scc1 L_startA
    s_bitcmp1_b32 s23, 19
    s_cbranch_scc1 L_startBH
    s_add_u32 m0, s88, 0
    s_mov_b32 s96, 0
    buffer_load_dwordx4 v19, s[12:15], s96 offen lds
    s_add_u32 m0, s89, 4128
    s_mov_b32 s96, 4096
    buffer_load_dwordx4 v19, s[12:15], s96 offen lds
    s_movk_i32 s97, 223
    v_add_u32 v74, s34, v76
    v_subrev_u32 v75, s100, v76
    v_med3_i32 v74, v74, 0, s97
    v_cmp_ge_u32 vcc, s101, v75
    v_mul_u32_u24 v74, 192, v74
    s_and_b64 s[92:93], s[92:93], vcc
    v_add_u32 v20, v74, v20
    s_add_u32 m0, s90, 8256
    s_mov_b32 s96, 8192
    buffer_load_dwordx4 v19, s[12:15], s96 offen lds
    s_add_u32 m0, s88, 12416
    s_mov_b32 s96, 12288
    buffer_load_dwordx4 v19, s[12:15], s96 offen lds
    s_add_u32 m0, s89, 16544
    s_mov_b32 s96, 16384
    buffer_load_dwordx4 v19, s[12:15], s96 offen lds
    s_max_i32 s96, s20, 0
    s_add_u32 m0, s94, 0
    s_mov_b64 exec, s[92:93]
    s_add_u32 s20, s20, 43008
    buffer_load_dwordx4 v20, s[4:7], s96 offen lds
    s_max_i32 s96, s20, 0
    s_addk_i32 m0, 3904
    s_add_u32 s20, s20, 43008
    buffer_load_dwordx4 v20, s[4:7], s96 offen lds
    s_min_i32 s96, s20, s21
    s_addk_i32 m0, 3904
    s_add_u32 s20, s20, 43008
    buffer_load_dwordx4 v20, s[4:7], s96 offen lds
    s_min_i32 s96, s20, s21
    s_addk_i32 m0, 3904
    s_add_u32 s20, s20, 43008
    buffer_load_dwordx4 v20, s[4:7], s96 offen lds
    s_min_i32 s96, s20, s21
    s_addk_i32 m0, 3904
    s_add_u32 s20, s20, 43008
    buffer_load_dwordx4 v20, s[4:7], s96 offen lds
    s_min_i32 s96, s20, s21
    s_addk_i32 m0, 3904
    s_add_u32 s20, s20, 43008
    buffer_load_dwordx4 v20, s[4:7], s96 offen lds
    s_min_i32 s96, s20, s21
    s_addk_i32 m0, 3904
    s_add_u32 s20, s20, 43008
    buffer_load_dwordx4 v20, s[4:7], s96 offen lds
    s_min_i32 s96, s20, s21
    s_addk_i32 m0, 3904
    s_add_u32 s20, s20, 43008
    buffer_load_dwordx4 v20, s[4:7], s96 offen lds
    s_mov_b64 exec, -1
    s_mov_b32 s26, s27
    s_waitcnt vmcnt(13)
    s_call_b64 s[76:77], L_pos
    s_add_u32 m0, s90, 20672
    s_mov_b32 s96, 20480
    buffer_load_dwordx4 v19, s[12:15], s96 offen lds
    s_add_u32 m0, s88, 24832
    s_mov_b32 s96, 24576
    buffer_load_dwordx4 v19, s[12:15], s96 offen lds
    s_add_u32 m0, s89, 28960
    s_mov_b32 s96, 28672
    buffer_load_dwordx4 v19, s[12:15], s96 offen lds
    s_add_u32 m0, s90, 33088
    s_mov_b32 s96, 32768
    buffer_load_dwordx4 v19, s[12:15], s96 offen lds
    s_min_i32 s96, s20, s21
    s_add_u32 m0, s94, 31232
    s_mov_b64 exec, s[92:93]
    s_add_u32 s20, s20, 43008
    buffer_load_dwordx4 v20, s[4:7], s96 offen lds
    s_min_i32 s96, s20, s21
    s_addk_i32 m0, 3904
    s_add_u32 s20, s20, 43008
    buffer_load_dwordx4 v20, s[4:7], s96 offen lds
    s_min_i32 s96, s20, s21
    s_addk_i32 m0, 3904
    s_add_u32 s20, s20, 43008
    buffer_load_dwordx4 v20, s[4:7], s96 offen lds
    s_min_i32 s96, s20, s21
    s_addk_i32 m0, 3904
    s_add_u32 s20, s20, 43008
    buffer_load_dwordx4 v20, s[4:7], s96 offen lds
    s_mov_b64 exec, -1
    s_waitcnt vmcnt(8)
    s_waitcnt lgkmcnt(0)
    s_barrier
    s_min_i32 s96, s20, s21
    s_add_u32 m0, s94, 46848
    s_mov_b64 exec, s[92:93]
    s_add_u32 s20, s20, 43008
    buffer_load_dwordx4 v20, s[4:7], s96 offen lds
    s_min_i32 s96, s20, s21
    s_addk_i32 m0, 3904
    s_add_u32 s20, s20, 43008
    buffer_load_dwordx4 v20, s[4:7], s96 offen lds
    s_min_i32 s96, s20, s21
    s_addk_i32 m0, 3904
    s_add_u32 s20, s20, 43008
    buffer_load_dwordx4 v20, s[4:7], s96 offen lds
    s_mov_b64 exec, -1
    s_add_u32 m0, s88, 37248
    s_mov_b32 s96, 36864
    buffer_load_dwordx4 v19, s[12:15], s96 offen lds
    s_call_b64 s[76:77], L_list2
    s_waitcnt vmcnt(8)
    s_waitcnt lgkmcnt(0)
    s_barrier
    s_add_u32 m0, s89, 41376
    s_mov_b32 s96, 40960
    buffer_load_dwordx4 v19, s[12:15], s96 offen lds
    s_add_u32 m0, s90, 45504
    s_mov_b32 s96, 45056
    buffer_load_dwordx4 v19, s[12:15], s96 offen lds
    s_add_u32 m0, s88, 49664
    s_mov_b32 s96, 49152
    buffer_load_dwordx4 v19, s[12:15], s96 offen lds
    s_add_u32 m0, s89, 53792
    s_mov_b32 s96, 53248
    buffer_load_dwordx4 v19, s[12:15], s96 offen lds
    s_add_u32 m0, s90, 57920
    s_mov_b32 s96, 57344
    buffer_load_dwordx4 v19, s[12:15], s96 offen lds
    s_add_u32 m0, s88, 62080
    s_mov_b32 s96, 61440
    buffer_load_dwordx4 v19, s[12:15], s96 offen lds
    s_add_u32 m0, s89, 66208
    s_mov_b32 s96, 65536
    buffer_load_dwordx4 v19, s[12:15], s96 offen lds
    s_add_u32 m0, s90, 70336
    s_mov_b32 s96, 69632
    buffer_load_dwordx4 v19, s[12:15], s96 offen lds
    s_waitcnt vmcnt(4)
    s_branch L_first
L_startA:
    s_bitcmp1_b32 s23, 19
    s_cbranch_scc1 L_startAH
    s_lshr_b32 s96, s2, 3
    s_and_b32 s96, s96, 31
    s_lshl_b32 s96, s96, 2
    s_add_u32 s96, s96, s28
    s_mul_i32 s96, s96, 1152
    s_add_u32 s96, s96, 18432
    v_lshlrev_b32 v23, 3, v16
    s_mov_b64 exec, 0x1ff
    buffer_load_dword v23, v23, s[12:15], s96 offen
    s_mov_b64 exec, -1
    s_waitcnt vmcnt(1)
    s_call_b64 s[76:77], L_pos
    s_call_b64 s[76:77], L_list2
    s_branch L_first
L_startBH:
    s_movk_i32 s97, 223
    v_add_u32 v74, s34, v76
    v_subrev_u32 v75, s100, v76
    v_med3_i32 v74, v74, 0, s97
    v_cmp_ge_u32 vcc, s101, v75
    v_mul_u32_u24 v74, 192, v74
    s_and_b64 s[92:93], s[92:93], vcc
    v_add_u32 v20, v74, v20
    s_max_i32 s96, s20, 0
    s_add_u32 m0, s94, 0
    s_mov_b64 exec, s[92:93]
    s_add_u32 s20, s20, 43008
    buffer_load_dwordx4 v20, s[4:7], s96 offen lds
    s_max_i32 s96, s20, 0
    s_addk_i32 m0, 3904
    s_add_u32 s20, s20, 43008
    buffer_load_dwordx4 v20, s[4:7], s96 offen lds
    s_min_i32 s96, s20, s21
    s_addk_i32 m0, 3904
    s_add_u32 s20, s20, 43008
    buffer_load_dwordx4 v20, s[4:7], s96 offen lds
    s_min_i32 s96, s20, s21
    s_addk_i32 m0, 3904
    s_add_u32 s20, s20, 43008
    buffer_load_dwordx4 v20, s[4:7], s96 offen lds
    s_min_i32 s96, s20, s21
    s_addk_i32 m0, 3904
    s_add_u32 s20, s20, 43008
    buffer_load_dwordx4 v20, s[4:7], s96 offen lds
    s_min_i32 s96, s20, s21
    s_addk_i32 m0, 3904
    s_add_u32 s20, s20, 43008
    buffer_load_dwordx4 v20, s[4:7], s96 offen lds
    s_min_i32 s96, s20, s21
    s_addk_i32 m0, 3904
    s_add_u32 s20, s20, 43008
    buffer_load_dwordx4 v20, s[4:7], s96 offen lds
    s_min_i32 s96, s20, s21
    s_addk_i32 m0, 3904
    s_add_u32 s20, s20, 43008
    buffer_load_dwordx4 v20, s[4:7], s96 offen lds
    s_mov_b64 exec, -1
    s_mov_b32 s26, s27
    s_waitcnt vmcnt(8)
    s_call_b64 s[76:77], L_pos
    s_min_i32 s96, s20, s21
    s_add_u32 m0, s94, 31232
    s_mov_b64 exec, s[92:93]
    s_add_u32 s20, s20, 43008
    buffer_load_dwordx4 v20, s[4:7], s96 offen lds
    s_min_i32 s96, s20, s21
    s_addk_i32 m0, 3904
    s_add_u32 s20, s20, 43008
    buffer_load_dwordx4 v20, s[4:7], s96 offen lds
    s_min_i32 s96, s20, s21
    s_addk_i32 m0, 3904
    s_add_u32 s20, s20, 43008
    buffer_load_dwordx4 v20, s[4:7], s96 offen lds
    s_min_i32 s96, s20, s21
    s_addk_i32 m0, 3904
    s_add_u32 s20, s20, 43008
    buffer_load_dwordx4 v20, s[4:7], s96 offen lds
    s_min_i32 s96, s20, s21
    s_addk_i32 m0, 3904
    s_add_u32 s20, s20, 43008
    buffer_load_dwordx4 v20, s[4:7], s96 offen lds
    s_mov_b64 exec, -1
    s_waitcnt vmcnt(5)
    s_waitcnt lgkmcnt(0)
    s_barrier
    s_call_b64 s[76:77], L_list2
    s_min_i32 s96, s20, s21
    s_add_u32 m0, s94, 50752
    s_mov_b64 exec, s[92:93]
    s_add_u32 s20, s20, 43008
    buffer_load_dwordx4 v20, s[4:7], s96 offen lds
    s_min_i32 s96, s20, s21
    s_addk_i32 m0, 3904
    s_add_u32 s20, s20, 43008
    buffer_load_dwordx4 v20, s[4:7], s96 offen lds
    s_mov_b64 exec, -1
    s_add_u32 m0, s88, 37248
    s_mov_b32 s96, 36864
    buffer_load_dwordx4 v19, s[12:15], s96 offen lds
    s_add_u32 m0, s89, 41376
    s_mov_b32 s96, 40960
    buffer_load_dwordx4 v19, s[12:15], s96 offen lds
    s_add_u32 m0, s90, 45504
    s_mov_b32 s96, 45056
    buffer_load_dwordx4 v19, s[12:15], s96 offen lds
    s_add_u32 m0, s88, 49664
    s_mov_b32 s96, 49152
    buffer_load_dwordx4 v19, s[12:15], s96 offen lds
    s_add_u32 m0, s89, 53792
    s_mov_b32 s96, 53248
    buffer_load_dwordx4 v19, s[12:15], s96 offen lds
    s_waitcnt vmcnt(12)
    s_waitcnt lgkmcnt(0)
    s_barrier
    s_add_u32 m0, s90, 57920
    s_mov_b32 s96, 57344
    buffer_load_dwordx4 v19, s[12:15], s96 offen lds
    s_add_u32 m0, s88, 62080
    s_mov_b32 s96, 61440
    buffer_load_dwordx4 v19, s[12:15], s96 offen lds
    s_add_u32 m0, s89, 66208
    s_mov_b32 s96, 65536
    buffer_load_dwordx4 v19, s[12:15], s96 offen lds
    s_add_u32 m0, s90, 70336
    s_mov_b32 s96, 69632
    buffer_load_dwordx4 v19, s[12:15], s96 offen lds
    s_waitcnt vmcnt(4)
    s_branch L_first
L_startAH:
    s_add_u32 m0, s88, 0
    s_mov_b32 s96, 0
    buffer_load_dwordx4 v19, s[12:15], s96 offen lds
    s_add_u32 m0, s89, 4128
    s_mov_b32 s96, 4096
    buffer_load_dwordx4 v19, s[12:15], s96 offen lds
    s_add_u32 m0, s90, 8256
    s_mov_b32 s96, 8192
    buffer_load_dwordx4 v19, s[12:15], s96 offen lds
    s_add_u32 m0, s88, 12416
    s_mov_b32 s96, 12288
    buffer_load_dwordx4 v19, s[12:15], s96 offen lds
    s_add_u32 m0, s89, 16544
    s_mov_b32 s96, 16384
    buffer_load_dwordx4 v19, s[12:15], s96 offen lds
    s_lshr_b32 s96, s2, 3
    s_and_b32 s96, s96, 31
    s_lshl_b32 s96, s96, 2
    s_add_u32 s96, s96, s28
    s_mul_i32 s96, s96, 1152
    s_add_u32 s96, s96, 18432
    v_lshlrev_b32 v23, 3, v16
    s_mov_b64 exec, 0x1ff
    buffer_load_dword v23, v23, s[12:15], s96 offen
    s_mov_b64 exec, -1
    s_waitcnt vmcnt(6)
    s_call_b64 s[76:77], L_pos
    s_call_b64 s[76:77], L_list2
    s_add_u32 m0, s90, 20672
    s_mov_b32 s96, 20480
    buffer_load_dwordx4 v19, s[12:15], s96 offen lds
    s_add_u32 m0, s88, 24832
    s_mov_b32 s96, 24576
    buffer_load_dwordx4 v19, s[12:15], s96 offen lds
    s_add_u32 m0, s89, 28960
    s_mov_b32 s96, 28672
    buffer_load_dwordx4 v19, s[12:15], s96 offen lds
    s_add_u32 m0, s90, 33088
    s_mov_b32 s96, 32768
    buffer_load_dwordx4 v19, s[12:15], s96 offen lds
    s_waitcnt vmcnt(4)
    s_branch L_first
L_list2:
    s_cmp_eq_u32 s38, 1
    s_cbranch_scc1 L_list3
    s_setpc_b64 s[76:77]
L_pos:
    s_cmp_lg_u32 s75, 0
    s_cbranch_scc1 L_exact0
    s_mov_b32 s64, 0x7fff7fff
    v_and_b32 v74, s64, v204
    s_sub_u32 s96, s0, s33
    v_and_b32 v75, s64, v205
    s_mul_i32 s97, s29, 96
    v_pk_max_u16 v72, v74, s26
    s_sub_u32 s96, s96, 1
    v_pk_max_u16 v73, v75, s26
    s_add_u32 s98, s97, 89280
    v_and_b32 v74, s64, v206
    s_mul_i32 s96, s96, 3904
    v_and_b32 v75, s64, v208
    v_add_u32_sdwa v4, s98, v240 dst_sel:DWORD dst_unused:UNUSED_PAD src0_sel:DWORD src1_sel:WORD_0
    v_pk_max_u16 v72, v74, v72
    v_add_u32_sdwa v5, s98, v240 dst_sel:DWORD dst_unused:UNUSED_PAD src0_sel:DWORD src1_sel:WORD_0
    v_pk_max_u16 v73, v75, v73
    s_bfe_u32 s98, s23, 0x40014
    v_and_b32 v74, s64, v209
    v_add_u32_sdwa v1, s96, v240 dst_sel:DWORD dst_unused:UNUSED_PAD src0_sel:DWORD src1_sel:WORD_1
    v_and_b32 v75, s64, v210
    v_add_u32_sdwa v2, s96, v241 dst_sel:DWORD dst_unused:UNUSED_PAD src0_sel:DWORD src1_sel:WORD_0
    v_pk_max_u16 v72, v74, v72
    v_add_u32_sdwa v3, s96, v241 dst_sel:DWORD dst_unused:UNUSED_PAD src0_sel:DWORD src1_sel:WORD_1
    v_pk_max_u16 v73, v75, v73
    s_mul_i32 s98, s98, 3904
    v_and_b32 v74, s64, v212
    s_sub_u32 s98, 107904, s98
    v_and_b32 v75, s64, v213
    s_cmp_lt_u32 s28, 4
    v_pk_max_u16 v72, v74, v72
    s_cselect_b32 s98, 0, s98
    v_pk_max_u16 v73, v75, v73
    s_mul_i32 s96, s31, 3904
    v_and_b32 v74, s64, v214
    s_add_u32 s96, s96, s98
    v_and_b32 v75, s64, v216
    s_add_u32 s97, s97, s96
    v_pk_max_u16 v72, v74, v72
    v_add_u32_sdwa v21, s97, v242 dst_sel:DWORD dst_unused:UNUSED_PAD src0_sel:DWORD src1_sel:WORD_0
    v_pk_max_u16 v73, v75, v73
    s_mul_i32 s97, s29, 3904
    v_and_b32 v74, s64, v217
    s_add_u32 s97, s97, s96
    v_and_b32 v75, s64, v218
    v_add_u32_sdwa v248, s97, v242 dst_sel:DWORD dst_unused:UNUSED_PAD src0_sel:DWORD src1_sel:WORD_1
    v_pk_max_u16 v72, v74, v72
    v_add_u32_sdwa v249, s97, v243 dst_sel:DWORD dst_unused:UNUSED_PAD src0_sel:DWORD src1_sel:WORD_0
    v_pk_max_u16 v73, v75, v73
    v_add_u32_sdwa v250, s97, v243 dst_sel:DWORD dst_unused:UNUSED_PAD src0_sel:DWORD src1_sel:WORD_1
    v_pk_max_u16 v72, v72, v73
    s_mov_b32 exec_hi, 0xffff
    v_cmp_ne_u32 vcc, s26, v72
    s_mov_b32 exec_hi, -1
    s_cbranch_vccnz L_exact
    s_setpc_b64 s[76:77]
.p2align 12
L_first:
    s_waitcnt lgkmcnt(0)
    s_or_b32 s3, s37, s39
    s_or_b32 s3, s3, s99
    s_or_b32 s3, s3, 512
    s_cmp_lg_u32 s38, 0
    s_cbranch_scc1 L_first2
    s_barrier
L_nfirst:
    ds_read_b128 v[108:111], v1 offset:0
    ds_read_b64_tr_b16 v[72:73], v5 offset:0
    ds_read_b64_tr_b16 v[74:75], v5 offset:768
    ds_read_b64_tr_b16 v[76:77], v5 offset:32
    ds_read_b64_tr_b16 v[78:79], v5 offset:800
    ds_read_b64_tr_b16 v[80:81], v5 offset:64
    ds_read_b64_tr_b16 v[82:83], v5 offset:832
    ds_read_b128 v[112:115], v1 offset:3904
    ds_read_b128 v[116:119], v1 offset:7808
    ds_read_b128 v[120:123], v1 offset:11712
    s_cmp_eq_u32 s30, 4
    s_cbranch_scc0 L_nf3
    s_waitcnt lgkmcnt(7)
    v_mfma_f32_16x16x32_bf16 v[24:27], v[72:75], v[108:111], v[24:27]
    ds_read_b64_tr_b16 v[84:85], v5 offset:6208
    ds_read_b64_tr_b16 v[86:87], v5 offset:6976
    s_waitcnt lgkmcnt(7)
    v_mfma_f32_16x16x32_bf16 v[28:31], v[76:79], v[108:111], v[28:31]
    ds_read_b64_tr_b16 v[88:89], v5 offset:6240
    ds_read_b64_tr_b16 v[90:91], v5 offset:7008
    s_waitcnt lgkmcnt(7)
    v_mfma_f32_16x16x32_bf16 v[32:35], v[80:83], v[108:111], v[32:35]
    ds_read_b64_tr_b16 v[92:93], v5 offset:6272
    ds_read_b64_tr_b16 v[94:95], v5 offset:7040
    s_waitcnt lgkmcnt(8)
    v_mfma_f32_16x16x32_bf16 v[44:47], v[80:83], v[112:115], v[44:47]
    ds_read_b128 v[124:127], v1 offset:64
    ds_read_b128 v[128:131], v1 offset:3968
    v_mfma_f32_16x16x32_bf16 v[40:43], v[76:79], v[112:115], v[40:43]
    ds_read_b128 v[132:135], v1 offset:7872
    ds_read_b128 v[136:139], v1 offset:11776
    v_mfma_f32_16x16x32_bf16 v[36:39], v[72:75], v[112:115], v[36:39]
    ds_read_b128 v[140:143], v1 offset:128
    ds_read_b128 v[144:147], v1 offset:4032
    s_waitcnt lgkmcnt(13)
    v_mfma_f32_16x16x32_bf16 v[48:51], v[72:75], v[116:119], v[48:51]
    ds_read_b128 v[148:151], v1 offset:7936
    ds_read_b128 v[152:155], v1 offset:11840
    v_mfma_f32_16x16x32_bf16 v[52:55], v[76:79], v[116:119], v[52:55]
    ds_read_b64_tr_b16 v[96:97], v5 offset:12416
    ds_read_b64_tr_b16 v[98:99], v5 offset:13184
    v_mfma_f32_16x16x32_bf16 v[56:59], v[80:83], v[116:119], v[56:59]
    ds_read_b64_tr_b16 v[100:101], v5 offset:12448
    ds_read_b64_tr_b16 v[102:103], v5 offset:13216
    s_waitcnt lgkmcnt(15)
    v_mfma_f32_16x16x32_bf16 v[68:71], v[80:83], v[120:123], v[68:71]
    ds_read_b64_tr_b16 v[104:105], v5 offset:12480
    ds_read_b64_tr_b16 v[106:107], v5 offset:13248
    v_mfma_f32_16x16x32_bf16 v[64:67], v[76:79], v[120:123], v[64:67]
    v_mfma_f32_16x16x32_bf16 v[60:63], v[72:75], v[120:123], v[60:63]
    s_add_u32 s35, s35, 1
    v_add_u32 v17, 3904, v1
    s_and_b32 s36, s35, 3
    v_mov_b32 v1, v2
    s_mul_i32 s36, s36, 18624
    v_mov_b32 v2, v3
    v_mov_b32 v3, v17
    v_add_u32 v5, s36, v4
    s_branch L_end4
L_nf3:
    s_cmp_eq_u32 s30, 3
    s_cbranch_scc0 L_nf2
    s_waitcnt lgkmcnt(7)
    v_mfma_f32_16x16x32_bf16 v[24:27], v[72:75], v[108:111], v[24:27]
    ds_read_b64_tr_b16 v[84:85], v5 offset:6208
    ds_read_b64_tr_b16 v[86:87], v5 offset:6976
    s_waitcnt lgkmcnt(7)
    v_mfma_f32_16x16x32_bf16 v[28:31], v[76:79], v[108:111], v[28:31]
    ds_read_b64_tr_b16 v[88:89], v5 offset:6240
    ds_read_b64_tr_b16 v[90:91], v5 offset:7008
    s_waitcnt lgkmcnt(7)
    v_mfma_f32_16x16x32_bf16 v[32:35], v[80:83], v[108:111], v[32:35]
    ds_read_b64_tr_b16 v[92:93], v5 offset:6272
    ds_read_b64_tr_b16 v[94:95], v5 offset:7040
    s_waitcnt lgkmcnt(8)
    v_mfma_f32_16x16x32_bf16 v[44:47], v[80:83], v[112:115], v[44:47]
    ds_read_b128 v[124:127], v1 offset:64
    ds_read_b128 v[128:131], v1 offset:3968
    v_mfma_f32_16x16x32_bf16 v[40:43], v[76:79], v[112:115], v[40:43]
    ds_read_b128 v[132:135], v1 offset:7872
    ds_read_b128 v[140:143], v1 offset:128
    v_mfma_f32_16x16x32_bf16 v[36:39], v[72:75], v[112:115], v[36:39]
    ds_read_b128 v[144:147], v1 offset:4032
    ds_read_b128 v[148:151], v1 offset:7936
    s_waitcnt lgkmcnt(13)
    v_mfma_f32_16x16x32_bf16 v[48:51], v[72:75], v[116:119], v[48:51]
    ds_read_b64_tr_b16 v[96:97], v5 offset:12416
    ds_read_b64_tr_b16 v[98:99], v5 offset:13184
    v_mfma_f32_16x16x32_bf16 v[52:55], v[76:79], v[116:119], v[52:55]
    ds_read_b64_tr_b16 v[100:101], v5 offset:12448
    ds_read_b64_tr_b16 v[102:103], v5 offset:13216
    v_mfma_f32_16x16x32_bf16 v[56:59], v[80:83], v[116:119], v[56:59]
    ds_read_b64_tr_b16 v[104:105], v5 offset:12480
    ds_read_b64_tr_b16 v[106:107], v5 offset:13248
    s_add_u32 s35, s35, 1
    v_add_u32 v17, 3904, v1
    s_and_b32 s36, s35, 3
    v_mov_b32 v1, v2
    s_mul_i32 s36, s36, 18624
    v_mov_b32 v2, v3
    v_mov_b32 v3, v17
    v_add_u32 v5, s36, v4
    s_branch L_end3
.p2align 3
L_top4:
    s_barrier
L_body4:
    s_setprio 2
.p2align 3
    v_mfma_f32_16x16x32_bf16 v[24:27], v[84:87], v[124:127], v[24:27]
    ds_read_b128 v[108:111], v1 offset:0
    v_mfma_f32_16x16x32_bf16 v[28:31], v[88:91], v[124:127], v[28:31]
    ds_read_b64_tr_b16 v[72:73], v5 offset:0
    v_mfma_f32_16x16x32_bf16 v[32:35], v[92:95], v[124:127], v[32:35]
    ds_read_b64_tr_b16 v[74:75], v5 offset:768
    v_mfma_f32_16x16x32_bf16 v[44:47], v[92:95], v[128:131], v[44:47]
    ds_read_b64_tr_b16 v[76:77], v5 offset:32
    v_mfma_f32_16x16x32_bf16 v[40:43], v[88:91], v[128:131], v[40:43]
    ds_read_b64_tr_b16 v[78:79], v5 offset:800
    v_mfma_f32_16x16x32_bf16 v[36:39], v[84:87], v[128:131], v[36:39]
    ds_read_b64_tr_b16 v[80:81], v5 offset:64
    v_mfma_f32_16x16x32_bf16 v[48:51], v[84:87], v[132:135], v[48:51]
    ds_read_b64_tr_b16 v[82:83], v5 offset:832
    v_mfma_f32_16x16x32_bf16 v[52:55], v[88:91], v[132:135], v[52:55]
    ds_read_b128 v[112:115], v1 offset:3904
    v_mfma_f32_16x16x32_bf16 v[56:59], v[92:95], v[132:135], v[56:59]
    ds_read_b128 v[116:119], v1 offset:7808
    v_mfma_f32_16x16x32_bf16 v[68:71], v[92:95], v[136:139], v[68:71]
    ds_read_b128 v[120:123], v1 offset:11712
    v_mfma_f32_16x16x32_bf16 v[64:67], v[88:91], v[136:139], v[64:67]
    v_mfma_f32_16x16x32_bf16 v[60:63], v[84:87], v[136:139], v[60:63]
    s_setprio 1
.p2align 3
    v_mfma_f32_16x16x32_bf16 v[24:27], v[96:99], v[140:143], v[24:27]
    ds_read_b64_tr_b16 v[84:85], v5 offset:6208
    v_mfma_f32_16x16x32_bf16 v[28:31], v[100:103], v[140:143], v[28:31]
    ds_read_b64_tr_b16 v[86:87], v5 offset:6976
    v_mfma_f32_16x16x32_bf16 v[32:35], v[104:107], v[140:143], v[32:35]
    ds_read_b64_tr_b16 v[88:89], v5 offset:6240
    v_mfma_f32_16x16x32_bf16 v[44:47], v[104:107], v[144:147], v[44:47]
    ds_read_b128 v[140:143], v1 offset:128
    v_mfma_f32_16x16x32_bf16 v[40:43], v[100:103], v[144:147], v[40:43]
    ds_read_b64_tr_b16 v[90:91], v5 offset:7008
    v_mfma_f32_16x16x32_bf16 v[36:39], v[96:99], v[144:147], v[36:39]
    ds_read_b64_tr_b16 v[92:93], v5 offset:6272
    v_mfma_f32_16x16x32_bf16 v[48:51], v[96:99], v[148:151], v[48:51]
    ds_read_b128 v[144:147], v1 offset:4032
    v_mfma_f32_16x16x32_bf16 v[52:55], v[100:103], v[148:151], v[52:55]
    ds_read_b64_tr_b16 v[94:95], v5 offset:7040
    v_mfma_f32_16x16x32_bf16 v[56:59], v[104:107], v[148:151], v[56:59]
    ds_read_b128 v[124:127], v1 offset:64
    v_mfma_f32_16x16x32_bf16 v[68:71], v[104:107], v[152:155], v[68:71]
    ds_read_b128 v[148:151], v1 offset:7936
    ds_read_b128 v[128:131], v1 offset:3968
    v_mfma_f32_16x16x32_bf16 v[64:67], v[100:103], v[152:155], v[64:67]
    ds_read_b128 v[132:135], v1 offset:7872
    v_mfma_f32_16x16x32_bf16 v[60:63], v[96:99], v[152:155], v[60:63]
    ds_read_b128 v[136:139], v1 offset:11776
    ds_read_b128 v[152:155], v1 offset:11840
L_mid4:
    s_waitcnt lgkmcnt(14)
    s_setprio 0
.p2align 3
    v_mfma_f32_16x16x32_bf16 v[24:27], v[72:75], v[108:111], v[24:27]
    ds_read_b64_tr_b16 v[96:97], v5 offset:12416
    v_mfma_f32_16x16x32_bf16 v[28:31], v[76:79], v[108:111], v[28:31]
    ds_read_b64_tr_b16 v[98:99], v5 offset:13184
    v_mfma_f32_16x16x32_bf16 v[32:35], v[80:83], v[108:111], v[32:35]
    ds_read_b64_tr_b16 v[100:101], v5 offset:12448
    v_mfma_f32_16x16x32_bf16 v[44:47], v[80:83], v[112:115], v[44:47]
    ds_read_b64_tr_b16 v[102:103], v5 offset:13216
    v_mfma_f32_16x16x32_bf16 v[40:43], v[76:79], v[112:115], v[40:43]
    ds_read_b64_tr_b16 v[104:105], v5 offset:12480
    v_mfma_f32_16x16x32_bf16 v[36:39], v[72:75], v[112:115], v[36:39]
    ds_read_b64_tr_b16 v[106:107], v5 offset:13248
    v_mfma_f32_16x16x32_bf16 v[48:51], v[72:75], v[116:119], v[48:51]
    s_add_u32 s35, s35, 1
    v_add_u32 v17, 3904, v1
    v_mfma_f32_16x16x32_bf16 v[52:55], v[76:79], v[116:119], v[52:55]
    s_and_b32 s36, s35, 3
    v_mov_b32 v1, v2
    v_mfma_f32_16x16x32_bf16 v[56:59], v[80:83], v[116:119], v[56:59]
    s_mul_i32 s36, s36, 18624
    v_mov_b32 v2, v3
    v_mfma_f32_16x16x32_bf16 v[68:71], v[80:83], v[120:123], v[68:71]
    v_mov_b32 v3, v17
    v_add_u32 v5, s36, v4
    v_mfma_f32_16x16x32_bf16 v[64:67], v[76:79], v[120:123], v[64:67]
    v_mfma_f32_16x16x32_bf16 v[60:63], v[72:75], v[120:123], v[60:63]
L_end4:
    s_bitcmp1_b32 s3, s35
    s_waitcnt vmcnt(0) lgkmcnt(0)
    s_cbranch_scc0 L_top4
    s_bitcmp1_b32 s99, s35
    s_cbranch_scc1 L_sp4
    s_barrier
    s_bitcmp1_b32 s39, s35
    s_cbranch_scc0 L_sp4
    s_call_b64 s[76:77], L_dma
L_sp4:
    s_bitcmp1_b32 s37, s35
    s_cbranch_scc1 L_g4
    s_cmp_lg_u32 s35, 9
    s_cbranch_scc1 L_body4
L_last4:
    s_setprio 3
    v_mfma_f32_16x16x32_bf16 v[24:27], v[84:87], v[124:127], v[24:27]
    s_add_u32 s96, s0, s29
    s_mul_i32 s96, s96, 224
    s_add_u32 s96, s96, s32
    v_mfma_f32_16x16x32_bf16 v[28:31], v[88:91], v[124:127], v[28:31]
    s_mul_i32 s96, s96, 192
    s_add_u32 s97, s96, 86016
    s_add_u32 s98, s29, 2
    v_mfma_f32_16x16x32_bf16 v[32:35], v[92:95], v[124:127], v[32:35]
    v_mfma_f32_16x16x32_bf16 v[24:27], v[96:99], v[140:143], v[24:27]
    v_mfma_f32_16x16x32_bf16 v[28:31], v[100:103], v[140:143], v[28:31]
    v_mfma_f32_16x16x32_bf16 v[32:35], v[104:107], v[140:143], v[32:35]
    v_mfma_f32_16x16x32_bf16 v[36:39], v[84:87], v[128:131], v[36:39]
    v_mfma_f32_16x16x32_bf16 v[40:43], v[88:91], v[128:131], v[40:43]
    v_mfma_f32_16x16x32_bf16 v[44:47], v[92:95], v[128:131], v[44:47]
    s_nop 2
    v_cvt_pk_bf16_f32 v156, v24, v25
    v_cvt_pk_bf16_f32 v157, v26, v27
    ds_write_b64 v21, v[156:157] offset:0
    v_mfma_f32_16x16x32_bf16 v[36:39], v[96:99], v[144:147], v[36:39]
    v_cvt_pk_bf16_f32 v158, v28, v29
    v_cvt_pk_bf16_f32 v159, v30, v31
    ds_write_b64 v21, v[158:159] offset:32
    v_mfma_f32_16x16x32_bf16 v[40:43], v[100:103], v[144:147], v[40:43]
    v_cvt_pk_bf16_f32 v160, v32, v33
    v_cvt_pk_bf16_f32 v161, v34, v35
    ds_write_b64 v21, v[160:161] offset:64
    v_mfma_f32_16x16x32_bf16 v[44:47], v[104:107], v[144:147], v[44:47]
    v_mfma_f32_16x16x32_bf16 v[48:51], v[84:87], v[132:135], v[48:51]
    v_mfma_f32_16x16x32_bf16 v[52:55], v[88:91], v[132:135], v[52:55]
    v_mfma_f32_16x16x32_bf16 v[56:59], v[92:95], v[132:135], v[56:59]
    v_cvt_pk_bf16_f32 v162, v36, v37
    v_cvt_pk_bf16_f32 v163, v38, v39
    ds_write_b64 v21, v[162:163] offset:3904
    v_mfma_f32_16x16x32_bf16 v[48:51], v[96:99], v[148:151], v[48:51]
    v_cvt_pk_bf16_f32 v164, v40, v41
    v_cvt_pk_bf16_f32 v165, v42, v43
    ds_write_b64 v21, v[164:165] offset:3936
    v_mfma_f32_16x16x32_bf16 v[52:55], v[100:103], v[148:151], v[52:55]
    v_cvt_pk_bf16_f32 v166, v44, v45
    v_cvt_pk_bf16_f32 v167, v46, v47
    ds_write_b64 v21, v[166:167] offset:3968
    v_mfma_f32_16x16x32_bf16 v[56:59], v[104:107], v[148:151], v[56:59]
    v_mov_b32 v17, 1
    ds_write_b32 v254, v17
    v_mfma_f32_16x16x32_bf16 v[60:63], v[84:87], v[136:139], v[60:63]
    v_mfma_f32_16x16x32_bf16 v[64:67], v[88:91], v[136:139], v[64:67]
    v_mfma_f32_16x16x32_bf16 v[68:71], v[92:95], v[136:139], v[68:71]
    v_cvt_pk_bf16_f32 v168, v48, v49
    v_cvt_pk_bf16_f32 v169, v50, v51
    ds_write_b64 v21, v[168:169] offset:7808
    v_mfma_f32_16x16x32_bf16 v[60:63], v[96:99], v[152:155], v[60:63]
    v_cvt_pk_bf16_f32 v170, v52, v53
    v_cvt_pk_bf16_f32 v171, v54, v55
    ds_write_b64 v21, v[170:171] offset:7840
    v_mfma_f32_16x16x32_bf16 v[64:67], v[100:103], v[152:155], v[64:67]
    v_cvt_pk_bf16_f32 v172, v56, v57
    v_cvt_pk_bf16_f32 v173, v58, v59
    ds_write_b64 v21, v[172:173] offset:7872
    v_mfma_f32_16x16x32_bf16 v[68:71], v[104:107], v[152:155], v[68:71]
    v_cvt_pk_bf16_f32 v174, v60, v61
    v_cvt_pk_bf16_f32 v175, v62, v63
    ds_write_b64 v21, v[174:175] offset:11712
    s_nop 0
    v_cvt_pk_bf16_f32 v176, v64, v65
    v_cvt_pk_bf16_f32 v177, v66, v67
    ds_write_b64 v21, v[176:177] offset:11744
    s_nop 0
    v_cvt_pk_bf16_f32 v178, v68, v69
    v_cvt_pk_bf16_f32 v179, v70, v71
    ds_write_b64 v21, v[178:179] offset:11776
    s_branch L_epi
.p2align 3
L_top3:
    s_barrier
L_body3:
    s_setprio 2
.p2align 3
    v_mfma_f32_16x16x32_bf16 v[24:27], v[84:87], v[124:127], v[24:27]
    ds_read_b128 v[108:111], v1 offset:0
    v_mfma_f32_16x16x32_bf16 v[28:31], v[88:91], v[124:127], v[28:31]
    ds_read_b64_tr_b16 v[72:73], v5 offset:0
    v_mfma_f32_16x16x32_bf16 v[32:35], v[92:95], v[124:127], v[32:35]
    ds_read_b64_tr_b16 v[74:75], v5 offset:768
    v_mfma_f32_16x16x32_bf16 v[44:47], v[92:95], v[128:131], v[44:47]
    ds_read_b64_tr_b16 v[76:77], v5 offset:32
    v_mfma_f32_16x16x32_bf16 v[40:43], v[88:91], v[128:131], v[40:43]
    ds_read_b64_tr_b16 v[78:79], v5 offset:800
    v_mfma_f32_16x16x32_bf16 v[36:39], v[84:87], v[128:131], v[36:39]
    ds_read_b64_tr_b16 v[80:81], v5 offset:64
    v_mfma_f32_16x16x32_bf16 v[48:51], v[84:87], v[132:135], v[48:51]
    ds_read_b64_tr_b16 v[82:83], v5 offset:832
    v_mfma_f32_16x16x32_bf16 v[52:55], v[88:91], v[132:135], v[52:55]
    ds_read_b128 v[112:115], v1 offset:3904
    v_mfma_f32_16x16x32_bf16 v[56:59], v[92:95], v[132:135], v[56:59]
    ds_read_b128 v[116:119], v1 offset:7808
    s_setprio 1
.p2align 3
    v_mfma_f32_16x16x32_bf16 v[24:27], v[96:99], v[140:143], v[24:27]
    ds_read_b64_tr_b16 v[84:85], v5 offset:6208
    v_mfma_f32_16x16x32_bf16 v[28:31], v[100:103], v[140:143], v[28:31]
    ds_read_b64_tr_b16 v[86:87], v5 offset:6976
    v_mfma_f32_16x16x32_bf16 v[32:35], v[104:107], v[140:143], v[32:35]
    ds_read_b64_tr_b16 v[88:89], v5 offset:6240
    v_mfma_f32_16x16x32_bf16 v[44:47], v[104:107], v[144:147], v[44:47]
    ds_read_b128 v[140:143], v1 offset:128
    ds_read_b64_tr_b16 v[90:91], v5 offset:7008
    v_mfma_f32_16x16x32_bf16 v[40:43], v[100:103], v[144:147], v[40:43]
    ds_read_b64_tr_b16 v[92:93], v5 offset:6272
    v_mfma_f32_16x16x32_bf16 v[36:39], v[96:99], v[144:147], v[36:39]
    ds_read_b64_tr_b16 v[94:95], v5 offset:7040
    v_mfma_f32_16x16x32_bf16 v[48:51], v[96:99], v[148:151], v[48:51]
    ds_read_b128 v[144:147], v1 offset:4032
    ds_read_b128 v[124:127], v1 offset:64
    v_mfma_f32_16x16x32_bf16 v[52:55], v[100:103], v[148:151], v[52:55]
    ds_read_b128 v[128:131], v1 offset:3968
    v_mfma_f32_16x16x32_bf16 v[56:59], v[104:107], v[148:151], v[56:59]
    ds_read_b128 v[132:135], v1 offset:7872
    ds_read_b128 v[148:151], v1 offset:7936
L_mid3:
    s_waitcnt lgkmcnt(12)
    s_setprio 0
.p2align 3
    v_mfma_f32_16x16x32_bf16 v[24:27], v[72:75], v[108:111], v[24:27]
    ds_read_b64_tr_b16 v[96:97], v5 offset:12416
    v_mfma_f32_16x16x32_bf16 v[28:31], v[76:79], v[108:111], v[28:31]
    ds_read_b64_tr_b16 v[98:99], v5 offset:13184
    v_mfma_f32_16x16x32_bf16 v[32:35], v[80:83], v[108:111], v[32:35]
    ds_read_b64_tr_b16 v[100:101], v5 offset:12448
    v_mfma_f32_16x16x32_bf16 v[44:47], v[80:83], v[112:115], v[44:47]
    ds_read_b64_tr_b16 v[102:103], v5 offset:13216
    v_mfma_f32_16x16x32_bf16 v[40:43], v[76:79], v[112:115], v[40:43]
    ds_read_b64_tr_b16 v[104:105], v5 offset:12480
    v_mfma_f32_16x16x32_bf16 v[36:39], v[72:75], v[112:115], v[36:39]
    ds_read_b64_tr_b16 v[106:107], v5 offset:13248
    v_mfma_f32_16x16x32_bf16 v[48:51], v[72:75], v[116:119], v[48:51]
    s_add_u32 s35, s35, 1
    v_add_u32 v17, 3904, v1
    v_mfma_f32_16x16x32_bf16 v[52:55], v[76:79], v[116:119], v[52:55]
    s_and_b32 s36, s35, 3
    v_mov_b32 v1, v2
    v_mfma_f32_16x16x32_bf16 v[56:59], v[80:83], v[116:119], v[56:59]
    s_mul_i32 s36, s36, 18624
    v_mov_b32 v2, v3
    v_mov_b32 v3, v17
    v_add_u32 v5, s36, v4
L_end3:
    s_bitcmp1_b32 s3, s35
    s_waitcnt vmcnt(0) lgkmcnt(0)
    s_cbranch_scc0 L_top3
    s_bitcmp1_b32 s99, s35
    s_cbranch_scc1 L_sp3
    s_barrier
    s_bitcmp1_b32 s39, s35
    s_cbranch_scc0 L_sp3
    s_call_b64 s[76:77], L_dma
L_sp3:
    s_bitcmp1_b32 s37, s35
    s_cbranch_scc1 L_g3
    s_cmp_lg_u32 s35, 9
    s_cbranch_scc1 L_body3
L_last3:
    s_setprio 3
    v_mfma_f32_16x16x32_bf16 v[24:27], v[84:87], v[124:127], v[24:27]
    s_add_u32 s96, s0, s29
    s_mul_i32 s96, s96, 224
    s_add_u32 s96, s96, s32
    v_mfma_f32_16x16x32_bf16 v[28:31], v[88:91], v[124:127], v[28:31]
    s_mul_i32 s96, s96, 192
    s_add_u32 s97, s96, 86016
    s_add_u32 s98, s29, 2
    v_mfma_f32_16x16x32_bf16 v[32:35], v[92:95], v[124:127], v[32:35]
    v_mfma_f32_16x16x32_bf16 v[24:27], v[96:99], v[140:143], v[24:27]
    v_mfma_f32_16x16x32_bf16 v[28:31], v[100:103], v[140:143], v[28:31]
    v_mfma_f32_16x16x32_bf16 v[32:35], v[104:107], v[140:143], v[32:35]
    v_mfma_f32_16x16x32_bf16 v[36:39], v[84:87], v[128:131], v[36:39]
    v_mfma_f32_16x16x32_bf16 v[40:43], v[88:91], v[128:131], v[40:43]
    v_mfma_f32_16x16x32_bf16 v[44:47], v[92:95], v[128:131], v[44:47]
    s_nop 2
    v_cvt_pk_bf16_f32 v156, v24, v25
    v_cvt_pk_bf16_f32 v157, v26, v27
    ds_write_b64 v21, v[156:157] offset:0
    v_mfma_f32_16x16x32_bf16 v[36:39], v[96:99], v[144:147], v[36:39]
    v_cvt_pk_bf16_f32 v158, v28, v29
    v_cvt_pk_bf16_f32 v159, v30, v31
    ds_write_b64 v21, v[158:159] offset:32
    v_mfma_f32_16x16x32_bf16 v[40:43], v[100:103], v[144:147], v[40:43]
    v_cvt_pk_bf16_f32 v160, v32, v33
    v_cvt_pk_bf16_f32 v161, v34, v35
    ds_write_b64 v21, v[160:161] offset:64
    v_mfma_f32_16x16x32_bf16 v[44:47], v[104:107], v[144:147], v[44:47]
    v_mfma_f32_16x16x32_bf16 v[48:51], v[84:87], v[132:135], v[48:51]
    v_mfma_f32_16x16x32_bf16 v[52:55], v[88:91], v[132:135], v[52:55]
    v_mfma_f32_16x16x32_bf16 v[56:59], v[92:95], v[132:135], v[56:59]
    v_cvt_pk_bf16_f32 v162, v36, v37
    v_cvt_pk_bf16_f32 v163, v38, v39
    ds_write_b64 v21, v[162:163] offset:3904
    v_mfma_f32_16x16x32_bf16 v[48:51], v[96:99], v[148:151], v[48:51]
    v_cvt_pk_bf16_f32 v164, v40, v41
    v_cvt_pk_bf16_f32 v165, v42, v43
    ds_write_b64 v21, v[164:165] offset:3936
    v_mfma_f32_16x16x32_bf16 v[52:55], v[100:103], v[148:151], v[52:55]
    v_cvt_pk_bf16_f32 v166, v44, v45
    v_cvt_pk_bf16_f32 v167, v46, v47
    ds_write_b64 v21, v[166:167] offset:3968
    v_mfma_f32_16x16x32_bf16 v[56:59], v[104:107], v[148:151], v[56:59]
    v_mov_b32 v17, 1
    ds_write_b32 v254, v17
    v_cvt_pk_bf16_f32 v168, v48, v49
    v_cvt_pk_bf16_f32 v169, v50, v51
    ds_write_b64 v21, v[168:169] offset:7808
    v_cvt_pk_bf16_f32 v170, v52, v53
    v_cvt_pk_bf16_f32 v171, v54, v55
    ds_write_b64 v21, v[170:171] offset:7840
    v_cvt_pk_bf16_f32 v172, v56, v57
    v_cvt_pk_bf16_f32 v173, v58, v59
    ds_write_b64 v21, v[172:173] offset:7872
L_epi:
    v_mov_b32 v17, 2
    ds_write_b32 v254, v17
    s_setprio 0
    s_cmp_ge_u32 s29, s30
    s_cbranch_scc1 L_fin
L_t1:
    ds_read_b32 v236, v255
    ds_read_b128 v[180:183], v248 offset:0
    ds_read_b128 v[184:187], v249 offset:0
    ds_read_b128 v[188:191], v250 offset:0
    s_waitcnt lgkmcnt(3)
    v_cmp_eq_u32 vcc, 0, v236
    s_cbranch_vccnz L_t1
    s_cmp_ge_u32 s98, s30
    s_cbranch_scc1 L_t3
    ds_read_b32 v237, v255
    ds_read_b128 v[192:195], v248 offset:7808
    ds_read_b128 v[196:199], v249 offset:7808
    ds_read_b128 v[200:203], v250 offset:7808
    s_waitcnt lgkmcnt(6)
    buffer_store_dwordx4 v[180:183], v16, s[16:19], s96 offen offset:0 sc1
    s_waitcnt lgkmcnt(5)
    buffer_store_dwordx4 v[184:187], v16, s[16:19], s96 offen offset:1024 sc1
    s_waitcnt lgkmcnt(4)
    buffer_store_dwordx4 v[188:191], v16, s[16:19], s96 offen offset:2048 sc1
L_t2:
    s_waitcnt lgkmcnt(3)
    v_cmp_ne_u32 vcc, 2, v237
    s_cbranch_vccnz L_t4
    s_waitcnt lgkmcnt(2)
    buffer_store_dwordx4 v[192:195], v16, s[16:19], s97 offen offset:0 sc1
    s_waitcnt lgkmcnt(1)
    buffer_store_dwordx4 v[196:199], v16, s[16:19], s97 offen offset:1024 sc1
    s_waitcnt lgkmcnt(0)
    buffer_store_dwordx4 v[200:203], v16, s[16:19], s97 offen offset:2048 sc1
    s_branch L_fin
L_t4:
    ds_read_b32 v237, v255
    ds_read_b128 v[192:195], v248 offset:7808
    ds_read_b128 v[196:199], v249 offset:7808
    ds_read_b128 v[200:203], v250 offset:7808
    s_branch L_t2
L_t3:
    s_waitcnt lgkmcnt(2)
    buffer_store_dwordx4 v[180:183], v16, s[16:19], s96 offen offset:0 sc1
    s_waitcnt lgkmcnt(1)
    buffer_store_dwordx4 v[184:187], v16, s[16:19], s96 offen offset:1024 sc1
    s_waitcnt lgkmcnt(0)
    buffer_store_dwordx4 v[188:191], v16, s[16:19], s96 offen offset:2048 sc1
L_fin:
L_end:
    s_endpgm
L_dma:
    s_add_u32 s98, s35, 3
    s_and_b32 s98, s98, 3
    s_mul_i32 s98, s98, 18624
L_dma2:
    s_add_u32 s97, s88, s98
    s_add_u32 m0, s97, 0
    s_add_u32 s96, s95, 0
    buffer_load_dwordx4 v19, s[12:15], s96 offen lds
    s_add_u32 s97, s89, s98
    s_add_u32 m0, s97, 4128
    s_add_u32 s96, s95, 4096
    buffer_load_dwordx4 v19, s[12:15], s96 offen lds
    s_add_u32 s97, s90, s98
    s_add_u32 m0, s97, 8256
    s_add_u32 s96, s95, 8192
    buffer_load_dwordx4 v19, s[12:15], s96 offen lds
    s_add_u32 s97, s88, s98
    s_add_u32 m0, s97, 12416
    s_add_u32 s96, s95, 12288
    buffer_load_dwordx4 v19, s[12:15], s96 offen lds
    s_bitcmp1_b32 s28, 1
    s_cbranch_scc1 L_nd2
    s_add_u32 s97, s89, s98
    s_add_u32 m0, s97, 16544
    s_add_u32 s96, s95, 16384
    buffer_load_dwordx4 v19, s[12:15], s96 offen lds
L_nd2:
    s_add_u32 s95, s95, 18432
    s_cmp_eq_u32 s35, 1
    s_cbranch_scc0 L_nd3
    s_cmp_lt_u32 s23, 268435456
    s_cbranch_scc1 L_nd3
    s_min_i32 s96, s20, s21
    s_add_u32 m0, s94, 58560
    s_mov_b64 exec, s[92:93]
    s_add_u32 s20, s20, 43008
    buffer_load_dwordx4 v20, s[4:7], s96 offen lds
    s_mov_b64 exec, -1
    s_cmp_lt_u32 s23, 285212672
    s_cbranch_scc1 L_nd3
    s_min_i32 s96, s20, s21
    s_add_u32 m0, s94, 62464
    s_mov_b64 exec, s[92:93]
    s_add_u32 s20, s20, 43008
    buffer_load_dwordx4 v20, s[4:7], s96 offen lds
    s_mov_b64 exec, -1
L_nd3:
    s_setpc_b64 s[76:77]
.p2align 3
L_top0:
    s_barrier
L_body0:
L_mid0:
    s_add_u32 s35, s35, 1
    s_and_b32 s36, s35, 3
    s_mul_i32 s36, s36, 18624
L_end0:
    s_bitcmp1_b32 s3, s35
    s_waitcnt vmcnt(0) lgkmcnt(0)
    s_cbranch_scc0 L_top0
    s_bitcmp1_b32 s99, s35
    s_cbranch_scc1 L_sp0
    s_barrier
    s_bitcmp1_b32 s39, s35
    s_cbranch_scc0 L_sp0
    s_call_b64 s[76:77], L_dma
L_sp0:
    s_cmp_lg_u32 s35, 9
    s_cbranch_scc1 L_body0
L_last0:
    s_setprio 3
    s_add_u32 s96, s0, s29
    s_mul_i32 s96, s96, 224
    s_add_u32 s96, s96, s32
    s_mul_i32 s96, s96, 192
    s_add_u32 s97, s96, 86016
    s_add_u32 s98, s29, 2
    s_branch L_epi
L_nf2:
    ds_read_b64_tr_b16 v[84:85], v5 offset:6208
    ds_read_b64_tr_b16 v[86:87], v5 offset:6976
    ds_read_b64_tr_b16 v[88:89], v5 offset:6240
    ds_read_b64_tr_b16 v[90:91], v5 offset:7008
    ds_read_b64_tr_b16 v[92:93], v5 offset:6272
    ds_read_b64_tr_b16 v[94:95], v5 offset:7040
    ds_read_b128 v[124:127], v1 offset:64
    ds_read_b128 v[128:131], v1 offset:3968
    ds_read_b128 v[132:135], v1 offset:7872
    ds_read_b128 v[136:139], v1 offset:11776
    ds_read_b128 v[140:143], v1 offset:128
    ds_read_b128 v[144:147], v1 offset:4032
    ds_read_b128 v[148:151], v1 offset:7936
    ds_read_b128 v[152:155], v1 offset:11840
L_fdisp:
    s_cmp_eq_u32 s30, 3
    s_cbranch_scc1 L_mid3
    s_cmp_eq_u32 s30, 2
    s_cbranch_scc1 L_mid2
    s_cmp_eq_u32 s30, 1
    s_cbranch_scc1 L_mid1
    s_cmp_eq_u32 s30, 0
    s_cbranch_scc1 L_mid0
    s_branch L_mid4
.p2align 12
L_exact0:
    s_sub_u32 s96, s0, s33
    s_mul_i32 s97, s29, 96
    s_sub_u32 s96, s96, 1
    s_add_u32 s98, s97, 89280
    s_mul_i32 s96, s96, 3904
    v_add_u32_sdwa v4, s98, v240 dst_sel:DWORD dst_unused:UNUSED_PAD src0_sel:DWORD src1_sel:WORD_0
    v_add_u32_sdwa v5, s98, v240 dst_sel:DWORD dst_unused:UNUSED_PAD src0_sel:DWORD src1_sel:WORD_0
    s_bfe_u32 s98, s23, 0x40014
    v_add_u32_sdwa v1, s96, v240 dst_sel:DWORD dst_unused:UNUSED_PAD src0_sel:DWORD src1_sel:WORD_1
    v_add_u32_sdwa v2, s96, v241 dst_sel:DWORD dst_unused:UNUSED_PAD src0_sel:DWORD src1_sel:WORD_0
    v_add_u32_sdwa v3, s96, v241 dst_sel:DWORD dst_unused:UNUSED_PAD src0_sel:DWORD src1_sel:WORD_1
    s_mul_i32 s98, s98, 3904
    s_sub_u32 s98, 107904, s98
    s_cmp_lt_u32 s28, 4
    s_cselect_b32 s98, 0, s98
    s_mul_i32 s96, s31, 3904
    s_add_u32 s96, s96, s98
    s_add_u32 s97, s97, s96
    v_add_u32_sdwa v21, s97, v242 dst_sel:DWORD dst_unused:UNUSED_PAD src0_sel:DWORD src1_sel:WORD_0
    s_mul_i32 s97, s29, 3904
    s_add_u32 s97, s97, s96
    v_add_u32_sdwa v248, s97, v242 dst_sel:DWORD dst_unused:UNUSED_PAD src0_sel:DWORD src1_sel:WORD_1
    v_add_u32_sdwa v249, s97, v243 dst_sel:DWORD dst_unused:UNUSED_PAD src0_sel:DWORD src1_sel:WORD_0
    v_add_u32_sdwa v250, s97, v243 dst_sel:DWORD dst_unused:UNUSED_PAD src0_sel:DWORD src1_sel:WORD_1
L_exact:
    s_bitcmp1_b32 s23, 19
    s_cbranch_scc0 L_lazy
L_exact1:
    v_cvt_f32_u32 v222, s32
    v_cvt_f32_u32 v220, s0
    v_bfe_u32 v238, v226, 8, 8
    v_add_f32 v221, v222, v224
    v_add_f32 v220, v220, v225
    v_and_b32 v251, 0xffff, v235
    v_add_f32 v222, 1.0, v221
    v_add_f32 v223, 2.0, v221
    v_mov_b32 v236, 0xf400f40
    s_mov_b32 s91, 0x435f435f
    s_mov_b32 exec_hi, 0xffff
    v_mov_b32 v237, v220
    v_lshlrev_b32 v72, 16, v204
    v_lshlrev_b32 v156, 16, v205
    v_lshlrev_b32 v180, 16, v206
    v_and_b32 v73, 0xffff0000, v204
    v_and_b32 v157, 0xffff0000, v205
    v_and_b32 v181, 0xffff0000, v206
    v_cvt_pk_bf16_f32 v74, v237, v221
    v_cvt_pk_bf16_f32 v158, v237, v222
    v_cvt_pk_bf16_f32 v182, v237, v223
    v_add_f32 v72, v72, v237
    v_add_f32 v156, v156, v237
    v_add_f32 v180, v180, v237
    v_add_f32 v73, v73, v221
    v_add_f32 v157, v157, v222
    v_add_f32 v181, v181, v223
    v_cvt_pk_bf16_f32 v72, v72, v73
    v_cvt_pk_bf16_f32 v156, v156, v157
    v_cvt_pk_bf16_f32 v180, v180, v181
    v_cmp_ne_u32 s[40:41], v72, v74
    v_cmp_ne_u32 s[42:43], v156, v158
    v_cmp_ne_u32 s[44:45], v180, v182
    v_add_f32 v237, 1.0, v237
    v_lshlrev_b32 v72, 16, v208
    v_lshlrev_b32 v156, 16, v209
    v_lshlrev_b32 v180, 16, v210
    v_and_b32 v73, 0xffff0000, v208
    v_and_b32 v157, 0xffff0000, v209
    v_and_b32 v181, 0xffff0000, v210
    v_cvt_pk_bf16_f32 v74, v237, v221
    v_cvt_pk_bf16_f32 v158, v237, v222
    v_cvt_pk_bf16_f32 v182, v237, v223
    v_add_f32 v72, v72, v237
    v_add_f32 v156, v156, v237
    v_add_f32 v180, v180, v237
    v_add_f32 v73, v73, v221
    v_add_f32 v157, v157, v222
    v_add_f32 v181, v181, v223
    v_cvt_pk_bf16_f32 v72, v72, v73
    v_cvt_pk_bf16_f32 v156, v156, v157
    v_cvt_pk_bf16_f32 v180, v180, v181
    v_cmp_ne_u32 s[46:47], v72, v74
    v_cmp_ne_u32 s[48:49], v156, v158
    v_cmp_ne_u32 s[50:51], v180, v182
    v_add_f32 v237, 1.0, v237
    v_lshlrev_b32 v72, 16, v212
    v_lshlrev_b32 v156, 16, v213
    v_lshlrev_b32 v180, 16, v214
    v_and_b32 v73, 0xffff0000, v212
    v_and_b32 v157, 0xffff0000, v213
    v_and_b32 v181, 0xffff0000, v214
    v_cvt_pk_bf16_f32 v74, v237, v221
    v_cvt_pk_bf16_f32 v158, v237, v222
    v_cvt_pk_bf16_f32 v182, v237, v223
    v_add_f32 v72, v72, v237
    v_add_f32 v156, v156, v237
    v_add_f32 v180, v180, v237
    v_add_f32 v73, v73, v221
    v_add_f32 v157, v157, v222
    v_add_f32 v181, v181, v223
    v_cvt_pk_bf16_f32 v72, v72, v73
    v_cvt_pk_bf16_f32 v156, v156, v157
    v_cvt_pk_bf16_f32 v180, v180, v181
    v_cmp_ne_u32 s[52:53], v72, v74
    v_cmp_ne_u32 s[54:55], v156, v158
    v_cmp_ne_u32 s[56:57], v180, v182
    v_add_f32 v237, 1.0, v237
    v_lshlrev_b32 v72, 16, v216
    v_lshlrev_b32 v156, 16, v217
    v_lshlrev_b32 v180, 16, v218
    v_and_b32 v73, 0xffff0000, v216
    v_and_b32 v157, 0xffff0000, v217
    v_and_b32 v181, 0xffff0000, v218
    v_cvt_pk_bf16_f32 v74, v237, v221
    v_cvt_pk_bf16_f32 v158, v237, v222
    v_cvt_pk_bf16_f32 v182, v237, v223
    v_add_f32 v72, v72, v237
    v_add_f32 v156, v156, v237
    v_add_f32 v180, v180, v237
    v_add_f32 v73, v73, v221
    v_add_f32 v157, v157, v222
    v_add_f32 v181, v181, v223
    v_cvt_pk_bf16_f32 v72, v72, v73
    v_cvt_pk_bf16_f32 v156, v156, v157
    v_cvt_pk_bf16_f32 v180, v180, v181
    v_cmp_ne_u32 s[58:59], v72, v74
    v_cmp_ne_u32 s[60:61], v156, v158
    v_cmp_ne_u32 s[62:63], v180, v182
    s_mov_b32 exec_hi, -1
    v_mov_b32 v73, 0
    v_mov_b32 v72, 0
    v_addc_co_u32 v73, s[64:65], 0, v73, s[40:41]
    s_lshr_b32 s97, s28, 1
    v_addc_co_u32 v72, s[64:65], 0, v72, s[42:43]
    s_mul_i32 s36, s97, 576
    v_addc_co_u32 v73, s[64:65], 0, v73, s[44:45]
    s_lshl_b32 s97, s97, 4
    v_addc_co_u32 v72, s[64:65], 0, v72, s[46:47]
    s_lshr_b64 s[70:71], s[24:25], s97
    v_addc_co_u32 v73, s[64:65], 0, v73, s[48:49]
    s_bfe_u32 s69, s70, 0x5000b
    v_addc_co_u32 v72, s[64:65], 0, v72, s[50:51]
    s_and_b32 s68, s70, 0x7ff
    v_addc_co_u32 v73, s[64:65], 0, v73, s[52:53]
    s_lshl_b32 s69, s69, 2
    v_addc_co_u32 v72, s[64:65], 0, v72, s[54:55]
    s_lshl_b32 s68, s68, 6
    v_addc_co_u32 v73, s[64:65], 0, v73, s[56:57]
    s_add_u32 s36, s36, 149248
    v_addc_co_u32 v72, s[64:65], 0, v72, s[58:59]
    s_mov_b32 s66, s68
    v_addc_co_u32 v73, s[64:65], 0, v73, s[60:61]
    s_add_u32 s67, s68, 1152
    v_addc_co_u32 v72, s[64:65], 0, v72, s[62:63]
    s_lshl_b32 s96, s69, 4
    v_add_u32 v73, v73, v72
    s_add_u32 s68, s67, s96
    v_cmp_eq_u32 s[64:65], 0, v238
    v_lshlrev_b32 v74, 16, v73
    s_nop 0
    v_cndmask_b32 v73, v74, v73, s[64:65]
    v_mov_b32 v74, v73
    s_nop 1
    v_add_u32_dpp v74, v74, v74 row_shr:1 row_mask:0xf bank_mask:0xf bound_ctrl:0
    s_sub_u32 s96, s0, s33
    s_sub_u32 s96, s96, 1
    v_add_u32_dpp v74, v74, v74 row_shr:2 row_mask:0xf bank_mask:0xf bound_ctrl:0
    s_mul_i32 s96, s96, 0xf400f4
    s_add_u32 s97, s96, 0x1e801e8
    v_add_u32_dpp v74, v74, v74 row_shr:4 row_mask:0xf bank_mask:0xf bound_ctrl:0
    v_add_u32 v77, s66, v227
    v_add_u32 v180, s96, v232
    v_add_u32_dpp v74, v74, v74 row_shr:8 row_mask:0xf bank_mask:0xf bound_ctrl:0
    v_add_u32 v181, s97, v232
    v_add_u32 v184, s96, v233
    v_add_u32_dpp v74, v74, v74 row_bcast:15 row_mask:0xa bank_mask:0xf
    v_add_u32 v185, s97, v233
    v_add_u32 v188, s96, v234
    v_add_u32_dpp v74, v74, v74 row_bcast:31 row_mask:0xc bank_mask:0xf
    v_add_u32 v189, s97, v234
    v_readlane_b32 s27, v74, 63
    v_sub_u32 v74, v74, v73
    s_and_b32 s26, s27, 0xffff
    s_lshr_b32 s27, s27, 16
    s_add_u32 s27, s27, s26
    s_cmp_gt_u32 s27, s69
    s_cbranch_scc1 L_table
    s_cmp_eq_u32 s27, 0
    s_cbranch_scc1 L_gpr
    s_mov_b32 exec_hi, 0xffff
    v_lshrrev_b32 v79, 16, v74
    v_and_b32 v74, 0xffff, v74
    v_add_u32 v79, s26, v79
    v_cndmask_b32 v74, v79, v74, s[64:65]
    v_lshl_add_u32 v79, v74, 3, s36
    ds_write_b64 v77, v[180:181] offset:0
    ds_write_b64 v77, v[184:185] offset:128
    ds_write_b64 v77, v[188:189] offset:256
    s_mov_b32 s38, 1
    s_mov_b32 exec_hi, -1
    s_setpc_b64 s[76:77]
L_list3:
    s_mov_b64 exec, s[40:41]
    s_cbranch_execz L_lb00
    v_add_u32 v78, 0x0, v226
    v_add_u32 v79, 8, v79
    ds_write2_b32 v79, v204, v78 offset1:1
L_lb00:
    s_mov_b64 exec, s[42:43]
    s_cbranch_execz L_lb01
    v_add_u32 v78, 0x1000000, v226
    v_add_u32 v79, 8, v79
    ds_write2_b32 v79, v205, v78 offset1:1
L_lb01:
    s_mov_b64 exec, s[44:45]
    s_cbranch_execz L_lb02
    v_add_u32 v78, 0x2000000, v226
    v_add_u32 v79, 8, v79
    ds_write2_b32 v79, v206, v78 offset1:1
L_lb02:
    s_mov_b64 exec, s[46:47]
    s_cbranch_execz L_lb10
    v_add_u32 v78, 0x10000, v226
    v_add_u32 v79, 8, v79
    ds_write2_b32 v79, v208, v78 offset1:1
L_lb10:
    s_mov_b64 exec, s[48:49]
    s_cbranch_execz L_lb11
    v_add_u32 v78, 0x1010000, v226
    v_add_u32 v79, 8, v79
    ds_write2_b32 v79, v209, v78 offset1:1
L_lb11:
    s_mov_b64 exec, s[50:51]
    s_cbranch_execz L_lb12
    v_add_u32 v78, 0x2010000, v226
    v_add_u32 v79, 8, v79
    ds_write2_b32 v79, v210, v78 offset1:1
L_lb12:
    s_mov_b64 exec, s[52:53]
    s_cbranch_execz L_lb20
    v_add_u32 v78, 0x20000, v226
    v_add_u32 v79, 8, v79
    ds_write2_b32 v79, v212, v78 offset1:1
L_lb20:
    s_mov_b64 exec, s[54:55]
    s_cbranch_execz L_lb21
    v_add_u32 v78, 0x1020000, v226
    v_add_u32 v79, 8, v79
    ds_write2_b32 v79, v213, v78 offset1:1
L_lb21:
    s_mov_b64 exec, s[56:57]
    s_cbranch_execz L_lb22
    v_add_u32 v78, 0x2020000, v226
    v_add_u32 v79, 8, v79
    ds_write2_b32 v79, v214, v78 offset1:1
L_lb22:
    s_mov_b64 exec, s[58:59]
    s_cbranch_execz L_lb30
    v_add_u32 v78, 0x30000, v226
    v_add_u32 v79, 8, v79
    ds_write2_b32 v79, v216, v78 offset1:1
L_lb30:
    s_mov_b64 exec, s[60:61]
    s_cbranch_execz L_lb31
    v_add_u32 v78, 0x1030000, v226
    v_add_u32 v79, 8, v79
    ds_write2_b32 v79, v217, v78 offset1:1
L_lb31:
    s_mov_b64 exec, s[62:63]
    s_cbranch_execz L_lb32
    v_add_u32 v78, 0x2030000, v226
    v_add_u32 v79, 8, v79
    ds_write2_b32 v79, v218, v78 offset1:1
L_lb32:
    s_mov_b64 exec, -1
    s_sub_u32 s96, s27, 1
    v_lshrrev_b32 v78, 4, v16
    v_min_u32 v78, s96, v78
    v_lshl_add_u32 v79, v78, 3, s36
    ds_read_b64 v[158:159], v79 offset:8
    v_lshl_add_u32 v231, v78, 4, s67
    s_lshr_b32 s96, s68, 4
    v_bfe_u32 v161, v78, 1, 2
    v_mad_u32_u24 v78, v78, 12, s96
    v_add_u32 v161, v161, v78
    s_sub_u32 s97, s32, 1
    s_sub_u32 s98, s0, 1
    s_bfe_u32 s96, s23, 0x50018
    s_sub_u32 s96, s96, 1
    s_bfe_u32 s73, s23, 0x40014
    s_cmp_lt_u32 s28, 4
    s_cselect_b32 s70, 7, 14
    s_cselect_b32 s71, 14, 16
    s_cselect_b32 s72, 14, 16
    s_cselect_b32 s73, 0, s73
    s_min_u32 s70, s70, s96
    s_min_u32 s71, s71, s96
    s_min_u32 s72, s72, s96
    s_mov_b32 s64, s70
    s_waitcnt lgkmcnt(0)
    v_bfe_u32 v156, v159, 8, 8
    v_and_b32 v78, 0xff, v159
    v_bfe_u32 v79, v159, 16, 8
    v_lshrrev_b32 v159, 24, v159
    v_mad_u32_u24 v160, v156, 3, v159
    v_lshl_add_u32 v74, v78, 2, v79
    v_add3_u32 v78, v78, v159, s97
    v_add3_u32 v79, v79, v156, s98
    v_lshl_add_u32 v160, v160, 6, v74
    v_cvt_f32_i32 v157, v78
    v_cvt_f32_i32 v237, v79
    v_lshl_add_u32 v160, v160, 1, s66
    v_mov_b32 v230, s70
    v_mov_b32 v229, s71
    v_cmp_eq_u32 vcc, 1, v156
    v_mov_b32 v17, s72
    s_nop 0
    v_cndmask_b32 v230, v230, v229, vcc
    v_cmp_eq_u32 vcc, 2, v156
    v_mov_b32 v229, 0
    s_nop 0
    v_cndmask_b32 v230, v230, v17, vcc
    s_mov_b64 s[70:71], s[44:45]
    s_mov_b64 s[72:73], s[46:47]
    s_mov_b64 s[74:75], s[48:49]
    v_lshlrev_b32 v77, 16, v158
    v_and_b32 v78, 0xffff0000, v158
    v_add_f32 v77, v77, v237
    v_add_f32 v78, v78, v157
    v_cvt_pk_bf16_f32 v76, v77, v78
    v_pk_max_i16 v76, v76, 0
    v_pk_min_i16 v76, v76, s91
    v_lshlrev_b32 v77, 16, v76
    v_and_b32 v78, 0xffff0000, v76
    v_fract_f32 v79, v77
    v_fract_f32 v80, v78
    v_cvt_u32_f32 v81, v77
    v_cvt_u32_f32 v82, v78
    v_cmp_neq_f32 s[44:45], 0, v80
    v_cmp_neq_f32 s[46:47], 0, v79
    v_sub_f32 v83, 1.0, v79
    v_sub_f32 v84, 1.0, v80
    v_subrev_u32 v81, s33, v81
    v_subrev_u32 v82, s34, v82
    v_cvt_pk_bf16_f32 v77, v83, v84
    v_sub_u32 v89, v81, v229
    v_addc_co_u32 v91, vcc, 0, v82, s[44:45]
    v_lshlrev_b32 v83, 16, v77
    v_and_b32 v84, 0xffff0000, v77
    v_addc_co_u32 v90, vcc, 0, v89, s[46:47]
    v_mul_u32_u24 v92, 976, v81
    v_mul_f32 v85, v83, v84
    v_mul_f32 v86, v83, v80
    v_mul_f32 v87, v79, v84
    v_mul_f32 v88, v79, v80
    v_max_u32 v89, v89, v90
    v_subrev_u32 v77, s100, v82
    v_subrev_u32 v78, s100, v91
    v_mad_u32_u24 v83, v82, 48, v92
    v_mad_u32_u24 v84, v91, 48, v92
    v_and_b32 v82, 12, v82
    v_and_b32 v91, 12, v91
    v_max_u32 v77, v77, v78
    s_andn2_b64 s[48:49], s[46:47], s[44:45]
    v_add_lshl_u32 v83, v83, v82, 2
    v_add_lshl_u32 v84, v84, v91, 2
    v_cndmask_b32 v86, v87, v86, s[44:45]
    v_cndmask_b32 v78, 0, v236, s[48:49]
    s_and_b64 s[48:49], s[46:47], s[44:45]
    v_cndmask_b32 v87, 0, v87, s[44:45]
    v_cndmask_b32 v90, 0, v236, s[46:47]
    v_cmp_lt_u32 s[46:47], v230, v89
    v_cmp_lt_u32 s[44:45], s101, v77
    v_lshl_or_b32 v74, v84, 16, v83
    v_cvt_pk_bf16_f32 v73, v85, v86
    v_cvt_pk_bf16_f32 v75, v87, v88
    v_and_b32 v78, 0xffff0000, v78
    v_cndmask_b32 v77, 0, v236, s[48:49]
    s_or_b64 s[44:45], s[44:45], s[46:47]
    v_add_u32_sdwa v90, v90, v84 dst_sel:DWORD dst_unused:UNUSED_PAD src0_sel:WORD_1 src1_sel:DWORD
    v_cmp_lt_u32 vcc, 0xffff, v90
    s_or_b64 s[44:45], s[44:45], vcc
    v_add_u32 v72, v74, v78
    v_add_u32 v74, v74, v77
    v_cmp_lt_u32 vcc, s64, v89
    ds_write_b128 v231, v[72:75]
    ds_write_b16 v160, v161
    s_cmp_lg_u64 s[44:45], 0
    s_cbranch_scc1 L_table0
    s_cmp_eq_u64 vcc, 0
    s_cselect_b32 s26, s27, s26
    s_cselect_b32 s37, 0, 8
    s_mov_b32 s52, 0
    s_mov_b32 s53, s26
    s_mov_b32 s54, 16
    s_setpc_b64 s[76:77]
L_first2:
    s_cmp_eq_u32 s38, 2
    s_cbranch_scc1 L_gfirst0
    v_lshl_add_u32 v7, v14, 3, s66
    s_cmp_eq_u32 s26, 0
    s_cbranch_scc1 L_pf0
    s_sub_u32 s97, s53, 1
    v_add_u32 v17, s52, v251
    v_add_u32 v252, s52, v14
    v_min_u32 v17, s97, v17
    v_min_u32 v252, s97, v252
    v_lshl_add_u32 v17, v17, 4, s67
    v_bfe_u32 v253, v252, 1, 2
    ds_read_b128 v[236:239], v17
    v_mad_u32_u24 v252, v252, 12, v253
    v_and_b32 v253, 3, v15
    s_add_u32 s52, s52, s54
    v_xor_b32 v252, v252, v253
    v_lshl_add_u32 v252, v252, 4, s68
    s_waitcnt lgkmcnt(0)
    v_xor_b32_sdwa v244, v236, v12 dst_sel:DWORD dst_unused:UNUSED_PAD src0_sel:WORD_0 src1_sel:DWORD
    v_xor_b32_sdwa v246, v236, v12 dst_sel:DWORD dst_unused:UNUSED_PAD src0_sel:WORD_1 src1_sel:DWORD
    v_xor_b32_sdwa v245, v236, v13 dst_sel:DWORD dst_unused:UNUSED_PAD src0_sel:WORD_0 src1_sel:DWORD
    v_xor_b32_sdwa v247, v236, v13 dst_sel:DWORD dst_unused:UNUSED_PAD src0_sel:WORD_1 src1_sel:DWORD
    v_cmp_ne_u32 vcc, 0, v239
    v_perm_b32 v228, v237, v237, v8
    v_perm_b32 v229, v237, v237, v9
    v_perm_b32 v230, v237, v237, v10
    v_perm_b32 v231, v237, v237, v11
    s_setprio 3
    s_barrier
    s_call_b64 s[76:77], L_gpb
    s_branch L_pf1
L_pf0:
    s_barrier
L_pf1:
    ds_read_b64 v[236:237], v7
    ds_read_b64_tr_b16 v[72:73], v5 offset:0
    ds_read_b64_tr_b16 v[74:75], v5 offset:768
    ds_read_b64_tr_b16 v[76:77], v5 offset:32
    ds_read_b64_tr_b16 v[78:79], v5 offset:800
    ds_read_b64_tr_b16 v[80:81], v5 offset:64
    ds_read_b64_tr_b16 v[82:83], v5 offset:832
    s_mov_b32 s52, s26
    s_mov_b32 s53, s27
    s_waitcnt lgkmcnt(6)
    v_xor_b32 v236, v236, v15
    v_xor_b32 v237, v237, v15
    v_lshlrev_b32_sdwa v240, 4, v236 dst_sel:DWORD dst_unused:UNUSED_PAD src0_sel:DWORD src1_sel:WORD_0
    v_lshlrev_b32_sdwa v241, 4, v236 dst_sel:DWORD dst_unused:UNUSED_PAD src0_sel:DWORD src1_sel:WORD_1
    v_lshlrev_b32_sdwa v242, 4, v237 dst_sel:DWORD dst_unused:UNUSED_PAD src0_sel:DWORD src1_sel:WORD_0
    v_lshlrev_b32_sdwa v243, 4, v237 dst_sel:DWORD dst_unused:UNUSED_PAD src0_sel:DWORD src1_sel:WORD_1
    ds_read_b128 v[108:111], v240 offset:0
    ds_read_b128 v[112:115], v241 offset:0
    ds_read_b128 v[116:119], v242 offset:0
    ds_read_b128 v[120:123], v243 offset:0
    s_cmp_eq_u32 s30, 3
    s_cbranch_scc0 L_pf4
    s_waitcnt lgkmcnt(3)
    v_mfma_f32_16x16x32_bf16 v[24:27], v[72:75], v[108:111], v[24:27]
    ds_read_b64_tr_b16 v[84:85], v5 offset:6208
    ds_read_b64_tr_b16 v[86:87], v5 offset:6976
    v_mfma_f32_16x16x32_bf16 v[28:31], v[76:79], v[108:111], v[28:31]
    ds_read_b64_tr_b16 v[88:89], v5 offset:6240
    ds_read_b64_tr_b16 v[90:91], v5 offset:7008
    v_mfma_f32_16x16x32_bf16 v[32:35], v[80:83], v[108:111], v[32:35]
    ds_read_b64_tr_b16 v[92:93], v5 offset:6272
    ds_read_b64_tr_b16 v[94:95], v5 offset:7040
    s_waitcnt lgkmcnt(8)
    v_mfma_f32_16x16x32_bf16 v[44:47], v[80:83], v[112:115], v[44:47]
    ds_read_b128 v[124:127], v240 offset:64
    ds_read_b128 v[128:131], v241 offset:64
    v_mfma_f32_16x16x32_bf16 v[40:43], v[76:79], v[112:115], v[40:43]
    ds_read_b128 v[132:135], v242 offset:64
    ds_read_b128 v[140:143], v240 offset:128
    v_mfma_f32_16x16x32_bf16 v[36:39], v[72:75], v[112:115], v[36:39]
    ds_read_b128 v[144:147], v241 offset:128
    ds_read_b128 v[148:151], v242 offset:128
    s_waitcnt lgkmcnt(13)
    v_mfma_f32_16x16x32_bf16 v[48:51], v[72:75], v[116:119], v[48:51]
    ds_read_b64 v[236:237], v7 offset:128
    ds_read_b64_tr_b16 v[96:97], v5 offset:12416
    v_mfma_f32_16x16x32_bf16 v[52:55], v[76:79], v[116:119], v[52:55]
    ds_read_b64_tr_b16 v[98:99], v5 offset:13184
    ds_read_b64_tr_b16 v[100:101], v5 offset:12448
    v_mfma_f32_16x16x32_bf16 v[56:59], v[80:83], v[116:119], v[56:59]
    ds_read_b64_tr_b16 v[102:103], v5 offset:13216
    ds_read_b64_tr_b16 v[104:105], v5 offset:12480
    ds_read_b64_tr_b16 v[106:107], v5 offset:13248
    s_add_u32 s35, s35, 1
    s_and_b32 s36, s35, 3
    s_mul_i32 s36, s36, 18624
    v_add_u32 v7, 128, v7
    v_add_u32 v5, s36, v4
    s_waitcnt lgkmcnt(6)
    v_xor_b32 v236, v236, v15
    v_xor_b32 v237, v237, v15
    v_lshlrev_b32_sdwa v240, 4, v236 dst_sel:DWORD dst_unused:UNUSED_PAD src0_sel:DWORD src1_sel:WORD_0
    v_lshlrev_b32_sdwa v241, 4, v236 dst_sel:DWORD dst_unused:UNUSED_PAD src0_sel:DWORD src1_sel:WORD_1
    v_lshlrev_b32_sdwa v242, 4, v237 dst_sel:DWORD dst_unused:UNUSED_PAD src0_sel:DWORD src1_sel:WORD_0
    s_branch L_endp3
L_pf4:
    s_cmp_eq_u32 s30, 4
    s_cbranch_scc0 L_pf2
    s_waitcnt lgkmcnt(3)
    v_mfma_f32_16x16x32_bf16 v[24:27], v[72:75], v[108:111], v[24:27]
    ds_read_b64_tr_b16 v[84:85], v5 offset:6208
    ds_read_b64_tr_b16 v[86:87], v5 offset:6976
    v_mfma_f32_16x16x32_bf16 v[28:31], v[76:79], v[108:111], v[28:31]
    ds_read_b64_tr_b16 v[88:89], v5 offset:6240
    ds_read_b64_tr_b16 v[90:91], v5 offset:7008
    v_mfma_f32_16x16x32_bf16 v[32:35], v[80:83], v[108:111], v[32:35]
    ds_read_b64_tr_b16 v[92:93], v5 offset:6272
    ds_read_b64_tr_b16 v[94:95], v5 offset:7040
    s_waitcnt lgkmcnt(8)
    v_mfma_f32_16x16x32_bf16 v[44:47], v[80:83], v[112:115], v[44:47]
    ds_read_b128 v[124:127], v240 offset:64
    ds_read_b128 v[128:131], v241 offset:64
    v_mfma_f32_16x16x32_bf16 v[40:43], v[76:79], v[112:115], v[40:43]
    ds_read_b128 v[132:135], v242 offset:64
    ds_read_b128 v[136:139], v243 offset:64
    v_mfma_f32_16x16x32_bf16 v[36:39], v[72:75], v[112:115], v[36:39]
    ds_read_b128 v[140:143], v240 offset:128
    ds_read_b128 v[144:147], v241 offset:128
    s_waitcnt lgkmcnt(13)
    v_mfma_f32_16x16x32_bf16 v[48:51], v[72:75], v[116:119], v[48:51]
    ds_read_b128 v[148:151], v242 offset:128
    ds_read_b128 v[152:155], v243 offset:128
    v_mfma_f32_16x16x32_bf16 v[52:55], v[76:79], v[116:119], v[52:55]
    ds_read_b64 v[236:237], v7 offset:128
    ds_read_b64_tr_b16 v[96:97], v5 offset:12416
    v_mfma_f32_16x16x32_bf16 v[56:59], v[80:83], v[116:119], v[56:59]
    ds_read_b64_tr_b16 v[98:99], v5 offset:13184
    ds_read_b64_tr_b16 v[100:101], v5 offset:12448
    s_waitcnt lgkmcnt(15)
    v_mfma_f32_16x16x32_bf16 v[68:71], v[80:83], v[120:123], v[68:71]
    ds_read_b64_tr_b16 v[102:103], v5 offset:13216
    ds_read_b64_tr_b16 v[104:105], v5 offset:12480
    v_mfma_f32_16x16x32_bf16 v[64:67], v[76:79], v[120:123], v[64:67]
    ds_read_b64_tr_b16 v[106:107], v5 offset:13248
    v_mfma_f32_16x16x32_bf16 v[60:63], v[72:75], v[120:123], v[60:63]
    s_add_u32 s35, s35, 1
    s_and_b32 s36, s35, 3
    s_mul_i32 s36, s36, 18624
    v_add_u32 v7, 128, v7
    v_add_u32 v5, s36, v4
    s_waitcnt lgkmcnt(6)
    v_xor_b32 v236, v236, v15
    v_xor_b32 v237, v237, v15
    v_lshlrev_b32_sdwa v240, 4, v236 dst_sel:DWORD dst_unused:UNUSED_PAD src0_sel:DWORD src1_sel:WORD_0
    v_lshlrev_b32_sdwa v241, 4, v236 dst_sel:DWORD dst_unused:UNUSED_PAD src0_sel:DWORD src1_sel:WORD_1
    v_lshlrev_b32_sdwa v242, 4, v237 dst_sel:DWORD dst_unused:UNUSED_PAD src0_sel:DWORD src1_sel:WORD_0
    v_lshlrev_b32_sdwa v243, 4, v237 dst_sel:DWORD dst_unused:UNUSED_PAD src0_sel:DWORD src1_sel:WORD_1
    s_branch L_endp4
L_gp:
    s_cmp_ge_u32 s52, s53
    s_cbranch_scc1 L_gpr
    s_setprio 3
L_gpl:
    s_sub_u32 s97, s53, 1
    v_add_u32 v17, s52, v251
    v_add_u32 v252, s52, v14
    v_min_u32 v17, s97, v17
    v_min_u32 v252, s97, v252
    v_lshl_add_u32 v17, v17, 4, s67
    v_bfe_u32 v253, v252, 1, 2
    ds_read_b128 v[236:239], v17
    v_mad_u32_u24 v252, v252, 12, v253
    v_and_b32 v253, 3, v15
    s_add_u32 s52, s52, s54
    v_xor_b32 v252, v252, v253
    v_lshl_add_u32 v252, v252, 4, s68
    s_waitcnt lgkmcnt(0)
    v_xor_b32_sdwa v244, v236, v12 dst_sel:DWORD dst_unused:UNUSED_PAD src0_sel:WORD_0 src1_sel:DWORD
    v_xor_b32_sdwa v246, v236, v12 dst_sel:DWORD dst_unused:UNUSED_PAD src0_sel:WORD_1 src1_sel:DWORD
    v_xor_b32_sdwa v245, v236, v13 dst_sel:DWORD dst_unused:UNUSED_PAD src0_sel:WORD_0 src1_sel:DWORD
    v_xor_b32_sdwa v247, v236, v13 dst_sel:DWORD dst_unused:UNUSED_PAD src0_sel:WORD_1 src1_sel:DWORD
    v_cmp_ne_u32 vcc, 0, v239
    v_perm_b32 v228, v237, v237, v8
    v_perm_b32 v229, v237, v237, v9
    v_perm_b32 v230, v237, v237, v10
    v_perm_b32 v231, v237, v237, v11
L_gpb:
    ds_read_b64_tr_b16 v[156:157], v244 offset:0
    ds_read_b64_tr_b16 v[158:159], v246 offset:0
    ds_read_b64_tr_b16 v[160:161], v245 offset:0
    ds_read_b64_tr_b16 v[162:163], v247 offset:0
    ds_read_b64_tr_b16 v[164:165], v244 offset:64
    ds_read_b64_tr_b16 v[166:167], v246 offset:64
    ds_read_b64_tr_b16 v[168:169], v245 offset:64
    ds_read_b64_tr_b16 v[170:171], v247 offset:64
    ds_read_b64_tr_b16 v[172:173], v244 offset:128
    ds_read_b64_tr_b16 v[174:175], v246 offset:128
    ds_read_b64_tr_b16 v[176:177], v245 offset:128
    ds_read_b64_tr_b16 v[178:179], v247 offset:128
    s_cbranch_vccnz L_gp4
    s_waitcnt lgkmcnt(8)
    v_mfma_f32_16x16x32_bf16 v[204:207], v[156:159], v[228:231], 0
    v_mfma_f32_16x16x32_bf16 v[208:211], v[160:163], v[228:231], 0
    s_waitcnt lgkmcnt(4)
    v_mfma_f32_16x16x32_bf16 v[212:215], v[164:167], v[228:231], 0
    v_mfma_f32_16x16x32_bf16 v[216:219], v[168:171], v[228:231], 0
    s_waitcnt lgkmcnt(0)
    v_mfma_f32_16x16x32_bf16 v[220:223], v[172:175], v[228:231], 0
    v_mfma_f32_16x16x32_bf16 v[224:227], v[176:179], v[228:231], 0
L_gpw:
    s_nop 1
    v_cvt_pk_bf16_f32 v156, v204, v205
    v_cvt_pk_bf16_f32 v157, v206, v207
    v_cvt_pk_bf16_f32 v158, v208, v209
    v_cvt_pk_bf16_f32 v159, v210, v211
    v_cvt_pk_bf16_f32 v160, v212, v213
    v_cvt_pk_bf16_f32 v161, v214, v215
    v_cvt_pk_bf16_f32 v162, v216, v217
    v_cvt_pk_bf16_f32 v163, v218, v219
    v_cvt_pk_bf16_f32 v164, v220, v221
    v_cvt_pk_bf16_f32 v165, v222, v223
    v_cvt_pk_bf16_f32 v166, v224, v225
    v_cvt_pk_bf16_f32 v167, v226, v227
    v_permlane32_swap_b32 v156, v158
    v_permlane32_swap_b32 v157, v159
    v_permlane32_swap_b32 v160, v162
    v_permlane32_swap_b32 v161, v163
    v_permlane32_swap_b32 v164, v166
    v_permlane32_swap_b32 v165, v167
    ds_write_b128 v252, v[156:159] offset:0
    ds_write_b128 v252, v[160:163] offset:64
    ds_write_b128 v252, v[164:167] offset:128
    s_cmp_lt_u32 s52, s53
    s_cbranch_scc1 L_gpl
L_gpr:
    s_setpc_b64 s[76:77]
L_gp4:
    v_xor_b32_sdwa v244, v238, v12 dst_sel:DWORD dst_unused:UNUSED_PAD src0_sel:WORD_0 src1_sel:DWORD
    v_xor_b32_sdwa v246, v238, v12 dst_sel:DWORD dst_unused:UNUSED_PAD src0_sel:WORD_1 src1_sel:DWORD
    v_xor_b32_sdwa v245, v238, v13 dst_sel:DWORD dst_unused:UNUSED_PAD src0_sel:WORD_0 src1_sel:DWORD
    v_xor_b32_sdwa v247, v238, v13 dst_sel:DWORD dst_unused:UNUSED_PAD src0_sel:WORD_1 src1_sel:DWORD
    ds_read_b64_tr_b16 v[180:181], v244 offset:0
    ds_read_b64_tr_b16 v[182:183], v246 offset:0
    ds_read_b64_tr_b16 v[184:185], v245 offset:0
    ds_read_b64_tr_b16 v[186:187], v247 offset:0
    ds_read_b64_tr_b16 v[188:189], v244 offset:64
    ds_read_b64_tr_b16 v[190:191], v246 offset:64
    ds_read_b64_tr_b16 v[192:193], v245 offset:64
    ds_read_b64_tr_b16 v[194:195], v247 offset:64
    ds_read_b64_tr_b16 v[196:197], v244 offset:128
    ds_read_b64_tr_b16 v[198:199], v246 offset:128
    ds_read_b64_tr_b16 v[200:201], v245 offset:128
    ds_read_b64_tr_b16 v[202:203], v247 offset:128
    v_perm_b32 v232, v239, v239, v8
    v_perm_b32 v233, v239, v239, v9
    v_perm_b32 v234, v239, v239, v10
    v_perm_b32 v235, v239, v239, v11
    s_waitcnt lgkmcnt(12)
    v_mfma_f32_16x16x32_bf16 v[204:207], v[156:159], v[228:231], 0
    v_mfma_f32_16x16x32_bf16 v[208:211], v[160:163], v[228:231], 0
    v_mfma_f32_16x16x32_bf16 v[212:215], v[164:167], v[228:231], 0
    v_mfma_f32_16x16x32_bf16 v[216:219], v[168:171], v[228:231], 0
    v_mfma_f32_16x16x32_bf16 v[220:223], v[172:175], v[228:231], 0
    v_mfma_f32_16x16x32_bf16 v[224:227], v[176:179], v[228:231], 0
    s_waitcnt lgkmcnt(0)
    v_mfma_f32_16x16x32_bf16 v[204:207], v[180:183], v[232:235], v[204:207]
    v_mfma_f32_16x16x32_bf16 v[208:211], v[184:187], v[232:235], v[208:211]
    v_mfma_f32_16x16x32_bf16 v[212:215], v[188:191], v[232:235], v[212:215]
    v_mfma_f32_16x16x32_bf16 v[216:219], v[192:195], v[232:235], v[216:219]
    v_mfma_f32_16x16x32_bf16 v[220:223], v[196:199], v[232:235], v[220:223]
    v_mfma_f32_16x16x32_bf16 v[224:227], v[200:203], v[232:235], v[224:227]
    s_branch L_gpw
.p2align 12
.p2align 3
L_topp3:
    s_barrier
L_bodyp3:
    s_setprio 2
.p2align 3
    v_mfma_f32_16x16x32_bf16 v[24:27], v[84:87], v[124:127], v[24:27]
    ds_read_b128 v[108:111], v240 offset:0
    v_mfma_f32_16x16x32_bf16 v[28:31], v[88:91], v[124:127], v[28:31]
    ds_read_b64_tr_b16 v[72:73], v5 offset:0
    v_mfma_f32_16x16x32_bf16 v[32:35], v[92:95], v[124:127], v[32:35]
    ds_read_b64_tr_b16 v[74:75], v5 offset:768
    v_mfma_f32_16x16x32_bf16 v[44:47], v[92:95], v[128:131], v[44:47]
    ds_read_b64_tr_b16 v[76:77], v5 offset:32
    v_mfma_f32_16x16x32_bf16 v[40:43], v[88:91], v[128:131], v[40:43]
    ds_read_b64_tr_b16 v[78:79], v5 offset:800
    v_mfma_f32_16x16x32_bf16 v[36:39], v[84:87], v[128:131], v[36:39]
    ds_read_b64_tr_b16 v[80:81], v5 offset:64
    v_mfma_f32_16x16x32_bf16 v[48:51], v[84:87], v[132:135], v[48:51]
    ds_read_b64_tr_b16 v[82:83], v5 offset:832
    v_mfma_f32_16x16x32_bf16 v[52:55], v[88:91], v[132:135], v[52:55]
    ds_read_b128 v[112:115], v241 offset:0
    v_mfma_f32_16x16x32_bf16 v[56:59], v[92:95], v[132:135], v[56:59]
    ds_read_b128 v[116:119], v242 offset:0
    s_setprio 1
.p2align 3
    v_mfma_f32_16x16x32_bf16 v[24:27], v[96:99], v[140:143], v[24:27]
    ds_read_b64_tr_b16 v[84:85], v5 offset:6208
    v_mfma_f32_16x16x32_bf16 v[28:31], v[100:103], v[140:143], v[28:31]
    ds_read_b64_tr_b16 v[86:87], v5 offset:6976
    v_mfma_f32_16x16x32_bf16 v[32:35], v[104:107], v[140:143], v[32:35]
    ds_read_b64_tr_b16 v[88:89], v5 offset:6240
    v_mfma_f32_16x16x32_bf16 v[44:47], v[104:107], v[144:147], v[44:47]
    ds_read_b128 v[140:143], v240 offset:128
    ds_read_b64_tr_b16 v[90:91], v5 offset:7008
    v_mfma_f32_16x16x32_bf16 v[40:43], v[100:103], v[144:147], v[40:43]
    ds_read_b64_tr_b16 v[92:93], v5 offset:6272
    v_mfma_f32_16x16x32_bf16 v[36:39], v[96:99], v[144:147], v[36:39]
    ds_read_b64_tr_b16 v[94:95], v5 offset:7040
    v_mfma_f32_16x16x32_bf16 v[48:51], v[96:99], v[148:151], v[48:51]
    ds_read_b128 v[144:147], v241 offset:128
    ds_read_b128 v[124:127], v240 offset:64
    v_mfma_f32_16x16x32_bf16 v[52:55], v[100:103], v[148:151], v[52:55]
    ds_read_b128 v[128:131], v241 offset:64
    v_mfma_f32_16x16x32_bf16 v[56:59], v[104:107], v[148:151], v[56:59]
    ds_read_b128 v[132:135], v242 offset:64
    ds_read_b128 v[148:151], v242 offset:128
L_midp3:
    s_waitcnt lgkmcnt(12)
    s_setprio 0
.p2align 3
    v_mfma_f32_16x16x32_bf16 v[24:27], v[72:75], v[108:111], v[24:27]
    ds_read_b64 v[236:237], v7 offset:128
    v_mfma_f32_16x16x32_bf16 v[28:31], v[76:79], v[108:111], v[28:31]
    ds_read_b64_tr_b16 v[96:97], v5 offset:12416
    v_mfma_f32_16x16x32_bf16 v[32:35], v[80:83], v[108:111], v[32:35]
    ds_read_b64_tr_b16 v[98:99], v5 offset:13184
    v_mfma_f32_16x16x32_bf16 v[44:47], v[80:83], v[112:115], v[44:47]
    ds_read_b64_tr_b16 v[100:101], v5 offset:12448
    v_mfma_f32_16x16x32_bf16 v[40:43], v[76:79], v[112:115], v[40:43]
    ds_read_b64_tr_b16 v[102:103], v5 offset:13216
    v_mfma_f32_16x16x32_bf16 v[36:39], v[72:75], v[112:115], v[36:39]
    s_add_u32 s35, s35, 1
    s_and_b32 s36, s35, 3
    v_mfma_f32_16x16x32_bf16 v[48:51], v[72:75], v[116:119], v[48:51]
    s_mul_i32 s36, s36, 18624
    ds_read_b64_tr_b16 v[104:105], v5 offset:12480
    v_mfma_f32_16x16x32_bf16 v[52:55], v[76:79], v[116:119], v[52:55]
    ds_read_b64_tr_b16 v[106:107], v5 offset:13248
    v_mfma_f32_16x16x32_bf16 v[56:59], v[80:83], v[116:119], v[56:59]
    v_add_u32 v7, 128, v7
    v_add_u32 v5, s36, v4
    s_waitcnt lgkmcnt(6)
    v_xor_b32 v236, v236, v15
    v_xor_b32 v237, v237, v15
    v_lshlrev_b32_sdwa v240, 4, v236 dst_sel:DWORD dst_unused:UNUSED_PAD src0_sel:DWORD src1_sel:WORD_0
    v_lshlrev_b32_sdwa v241, 4, v236 dst_sel:DWORD dst_unused:UNUSED_PAD src0_sel:DWORD src1_sel:WORD_1
    v_lshlrev_b32_sdwa v242, 4, v237 dst_sel:DWORD dst_unused:UNUSED_PAD src0_sel:DWORD src1_sel:WORD_0
L_endp3:
    s_bitcmp1_b32 s3, s35
    s_waitcnt vmcnt(0) lgkmcnt(0)
    s_cbranch_scc0 L_topp3
    s_bitcmp1_b32 s99, s35
    s_cbranch_scc1 L_spp3
    s_barrier
    s_bitcmp1_b32 s39, s35
    s_cbranch_scc0 L_spp3
    s_call_b64 s[76:77], L_dma
L_spp3:
    s_bitcmp1_b32 s37, s35
    s_cbranch_scc0 L_pn3
    s_call_b64 s[76:77], L_gp
L_pn3:
    s_cmp_lg_u32 s35, 9
    s_cbranch_scc1 L_bodyp3
    s_branch L_last3
.p2align 3
L_topp4:
    s_barrier
L_bodyp4:
    s_setprio 2
.p2align 3
    v_mfma_f32_16x16x32_bf16 v[24:27], v[84:87], v[124:127], v[24:27]
    ds_read_b128 v[108:111], v240 offset:0
    v_mfma_f32_16x16x32_bf16 v[28:31], v[88:91], v[124:127], v[28:31]
    ds_read_b64_tr_b16 v[72:73], v5 offset:0
    v_mfma_f32_16x16x32_bf16 v[32:35], v[92:95], v[124:127], v[32:35]
    ds_read_b64_tr_b16 v[74:75], v5 offset:768
    v_mfma_f32_16x16x32_bf16 v[44:47], v[92:95], v[128:131], v[44:47]
    ds_read_b64_tr_b16 v[76:77], v5 offset:32
    v_mfma_f32_16x16x32_bf16 v[40:43], v[88:91], v[128:131], v[40:43]
    ds_read_b64_tr_b16 v[78:79], v5 offset:800
    v_mfma_f32_16x16x32_bf16 v[36:39], v[84:87], v[128:131], v[36:39]
    ds_read_b64_tr_b16 v[80:81], v5 offset:64
    v_mfma_f32_16x16x32_bf16 v[48:51], v[84:87], v[132:135], v[48:51]
    ds_read_b64_tr_b16 v[82:83], v5 offset:832
    v_mfma_f32_16x16x32_bf16 v[52:55], v[88:91], v[132:135], v[52:55]
    ds_read_b128 v[112:115], v241 offset:0
    v_mfma_f32_16x16x32_bf16 v[56:59], v[92:95], v[132:135], v[56:59]
    ds_read_b128 v[116:119], v242 offset:0
    v_mfma_f32_16x16x32_bf16 v[68:71], v[92:95], v[136:139], v[68:71]
    ds_read_b128 v[120:123], v243 offset:0
    v_mfma_f32_16x16x32_bf16 v[64:67], v[88:91], v[136:139], v[64:67]
    v_mfma_f32_16x16x32_bf16 v[60:63], v[84:87], v[136:139], v[60:63]
    s_setprio 1
.p2align 3
    v_mfma_f32_16x16x32_bf16 v[24:27], v[96:99], v[140:143], v[24:27]
    ds_read_b64_tr_b16 v[84:85], v5 offset:6208
    v_mfma_f32_16x16x32_bf16 v[28:31], v[100:103], v[140:143], v[28:31]
    ds_read_b64_tr_b16 v[86:87], v5 offset:6976
    v_mfma_f32_16x16x32_bf16 v[32:35], v[104:107], v[140:143], v[32:35]
    ds_read_b64_tr_b16 v[88:89], v5 offset:6240
    v_mfma_f32_16x16x32_bf16 v[44:47], v[104:107], v[144:147], v[44:47]
    ds_read_b128 v[140:143], v240 offset:128
    v_mfma_f32_16x16x32_bf16 v[40:43], v[100:103], v[144:147], v[40:43]
    ds_read_b64_tr_b16 v[90:91], v5 offset:7008
    v_mfma_f32_16x16x32_bf16 v[36:39], v[96:99], v[144:147], v[36:39]
    ds_read_b64_tr_b16 v[92:93], v5 offset:6272
    v_mfma_f32_16x16x32_bf16 v[48:51], v[96:99], v[148:151], v[48:51]
    ds_read_b128 v[144:147], v241 offset:128
    v_mfma_f32_16x16x32_bf16 v[52:55], v[100:103], v[148:151], v[52:55]
    ds_read_b64_tr_b16 v[94:95], v5 offset:7040
    v_mfma_f32_16x16x32_bf16 v[56:59], v[104:107], v[148:151], v[56:59]
    ds_read_b128 v[124:127], v240 offset:64
    v_mfma_f32_16x16x32_bf16 v[68:71], v[104:107], v[152:155], v[68:71]
    ds_read_b128 v[148:151], v242 offset:128
    ds_read_b128 v[128:131], v241 offset:64
    v_mfma_f32_16x16x32_bf16 v[64:67], v[100:103], v[152:155], v[64:67]
    ds_read_b128 v[132:135], v242 offset:64
    v_mfma_f32_16x16x32_bf16 v[60:63], v[96:99], v[152:155], v[60:63]
    ds_read_b128 v[136:139], v243 offset:64
    ds_read_b128 v[152:155], v243 offset:128
L_midp4:
    s_waitcnt lgkmcnt(14)
    s_setprio 0
.p2align 3
    v_mfma_f32_16x16x32_bf16 v[24:27], v[72:75], v[108:111], v[24:27]
    ds_read_b64 v[236:237], v7 offset:128
    v_mfma_f32_16x16x32_bf16 v[28:31], v[76:79], v[108:111], v[28:31]
    ds_read_b64_tr_b16 v[96:97], v5 offset:12416
    v_mfma_f32_16x16x32_bf16 v[32:35], v[80:83], v[108:111], v[32:35]
    ds_read_b64_tr_b16 v[98:99], v5 offset:13184
    v_mfma_f32_16x16x32_bf16 v[44:47], v[80:83], v[112:115], v[44:47]
    ds_read_b64_tr_b16 v[100:101], v5 offset:12448
    v_mfma_f32_16x16x32_bf16 v[40:43], v[76:79], v[112:115], v[40:43]
    ds_read_b64_tr_b16 v[102:103], v5 offset:13216
    v_mfma_f32_16x16x32_bf16 v[36:39], v[72:75], v[112:115], v[36:39]
    s_add_u32 s35, s35, 1
    s_and_b32 s36, s35, 3
    v_mfma_f32_16x16x32_bf16 v[48:51], v[72:75], v[116:119], v[48:51]
    s_mul_i32 s36, s36, 18624
    ds_read_b64_tr_b16 v[104:105], v5 offset:12480
    v_mfma_f32_16x16x32_bf16 v[52:55], v[76:79], v[116:119], v[52:55]
    ds_read_b64_tr_b16 v[106:107], v5 offset:13248
    v_mfma_f32_16x16x32_bf16 v[56:59], v[80:83], v[116:119], v[56:59]
    v_add_u32 v7, 128, v7
    v_add_u32 v5, s36, v4
    v_mfma_f32_16x16x32_bf16 v[68:71], v[80:83], v[120:123], v[68:71]
    s_waitcnt lgkmcnt(6)
    v_xor_b32 v236, v236, v15
    v_mfma_f32_16x16x32_bf16 v[64:67], v[76:79], v[120:123], v[64:67]
    v_xor_b32 v237, v237, v15
    v_lshlrev_b32_sdwa v240, 4, v236 dst_sel:DWORD dst_unused:UNUSED_PAD src0_sel:DWORD src1_sel:WORD_0
    v_mfma_f32_16x16x32_bf16 v[60:63], v[72:75], v[120:123], v[60:63]
    v_lshlrev_b32_sdwa v241, 4, v236 dst_sel:DWORD dst_unused:UNUSED_PAD src0_sel:DWORD src1_sel:WORD_1
    v_lshlrev_b32_sdwa v242, 4, v237 dst_sel:DWORD dst_unused:UNUSED_PAD src0_sel:DWORD src1_sel:WORD_0
    v_lshlrev_b32_sdwa v243, 4, v237 dst_sel:DWORD dst_unused:UNUSED_PAD src0_sel:DWORD src1_sel:WORD_1
L_endp4:
    s_bitcmp1_b32 s3, s35
    s_waitcnt vmcnt(0) lgkmcnt(0)
    s_cbranch_scc0 L_topp4
    s_bitcmp1_b32 s99, s35
    s_cbranch_scc1 L_spp4
    s_barrier
    s_bitcmp1_b32 s39, s35
    s_cbranch_scc0 L_spp4
    s_call_b64 s[76:77], L_dma
L_spp4:
    s_bitcmp1_b32 s37, s35
    s_cbranch_scc0 L_pn4
    s_call_b64 s[76:77], L_gp
L_pn4:
    s_cmp_lg_u32 s35, 9
    s_cbranch_scc1 L_bodyp4
    s_branch L_last4
L_pf2:
    s_cmp_eq_u32 s30, 2
    s_cbranch_scc0 L_pf5
    s_waitcnt lgkmcnt(3)
    v_mfma_f32_16x16x32_bf16 v[24:27], v[72:75], v[108:111], v[24:27]
    ds_read_b64_tr_b16 v[84:85], v5 offset:6208
    ds_read_b64_tr_b16 v[86:87], v5 offset:6976
    v_mfma_f32_16x16x32_bf16 v[28:31], v[76:79], v[108:111], v[28:31]
    ds_read_b64_tr_b16 v[88:89], v5 offset:6240
    ds_read_b64_tr_b16 v[90:91], v5 offset:7008
    v_mfma_f32_16x16x32_bf16 v[32:35], v[80:83], v[108:111], v[32:35]
    ds_read_b64_tr_b16 v[92:93], v5 offset:6272
    ds_read_b64_tr_b16 v[94:95], v5 offset:7040
    s_waitcnt lgkmcnt(8)
    v_mfma_f32_16x16x32_bf16 v[44:47], v[80:83], v[112:115], v[44:47]
    ds_read_b128 v[124:127], v240 offset:64
    ds_read_b128 v[128:131], v241 offset:64
    v_mfma_f32_16x16x32_bf16 v[40:43], v[76:79], v[112:115], v[40:43]
    ds_read_b128 v[140:143], v240 offset:128
    ds_read_b128 v[144:147], v241 offset:128
    v_mfma_f32_16x16x32_bf16 v[36:39], v[72:75], v[112:115], v[36:39]
    ds_read_b64 v[236:237], v7 offset:128
    ds_read_b64_tr_b16 v[96:97], v5 offset:12416
    ds_read_b64_tr_b16 v[98:99], v5 offset:13184
    ds_read_b64_tr_b16 v[100:101], v5 offset:12448
    ds_read_b64_tr_b16 v[102:103], v5 offset:13216
    ds_read_b64_tr_b16 v[104:105], v5 offset:12480
    ds_read_b64_tr_b16 v[106:107], v5 offset:13248
    s_add_u32 s35, s35, 1
    s_and_b32 s36, s35, 3
    s_mul_i32 s36, s36, 18624
    v_add_u32 v7, 128, v7
    v_add_u32 v5, s36, v4
    s_waitcnt lgkmcnt(6)
    v_xor_b32 v236, v236, v15
    v_lshlrev_b32_sdwa v240, 4, v236 dst_sel:DWORD dst_unused:UNUSED_PAD src0_sel:DWORD src1_sel:WORD_0
    v_lshlrev_b32_sdwa v241, 4, v236 dst_sel:DWORD dst_unused:UNUSED_PAD src0_sel:DWORD src1_sel:WORD_1
    s_branch L_endp2
L_pf5:
    s_waitcnt lgkmcnt(3)
    v_mfma_f32_16x16x32_bf16 v[24:27], v[72:75], v[108:111], v[24:27]
    ds_read_b64_tr_b16 v[84:85], v5 offset:6208
    ds_read_b64_tr_b16 v[86:87], v5 offset:6976
    v_mfma_f32_16x16x32_bf16 v[28:31], v[76:79], v[108:111], v[28:31]
    ds_read_b64_tr_b16 v[88:89], v5 offset:6240
    ds_read_b64_tr_b16 v[90:91], v5 offset:7008
    v_mfma_f32_16x16x32_bf16 v[32:35], v[80:83], v[108:111], v[32:35]
    ds_read_b64_tr_b16 v[92:93], v5 offset:6272
    ds_read_b64_tr_b16 v[94:95], v5 offset:7040
    ds_read_b128 v[124:127], v240 offset:64
    ds_read_b128 v[140:143], v240 offset:128
    ds_read_b64 v[236:237], v7 offset:128
    ds_read_b64_tr_b16 v[96:97], v5 offset:12416
    ds_read_b64_tr_b16 v[98:99], v5 offset:13184
    ds_read_b64_tr_b16 v[100:101], v5 offset:12448
    ds_read_b64_tr_b16 v[102:103], v5 offset:13216
    ds_read_b64_tr_b16 v[104:105], v5 offset:12480
    ds_read_b64_tr_b16 v[106:107], v5 offset:13248
    s_add_u32 s35, s35, 1
    s_and_b32 s36, s35, 3
    s_mul_i32 s36, s36, 18624
    v_add_u32 v7, 128, v7
    v_add_u32 v5, s36, v4
    s_waitcnt lgkmcnt(6)
    v_xor_b32 v236, v236, v15
    v_lshlrev_b32_sdwa v240, 4, v236 dst_sel:DWORD dst_unused:UNUSED_PAD src0_sel:DWORD src1_sel:WORD_0
    s_branch L_endp1
.p2align 3
L_topp2:
    s_barrier
L_bodyp2:
    s_setprio 2
.p2align 3
    v_mfma_f32_16x16x32_bf16 v[24:27], v[84:87], v[124:127], v[24:27]
    ds_read_b128 v[108:111], v240 offset:0
    v_mfma_f32_16x16x32_bf16 v[28:31], v[88:91], v[124:127], v[28:31]
    ds_read_b64_tr_b16 v[72:73], v5 offset:0
    v_mfma_f32_16x16x32_bf16 v[32:35], v[92:95], v[124:127], v[32:35]
    ds_read_b64_tr_b16 v[74:75], v5 offset:768
    v_mfma_f32_16x16x32_bf16 v[44:47], v[92:95], v[128:131], v[44:47]
    ds_read_b64_tr_b16 v[76:77], v5 offset:32
    v_mfma_f32_16x16x32_bf16 v[40:43], v[88:91], v[128:131], v[40:43]
    ds_read_b64_tr_b16 v[78:79], v5 offset:800
    v_mfma_f32_16x16x32_bf16 v[36:39], v[84:87], v[128:131], v[36:39]
    ds_read_b64_tr_b16 v[80:81], v5 offset:64
    ds_read_b64_tr_b16 v[82:83], v5 offset:832
    ds_read_b128 v[112:115], v241 offset:0
    s_setprio 1
.p2align 3
    v_mfma_f32_16x16x32_bf16 v[24:27], v[96:99], v[140:143], v[24:27]
    ds_read_b64_tr_b16 v[84:85], v5 offset:6208
    ds_read_b64_tr_b16 v[86:87], v5 offset:6976
    v_mfma_f32_16x16x32_bf16 v[28:31], v[100:103], v[140:143], v[28:31]
    ds_read_b64_tr_b16 v[88:89], v5 offset:6240
    ds_read_b64_tr_b16 v[90:91], v5 offset:7008
    v_mfma_f32_16x16x32_bf16 v[32:35], v[104:107], v[140:143], v[32:35]
    ds_read_b64_tr_b16 v[92:93], v5 offset:6272
    ds_read_b64_tr_b16 v[94:95], v5 offset:7040
    v_mfma_f32_16x16x32_bf16 v[44:47], v[104:107], v[144:147], v[44:47]
    ds_read_b128 v[140:143], v240 offset:128
    ds_read_b128 v[124:127], v240 offset:64
    v_mfma_f32_16x16x32_bf16 v[40:43], v[100:103], v[144:147], v[40:43]
    ds_read_b128 v[128:131], v241 offset:64
    v_mfma_f32_16x16x32_bf16 v[36:39], v[96:99], v[144:147], v[36:39]
    ds_read_b128 v[144:147], v241 offset:128
L_midp2:
    s_waitcnt lgkmcnt(10)
    s_setprio 0
.p2align 3
    v_mfma_f32_16x16x32_bf16 v[24:27], v[72:75], v[108:111], v[24:27]
    ds_read_b64 v[236:237], v7 offset:128
    v_mfma_f32_16x16x32_bf16 v[28:31], v[76:79], v[108:111], v[28:31]
    ds_read_b64_tr_b16 v[96:97], v5 offset:12416
    v_mfma_f32_16x16x32_bf16 v[32:35], v[80:83], v[108:111], v[32:35]
    ds_read_b64_tr_b16 v[98:99], v5 offset:13184
    v_mfma_f32_16x16x32_bf16 v[44:47], v[80:83], v[112:115], v[44:47]
    ds_read_b64_tr_b16 v[100:101], v5 offset:12448
    v_mfma_f32_16x16x32_bf16 v[40:43], v[76:79], v[112:115], v[40:43]
    ds_read_b64_tr_b16 v[102:103], v5 offset:13216
    v_mfma_f32_16x16x32_bf16 v[36:39], v[72:75], v[112:115], v[36:39]
    s_add_u32 s35, s35, 1
    s_and_b32 s36, s35, 3
    s_mul_i32 s36, s36, 18624
    ds_read_b64_tr_b16 v[104:105], v5 offset:12480
    ds_read_b64_tr_b16 v[106:107], v5 offset:13248
    v_add_u32 v7, 128, v7
    v_add_u32 v5, s36, v4
    s_waitcnt lgkmcnt(6)
    v_xor_b32 v236, v236, v15
    v_lshlrev_b32_sdwa v240, 4, v236 dst_sel:DWORD dst_unused:UNUSED_PAD src0_sel:DWORD src1_sel:WORD_0
    v_lshlrev_b32_sdwa v241, 4, v236 dst_sel:DWORD dst_unused:UNUSED_PAD src0_sel:DWORD src1_sel:WORD_1
L_endp2:
    s_bitcmp1_b32 s3, s35
    s_waitcnt vmcnt(0) lgkmcnt(0)
    s_cbranch_scc0 L_topp2
    s_bitcmp1_b32 s99, s35
    s_cbranch_scc1 L_spp2
    s_barrier
    s_bitcmp1_b32 s39, s35
    s_cbranch_scc0 L_spp2
    s_call_b64 s[76:77], L_dma
L_spp2:
    s_bitcmp1_b32 s37, s35
    s_cbranch_scc0 L_pn2
    s_call_b64 s[76:77], L_gp
L_pn2:
    s_cmp_lg_u32 s35, 9
    s_cbranch_scc1 L_bodyp2
    s_branch L_last2
.p2align 3
L_topp1:
    s_barrier
L_bodyp1:
    s_setprio 2
.p2align 3
    v_mfma_f32_16x16x32_bf16 v[24:27], v[84:87], v[124:127], v[24:27]
    ds_read_b128 v[108:111], v240 offset:0
    v_mfma_f32_16x16x32_bf16 v[28:31], v[88:91], v[124:127], v[28:31]
    ds_read_b64_tr_b16 v[72:73], v5 offset:0
    v_mfma_f32_16x16x32_bf16 v[32:35], v[92:95], v[124:127], v[32:35]
    ds_read_b64_tr_b16 v[74:75], v5 offset:768
    ds_read_b64_tr_b16 v[76:77], v5 offset:32
    ds_read_b64_tr_b16 v[78:79], v5 offset:800
    ds_read_b64_tr_b16 v[80:81], v5 offset:64
    ds_read_b64_tr_b16 v[82:83], v5 offset:832
    s_setprio 1
.p2align 3
    v_mfma_f32_16x16x32_bf16 v[24:27], v[96:99], v[140:143], v[24:27]
    ds_read_b64_tr_b16 v[84:85], v5 offset:6208
    ds_read_b64_tr_b16 v[86:87], v5 offset:6976
    ds_read_b64_tr_b16 v[88:89], v5 offset:6240
    v_mfma_f32_16x16x32_bf16 v[28:31], v[100:103], v[140:143], v[28:31]
    ds_read_b64_tr_b16 v[90:91], v5 offset:7008
    ds_read_b64_tr_b16 v[92:93], v5 offset:6272
    ds_read_b64_tr_b16 v[94:95], v5 offset:7040
    v_mfma_f32_16x16x32_bf16 v[32:35], v[104:107], v[140:143], v[32:35]
    ds_read_b128 v[124:127], v240 offset:64
    ds_read_b128 v[140:143], v240 offset:128
L_midp1:
    s_waitcnt lgkmcnt(8)
    s_setprio 0
.p2align 3
    v_mfma_f32_16x16x32_bf16 v[24:27], v[72:75], v[108:111], v[24:27]
    ds_read_b64 v[236:237], v7 offset:128
    v_mfma_f32_16x16x32_bf16 v[28:31], v[76:79], v[108:111], v[28:31]
    ds_read_b64_tr_b16 v[96:97], v5 offset:12416
    v_mfma_f32_16x16x32_bf16 v[32:35], v[80:83], v[108:111], v[32:35]
    ds_read_b64_tr_b16 v[98:99], v5 offset:13184
    ds_read_b64_tr_b16 v[100:101], v5 offset:12448
    ds_read_b64_tr_b16 v[102:103], v5 offset:13216
    s_add_u32 s35, s35, 1
    s_and_b32 s36, s35, 3
    s_mul_i32 s36, s36, 18624
    ds_read_b64_tr_b16 v[104:105], v5 offset:12480
    ds_read_b64_tr_b16 v[106:107], v5 offset:13248
    v_add_u32 v7, 128, v7
    v_add_u32 v5, s36, v4
    s_waitcnt lgkmcnt(6)
    v_xor_b32 v236, v236, v15
    v_lshlrev_b32_sdwa v240, 4, v236 dst_sel:DWORD dst_unused:UNUSED_PAD src0_sel:DWORD src1_sel:WORD_0
L_endp1:
    s_bitcmp1_b32 s3, s35
    s_waitcnt vmcnt(0) lgkmcnt(0)
    s_cbranch_scc0 L_topp1
    s_bitcmp1_b32 s99, s35
    s_cbranch_scc1 L_spp1
    s_barrier
    s_bitcmp1_b32 s39, s35
    s_cbranch_scc0 L_spp1
    s_call_b64 s[76:77], L_dma
L_spp1:
    s_bitcmp1_b32 s37, s35
    s_cbranch_scc0 L_pn1
    s_call_b64 s[76:77], L_gp
L_pn1:
    s_cmp_lg_u32 s35, 9
    s_cbranch_scc1 L_bodyp1
    s_branch L_last1
.p2align 12
L_startD:
    s_lshr_b32 s26, s28, 2
    s_lshl_b32 s26, s26, 1
    s_add_u32 s26, s26, s29
    s_mul_i32 s96, s26, 8064
    s_add_u32 s96, s96, s3
    buffer_load_dwordx3 v[204:206], v228, s[8:11], s96 offen
    s_sub_u32 s34, s32, 2
    s_bfe_u32 s100, s23, 0x10011
    s_lshl_b32 s101, s100, 1
    s_sub_u32 s101, 19, s101
    s_bfe_u32 s96, s23, 0x10010
    s_sub_u32 s33, s33, s96
    s_sub_u32 s33, s33, 1
    s_movk_i32 s97, 223
    v_add_u32 v74, s34, v76
    v_subrev_u32 v75, s100, v76
    v_med3_i32 v74, v74, 0, s97
    v_cmp_ge_u32 vcc, s101, v75
    v_mul_u32_u24 v74, 192, v74
    s_and_b64 s[92:93], s[92:93], vcc
    v_add_u32 v20, v74, v20
    s_cmp_lt_u32 s28, 4
    s_cbranch_scc1 L_startAD
    s_max_i32 s96, s20, 0
    s_add_u32 m0, s94, 0
    s_mov_b64 exec, s[92:93]
    s_add_u32 s20, s20, 43008
    buffer_load_dwordx4 v20, s[4:7], s96 offen lds
    s_max_i32 s96, s20, 0
    s_addk_i32 m0, 3904
    s_add_u32 s20, s20, 43008
    buffer_load_dwordx4 v20, s[4:7], s96 offen lds
    s_min_i32 s96, s20, s21
    s_addk_i32 m0, 3904
    s_add_u32 s20, s20, 43008
    buffer_load_dwordx4 v20, s[4:7], s96 offen lds
    s_min_i32 s96, s20, s21
    s_addk_i32 m0, 3904
    s_add_u32 s20, s20, 43008
    buffer_load_dwordx4 v20, s[4:7], s96 offen lds
    s_min_i32 s96, s20, s21
    s_addk_i32 m0, 3904
    s_add_u32 s20, s20, 43008
    buffer_load_dwordx4 v20, s[4:7], s96 offen lds
    s_min_i32 s96, s20, s21
    s_addk_i32 m0, 3904
    s_add_u32 s20, s20, 43008
    buffer_load_dwordx4 v20, s[4:7], s96 offen lds
    s_min_i32 s96, s20, s21
    s_addk_i32 m0, 3904
    s_add_u32 s20, s20, 43008
    buffer_load_dwordx4 v20, s[4:7], s96 offen lds
    s_min_i32 s96, s20, s21
    s_addk_i32 m0, 3904
    s_add_u32 s20, s20, 43008
    buffer_load_dwordx4 v20, s[4:7], s96 offen lds
    s_mov_b64 exec, -1
    s_waitcnt vmcnt(8)
    s_call_b64 s[76:77], L_dsetup
    s_add_u32 m0, s90, 20672
    s_mov_b32 s96, 20480
    buffer_load_dwordx4 v19, s[12:15], s96 offen lds
    s_add_u32 m0, s88, 24832
    s_mov_b32 s96, 24576
    buffer_load_dwordx4 v19, s[12:15], s96 offen lds
    s_add_u32 m0, s89, 28960
    s_mov_b32 s96, 28672
    buffer_load_dwordx4 v19, s[12:15], s96 offen lds
    s_add_u32 m0, s90, 33088
    s_mov_b32 s96, 32768
    buffer_load_dwordx4 v19, s[12:15], s96 offen lds
    s_waitcnt vmcnt(4)
    s_branch L_dfirst
L_startAD:
    s_add_u32 s20, s20, 344064
    s_add_u32 m0, s94, 31232
    s_mov_b64 exec, s[92:93]
    s_cmp_lt_u32 s23, 150994944
    s_cbranch_scc1 L_ad1
    s_min_i32 s96, s20, s21
    s_add_u32 s20, s20, 43008
    buffer_load_dwordx4 v20, s[4:7], s96 offen lds
    s_addk_i32 m0, 3904
    s_cmp_lt_u32 s23, 167772160
    s_cbranch_scc1 L_ad1
    s_min_i32 s96, s20, s21
    s_add_u32 s20, s20, 43008
    buffer_load_dwordx4 v20, s[4:7], s96 offen lds
    s_addk_i32 m0, 3904
    s_cmp_lt_u32 s23, 184549376
    s_cbranch_scc1 L_ad1
    s_min_i32 s96, s20, s21
    s_add_u32 s20, s20, 43008
    buffer_load_dwordx4 v20, s[4:7], s96 offen lds
    s_addk_i32 m0, 3904
    s_cmp_lt_u32 s23, 201326592
    s_cbranch_scc1 L_ad1
    s_min_i32 s96, s20, s21
    s_add_u32 s20, s20, 43008
    buffer_load_dwordx4 v20, s[4:7], s96 offen lds
    s_addk_i32 m0, 3904
L_ad1:
    s_mov_b64 exec, -1
    s_lshr_b32 s96, s2, 3
    s_and_b32 s96, s96, 31
    s_lshl_b32 s96, s96, 2
    s_add_u32 s96, s96, s28
    s_mul_i32 s96, s96, 1152
    s_add_u32 s96, s96, 18432
    v_lshlrev_b32 v23, 3, v16
    s_mov_b64 exec, 0x1ff
    buffer_load_dword v23, v23, s[12:15], s96 offen
    s_mov_b64 exec, -1
    s_cmp_lt_u32 s23, 167772160
    s_cbranch_scc1 L_ad2
    s_cmp_lt_u32 s23, 201326592
    s_cbranch_scc1 L_ad4
    s_waitcnt vmcnt(5)
    s_branch L_ad3
L_ad2:
    s_waitcnt vmcnt(1)
L_ad4:
    s_waitcnt vmcnt(3)
L_ad3:
    s_call_b64 s[76:77], L_dsetup
    s_add_u32 m0, s88, 0
    s_mov_b32 s96, 0
    buffer_load_dwordx4 v19, s[12:15], s96 offen lds
    s_add_u32 m0, s89, 4128
    s_mov_b32 s96, 4096
    buffer_load_dwordx4 v19, s[12:15], s96 offen lds
    s_add_u32 m0, s90, 8256
    s_mov_b32 s96, 8192
    buffer_load_dwordx4 v19, s[12:15], s96 offen lds
    s_add_u32 m0, s88, 12416
    s_mov_b32 s96, 12288
    buffer_load_dwordx4 v19, s[12:15], s96 offen lds
    s_add_u32 m0, s89, 16544
    s_mov_b32 s96, 16384
    buffer_load_dwordx4 v19, s[12:15], s96 offen lds
    s_waitcnt vmcnt(5)
    s_branch L_dfirst
L_dsetup:
    s_sub_u32 s96, s0, s33
    s_mul_i32 s97, s29, 96
    s_sub_u32 s96, s96, 1
    s_add_u32 s98, s97, 89280
    s_mul_i32 s96, s96, 3904
    v_add_u32_sdwa v4, s98, v240 dst_sel:DWORD dst_unused:UNUSED_PAD src0_sel:DWORD src1_sel:WORD_0
    v_add_u32_sdwa v5, s98, v240 dst_sel:DWORD dst_unused:UNUSED_PAD src0_sel:DWORD src1_sel:WORD_0
    s_bfe_u32 s98, s23, 0x40014
    v_add_u32_sdwa v1, s96, v240 dst_sel:DWORD dst_unused:UNUSED_PAD src0_sel:DWORD src1_sel:WORD_1
    v_add_u32_sdwa v2, s96, v241 dst_sel:DWORD dst_unused:UNUSED_PAD src0_sel:DWORD src1_sel:WORD_0
    v_add_u32_sdwa v3, s96, v241 dst_sel:DWORD dst_unused:UNUSED_PAD src0_sel:DWORD src1_sel:WORD_1
    s_mul_i32 s98, s98, 3904
    s_sub_u32 s98, 107904, s98
    s_cmp_lt_u32 s28, 4
    s_cselect_b32 s98, 0, s98
    s_mul_i32 s96, s31, 3904
    s_add_u32 s96, s96, s98
    s_add_u32 s97, s97, s96
    v_add_u32_sdwa v21, s97, v242 dst_sel:DWORD dst_unused:UNUSED_PAD src0_sel:DWORD src1_sel:WORD_0
    s_mul_i32 s97, s29, 3904
    s_add_u32 s97, s97, s96
    v_add_u32_sdwa v248, s97, v242 dst_sel:DWORD dst_unused:UNUSED_PAD src0_sel:DWORD src1_sel:WORD_1
    v_add_u32_sdwa v249, s97, v243 dst_sel:DWORD dst_unused:UNUSED_PAD src0_sel:DWORD src1_sel:WORD_0
    v_add_u32_sdwa v250, s97, v243 dst_sel:DWORD dst_unused:UNUSED_PAD src0_sel:DWORD src1_sel:WORD_1
    v_cvt_f32_u32 v222, s32
    v_cvt_f32_u32 v220, s0
    v_bfe_u32 v238, v226, 8, 8
    v_add_f32 v221, v222, v224
    v_add_f32 v220, v220, v225
    v_and_b32 v251, 0xffff, v235
    v_add_f32 v222, 1.0, v221
    v_add_f32 v223, 2.0, v221
    v_mov_b32 v236, 0xf400f40
    s_mov_b32 s91, 0x435f435f
    s_mov_b32 s97, 0
    s_lshr_b64 s[70:71], s[24:25], s97
    s_bfe_u32 s69, s70, 0x5000b
    s_and_b32 s68, s70, 0x7ff
    s_lshl_b32 s69, s69, 2
    s_lshl_b32 s68, s68, 6
    s_mov_b32 s25, s68
    s_bfe_u32 s66, s28, 0x10001
    s_mul_i32 s66, s66, 4608
    s_add_u32 s66, s66, 65536
    s_add_u32 s96, s26, s31
    s_mul_i32 s67, s96, 1792
    s_add_u32 s67, s67, 74752
    s_mul_i32 s96, s96, s69
    s_mul_i32 s96, s96, 192
    s_add_u32 s68, s96, s25
    s_cmp_lt_u32 s26, s30
    s_cselect_b32 s40, 1, 0
    s_mov_b32 s42, s26
    s_bfe_u32 s96, s23, 0x50018
    s_sub_u32 s96, s96, 1
    v_mov_b32 v229, 0
    v_mov_b32 v230, s96
    v_lshrrev_b32 v240, 16, v235
    s_branch L_tables1
L_tables:
    s_mov_b32 s42, 0
L_tables1:
    s_mov_b32 exec_hi, 0xffff
    s_mov_b32 s43, 0
    s_mov_b32 s27, 0
L_tl:
    s_bitcmp1_b32 s40, 0
    s_cbranch_scc0 L_tn
    s_mul_i32 s96, s42, 1152
    v_cvt_f32_u32 v237, s42
    s_add_u32 s96, s96, s66
    v_add_f32 v237, v237, v220
    v_add_u32 v231, s96, v227
    v_lshlrev_b32 v77, 16, v204
    v_lshlrev_b32 v161, 16, v205
    v_lshlrev_b32 v185, 16, v206
    v_and_b32 v78, 0xffff0000, v204
    v_and_b32 v162, 0xffff0000, v205
    v_and_b32 v186, 0xffff0000, v206
    v_add_f32 v77, v77, v237
    v_add_f32 v161, v161, v237
    v_add_f32 v185, v185, v237
    v_add_f32 v78, v78, v221
    v_add_f32 v162, v162, v222
    v_add_f32 v186, v186, v223
    v_cvt_pk_bf16_f32 v76, v77, v78
    v_cvt_pk_bf16_f32 v160, v161, v162
    v_cvt_pk_bf16_f32 v184, v185, v186
    v_pk_max_i16 v76, v76, 0
    v_pk_max_i16 v160, v160, 0
    v_pk_max_i16 v184, v184, 0
    v_pk_min_i16 v76, v76, s91
    v_pk_min_i16 v160, v160, s91
    v_pk_min_i16 v184, v184, s91
    v_lshlrev_b32 v77, 16, v76
    v_lshlrev_b32 v161, 16, v160
    v_lshlrev_b32 v185, 16, v184
    v_and_b32 v78, 0xffff0000, v76
    v_and_b32 v162, 0xffff0000, v160
    v_and_b32 v186, 0xffff0000, v184
    v_fract_f32 v79, v77
    v_fract_f32 v163, v161
    v_fract_f32 v187, v185
    v_fract_f32 v80, v78
    v_fract_f32 v164, v162
    v_fract_f32 v188, v186
    v_cvt_u32_f32 v81, v77
    v_cvt_u32_f32 v165, v161
    v_cvt_u32_f32 v189, v185
    v_cvt_u32_f32 v82, v78
    v_cvt_u32_f32 v166, v162
    v_cvt_u32_f32 v190, v186
    v_cmp_neq_f32 s[44:45], 0, v80
    v_cmp_neq_f32 s[50:51], 0, v164
    v_cmp_neq_f32 s[56:57], 0, v188
    v_cmp_neq_f32 s[46:47], 0, v79
    v_cmp_neq_f32 s[52:53], 0, v163
    v_cmp_neq_f32 s[58:59], 0, v187
    v_sub_f32 v83, 1.0, v79
    v_sub_f32 v167, 1.0, v163
    v_sub_f32 v191, 1.0, v187
    v_sub_f32 v84, 1.0, v80
    v_sub_f32 v168, 1.0, v164
    v_sub_f32 v192, 1.0, v188
    v_subrev_u32 v81, s33, v81
    v_subrev_u32 v165, s33, v165
    v_subrev_u32 v189, s33, v189
    v_subrev_u32 v82, s34, v82
    v_subrev_u32 v166, s34, v166
    v_subrev_u32 v190, s34, v190
    v_cvt_pk_bf16_f32 v77, v83, v84
    v_cvt_pk_bf16_f32 v161, v167, v168
    v_cvt_pk_bf16_f32 v185, v191, v192
    v_sub_u32 v89, v81, v229
    v_sub_u32 v173, v165, v229
    v_sub_u32 v197, v189, v229
    v_addc_co_u32 v91, vcc, 0, v82, s[44:45]
    v_addc_co_u32 v175, vcc, 0, v166, s[50:51]
    v_addc_co_u32 v199, vcc, 0, v190, s[56:57]
    v_lshlrev_b32 v83, 16, v77
    v_lshlrev_b32 v167, 16, v161
    v_lshlrev_b32 v191, 16, v185
    v_and_b32 v84, 0xffff0000, v77
    v_and_b32 v168, 0xffff0000, v161
    v_and_b32 v192, 0xffff0000, v185
    v_addc_co_u32 v90, vcc, 0, v89, s[46:47]
    v_addc_co_u32 v174, vcc, 0, v173, s[52:53]
    v_addc_co_u32 v198, vcc, 0, v197, s[58:59]
    v_mul_u32_u24 v92, 976, v81
    v_mul_u32_u24 v176, 976, v165
    v_mul_u32_u24 v200, 976, v189
    v_mul_f32 v85, v83, v84
    v_mul_f32 v169, v167, v168
    v_mul_f32 v193, v191, v192
    v_mul_f32 v86, v83, v80
    v_mul_f32 v170, v167, v164
    v_mul_f32 v194, v191, v188
    v_mul_f32 v87, v79, v84
    v_mul_f32 v171, v163, v168
    v_mul_f32 v195, v187, v192
    v_mul_f32 v88, v79, v80
    v_mul_f32 v172, v163, v164
    v_mul_f32 v196, v187, v188
    v_max_u32 v89, v89, v90
    v_max_u32 v173, v173, v174
    v_max_u32 v197, v197, v198
    v_subrev_u32 v77, s100, v82
    v_subrev_u32 v161, s100, v166
    v_subrev_u32 v185, s100, v190
    v_subrev_u32 v78, s100, v91
    v_subrev_u32 v162, s100, v175
    v_subrev_u32 v186, s100, v199
    v_mad_u32_u24 v83, v82, 48, v92
    v_mad_u32_u24 v167, v166, 48, v176
    v_mad_u32_u24 v191, v190, 48, v200
    v_mad_u32_u24 v84, v91, 48, v92
    v_mad_u32_u24 v168, v175, 48, v176
    v_mad_u32_u24 v192, v199, 48, v200
    v_and_b32 v82, 12, v82
    v_and_b32 v166, 12, v166
    v_and_b32 v190, 12, v190
    v_and_b32 v91, 12, v91
    v_and_b32 v175, 12, v175
    v_and_b32 v199, 12, v199
    v_max_u32 v77, v77, v78
    v_max_u32 v161, v161, v162
    v_max_u32 v185, v185, v186
    s_andn2_b64 s[48:49], s[46:47], s[44:45]
    s_andn2_b64 s[54:55], s[52:53], s[50:51]
    s_andn2_b64 s[60:61], s[58:59], s[56:57]
    v_add_lshl_u32 v83, v83, v82, 2
    v_add_lshl_u32 v167, v167, v166, 2
    v_add_lshl_u32 v191, v191, v190, 2
    v_add_lshl_u32 v84, v84, v91, 2
    v_add_lshl_u32 v168, v168, v175, 2
    v_add_lshl_u32 v192, v192, v199, 2
    v_cndmask_b32 v86, v87, v86, s[44:45]
    v_cndmask_b32 v170, v171, v170, s[50:51]
    v_cndmask_b32 v194, v195, v194, s[56:57]
    v_cndmask_b32 v78, 0, v236, s[48:49]
    v_cndmask_b32 v162, 0, v236, s[54:55]
    v_cndmask_b32 v186, 0, v236, s[60:61]
    s_and_b64 s[48:49], s[46:47], s[44:45]
    s_and_b64 s[54:55], s[52:53], s[50:51]
    s_and_b64 s[60:61], s[58:59], s[56:57]
    v_cndmask_b32 v87, 0, v87, s[44:45]
    v_cndmask_b32 v171, 0, v171, s[50:51]
    v_cndmask_b32 v195, 0, v195, s[56:57]
    v_cmp_lt_u32 s[46:47], v230, v89
    v_cmp_lt_u32 s[52:53], v230, v173
    v_cmp_lt_u32 s[58:59], v230, v197
    v_cmp_lt_u32 s[44:45], s101, v77
    v_cmp_lt_u32 s[50:51], s101, v161
    v_cmp_lt_u32 s[56:57], s101, v185
    v_lshl_or_b32 v74, v84, 16, v83
    v_lshl_or_b32 v158, v168, 16, v167
    v_lshl_or_b32 v182, v192, 16, v191
    v_cvt_pk_bf16_f32 v73, v85, v86
    v_cvt_pk_bf16_f32 v157, v169, v170
    v_cvt_pk_bf16_f32 v181, v193, v194
    v_cvt_pk_bf16_f32 v75, v87, v88
    v_cvt_pk_bf16_f32 v159, v171, v172
    v_cvt_pk_bf16_f32 v183, v195, v196
    v_and_b32 v78, 0xffff0000, v78
    v_and_b32 v162, 0xffff0000, v162
    v_and_b32 v186, 0xffff0000, v186
    v_cndmask_b32 v77, 0, v236, s[48:49]
    v_cndmask_b32 v161, 0, v236, s[54:55]
    v_cndmask_b32 v185, 0, v236, s[60:61]
    s_or_b64 s[44:45], s[44:45], s[46:47]
    s_or_b64 s[50:51], s[50:51], s[52:53]
    s_or_b64 s[56:57], s[56:57], s[58:59]
    v_add_u32 v72, v74, v78
    v_add_u32 v156, v158, v162
    v_add_u32 v180, v182, v186
    v_add_u32 v74, v74, v77
    v_add_u32 v158, v158, v161
    v_add_u32 v182, v182, v185
    s_or_b64 s[70:71], s[44:45], s[48:49]
    s_cbranch_scc1 L_tx0
L_tw0:
    ds_write_b64 v231, v[72:73] offset:0
    s_or_b64 s[70:71], s[50:51], s[54:55]
    s_cbranch_scc1 L_tx1
L_tw1:
    ds_write_b64 v231, v[156:157] offset:128
    s_or_b64 s[70:71], s[56:57], s[60:61]
    s_cbranch_scc1 L_tx2
L_tw2:
    ds_write_b64 v231, v[180:181] offset:256
L_tn:
    s_lshr_b32 s40, s40, 1
    s_cbranch_scc1 L_tm
    s_mov_b32 exec_hi, -1
    v_lshl_add_u32 v6, v251, 3, s66
    s_setpc_b64 s[76:77]
L_tm:
    v_mov_b32 v204, v208
    v_mov_b32 v205, v209
    v_mov_b32 v206, v210
    v_mov_b32 v208, v212
    v_mov_b32 v209, v213
    v_mov_b32 v210, v214
    v_mov_b32 v212, v216
    v_mov_b32 v213, v217
    v_mov_b32 v214, v218
    s_add_u32 s42, s42, 1
    s_branch L_tl
L_tx0:
    s_andn2_b64 s[48:49], s[48:49], s[44:45]
    s_bcnt1_i32_b64 s96, s[48:49]
    s_add_u32 s96, s96, s27
    s_cmp_gt_u32 s96, s69
    s_cselect_b64 s[44:45], s[70:71], s[44:45]
    s_cselect_b64 s[48:49], 0, s[48:49]
    s_cselect_b32 s96, s27, s96
    v_mbcnt_lo_u32_b32 v76, s48, 0
    v_mbcnt_hi_u32_b32 v76, s49, v76
    v_add_u32 v76, s27, v76
    s_mov_b32 s27, s96
    v_lshl_add_u32 v77, v76, 4, s67
    v_bfe_u32 v78, v76, 1, 2
    v_mad_u32_u24 v76, v76, 12, v78
    s_mov_b64 exec, s[48:49]
    v_lshl_add_u32 v76, v76, 4, s68
    ds_write_b128 v77, v[72:75]
    v_mul_u32_u24 v72, 0x10001, v76
    v_mov_b32 v73, 0x3f80
    s_mov_b64 exec, s[44:45]
    v_mov_b32 v72, 2
    s_or_b32 s43, s43, s44
    s_or_b32 s43, s43, s45
    s_mov_b32 exec_lo, -1
    s_mov_b32 exec_hi, 0xffff
    s_branch L_tw0
L_tx1:
    s_andn2_b64 s[54:55], s[54:55], s[50:51]
    s_bcnt1_i32_b64 s96, s[54:55]
    s_add_u32 s96, s96, s27
    s_cmp_gt_u32 s96, s69
    s_cselect_b64 s[50:51], s[70:71], s[50:51]
    s_cselect_b64 s[54:55], 0, s[54:55]
    s_cselect_b32 s96, s27, s96
    v_mbcnt_lo_u32_b32 v160, s54, 0
    v_mbcnt_hi_u32_b32 v160, s55, v160
    v_add_u32 v160, s27, v160
    s_mov_b32 s27, s96
    v_lshl_add_u32 v161, v160, 4, s67
    v_bfe_u32 v162, v160, 1, 2
    v_mad_u32_u24 v160, v160, 12, v162
    s_mov_b64 exec, s[54:55]
    v_lshl_add_u32 v160, v160, 4, s68
    ds_write_b128 v161, v[156:159]
    v_mul_u32_u24 v156, 0x10001, v160
    v_mov_b32 v157, 0x3f80
    s_mov_b64 exec, s[50:51]
    v_mov_b32 v156, 2
    s_or_b32 s43, s43, s50
    s_or_b32 s43, s43, s51
    s_mov_b32 exec_lo, -1
    s_mov_b32 exec_hi, 0xffff
    s_branch L_tw1
L_tx2:
    s_andn2_b64 s[60:61], s[60:61], s[56:57]
    s_bcnt1_i32_b64 s96, s[60:61]
    s_add_u32 s96, s96, s27
    s_cmp_gt_u32 s96, s69
    s_cselect_b64 s[56:57], s[70:71], s[56:57]
    s_cselect_b64 s[60:61], 0, s[60:61]
    s_cselect_b32 s96, s27, s96
    v_mbcnt_lo_u32_b32 v184, s60, 0
    v_mbcnt_hi_u32_b32 v184, s61, v184
    v_add_u32 v184, s27, v184
    s_mov_b32 s27, s96
    v_lshl_add_u32 v185, v184, 4, s67
    v_bfe_u32 v186, v184, 1, 2
    v_mad_u32_u24 v184, v184, 12, v186
    s_mov_b64 exec, s[60:61]
    v_lshl_add_u32 v184, v184, 4, s68
    ds_write_b128 v185, v[180:183]
    v_mul_u32_u24 v180, 0x10001, v184
    v_mov_b32 v181, 0x3f80
    s_mov_b64 exec, s[56:57]
    v_mov_b32 v180, 2
    s_or_b32 s43, s43, s56
    s_or_b32 s43, s43, s57
    s_mov_b32 exec_lo, -1
    s_mov_b32 exec_hi, 0xffff
    s_branch L_tw2
.p2align 12
L_dfirst:
    s_cmp_lg_u32 s43, 0
    s_cselect_b32 s96, 0x10000, 0
    s_or_b32 s96, s96, s27
    v_mov_b32 v17, s96
    ds_write_b32 v254, v17 offset:32
    v_mov_b32 v17, 163808
    v_xor_b32 v255, 16, v254
    v_mfma_f32_32x32x16_bf16 v[72:87], v[108:111], v[108:111], 0
    v_mfma_f32_32x32x16_bf16 v[80:95], v[108:111], v[108:111], 0
    v_mov_b32 v112, 0
    v_mov_b32 v113, 0
    v_mov_b32 v114, 0
    v_mov_b32 v115, 0
    v_mov_b32 v116, 0
    v_mov_b32 v117, 0
    v_mov_b32 v118, 0
    v_mov_b32 v119, 0
    s_add_u32 s97, s29, 2
    s_cmp_lt_u32 s97, s30
    s_cselect_b32 s96, s26, s29
    s_cselect_b32 s40, 2304, 0
    s_mul_i32 s96, s96, 1152
    s_lshr_b32 s35, s28, 2
    s_lshl_b32 s97, s35, 7
    s_add_u32 s96, s96, s97
    s_sub_u32 s98, 0, s40
    s_cmp_eq_u32 s35, 0
    s_cselect_b32 s40, s40, s98
    v_add_u32 v7, s96, v6
    v_add_u32 v252, s40, v7
    s_waitcnt lgkmcnt(0)
    s_barrier
    ds_read_b128 v[156:159], v17
    ds_read_b128 v[160:163], v17 offset:16
    ds_read_b32 v164, v255 offset:32
    ds_read_b64 v[236:237], v7
    ds_read_b64 v[238:239], v252
    s_waitcnt lgkmcnt(3)
    v_or3_b32 v156, v156, v157, v158
    v_or3_b32 v159, v159, v160, v161
    v_or3_b32 v156, v156, v162, v163
    v_or_b32 v156, v156, v159
    v_cmp_ne_u32 vcc, 0, v156
    s_cbranch_vccnz L_dpatch
L_dgo:
    s_cmp_ge_u32 s29, s30
    s_cbranch_scc1 L_dnone0
    s_mul_i32 s36, s35, 18624
    v_add_u32 v4, 89280, v240
    s_waitcnt lgkmcnt(0)
    v_xor_b32_sdwa v244, v236, v12 dst_sel:DWORD dst_unused:UNUSED_PAD src0_sel:WORD_0 src1_sel:DWORD
    v_xor_b32_sdwa v246, v236, v12 dst_sel:DWORD dst_unused:UNUSED_PAD src0_sel:WORD_1 src1_sel:DWORD
    v_xor_b32_sdwa v245, v236, v13 dst_sel:DWORD dst_unused:UNUSED_PAD src0_sel:WORD_0 src1_sel:DWORD
    v_xor_b32_sdwa v247, v236, v13 dst_sel:DWORD dst_unused:UNUSED_PAD src0_sel:WORD_1 src1_sel:DWORD
    v_xor_b32_sdwa v152, v238, v12 dst_sel:DWORD dst_unused:UNUSED_PAD src0_sel:WORD_0 src1_sel:DWORD
    v_xor_b32_sdwa v154, v238, v12 dst_sel:DWORD dst_unused:UNUSED_PAD src0_sel:WORD_1 src1_sel:DWORD
    v_xor_b32_sdwa v153, v238, v13 dst_sel:DWORD dst_unused:UNUSED_PAD src0_sel:WORD_0 src1_sel:DWORD
    v_xor_b32_sdwa v155, v238, v13 dst_sel:DWORD dst_unused:UNUSED_PAD src0_sel:WORD_1 src1_sel:DWORD
    ds_read_b64_tr_b16 v[120:121], v244 offset:0
    ds_read_b64_tr_b16 v[122:123], v246 offset:0
    ds_read_b64_tr_b16 v[124:125], v245 offset:0
    ds_read_b64_tr_b16 v[126:127], v247 offset:0
    ds_read_b64_tr_b16 v[128:129], v152 offset:0
    ds_read_b64_tr_b16 v[130:131], v154 offset:0
    ds_read_b64_tr_b16 v[132:133], v153 offset:0
    ds_read_b64_tr_b16 v[134:135], v155 offset:0
    v_perm_b32 v228, v237, v237, v8
    v_perm_b32 v229, v237, v237, v9
    v_perm_b32 v230, v237, v237, v10
    v_perm_b32 v231, v237, v237, v11
    v_perm_b32 v232, v239, v239, v8
    v_perm_b32 v233, v239, v239, v9
    v_perm_b32 v234, v239, v239, v10
    v_perm_b32 v235, v239, v239, v11
    v_add_u32 v5, s36, v4
    v_add_u32 v7, 256, v7
    v_add_u32 v252, 256, v252
    s_waitcnt lgkmcnt(0)
    v_mfma_f32_16x16x32_bf16 v[136:139], v[120:123], v[228:231], 0
    v_mfma_f32_16x16x32_bf16 v[140:143], v[124:127], v[228:231], 0
    v_mfma_f32_16x16x32_bf16 v[144:147], v[128:131], v[232:235], 0
    v_mfma_f32_16x16x32_bf16 v[148:151], v[132:135], v[232:235], 0
    ds_read_b64_tr_b16 v[120:121], v244 offset:64
    ds_read_b64_tr_b16 v[122:123], v246 offset:64
    ds_read_b64_tr_b16 v[124:125], v245 offset:64
    ds_read_b64_tr_b16 v[126:127], v247 offset:64
    ds_read_b64_tr_b16 v[128:129], v152 offset:64
    ds_read_b64_tr_b16 v[130:131], v154 offset:64
    ds_read_b64_tr_b16 v[132:133], v153 offset:64
    ds_read_b64_tr_b16 v[134:135], v155 offset:64
    ds_read_b64 v[236:237], v7
    ds_read_b64 v[238:239], v252
    v_cvt_pk_bf16_f32 v96, v136, v137
    v_cvt_pk_bf16_f32 v97, v138, v139
    v_cvt_pk_bf16_f32 v98, v140, v141
    v_cvt_pk_bf16_f32 v99, v142, v143
    v_cvt_pk_bf16_f32 v100, v144, v145
    v_cvt_pk_bf16_f32 v101, v146, v147
    v_cvt_pk_bf16_f32 v102, v148, v149
    v_cvt_pk_bf16_f32 v103, v150, v151
    s_waitcnt lgkmcnt(2)
    v_mfma_f32_16x16x32_bf16 v[136:139], v[120:123], v[228:231], 0
    v_mfma_f32_16x16x32_bf16 v[140:143], v[124:127], v[228:231], 0
    v_mfma_f32_16x16x32_bf16 v[144:147], v[128:131], v[232:235], 0
    v_mfma_f32_16x16x32_bf16 v[148:151], v[132:135], v[232:235], 0
    s_waitcnt vmcnt(0) lgkmcnt(0)
    s_barrier
    s_cmp_lt_u32 s28, 4
    s_cbranch_scc1 L_dbody
    s_call_b64 s[76:77], L_dw23
.p2align 3
L_dbody:
    s_setprio 2
    v_mfma_f32_16x16x32_bf16 v[24:27], v[72:75], v[112:115], v[24:27]
    ds_read_b64_tr_b16 v[120:121], v244 offset:128
    ds_read_b64_tr_b16 v[122:123], v246 offset:128
    v_mfma_f32_16x16x32_bf16 v[48:51], v[72:75], v[116:119], v[48:51]
    ds_read_b64_tr_b16 v[124:125], v245 offset:128
    ds_read_b64_tr_b16 v[126:127], v247 offset:128
    v_mfma_f32_16x16x32_bf16 v[52:55], v[76:79], v[116:119], v[52:55]
    ds_read_b64_tr_b16 v[128:129], v152 offset:128
    v_cvt_pk_bf16_f32 v104, v136, v137
    v_mfma_f32_16x16x32_bf16 v[28:31], v[76:79], v[112:115], v[28:31]
    ds_read_b64_tr_b16 v[130:131], v154 offset:128
    v_cvt_pk_bf16_f32 v105, v138, v139
    v_mfma_f32_16x16x32_bf16 v[32:35], v[80:83], v[112:115], v[32:35]
    ds_read_b64_tr_b16 v[132:133], v153 offset:128
    v_cvt_pk_bf16_f32 v106, v140, v141
    v_mfma_f32_16x16x32_bf16 v[56:59], v[80:83], v[116:119], v[56:59]
    ds_read_b64_tr_b16 v[134:135], v155 offset:128
    v_cvt_pk_bf16_f32 v107, v142, v143
    ds_read_b64_tr_b16 v[72:73], v5 offset:0
    v_mfma_f32_16x16x32_bf16 v[60:63], v[84:87], v[116:119], v[60:63]
    ds_read_b64_tr_b16 v[74:75], v5 offset:1536
    v_cvt_pk_bf16_f32 v108, v144, v145
    v_mfma_f32_16x16x32_bf16 v[36:39], v[84:87], v[112:115], v[36:39]
    ds_read_b64_tr_b16 v[76:77], v5 offset:32
    v_cvt_pk_bf16_f32 v109, v146, v147
    v_mfma_f32_16x16x32_bf16 v[40:43], v[88:91], v[112:115], v[40:43]
    ds_read_b64_tr_b16 v[78:79], v5 offset:1568
    v_cvt_pk_bf16_f32 v110, v148, v149
    v_mfma_f32_16x16x32_bf16 v[64:67], v[88:91], v[116:119], v[64:67]
    ds_read_b64_tr_b16 v[80:81], v5 offset:64
    v_cvt_pk_bf16_f32 v111, v150, v151
    ds_read_b64_tr_b16 v[82:83], v5 offset:1600
    v_mfma_f32_16x16x32_bf16 v[68:71], v[92:95], v[116:119], v[68:71]
    ds_read_b64_tr_b16 v[84:85], v5 offset:96
    v_xor_b32_sdwa v244, v236, v12 dst_sel:DWORD dst_unused:UNUSED_PAD src0_sel:WORD_0 src1_sel:DWORD
    v_mfma_f32_16x16x32_bf16 v[44:47], v[92:95], v[112:115], v[44:47]
    ds_read_b64_tr_b16 v[86:87], v5 offset:1632
    v_xor_b32_sdwa v246, v236, v12 dst_sel:DWORD dst_unused:UNUSED_PAD src0_sel:WORD_1 src1_sel:DWORD
    s_waitcnt lgkmcnt(8)
    v_mfma_f32_16x16x32_bf16 v[136:139], v[120:123], v[228:231], 0
    ds_read_b64_tr_b16 v[88:89], v5 offset:128
    v_xor_b32_sdwa v245, v236, v13 dst_sel:DWORD dst_unused:UNUSED_PAD src0_sel:WORD_0 src1_sel:DWORD
    v_mfma_f32_16x16x32_bf16 v[140:143], v[124:127], v[228:231], 0
    ds_read_b64_tr_b16 v[90:91], v5 offset:1664
    v_xor_b32_sdwa v247, v236, v13 dst_sel:DWORD dst_unused:UNUSED_PAD src0_sel:WORD_1 src1_sel:DWORD
    ds_read_b64_tr_b16 v[92:93], v5 offset:160
    v_mfma_f32_16x16x32_bf16 v[144:147], v[128:131], v[232:235], 0
    ds_read_b64_tr_b16 v[94:95], v5 offset:1696
    v_xor_b32_sdwa v152, v238, v12 dst_sel:DWORD dst_unused:UNUSED_PAD src0_sel:WORD_0 src1_sel:DWORD
    v_mfma_f32_16x16x32_bf16 v[148:151], v[132:135], v[232:235], 0
    v_xor_b32_sdwa v154, v238, v12 dst_sel:DWORD dst_unused:UNUSED_PAD src0_sel:WORD_1 src1_sel:DWORD
    v_xor_b32_sdwa v153, v238, v13 dst_sel:DWORD dst_unused:UNUSED_PAD src0_sel:WORD_0 src1_sel:DWORD
    v_xor_b32_sdwa v155, v238, v13 dst_sel:DWORD dst_unused:UNUSED_PAD src0_sel:WORD_1 src1_sel:DWORD
    s_setprio 1
    s_bitcmp1_b32 0x54, s35
    s_cbranch_scc1 L_dra
L_drb:
    s_waitcnt lgkmcnt(8)
    v_mfma_f32_16x16x32_bf16 v[24:27], v[72:75], v[96:99], v[24:27]
    ds_read_b64_tr_b16 v[120:121], v244 offset:0
    v_perm_b32 v228, v237, v237, v8
    v_mfma_f32_16x16x32_bf16 v[48:51], v[72:75], v[100:103], v[48:51]
    ds_read_b64_tr_b16 v[122:123], v246 offset:0
    v_perm_b32 v229, v237, v237, v9
    v_mfma_f32_16x16x32_bf16 v[52:55], v[76:79], v[100:103], v[52:55]
    ds_read_b64_tr_b16 v[124:125], v245 offset:0
    v_perm_b32 v230, v237, v237, v10
    v_mfma_f32_16x16x32_bf16 v[28:31], v[76:79], v[96:99], v[28:31]
    ds_read_b64_tr_b16 v[126:127], v247 offset:0
    v_perm_b32 v231, v237, v237, v11
    ds_read_b64_tr_b16 v[128:129], v152 offset:0
    s_waitcnt lgkmcnt(9)
    v_mfma_f32_16x16x32_bf16 v[32:35], v[80:83], v[96:99], v[32:35]
    ds_read_b64_tr_b16 v[130:131], v154 offset:0
    v_perm_b32 v232, v239, v239, v8
    v_mfma_f32_16x16x32_bf16 v[56:59], v[80:83], v[100:103], v[56:59]
    ds_read_b64_tr_b16 v[132:133], v153 offset:0
    v_perm_b32 v233, v239, v239, v9
    v_mfma_f32_16x16x32_bf16 v[60:63], v[84:87], v[100:103], v[60:63]
    ds_read_b64_tr_b16 v[134:135], v155 offset:0
    v_perm_b32 v234, v239, v239, v10
    v_mfma_f32_16x16x32_bf16 v[36:39], v[84:87], v[96:99], v[36:39]
    ds_read_b64_tr_b16 v[72:73], v5 offset:6208
    v_perm_b32 v235, v239, v239, v11
    ds_read_b64_tr_b16 v[74:75], v5 offset:7744
    s_waitcnt lgkmcnt(10)
    v_mfma_f32_16x16x32_bf16 v[40:43], v[88:91], v[96:99], v[40:43]
    ds_read_b64_tr_b16 v[76:77], v5 offset:6240
    v_cvt_pk_bf16_f32 v112, v136, v137
    v_mfma_f32_16x16x32_bf16 v[64:67], v[88:91], v[100:103], v[64:67]
    ds_read_b64_tr_b16 v[78:79], v5 offset:7776
    v_cvt_pk_bf16_f32 v113, v138, v139
    v_mfma_f32_16x16x32_bf16 v[68:71], v[92:95], v[100:103], v[68:71]
    v_cvt_pk_bf16_f32 v114, v140, v141
    v_cvt_pk_bf16_f32 v115, v142, v143
    v_cvt_pk_bf16_f32 v116, v144, v145
    v_cvt_pk_bf16_f32 v117, v146, v147
    v_cvt_pk_bf16_f32 v118, v148, v149
    v_cvt_pk_bf16_f32 v119, v150, v151
    v_mfma_f32_16x16x32_bf16 v[44:47], v[92:95], v[96:99], v[44:47]
    s_waitcnt lgkmcnt(4)
    v_mfma_f32_16x16x32_bf16 v[136:139], v[120:123], v[228:231], 0
    ds_read_b64_tr_b16 v[80:81], v5 offset:6272
    ds_read_b64_tr_b16 v[82:83], v5 offset:7808
    v_mfma_f32_16x16x32_bf16 v[140:143], v[124:127], v[228:231], 0
    ds_read_b64_tr_b16 v[84:85], v5 offset:6304
    ds_read_b64_tr_b16 v[86:87], v5 offset:7840
    v_mfma_f32_16x16x32_bf16 v[144:147], v[128:131], v[232:235], 0
    ds_read_b64_tr_b16 v[88:89], v5 offset:6336
    ds_read_b64_tr_b16 v[90:91], v5 offset:7872
    v_mfma_f32_16x16x32_bf16 v[148:151], v[132:135], v[232:235], 0
    ds_read_b64_tr_b16 v[92:93], v5 offset:6368
    ds_read_b64_tr_b16 v[94:95], v5 offset:7904
    s_setprio 0
    s_waitcnt lgkmcnt(8)
    v_mfma_f32_16x16x32_bf16 v[24:27], v[72:75], v[104:107], v[24:27]
    ds_read_b64_tr_b16 v[120:121], v244 offset:64
    ds_read_b64_tr_b16 v[122:123], v246 offset:64
    v_mfma_f32_16x16x32_bf16 v[48:51], v[72:75], v[108:111], v[48:51]
    ds_read_b64_tr_b16 v[124:125], v245 offset:64
    ds_read_b64_tr_b16 v[126:127], v247 offset:64
    v_mfma_f32_16x16x32_bf16 v[52:55], v[76:79], v[108:111], v[52:55]
    ds_read_b64_tr_b16 v[128:129], v152 offset:64
    v_cvt_pk_bf16_f32 v96, v136, v137
    v_mfma_f32_16x16x32_bf16 v[28:31], v[76:79], v[104:107], v[28:31]
    ds_read_b64_tr_b16 v[130:131], v154 offset:64
    v_cvt_pk_bf16_f32 v97, v138, v139
    s_waitcnt lgkmcnt(10)
    v_mfma_f32_16x16x32_bf16 v[32:35], v[80:83], v[104:107], v[32:35]
    ds_read_b64_tr_b16 v[132:133], v153 offset:64
    v_cvt_pk_bf16_f32 v98, v140, v141
    v_mfma_f32_16x16x32_bf16 v[56:59], v[80:83], v[108:111], v[56:59]
    ds_read_b64_tr_b16 v[134:135], v155 offset:64
    v_cvt_pk_bf16_f32 v99, v142, v143
    ds_read_b64_tr_b16 v[72:73], v5 offset:12416
    v_mfma_f32_16x16x32_bf16 v[60:63], v[84:87], v[108:111], v[60:63]
    ds_read_b64_tr_b16 v[74:75], v5 offset:13952
    v_cvt_pk_bf16_f32 v100, v144, v145
    v_mfma_f32_16x16x32_bf16 v[36:39], v[84:87], v[104:107], v[36:39]
    ds_read_b64_tr_b16 v[76:77], v5 offset:12448
    v_cvt_pk_bf16_f32 v101, v146, v147
    s_waitcnt lgkmcnt(11)
    v_mfma_f32_16x16x32_bf16 v[40:43], v[88:91], v[104:107], v[40:43]
    ds_read_b64_tr_b16 v[78:79], v5 offset:13984
    v_cvt_pk_bf16_f32 v102, v148, v149
    v_mfma_f32_16x16x32_bf16 v[64:67], v[88:91], v[108:111], v[64:67]
    ds_read_b64_tr_b16 v[80:81], v5 offset:12480
    v_cvt_pk_bf16_f32 v103, v150, v151
    ds_read_b64_tr_b16 v[82:83], v5 offset:14016
    v_mfma_f32_16x16x32_bf16 v[68:71], v[92:95], v[108:111], v[68:71]
    ds_read_b64_tr_b16 v[84:85], v5 offset:12512
    s_sub_u32 s96, 6, s35
    v_mfma_f32_16x16x32_bf16 v[44:47], v[92:95], v[104:107], v[44:47]
    ds_read_b64_tr_b16 v[86:87], v5 offset:14048
    s_max_i32 s96, s96, 0
    s_waitcnt lgkmcnt(8)
    v_mfma_f32_16x16x32_bf16 v[136:139], v[120:123], v[228:231], 0
    ds_read_b64_tr_b16 v[88:89], v5 offset:12544
    s_min_u32 s96, s96, 2
    v_mfma_f32_16x16x32_bf16 v[140:143], v[124:127], v[228:231], 0
    ds_read_b64_tr_b16 v[90:91], v5 offset:14080
    s_lshl_b32 s96, s96, 7
    ds_read_b64_tr_b16 v[92:93], v5 offset:12576
    v_mfma_f32_16x16x32_bf16 v[144:147], v[128:131], v[232:235], 0
    ds_read_b64_tr_b16 v[94:95], v5 offset:14112
    v_add_u32 v7, s96, v7
    v_mfma_f32_16x16x32_bf16 v[148:151], v[132:135], v[232:235], 0
    v_add_u32 v252, s96, v252
    ds_read_b64 v[236:237], v7
    ds_read_b64 v[238:239], v252
    s_add_u32 s35, s35, 2
    s_and_b32 s36, s35, 3
    s_mul_i32 s36, s36, 18624
    v_add_u32 v5, s36, v4
    s_cmp_ge_u32 s35, 8
    s_waitcnt vmcnt(0) lgkmcnt(0)
    s_barrier
    s_cbranch_scc1 L_dbodyL
    s_bitcmp1_b32 0x28, s35
    s_cbranch_scc0 L_dbody
    s_add_u32 s95, s35, 2
    s_and_b32 s98, s95, 3
    s_mul_i32 s95, s95, 18432
    s_mul_i32 s98, s98, 18624
    s_call_b64 s[76:77], L_dma2
    s_branch L_dbody
L_dra:
    s_add_u32 s95, s35, 2
    s_and_b32 s98, s95, 3
    s_mul_i32 s95, s95, 18432
    s_mul_i32 s98, s98, 18624
    s_call_b64 s[76:77], L_dma2
    s_branch L_drb
L_dbodyL:
    v_mov_b32 v5, v4
    v_mfma_f32_16x16x32_bf16 v[48:51], v[72:75], v[116:119], v[48:51]
    ds_read_b64_tr_b16 v[120:121], v244 offset:128
    ds_read_b64_tr_b16 v[122:123], v246 offset:128
    v_mfma_f32_16x16x32_bf16 v[52:55], v[76:79], v[116:119], v[52:55]
    ds_read_b64_tr_b16 v[124:125], v245 offset:128
    ds_read_b64_tr_b16 v[126:127], v247 offset:128
    v_mfma_f32_16x16x32_bf16 v[56:59], v[80:83], v[116:119], v[56:59]
    s_mul_i32 s96, s28, 6144
    s_add_u32 s96, s96, 107904
    s_xor_b32 s97, s28, 4
    s_mul_i32 s97, s97, 6144
    v_mfma_f32_16x16x32_bf16 v[60:63], v[84:87], v[116:119], v[60:63]
    s_add_u32 s97, s97, 107904
    v_add_u32 v152, s96, v16
    v_add_u32 v153, s97, v16
    v_cvt_pk_bf16_f32 v104, v136, v137
    v_mfma_f32_16x16x32_bf16 v[64:67], v[88:91], v[116:119], v[64:67]
    v_cvt_pk_bf16_f32 v105, v138, v139
    v_cvt_pk_bf16_f32 v106, v140, v141
    v_cvt_pk_bf16_f32 v107, v142, v143
    v_mfma_f32_16x16x32_bf16 v[68:71], v[92:95], v[116:119], v[68:71]
    v_mfma_f32_16x16x32_bf16 v[24:27], v[72:75], v[112:115], v[24:27]
    ds_read_b64_tr_b16 v[72:73], v5 offset:0
    ds_read_b64_tr_b16 v[74:75], v5 offset:1536
    ds_write_b128 v152, v[48:51] offset:0
    v_mfma_f32_16x16x32_bf16 v[28:31], v[76:79], v[112:115], v[28:31]
    ds_read_b64_tr_b16 v[76:77], v5 offset:32
    ds_read_b64_tr_b16 v[78:79], v5 offset:1568
    ds_write_b128 v152, v[52:55] offset:1024
    v_mfma_f32_16x16x32_bf16 v[32:35], v[80:83], v[112:115], v[32:35]
    ds_read_b64_tr_b16 v[80:81], v5 offset:64
    ds_read_b64_tr_b16 v[82:83], v5 offset:1600
    ds_write_b128 v152, v[56:59] offset:2048
    v_mfma_f32_16x16x32_bf16 v[36:39], v[84:87], v[112:115], v[36:39]
    ds_read_b64_tr_b16 v[84:85], v5 offset:96
    ds_read_b64_tr_b16 v[86:87], v5 offset:1632
    ds_write_b128 v152, v[60:63] offset:3072
    v_mfma_f32_16x16x32_bf16 v[40:43], v[88:91], v[112:115], v[40:43]
    ds_read_b64_tr_b16 v[88:89], v5 offset:128
    ds_read_b64_tr_b16 v[90:91], v5 offset:1664
    ds_write_b128 v152, v[64:67] offset:4096
    v_mfma_f32_16x16x32_bf16 v[44:47], v[92:95], v[112:115], v[44:47]
    ds_read_b64_tr_b16 v[92:93], v5 offset:160
    ds_read_b64_tr_b16 v[94:95], v5 offset:1696
    ds_write_b128 v152, v[68:71] offset:5120
    v_mov_b32 v17, 1
    ds_write_b32 v254, v17
    s_waitcnt lgkmcnt(15)
    v_mfma_f32_16x16x32_bf16 v[136:139], v[120:123], v[228:231], 0
    v_mfma_f32_16x16x32_bf16 v[140:143], v[124:127], v[228:231], 0
    s_waitcnt lgkmcnt(14)
    v_mfma_f32_16x16x32_bf16 v[24:27], v[72:75], v[96:99], v[24:27]
    ds_read_b64_tr_b16 v[72:73], v5 offset:6208
    ds_read_b64_tr_b16 v[74:75], v5 offset:7744
    v_readfirstlane_b32 s98, v248
    v_readfirstlane_b32 s96, v21
    v_mfma_f32_16x16x32_bf16 v[28:31], v[76:79], v[96:99], v[28:31]
    ds_read_b64_tr_b16 v[76:77], v5 offset:6240
    ds_read_b64_tr_b16 v[78:79], v5 offset:7776
    v_cvt_pk_bf16_f32 v112, v136, v137
    v_cvt_pk_bf16_f32 v113, v138, v139
    s_waitcnt lgkmcnt(12)
    v_mfma_f32_16x16x32_bf16 v[32:35], v[80:83], v[96:99], v[32:35]
    ds_read_b64_tr_b16 v[80:81], v5 offset:6272
    ds_read_b64_tr_b16 v[82:83], v5 offset:7808
    v_cvt_pk_bf16_f32 v114, v140, v141
    v_cvt_pk_bf16_f32 v115, v142, v143
    v_mfma_f32_16x16x32_bf16 v[36:39], v[84:87], v[96:99], v[36:39]
    ds_read_b64_tr_b16 v[84:85], v5 offset:6304
    ds_read_b64_tr_b16 v[86:87], v5 offset:7840
    s_sub_u32 s98, s97, s98
    s_sub_u32 s96, s97, s96
    s_waitcnt lgkmcnt(10)
    v_mfma_f32_16x16x32_bf16 v[40:43], v[88:91], v[96:99], v[40:43]
    ds_read_b64_tr_b16 v[88:89], v5 offset:6336
    ds_read_b64_tr_b16 v[90:91], v5 offset:7872
    v_add_u32 v248, s98, v248
    v_add_u32 v249, s98, v249
    v_mfma_f32_16x16x32_bf16 v[44:47], v[92:95], v[96:99], v[44:47]
    ds_read_b64_tr_b16 v[92:93], v5 offset:6368
    ds_read_b64_tr_b16 v[94:95], v5 offset:7904
    v_add_u32 v250, s98, v250
    v_add_u32 v21, s96, v21
    s_waitcnt lgkmcnt(8)
    v_mfma_f32_16x16x32_bf16 v[24:27], v[72:75], v[104:107], v[24:27]
    ds_read_b64_tr_b16 v[72:73], v5 offset:12416
    ds_read_b64_tr_b16 v[74:75], v5 offset:13952
    s_mov_b32 s29, s26
    s_add_u32 s96, s0, s29
    v_mfma_f32_16x16x32_bf16 v[28:31], v[76:79], v[104:107], v[28:31]
    ds_read_b64_tr_b16 v[76:77], v5 offset:12448
    ds_read_b64_tr_b16 v[78:79], v5 offset:13984
    s_mul_i32 s96, s96, 224
    s_add_u32 s96, s96, s32
    s_waitcnt lgkmcnt(8)
    v_mfma_f32_16x16x32_bf16 v[32:35], v[80:83], v[104:107], v[32:35]
    ds_read_b64_tr_b16 v[80:81], v5 offset:12480
    ds_read_b64_tr_b16 v[82:83], v5 offset:14016
    s_mul_i32 s96, s96, 192
    s_mov_b32 s98, 9
    v_mfma_f32_16x16x32_bf16 v[36:39], v[84:87], v[104:107], v[36:39]
    ds_read_b64_tr_b16 v[84:85], v5 offset:12512
    ds_read_b64_tr_b16 v[86:87], v5 offset:14048
    s_waitcnt lgkmcnt(8)
    v_mfma_f32_16x16x32_bf16 v[40:43], v[88:91], v[104:107], v[40:43]
    ds_read_b64_tr_b16 v[88:89], v5 offset:12544
    ds_read_b64_tr_b16 v[90:91], v5 offset:14080
    v_mfma_f32_16x16x32_bf16 v[44:47], v[92:95], v[104:107], v[44:47]
    ds_read_b64_tr_b16 v[92:93], v5 offset:12576
    ds_read_b64_tr_b16 v[94:95], v5 offset:14112
L_dr1:
    ds_read_b32 v236, v255
    ds_read_b128 v[156:159], v153 offset:0
    ds_read_b128 v[160:163], v153 offset:1024
    ds_read_b128 v[164:167], v153 offset:2048
    ds_read_b128 v[168:171], v153 offset:3072
    ds_read_b128 v[172:175], v153 offset:4096
    ds_read_b128 v[176:179], v153 offset:5120
    s_waitcnt lgkmcnt(6)
    v_cmp_eq_u32 vcc, 0, v236
    s_cbranch_vccnz L_dr1
    v_mfma_f32_16x16x32_bf16 v[24:27], v[72:75], v[112:115], v[24:27]
    v_mfma_f32_16x16x32_bf16 v[28:31], v[76:79], v[112:115], v[28:31]
    v_mfma_f32_16x16x32_bf16 v[32:35], v[80:83], v[112:115], v[32:35]
    v_mfma_f32_16x16x32_bf16 v[36:39], v[84:87], v[112:115], v[36:39]
    v_mfma_f32_16x16x32_bf16 v[40:43], v[88:91], v[112:115], v[40:43]
    v_mfma_f32_16x16x32_bf16 v[44:47], v[92:95], v[112:115], v[44:47]
    s_waitcnt lgkmcnt(0)
    s_nop 1
    v_add_f32 v156, v156, v24
    v_add_f32 v157, v157, v25
    v_add_f32 v158, v158, v26
    v_add_f32 v159, v159, v27
    v_cvt_pk_bf16_f32 v156, v156, v157
    v_cvt_pk_bf16_f32 v157, v158, v159
    ds_write_b64 v21, v[156:157] offset:0
    v_add_f32 v160, v160, v28
    v_add_f32 v161, v161, v29
    v_add_f32 v162, v162, v30
    v_add_f32 v163, v163, v31
    v_cvt_pk_bf16_f32 v160, v160, v161
    v_cvt_pk_bf16_f32 v161, v162, v163
    ds_write_b64 v21, v[160:161] offset:32
    v_add_f32 v164, v164, v32
    v_add_f32 v165, v165, v33
    v_add_f32 v166, v166, v34
    v_add_f32 v167, v167, v35
    v_cvt_pk_bf16_f32 v164, v164, v165
    v_cvt_pk_bf16_f32 v165, v166, v167
    ds_write_b64 v21, v[164:165] offset:64
    v_add_f32 v168, v168, v36
    v_add_f32 v169, v169, v37
    v_add_f32 v170, v170, v38
    v_add_f32 v171, v171, v39
    v_cvt_pk_bf16_f32 v168, v168, v169
    v_cvt_pk_bf16_f32 v169, v170, v171
    ds_write_b64 v21, v[168:169] offset:96
    v_add_f32 v172, v172, v40
    v_add_f32 v173, v173, v41
    v_add_f32 v174, v174, v42
    v_add_f32 v175, v175, v43
    v_cvt_pk_bf16_f32 v172, v172, v173
    v_cvt_pk_bf16_f32 v173, v174, v175
    ds_write_b64 v21, v[172:173] offset:128
    v_add_f32 v176, v176, v44
    v_add_f32 v177, v177, v45
    v_add_f32 v178, v178, v46
    v_add_f32 v179, v179, v47
    v_cvt_pk_bf16_f32 v176, v176, v177
    v_cvt_pk_bf16_f32 v177, v178, v179
    ds_write_b64 v21, v[176:177] offset:160
    s_branch L_epi
L_dw23:
    s_add_u32 m0, s88, 37248
    s_mov_b32 s96, 36864
    buffer_load_dwordx4 v19, s[12:15], s96 offen lds
    s_add_u32 m0, s89, 41376
    s_mov_b32 s96, 40960
    buffer_load_dwordx4 v19, s[12:15], s96 offen lds
    s_add_u32 m0, s90, 45504
    s_mov_b32 s96, 45056
    buffer_load_dwordx4 v19, s[12:15], s96 offen lds
    s_add_u32 m0, s88, 49664
    s_mov_b32 s96, 49152
    buffer_load_dwordx4 v19, s[12:15], s96 offen lds
    s_add_u32 m0, s89, 53792
    s_mov_b32 s96, 53248
    buffer_load_dwordx4 v19, s[12:15], s96 offen lds
    s_add_u32 m0, s90, 57920
    s_mov_b32 s96, 57344
    buffer_load_dwordx4 v19, s[12:15], s96 offen lds
    s_add_u32 m0, s88, 62080
    s_mov_b32 s96, 61440
    buffer_load_dwordx4 v19, s[12:15], s96 offen lds
    s_add_u32 m0, s89, 66208
    s_mov_b32 s96, 65536
    buffer_load_dwordx4 v19, s[12:15], s96 offen lds
    s_add_u32 m0, s90, 70336
    s_mov_b32 s96, 69632
    buffer_load_dwordx4 v19, s[12:15], s96 offen lds
    s_setpc_b64 s[76:77]
L_dnone0:
    s_waitcnt vmcnt(0)
    s_barrier
    s_cmp_lt_u32 s28, 4
    s_cbranch_scc1 L_dnone
    s_call_b64 s[76:77], L_dw23
L_dnone:
    s_bitcmp1_b32 0x54, s35
    s_cbranch_scc0 L_dn1
    s_add_u32 s95, s35, 2
    s_and_b32 s98, s95, 3
    s_mul_i32 s95, s95, 18432
    s_mul_i32 s98, s98, 18624
    s_call_b64 s[76:77], L_dma2
L_dn1:
    s_add_u32 s35, s35, 2
    s_cmp_ge_u32 s35, 8
    s_waitcnt vmcnt(0) lgkmcnt(0)
    s_barrier
    s_cbranch_scc1 L_dnoneL
    s_bitcmp1_b32 0x28, s35
    s_cbranch_scc0 L_dnone
    s_add_u32 s95, s35, 2
    s_and_b32 s98, s95, 3
    s_mul_i32 s95, s95, 18432
    s_mul_i32 s98, s98, 18624
    s_call_b64 s[76:77], L_dma2
    s_branch L_dnone
L_dnoneL:
    s_branch L_fin
L_dpatch:
    v_readfirstlane_b32 s41, v156
    s_waitcnt lgkmcnt(0)
    v_readfirstlane_b32 s42, v164
    s_mov_b32 s52, 0
    s_mov_b32 s53, s27
    s_mov_b32 s54, 32
    s_call_b64 s[76:77], L_gp
    s_xor_b32 s97, s26, 2
    s_add_u32 s96, s97, s31
    s_mul_i32 s67, s96, 1792
    s_add_u32 s67, s67, 74752
    s_mul_i32 s96, s96, s69
    s_mul_i32 s96, s96, 192
    s_add_u32 s68, s96, s25
    s_mov_b32 s52, 16
    s_and_b32 s53, s42, 0xffff
    s_call_b64 s[76:77], L_gp
    v_add_u32 v252, s40, v7
    ds_read_b64 v[236:237], v7
    ds_read_b64 v[238:239], v252
    s_waitcnt vmcnt(0) lgkmcnt(0)
    s_barrier
    s_cmp_lt_u32 s41, 0x10000
    s_cbranch_scc1 L_dgo
    s_branch L_dfall
.p2align 3
L_top2:
    s_barrier
L_body2:
    s_setprio 2
.p2align 3
    v_mfma_f32_16x16x32_bf16 v[24:27], v[84:87], v[124:127], v[24:27]
    ds_read_b128 v[108:111], v1 offset:0
    v_mfma_f32_16x16x32_bf16 v[28:31], v[88:91], v[124:127], v[28:31]
    ds_read_b64_tr_b16 v[72:73], v5 offset:0
    v_mfma_f32_16x16x32_bf16 v[32:35], v[92:95], v[124:127], v[32:35]
    ds_read_b64_tr_b16 v[74:75], v5 offset:768
    v_mfma_f32_16x16x32_bf16 v[44:47], v[92:95], v[128:131], v[44:47]
    ds_read_b64_tr_b16 v[76:77], v5 offset:32
    v_mfma_f32_16x16x32_bf16 v[40:43], v[88:91], v[128:131], v[40:43]
    ds_read_b64_tr_b16 v[78:79], v5 offset:800
    v_mfma_f32_16x16x32_bf16 v[36:39], v[84:87], v[128:131], v[36:39]
    ds_read_b64_tr_b16 v[80:81], v5 offset:64
    ds_read_b64_tr_b16 v[82:83], v5 offset:832
    ds_read_b128 v[112:115], v1 offset:3904
    s_setprio 1
.p2align 3
    v_mfma_f32_16x16x32_bf16 v[24:27], v[96:99], v[140:143], v[24:27]
    ds_read_b64_tr_b16 v[84:85], v5 offset:6208
    ds_read_b64_tr_b16 v[86:87], v5 offset:6976
    v_mfma_f32_16x16x32_bf16 v[28:31], v[100:103], v[140:143], v[28:31]
    ds_read_b64_tr_b16 v[88:89], v5 offset:6240
    ds_read_b64_tr_b16 v[90:91], v5 offset:7008
    v_mfma_f32_16x16x32_bf16 v[32:35], v[104:107], v[140:143], v[32:35]
    ds_read_b64_tr_b16 v[92:93], v5 offset:6272
    ds_read_b64_tr_b16 v[94:95], v5 offset:7040
    v_mfma_f32_16x16x32_bf16 v[44:47], v[104:107], v[144:147], v[44:47]
    ds_read_b128 v[140:143], v1 offset:128
    ds_read_b128 v[124:127], v1 offset:64
    v_mfma_f32_16x16x32_bf16 v[40:43], v[100:103], v[144:147], v[40:43]
    ds_read_b128 v[128:131], v1 offset:3968
    v_mfma_f32_16x16x32_bf16 v[36:39], v[96:99], v[144:147], v[36:39]
    ds_read_b128 v[144:147], v1 offset:4032
L_mid2:
    s_waitcnt lgkmcnt(10)
    s_setprio 0
.p2align 3
    v_mfma_f32_16x16x32_bf16 v[24:27], v[72:75], v[108:111], v[24:27]
    ds_read_b64_tr_b16 v[96:97], v5 offset:12416
    v_mfma_f32_16x16x32_bf16 v[28:31], v[76:79], v[108:111], v[28:31]
    ds_read_b64_tr_b16 v[98:99], v5 offset:13184
    v_mfma_f32_16x16x32_bf16 v[32:35], v[80:83], v[108:111], v[32:35]
    ds_read_b64_tr_b16 v[100:101], v5 offset:12448
    v_mfma_f32_16x16x32_bf16 v[44:47], v[80:83], v[112:115], v[44:47]
    ds_read_b64_tr_b16 v[102:103], v5 offset:13216
    v_mfma_f32_16x16x32_bf16 v[40:43], v[76:79], v[112:115], v[40:43]
    ds_read_b64_tr_b16 v[104:105], v5 offset:12480
    v_mfma_f32_16x16x32_bf16 v[36:39], v[72:75], v[112:115], v[36:39]
    ds_read_b64_tr_b16 v[106:107], v5 offset:13248
    s_add_u32 s35, s35, 1
    v_add_u32 v17, 3904, v1
    s_and_b32 s36, s35, 3
    v_mov_b32 v1, v2
    s_mul_i32 s36, s36, 18624
    v_mov_b32 v2, v3
    v_mov_b32 v3, v17
    v_add_u32 v5, s36, v4
L_end2:
    s_bitcmp1_b32 s3, s35
    s_waitcnt vmcnt(0) lgkmcnt(0)
    s_cbranch_scc0 L_top2
    s_bitcmp1_b32 s99, s35
    s_cbranch_scc1 L_sp2
    s_barrier
    s_bitcmp1_b32 s39, s35
    s_cbranch_scc0 L_sp2
    s_call_b64 s[76:77], L_dma
L_sp2:
    s_bitcmp1_b32 s37, s35
    s_cbranch_scc1 L_g2
    s_cmp_lg_u32 s35, 9
    s_cbranch_scc1 L_body2
L_last2:
    s_setprio 3
    v_mfma_f32_16x16x32_bf16 v[24:27], v[84:87], v[124:127], v[24:27]
    s_add_u32 s96, s0, s29
    s_mul_i32 s96, s96, 224
    s_add_u32 s96, s96, s32
    v_mfma_f32_16x16x32_bf16 v[28:31], v[88:91], v[124:127], v[28:31]
    s_mul_i32 s96, s96, 192
    s_add_u32 s97, s96, 86016
    s_add_u32 s98, s29, 2
    v_mfma_f32_16x16x32_bf16 v[32:35], v[92:95], v[124:127], v[32:35]
    v_mfma_f32_16x16x32_bf16 v[24:27], v[96:99], v[140:143], v[24:27]
    v_mfma_f32_16x16x32_bf16 v[28:31], v[100:103], v[140:143], v[28:31]
    v_mfma_f32_16x16x32_bf16 v[32:35], v[104:107], v[140:143], v[32:35]
    v_mfma_f32_16x16x32_bf16 v[36:39], v[84:87], v[128:131], v[36:39]
    v_mfma_f32_16x16x32_bf16 v[40:43], v[88:91], v[128:131], v[40:43]
    v_mfma_f32_16x16x32_bf16 v[44:47], v[92:95], v[128:131], v[44:47]
    s_nop 2
    v_cvt_pk_bf16_f32 v156, v24, v25
    v_cvt_pk_bf16_f32 v157, v26, v27
    ds_write_b64 v21, v[156:157] offset:0
    v_mfma_f32_16x16x32_bf16 v[36:39], v[96:99], v[144:147], v[36:39]
    v_cvt_pk_bf16_f32 v158, v28, v29
    v_cvt_pk_bf16_f32 v159, v30, v31
    ds_write_b64 v21, v[158:159] offset:32
    v_mfma_f32_16x16x32_bf16 v[40:43], v[100:103], v[144:147], v[40:43]
    v_cvt_pk_bf16_f32 v160, v32, v33
    v_cvt_pk_bf16_f32 v161, v34, v35
    ds_write_b64 v21, v[160:161] offset:64
    v_mfma_f32_16x16x32_bf16 v[44:47], v[104:107], v[144:147], v[44:47]
    v_cvt_pk_bf16_f32 v162, v36, v37
    v_cvt_pk_bf16_f32 v163, v38, v39
    ds_write_b64 v21, v[162:163] offset:3904
    s_nop 0
    v_cvt_pk_bf16_f32 v164, v40, v41
    v_cvt_pk_bf16_f32 v165, v42, v43
    ds_write_b64 v21, v[164:165] offset:3936
    s_nop 0
    v_cvt_pk_bf16_f32 v166, v44, v45
    v_cvt_pk_bf16_f32 v167, v46, v47
    ds_write_b64 v21, v[166:167] offset:3968
    s_branch L_epi
.p2align 3
L_top1:
    s_barrier
L_body1:
    s_setprio 2
.p2align 3
    v_mfma_f32_16x16x32_bf16 v[24:27], v[84:87], v[124:127], v[24:27]
    ds_read_b128 v[108:111], v1 offset:0
    v_mfma_f32_16x16x32_bf16 v[28:31], v[88:91], v[124:127], v[28:31]
    ds_read_b64_tr_b16 v[72:73], v5 offset:0
    v_mfma_f32_16x16x32_bf16 v[32:35], v[92:95], v[124:127], v[32:35]
    ds_read_b64_tr_b16 v[74:75], v5 offset:768
    ds_read_b64_tr_b16 v[76:77], v5 offset:32
    ds_read_b64_tr_b16 v[78:79], v5 offset:800
    ds_read_b64_tr_b16 v[80:81], v5 offset:64
    ds_read_b64_tr_b16 v[82:83], v5 offset:832
    s_setprio 1
.p2align 3
    v_mfma_f32_16x16x32_bf16 v[24:27], v[96:99], v[140:143], v[24:27]
    ds_read_b64_tr_b16 v[84:85], v5 offset:6208
    ds_read_b64_tr_b16 v[86:87], v5 offset:6976
    ds_read_b64_tr_b16 v[88:89], v5 offset:6240
    v_mfma_f32_16x16x32_bf16 v[28:31], v[100:103], v[140:143], v[28:31]
    ds_read_b64_tr_b16 v[90:91], v5 offset:7008
    ds_read_b64_tr_b16 v[92:93], v5 offset:6272
    ds_read_b64_tr_b16 v[94:95], v5 offset:7040
    v_mfma_f32_16x16x32_bf16 v[32:35], v[104:107], v[140:143], v[32:35]
    ds_read_b128 v[124:127], v1 offset:64
    ds_read_b128 v[140:143], v1 offset:128
L_mid1:
    s_waitcnt lgkmcnt(8)
    s_setprio 0
.p2align 3
    v_mfma_f32_16x16x32_bf16 v[24:27], v[72:75], v[108:111], v[24:27]
    ds_read_b64_tr_b16 v[96:97], v5 offset:12416
    v_mfma_f32_16x16x32_bf16 v[28:31], v[76:79], v[108:111], v[28:31]
    ds_read_b64_tr_b16 v[98:99], v5 offset:13184
    v_mfma_f32_16x16x32_bf16 v[32:35], v[80:83], v[108:111], v[32:35]
    ds_read_b64_tr_b16 v[100:101], v5 offset:12448
    ds_read_b64_tr_b16 v[102:103], v5 offset:13216
    ds_read_b64_tr_b16 v[104:105], v5 offset:12480
    ds_read_b64_tr_b16 v[106:107], v5 offset:13248
    s_add_u32 s35, s35, 1
    v_add_u32 v17, 3904, v1
    s_and_b32 s36, s35, 3
    v_mov_b32 v1, v2
    s_mul_i32 s36, s36, 18624
    v_mov_b32 v2, v3
    v_mov_b32 v3, v17
    v_add_u32 v5, s36, v4
L_end1:
    s_bitcmp1_b32 s3, s35
    s_waitcnt vmcnt(0) lgkmcnt(0)
    s_cbranch_scc0 L_top1
    s_bitcmp1_b32 s99, s35
    s_cbranch_scc1 L_sp1
    s_barrier
    s_bitcmp1_b32 s39, s35
    s_cbranch_scc0 L_sp1
    s_call_b64 s[76:77], L_dma
L_sp1:
    s_bitcmp1_b32 s37, s35
    s_cbranch_scc1 L_g1
    s_cmp_lg_u32 s35, 9
    s_cbranch_scc1 L_body1
L_last1:
    s_setprio 3
    v_mfma_f32_16x16x32_bf16 v[24:27], v[84:87], v[124:127], v[24:27]
    s_add_u32 s96, s0, s29
    s_mul_i32 s96, s96, 224
    s_add_u32 s96, s96, s32
    v_mfma_f32_16x16x32_bf16 v[28:31], v[88:91], v[124:127], v[28:31]
    s_mul_i32 s96, s96, 192
    s_add_u32 s97, s96, 86016
    s_add_u32 s98, s29, 2
    v_mfma_f32_16x16x32_bf16 v[32:35], v[92:95], v[124:127], v[32:35]
    v_mfma_f32_16x16x32_bf16 v[24:27], v[96:99], v[140:143], v[24:27]
    v_mfma_f32_16x16x32_bf16 v[28:31], v[100:103], v[140:143], v[28:31]
    v_mfma_f32_16x16x32_bf16 v[32:35], v[104:107], v[140:143], v[32:35]
    s_nop 5
    v_cvt_pk_bf16_f32 v156, v24, v25
    v_cvt_pk_bf16_f32 v157, v26, v27
    ds_write_b64 v21, v[156:157] offset:0
    v_cvt_pk_bf16_f32 v158, v28, v29
    v_cvt_pk_bf16_f32 v159, v30, v31
    ds_write_b64 v21, v[158:159] offset:32
    v_cvt_pk_bf16_f32 v160, v32, v33
    v_cvt_pk_bf16_f32 v161, v34, v35
    ds_write_b64 v21, v[160:161] offset:64
    s_branch L_epi
L_cold:
L_lazy:
    global_load_dwordx4 v[224:227], v0, s[40:41] offset:-1024
    global_load_dwordx4 v[232:235], v0, s[40:41] offset:0
    global_load_dwordx4 v[12:15], v0, s[40:41] offset:1024
    global_load_dwordx4 v[8:11], v0, s[40:41] offset:2048
    s_waitcnt vmcnt(0)
    s_branch L_exact1
L_dfall:
    s_mov_b32 s35, 0
    v_xor_b32 v255, 4, v254
    s_or_b32 s3, s39, s99
    s_or_b32 s3, s3, 512
    s_cmp_lt_u32 s28, 4
    s_cbranch_scc1 L_df1
    s_mov_b32 s30, 0
    s_call_b64 s[76:77], L_dw23
    s_waitcnt vmcnt(0)
    s_barrier
    s_barrier
    s_branch L_mid0
L_df1:
    s_cmp_eq_u32 s30, 0
    s_cbranch_scc1 L_mid0
    s_movk_i32 s37, 0x1ff
    s_or_b32 s3, s3, s37
    s_bfm_b32 s63, s30, 0
    s_mul_i32 s62, s63, 0x11111111
    s_branch L_gfirst
L_table0:
    s_mov_b64 s[44:45], s[70:71]
    s_mov_b64 s[46:47], s[72:73]
    s_mov_b64 s[48:49], s[74:75]
L_table:
    s_mov_b32 s37, 0
    s_mov_b32 s97, 0
    s_mov_b32 s98, 0
    s_mov_b32 s38, 2
    s_mov_b32 s69, 0
    s_mov_b32 s64, 0x24924924
    s_mov_b32 s65, 0x9249
    s_and_b64 s[70:71], s[62:63], s[64:65]
    s_addc_u32 s98, s98, s98
    s_and_b64 s[70:71], s[56:57], s[64:65]
    s_addc_u32 s98, s98, s98
    s_and_b64 s[70:71], s[50:51], s[64:65]
    s_addc_u32 s98, s98, s98
    s_and_b64 s[70:71], s[44:45], s[64:65]
    s_addc_u32 s98, s98, s98
    s_and_b32 s96, s98, 15
    s_addc_u32 s37, s37, s37
    s_and_b64 s[70:71], s[60:61], s[64:65]
    s_addc_u32 s97, s97, s97
    s_and_b64 s[70:71], s[54:55], s[64:65]
    s_addc_u32 s97, s97, s97
    s_and_b64 s[70:71], s[48:49], s[64:65]
    s_addc_u32 s97, s97, s97
    s_and_b64 s[70:71], s[42:43], s[64:65]
    s_addc_u32 s97, s97, s97
    s_and_b32 s96, s97, 15
    s_addc_u32 s37, s37, s37
    s_and_b64 s[70:71], s[58:59], s[64:65]
    s_addc_u32 s97, s97, s97
    s_and_b64 s[70:71], s[52:53], s[64:65]
    s_addc_u32 s97, s97, s97
    s_and_b64 s[70:71], s[46:47], s[64:65]
    s_addc_u32 s97, s97, s97
    s_and_b64 s[70:71], s[40:41], s[64:65]
    s_addc_u32 s97, s97, s97
    s_and_b32 s96, s97, 15
    s_addc_u32 s37, s37, s37
    s_mov_b32 s64, 0x92492492
    s_mov_b32 s65, 0x4924
    s_and_b64 s[70:71], s[62:63], s[64:65]
    s_addc_u32 s97, s97, s97
    s_and_b64 s[70:71], s[56:57], s[64:65]
    s_addc_u32 s97, s97, s97
    s_and_b64 s[70:71], s[50:51], s[64:65]
    s_addc_u32 s97, s97, s97
    s_and_b64 s[70:71], s[44:45], s[64:65]
    s_addc_u32 s97, s97, s97
    s_and_b32 s96, s97, 15
    s_addc_u32 s37, s37, s37
    s_and_b64 s[70:71], s[60:61], s[64:65]
    s_addc_u32 s97, s97, s97
    s_and_b64 s[70:71], s[54:55], s[64:65]
    s_addc_u32 s97, s97, s97
    s_and_b64 s[70:71], s[48:49], s[64:65]
    s_addc_u32 s97, s97, s97
    s_and_b64 s[70:71], s[42:43], s[64:65]
    s_addc_u32 s97, s97, s97
    s_and_b32 s96, s97, 15
    s_addc_u32 s37, s37, s37
    s_and_b64 s[70:71], s[58:59], s[64:65]
    s_addc_u32 s97, s97, s97
    s_and_b64 s[70:71], s[52:53], s[64:65]
    s_addc_u32 s97, s97, s97
    s_and_b64 s[70:71], s[46:47], s[64:65]
    s_addc_u32 s97, s97, s97
    s_and_b64 s[70:71], s[40:41], s[64:65]
    s_addc_u32 s97, s97, s97
    s_and_b32 s96, s97, 15
    s_addc_u32 s37, s37, s37
    s_mov_b32 s64, 0x49249249
    s_mov_b32 s65, 0x2492
    s_and_b64 s[70:71], s[62:63], s[64:65]
    s_addc_u32 s97, s97, s97
    s_and_b64 s[70:71], s[56:57], s[64:65]
    s_addc_u32 s97, s97, s97
    s_and_b64 s[70:71], s[50:51], s[64:65]
    s_addc_u32 s97, s97, s97
    s_and_b64 s[70:71], s[44:45], s[64:65]
    s_addc_u32 s97, s97, s97
    s_and_b32 s96, s97, 15
    s_addc_u32 s37, s37, s37
    s_and_b64 s[70:71], s[60:61], s[64:65]
    s_addc_u32 s97, s97, s97
    s_and_b64 s[70:71], s[54:55], s[64:65]
    s_addc_u32 s97, s97, s97
    s_and_b64 s[70:71], s[48:49], s[64:65]
    s_addc_u32 s97, s97, s97
    s_and_b64 s[70:71], s[42:43], s[64:65]
    s_addc_u32 s97, s97, s97
    s_and_b32 s96, s97, 15
    s_addc_u32 s37, s37, s37
    s_and_b64 s[70:71], s[58:59], s[64:65]
    s_addc_u32 s97, s97, s97
    s_and_b64 s[70:71], s[52:53], s[64:65]
    s_addc_u32 s97, s97, s97
    s_and_b64 s[70:71], s[46:47], s[64:65]
    s_addc_u32 s97, s97, s97
    s_and_b64 s[70:71], s[40:41], s[64:65]
    s_addc_u32 s97, s97, s97
    s_and_b32 s96, s97, 15
    s_addc_u32 s37, s37, s37
    s_mov_b32 s62, s97
    s_mov_b32 s63, s98
    s_bfm_b32 s40, s30, 0
    s_bfe_u32 s96, s23, 0x50018
    s_sub_u32 s96, s96, 1
    s_bfe_u32 s73, s23, 0x40014
    s_cmp_lt_u32 s28, 4
    s_cselect_b32 s70, 7, 14
    s_cselect_b32 s71, 14, 15
    s_cselect_b32 s72, 15, 15
    s_cselect_b32 s73, 0, s73
    s_min_u32 s70, s70, s96
    s_min_u32 s71, s71, s96
    s_min_u32 s72, s72, s96
    s_sub_u32 s72, s72, s73
    v_mov_b32 v230, s70
    v_mov_b32 v229, s71
    v_cmp_eq_u32 vcc, 1, v238
    v_mov_b32 v17, s72
    s_nop 0
    v_cndmask_b32 v230, v230, v229, vcc
    v_cmp_eq_u32 vcc, 2, v238
    v_mov_b32 v229, s73
    s_nop 0
    v_cndmask_b32 v230, v230, v17, vcc
    v_cndmask_b32 v229, 0, v229, vcc
    s_setpc_b64 s[76:77]
L_gfirst0:
    s_barrier
    s_call_b64 s[76:77], L_tables
L_gfirst:
    s_bitcmp1_b32 s37, 0
    s_cbranch_scc0 L_nfirst
    s_call_b64 s[76:77], L_H0
    ds_read_b128 v[108:111], v1 offset:0
    ds_read_b64_tr_b16 v[72:73], v5 offset:0
    ds_read_b64_tr_b16 v[74:75], v5 offset:768
    ds_read_b64_tr_b16 v[76:77], v5 offset:32
    ds_read_b64_tr_b16 v[78:79], v5 offset:800
    ds_read_b64_tr_b16 v[80:81], v5 offset:64
    ds_read_b64_tr_b16 v[82:83], v5 offset:832
    ds_read_b128 v[112:115], v1 offset:3904
    ds_read_b128 v[116:119], v1 offset:7808
    ds_read_b128 v[120:123], v1 offset:11712
    s_waitcnt lgkmcnt(10)
    s_call_b64 s[76:77], L_H1
    ds_read_b64_tr_b16 v[84:85], v5 offset:6208
    ds_read_b64_tr_b16 v[86:87], v5 offset:6976
    ds_read_b64_tr_b16 v[88:89], v5 offset:6240
    ds_read_b64_tr_b16 v[90:91], v5 offset:7008
    ds_read_b64_tr_b16 v[92:93], v5 offset:6272
    ds_read_b64_tr_b16 v[94:95], v5 offset:7040
    ds_read_b128 v[124:127], v1 offset:64
    ds_read_b128 v[128:131], v1 offset:3968
    ds_read_b128 v[132:135], v1 offset:7872
    ds_read_b128 v[136:139], v1 offset:11776
    ds_read_b128 v[140:143], v1 offset:128
    ds_read_b128 v[144:147], v1 offset:4032
    ds_read_b128 v[148:151], v1 offset:7936
    ds_read_b128 v[152:155], v1 offset:11840
    s_waitcnt lgkmcnt(14)
    s_call_b64 s[76:77], L_H2
    s_branch L_fdisp
L_H0:
    s_lshl_b32 s97, s35, 2
    s_lshr_b64 s[70:71], s[62:63], s97
    s_and_b32 s98, s70, 15
    s_lshl_b32 s97, s35, 7
    s_bcnt1_i32_b32 s48, s98
    s_ff1_i32_b32 s44, s98
    s_mul_i32 s96, s44, 1152
    s_add_u32 s96, s96, s97
    v_add_u32 v7, s96, v6
    s_bitset0_b32 s98, s44
    ds_read_b64 v[236:237], v7
    s_cmp_eq_u32 s98, 0
    s_cbranch_scc1 L_H0r
    s_ff1_i32_b32 s45, s98
    s_mul_i32 s96, s45, 1152
    s_add_u32 s96, s96, s97
    v_add_u32 v7, s96, v6
    s_bitset0_b32 s98, s45
    ds_read_b64 v[238:239], v7
    s_cmp_eq_u32 s98, 0
    s_cbranch_scc1 L_H0r
    s_ff1_i32_b32 s46, s98
    s_mul_i32 s96, s46, 1152
    s_add_u32 s96, s96, s97
    v_add_u32 v7, s96, v6
    s_bitset0_b32 s98, s46
    ds_read_b64 v[240:241], v7
    s_cmp_eq_u32 s98, 0
    s_cbranch_scc1 L_H0r
    s_ff1_i32_b32 s47, s98
    s_mul_i32 s96, s47, 1152
    s_add_u32 s96, s96, s97
    v_add_u32 v7, s96, v6
    s_bitset0_b32 s98, s47
    ds_read_b64 v[242:243], v7
L_H0r:
    s_setpc_b64 s[76:77]
L_H1:
    v_cmp_eq_u32 vcc, 2, v236
    v_and_b32 v236, -4, v236
    s_or_b32 s50, vcc_lo, vcc_hi
    v_xor_b32_sdwa v244, v236, v12 dst_sel:DWORD dst_unused:UNUSED_PAD src0_sel:WORD_0 src1_sel:DWORD
    v_xor_b32_sdwa v246, v236, v12 dst_sel:DWORD dst_unused:UNUSED_PAD src0_sel:WORD_1 src1_sel:DWORD
    v_xor_b32_sdwa v245, v236, v13 dst_sel:DWORD dst_unused:UNUSED_PAD src0_sel:WORD_0 src1_sel:DWORD
    v_xor_b32_sdwa v247, v236, v13 dst_sel:DWORD dst_unused:UNUSED_PAD src0_sel:WORD_1 src1_sel:DWORD
    ds_read_b64_tr_b16 v[156:157], v244 offset:0
    ds_read_b64_tr_b16 v[158:159], v246 offset:0
    ds_read_b64_tr_b16 v[160:161], v245 offset:0
    ds_read_b64_tr_b16 v[162:163], v247 offset:0
    ds_read_b64_tr_b16 v[164:165], v244 offset:64
    ds_read_b64_tr_b16 v[166:167], v246 offset:64
    ds_read_b64_tr_b16 v[168:169], v245 offset:64
    ds_read_b64_tr_b16 v[170:171], v247 offset:64
    ds_read_b64_tr_b16 v[172:173], v244 offset:128
    ds_read_b64_tr_b16 v[174:175], v246 offset:128
    ds_read_b64_tr_b16 v[176:177], v245 offset:128
    ds_read_b64_tr_b16 v[178:179], v247 offset:128
    v_perm_b32 v228, v237, v237, v8
    v_perm_b32 v229, v237, v237, v9
    v_perm_b32 v230, v237, v237, v10
    v_perm_b32 v231, v237, v237, v11
    s_cmp_eq_u32 s48, 1
    s_cbranch_scc1 L_H0r
    v_cmp_eq_u32 vcc, 2, v238
    v_and_b32 v238, -4, v238
    s_or_b32 s51, vcc_lo, vcc_hi
    v_xor_b32_sdwa v244, v238, v12 dst_sel:DWORD dst_unused:UNUSED_PAD src0_sel:WORD_0 src1_sel:DWORD
    v_xor_b32_sdwa v246, v238, v12 dst_sel:DWORD dst_unused:UNUSED_PAD src0_sel:WORD_1 src1_sel:DWORD
    v_xor_b32_sdwa v245, v238, v13 dst_sel:DWORD dst_unused:UNUSED_PAD src0_sel:WORD_0 src1_sel:DWORD
    v_xor_b32_sdwa v247, v238, v13 dst_sel:DWORD dst_unused:UNUSED_PAD src0_sel:WORD_1 src1_sel:DWORD
    ds_read_b64_tr_b16 v[180:181], v244 offset:0
    ds_read_b64_tr_b16 v[182:183], v246 offset:0
    ds_read_b64_tr_b16 v[184:185], v245 offset:0
    ds_read_b64_tr_b16 v[186:187], v247 offset:0
    ds_read_b64_tr_b16 v[188:189], v244 offset:64
    ds_read_b64_tr_b16 v[190:191], v246 offset:64
    ds_read_b64_tr_b16 v[192:193], v245 offset:64
    ds_read_b64_tr_b16 v[194:195], v247 offset:64
    ds_read_b64_tr_b16 v[196:197], v244 offset:128
    ds_read_b64_tr_b16 v[198:199], v246 offset:128
    ds_read_b64_tr_b16 v[200:201], v245 offset:128
    ds_read_b64_tr_b16 v[202:203], v247 offset:128
    v_perm_b32 v232, v239, v239, v8
    v_perm_b32 v233, v239, v239, v9
    v_perm_b32 v234, v239, v239, v10
    v_perm_b32 v235, v239, v239, v11
    s_setpc_b64 s[76:77]
L_H2:
    s_mov_b32 s49, s44
    s_cmp_eq_u32 s50, 0
    s_cbranch_scc1 L_in0
    s_call_b64 s[78:79], L_slow0
    s_branch L_ie0
L_in0:
    v_mfma_f32_16x16x32_bf16 v[204:207], v[156:159], v[228:231], 0
    v_mfma_f32_16x16x32_bf16 v[208:211], v[160:163], v[228:231], 0
    v_mfma_f32_16x16x32_bf16 v[212:215], v[164:167], v[228:231], 0
    v_mfma_f32_16x16x32_bf16 v[216:219], v[168:171], v[228:231], 0
    v_mfma_f32_16x16x32_bf16 v[220:223], v[172:175], v[228:231], 0
    v_mfma_f32_16x16x32_bf16 v[224:227], v[176:179], v[228:231], 0
L_ie0:
    s_cmp_le_u32 s48, 2
    s_cbranch_scc1 L_H2a0
    v_cmp_eq_u32 vcc, 2, v240
    v_and_b32 v240, -4, v240
    s_or_b32 s50, vcc_lo, vcc_hi
    v_xor_b32_sdwa v244, v240, v12 dst_sel:DWORD dst_unused:UNUSED_PAD src0_sel:WORD_0 src1_sel:DWORD
    v_xor_b32_sdwa v246, v240, v12 dst_sel:DWORD dst_unused:UNUSED_PAD src0_sel:WORD_1 src1_sel:DWORD
    v_xor_b32_sdwa v245, v240, v13 dst_sel:DWORD dst_unused:UNUSED_PAD src0_sel:WORD_0 src1_sel:DWORD
    v_xor_b32_sdwa v247, v240, v13 dst_sel:DWORD dst_unused:UNUSED_PAD src0_sel:WORD_1 src1_sel:DWORD
    ds_read_b64_tr_b16 v[156:157], v244 offset:0
    ds_read_b64_tr_b16 v[158:159], v246 offset:0
    ds_read_b64_tr_b16 v[160:161], v245 offset:0
    ds_read_b64_tr_b16 v[162:163], v247 offset:0
    ds_read_b64_tr_b16 v[164:165], v244 offset:64
    ds_read_b64_tr_b16 v[166:167], v246 offset:64
    ds_read_b64_tr_b16 v[168:169], v245 offset:64
    ds_read_b64_tr_b16 v[170:171], v247 offset:64
    ds_read_b64_tr_b16 v[172:173], v244 offset:128
    ds_read_b64_tr_b16 v[174:175], v246 offset:128
    ds_read_b64_tr_b16 v[176:177], v245 offset:128
    ds_read_b64_tr_b16 v[178:179], v247 offset:128
    v_perm_b32 v228, v241, v241, v8
    v_perm_b32 v229, v241, v241, v9
    v_perm_b32 v230, v241, v241, v10
    v_perm_b32 v231, v241, v241, v11
    s_waitcnt lgkmcnt(12)
    s_branch L_H2b0
L_H2a0:
    s_waitcnt lgkmcnt(0)
L_H2b0:
    s_call_b64 s[78:79], L_V
    s_cmp_eq_u32 s48, 1
    s_cbranch_scc1 L_H0r
    s_mov_b32 s49, s45
    s_cmp_eq_u32 s51, 0
    s_cbranch_scc1 L_in1
    s_call_b64 s[78:79], L_slow1
    s_branch L_ie1
L_in1:
    v_mfma_f32_16x16x32_bf16 v[204:207], v[180:183], v[232:235], 0
    v_mfma_f32_16x16x32_bf16 v[208:211], v[184:187], v[232:235], 0
    v_mfma_f32_16x16x32_bf16 v[212:215], v[188:191], v[232:235], 0
    v_mfma_f32_16x16x32_bf16 v[216:219], v[192:195], v[232:235], 0
    v_mfma_f32_16x16x32_bf16 v[220:223], v[196:199], v[232:235], 0
    v_mfma_f32_16x16x32_bf16 v[224:227], v[200:203], v[232:235], 0
L_ie1:
    s_cmp_le_u32 s48, 3
    s_cbranch_scc1 L_H2a1
    v_cmp_eq_u32 vcc, 2, v242
    v_and_b32 v242, -4, v242
    s_or_b32 s51, vcc_lo, vcc_hi
    v_xor_b32_sdwa v244, v242, v12 dst_sel:DWORD dst_unused:UNUSED_PAD src0_sel:WORD_0 src1_sel:DWORD
    v_xor_b32_sdwa v246, v242, v12 dst_sel:DWORD dst_unused:UNUSED_PAD src0_sel:WORD_1 src1_sel:DWORD
    v_xor_b32_sdwa v245, v242, v13 dst_sel:DWORD dst_unused:UNUSED_PAD src0_sel:WORD_0 src1_sel:DWORD
    v_xor_b32_sdwa v247, v242, v13 dst_sel:DWORD dst_unused:UNUSED_PAD src0_sel:WORD_1 src1_sel:DWORD
    ds_read_b64_tr_b16 v[180:181], v244 offset:0
    ds_read_b64_tr_b16 v[182:183], v246 offset:0
    ds_read_b64_tr_b16 v[184:185], v245 offset:0
    ds_read_b64_tr_b16 v[186:187], v247 offset:0
    ds_read_b64_tr_b16 v[188:189], v244 offset:64
    ds_read_b64_tr_b16 v[190:191], v246 offset:64
    ds_read_b64_tr_b16 v[192:193], v245 offset:64
    ds_read_b64_tr_b16 v[194:195], v247 offset:64
    ds_read_b64_tr_b16 v[196:197], v244 offset:128
    ds_read_b64_tr_b16 v[198:199], v246 offset:128
    ds_read_b64_tr_b16 v[200:201], v245 offset:128
    ds_read_b64_tr_b16 v[202:203], v247 offset:128
    v_perm_b32 v232, v243, v243, v8
    v_perm_b32 v233, v243, v243, v9
    v_perm_b32 v234, v243, v243, v10
    v_perm_b32 v235, v243, v243, v11
    s_waitcnt lgkmcnt(12)
    s_branch L_H2b1
L_H2a1:
L_H2b1:
    s_call_b64 s[78:79], L_V
    s_cmp_eq_u32 s48, 2
    s_cbranch_scc1 L_H0r
    s_mov_b32 s49, s46
    s_waitcnt lgkmcnt(0)
    s_cmp_eq_u32 s50, 0
    s_cbranch_scc1 L_in2
    s_call_b64 s[78:79], L_slow0
    s_branch L_ie2
L_in2:
    v_mfma_f32_16x16x32_bf16 v[204:207], v[156:159], v[228:231], 0
    v_mfma_f32_16x16x32_bf16 v[208:211], v[160:163], v[228:231], 0
    v_mfma_f32_16x16x32_bf16 v[212:215], v[164:167], v[228:231], 0
    v_mfma_f32_16x16x32_bf16 v[216:219], v[168:171], v[228:231], 0
    v_mfma_f32_16x16x32_bf16 v[220:223], v[172:175], v[228:231], 0
    v_mfma_f32_16x16x32_bf16 v[224:227], v[176:179], v[228:231], 0
L_ie2:
    s_call_b64 s[78:79], L_V
    s_cmp_eq_u32 s48, 3
    s_cbranch_scc1 L_H0r
    s_mov_b32 s49, s47
    s_waitcnt lgkmcnt(0)
    s_cmp_eq_u32 s51, 0
    s_cbranch_scc1 L_in3
    s_call_b64 s[78:79], L_slow1
    s_branch L_ie3
L_in3:
    v_mfma_f32_16x16x32_bf16 v[204:207], v[180:183], v[232:235], 0
    v_mfma_f32_16x16x32_bf16 v[208:211], v[184:187], v[232:235], 0
    v_mfma_f32_16x16x32_bf16 v[212:215], v[188:191], v[232:235], 0
    v_mfma_f32_16x16x32_bf16 v[216:219], v[192:195], v[232:235], 0
    v_mfma_f32_16x16x32_bf16 v[220:223], v[196:199], v[232:235], 0
    v_mfma_f32_16x16x32_bf16 v[224:227], v[200:203], v[232:235], 0
L_ie3:
    s_call_b64 s[78:79], L_V
    s_setpc_b64 s[76:77]
L_V:
    s_cmp_eq_u32 s49, 1
    s_cbranch_scc1 L_V1
    s_cmp_eq_u32 s49, 2
    s_cbranch_scc1 L_V2
    s_cmp_eq_u32 s49, 3
    s_cbranch_scc1 L_V3
L_V0:
    v_cvt_pk_bf16_f32 v108, v204, v205
    v_cvt_pk_bf16_f32 v109, v206, v207
    v_cvt_pk_bf16_f32 v110, v208, v209
    v_cvt_pk_bf16_f32 v111, v210, v211
    v_cvt_pk_bf16_f32 v124, v212, v213
    v_cvt_pk_bf16_f32 v125, v214, v215
    v_permlane32_swap_b32 v108, v110
    v_permlane32_swap_b32 v109, v111
    v_cvt_pk_bf16_f32 v126, v216, v217
    v_cvt_pk_bf16_f32 v127, v218, v219
    v_cvt_pk_bf16_f32 v140, v220, v221
    v_cvt_pk_bf16_f32 v141, v222, v223
    v_permlane32_swap_b32 v124, v126
    v_permlane32_swap_b32 v125, v127
    v_cvt_pk_bf16_f32 v142, v224, v225
    v_cvt_pk_bf16_f32 v143, v226, v227
    s_nop 0
    v_permlane32_swap_b32 v140, v142
    v_permlane32_swap_b32 v141, v143
    s_setpc_b64 s[78:79]
L_V1:
    v_cvt_pk_bf16_f32 v112, v204, v205
    v_cvt_pk_bf16_f32 v113, v206, v207
    v_cvt_pk_bf16_f32 v114, v208, v209
    v_cvt_pk_bf16_f32 v115, v210, v211
    v_cvt_pk_bf16_f32 v128, v212, v213
    v_cvt_pk_bf16_f32 v129, v214, v215
    v_permlane32_swap_b32 v112, v114
    v_permlane32_swap_b32 v113, v115
    v_cvt_pk_bf16_f32 v130, v216, v217
    v_cvt_pk_bf16_f32 v131, v218, v219
    v_cvt_pk_bf16_f32 v144, v220, v221
    v_cvt_pk_bf16_f32 v145, v222, v223
    v_permlane32_swap_b32 v128, v130
    v_permlane32_swap_b32 v129, v131
    v_cvt_pk_bf16_f32 v146, v224, v225
    v_cvt_pk_bf16_f32 v147, v226, v227
    s_nop 0
    v_permlane32_swap_b32 v144, v146
    v_permlane32_swap_b32 v145, v147
    s_setpc_b64 s[78:79]
L_V2:
    v_cvt_pk_bf16_f32 v116, v204, v205
    v_cvt_pk_bf16_f32 v117, v206, v207
    v_cvt_pk_bf16_f32 v118, v208, v209
    v_cvt_pk_bf16_f32 v119, v210, v211
    v_cvt_pk_bf16_f32 v132, v212, v213
    v_cvt_pk_bf16_f32 v133, v214, v215
    v_permlane32_swap_b32 v116, v118
    v_permlane32_swap_b32 v117, v119
    v_cvt_pk_bf16_f32 v134, v216, v217
    v_cvt_pk_bf16_f32 v135, v218, v219
    v_cvt_pk_bf16_f32 v148, v220, v221
    v_cvt_pk_bf16_f32 v149, v222, v223
    v_permlane32_swap_b32 v132, v134
    v_permlane32_swap_b32 v133, v135
    v_cvt_pk_bf16_f32 v150, v224, v225
    v_cvt_pk_bf16_f32 v151, v226, v227
    s_nop 0
    v_permlane32_swap_b32 v148, v150
    v_permlane32_swap_b32 v149, v151
    s_setpc_b64 s[78:79]
L_V3:
    v_cvt_pk_bf16_f32 v120, v204, v205
    v_cvt_pk_bf16_f32 v121, v206, v207
    v_cvt_pk_bf16_f32 v122, v208, v209
    v_cvt_pk_bf16_f32 v123, v210, v211
    v_cvt_pk_bf16_f32 v136, v212, v213
    v_cvt_pk_bf16_f32 v137, v214, v215
    v_permlane32_swap_b32 v120, v122
    v_permlane32_swap_b32 v121, v123
    v_cvt_pk_bf16_f32 v138, v216, v217
    v_cvt_pk_bf16_f32 v139, v218, v219
    v_cvt_pk_bf16_f32 v152, v220, v221
    v_cvt_pk_bf16_f32 v153, v222, v223
    v_permlane32_swap_b32 v136, v138
    v_permlane32_swap_b32 v137, v139
    v_cvt_pk_bf16_f32 v154, v224, v225
    v_cvt_pk_bf16_f32 v155, v226, v227
    s_nop 0
    v_permlane32_swap_b32 v152, v154
    v_permlane32_swap_b32 v153, v155
    s_setpc_b64 s[78:79]
L_g4:
    s_setprio 2
    s_call_b64 s[76:77], L_H0
.p2align 3
    v_mfma_f32_16x16x32_bf16 v[24:27], v[84:87], v[124:127], v[24:27]
    ds_read_b128 v[108:111], v1 offset:0
    v_mfma_f32_16x16x32_bf16 v[28:31], v[88:91], v[124:127], v[28:31]
    ds_read_b64_tr_b16 v[72:73], v5 offset:0
    v_mfma_f32_16x16x32_bf16 v[32:35], v[92:95], v[124:127], v[32:35]
    ds_read_b64_tr_b16 v[74:75], v5 offset:768
    v_mfma_f32_16x16x32_bf16 v[44:47], v[92:95], v[128:131], v[44:47]
    ds_read_b64_tr_b16 v[76:77], v5 offset:32
    v_mfma_f32_16x16x32_bf16 v[40:43], v[88:91], v[128:131], v[40:43]
    ds_read_b64_tr_b16 v[78:79], v5 offset:800
    v_mfma_f32_16x16x32_bf16 v[36:39], v[84:87], v[128:131], v[36:39]
    ds_read_b64_tr_b16 v[80:81], v5 offset:64
    v_mfma_f32_16x16x32_bf16 v[48:51], v[84:87], v[132:135], v[48:51]
    ds_read_b64_tr_b16 v[82:83], v5 offset:832
    v_mfma_f32_16x16x32_bf16 v[52:55], v[88:91], v[132:135], v[52:55]
    ds_read_b128 v[112:115], v1 offset:3904
    v_mfma_f32_16x16x32_bf16 v[56:59], v[92:95], v[132:135], v[56:59]
    ds_read_b128 v[116:119], v1 offset:7808
    v_mfma_f32_16x16x32_bf16 v[68:71], v[92:95], v[136:139], v[68:71]
    ds_read_b128 v[120:123], v1 offset:11712
    v_mfma_f32_16x16x32_bf16 v[64:67], v[88:91], v[136:139], v[64:67]
    v_mfma_f32_16x16x32_bf16 v[60:63], v[84:87], v[136:139], v[60:63]
    s_waitcnt lgkmcnt(10)
    s_call_b64 s[76:77], L_H1
.p2align 3
    v_mfma_f32_16x16x32_bf16 v[24:27], v[96:99], v[140:143], v[24:27]
    ds_read_b64_tr_b16 v[84:85], v5 offset:6208
    v_mfma_f32_16x16x32_bf16 v[28:31], v[100:103], v[140:143], v[28:31]
    ds_read_b64_tr_b16 v[86:87], v5 offset:6976
    v_mfma_f32_16x16x32_bf16 v[32:35], v[104:107], v[140:143], v[32:35]
    ds_read_b64_tr_b16 v[88:89], v5 offset:6240
    v_mfma_f32_16x16x32_bf16 v[44:47], v[104:107], v[144:147], v[44:47]
    ds_read_b128 v[140:143], v1 offset:128
    v_mfma_f32_16x16x32_bf16 v[40:43], v[100:103], v[144:147], v[40:43]
    ds_read_b64_tr_b16 v[90:91], v5 offset:7008
    v_mfma_f32_16x16x32_bf16 v[36:39], v[96:99], v[144:147], v[36:39]
    ds_read_b64_tr_b16 v[92:93], v5 offset:6272
    v_mfma_f32_16x16x32_bf16 v[48:51], v[96:99], v[148:151], v[48:51]
    ds_read_b128 v[144:147], v1 offset:4032
    v_mfma_f32_16x16x32_bf16 v[52:55], v[100:103], v[148:151], v[52:55]
    ds_read_b64_tr_b16 v[94:95], v5 offset:7040
    v_mfma_f32_16x16x32_bf16 v[56:59], v[104:107], v[148:151], v[56:59]
    ds_read_b128 v[124:127], v1 offset:64
    v_mfma_f32_16x16x32_bf16 v[68:71], v[104:107], v[152:155], v[68:71]
    ds_read_b128 v[148:151], v1 offset:7936
    ds_read_b128 v[128:131], v1 offset:3968
    v_mfma_f32_16x16x32_bf16 v[64:67], v[100:103], v[152:155], v[64:67]
    ds_read_b128 v[132:135], v1 offset:7872
    v_mfma_f32_16x16x32_bf16 v[60:63], v[96:99], v[152:155], v[60:63]
    ds_read_b128 v[136:139], v1 offset:11776
    ds_read_b128 v[152:155], v1 offset:11840
    s_waitcnt lgkmcnt(14)
    s_call_b64 s[76:77], L_H2
    s_branch L_mid4
L_g3:
    s_setprio 2
    s_call_b64 s[76:77], L_H0
.p2align 3
    v_mfma_f32_16x16x32_bf16 v[24:27], v[84:87], v[124:127], v[24:27]
    ds_read_b128 v[108:111], v1 offset:0
    v_mfma_f32_16x16x32_bf16 v[28:31], v[88:91], v[124:127], v[28:31]
    ds_read_b64_tr_b16 v[72:73], v5 offset:0
    v_mfma_f32_16x16x32_bf16 v[32:35], v[92:95], v[124:127], v[32:35]
    ds_read_b64_tr_b16 v[74:75], v5 offset:768
    v_mfma_f32_16x16x32_bf16 v[44:47], v[92:95], v[128:131], v[44:47]
    ds_read_b64_tr_b16 v[76:77], v5 offset:32
    v_mfma_f32_16x16x32_bf16 v[40:43], v[88:91], v[128:131], v[40:43]
    ds_read_b64_tr_b16 v[78:79], v5 offset:800
    v_mfma_f32_16x16x32_bf16 v[36:39], v[84:87], v[128:131], v[36:39]
    ds_read_b64_tr_b16 v[80:81], v5 offset:64
    v_mfma_f32_16x16x32_bf16 v[48:51], v[84:87], v[132:135], v[48:51]
    ds_read_b64_tr_b16 v[82:83], v5 offset:832
    v_mfma_f32_16x16x32_bf16 v[52:55], v[88:91], v[132:135], v[52:55]
    ds_read_b128 v[112:115], v1 offset:3904
    v_mfma_f32_16x16x32_bf16 v[56:59], v[92:95], v[132:135], v[56:59]
    ds_read_b128 v[116:119], v1 offset:7808
    s_waitcnt lgkmcnt(9)
    s_call_b64 s[76:77], L_H1
.p2align 3
    v_mfma_f32_16x16x32_bf16 v[24:27], v[96:99], v[140:143], v[24:27]
    ds_read_b64_tr_b16 v[84:85], v5 offset:6208
    v_mfma_f32_16x16x32_bf16 v[28:31], v[100:103], v[140:143], v[28:31]
    ds_read_b64_tr_b16 v[86:87], v5 offset:6976
    v_mfma_f32_16x16x32_bf16 v[32:35], v[104:107], v[140:143], v[32:35]
    ds_read_b64_tr_b16 v[88:89], v5 offset:6240
    v_mfma_f32_16x16x32_bf16 v[44:47], v[104:107], v[144:147], v[44:47]
    ds_read_b128 v[140:143], v1 offset:128
    ds_read_b64_tr_b16 v[90:91], v5 offset:7008
    v_mfma_f32_16x16x32_bf16 v[40:43], v[100:103], v[144:147], v[40:43]
    ds_read_b64_tr_b16 v[92:93], v5 offset:6272
    v_mfma_f32_16x16x32_bf16 v[36:39], v[96:99], v[144:147], v[36:39]
    ds_read_b64_tr_b16 v[94:95], v5 offset:7040
    v_mfma_f32_16x16x32_bf16 v[48:51], v[96:99], v[148:151], v[48:51]
    ds_read_b128 v[144:147], v1 offset:4032
    ds_read_b128 v[124:127], v1 offset:64
    v_mfma_f32_16x16x32_bf16 v[52:55], v[100:103], v[148:151], v[52:55]
    ds_read_b128 v[128:131], v1 offset:3968
    v_mfma_f32_16x16x32_bf16 v[56:59], v[104:107], v[148:151], v[56:59]
    ds_read_b128 v[132:135], v1 offset:7872
    ds_read_b128 v[148:151], v1 offset:7936
    s_waitcnt lgkmcnt(12)
    s_call_b64 s[76:77], L_H2
    s_branch L_mid3
L_g2:
    s_setprio 2
    s_call_b64 s[76:77], L_H0
.p2align 3
    v_mfma_f32_16x16x32_bf16 v[24:27], v[84:87], v[124:127], v[24:27]
    ds_read_b128 v[108:111], v1 offset:0
    v_mfma_f32_16x16x32_bf16 v[28:31], v[88:91], v[124:127], v[28:31]
    ds_read_b64_tr_b16 v[72:73], v5 offset:0
    v_mfma_f32_16x16x32_bf16 v[32:35], v[92:95], v[124:127], v[32:35]
    ds_read_b64_tr_b16 v[74:75], v5 offset:768
    v_mfma_f32_16x16x32_bf16 v[44:47], v[92:95], v[128:131], v[44:47]
    ds_read_b64_tr_b16 v[76:77], v5 offset:32
    v_mfma_f32_16x16x32_bf16 v[40:43], v[88:91], v[128:131], v[40:43]
    ds_read_b64_tr_b16 v[78:79], v5 offset:800
    v_mfma_f32_16x16x32_bf16 v[36:39], v[84:87], v[128:131], v[36:39]
    ds_read_b64_tr_b16 v[80:81], v5 offset:64
    ds_read_b64_tr_b16 v[82:83], v5 offset:832
    ds_read_b128 v[112:115], v1 offset:3904
    s_waitcnt lgkmcnt(8)
    s_call_b64 s[76:77], L_H1
.p2align 3
    v_mfma_f32_16x16x32_bf16 v[24:27], v[96:99], v[140:143], v[24:27]
    ds_read_b64_tr_b16 v[84:85], v5 offset:6208
    ds_read_b64_tr_b16 v[86:87], v5 offset:6976
    v_mfma_f32_16x16x32_bf16 v[28:31], v[100:103], v[140:143], v[28:31]
    ds_read_b64_tr_b16 v[88:89], v5 offset:6240
    ds_read_b64_tr_b16 v[90:91], v5 offset:7008
    v_mfma_f32_16x16x32_bf16 v[32:35], v[104:107], v[140:143], v[32:35]
    ds_read_b64_tr_b16 v[92:93], v5 offset:6272
    ds_read_b64_tr_b16 v[94:95], v5 offset:7040
    v_mfma_f32_16x16x32_bf16 v[44:47], v[104:107], v[144:147], v[44:47]
    ds_read_b128 v[140:143], v1 offset:128
    ds_read_b128 v[124:127], v1 offset:64
    v_mfma_f32_16x16x32_bf16 v[40:43], v[100:103], v[144:147], v[40:43]
    ds_read_b128 v[128:131], v1 offset:3968
    v_mfma_f32_16x16x32_bf16 v[36:39], v[96:99], v[144:147], v[36:39]
    ds_read_b128 v[144:147], v1 offset:4032
    s_waitcnt lgkmcnt(10)
    s_call_b64 s[76:77], L_H2
    s_branch L_mid2
L_g1:
    s_setprio 2
    s_call_b64 s[76:77], L_H0
.p2align 3
    v_mfma_f32_16x16x32_bf16 v[24:27], v[84:87], v[124:127], v[24:27]
    ds_read_b128 v[108:111], v1 offset:0
    v_mfma_f32_16x16x32_bf16 v[28:31], v[88:91], v[124:127], v[28:31]
    ds_read_b64_tr_b16 v[72:73], v5 offset:0
    v_mfma_f32_16x16x32_bf16 v[32:35], v[92:95], v[124:127], v[32:35]
    ds_read_b64_tr_b16 v[74:75], v5 offset:768
    ds_read_b64_tr_b16 v[76:77], v5 offset:32
    ds_read_b64_tr_b16 v[78:79], v5 offset:800
    ds_read_b64_tr_b16 v[80:81], v5 offset:64
    ds_read_b64_tr_b16 v[82:83], v5 offset:832
    s_waitcnt lgkmcnt(7)
    s_call_b64 s[76:77], L_H1
.p2align 3
    v_mfma_f32_16x16x32_bf16 v[24:27], v[96:99], v[140:143], v[24:27]
    ds_read_b64_tr_b16 v[84:85], v5 offset:6208
    ds_read_b64_tr_b16 v[86:87], v5 offset:6976
    ds_read_b64_tr_b16 v[88:89], v5 offset:6240
    v_mfma_f32_16x16x32_bf16 v[28:31], v[100:103], v[140:143], v[28:31]
    ds_read_b64_tr_b16 v[90:91], v5 offset:7008
    ds_read_b64_tr_b16 v[92:93], v5 offset:6272
    ds_read_b64_tr_b16 v[94:95], v5 offset:7040
    v_mfma_f32_16x16x32_bf16 v[32:35], v[104:107], v[140:143], v[32:35]
    ds_read_b128 v[124:127], v1 offset:64
    ds_read_b128 v[140:143], v1 offset:128
    s_waitcnt lgkmcnt(8)
    s_call_b64 s[76:77], L_H2
    s_branch L_mid1
L_slow0:
    s_mul_i32 s96, s35, 11
    s_lshr_b32 s96, s96, 5
    s_mul_i32 s97, s96, 3
    s_sub_u32 s97, s35, s97
    s_add_u32 s98, s0, s49
    s_add_u32 s96, s96, s98
    s_sub_u32 s96, s96, 1
    s_add_u32 s97, s97, s32
    s_sub_u32 s97, s97, 1
    s_mul_i32 s98, s98, 224
    s_add_u32 s98, s98, s32
    s_mul_i32 s98, s98, 9
    s_add_u32 s98, s98, s35
    s_lshl_b32 s98, s98, 2
    v_mul_u32_u24 v177, 36, v14
    buffer_load_dword v168, v177, s[8:11], s98 offen
    v_cvt_f32_i32 v173, s96
    v_add_u32 v174, s97, v14
    v_cvt_f32_i32 v174, v174
    v_mov_b32 v204, 0
    v_mov_b32 v205, 0
    v_mov_b32 v206, 0
    v_mov_b32 v207, 0
    v_mov_b32 v208, 0
    v_mov_b32 v209, 0
    v_mov_b32 v210, 0
    v_mov_b32 v211, 0
    v_mov_b32 v212, 0
    v_mov_b32 v213, 0
    v_mov_b32 v214, 0
    v_mov_b32 v215, 0
    v_mov_b32 v216, 0
    v_mov_b32 v217, 0
    v_mov_b32 v218, 0
    v_mov_b32 v219, 0
    v_mov_b32 v220, 0
    v_mov_b32 v221, 0
    v_mov_b32 v222, 0
    v_mov_b32 v223, 0
    v_mov_b32 v224, 0
    v_mov_b32 v225, 0
    v_mov_b32 v226, 0
    v_mov_b32 v227, 0
    s_waitcnt vmcnt(0)
    v_lshlrev_b32 v169, 16, v168
    v_and_b32 v170, 0xffff0000, v168
    v_add_f32 v169, v169, v173
    v_add_f32 v170, v170, v174
    v_cvt_pk_bf16_f32 v168, v169, v170
    v_pk_max_i16 v168, v168, 0
    v_pk_min_i16 v168, v168, s91
    v_lshlrev_b32 v169, 16, v168
    v_and_b32 v170, 0xffff0000, v168
    v_fract_f32 v171, v169
    v_fract_f32 v172, v170
    v_cvt_u32_f32 v173, v169
    v_cvt_u32_f32 v174, v170
    v_sub_f32 v175, 1.0, v171
    v_sub_f32 v176, 1.0, v172
    v_cvt_pk_bf16_f32 v169, v175, v176
    v_lshlrev_b32 v175, 16, v169
    v_and_b32 v176, 0xffff0000, v169
    v_mul_f32 v228, v175, v176
    v_mul_f32 v229, v175, v172
    v_mul_f32 v230, v171, v176
    v_mul_f32 v231, v171, v172
    v_cvt_pk_bf16_f32 v169, v228, v229
    v_cvt_pk_bf16_f32 v170, v230, v231
    v_lshlrev_b32 v228, 16, v169
    v_and_b32 v229, 0xffff0000, v169
    v_lshlrev_b32 v230, 16, v170
    v_and_b32 v231, 0xffff0000, v170
    v_cmp_neq_f32 vcc, 0, v172
    v_mul_u32_u24 v177, 224, v173
    v_mov_b32 v169, 192
    v_mov_b32 v170, 43008
    v_cndmask_b32 v179, 0, v169, vcc
    v_cmp_neq_f32 vcc, 0, v171
    v_add_u32 v177, v177, v174
    v_mul_u32_u24 v177, 192, v177
    v_cndmask_b32 v178, 0, v170, vcc
    v_bfe_u32 v169, v16, 8, 1
    v_lshrrev_b32 v170, 9, v16
    v_lshl_add_u32 v177, v169, 5, v177
    v_lshl_add_u32 v177, v170, 3, v177
    v_sub_u32 v178, v178, v179
    s_mov_b32 s96, 4
L_sl0:
    buffer_load_dwordx2 v[156:157], v177, s[4:7], 0 offen offset:0
    buffer_load_dwordx2 v[158:159], v177, s[4:7], 0 offen offset:16
    buffer_load_dwordx2 v[160:161], v177, s[4:7], 0 offen offset:64
    buffer_load_dwordx2 v[162:163], v177, s[4:7], 0 offen offset:80
    buffer_load_dwordx2 v[164:165], v177, s[4:7], 0 offen offset:128
    buffer_load_dwordx2 v[166:167], v177, s[4:7], 0 offen offset:144
    v_add_u32 v177, v177, v179
    v_swap_b32 v179, v178
    s_waitcnt vmcnt(0)
    v_lshlrev_b32 v169, 16, v156
    v_and_b32 v170, 0xffff0000, v156
    v_fmac_f32 v204, v228, v169
    v_fmac_f32 v205, v228, v170
    v_lshlrev_b32 v169, 16, v157
    v_and_b32 v170, 0xffff0000, v157
    v_fmac_f32 v206, v228, v169
    v_fmac_f32 v207, v228, v170
    v_lshlrev_b32 v169, 16, v158
    v_and_b32 v170, 0xffff0000, v158
    v_fmac_f32 v208, v228, v169
    v_fmac_f32 v209, v228, v170
    v_lshlrev_b32 v169, 16, v159
    v_and_b32 v170, 0xffff0000, v159
    v_fmac_f32 v210, v228, v169
    v_fmac_f32 v211, v228, v170
    v_lshlrev_b32 v169, 16, v160
    v_and_b32 v170, 0xffff0000, v160
    v_fmac_f32 v212, v228, v169
    v_fmac_f32 v213, v228, v170
    v_lshlrev_b32 v169, 16, v161
    v_and_b32 v170, 0xffff0000, v161
    v_fmac_f32 v214, v228, v169
    v_fmac_f32 v215, v228, v170
    v_lshlrev_b32 v169, 16, v162
    v_and_b32 v170, 0xffff0000, v162
    v_fmac_f32 v216, v228, v169
    v_fmac_f32 v217, v228, v170
    v_lshlrev_b32 v169, 16, v163
    v_and_b32 v170, 0xffff0000, v163
    v_fmac_f32 v218, v228, v169
    v_fmac_f32 v219, v228, v170
    v_lshlrev_b32 v169, 16, v164
    v_and_b32 v170, 0xffff0000, v164
    v_fmac_f32 v220, v228, v169
    v_fmac_f32 v221, v228, v170
    v_lshlrev_b32 v169, 16, v165
    v_and_b32 v170, 0xffff0000, v165
    v_fmac_f32 v222, v228, v169
    v_fmac_f32 v223, v228, v170
    v_lshlrev_b32 v169, 16, v166
    v_and_b32 v170, 0xffff0000, v166
    v_fmac_f32 v224, v228, v169
    v_fmac_f32 v225, v228, v170
    v_lshlrev_b32 v169, 16, v167
    v_and_b32 v170, 0xffff0000, v167
    v_fmac_f32 v226, v228, v169
    v_fmac_f32 v227, v228, v170
    v_mov_b32 v228, v229
    v_mov_b32 v229, v230
    v_mov_b32 v230, v231
    s_sub_u32 s96, s96, 1
    s_cmp_lg_u32 s96, 0
    s_cbranch_scc1 L_sl0
    s_setpc_b64 s[78:79]
L_slow1:
    s_mul_i32 s96, s35, 11
    s_lshr_b32 s96, s96, 5
    s_mul_i32 s97, s96, 3
    s_sub_u32 s97, s35, s97
    s_add_u32 s98, s0, s49
    s_add_u32 s96, s96, s98
    s_sub_u32 s96, s96, 1
    s_add_u32 s97, s97, s32
    s_sub_u32 s97, s97, 1
    s_mul_i32 s98, s98, 224
    s_add_u32 s98, s98, s32
    s_mul_i32 s98, s98, 9
    s_add_u32 s98, s98, s35
    s_lshl_b32 s98, s98, 2
    v_mul_u32_u24 v201, 36, v14
    buffer_load_dword v192, v201, s[8:11], s98 offen
    v_cvt_f32_i32 v197, s96
    v_add_u32 v198, s97, v14
    v_cvt_f32_i32 v198, v198
    v_mov_b32 v204, 0
    v_mov_b32 v205, 0
    v_mov_b32 v206, 0
    v_mov_b32 v207, 0
    v_mov_b32 v208, 0
    v_mov_b32 v209, 0
    v_mov_b32 v210, 0
    v_mov_b32 v211, 0
    v_mov_b32 v212, 0
    v_mov_b32 v213, 0
    v_mov_b32 v214, 0
    v_mov_b32 v215, 0
    v_mov_b32 v216, 0
    v_mov_b32 v217, 0
    v_mov_b32 v218, 0
    v_mov_b32 v219, 0
    v_mov_b32 v220, 0
    v_mov_b32 v221, 0
    v_mov_b32 v222, 0
    v_mov_b32 v223, 0
    v_mov_b32 v224, 0
    v_mov_b32 v225, 0
    v_mov_b32 v226, 0
    v_mov_b32 v227, 0
    s_waitcnt vmcnt(0)
    v_lshlrev_b32 v193, 16, v192
    v_and_b32 v194, 0xffff0000, v192
    v_add_f32 v193, v193, v197
    v_add_f32 v194, v194, v198
    v_cvt_pk_bf16_f32 v192, v193, v194
    v_pk_max_i16 v192, v192, 0
    v_pk_min_i16 v192, v192, s91
    v_lshlrev_b32 v193, 16, v192
    v_and_b32 v194, 0xffff0000, v192
    v_fract_f32 v195, v193
    v_fract_f32 v196, v194
    v_cvt_u32_f32 v197, v193
    v_cvt_u32_f32 v198, v194
    v_sub_f32 v199, 1.0, v195
    v_sub_f32 v200, 1.0, v196
    v_cvt_pk_bf16_f32 v193, v199, v200
    v_lshlrev_b32 v199, 16, v193
    v_and_b32 v200, 0xffff0000, v193
    v_mul_f32 v232, v199, v200
    v_mul_f32 v233, v199, v196
    v_mul_f32 v234, v195, v200
    v_mul_f32 v235, v195, v196
    v_cvt_pk_bf16_f32 v193, v232, v233
    v_cvt_pk_bf16_f32 v194, v234, v235
    v_lshlrev_b32 v232, 16, v193
    v_and_b32 v233, 0xffff0000, v193
    v_lshlrev_b32 v234, 16, v194
    v_and_b32 v235, 0xffff0000, v194
    v_cmp_neq_f32 vcc, 0, v196
    v_mul_u32_u24 v201, 224, v197
    v_mov_b32 v193, 192
    v_mov_b32 v194, 43008
    v_cndmask_b32 v203, 0, v193, vcc
    v_cmp_neq_f32 vcc, 0, v195
    v_add_u32 v201, v201, v198
    v_mul_u32_u24 v201, 192, v201
    v_cndmask_b32 v202, 0, v194, vcc
    v_bfe_u32 v193, v16, 8, 1
    v_lshrrev_b32 v194, 9, v16
    v_lshl_add_u32 v201, v193, 5, v201
    v_lshl_add_u32 v201, v194, 3, v201
    v_sub_u32 v202, v202, v203
    s_mov_b32 s96, 4
L_sl1:
    buffer_load_dwordx2 v[180:181], v201, s[4:7], 0 offen offset:0
    buffer_load_dwordx2 v[182:183], v201, s[4:7], 0 offen offset:16
    buffer_load_dwordx2 v[184:185], v201, s[4:7], 0 offen offset:64
    buffer_load_dwordx2 v[186:187], v201, s[4:7], 0 offen offset:80
    buffer_load_dwordx2 v[188:189], v201, s[4:7], 0 offen offset:128
    buffer_load_dwordx2 v[190:191], v201, s[4:7], 0 offen offset:144
    v_add_u32 v201, v201, v203
    v_swap_b32 v203, v202
    s_waitcnt vmcnt(0)
    v_lshlrev_b32 v193, 16, v180
    v_and_b32 v194, 0xffff0000, v180
    v_fmac_f32 v204, v232, v193
    v_fmac_f32 v205, v232, v194
    v_lshlrev_b32 v193, 16, v181
    v_and_b32 v194, 0xffff0000, v181
    v_fmac_f32 v206, v232, v193
    v_fmac_f32 v207, v232, v194
    v_lshlrev_b32 v193, 16, v182
    v_and_b32 v194, 0xffff0000, v182
    v_fmac_f32 v208, v232, v193
    v_fmac_f32 v209, v232, v194
    v_lshlrev_b32 v193, 16, v183
    v_and_b32 v194, 0xffff0000, v183
    v_fmac_f32 v210, v232, v193
    v_fmac_f32 v211, v232, v194
    v_lshlrev_b32 v193, 16, v184
    v_and_b32 v194, 0xffff0000, v184
    v_fmac_f32 v212, v232, v193
    v_fmac_f32 v213, v232, v194
    v_lshlrev_b32 v193, 16, v185
    v_and_b32 v194, 0xffff0000, v185
    v_fmac_f32 v214, v232, v193
    v_fmac_f32 v215, v232, v194
    v_lshlrev_b32 v193, 16, v186
    v_and_b32 v194, 0xffff0000, v186
    v_fmac_f32 v216, v232, v193
    v_fmac_f32 v217, v232, v194
    v_lshlrev_b32 v193, 16, v187
    v_and_b32 v194, 0xffff0000, v187
    v_fmac_f32 v218, v232, v193
    v_fmac_f32 v219, v232, v194
    v_lshlrev_b32 v193, 16, v188
    v_and_b32 v194, 0xffff0000, v188
    v_fmac_f32 v220, v232, v193
    v_fmac_f32 v221, v232, v194
    v_lshlrev_b32 v193, 16, v189
    v_and_b32 v194, 0xffff0000, v189
    v_fmac_f32 v222, v232, v193
    v_fmac_f32 v223, v232, v194
    v_lshlrev_b32 v193, 16, v190
    v_and_b32 v194, 0xffff0000, v190
    v_fmac_f32 v224, v232, v193
    v_fmac_f32 v225, v232, v194
    v_lshlrev_b32 v193, 16, v191
    v_and_b32 v194, 0xffff0000, v191
    v_fmac_f32 v226, v232, v193
    v_fmac_f32 v227, v232, v194
    v_mov_b32 v232, v233
    v_mov_b32 v233, v234
    v_mov_b32 v234, v235
    s_sub_u32 s96, s96, 1
    s_cmp_lg_u32 s96, 0
    s_cbranch_scc1 L_sl1
    s_setpc_b64 s[78:79]
.p2align 7
L_ctab:
    .long 0xc00000, 0x2400180, 0x0, 0x8a00450
    .long 0x3d00008, 0x5500490, 0x100340, 0x8b00460
    .long 0x6e00010, 0x86007a0, 0x200680, 0x8c00470
    .long 0x9f00018, 0xb700ab0, 0x3009c0, 0x8d00480
    .long 0x18000c0, 0x3100240, 0x4000d0, 0x8f00490
    .long 0x49000c8, 0x6200550, 0x500410, 0x90004a0
    .long 0x7a000d0, 0x9300860, 0x600750, 0x91004b0
    .long 0xab000d8, 0xc000b70, 0x700a90, 0x92004c0
    .long 0x2400180, 0x3d00310, 0x8001a0, 0x93004e0
    .long 0x5500188, 0x6e00620, 0x9004e0, 0x94004f0
    .long 0x8600190, 0x9f00930, 0xa00820, 0x9500500
    .long 0xb700198, 0xcc00c00, 0xb00b60, 0x9600510
    .long 0x3100240, 0x49003d0, 0xd00270, 0x9700520
    .long 0x6200248, 0x7a006e0, 0xe005b0, 0x9800530
    .long 0x9300250, 0xab009f0, 0xf008f0, 0x9900540
    .long 0xc000258, 0xd800cc0, 0x1000c30, 0x9a00550
    .long 0xe00c20, 0x26001a0, 0x1100008, 0x9c00560
    .long 0x3f00c28, 0x57004b0, 0x1200348, 0x9d00570
    .long 0x6c00c30, 0x8400780, 0x1300688, 0x9e00580
    .long 0x9d00c38, 0xb500a90, 0x14009c8, 0x9f00590
    .long 0x1a00ce0, 0x3300260, 0x15000d8, 0xa0005b0
    .long 0x4b00ce8, 0x6000570, 0x1600418, 0xa1005c0
    .long 0x7800cf0, 0x9100840, 0x1700758, 0xa2005d0
    .long 0xa900cf8, 0xc200b50, 0x1800a98, 0xa3005e0
    .long 0x2600da0, 0x3f00330, 0x1a001a8, 0xa4005f0
    .long 0x5700da8, 0x6c00600, 0x1b004e8, 0xa500600
    .long 0x8400db0, 0x9d00910, 0x1c00828, 0xa600610
    .long 0xb500db8, 0xce00c20, 0x1d00b68, 0xa700620
    .long 0x3300e60, 0x4b003f0, 0x1e00278, 0xa900630
    .long 0x6000e68, 0x78006c0, 0x1f005b8, 0xaa00640
    .long 0x9100e70, 0xa9009d0, 0x20008f8, 0xab00650
    .long 0xc200e78, 0xda00ce0, 0x2100c38, 0xac00660
    .long 0xd00600, 0x2500190, 0x2200010, 0xad00680
    .long 0x3c00608, 0x5400480, 0x2300350, 0xae00690
    .long 0x6f00610, 0x87007b0, 0x2400690, 0xaf006a0
    .long 0x9e00618, 0xb600aa0, 0x25009d0, 0xb0006b0
    .long 0x19006c0, 0x3000250, 0x27000e0, 0xb1006c0
    .long 0x48006c8, 0x6300540, 0x2800420, 0xb2006d0
    .long 0x7b006d0, 0x9200870, 0x2900760, 0xb3006e0
    .long 0xaa006d8, 0xc100b60, 0x2a00aa0, 0xb4006f0
    .long 0x2500780, 0x3c00300, 0x2b001b0, 0xb600700
    .long 0x5400788, 0x6f00630, 0x2c004f0, 0xb700710
    .long 0x8700790, 0x9e00920, 0x2d00830, 0xb800720
    .long 0xb600798, 0xcd00c10, 0x2e00b70, 0xb900730
    .long 0x3000840, 0x48003c0, 0x2f00280, 0xba00750
    .long 0x6300848, 0x7b006f0, 0x30005c0, 0xbb00760
    .long 0x9200850, 0xaa009e0, 0x3100900, 0xbc00770
    .long 0xc100858, 0xd900cd0, 0x3200c40, 0xbd00780
    .long 0xf01220, 0x27001b0, 0x3400018, 0xbe00790
    .long 0x3e01228, 0x56004a0, 0x3500358, 0xbf007a0
    .long 0x6d01230, 0x8500790, 0x3600698, 0xc0007b0
    .long 0x9c01238, 0xb400a80, 0x37009d8, 0xc1007c0
    .long 0x1b012e0, 0x3200270, 0x38000e8, 0xc3007d0
    .long 0x4a012e8, 0x6100560, 0x3900428, 0xc4007e0
    .long 0x79012f0, 0x9000850, 0x3a00768, 0xc5007f0
    .long 0xa8012f8, 0xc300b40, 0x3b00aa8, 0xc600800
    .long 0x27013a0, 0x3e00320, 0x3c001b8, 0xc700820
    .long 0x56013a8, 0x6d00610, 0x3d004f8, 0xc800830
    .long 0x85013b0, 0x9c00900, 0x3e00838, 0xc900840
    .long 0xb4013b8, 0xcf00c30, 0x3f00b78, 0xca00850
    .long 0x3201460, 0x4a003e0, 0x4100288, 0xcb00860
    .long 0x6101468, 0x79006d0, 0x42005c8, 0xcc00870
    .long 0x9001470, 0xa8009c0, 0x4300908, 0xcd00880
    .long 0xc301478, 0xdb00cf0, 0x4400c48, 0xce00890
    .long 0xbf800000, 0xbf800000, 0x0, 0x0
    .long 0xbf800000, 0x0, 0x100, 0x180
    .long 0xbf800000, 0x3f800000, 0x200, 0x300
    .long 0x0, 0xbf800000, 0x1, 0x8
    .long 0x0, 0x0, 0x101, 0x188
    .long 0x0, 0x3f800000, 0x201, 0x308
    .long 0x3f800000, 0xbf800000, 0x2, 0x10
    .long 0x3f800000, 0x0, 0x102, 0x190
    .long 0x3f800000, 0x3f800000, 0x202, 0x310
    .long 0x40000000, 0xbf800000, 0x3, 0x18
    .long 0x40000000, 0x0, 0x103, 0x198
    .long 0x40000000, 0x3f800000, 0x203, 0x318
    .long 0x40400000, 0xbf800000, 0x4, 0x20
    .long 0x40400000, 0x0, 0x104, 0x1a0
    .long 0x40400000, 0x3f800000, 0x204, 0x320
    .long 0x40800000, 0xbf800000, 0x5, 0x28
    .long 0x40800000, 0x0, 0x105, 0x1a8
    .long 0x40800000, 0x3f800000, 0x205, 0x328
    .long 0x40a00000, 0xbf800000, 0x6, 0x30
    .long 0x40a00000, 0x0, 0x106, 0x1b0
    .long 0x40a00000, 0x3f800000, 0x206, 0x330
    .long 0x40c00000, 0xbf800000, 0x7, 0x38
    .long 0x40c00000, 0x0, 0x107, 0x1b8
    .long 0x40c00000, 0x3f800000, 0x207, 0x338
    .long 0x40e00000, 0xbf800000, 0x8, 0x40
    .long 0x40e00000, 0x0, 0x108, 0x1c0
    .long 0x40e00000, 0x3f800000, 0x208, 0x340
    .long 0x41000000, 0xbf800000, 0x9, 0x48
    .long 0x41000000, 0x0, 0x109, 0x1c8
    .long 0x41000000, 0x3f800000, 0x209, 0x348
    .long 0x41100000, 0xbf800000, 0xa, 0x50
    .long 0x41100000, 0x0, 0x10a, 0x1d0
    .long 0x41100000, 0x3f800000, 0x20a, 0x350
    .long 0x41200000, 0xbf800000, 0xb, 0x58
    .long 0x41200000, 0x0, 0x10b, 0x1d8
    .long 0x41200000, 0x3f800000, 0x20b, 0x358
    .long 0x41300000, 0xbf800000, 0xc, 0x60
    .long 0x41300000, 0x0, 0x10c, 0x1e0
    .long 0x41300000, 0x3f800000, 0x20c, 0x360
    .long 0x41400000, 0xbf800000, 0xd, 0x68
    .long 0x41400000, 0x0, 0x10d, 0x1e8
    .long 0x41400000, 0x3f800000, 0x20d, 0x368
    .long 0x41500000, 0xbf800000, 0xe, 0x70
    .long 0x41500000, 0x0, 0x10e, 0x1f0
    .long 0x41500000, 0x3f800000, 0x20e, 0x370
    .long 0x41600000, 0xbf800000, 0xf, 0x78
    .long 0x41600000, 0x0, 0x10f, 0x1f8
    .long 0x41600000, 0x3f800000, 0x20f, 0x378
    .long 0x41700000, 0xbf800000, 0x10, 0x80
    .long 0x41700000, 0x0, 0x110, 0x200
    .long 0x41700000, 0x3f800000, 0x210, 0x380
    .long 0x41800000, 0xbf800000, 0x11, 0x88
    .long 0x41800000, 0x0, 0x111, 0x208
    .long 0x41800000, 0x3f800000, 0x211, 0x388
    .long 0x41880000, 0xbf800000, 0x12, 0x90
    .long 0x41880000, 0x0, 0x112, 0x210
    .long 0x41880000, 0x3f800000, 0x212, 0x390
    .long 0x41900000, 0xbf800000, 0x13, 0x98
    .long 0x41900000, 0x0, 0x113, 0x218
    .long 0x41900000, 0x3f800000, 0x213, 0x398
    .long 0x41980000, 0xbf800000, 0x14, 0xa0
    .long 0x41980000, 0x0, 0x114, 0x220
    .long 0x41980000, 0x3f800000, 0x214, 0x3a0
    .long 0x41a00000, 0xbf800000, 0x15, 0xa8
    .long 0x100000c, 0x10c0018, 0x1180024, 0x0
    .long 0x1f40100, 0x200010c, 0x20c0118, 0x80000
    .long 0x2e801f4, 0x2f40200, 0x300020c, 0x100000
    .long 0x10c0018, 0x1180024, 0x1250031, 0x180000
    .long 0x200010c, 0x20c0118, 0x2190125, 0xc00001
    .long 0x2f40200, 0x300020c, 0x30d0219, 0xc80001
    .long 0x1180024, 0x1250031, 0x131003d, 0xd00001
    .long 0x20c0118, 0x2190125, 0x2250131, 0xd80001
    .long 0x300020c, 0x30d0219, 0x3190225, 0x1800002
    .long 0x1250031, 0x131003d, 0x13d0049, 0x1880002
    .long 0x2190125, 0x2250131, 0x231013d, 0x1900002
    .long 0x30d0219, 0x3190225, 0x3250231, 0x1980002
    .long 0x131003d, 0x13d0049, 0x1490055, 0x2400003
    .long 0x2250131, 0x231013d, 0x23d0149, 0x2480003
    .long 0x3190225, 0x3250231, 0x331023d, 0x2500003
    .long 0x13d0049, 0x1490055, 0x1560062, 0x2580003
    .long 0x231013d, 0x23d0149, 0x24a0156, 0xc200004
    .long 0x3250231, 0x331023d, 0x33e024a, 0xc280004
    .long 0x1490055, 0x1560062, 0x162006e, 0xc300004
    .long 0x23d0149, 0x24a0156, 0x2560162, 0xc380004
    .long 0x331023d, 0x33e024a, 0x34a0256, 0xce00005
    .long 0x1560062, 0x162006e, 0x16e007a, 0xce80005
    .long 0x24a0156, 0x2560162, 0x262016e, 0xcf00005
    .long 0x33e024a, 0x34a0256, 0x3560262, 0xcf80005
    .long 0x162006e, 0x16e007a, 0x17a0086, 0xda00006
    .long 0x2560162, 0x262016e, 0x26e017a, 0xda80006
    .long 0x34a0256, 0x3560262, 0x362026e, 0xdb00006
    .long 0x16e007a, 0x17a0086, 0x1870093, 0xdb80006
    .long 0x262016e, 0x26e017a, 0x27b0187, 0xe600007
    .long 0x3560262, 0x362026e, 0x36f027b, 0xe680007
    .long 0x17a0086, 0x1870093, 0x193009f, 0xe700007
    .long 0x26e017a, 0x27b0187, 0x2870193, 0xe780007
    .long 0x362026e, 0x36f027b, 0x37b0287, 0x3000008
    .long 0x1870093, 0x193009f, 0x19f00ab, 0x3080008
    .long 0x27b0187, 0x2870193, 0x293019f, 0x3100008
    .long 0x36f027b, 0x37b0287, 0x3870293, 0x3180008
    .long 0x193009f, 0x19f00ab, 0x1ab00b7, 0x3c00009
    .long 0x2870193, 0x293019f, 0x29f01ab, 0x3c80009
    .long 0x37b0287, 0x3870293, 0x393029f, 0x3d00009
    .long 0x19f00ab, 0x1ab00b7, 0x1b400c0, 0x3d80009
    .long 0x293019f, 0x29f01ab, 0x2a801b4, 0x480000a
    .long 0x3870293, 0x393029f, 0x39c02a8, 0x488000a
    .long 0x1ab00b7, 0x1b400c0, 0x1c000cc, 0x490000a
    .long 0x29f01ab, 0x2a801b4, 0x2b401c0, 0x498000a
    .long 0x393029f, 0x39c02a8, 0x3a802b4, 0x540000b
    .long 0x1b400c0, 0x1c000cc, 0x1cc00d8, 0x548000b
    .long 0x2a801b4, 0x2b401c0, 0x2c001cc, 0x550000b
    .long 0x39c02a8, 0x3a802b4, 0x3b402c0, 0x558000b
    .long 0x1c000cc, 0x1cc00d8, 0x1d800e4, 0xf20000c
    .long 0x2b401c0, 0x2c001cc, 0x2cc01d8, 0xf28000c
    .long 0x3a802b4, 0x3b402c0, 0x3c002cc, 0xf30000c
    .long 0x1cc00d8, 0x1d800e4, 0x1e500f1, 0xf38000c
    .long 0x2c001cc, 0x2cc01d8, 0x2d901e5, 0xfe0000d
    .long 0x3b402c0, 0x3c002cc, 0x3cd02d9, 0xfe8000d
    .long 0x1d800e4, 0x1e500f1, 0x1f100fd, 0xff0000d
    .long 0x2cc01d8, 0x2d901e5, 0x2e501f1, 0xff8000d
    .long 0x3c002cc, 0x3cd02d9, 0x3d902e5, 0x10a0000e
    .long 0x1e500f1, 0x1f100fd, 0x1fd0109, 0x10a8000e
    .long 0x2d901e5, 0x2e501f1, 0x2f101fd, 0x10b0000e
    .long 0x3cd02d9, 0x3d902e5, 0x3e502f1, 0x10b8000e
    .long 0x1f100fd, 0x1fd0109, 0x2090115, 0x1160000f
    .long 0x2e501f1, 0x2f101fd, 0x2fd0209, 0x1168000f
    .long 0x3d902e5, 0x3e502f1, 0x3f102fd, 0x1170000f
    .long 0x1fd0109, 0x2090115, 0x2160122, 0x1178000f
    .long 0x0, 0x10, 0x0, 0x0
    .long 0x20, 0x30, 0x4, 0x0
    .long 0x8, 0x18, 0x8, 0x0
    .long 0x28, 0x38, 0xc, 0x0
    .long 0x0, 0x10, 0x1, 0x0
    .long 0x20, 0x30, 0x5, 0x0
    .long 0x8, 0x18, 0x9, 0x0
    .long 0x28, 0x38, 0xd, 0x0
    .long 0x0, 0x10, 0x2, 0x0
    .long 0x20, 0x30, 0x6, 0x0
    .long 0x8, 0x18, 0xa, 0x0
    .long 0x28, 0x38, 0xe, 0x0
    .long 0x0, 0x10, 0x3, 0x0
    .long 0x20, 0x30, 0x7, 0x0
    .long 0x8, 0x18, 0xb, 0x0
    .long 0x28, 0x38, 0xf, 0x0
    .long 0x0, 0x10, 0x0, 0x20002
    .long 0x20, 0x30, 0x4, 0x20002
    .long 0x8, 0x18, 0x8, 0x20002
    .long 0x28, 0x38, 0xc, 0x20002
    .long 0x0, 0x10, 0x1, 0x20002
    .long 0x20, 0x30, 0x5, 0x20002
    .long 0x8, 0x18, 0x9, 0x20002
    .long 0x28, 0x38, 0xd, 0x20002
    .long 0x0, 0x10, 0x2, 0x20002
    .long 0x20, 0x30, 0x6, 0x20002
    .long 0x8, 0x18, 0xa, 0x20002
    .long 0x28, 0x38, 0xe, 0x20002
    .long 0x0, 0x10, 0x3, 0x20002
    .long 0x20, 0x30, 0x7, 0x20002
    .long 0x8, 0x18, 0xb, 0x20002
    .long 0x28, 0x38, 0xf, 0x20002
    .long 0x0, 0x10, 0x0, 0x10001
    .long 0x20, 0x30, 0x4, 0x10001
    .long 0x8, 0x18, 0x8, 0x10001
    .long 0x28, 0x38, 0xc, 0x10001
    .long 0x0, 0x10, 0x1, 0x10001
    .long 0x20, 0x30, 0x5, 0x10001
    .long 0x8, 0x18, 0x9, 0x10001
    .long 0x28, 0x38, 0xd, 0x10001
    .long 0x0, 0x10, 0x2, 0x10001
    .long 0x20, 0x30, 0x6, 0x10001
    .long 0x8, 0x18, 0xa, 0x10001
    .long 0x28, 0x38, 0xe, 0x10001
    .long 0x0, 0x10, 0x3, 0x10001
    .long 0x20, 0x30, 0x7, 0x10001
    .long 0x8, 0x18, 0xb, 0x10001
    .long 0x28, 0x38, 0xf, 0x10001
    .long 0x0, 0x10, 0x0, 0x30003
    .long 0x20, 0x30, 0x4, 0x30003
    .long 0x8, 0x18, 0x8, 0x30003
    .long 0x28, 0x38, 0xc, 0x30003
    .long 0x0, 0x10, 0x1, 0x30003
    .long 0x20, 0x30, 0x5, 0x30003
    .long 0x8, 0x18, 0x9, 0x30003
    .long 0x28, 0x38, 0xd, 0x30003
    .long 0x0, 0x10, 0x2, 0x30003
    .long 0x20, 0x30, 0x6, 0x30003
    .long 0x8, 0x18, 0xa, 0x30003
    .long 0x28, 0x38, 0xe, 0x30003
    .long 0x0, 0x10, 0x3, 0x30003
    .long 0x20, 0x30, 0x7, 0x30003
    .long 0x8, 0x18, 0xb, 0x30003
    .long 0x28, 0x38, 0xf, 0x30003
    .long 0xc0c0100, 0xc0c0c0c, 0xc0c0302, 0xc0c0c0c
    .long 0xc0c0c0c, 0xc0c0c0c, 0xc0c0c0c, 0xc0c0c0c
    .long 0xc0c0c0c, 0xc0c0c0c, 0xc0c0c0c, 0xc0c0c0c
    .long 0xc0c0c0c, 0xc0c0c0c, 0xc0c0c0c, 0xc0c0c0c
    .long 0x1000c0c, 0xc0c0c0c, 0x3020c0c, 0xc0c0c0c
    .long 0xc0c0c0c, 0xc0c0c0c, 0xc0c0c0c, 0xc0c0c0c
    .long 0xc0c0c0c, 0xc0c0c0c, 0xc0c0c0c, 0xc0c0c0c
    .long 0xc0c0c0c, 0xc0c0c0c, 0xc0c0c0c, 0xc0c0c0c
    .long 0xc0c0c0c, 0xc0c0100, 0xc0c0c0c, 0xc0c0302
    .long 0xc0c0c0c, 0xc0c0c0c, 0xc0c0c0c, 0xc0c0c0c
    .long 0xc0c0c0c, 0xc0c0c0c, 0xc0c0c0c, 0xc0c0c0c
    .long 0xc0c0c0c, 0xc0c0c0c, 0xc0c0c0c, 0xc0c0c0c
    .long 0xc0c0c0c, 0x1000c0c, 0xc0c0c0c, 0x3020c0c
    .long 0xc0c0c0c, 0xc0c0c0c, 0xc0c0c0c, 0xc0c0c0c
    .long 0xc0c0c0c, 0xc0c0c0c, 0xc0c0c0c, 0xc0c0c0c
    .long 0xc0c0c0c, 0xc0c0c0c, 0xc0c0c0c, 0xc0c0c0c
    .long 0xc0c0c0c, 0xc0c0c0c, 0xc0c0c0c, 0xc0c0c0c
    .long 0xc0c0100, 0xc0c0c0c, 0xc0c0302, 0xc0c0c0c
    .long 0xc0c0c0c, 0xc0c0c0c, 0xc0c0c0c, 0xc0c0c0c
    .long 0xc0c0c0c, 0xc0c0c0c, 0xc0c0c0c, 0xc0c0c0c
    .long 0xc0c0c0c, 0xc0c0c0c, 0xc0c0c0c, 0xc0c0c0c
    .long 0x1000c0c, 0xc0c0c0c, 0x3020c0c, 0xc0c0c0c
    .long 0xc0c0c0c, 0xc0c0c0c, 0xc0c0c0c, 0xc0c0c0c
    .long 0xc0c0c0c, 0xc0c0c0c, 0xc0c0c0c, 0xc0c0c0c
    .long 0xc0c0c0c, 0xc0c0c0c, 0xc0c0c0c, 0xc0c0c0c
    .long 0xc0c0c0c, 0xc0c0100, 0xc0c0c0c, 0xc0c0302
    .long 0xc0c0c0c, 0xc0c0c0c, 0xc0c0c0c, 0xc0c0c0c
    .long 0xc0c0c0c, 0xc0c0c0c, 0xc0c0c0c, 0xc0c0c0c
    .long 0xc0c0c0c, 0xc0c0c0c, 0xc0c0c0c, 0xc0c0c0c
    .long 0xc0c0c0c, 0x1000c0c, 0xc0c0c0c, 0x3020c0c
    .long 0xc0c0c0c, 0xc0c0c0c, 0xc0c0c0c, 0xc0c0c0c
    .long 0xc0c0c0c, 0xc0c0c0c, 0xc0c0c0c, 0xc0c0c0c
    .long 0xc0c0c0c, 0xc0c0c0c, 0xc0c0c0c, 0xc0c0c0c
    .long 0xc0c0c0c, 0xc0c0c0c, 0xc0c0c0c, 0xc0c0c0c
    .long 0xc0c0100, 0xc0c0c0c, 0xc0c0302, 0xc0c0c0c
    .long 0xc0c0c0c, 0xc0c0c0c, 0xc0c0c0c, 0xc0c0c0c
    .long 0xc0c0c0c, 0xc0c0c0c, 0xc0c0c0c, 0xc0c0c0c
    .long 0xc0c0c0c, 0xc0c0c0c, 0xc0c0c0c, 0xc0c0c0c
    .long 0x1000c0c, 0xc0c0c0c, 0x3020c0c, 0xc0c0c0c
    .long 0xc0c0c0c, 0xc0c0c0c, 0xc0c0c0c, 0xc0c0c0c
    .long 0xc0c0c0c, 0xc0c0c0c, 0xc0c0c0c, 0xc0c0c0c
    .long 0xc0c0c0c, 0xc0c0c0c, 0xc0c0c0c, 0xc0c0c0c
    .long 0xc0c0c0c, 0xc0c0100, 0xc0c0c0c, 0xc0c0302
    .long 0xc0c0c0c, 0xc0c0c0c, 0xc0c0c0c, 0xc0c0c0c
    .long 0xc0c0c0c, 0xc0c0c0c, 0xc0c0c0c, 0xc0c0c0c
    .long 0xc0c0c0c, 0xc0c0c0c, 0xc0c0c0c, 0xc0c0c0c
    .long 0xc0c0c0c, 0x1000c0c, 0xc0c0c0c, 0x3020c0c
    .long 0xc0c0c0c, 0xc0c0c0c, 0xc0c0c0c, 0xc0c0c0c
    .long 0xc0c0c0c, 0xc0c0c0c, 0xc0c0c0c, 0xc0c0c0c
    .long 0xc0c0c0c, 0xc0c0c0c, 0xc0c0c0c, 0xc0c0c0c
    .long 0xc0c0c0c, 0xc0c0c0c, 0xc0c0c0c, 0xc0c0c0c
    .long 0xc0c0100, 0xc0c0c0c, 0xc0c0302, 0xc0c0c0c
    .long 0xc0c0c0c, 0xc0c0c0c, 0xc0c0c0c, 0xc0c0c0c
    .long 0xc0c0c0c, 0xc0c0c0c, 0xc0c0c0c, 0xc0c0c0c
    .long 0xc0c0c0c, 0xc0c0c0c, 0xc0c0c0c, 0xc0c0c0c
    .long 0x1000c0c, 0xc0c0c0c, 0x3020c0c, 0xc0c0c0c
    .long 0xc0c0c0c, 0xc0c0c0c, 0xc0c0c0c, 0xc0c0c0c
    .long 0xc0c0c0c, 0xc0c0c0c, 0xc0c0c0c, 0xc0c0c0c
    .long 0xc0c0c0c, 0xc0c0c0c, 0xc0c0c0c, 0xc0c0c0c
    .long 0xc0c0c0c, 0xc0c0100, 0xc0c0c0c, 0xc0c0302
    .long 0xc0c0c0c, 0xc0c0c0c, 0xc0c0c0c, 0xc0c0c0c
    .long 0xc0c0c0c, 0xc0c0c0c, 0xc0c0c0c, 0xc0c0c0c
    .long 0xc0c0c0c, 0xc0c0c0c, 0xc0c0c0c, 0xc0c0c0c
    .long 0xc0c0c0c, 0x1000c0c, 0xc0c0c0c, 0x3020c0c
L_runtab:
    .long 0xfffeb000, 0x1f800, 0x11101110, 0x462d0000, 0xb1e8b1e8, 0xb1e8b1e8, 0x0, 0x3aff
    .long 0x3e5800, 0x444000, 0x44404440, 0xa8c6000, 0x22622262, 0x22622262, 0x3e7f, 0x3e7f
    .long 0x83e800, 0x8c7000, 0x39363330, 0x4e68ca10, 0x440d4393, 0x44f43c87, 0x3cff3eff, 0x3cff3eff
    .long 0x2d4800, 0x372000, 0x3b384440, 0x10824660, 0x3c3d3bd0, 0x350a34aa, 0x3e7f3e7f, 0x3e7f3e7f
    .long 0xfffeb000, 0x5e800, 0x44404440, 0x4c8f0070, 0x1adc1adc, 0x1adc1adc, 0x3e7f0000, 0x3e7f3c7f
    .long 0x241800, 0x2df000, 0x3b384440, 0x108238a0, 0x3c3d3bd0, 0x350a34aa, 0x3eff3dff, 0x3eff3dff
    .long 0xfffeb000, 0x5e800, 0x44404440, 0x4c8f00b0, 0x1adc1adc, 0x1adc1adc, 0x3eff0000, 0x3eff3c7f
    .long 0x2d4800, 0x372000, 0x3b384440, 0x108246c0, 0x3c3d3bd0, 0x350a34aa, 0x3eff3e7f, 0x3eff3e7f
    .long 0x0, 0x34800, 0x11101110, 0x462d0200, 0xb1e8b1e8, 0xb1e8b1e8, 0x3aff, 0x3bff
    .long 0x3d0800, 0x459000, 0x39363330, 0x4e685e10, 0x3c0d4393, 0x44f4447a, 0x3cff3e7f, 0x3cff3e7f
    .long 0x7ff800, 0x89d000, 0x3b384440, 0x1088c420, 0x3c3033d0, 0x350a3c9d, 0x3d7f3eff, 0x3d7f3eff
    .long 0x367800, 0x405000, 0x3b384440, 0x10825430, 0x3c3d3bd0, 0x350a34aa, 0x3dff3e7f, 0x3dff3e7f
    .long 0x3f000, 0xb2800, 0x44404440, 0x4c8f0870, 0x1adc1adc, 0x1adc1adc, 0x3e7f3c7f, 0x3e7f3cff
    .long 0x2d4800, 0x372000, 0x3b384440, 0x10824670, 0x3c3d3bd0, 0x350a34aa, 0x3e7f3e7f, 0x3e7f3e7f
    .long 0x3f000, 0xb2800, 0x44404440, 0x4c8f08b0, 0x1adc1adc, 0x1adc1adc, 0x3eff3c7f, 0x3eff3cff
    .long 0x2d4800, 0x372000, 0x3b384440, 0x108246d0, 0x3c3d3bd0, 0x350a34aa, 0x3eff3e7f, 0x3eff3e7f
    .long 0x15000, 0x54000, 0x12201220, 0x473d0400, 0x71e871e8, 0x71e871e8, 0x3bff, 0x3c7f
    .long 0x367800, 0x405000, 0x3b384440, 0x10885420, 0x343d3bd0, 0x350a3c9d, 0x3d7f3e7f, 0x3d7f3e7f
    .long 0x8d1800, 0x925800, 0x44404440, 0xa8cd800, 0x22622262, 0x22622262, 0x3eff, 0x3eff
    .long 0x367800, 0x405000, 0x3b384440, 0x10825440, 0x3c3d3bd0, 0x350a34aa, 0x3dff3e7f, 0x3dff3e7f
    .long 0xfffeb000, 0x5e800, 0x44404440, 0x4c8f0080, 0x1adc1adc, 0x1adc1adc, 0x3e7f0000, 0x3e7f3c7f
    .long 0x2d4800, 0x372000, 0x3b384440, 0x10824680, 0x3c3d3bd0, 0x350a34aa, 0x3e7f3e7f, 0x3e7f3e7f
    .long 0xfffeb000, 0x5e800, 0x44404440, 0x4c8f00c0, 0x1adc1adc, 0x1adc1adc, 0x3eff0000, 0x3eff3c7f
    .long 0x367800, 0x405000, 0x3b384440, 0x108254b0, 0x3c3d3bd0, 0x350a34aa, 0x3eff3e7f, 0x3eff3e7f
    .long 0x34800, 0x73800, 0x12201220, 0x473d0700, 0x71e871e8, 0x71e871e8, 0x3c7f, 0x3cff
    .long 0x439800, 0x498000, 0x44404440, 0xa8c6800, 0x22622262, 0x22622262, 0x3e7f, 0x3e7f
    .long 0x8bc800, 0x925800, 0x28263330, 0x4c68d610, 0x4c0d4393, 0x3d013c94, 0x3cff3eff, 0x3cff3eff
    .long 0x367800, 0x405000, 0x3b384440, 0x10825450, 0x3c3d3bd0, 0x350a34aa, 0x3e7f3e7f, 0x3e7f3e7f
    .long 0x3f000, 0xb2800, 0x44404440, 0x4c8f0880, 0x1adc1adc, 0x1adc1adc, 0x3e7f3c7f, 0x3e7f3cff
    .long 0x2d4800, 0x372000, 0x3b384440, 0x10824690, 0x3c3d3bd0, 0x350a34aa, 0x3eff3e7f, 0x3eff3e7f
    .long 0x3f000, 0xb2800, 0x44404440, 0x4c8f08c0, 0x1adc1adc, 0x1adc1adc, 0x3eff3c7f, 0x3eff3cff
    .long 0x367800, 0x405000, 0x3b384440, 0x108254c0, 0x3c3d3bd0, 0x350a34aa, 0x3eff3e7f, 0x3eff3e7f
    .long 0x54000, 0x9d800, 0x22202220, 0x484d0a00, 0x59e859e8, 0x59e859e8, 0x3cff, 0x3cff
    .long 0x44e800, 0x4d7000, 0x39363330, 0x4e686a10, 0x440d4393, 0x44f43c87, 0x3cff3e7f, 0x3cff3e7f
    .long 0x892800, 0x925800, 0x3b384440, 0x1088d220, 0x343d3bd0, 0x350a3c9d, 0x3d7f3eff, 0x3d7f3eff
    .long 0x367800, 0x405000, 0x3b384440, 0x10825460, 0x3c3d3bd0, 0x350a34aa, 0x3e7f3e7f, 0x3e7f3e7f
    .long 0xfffeb000, 0x5e800, 0x44404440, 0x4c8f0090, 0x1adc1adc, 0x1adc1adc, 0x3eff0000, 0x3eff3c7f
    .long 0x2d4800, 0x372000, 0x3b384440, 0x108246a0, 0x3c3d3bd0, 0x350a34aa, 0x3eff3e7f, 0x3eff3e7f
    .long 0xfffeb000, 0x5e800, 0x44404440, 0x4c8f00d0, 0x1adc1adc, 0x1adc1adc, 0x3eff0000, 0x3eff3c7f
    .long 0x367800, 0x405000, 0x3b384440, 0x108254d0, 0x3c3d3bd0, 0x350a34aa, 0x3eff3e7f, 0x3eff3e7f
    .long 0xfffeb000, 0x5e800, 0x44404440, 0x4c8d0010, 0x1adc1adc, 0x1adc1adc, 0x3cff0000, 0x3cff3c7f
    .long 0x3fa800, 0x498000, 0x3b384440, 0x10886220, 0x3c3033d0, 0x3cfd349d, 0x3d7f3e7f, 0x3d7f3e7f
    .long 0xfffeb000, 0x5e800, 0x44404440, 0x4c8f0030, 0x1adc1adc, 0x1adc1adc, 0x3dff0000, 0x3dff3c7f
    .long 0x3fa800, 0x498000, 0x3b384440, 0x10826230, 0x3c3d3bd0, 0x350a34aa, 0x3dff3e7f, 0x3dff3e7f
    .long 0x3f000, 0xb2800, 0x44404440, 0x4c8f0890, 0x1adc1adc, 0x1adc1adc, 0x3eff3c7f, 0x3eff3cff
    .long 0x367800, 0x405000, 0x3b384440, 0x10825470, 0x3c3d3bd0, 0x350a34aa, 0x3e7f3e7f, 0x3e7f3e7f
    .long 0x3f000, 0xb2800, 0x44404440, 0x4c8f08d0, 0x1adc1adc, 0x1adc1adc, 0x3eff3c7f, 0x3eff3cff
    .long 0x3fa800, 0x498000, 0x3b384440, 0x108262b0, 0x3c3d3bd0, 0x350a34aa, 0x3eff3e7f, 0x3eff3e7f
    .long 0x3f000, 0xb2800, 0x44404440, 0x4c8d0810, 0x1adc1adc, 0x1adc1adc, 0x3cff3c7f, 0x3cff3cff
    .long 0x48d800, 0x4ec000, 0x44404440, 0xa8c7000, 0x22622262, 0x22622262, 0x3e7f, 0x3e7f
    .long 0x3f000, 0xb2800, 0x44404440, 0x4c8f0830, 0x1adc1adc, 0x1adc1adc, 0x3dff3c7f, 0x3dff3cff
    .long 0x3fa800, 0x498000, 0x3b384440, 0x10826240, 0x3c3d3bd0, 0x350a34aa, 0x3dff3e7f, 0x3dff3e7f
    .long 0xfffeb000, 0x5e800, 0x44404440, 0x4c8f00a0, 0x1adc1adc, 0x1adc1adc, 0x3eff0000, 0x3eff3c7f
    .long 0x367800, 0x405000, 0x3b384440, 0x10825480, 0x3c3d3bd0, 0x350a34aa, 0x3e7f3e7f, 0x3e7f3e7f
    .long 0x93000, 0x130800, 0x39363330, 0x506b10b0, 0x247e63d0, 0x2d172cc4, 0x3eff3cff, 0x3eff3d7f
    .long 0x3fa800, 0x498000, 0x3b384440, 0x108262c0, 0x3c3d3bd0, 0x350a34aa, 0x3eff3e7f, 0x3eff3e7f
    .long 0xfffeb000, 0x5e800, 0x44404440, 0x4c8d0020, 0x1adc1adc, 0x1adc1adc, 0x3d7f0000, 0x3d7f3c7f
    .long 0x4e1800, 0x540000, 0x44404440, 0xa8c7800, 0x22622262, 0x22622262, 0x3e7f, 0x3e7f
    .long 0xfffeb000, 0x5e800, 0x44404440, 0x4c8f0040, 0x1adc1adc, 0x1adc1adc, 0x3dff0000, 0x3dff3c7f
    .long 0x3fa800, 0x498000, 0x3b384440, 0x10826250, 0x3c3d3bd0, 0x350a34aa, 0x3e7f3e7f, 0x3e7f3e7f
    .long 0x3f000, 0xb2800, 0x44404440, 0x4c8f08a0, 0x1adc1adc, 0x1adc1adc, 0x3eff3c7f, 0x3eff3cff
    .long 0x367800, 0x405000, 0x3b384440, 0x10825490, 0x3c3d3bd0, 0x350a34aa, 0x3eff3e7f, 0x3eff3e7f
    .long 0x93000, 0x130800, 0x39363330, 0x506b10c0, 0x2c7e63d0, 0x2d1724d1, 0x3eff3cff, 0x3eff3d7f
    .long 0x3fa800, 0x498000, 0x3b384440, 0x108262d0, 0x3c3d3bd0, 0x350a34aa, 0x3eff3e7f, 0x3eff3e7f
    .long 0x3f000, 0xb2800, 0x44404440, 0x4c8d0820, 0x1adc1adc, 0x1adc1adc, 0x3d7f3c7f, 0x3d7f3cff
    .long 0x4cc800, 0x555000, 0x39363330, 0x4e687610, 0x440d4393, 0x3d014487, 0x3cff3e7f, 0x3cff3e7f
    .long 0x3f000, 0xb2800, 0x44404440, 0x4c8f0840, 0x1adc1adc, 0x1adc1adc, 0x3dff3c7f, 0x3dff3cff
    .long 0x3fa800, 0x498000, 0x3b384440, 0x10826260, 0x3c3d3bd0, 0x350a34aa, 0x3e7f3e7f, 0x3e7f3e7f
    .long 0x93000, 0x130800, 0x39363330, 0x506b1070, 0x2c7e63d0, 0x2d1724d1, 0x3e7f3cff, 0x3e7f3d7f
    .long 0x367800, 0x405000, 0x3b384440, 0x108254a0, 0x3c3d3bd0, 0x350a34aa, 0x3eff3e7f, 0x3eff3e7f
    .long 0x93000, 0x130800, 0x39363330, 0x506b10d0, 0x2c7e63d0, 0x2d1724d1, 0x3eff3cff, 0x3eff3d7f
    .long 0x48d800, 0x52b000, 0x3b384440, 0x108270b0, 0x3c3d3bd0, 0x350a34aa, 0x3eff3e7f, 0x3eff3e7f
    .long 0x7e000, 0xc7800, 0x22202220, 0x484d0e00, 0x59e859e8, 0x59e859e8, 0x3cff, 0x3d7f
    .long 0x48d800, 0x52b000, 0x3b384440, 0x10887020, 0x3c3d3bd0, 0x350a34aa, 0x3d7f3e7f, 0x3d7f3e7f
    .long 0xfffeb000, 0x5e800, 0x44404440, 0x4c8f0050, 0x1adc1adc, 0x1adc1adc, 0x3e7f0000, 0x3e7f3c7f
    .long 0x48d800, 0x52b000, 0x3b384440, 0x10827030, 0x3c3d3bd0, 0x350a34aa, 0x3dff3e7f, 0x3dff3e7f
    .long 0x93000, 0x130800, 0x39363330, 0x506b1080, 0x2c7e63d0, 0x2d1724d1, 0x3e7f3cff, 0x3e7f3d7f
    .long 0x3fa800, 0x498000, 0x3b384440, 0x10826270, 0x3c3d3bd0, 0x350a34aa, 0x3e7f3e7f, 0x3e7f3e7f
    .long 0x111000, 0x1b9000, 0x4a463330, 0x116b1cb0, 0x347a3c0d, 0x252224da, 0x3eff3d7f, 0x3eff3dff
    .long 0x48d800, 0x52b000, 0x3b384440, 0x108270c0, 0x3c3d3bd0, 0x350a34aa, 0x3eff3e7f, 0x3eff3e7f
    .long 0xa8000, 0x106800, 0x33303330, 0x4a6d1200, 0x2a622a62, 0x2a622a62, 0x3d7f, 0x3d7f
    .long 0x535800, 0x594000, 0x44404440, 0xa8c8000, 0x22622262, 0x22622262, 0x3e7f, 0x3eff
    .long 0x3f000, 0xb2800, 0x44404440, 0x4c8f0850, 0x1adc1adc, 0x1adc1adc, 0x3e7f3c7f, 0x3e7f3cff
    .long 0x48d800, 0x52b000, 0x3b384440, 0x10827040, 0x3c3d3bd0, 0x350a34aa, 0x3dff3e7f, 0x3dff3e7f
    .long 0x93000, 0x130800, 0x39363330, 0x506b1090, 0x247e63d0, 0x2d172cc4, 0x3eff3cff, 0x3eff3d7f
    .long 0x3fa800, 0x498000, 0x3b384440, 0x10826280, 0x3c3d3bd0, 0x350a34aa, 0x3e7f3e7f, 0x3e7f3e7f
    .long 0x111000, 0x1b9000, 0x4a463330, 0x116b1cc0, 0x347a3c0d, 0x252224da, 0x3eff3d7f, 0x3eff3dff
    .long 0x48d800, 0x52b000, 0x3b384440, 0x108270d0, 0x3c3d3bd0, 0x350a34aa, 0x3eff3e7f, 0x3eff3e7f
    .long 0xe7000, 0x15a800, 0x44404440, 0x4c8d1800, 0x1adc1adc, 0x1adc1adc, 0x3d7f, 0x3d7f
    .long 0x589800, 0x5e8000, 0x44404440, 0xa8c8800, 0x22622262, 0x22622262, 0x3eff, 0x3eff
    .long 0xfffeb000, 0x5e800, 0x44404440, 0x4c8f0060, 0x1adc1adc, 0x1adc1adc, 0x3e7f0000, 0x3e7f3c7f
    .long 0x48d800, 0x52b000, 0x3b384440, 0x10827050, 0x3c3d3bd0, 0x350a34aa, 0x3e7f3e7f, 0x3e7f3e7f
    .long 0x93000, 0x130800, 0x39363330, 0x506b10a0, 0x2c7e63d0, 0x2d1724d1, 0x3eff3cff, 0x3eff3d7f
    .long 0x3fa800, 0x498000, 0x3b384440, 0x10826290, 0x3c3d3bd0, 0x350a34aa, 0x3eff3e7f, 0x3eff3e7f
    .long 0x111000, 0x1b9000, 0x4a463330, 0x116b1cd0, 0x347a3c0d, 0x252224da, 0x3eff3d7f, 0x3eff3dff
    .long 0x520800, 0x5be000, 0x3b384440, 0x10827eb0, 0x3c3d3bd0, 0x350a34aa, 0x3eff3e7f, 0x3eff3eff
    .long 0x93000, 0x106800, 0x26242220, 0x4c491010, 0x344e6b93, 0x350e34ae, 0x3cff3cff, 0x3cff3d7f
    .long 0x54a800, 0x5d3000, 0x39363330, 0x4e688210, 0x3c0d4393, 0x44f4447a, 0x3cff3eff, 0x3cff3eff
    .long 0x3f000, 0xb2800, 0x44404440, 0x4c8f0860, 0x1adc1adc, 0x1adc1adc, 0x3e7f3c7f, 0x3e7f3cff
    .long 0x48d800, 0x52b000, 0x3b384440, 0x10827060, 0x3c3d3bd0, 0x350a34aa, 0x3e7f3e7f, 0x3e7f3e7f
    .long 0x111000, 0x1b9000, 0x4a463330, 0x116b1c70, 0x347a3c0d, 0x252224da, 0x3e7f3d7f, 0x3e7f3dff
    .long 0x3fa800, 0x498000, 0x3b384440, 0x108262a0, 0x3c3d3bd0, 0x350a34aa, 0x3eff3e7f, 0x3eff3e7f
    .long 0x6d9800, 0x777000, 0x3b384440, 0x1082a8a0, 0x3c3d3bd0, 0x350a34aa, 0x3eff3eff, 0x3eff3eff
    .long 0x520800, 0x5be000, 0x3b384440, 0x10827ec0, 0x3c3d3bd0, 0x350a34aa, 0x3eff3e7f, 0x3eff3eff
    .long 0xe7000, 0x16f800, 0x28263330, 0x4e691810, 0x44275393, 0x350e3ca1, 0x3cff3d7f, 0x3cff3d7f
    .long 0x520800, 0x5be000, 0x3b384440, 0x10887e20, 0x3c3d3bd0, 0x350a34aa, 0x3d7f3e7f, 0x3d7f3eff
    .long 0x93000, 0x130800, 0x39363330, 0x506b1030, 0x2c7e63d0, 0x2d1724d1, 0x3dff3cff, 0x3dff3d7f
    .long 0x520800, 0x5be000, 0x3b384440, 0x10827e30, 0x3c3d3bd0, 0x350a34aa, 0x3dff3e7f, 0x3dff3eff
    .long 0x111000, 0x1b9000, 0x4a463330, 0x116b1c80, 0x347a3c0d, 0x252224da, 0x3e7f3d7f, 0x3e7f3dff
    .long 0x48d800, 0x52b000, 0x3b384440, 0x10827070, 0x3c3d3bd0, 0x350a34aa, 0x3e7f3e7f, 0x3e7f3e7f
    .long 0x76c800, 0x80a000, 0x3b384440, 0x1082b670, 0x3c3d3bd0, 0x350a34aa, 0x3e7f3eff, 0x3e7f3eff
    .long 0x520800, 0x5be000, 0x3b384440, 0x10827ed0, 0x3c3d3bd0, 0x350a34aa, 0x3eff3e7f, 0x3eff3eff
    .long 0x93000, 0x130800, 0x39363330, 0x50691020, 0x248b6bd0, 0x2d1724d1, 0x3d7f3cff, 0x3d7f3d7f
    .long 0x5dd800, 0x63c000, 0x44404440, 0xa8c9000, 0x22622262, 0x22622262, 0x3eff, 0x3eff
    .long 0x93000, 0x130800, 0x39363330, 0x506b1040, 0x2c7e63d0, 0x2d1724d1, 0x3dff3cff, 0x3dff3d7f
    .long 0x520800, 0x5be000, 0x3b384440, 0x10827e40, 0x3c3d3bd0, 0x350a34aa, 0x3dff3e7f, 0x3dff3eff
    .long 0x111000, 0x1b9000, 0x4a463330, 0x116b1c90, 0x347a3c0d, 0x252224da, 0x3eff3d7f, 0x3eff3dff
    .long 0x48d800, 0x52b000, 0x3b384440, 0x10827080, 0x3c3d3bd0, 0x350a34aa, 0x3e7f3e7f, 0x3e7f3e7f
    .long 0x76c800, 0x80a000, 0x3b384440, 0x1082b680, 0x3c3d3bd0, 0x350a34aa, 0x3e7f3eff, 0x3e7f3eff
    .long 0x5b3800, 0x651000, 0x3b384440, 0x10828cb0, 0x3c3d3bd0, 0x350a34aa, 0x3eff3eff, 0x3eff3eff
    .long 0x13b000, 0x1ae800, 0x44404440, 0xc8d2000, 0x1adc1adc, 0x1adc1adc, 0x3d7f, 0x3dff
    .long 0x631800, 0x690000, 0x44404440, 0xa8c9800, 0x22622262, 0x22622262, 0x3eff, 0x3eff
    .long 0x93000, 0x130800, 0x39363330, 0x506b1050, 0x2c8b6bd0, 0x252424de, 0x3e7f3cff, 0x3e7f3d7f
    .long 0x520800, 0x5be000, 0x3b384440, 0x10827e50, 0x3c3d3bd0, 0x350a34aa, 0x3e7f3e7f, 0x3e7f3eff
    .long 0x111000, 0x1b9000, 0x4a463330, 0x116b1ca0, 0x347a3c0d, 0x252224da, 0x3eff3d7f, 0x3eff3dff
    .long 0x48d800, 0x52b000, 0x3b384440, 0x10827090, 0x3c3d3bd0, 0x350a34aa, 0x3eff3e7f, 0x3eff3e7f
    .long 0x76c800, 0x80a000, 0x3b384440, 0x1082b690, 0x3c3d3bd0, 0x350a34aa, 0x3eff3eff, 0x3eff3eff
    .long 0x5b3800, 0x651000, 0x3b384440, 0x10828cc0, 0x3c3d3bd0, 0x350a34aa, 0x3eff3eff, 0x3eff3eff
    .long 0x199800, 0x1f8000, 0x44404440, 0xa8c2800, 0x22622262, 0x22622262, 0x3dff, 0x3dff
    .long 0x5c8800, 0x651000, 0x39363330, 0x4e688e10, 0x440d4393, 0x44f43c87, 0x3cff3eff, 0x3cff3eff
    .long 0x93000, 0x130800, 0x39363330, 0x506b1060, 0x2c7e63d0, 0x25242cd1, 0x3e7f3cff, 0x3e7f3d7f
    .long 0x520800, 0x5be000, 0x3b384440, 0x10827e60, 0x3c3d3bd0, 0x350a34aa, 0x3e7f3e7f, 0x3e7f3eff
    .long 0x76c800, 0x80a000, 0x3b384440, 0x1082b660, 0x3c3d3bd0, 0x350a34aa, 0x3e7f3eff, 0x3e7f3eff
    .long 0x48d800, 0x52b000, 0x3b384440, 0x108270a0, 0x3c3d3bd0, 0x350a34aa, 0x3eff3e7f, 0x3eff3e7f
    .long 0x76c800, 0x80a000, 0x3b384440, 0x1082b6a0, 0x3c3d3bd0, 0x350a34aa, 0x3eff3eff, 0x3eff3eff
    .long 0x5b3800, 0x651000, 0x3b384440, 0x10828cd0, 0x3c3d3bd0, 0x350a34aa, 0x3eff3eff, 0x3eff3eff
    .long 0x150000, 0x1ed800, 0x39363330, 0x50692210, 0x343033d0, 0x3cfd3c90, 0x3cff3dff, 0x3cff3dff
    .long 0x5b3800, 0x651000, 0x3b384440, 0x10888c20, 0x3c3d3bd0, 0x350a34aa, 0x3d7f3eff, 0x3d7f3eff
    .long 0x111000, 0x1b9000, 0x4a463330, 0x116b1c30, 0x2c87440d, 0x252224da, 0x3dff3d7f, 0x3dff3dff
    .long 0x5b3800, 0x651000, 0x3b384440, 0x10828c30, 0x3c3d3bd0, 0x350a34aa, 0x3dff3eff, 0x3dff3eff
    .long 0x7ff800, 0x89d000, 0x3b384440, 0x1082c430, 0x3c3d3bd0, 0x350a34aa, 0x3dff3eff, 0x3dff3eff
    .long 0x520800, 0x5be000, 0x3b384440, 0x10827e70, 0x3c3d3bd0, 0x350a34aa, 0x3e7f3e7f, 0x3e7f3eff
    .long 0x7ff800, 0x89d000, 0x3b384440, 0x1082c470, 0x3c3d3bd0, 0x350a34aa, 0x3e7f3eff, 0x3e7f3eff
    .long 0x646800, 0x6e4000, 0x3b384440, 0x10829ab0, 0x3c3d3bd0, 0x350a34aa, 0x3eff3eff, 0x3eff3eff
    .long 0x111000, 0x1b9000, 0x4a463330, 0x11691c20, 0x347a3c0d, 0x252224da, 0x3d7f3d7f, 0x3d7f3dff
    .long 0x685800, 0x6e4000, 0x44404440, 0xa8ca000, 0x22622262, 0x22622262, 0x3eff, 0x3eff
    .long 0x111000, 0x1b9000, 0x4a463330, 0x116b1c40, 0x347a3c0d, 0x252224da, 0x3dff3d7f, 0x3dff3dff
    .long 0x5b3800, 0x651000, 0x3b384440, 0x10828c40, 0x3c3d3bd0, 0x350a34aa, 0x3dff3eff, 0x3dff3eff
    .long 0x7ff800, 0x89d000, 0x3b384440, 0x1082c440, 0x3c3d3bd0, 0x350a34aa, 0x3dff3eff, 0x3dff3eff
    .long 0x520800, 0x5be000, 0x3b384440, 0x10827e80, 0x3c3d3bd0, 0x350a34aa, 0x3e7f3e7f, 0x3e7f3eff
    .long 0x7ff800, 0x89d000, 0x3b384440, 0x1082c480, 0x3c3d3bd0, 0x350a34aa, 0x3e7f3eff, 0x3e7f3eff
    .long 0x646800, 0x6e4000, 0x3b384440, 0x10829ac0, 0x3c3d3bd0, 0x350a34aa, 0x3eff3eff, 0x3eff3eff
    .long 0x1ed800, 0x24c000, 0x44404440, 0xa8c3000, 0x22622262, 0x22622262, 0x3dff, 0x3dff
    .long 0x646800, 0x6cf000, 0x39363330, 0x4e689a10, 0x3c0d4393, 0x44f4447a, 0x3cff3eff, 0x3cff3eff
    .long 0x111000, 0x1b9000, 0x4a463330, 0x116b1c50, 0x347a3c0d, 0x252224da, 0x3e7f3d7f, 0x3e7f3dff
    .long 0x5b3800, 0x651000, 0x3b384440, 0x10828c50, 0x3c3d3bd0, 0x350a34aa, 0x3e7f3eff, 0x3e7f3eff
    .long 0x7ff800, 0x89d000, 0x3b384440, 0x1082c450, 0x3c3d3bd0, 0x350a34aa, 0x3e7f3eff, 0x3e7f3eff
    .long 0x520800, 0x5be000, 0x3b384440, 0x10827e90, 0x3c3d3bd0, 0x350a34aa, 0x3eff3e7f, 0x3eff3eff
    .long 0x7ff800, 0x89d000, 0x3b384440, 0x1082c490, 0x3c3d3bd0, 0x350a34aa, 0x3eff3eff, 0x3eff3eff
    .long 0x646800, 0x6e4000, 0x3b384440, 0x10829ad0, 0x3c3d3bd0, 0x350a34aa, 0x3eff3eff, 0x3eff3eff
    .long 0x1d8800, 0x261000, 0x39363330, 0x4e682e10, 0x3c0d4393, 0x44f4447a, 0x3cff3dff, 0x3cff3dff
    .long 0x6c4800, 0x74d000, 0x39363330, 0x4e68a610, 0x440d4393, 0x3d014487, 0x3cff3eff, 0x3cff3eff
    .long 0x111000, 0x1b9000, 0x4a463330, 0x116b1c60, 0x347a3c0d, 0x252224da, 0x3e7f3d7f, 0x3e7f3dff
    .long 0x5b3800, 0x651000, 0x3b384440, 0x10828c60, 0x3c3d3bd0, 0x350a34aa, 0x3e7f3eff, 0x3e7f3eff
    .long 0x7ff800, 0x89d000, 0x3b384440, 0x1082c460, 0x3c3d3bd0, 0x350a34aa, 0x3e7f3eff, 0x3e7f3eff
    .long 0x520800, 0x5be000, 0x3b384440, 0x10827ea0, 0x3c3d3bd0, 0x350a34aa, 0x3eff3e7f, 0x3eff3eff
    .long 0x7ff800, 0x89d000, 0x3b384440, 0x1082c4a0, 0x3c3d3bd0, 0x350a34aa, 0x3eff3eff, 0x3eff3eff
    .long 0x6d9800, 0x777000, 0x3b384440, 0x1082a8b0, 0x3c3d3bd0, 0x350a34aa, 0x3eff3eff, 0x3eff3eff
    .long 0x1ae800, 0x24c000, 0x3b384440, 0x10882a20, 0x3c3d3bd0, 0x350a34aa, 0x3d7f3dff, 0x3d7f3dff
    .long 0x646800, 0x6e4000, 0x3b384440, 0x10889a20, 0x3c3033d0, 0x350a3c9d, 0x3d7f3eff, 0x3d7f3eff
    .long 0x1ae800, 0x24c000, 0x3b384440, 0x10822a30, 0x3c3d3bd0, 0x350a34aa, 0x3dff3dff, 0x3dff3dff
    .long 0x646800, 0x6e4000, 0x3b384440, 0x10829a30, 0x3c3d3bd0, 0x350a34aa, 0x3dff3eff, 0x3dff3eff
    .long 0x892800, 0x925800, 0x3b384440, 0x1082d230, 0x3c3d3bd0, 0x350a34aa, 0x3dff3eff, 0x3dff3eff
    .long 0x5b3800, 0x651000, 0x3b384440, 0x10828c70, 0x3c3d3bd0, 0x350a34aa, 0x3e7f3eff, 0x3e7f3eff
    .long 0x892800, 0x925800, 0x3b384440, 0x1082d270, 0x3c3d3bd0, 0x350a34aa, 0x3e7f3eff, 0x3e7f3eff
    .long 0x6d9800, 0x777000, 0x3b384440, 0x1082a8c0, 0x3c3d3bd0, 0x350a34aa, 0x3eff3eff, 0x3eff3eff
    .long 0x241800, 0x2a0000, 0x44404440, 0xa8c3800, 0x22622262, 0x22622262, 0x3dff, 0x3dff
    .long 0x6d9800, 0x738000, 0x44404440, 0xa8ca800, 0x22622262, 0x22622262, 0x3eff, 0x3eff
    .long 0x1ae800, 0x24c000, 0x3b384440, 0x10822a40, 0x3c3d3bd0, 0x350a34aa, 0x3dff3dff, 0x3dff3dff
    .long 0x646800, 0x6e4000, 0x3b384440, 0x10829a40, 0x3c3d3bd0, 0x350a34aa, 0x3dff3eff, 0x3dff3eff
    .long 0x892800, 0x925800, 0x3b384440, 0x1082d240, 0x3c3d3bd0, 0x350a34aa, 0x3dff3eff, 0x3dff3eff
    .long 0x5b3800, 0x651000, 0x3b384440, 0x10828c80, 0x3c3d3bd0, 0x350a34aa, 0x3e7f3eff, 0x3e7f3eff
    .long 0x892800, 0x925800, 0x3b384440, 0x1082d280, 0x3c3d3bd0, 0x350a34aa, 0x3e7f3eff, 0x3e7f3eff
    .long 0x6d9800, 0x777000, 0x3b384440, 0x1082a8d0, 0x3c3d3bd0, 0x350a34aa, 0x3eff3eff, 0x3eff3eff
    .long 0x295800, 0x2f4000, 0x44404440, 0xa8c4000, 0x22622262, 0x22622262, 0x3dff, 0x3e7f
    .long 0x72d800, 0x78c000, 0x44404440, 0xa8cb000, 0x22622262, 0x22622262, 0x3eff, 0x3eff
    .long 0x1ae800, 0x24c000, 0x3b384440, 0x10822a50, 0x3c3d3bd0, 0x350a34aa, 0x3e7f3dff, 0x3e7f3dff
    .long 0x646800, 0x6e4000, 0x3b384440, 0x10829a50, 0x3c3d3bd0, 0x350a34aa, 0x3e7f3eff, 0x3e7f3eff
    .long 0x892800, 0x925800, 0x3b384440, 0x1082d250, 0x3c3d3bd0, 0x350a34aa, 0x3e7f3eff, 0x3e7f3eff
    .long 0x5b3800, 0x651000, 0x3b384440, 0x10828c90, 0x3c3d3bd0, 0x350a34aa, 0x3eff3eff, 0x3eff3eff
    .long 0x892800, 0x925800, 0x3b384440, 0x1082d290, 0x3c3d3bd0, 0x350a34aa, 0x3eff3eff, 0x3eff3eff
    .long 0x76c800, 0x80a000, 0x3b384440, 0x1082b6b0, 0x3c3d3bd0, 0x350a34aa, 0x3eff3eff, 0x3eff3eff
    .long 0x256800, 0x2df000, 0x39363330, 0x4e683a10, 0x440d4393, 0x44f43c87, 0x3cff3dff, 0x3cff3dff
    .long 0x742800, 0x7cb000, 0x39363330, 0x4e68b210, 0x44003b93, 0x44f4447a, 0x3cff3eff, 0x3cff3eff
    .long 0x1ae800, 0x24c000, 0x3b384440, 0x10822a60, 0x3c3d3bd0, 0x350a34aa, 0x3e7f3dff, 0x3e7f3dff
    .long 0x646800, 0x6e4000, 0x3b384440, 0x10829a60, 0x3c3d3bd0, 0x350a34aa, 0x3e7f3eff, 0x3e7f3eff
    .long 0x892800, 0x925800, 0x3b384440, 0x1082d260, 0x3c3d3bd0, 0x350a34aa, 0x3e7f3eff, 0x3e7f3eff
    .long 0x5b3800, 0x651000, 0x3b384440, 0x10828ca0, 0x3c3d3bd0, 0x350a34aa, 0x3eff3eff, 0x3eff3eff
    .long 0x892800, 0x925800, 0x3b384440, 0x1082d2a0, 0x3c3d3bd0, 0x350a34aa, 0x3eff3eff, 0x3eff3eff
    .long 0x76c800, 0x80a000, 0x3b384440, 0x1082b6c0, 0x3c3d3bd0, 0x350a34aa, 0x3eff3eff, 0x3eff3eff
    .long 0x241800, 0x2df000, 0x3b384440, 0x10883820, 0x3c3d3bd0, 0x350a34aa, 0x3d7f3dff, 0x3d7f3dff
    .long 0x6d9800, 0x777000, 0x3b384440, 0x1088a820, 0x3c3d3bd0, 0x350a34aa, 0x3d7f3eff, 0x3d7f3eff
    .long 0x241800, 0x2df000, 0x3b384440, 0x10823830, 0x3c3d3bd0, 0x350a34aa, 0x3dff3dff, 0x3dff3dff
    .long 0x6d9800, 0x777000, 0x3b384440, 0x1082a830, 0x3c3d3bd0, 0x350a34aa, 0x3dff3eff, 0x3dff3eff
    .long 0x1ae800, 0x24c000, 0x3b384440, 0x10822a70, 0x3c3d3bd0, 0x350a34aa, 0x3e7f3dff, 0x3e7f3dff
    .long 0x646800, 0x6e4000, 0x3b384440, 0x10829a70, 0x3c3d3bd0, 0x350a34aa, 0x3e7f3eff, 0x3e7f3eff
    .long 0x1ae800, 0x24c000, 0x3b384440, 0x10822ab0, 0x3c3d3bd0, 0x350a34aa, 0x3eff3dff, 0x3eff3dff
    .long 0x76c800, 0x80a000, 0x3b384440, 0x1082b6d0, 0x3c3d3bd0, 0x350a34aa, 0x3eff3eff, 0x3eff3eff
    .long 0x2e9800, 0x348000, 0x44404440, 0xa8c4800, 0x22622262, 0x22622262, 0x3e7f, 0x3e7f
    .long 0x781800, 0x7e0000, 0x44404440, 0xa8cb800, 0x22622262, 0x22622262, 0x3eff, 0x3eff
    .long 0x241800, 0x2df000, 0x3b384440, 0x10823840, 0x3c3d3bd0, 0x350a34aa, 0x3dff3dff, 0x3dff3dff
    .long 0x6d9800, 0x777000, 0x3b384440, 0x1082a840, 0x3c3d3bd0, 0x350a34aa, 0x3dff3eff, 0x3dff3eff
    .long 0x1ae800, 0x24c000, 0x3b384440, 0x10822a80, 0x3c3d3bd0, 0x350a34aa, 0x3e7f3dff, 0x3e7f3dff
    .long 0x646800, 0x6e4000, 0x3b384440, 0x10829a80, 0x3c3d3bd0, 0x350a34aa, 0x3e7f3eff, 0x3e7f3eff
    .long 0x1ae800, 0x24c000, 0x3b384440, 0x10822ac0, 0x3c3d3bd0, 0x350a34aa, 0x3eff3dff, 0x3eff3dff
    .long 0x7ff800, 0x89d000, 0x3b384440, 0x1082c4b0, 0x3c3d3bd0, 0x350a34aa, 0x3eff3eff, 0x3eff3eff
    .long 0x33d800, 0x39c000, 0x44404440, 0xa8c5000, 0x22622262, 0x22622262, 0x3e7f, 0x3e7f
    .long 0x7d5800, 0x834000, 0x44404440, 0xa8cc000, 0x22622262, 0x22622262, 0x3eff, 0x3eff
    .long 0x241800, 0x2df000, 0x3b384440, 0x10823850, 0x3c3d3bd0, 0x350a34aa, 0x3e7f3dff, 0x3e7f3dff
    .long 0x6d9800, 0x777000, 0x3b384440, 0x1082a850, 0x3c3d3bd0, 0x350a34aa, 0x3e7f3eff, 0x3e7f3eff
    .long 0x1ae800, 0x24c000, 0x3b384440, 0x10822a90, 0x3c3d3bd0, 0x350a34aa, 0x3eff3dff, 0x3eff3dff
    .long 0x646800, 0x6e4000, 0x3b384440, 0x10829a90, 0x3c3d3bd0, 0x350a34aa, 0x3eff3eff, 0x3eff3eff
    .long 0x1ae800, 0x24c000, 0x3b384440, 0x10822ad0, 0x3c3d3bd0, 0x350a34aa, 0x3eff3dff, 0x3eff3dff
    .long 0x7ff800, 0x89d000, 0x3b384440, 0x1082c4c0, 0x3c3d3bd0, 0x350a34aa, 0x3eff3eff, 0x3eff3eff
    .long 0x2d4800, 0x35d000, 0x39363330, 0x4e684610, 0x440d4393, 0x44f43c87, 0x3cff3e7f, 0x3cff3e7f
    .long 0x7c0800, 0x849000, 0x39363330, 0x4e68be10, 0x44003b93, 0x44f4447a, 0x3cff3eff, 0x3cff3eff
    .long 0x241800, 0x2df000, 0x3b384440, 0x10823860, 0x3c3d3bd0, 0x350a34aa, 0x3e7f3dff, 0x3e7f3dff
    .long 0x6d9800, 0x777000, 0x3b384440, 0x1082a860, 0x3c3d3bd0, 0x350a34aa, 0x3e7f3eff, 0x3e7f3eff
    .long 0x1ae800, 0x24c000, 0x3b384440, 0x10822aa0, 0x3c3d3bd0, 0x350a34aa, 0x3eff3dff, 0x3eff3dff
    .long 0x646800, 0x6e4000, 0x3b384440, 0x10829aa0, 0x3c3d3bd0, 0x350a34aa, 0x3eff3eff, 0x3eff3eff
    .long 0x241800, 0x2df000, 0x3b384440, 0x108238b0, 0x3c3d3bd0, 0x350a34aa, 0x3eff3dff, 0x3eff3dff
    .long 0x7ff800, 0x89d000, 0x3b384440, 0x1082c4d0, 0x3c3d3bd0, 0x350a34aa, 0x3eff3eff, 0x3eff3eff
    .long 0x352800, 0x3db000, 0x39363330, 0x4e685210, 0x44003b93, 0x44f4447a, 0x3cff3e7f, 0x3cff3e7f
    .long 0x76c800, 0x80a000, 0x3b384440, 0x1088b620, 0x343d3bd0, 0x350a3c9d, 0x3d7f3eff, 0x3d7f3eff
    .long 0x2d4800, 0x372000, 0x3b384440, 0x10824630, 0x3c3d3bd0, 0x350a34aa, 0x3dff3e7f, 0x3dff3e7f
    .long 0x76c800, 0x80a000, 0x3b384440, 0x1082b630, 0x3c3d3bd0, 0x350a34aa, 0x3dff3eff, 0x3dff3eff
    .long 0x241800, 0x2df000, 0x3b384440, 0x10823870, 0x3c3d3bd0, 0x350a34aa, 0x3e7f3dff, 0x3e7f3dff
    .long 0x6d9800, 0x777000, 0x3b384440, 0x1082a870, 0x3c3d3bd0, 0x350a34aa, 0x3e7f3eff, 0x3e7f3eff
    .long 0x241800, 0x2df000, 0x3b384440, 0x108238c0, 0x3c3d3bd0, 0x350a34aa, 0x3eff3dff, 0x3eff3dff
    .long 0x892800, 0x925800, 0x3b384440, 0x1082d2b0, 0x3c3d3bd0, 0x350a34aa, 0x3eff3eff, 0x3eff3eff
    .long 0x2d4800, 0x372000, 0x3b384440, 0x10884620, 0x3c3d3bd0, 0x350a34aa, 0x3d7f3e7f, 0x3d7f3e7f
    .long 0x829800, 0x888000, 0x44404440, 0xa8cc800, 0x22622262, 0x22622262, 0x3eff, 0x3eff
    .long 0x2d4800, 0x372000, 0x3b384440, 0x10824640, 0x3c3d3bd0, 0x350a34aa, 0x3dff3e7f, 0x3dff3e7f
    .long 0x76c800, 0x80a000, 0x3b384440, 0x1082b640, 0x3c3d3bd0, 0x350a34aa, 0x3dff3eff, 0x3dff3eff
    .long 0x241800, 0x2df000, 0x3b384440, 0x10823880, 0x3c3d3bd0, 0x350a34aa, 0x3e7f3dff, 0x3e7f3dff
    .long 0x6d9800, 0x777000, 0x3b384440, 0x1082a880, 0x3c3d3bd0, 0x350a34aa, 0x3e7f3eff, 0x3e7f3eff
    .long 0x241800, 0x2df000, 0x3b384440, 0x108238d0, 0x3c3d3bd0, 0x350a34aa, 0x3eff3dff, 0x3eff3dff
    .long 0x892800, 0x925800, 0x3b384440, 0x1082d2c0, 0x3c3d3bd0, 0x350a34aa, 0x3eff3eff, 0x3eff3eff
    .long 0x391800, 0x3f0000, 0x44404440, 0xa8c5800, 0x22622262, 0x22622262, 0x3e7f, 0x3e7f
    .long 0x87d800, 0x8dc000, 0x44404440, 0xa8cd000, 0x22622262, 0x22622262, 0x3eff, 0x3eff
    .long 0x2d4800, 0x372000, 0x3b384440, 0x10824650, 0x3c3d3bd0, 0x350a34aa, 0x3e7f3e7f, 0x3e7f3e7f
    .long 0x76c800, 0x80a000, 0x3b384440, 0x1082b650, 0x3c3d3bd0, 0x350a34aa, 0x3e7f3eff, 0x3e7f3eff
    .long 0x241800, 0x2df000, 0x3b384440, 0x10823890, 0x3c3d3bd0, 0x350a34aa, 0x3eff3dff, 0x3eff3dff
    .long 0x6d9800, 0x777000, 0x3b384440, 0x1082a890, 0x3c3d3bd0, 0x350a34aa, 0x3eff3eff, 0x3eff3eff
    .long 0x2d4800, 0x372000, 0x3b384440, 0x108246b0, 0x3c3d3bd0, 0x350a34aa, 0x3eff3e7f, 0x3eff3e7f
    .long 0x892800, 0x925800, 0x3b384440, 0x1082d2d0, 0x3c3d3bd0, 0x350a34aa, 0x3eff3eff, 0x3eff3eff
.section .rodata,"a"
.p2align 6
.amdhsa_kernel standalone__deformable_dcnv1__vision_kernel
  .amdhsa_next_free_vgpr 256
  .amdhsa_next_free_sgpr 102
  .amdhsa_accum_offset 256
  .amdhsa_group_segment_fixed_size 0
  .amdhsa_kernarg_size 48
  .amdhsa_user_sgpr_count 2
  .amdhsa_user_sgpr_kernarg_segment_ptr 1
  .amdhsa_system_sgpr_workgroup_id_x 1
  .amdhsa_float_denorm_mode_32 3
.end_amdhsa_kernel
```

```asm
; @launch grid=(256,1,1) block=(512,1,1) lds=163840
.amdgcn_target "amdgcn-amd-amdhsa--gfx950"
.text
.globl standalone__deformable_dcnv1__vision_kernel
.p2align 12
.p2align 8
.type standalone__deformable_dcnv1__vision_kernel,@function
standalone__deformable_dcnv1__vision_kernel:
    s_cmp_ge_u32 s2, 256
    s_cbranch_scc1 L_end
    s_getpc_b64 s[40:41]
L_pc:
    s_lshl_b32 s96, s2, 5
    s_add_u32 s96, s96, L_runtab-L_pc
    s_add_u32 s42, s40, s96
    s_addc_u32 s43, s41, 0
    s_load_dwordx8 s[20:27], s[42:43], 0
    s_load_dwordx2 s[12:13], s[0:1], 16
    s_load_dwordx2 s[4:5], s[0:1], 0
    s_load_dwordx2 s[8:9], s[0:1], 8
    s_load_dwordx2 s[16:17], s[0:1], 24
    v_lshrrev_b32 v73, 6, v0
    v_and_b32 v72, 63, v0
    v_readfirstlane_b32 s28, v73
    v_lshlrev_b32 v16, 4, v72
    v_mul_u32_u24 v228, 12, v72
    s_mov_b32 s6, 9633792
    s_mov_b32 s7, 0x00020000
    s_mov_b32 s10, 1806336
    s_mov_b32 s11, s7
    s_mov_b32 s14, 165888
    s_mov_b32 s15, s7
    s_mov_b32 s18, s6
    s_mov_b32 s19, s7
    s_and_b32 s29, s28, 1
    s_lshr_b32 s30, s28, 1
    s_lshl_b32 s30, s30, 3
    s_and_b32 s97, s28, 3
    v_add_u32 v0, L_ctab-L_pc+2048, v16
    s_mov_b32 s70, 0x152020
    s_mov_b32 s71, 0xc0010
    global_load_dwordx4 v[240:243], v0, s[40:41] offset:-2048
    s_lshl_b32 s96, s2, 3
    s_lshr_b64 s[70:71], s[70:71], s96
    s_and_b32 s70, s70, 0xff
    s_lshr_b32 s96, s2, 3
    s_cmp_ge_u32 s96, s70
    s_mov_b32 s75, 0
    s_cbranch_scc1 L_nocl
    global_load_dwordx4 v[224:227], v0, s[40:41] offset:-1024
    global_load_dwordx4 v[232:235], v0, s[40:41] offset:0
    global_load_dwordx4 v[12:15], v0, s[40:41] offset:1024
    global_load_dwordx4 v[8:11], v0, s[40:41] offset:2048
    s_mov_b32 s70, 0x90f14
    s_mov_b32 s71, 0x60008
    s_lshl_b32 s98, s2, 3
    s_lshr_b64 s[70:71], s[70:71], s98
    s_and_b32 s70, s70, 0xff
    s_lshr_b32 s75, s28, 2
    s_add_u32 s75, s75, 1
    s_cmp_lt_u32 s96, s70
    s_cselect_b32 s75, 3, s75
L_nocl:
    s_lshl_b32 s98, s28, 12
    v_lshlrev_b32 v22, 3, v16
    v_add_u32 v22, s98, v22
    v_min_u32 v22, L_cold-L_pc, v22
    s_lshl_b64 exec, 1, s96
    global_load_dword v22, v22, s[40:41]
    s_mov_b64 exec, -1
    s_lshl_b32 s96, s97, 10
    v_add_u32 v19, s96, v16
    s_add_u32 s96, s96, 89280
    s_cmp_ge_u32 s97, 3
    s_cselect_b32 s88, 32, 0
    s_add_u32 s88, s88, s96
    s_cmp_ge_u32 s97, 2
    s_cselect_b32 s89, 32, 0
    s_add_u32 s89, s89, s96
    s_cmp_ge_u32 s97, 1
    s_cselect_b32 s90, 32, 0
    s_add_u32 s90, s90, s96
    s_mul_i32 s94, s97, 960
    s_mul_i32 s98, s97, 5
    v_mul_u32_u24 v76, 5462, v72
    v_lshrrev_b32 v76, 16, v76
    v_mul_u32_u24 v73, 12, v76
    v_add_u32 v76, s98, v76
    v_sub_u32 v73, v72, v73
    v_bfe_u32 v74, v76, 2, 2
    v_xor_b32 v73, v73, v74
    v_lshlrev_b32 v20, 4, v73
    v_cmp_gt_u32 s[92:93], 60, v72
    s_cmp_eq_u32 s75, 1
    s_cbranch_scc1 L_startAH
    s_cmp_eq_u32 s75, 2
    s_cbranch_scc1 L_startBH
    s_cmp_eq_u32 s75, 3
    s_cbranch_scc1 L_startD
    s_mov_b32 s35, 0
    s_mov_b32 s37, 0
    s_mov_b32 s38, 0
    v_mov_b32 v108, 0
    v_mov_b32 v109, 0
    v_mov_b32 v110, 0
    v_mov_b32 v111, 0
    s_cmp_lt_u32 s28, 4
    s_cselect_b32 s39, 0, 0x3e
    s_cselect_b32 s99, 0, 768
    s_mov_b32 s95, 73728
    s_lshl_b32 s96, s28, 2
    s_add_u32 s96, s96, 163776
    v_mov_b32 v254, s96
    v_mfma_f32_32x32x16_bf16 v[24:39], v[108:111], v[108:111], 0
    v_mfma_f32_32x32x16_bf16 v[40:55], v[108:111], v[108:111], 0
    v_mfma_f32_32x32x16_bf16 v[56:71], v[108:111], v[108:111], 0
    v_xor_b32 v255, 4, v254
    ds_write_b32 v254, v108
    s_waitcnt lgkmcnt(0)
    s_lshr_b32 s96, s22, s30
    s_and_b32 s32, s23, 0xff
    s_and_b32 s31, s96, 15
    s_bfe_u32 s30, s96, 0x30004
    s_bfe_u32 s33, s23, 0x80008
    s_add_u32 s0, s33, s31
    s_mul_i32 s3, s0, 224
    s_add_u32 s3, s3, s32
    s_mul_i32 s3, s3, 36
    s_cmp_gt_u32 s30, 0
    s_cselect_b32 s96, s3, 2130706432
    s_addk_i32 s3, 8064
    buffer_load_dwordx3 v[204:206], v228, s[8:11], s96 offen
    s_cmp_gt_u32 s30, 1
    s_cselect_b32 s96, s3, 2130706432
    s_addk_i32 s3, 8064
    buffer_load_dwordx3 v[208:210], v228, s[8:11], s96 offen
    s_cmp_gt_u32 s30, 2
    s_cselect_b32 s96, s3, 2130706432
    s_addk_i32 s3, 8064
    buffer_load_dwordx3 v[212:214], v228, s[8:11], s96 offen
    s_cmp_gt_u32 s30, 3
    s_cselect_b32 s96, s3, 2130706432
    s_addk_i32 s3, 8064
    buffer_load_dwordx3 v[216:218], v228, s[8:11], s96 offen
    s_sub_u32 s34, s32, 2
    s_bfe_u32 s100, s23, 0x10011
    s_lshl_b32 s101, s100, 1
    s_sub_u32 s101, 19, s101
    s_bfe_u32 s96, s23, 0x10010
    s_sub_u32 s33, s33, s96
    s_sub_u32 s33, s33, 1
    s_cmp_lt_u32 s28, 4
    s_cbranch_scc1 L_startA
    s_add_u32 m0, s88, 0
    s_mov_b32 s96, 0
    buffer_load_dwordx4 v19, s[12:15], s96 offen lds
    s_add_u32 m0, s89, 4128
    s_mov_b32 s96, 4096
    buffer_load_dwordx4 v19, s[12:15], s96 offen lds
    s_movk_i32 s97, 223
    v_add_u32 v74, s34, v76
    v_subrev_u32 v75, s100, v76
    v_med3_i32 v74, v74, 0, s97
    v_cmp_ge_u32 vcc, s101, v75
    v_mul_u32_u24 v74, 192, v74
    s_and_b64 s[92:93], s[92:93], vcc
    v_add_u32 v20, v74, v20
    s_add_u32 m0, s90, 8256
    s_mov_b32 s96, 8192
    buffer_load_dwordx4 v19, s[12:15], s96 offen lds
    s_add_u32 m0, s88, 12416
    s_mov_b32 s96, 12288
    buffer_load_dwordx4 v19, s[12:15], s96 offen lds
    s_add_u32 m0, s89, 16544
    s_mov_b32 s96, 16384
    buffer_load_dwordx4 v19, s[12:15], s96 offen lds
    s_max_i32 s96, s20, 0
    s_add_u32 m0, s94, 0
    s_mov_b64 exec, s[92:93]
    s_add_u32 s20, s20, 43008
    buffer_load_dwordx4 v20, s[4:7], s96 offen lds
    s_max_i32 s96, s20, 0
    s_addk_i32 m0, 3840
    s_add_u32 s20, s20, 43008
    buffer_load_dwordx4 v20, s[4:7], s96 offen lds
    s_min_i32 s96, s20, s21
    s_addk_i32 m0, 3840
    s_add_u32 s20, s20, 43008
    buffer_load_dwordx4 v20, s[4:7], s96 offen lds
    s_min_i32 s96, s20, s21
    s_addk_i32 m0, 3840
    s_add_u32 s20, s20, 43008
    buffer_load_dwordx4 v20, s[4:7], s96 offen lds
    s_min_i32 s96, s20, s21
    s_addk_i32 m0, 3840
    s_add_u32 s20, s20, 43008
    buffer_load_dwordx4 v20, s[4:7], s96 offen lds
    s_min_i32 s96, s20, s21
    s_addk_i32 m0, 3840
    s_add_u32 s20, s20, 43008
    buffer_load_dwordx4 v20, s[4:7], s96 offen lds
    s_min_i32 s96, s20, s21
    s_addk_i32 m0, 3840
    s_add_u32 s20, s20, 43008
    buffer_load_dwordx4 v20, s[4:7], s96 offen lds
    s_min_i32 s96, s20, s21
    s_addk_i32 m0, 3840
    s_add_u32 s20, s20, 43008
    buffer_load_dwordx4 v20, s[4:7], s96 offen lds
    s_mov_b64 exec, -1
    s_mov_b32 s26, s27
    s_waitcnt vmcnt(13)
    s_call_b64 s[76:77], L_pos
    s_add_u32 m0, s90, 20672
    s_mov_b32 s96, 20480
    buffer_load_dwordx4 v19, s[12:15], s96 offen lds
    s_add_u32 m0, s88, 24832
    s_mov_b32 s96, 24576
    buffer_load_dwordx4 v19, s[12:15], s96 offen lds
    s_add_u32 m0, s89, 28960
    s_mov_b32 s96, 28672
    buffer_load_dwordx4 v19, s[12:15], s96 offen lds
    s_add_u32 m0, s90, 33088
    s_mov_b32 s96, 32768
    buffer_load_dwordx4 v19, s[12:15], s96 offen lds
    s_min_i32 s96, s20, s21
    s_add_u32 m0, s94, 30720
    s_mov_b64 exec, s[92:93]
    s_add_u32 s20, s20, 43008
    buffer_load_dwordx4 v20, s[4:7], s96 offen lds
    s_min_i32 s96, s20, s21
    s_addk_i32 m0, 3840
    s_add_u32 s20, s20, 43008
    buffer_load_dwordx4 v20, s[4:7], s96 offen lds
    s_min_i32 s96, s20, s21
    s_addk_i32 m0, 3840
    s_add_u32 s20, s20, 43008
    buffer_load_dwordx4 v20, s[4:7], s96 offen lds
    s_min_i32 s96, s20, s21
    s_addk_i32 m0, 3840
    s_add_u32 s20, s20, 43008
    buffer_load_dwordx4 v20, s[4:7], s96 offen lds
    s_mov_b64 exec, -1
    s_waitcnt vmcnt(8)
    s_barrier
    s_min_i32 s96, s20, s21
    s_add_u32 m0, s94, 46080
    s_mov_b64 exec, s[92:93]
    s_add_u32 s20, s20, 43008
    buffer_load_dwordx4 v20, s[4:7], s96 offen lds
    s_min_i32 s96, s20, s21
    s_addk_i32 m0, 3840
    s_add_u32 s20, s20, 43008
    buffer_load_dwordx4 v20, s[4:7], s96 offen lds
    s_min_i32 s96, s20, s21
    s_addk_i32 m0, 3840
    s_add_u32 s20, s20, 43008
    buffer_load_dwordx4 v20, s[4:7], s96 offen lds
    s_mov_b64 exec, -1
    s_add_u32 m0, s88, 37248
    s_mov_b32 s96, 36864
    buffer_load_dwordx4 v19, s[12:15], s96 offen lds
    s_waitcnt vmcnt(8)
    s_barrier
    s_add_u32 m0, s89, 41376
    s_mov_b32 s96, 40960
    buffer_load_dwordx4 v19, s[12:15], s96 offen lds
    s_add_u32 m0, s90, 45504
    s_mov_b32 s96, 45056
    buffer_load_dwordx4 v19, s[12:15], s96 offen lds
    s_add_u32 m0, s88, 49664
    s_mov_b32 s96, 49152
    buffer_load_dwordx4 v19, s[12:15], s96 offen lds
    s_add_u32 m0, s89, 53792
    s_mov_b32 s96, 53248
    buffer_load_dwordx4 v19, s[12:15], s96 offen lds
    s_add_u32 m0, s90, 57920
    s_mov_b32 s96, 57344
    buffer_load_dwordx4 v19, s[12:15], s96 offen lds
    s_add_u32 m0, s88, 62080
    s_mov_b32 s96, 61440
    buffer_load_dwordx4 v19, s[12:15], s96 offen lds
    s_add_u32 m0, s89, 66208
    s_mov_b32 s96, 65536
    buffer_load_dwordx4 v19, s[12:15], s96 offen lds
    s_add_u32 m0, s90, 70336
    s_mov_b32 s96, 69632
    buffer_load_dwordx4 v19, s[12:15], s96 offen lds
    s_waitcnt vmcnt(4)
    s_branch L_first
L_startA:
    s_lshr_b32 s96, s2, 3
    s_and_b32 s96, s96, 31
    s_lshl_b32 s96, s96, 2
    s_add_u32 s96, s96, s28
    s_mul_i32 s96, s96, 1152
    s_add_u32 s96, s96, 18432
    v_lshlrev_b32 v23, 3, v16
    s_mov_b64 exec, 0x1ff
    buffer_load_dword v23, v23, s[12:15], s96 offen
    s_mov_b64 exec, -1
    s_waitcnt vmcnt(1)
    s_call_b64 s[76:77], L_pos
    s_branch L_first
L_pos:
    s_mov_b32 s64, 0x7fff7fff
    v_and_b32 v74, s64, v204
    s_sub_u32 s96, s0, s33
    v_and_b32 v75, s64, v205
    s_mul_i32 s97, s29, 96
    v_pk_max_u16 v72, v74, s26
    s_sub_u32 s96, s96, 1
    v_pk_max_u16 v73, v75, s26
    s_add_u32 s98, s97, 89280
    v_and_b32 v74, s64, v206
    s_mul_i32 s96, s96, 3840
    v_and_b32 v75, s64, v208
    v_add_u32_sdwa v4, s98, v240 dst_sel:DWORD dst_unused:UNUSED_PAD src0_sel:DWORD src1_sel:WORD_0
    v_pk_max_u16 v72, v74, v72
    v_add_u32_sdwa v5, s98, v240 dst_sel:DWORD dst_unused:UNUSED_PAD src0_sel:DWORD src1_sel:WORD_0
    v_pk_max_u16 v73, v75, v73
    s_bfe_u32 s98, s23, 0x40014
    v_and_b32 v74, s64, v209
    v_add_u32_sdwa v1, s96, v240 dst_sel:DWORD dst_unused:UNUSED_PAD src0_sel:DWORD src1_sel:WORD_1
    v_and_b32 v75, s64, v210
    v_add_u32_sdwa v2, s96, v241 dst_sel:DWORD dst_unused:UNUSED_PAD src0_sel:DWORD src1_sel:WORD_0
    v_pk_max_u16 v72, v74, v72
    v_add_u32_sdwa v3, s96, v241 dst_sel:DWORD dst_unused:UNUSED_PAD src0_sel:DWORD src1_sel:WORD_1
    v_pk_max_u16 v73, v75, v73
    s_mul_i32 s98, s98, 3840
    v_and_b32 v74, s64, v212
    s_sub_u32 s98, 107904, s98
    v_and_b32 v75, s64, v213
    s_cmp_lt_u32 s28, 4
    v_pk_max_u16 v72, v74, v72
    s_cselect_b32 s98, 0, s98
    v_pk_max_u16 v73, v75, v73
    s_mul_i32 s96, s31, 3840
    v_and_b32 v74, s64, v214
    s_add_u32 s96, s96, s98
    v_and_b32 v75, s64, v216
    s_add_u32 s97, s97, s96
    v_pk_max_u16 v72, v74, v72
    v_add_u32_sdwa v21, s97, v242 dst_sel:DWORD dst_unused:UNUSED_PAD src0_sel:DWORD src1_sel:WORD_0
    v_pk_max_u16 v73, v75, v73
    s_mul_i32 s97, s29, 3840
    v_and_b32 v74, s64, v217
    s_add_u32 s97, s97, s96
    v_and_b32 v75, s64, v218
    v_add_u32_sdwa v248, s97, v242 dst_sel:DWORD dst_unused:UNUSED_PAD src0_sel:DWORD src1_sel:WORD_1
    v_pk_max_u16 v72, v74, v72
    v_add_u32_sdwa v249, s97, v243 dst_sel:DWORD dst_unused:UNUSED_PAD src0_sel:DWORD src1_sel:WORD_0
    v_pk_max_u16 v73, v75, v73
    v_add_u32_sdwa v250, s97, v243 dst_sel:DWORD dst_unused:UNUSED_PAD src0_sel:DWORD src1_sel:WORD_1
    v_pk_max_u16 v72, v72, v73
    s_mov_b32 exec_hi, 0xffff
    v_cmp_ne_u32 vcc, s26, v72
    s_mov_b32 exec_hi, -1
    s_cmp_lg_u64 vcc, 0
    s_cselect_b32 s38, 2, 0
    s_setpc_b64 s[76:77]
.p2align 12
L_first:
    s_waitcnt lgkmcnt(0)
    s_or_b32 s3, s37, s39
    s_or_b32 s3, s3, s99
    s_or_b32 s3, s3, 512
    s_cmp_lg_u32 s38, 0
    s_barrier
    s_cbranch_scc1 L_trip
L_nfirst:
    ds_read_b128 v[108:111], v1 offset:0
    ds_read_b64_tr_b16 v[72:73], v5 offset:0
    ds_read_b64_tr_b16 v[74:75], v5 offset:768
    ds_read_b64_tr_b16 v[76:77], v5 offset:32
    ds_read_b64_tr_b16 v[78:79], v5 offset:800
    ds_read_b64_tr_b16 v[80:81], v5 offset:64
    ds_read_b64_tr_b16 v[82:83], v5 offset:832
    ds_read_b128 v[112:115], v1 offset:3840
    ds_read_b128 v[116:119], v1 offset:7680
    ds_read_b128 v[120:123], v1 offset:11520
    s_cmp_eq_u32 s30, 4
    s_cbranch_scc0 L_nf3
    s_waitcnt lgkmcnt(7)
    v_mfma_f32_16x16x32_bf16 v[24:27], v[72:75], v[108:111], v[24:27]
    ds_read_b64_tr_b16 v[84:85], v5 offset:6208
    ds_read_b64_tr_b16 v[86:87], v5 offset:6976
    s_waitcnt lgkmcnt(7)
    v_mfma_f32_16x16x32_bf16 v[28:31], v[76:79], v[108:111], v[28:31]
    ds_read_b64_tr_b16 v[88:89], v5 offset:6240
    ds_read_b64_tr_b16 v[90:91], v5 offset:7008
    s_waitcnt lgkmcnt(7)
    v_mfma_f32_16x16x32_bf16 v[32:35], v[80:83], v[108:111], v[32:35]
    ds_read_b64_tr_b16 v[92:93], v5 offset:6272
    ds_read_b64_tr_b16 v[94:95], v5 offset:7040
    s_waitcnt lgkmcnt(8)
    v_mfma_f32_16x16x32_bf16 v[44:47], v[80:83], v[112:115], v[44:47]
    ds_read_b128 v[124:127], v1 offset:64
    ds_read_b128 v[128:131], v1 offset:3904
    v_mfma_f32_16x16x32_bf16 v[40:43], v[76:79], v[112:115], v[40:43]
    ds_read_b128 v[132:135], v1 offset:7744
    ds_read_b128 v[136:139], v1 offset:11584
    v_mfma_f32_16x16x32_bf16 v[36:39], v[72:75], v[112:115], v[36:39]
    ds_read_b128 v[140:143], v1 offset:128
    ds_read_b128 v[144:147], v1 offset:3968
    s_waitcnt lgkmcnt(13)
    v_mfma_f32_16x16x32_bf16 v[48:51], v[72:75], v[116:119], v[48:51]
    ds_read_b128 v[148:151], v1 offset:7808
    ds_read_b128 v[152:155], v1 offset:11648
    v_mfma_f32_16x16x32_bf16 v[52:55], v[76:79], v[116:119], v[52:55]
    ds_read_b64_tr_b16 v[96:97], v5 offset:12416
    ds_read_b64_tr_b16 v[98:99], v5 offset:13184
    v_mfma_f32_16x16x32_bf16 v[56:59], v[80:83], v[116:119], v[56:59]
    ds_read_b64_tr_b16 v[100:101], v5 offset:12448
    ds_read_b64_tr_b16 v[102:103], v5 offset:13216
    s_waitcnt lgkmcnt(15)
    v_mfma_f32_16x16x32_bf16 v[68:71], v[80:83], v[120:123], v[68:71]
    ds_read_b64_tr_b16 v[104:105], v5 offset:12480
    ds_read_b64_tr_b16 v[106:107], v5 offset:13248
    v_mfma_f32_16x16x32_bf16 v[64:67], v[76:79], v[120:123], v[64:67]
    v_mfma_f32_16x16x32_bf16 v[60:63], v[72:75], v[120:123], v[60:63]
    s_add_u32 s35, s35, 1
    v_add_u32 v17, 3840, v1
    s_and_b32 s36, s35, 3
    v_mov_b32 v1, v2
    s_mul_i32 s36, s36, 18624
    v_mov_b32 v2, v3
    v_mov_b32 v3, v17
    v_add_u32 v5, s36, v4
    s_branch L_end4
L_nf3:
    s_cmp_eq_u32 s30, 3
    s_cbranch_scc0 L_nf2
    s_waitcnt lgkmcnt(7)
    v_mfma_f32_16x16x32_bf16 v[24:27], v[72:75], v[108:111], v[24:27]
    ds_read_b64_tr_b16 v[84:85], v5 offset:6208
    ds_read_b64_tr_b16 v[86:87], v5 offset:6976
    s_waitcnt lgkmcnt(7)
    v_mfma_f32_16x16x32_bf16 v[28:31], v[76:79], v[108:111], v[28:31]
    ds_read_b64_tr_b16 v[88:89], v5 offset:6240
    ds_read_b64_tr_b16 v[90:91], v5 offset:7008
    s_waitcnt lgkmcnt(7)
    v_mfma_f32_16x16x32_bf16 v[32:35], v[80:83], v[108:111], v[32:35]
    ds_read_b64_tr_b16 v[92:93], v5 offset:6272
    ds_read_b64_tr_b16 v[94:95], v5 offset:7040
    s_waitcnt lgkmcnt(8)
    v_mfma_f32_16x16x32_bf16 v[44:47], v[80:83], v[112:115], v[44:47]
    ds_read_b128 v[124:127], v1 offset:64
    ds_read_b128 v[128:131], v1 offset:3904
    v_mfma_f32_16x16x32_bf16 v[40:43], v[76:79], v[112:115], v[40:43]
    ds_read_b128 v[132:135], v1 offset:7744
    ds_read_b128 v[140:143], v1 offset:128
    v_mfma_f32_16x16x32_bf16 v[36:39], v[72:75], v[112:115], v[36:39]
    ds_read_b128 v[144:147], v1 offset:3968
    ds_read_b128 v[148:151], v1 offset:7808
    s_waitcnt lgkmcnt(13)
    v_mfma_f32_16x16x32_bf16 v[48:51], v[72:75], v[116:119], v[48:51]
    ds_read_b64_tr_b16 v[96:97], v5 offset:12416
    ds_read_b64_tr_b16 v[98:99], v5 offset:13184
    v_mfma_f32_16x16x32_bf16 v[52:55], v[76:79], v[116:119], v[52:55]
    ds_read_b64_tr_b16 v[100:101], v5 offset:12448
    ds_read_b64_tr_b16 v[102:103], v5 offset:13216
    v_mfma_f32_16x16x32_bf16 v[56:59], v[80:83], v[116:119], v[56:59]
    ds_read_b64_tr_b16 v[104:105], v5 offset:12480
    ds_read_b64_tr_b16 v[106:107], v5 offset:13248
    s_add_u32 s35, s35, 1
    v_add_u32 v17, 3840, v1
    s_and_b32 s36, s35, 3
    v_mov_b32 v1, v2
    s_mul_i32 s36, s36, 18624
    v_mov_b32 v2, v3
    v_mov_b32 v3, v17
    v_add_u32 v5, s36, v4
    s_branch L_end3
.p2align 3
L_top4:
    s_barrier
L_body4:
    s_setprio 2
.p2align 3
    v_mfma_f32_16x16x32_bf16 v[24:27], v[84:87], v[124:127], v[24:27]
    ds_read_b128 v[108:111], v1 offset:0
    v_mfma_f32_16x16x32_bf16 v[28:31], v[88:91], v[124:127], v[28:31]
    ds_read_b64_tr_b16 v[72:73], v5 offset:0
    v_mfma_f32_16x16x32_bf16 v[32:35], v[92:95], v[124:127], v[32:35]
    ds_read_b64_tr_b16 v[74:75], v5 offset:768
    v_mfma_f32_16x16x32_bf16 v[44:47], v[92:95], v[128:131], v[44:47]
    ds_read_b64_tr_b16 v[76:77], v5 offset:32
    v_mfma_f32_16x16x32_bf16 v[40:43], v[88:91], v[128:131], v[40:43]
    ds_read_b64_tr_b16 v[78:79], v5 offset:800
    v_mfma_f32_16x16x32_bf16 v[36:39], v[84:87], v[128:131], v[36:39]
    ds_read_b64_tr_b16 v[80:81], v5 offset:64
    v_mfma_f32_16x16x32_bf16 v[48:51], v[84:87], v[132:135], v[48:51]
    ds_read_b64_tr_b16 v[82:83], v5 offset:832
    v_mfma_f32_16x16x32_bf16 v[52:55], v[88:91], v[132:135], v[52:55]
    ds_read_b128 v[112:115], v1 offset:3840
    v_mfma_f32_16x16x32_bf16 v[56:59], v[92:95], v[132:135], v[56:59]
    ds_read_b128 v[116:119], v1 offset:7680
    v_mfma_f32_16x16x32_bf16 v[68:71], v[92:95], v[136:139], v[68:71]
    ds_read_b128 v[120:123], v1 offset:11520
    v_mfma_f32_16x16x32_bf16 v[64:67], v[88:91], v[136:139], v[64:67]
    v_mfma_f32_16x16x32_bf16 v[60:63], v[84:87], v[136:139], v[60:63]
    s_setprio 1
.p2align 3
    v_mfma_f32_16x16x32_bf16 v[24:27], v[96:99], v[140:143], v[24:27]
    ds_read_b64_tr_b16 v[84:85], v5 offset:6208
    v_mfma_f32_16x16x32_bf16 v[28:31], v[100:103], v[140:143], v[28:31]
    ds_read_b64_tr_b16 v[86:87], v5 offset:6976
    v_mfma_f32_16x16x32_bf16 v[32:35], v[104:107], v[140:143], v[32:35]
    ds_read_b64_tr_b16 v[88:89], v5 offset:6240
    v_mfma_f32_16x16x32_bf16 v[44:47], v[104:107], v[144:147], v[44:47]
    ds_read_b128 v[140:143], v1 offset:128
    v_mfma_f32_16x16x32_bf16 v[40:43], v[100:103], v[144:147], v[40:43]
    ds_read_b64_tr_b16 v[90:91], v5 offset:7008
    v_mfma_f32_16x16x32_bf16 v[36:39], v[96:99], v[144:147], v[36:39]
    ds_read_b64_tr_b16 v[92:93], v5 offset:6272
    v_mfma_f32_16x16x32_bf16 v[48:51], v[96:99], v[148:151], v[48:51]
    ds_read_b128 v[144:147], v1 offset:3968
    v_mfma_f32_16x16x32_bf16 v[52:55], v[100:103], v[148:151], v[52:55]
    ds_read_b64_tr_b16 v[94:95], v5 offset:7040
    v_mfma_f32_16x16x32_bf16 v[56:59], v[104:107], v[148:151], v[56:59]
    ds_read_b128 v[124:127], v1 offset:64
    v_mfma_f32_16x16x32_bf16 v[68:71], v[104:107], v[152:155], v[68:71]
    ds_read_b128 v[148:151], v1 offset:7808
    ds_read_b128 v[128:131], v1 offset:3904
    v_mfma_f32_16x16x32_bf16 v[64:67], v[100:103], v[152:155], v[64:67]
    ds_read_b128 v[132:135], v1 offset:7744
    v_mfma_f32_16x16x32_bf16 v[60:63], v[96:99], v[152:155], v[60:63]
    ds_read_b128 v[136:139], v1 offset:11584
    ds_read_b128 v[152:155], v1 offset:11648
L_mid4:
    s_waitcnt lgkmcnt(14)
    s_setprio 0
.p2align 3
    v_mfma_f32_16x16x32_bf16 v[24:27], v[72:75], v[108:111], v[24:27]
    ds_read_b64_tr_b16 v[96:97], v5 offset:12416
    v_mfma_f32_16x16x32_bf16 v[28:31], v[76:79], v[108:111], v[28:31]
    ds_read_b64_tr_b16 v[98:99], v5 offset:13184
    v_mfma_f32_16x16x32_bf16 v[32:35], v[80:83], v[108:111], v[32:35]
    ds_read_b64_tr_b16 v[100:101], v5 offset:12448
    v_mfma_f32_16x16x32_bf16 v[44:47], v[80:83], v[112:115], v[44:47]
    ds_read_b64_tr_b16 v[102:103], v5 offset:13216
    v_mfma_f32_16x16x32_bf16 v[40:43], v[76:79], v[112:115], v[40:43]
    ds_read_b64_tr_b16 v[104:105], v5 offset:12480
    v_mfma_f32_16x16x32_bf16 v[36:39], v[72:75], v[112:115], v[36:39]
    ds_read_b64_tr_b16 v[106:107], v5 offset:13248
    v_mfma_f32_16x16x32_bf16 v[48:51], v[72:75], v[116:119], v[48:51]
    s_add_u32 s35, s35, 1
    v_add_u32 v17, 3840, v1
    v_mfma_f32_16x16x32_bf16 v[52:55], v[76:79], v[116:119], v[52:55]
    s_and_b32 s36, s35, 3
    v_mov_b32 v1, v2
    v_mfma_f32_16x16x32_bf16 v[56:59], v[80:83], v[116:119], v[56:59]
    s_mul_i32 s36, s36, 18624
    v_mov_b32 v2, v3
    v_mfma_f32_16x16x32_bf16 v[68:71], v[80:83], v[120:123], v[68:71]
    v_mov_b32 v3, v17
    v_add_u32 v5, s36, v4
    v_mfma_f32_16x16x32_bf16 v[64:67], v[76:79], v[120:123], v[64:67]
    v_mfma_f32_16x16x32_bf16 v[60:63], v[72:75], v[120:123], v[60:63]
L_end4:
    s_bitcmp1_b32 s3, s35
    s_waitcnt vmcnt(0) lgkmcnt(0)
    s_cbranch_scc0 L_top4
    s_bitcmp1_b32 s99, s35
    s_cbranch_scc1 L_sp4
    s_barrier
    s_bitcmp1_b32 s39, s35
    s_cbranch_scc0 L_sp4
    s_call_b64 s[76:77], L_dma
L_sp4:
    s_bitcmp1_b32 s37, s35
    s_cbranch_scc1 L_g4
    s_cmp_lg_u32 s35, 9
    s_cbranch_scc1 L_body4
L_last4:
    s_setprio 3
    v_mfma_f32_16x16x32_bf16 v[24:27], v[84:87], v[124:127], v[24:27]
    s_add_u32 s96, s0, s29
    s_mul_i32 s96, s96, 224
    s_add_u32 s96, s96, s32
    v_mfma_f32_16x16x32_bf16 v[28:31], v[88:91], v[124:127], v[28:31]
    s_mul_i32 s96, s96, 192
    s_add_u32 s97, s96, 86016
    s_add_u32 s98, s29, 2
    v_mfma_f32_16x16x32_bf16 v[32:35], v[92:95], v[124:127], v[32:35]
    v_mfma_f32_16x16x32_bf16 v[24:27], v[96:99], v[140:143], v[24:27]
    v_mfma_f32_16x16x32_bf16 v[28:31], v[100:103], v[140:143], v[28:31]
    v_mfma_f32_16x16x32_bf16 v[32:35], v[104:107], v[140:143], v[32:35]
    v_mfma_f32_16x16x32_bf16 v[36:39], v[84:87], v[128:131], v[36:39]
    v_mfma_f32_16x16x32_bf16 v[40:43], v[88:91], v[128:131], v[40:43]
    v_mfma_f32_16x16x32_bf16 v[44:47], v[92:95], v[128:131], v[44:47]
    s_nop 2
    v_cvt_pk_bf16_f32 v156, v24, v25
    v_cvt_pk_bf16_f32 v157, v26, v27
    ds_write_b64 v21, v[156:157] offset:0
    v_mfma_f32_16x16x32_bf16 v[36:39], v[96:99], v[144:147], v[36:39]
    v_cvt_pk_bf16_f32 v158, v28, v29
    v_cvt_pk_bf16_f32 v159, v30, v31
    ds_write_b64 v21, v[158:159] offset:32
    v_mfma_f32_16x16x32_bf16 v[40:43], v[100:103], v[144:147], v[40:43]
    v_cvt_pk_bf16_f32 v160, v32, v33
    v_cvt_pk_bf16_f32 v161, v34, v35
    ds_write_b64 v21, v[160:161] offset:64
    v_mfma_f32_16x16x32_bf16 v[44:47], v[104:107], v[144:147], v[44:47]
    v_mfma_f32_16x16x32_bf16 v[48:51], v[84:87], v[132:135], v[48:51]
    v_mfma_f32_16x16x32_bf16 v[52:55], v[88:91], v[132:135], v[52:55]
    v_mfma_f32_16x16x32_bf16 v[56:59], v[92:95], v[132:135], v[56:59]
    v_cvt_pk_bf16_f32 v162, v36, v37
    v_cvt_pk_bf16_f32 v163, v38, v39
    ds_write_b64 v21, v[162:163] offset:3840
    v_mfma_f32_16x16x32_bf16 v[48:51], v[96:99], v[148:151], v[48:51]
    v_cvt_pk_bf16_f32 v164, v40, v41
    v_cvt_pk_bf16_f32 v165, v42, v43
    ds_write_b64 v21, v[164:165] offset:3872
    v_mfma_f32_16x16x32_bf16 v[52:55], v[100:103], v[148:151], v[52:55]
    v_cvt_pk_bf16_f32 v166, v44, v45
    v_cvt_pk_bf16_f32 v167, v46, v47
    ds_write_b64 v21, v[166:167] offset:3904
    v_mfma_f32_16x16x32_bf16 v[56:59], v[104:107], v[148:151], v[56:59]
    v_mov_b32 v17, 1
    ds_write_b32 v254, v17
    v_mfma_f32_16x16x32_bf16 v[60:63], v[84:87], v[136:139], v[60:63]
    v_mfma_f32_16x16x32_bf16 v[64:67], v[88:91], v[136:139], v[64:67]
    v_mfma_f32_16x16x32_bf16 v[68:71], v[92:95], v[136:139], v[68:71]
    v_cvt_pk_bf16_f32 v168, v48, v49
    v_cvt_pk_bf16_f32 v169, v50, v51
    ds_write_b64 v21, v[168:169] offset:7680
    v_mfma_f32_16x16x32_bf16 v[60:63], v[96:99], v[152:155], v[60:63]
    v_cvt_pk_bf16_f32 v170, v52, v53
    v_cvt_pk_bf16_f32 v171, v54, v55
    ds_write_b64 v21, v[170:171] offset:7712
    v_mfma_f32_16x16x32_bf16 v[64:67], v[100:103], v[152:155], v[64:67]
    v_cvt_pk_bf16_f32 v172, v56, v57
    v_cvt_pk_bf16_f32 v173, v58, v59
    ds_write_b64 v21, v[172:173] offset:7744
    v_mfma_f32_16x16x32_bf16 v[68:71], v[104:107], v[152:155], v[68:71]
    v_cvt_pk_bf16_f32 v174, v60, v61
    v_cvt_pk_bf16_f32 v175, v62, v63
    ds_write_b64 v21, v[174:175] offset:11520
    s_nop 0
    v_cvt_pk_bf16_f32 v176, v64, v65
    v_cvt_pk_bf16_f32 v177, v66, v67
    ds_write_b64 v21, v[176:177] offset:11552
    s_nop 0
    v_cvt_pk_bf16_f32 v178, v68, v69
    v_cvt_pk_bf16_f32 v179, v70, v71
    ds_write_b64 v21, v[178:179] offset:11584
    s_branch L_epi
.p2align 3
L_top3:
    s_barrier
L_body3:
    s_setprio 2
.p2align 3
    v_mfma_f32_16x16x32_bf16 v[24:27], v[84:87], v[124:127], v[24:27]
    ds_read_b128 v[108:111], v1 offset:0
    v_mfma_f32_16x16x32_bf16 v[28:31], v[88:91], v[124:127], v[28:31]
    ds_read_b64_tr_b16 v[72:73], v5 offset:0
    v_mfma_f32_16x16x32_bf16 v[32:35], v[92:95], v[124:127], v[32:35]
    ds_read_b64_tr_b16 v[74:75], v5 offset:768
    v_mfma_f32_16x16x32_bf16 v[44:47], v[92:95], v[128:131], v[44:47]
    ds_read_b64_tr_b16 v[76:77], v5 offset:32
    v_mfma_f32_16x16x32_bf16 v[40:43], v[88:91], v[128:131], v[40:43]
    ds_read_b64_tr_b16 v[78:79], v5 offset:800
    v_mfma_f32_16x16x32_bf16 v[36:39], v[84:87], v[128:131], v[36:39]
    ds_read_b64_tr_b16 v[80:81], v5 offset:64
    v_mfma_f32_16x16x32_bf16 v[48:51], v[84:87], v[132:135], v[48:51]
    ds_read_b64_tr_b16 v[82:83], v5 offset:832
    v_mfma_f32_16x16x32_bf16 v[52:55], v[88:91], v[132:135], v[52:55]
    ds_read_b128 v[112:115], v1 offset:3840
    v_mfma_f32_16x16x32_bf16 v[56:59], v[92:95], v[132:135], v[56:59]
    ds_read_b128 v[116:119], v1 offset:7680
    s_setprio 1
.p2align 3
    v_mfma_f32_16x16x32_bf16 v[24:27], v[96:99], v[140:143], v[24:27]
    ds_read_b64_tr_b16 v[84:85], v5 offset:6208
    v_mfma_f32_16x16x32_bf16 v[28:31], v[100:103], v[140:143], v[28:31]
    ds_read_b64_tr_b16 v[86:87], v5 offset:6976
    v_mfma_f32_16x16x32_bf16 v[32:35], v[104:107], v[140:143], v[32:35]
    ds_read_b64_tr_b16 v[88:89], v5 offset:6240
    v_mfma_f32_16x16x32_bf16 v[44:47], v[104:107], v[144:147], v[44:47]
    ds_read_b128 v[140:143], v1 offset:128
    ds_read_b64_tr_b16 v[90:91], v5 offset:7008
    v_mfma_f32_16x16x32_bf16 v[40:43], v[100:103], v[144:147], v[40:43]
    ds_read_b64_tr_b16 v[92:93], v5 offset:6272
    v_mfma_f32_16x16x32_bf16 v[36:39], v[96:99], v[144:147], v[36:39]
    ds_read_b64_tr_b16 v[94:95], v5 offset:7040
    v_mfma_f32_16x16x32_bf16 v[48:51], v[96:99], v[148:151], v[48:51]
    ds_read_b128 v[144:147], v1 offset:3968
    ds_read_b128 v[124:127], v1 offset:64
    v_mfma_f32_16x16x32_bf16 v[52:55], v[100:103], v[148:151], v[52:55]
    ds_read_b128 v[128:131], v1 offset:3904
    v_mfma_f32_16x16x32_bf16 v[56:59], v[104:107], v[148:151], v[56:59]
    ds_read_b128 v[132:135], v1 offset:7744
    ds_read_b128 v[148:151], v1 offset:7808
L_mid3:
    s_waitcnt lgkmcnt(12)
    s_setprio 0
.p2align 3
    v_mfma_f32_16x16x32_bf16 v[24:27], v[72:75], v[108:111], v[24:27]
    ds_read_b64_tr_b16 v[96:97], v5 offset:12416
    v_mfma_f32_16x16x32_bf16 v[28:31], v[76:79], v[108:111], v[28:31]
    ds_read_b64_tr_b16 v[98:99], v5 offset:13184
    v_mfma_f32_16x16x32_bf16 v[32:35], v[80:83], v[108:111], v[32:35]
    ds_read_b64_tr_b16 v[100:101], v5 offset:12448
    v_mfma_f32_16x16x32_bf16 v[44:47], v[80:83], v[112:115], v[44:47]
    ds_read_b64_tr_b16 v[102:103], v5 offset:13216
    v_mfma_f32_16x16x32_bf16 v[40:43], v[76:79], v[112:115], v[40:43]
    ds_read_b64_tr_b16 v[104:105], v5 offset:12480
    v_mfma_f32_16x16x32_bf16 v[36:39], v[72:75], v[112:115], v[36:39]
    ds_read_b64_tr_b16 v[106:107], v5 offset:13248
    v_mfma_f32_16x16x32_bf16 v[48:51], v[72:75], v[116:119], v[48:51]
    s_add_u32 s35, s35, 1
    v_add_u32 v17, 3840, v1
    v_mfma_f32_16x16x32_bf16 v[52:55], v[76:79], v[116:119], v[52:55]
    s_and_b32 s36, s35, 3
    v_mov_b32 v1, v2
    v_mfma_f32_16x16x32_bf16 v[56:59], v[80:83], v[116:119], v[56:59]
    s_mul_i32 s36, s36, 18624
    v_mov_b32 v2, v3
    v_mov_b32 v3, v17
    v_add_u32 v5, s36, v4
L_end3:
    s_bitcmp1_b32 s3, s35
    s_waitcnt vmcnt(0) lgkmcnt(0)
    s_cbranch_scc0 L_top3
    s_bitcmp1_b32 s99, s35
    s_cbranch_scc1 L_sp3
    s_barrier
    s_bitcmp1_b32 s39, s35
    s_cbranch_scc0 L_sp3
    s_call_b64 s[76:77], L_dma
L_sp3:
    s_bitcmp1_b32 s37, s35
    s_cbranch_scc1 L_g3
    s_cmp_lg_u32 s35, 9
    s_cbranch_scc1 L_body3
L_last3:
    s_setprio 3
    v_mfma_f32_16x16x32_bf16 v[24:27], v[84:87], v[124:127], v[24:27]
    s_add_u32 s96, s0, s29
    s_mul_i32 s96, s96, 224
    s_add_u32 s96, s96, s32
    v_mfma_f32_16x16x32_bf16 v[28:31], v[88:91], v[124:127], v[28:31]
    s_mul_i32 s96, s96, 192
    s_add_u32 s97, s96, 86016
    s_add_u32 s98, s29, 2
    v_mfma_f32_16x16x32_bf16 v[32:35], v[92:95], v[124:127], v[32:35]
    v_mfma_f32_16x16x32_bf16 v[24:27], v[96:99], v[140:143], v[24:27]
    v_mfma_f32_16x16x32_bf16 v[28:31], v[100:103], v[140:143], v[28:31]
    v_mfma_f32_16x16x32_bf16 v[32:35], v[104:107], v[140:143], v[32:35]
    v_mfma_f32_16x16x32_bf16 v[36:39], v[84:87], v[128:131], v[36:39]
    v_mfma_f32_16x16x32_bf16 v[40:43], v[88:91], v[128:131], v[40:43]
    v_mfma_f32_16x16x32_bf16 v[44:47], v[92:95], v[128:131], v[44:47]
    s_nop 2
    v_cvt_pk_bf16_f32 v156, v24, v25
    v_cvt_pk_bf16_f32 v157, v26, v27
    ds_write_b64 v21, v[156:157] offset:0
    v_mfma_f32_16x16x32_bf16 v[36:39], v[96:99], v[144:147], v[36:39]
    v_cvt_pk_bf16_f32 v158, v28, v29
    v_cvt_pk_bf16_f32 v159, v30, v31
    ds_write_b64 v21, v[158:159] offset:32
    v_mfma_f32_16x16x32_bf16 v[40:43], v[100:103], v[144:147], v[40:43]
    v_cvt_pk_bf16_f32 v160, v32, v33
    v_cvt_pk_bf16_f32 v161, v34, v35
    ds_write_b64 v21, v[160:161] offset:64
    v_mfma_f32_16x16x32_bf16 v[44:47], v[104:107], v[144:147], v[44:47]
    v_mfma_f32_16x16x32_bf16 v[48:51], v[84:87], v[132:135], v[48:51]
    v_mfma_f32_16x16x32_bf16 v[52:55], v[88:91], v[132:135], v[52:55]
    v_mfma_f32_16x16x32_bf16 v[56:59], v[92:95], v[132:135], v[56:59]
    v_cvt_pk_bf16_f32 v162, v36, v37
    v_cvt_pk_bf16_f32 v163, v38, v39
    ds_write_b64 v21, v[162:163] offset:3840
    v_mfma_f32_16x16x32_bf16 v[48:51], v[96:99], v[148:151], v[48:51]
    v_cvt_pk_bf16_f32 v164, v40, v41
    v_cvt_pk_bf16_f32 v165, v42, v43
    ds_write_b64 v21, v[164:165] offset:3872
    v_mfma_f32_16x16x32_bf16 v[52:55], v[100:103], v[148:151], v[52:55]
    v_cvt_pk_bf16_f32 v166, v44, v45
    v_cvt_pk_bf16_f32 v167, v46, v47
    ds_write_b64 v21, v[166:167] offset:3904
    v_mfma_f32_16x16x32_bf16 v[56:59], v[104:107], v[148:151], v[56:59]
    v_mov_b32 v17, 1
    ds_write_b32 v254, v17
    v_cvt_pk_bf16_f32 v168, v48, v49
    v_cvt_pk_bf16_f32 v169, v50, v51
    ds_write_b64 v21, v[168:169] offset:7680
    v_cvt_pk_bf16_f32 v170, v52, v53
    v_cvt_pk_bf16_f32 v171, v54, v55
    ds_write_b64 v21, v[170:171] offset:7712
    v_cvt_pk_bf16_f32 v172, v56, v57
    v_cvt_pk_bf16_f32 v173, v58, v59
    ds_write_b64 v21, v[172:173] offset:7744
L_epi:
    v_mov_b32 v17, 2
    ds_write_b32 v254, v17
    s_setprio 0
    s_cmp_ge_u32 s29, s30
    s_cbranch_scc1 L_fin
L_t1:
    ds_read_b32 v236, v255
    ds_read_b128 v[180:183], v248 offset:0
    ds_read_b128 v[184:187], v249 offset:0
    ds_read_b128 v[188:191], v250 offset:0
    s_waitcnt lgkmcnt(3)
    v_cmp_eq_u32 vcc, 0, v236
    s_cbranch_vccnz L_t1
    s_cmp_ge_u32 s98, s30
    s_cbranch_scc1 L_t3
    ds_read_b32 v237, v255
    ds_read_b128 v[192:195], v248 offset:7680
    ds_read_b128 v[196:199], v249 offset:7680
    ds_read_b128 v[200:203], v250 offset:7680
    s_waitcnt lgkmcnt(6)
    buffer_store_dwordx4 v[180:183], v16, s[16:19], s96 offen offset:0 sc1
    s_waitcnt lgkmcnt(5)
    buffer_store_dwordx4 v[184:187], v16, s[16:19], s96 offen offset:1024 sc1
    s_waitcnt lgkmcnt(4)
    buffer_store_dwordx4 v[188:191], v16, s[16:19], s96 offen offset:2048 sc1
L_t2:
    s_waitcnt lgkmcnt(3)
    v_cmp_ne_u32 vcc, 2, v237
    s_cbranch_vccnz L_t4
    s_waitcnt lgkmcnt(2)
    buffer_store_dwordx4 v[192:195], v16, s[16:19], s97 offen offset:0 sc1
    s_waitcnt lgkmcnt(1)
    buffer_store_dwordx4 v[196:199], v16, s[16:19], s97 offen offset:1024 sc1
    s_waitcnt lgkmcnt(0)
    buffer_store_dwordx4 v[200:203], v16, s[16:19], s97 offen offset:2048 sc1
    s_branch L_fin
L_t4:
    ds_read_b32 v237, v255
    ds_read_b128 v[192:195], v248 offset:7680
    ds_read_b128 v[196:199], v249 offset:7680
    ds_read_b128 v[200:203], v250 offset:7680
    s_branch L_t2
L_t3:
    s_waitcnt lgkmcnt(2)
    buffer_store_dwordx4 v[180:183], v16, s[16:19], s96 offen offset:0 sc1
    s_waitcnt lgkmcnt(1)
    buffer_store_dwordx4 v[184:187], v16, s[16:19], s96 offen offset:1024 sc1
    s_waitcnt lgkmcnt(0)
    buffer_store_dwordx4 v[188:191], v16, s[16:19], s96 offen offset:2048 sc1
L_fin:
L_end:
    s_endpgm
L_dma:
    s_add_u32 s98, s35, 3
    s_and_b32 s98, s98, 3
    s_mul_i32 s98, s98, 18624
L_dma2:
    s_add_u32 s97, s88, s98
    s_add_u32 m0, s97, 0
    s_add_u32 s96, s95, 0
    buffer_load_dwordx4 v19, s[12:15], s96 offen lds
    s_add_u32 s97, s89, s98
    s_add_u32 m0, s97, 4128
    s_add_u32 s96, s95, 4096
    buffer_load_dwordx4 v19, s[12:15], s96 offen lds
    s_add_u32 s97, s90, s98
    s_add_u32 m0, s97, 8256
    s_add_u32 s96, s95, 8192
    buffer_load_dwordx4 v19, s[12:15], s96 offen lds
    s_add_u32 s97, s88, s98
    s_add_u32 m0, s97, 12416
    s_add_u32 s96, s95, 12288
    buffer_load_dwordx4 v19, s[12:15], s96 offen lds
    s_bitcmp1_b32 s28, 1
    s_cbranch_scc1 L_nd2
    s_add_u32 s97, s89, s98
    s_add_u32 m0, s97, 16544
    s_add_u32 s96, s95, 16384
    buffer_load_dwordx4 v19, s[12:15], s96 offen lds
L_nd2:
    s_add_u32 s95, s95, 18432
    s_cmp_eq_u32 s35, 1
    s_cbranch_scc0 L_nd3
    s_bitcmp1_b32 s23, 19
    s_cbranch_scc1 L_nd3
    s_cmp_lt_u32 s23, 268435456
    s_cbranch_scc1 L_nd3
    s_min_i32 s96, s20, s21
    s_add_u32 m0, s94, 57600
    s_mov_b64 exec, s[92:93]
    s_add_u32 s20, s20, 43008
    buffer_load_dwordx4 v20, s[4:7], s96 offen lds
    s_mov_b64 exec, -1
    s_cmp_lt_u32 s23, 285212672
    s_cbranch_scc1 L_nd3
    s_min_i32 s96, s20, s21
    s_add_u32 m0, s94, 61440
    s_mov_b64 exec, s[92:93]
    s_add_u32 s20, s20, 43008
    buffer_load_dwordx4 v20, s[4:7], s96 offen lds
    s_mov_b64 exec, -1
L_nd3:
    s_setpc_b64 s[76:77]
.p2align 3
L_top0:
    s_barrier
L_body0:
L_mid0:
    s_add_u32 s35, s35, 1
    s_and_b32 s36, s35, 3
    s_mul_i32 s36, s36, 18624
L_end0:
    s_bitcmp1_b32 s3, s35
    s_waitcnt vmcnt(0) lgkmcnt(0)
    s_cbranch_scc0 L_top0
    s_bitcmp1_b32 s99, s35
    s_cbranch_scc1 L_sp0
    s_barrier
    s_bitcmp1_b32 s39, s35
    s_cbranch_scc0 L_sp0
    s_call_b64 s[76:77], L_dma
L_sp0:
    s_cmp_lg_u32 s35, 9
    s_cbranch_scc1 L_body0
L_last0:
    s_setprio 3
    s_add_u32 s96, s0, s29
    s_mul_i32 s96, s96, 224
    s_add_u32 s96, s96, s32
    s_mul_i32 s96, s96, 192
    s_add_u32 s97, s96, 86016
    s_add_u32 s98, s29, 2
    s_branch L_epi
L_nf2:
    ds_read_b64_tr_b16 v[84:85], v5 offset:6208
    ds_read_b64_tr_b16 v[86:87], v5 offset:6976
    ds_read_b64_tr_b16 v[88:89], v5 offset:6240
    ds_read_b64_tr_b16 v[90:91], v5 offset:7008
    ds_read_b64_tr_b16 v[92:93], v5 offset:6272
    ds_read_b64_tr_b16 v[94:95], v5 offset:7040
    ds_read_b128 v[124:127], v1 offset:64
    ds_read_b128 v[128:131], v1 offset:3904
    ds_read_b128 v[132:135], v1 offset:7744
    ds_read_b128 v[136:139], v1 offset:11584
    ds_read_b128 v[140:143], v1 offset:128
    ds_read_b128 v[144:147], v1 offset:3968
    ds_read_b128 v[148:151], v1 offset:7808
    ds_read_b128 v[152:155], v1 offset:11648
L_fdisp:
    s_cmp_eq_u32 s30, 3
    s_cbranch_scc1 L_mid3
    s_cmp_eq_u32 s30, 2
    s_cbranch_scc1 L_mid2
    s_cmp_eq_u32 s30, 1
    s_cbranch_scc1 L_mid1
    s_cmp_eq_u32 s30, 0
    s_cbranch_scc1 L_mid0
    s_branch L_mid4
.p2align 12
L_startAH:
    s_waitcnt lgkmcnt(0)
    s_bfe_u32 s75, s23, 0x1001e
    s_bitset0_b32 s23, 30
    s_lshr_b32 s96, s22, s30
    s_and_b32 s32, s23, 0xff
    s_and_b32 s31, s96, 15
    s_bfe_u32 s30, s96, 0x30004
    s_bfe_u32 s33, s23, 0x80008
    s_add_u32 s0, s33, s31
    s_mul_i32 s3, s0, 224
    s_add_u32 s3, s3, s32
    s_mul_i32 s3, s3, 36
    s_mov_b32 s74, s0
    s_lshr_b32 s73, s28, 1
    s_lshl_b32 s96, s29, 1
    s_add_u32 s73, s73, s96
    s_lshl_b32 s96, s73, 3
    s_lshr_b32 s96, s22, s96
    s_and_b32 s74, s96, 15
    s_bfe_u32 s98, s96, 0x30004
    s_add_u32 s74, s74, s33
    s_mul_i32 s3, s74, 224
    s_add_u32 s3, s3, s32
    s_mul_i32 s3, s3, 36
    s_cmp_gt_u32 s98, 0
    s_cselect_b32 s96, s3, 2130706432
    s_addk_i32 s3, 8064
    buffer_load_dwordx3 v[204:206], v228, s[8:11], s96 offen
    s_cmp_gt_u32 s98, 1
    s_cselect_b32 s96, s3, 2130706432
    s_addk_i32 s3, 8064
    buffer_load_dwordx3 v[208:210], v228, s[8:11], s96 offen
    s_cmp_gt_u32 s98, 2
    s_cselect_b32 s96, s3, 2130706432
    s_addk_i32 s3, 8064
    buffer_load_dwordx3 v[212:214], v228, s[8:11], s96 offen
    s_cmp_gt_u32 s98, 3
    s_cselect_b32 s96, s3, 2130706432
    s_addk_i32 s3, 8064
    buffer_load_dwordx3 v[216:218], v228, s[8:11], s96 offen
    s_lshr_b32 s96, s2, 3
    s_and_b32 s96, s96, 31
    s_lshl_b32 s96, s96, 2
    s_add_u32 s96, s96, s28
    s_mul_i32 s96, s96, 1152
    s_add_u32 s96, s96, 18432
    v_lshlrev_b32 v23, 3, v16
    s_mov_b64 exec, 0x1ff
    buffer_load_dword v23, v23, s[12:15], s96 offen
    s_mov_b64 exec, -1
    s_mov_b32 s35, 0
    s_mov_b32 s37, 0
    s_mov_b32 s38, 0
    v_mov_b32 v108, 0
    v_mov_b32 v109, 0
    v_mov_b32 v110, 0
    v_mov_b32 v111, 0
    s_cmp_lt_u32 s28, 4
    s_cselect_b32 s39, 0, 0x3e
    s_cselect_b32 s99, 0, 768
    s_mov_b32 s95, 73728
    s_lshl_b32 s96, s28, 2
    s_add_u32 s96, s96, 163776
    v_mov_b32 v254, s96
    v_mfma_f32_32x32x16_bf16 v[24:39], v[108:111], v[108:111], 0
    v_mfma_f32_32x32x16_bf16 v[40:55], v[108:111], v[108:111], 0
    v_mfma_f32_32x32x16_bf16 v[56:71], v[108:111], v[108:111], 0
    v_xor_b32 v255, 4, v254
    ds_write_b32 v254, v108
    s_sub_u32 s34, s32, 2
    s_bfe_u32 s100, s23, 0x10011
    s_lshl_b32 s101, s100, 1
    s_sub_u32 s101, 19, s101
    s_bfe_u32 s96, s23, 0x10010
    s_sub_u32 s33, s33, s96
    s_sub_u32 s33, s33, 1
    s_cmp_eq_u32 s29, 0
    s_cselect_b32 s26, s26, s27
    s_waitcnt vmcnt(5)
    s_sub_u32 s96, s0, s33
    s_mul_i32 s97, s29, 96
    s_sub_u32 s96, s96, 1
    s_add_u32 s98, s97, 89280
    s_mul_i32 s96, s96, 3840
    v_add_u32_sdwa v4, s98, v240 dst_sel:DWORD dst_unused:UNUSED_PAD src0_sel:DWORD src1_sel:WORD_0
    v_add_u32_sdwa v5, s98, v240 dst_sel:DWORD dst_unused:UNUSED_PAD src0_sel:DWORD src1_sel:WORD_0
    s_bfe_u32 s98, s23, 0x40014
    v_add_u32_sdwa v1, s96, v240 dst_sel:DWORD dst_unused:UNUSED_PAD src0_sel:DWORD src1_sel:WORD_1
    v_add_u32_sdwa v2, s96, v241 dst_sel:DWORD dst_unused:UNUSED_PAD src0_sel:DWORD src1_sel:WORD_0
    v_add_u32_sdwa v3, s96, v241 dst_sel:DWORD dst_unused:UNUSED_PAD src0_sel:DWORD src1_sel:WORD_1
    s_mul_i32 s98, s98, 3840
    s_sub_u32 s98, 107904, s98
    s_cmp_lt_u32 s28, 4
    s_cselect_b32 s98, 0, s98
    s_mul_i32 s96, s31, 3840
    s_add_u32 s96, s96, s98
    s_add_u32 s97, s97, s96
    v_add_u32_sdwa v21, s97, v242 dst_sel:DWORD dst_unused:UNUSED_PAD src0_sel:DWORD src1_sel:WORD_0
    s_mul_i32 s97, s29, 3840
    s_add_u32 s97, s97, s96
    v_add_u32_sdwa v248, s97, v242 dst_sel:DWORD dst_unused:UNUSED_PAD src0_sel:DWORD src1_sel:WORD_1
    v_add_u32_sdwa v249, s97, v243 dst_sel:DWORD dst_unused:UNUSED_PAD src0_sel:DWORD src1_sel:WORD_0
    v_add_u32_sdwa v250, s97, v243 dst_sel:DWORD dst_unused:UNUSED_PAD src0_sel:DWORD src1_sel:WORD_1
    s_lshr_b32 s97, s28, 1
    s_lshl_b32 s98, s97, 2
    s_lshl_b32 s97, s97, 4
    s_lshr_b64 s[70:71], s[24:25], s97
    s_add_u32 s98, s98, 163808
    s_and_b32 s70, s70, 0x7ff
    v_mov_b32 v6, s98
    s_lshl_b32 s70, s70, 6
    v_lshl_add_u32 v7, v14, 3, s70
    v_cvt_f32_u32 v222, s32
    v_cvt_f32_u32 v220, s74
    v_bfe_u32 v238, v226, 8, 8
    v_add_f32 v221, v222, v224
    v_add_f32 v220, v220, v225
    v_and_b32 v251, 0xffff, v235
    v_add_f32 v222, 1.0, v221
    v_add_f32 v223, 2.0, v221
    v_mov_b32 v236, 0xf000f00
    s_mov_b32 s91, 0x435f435f
    s_lshl_b32 s97, s73, 4
    s_lshr_b64 s[70:71], s[24:25], s97
    s_bfe_u32 s69, s70, 0x5000b
    s_and_b32 s68, s70, 0x7ff
    s_lshl_b32 s69, s69, 2
    s_lshl_b32 s68, s68, 6
    s_mov_b32 s66, s68
    s_add_u32 s67, s68, 1152
    s_lshl_b32 s96, s69, 4
    s_add_u32 s68, s67, s96
    s_sub_u32 s96, s74, s33
    s_sub_u32 s96, s96, 1
    s_mul_i32 s96, s96, 0xf000f0
    s_add_u32 s97, s96, 0x1e001e0
    v_add_u32 v79, s66, v227
    v_add_u32 v184, s96, v232
    v_add_u32 v185, s97, v232
    v_add_u32 v186, s96, v233
    v_add_u32 v187, s97, v233
    v_add_u32 v188, s96, v234
    v_add_u32 v189, s97, v234
    s_bfe_u32 s96, s23, 0x50018
    s_sub_u32 s96, s96, 1
    s_min_u32 s97, s96, 9
    s_cmp_eq_u32 s29, 0
    s_cselect_b32 s96, s97, s96
    v_mov_b32 v229, 0
    v_mov_b32 v230, s96
    s_mov_b32 exec_hi, 0xffff
    ds_write_b64 v79, v[184:185] offset:0
    ds_write_b64 v79, v[186:187] offset:128
    ds_write_b64 v79, v[188:189] offset:256
    s_mov_b32 exec_hi, -1
    s_mov_b32 s27, 0
    s_mov_b32 s64, 0x7fff7fff
    s_cmp_lg_u32 s75, 0
    s_waitcnt vmcnt(1)
    s_cbranch_scc1 L_lx
    v_and_b32 v74, s64, v204
    v_and_b32 v75, s64, v205
    v_pk_max_u16 v72, v74, s26
    v_pk_max_u16 v73, v75, s26
    v_and_b32 v74, s64, v206
    v_and_b32 v75, s64, v208
    v_pk_max_u16 v72, v74, v72
    v_pk_max_u16 v73, v75, v73
    v_and_b32 v74, s64, v209
    v_and_b32 v75, s64, v210
    v_pk_max_u16 v72, v74, v72
    v_pk_max_u16 v73, v75, v73
    v_and_b32 v74, s64, v212
    v_and_b32 v75, s64, v213
    v_pk_max_u16 v72, v74, v72
    v_pk_max_u16 v73, v75, v73
    v_and_b32 v74, s64, v214
    v_and_b32 v75, s64, v216
    v_pk_max_u16 v72, v74, v72
    v_pk_max_u16 v73, v75, v73
    v_and_b32 v74, s64, v217
    v_and_b32 v75, s64, v218
    v_pk_max_u16 v72, v74, v72
    v_pk_max_u16 v73, v75, v73
    v_pk_max_u16 v72, v72, v73
    s_mov_b32 exec_hi, 0xffff
    v_cmp_ne_u32 vcc, s26, v72
    s_mov_b32 exec_hi, -1
    s_cbranch_vccz L_lpub
L_lx:
    s_mov_b32 exec_hi, 0xffff
    v_mov_b32 v237, v220
    v_lshlrev_b32 v72, 16, v204
    v_lshlrev_b32 v156, 16, v205
    v_lshlrev_b32 v180, 16, v206
    v_and_b32 v73, 0xffff0000, v204
    v_and_b32 v157, 0xffff0000, v205
    v_and_b32 v181, 0xffff0000, v206
    v_cvt_pk_bf16_f32 v74, v237, v221
    v_cvt_pk_bf16_f32 v158, v237, v222
    v_cvt_pk_bf16_f32 v182, v237, v223
    v_add_f32 v72, v72, v237
    v_add_f32 v156, v156, v237
    v_add_f32 v180, v180, v237
    v_add_f32 v73, v73, v221
    v_add_f32 v157, v157, v222
    v_add_f32 v181, v181, v223
    v_cvt_pk_bf16_f32 v72, v72, v73
    v_cvt_pk_bf16_f32 v156, v156, v157
    v_cvt_pk_bf16_f32 v180, v180, v181
    v_cmp_ne_u32 s[40:41], v72, v74
    v_cmp_ne_u32 s[42:43], v156, v158
    v_cmp_ne_u32 s[44:45], v180, v182
    v_add_f32 v237, 1.0, v237
    v_lshlrev_b32 v72, 16, v208
    v_lshlrev_b32 v156, 16, v209
    v_lshlrev_b32 v180, 16, v210
    v_and_b32 v73, 0xffff0000, v208
    v_and_b32 v157, 0xffff0000, v209
    v_and_b32 v181, 0xffff0000, v210
    v_cvt_pk_bf16_f32 v74, v237, v221
    v_cvt_pk_bf16_f32 v158, v237, v222
    v_cvt_pk_bf16_f32 v182, v237, v223
    v_add_f32 v72, v72, v237
    v_add_f32 v156, v156, v237
    v_add_f32 v180, v180, v237
    v_add_f32 v73, v73, v221
    v_add_f32 v157, v157, v222
    v_add_f32 v181, v181, v223
    v_cvt_pk_bf16_f32 v72, v72, v73
    v_cvt_pk_bf16_f32 v156, v156, v157
    v_cvt_pk_bf16_f32 v180, v180, v181
    v_cmp_ne_u32 s[46:47], v72, v74
    v_cmp_ne_u32 s[48:49], v156, v158
    v_cmp_ne_u32 s[50:51], v180, v182
    v_add_f32 v237, 1.0, v237
    v_lshlrev_b32 v72, 16, v212
    v_lshlrev_b32 v156, 16, v213
    v_lshlrev_b32 v180, 16, v214
    v_and_b32 v73, 0xffff0000, v212
    v_and_b32 v157, 0xffff0000, v213
    v_and_b32 v181, 0xffff0000, v214
    v_cvt_pk_bf16_f32 v74, v237, v221
    v_cvt_pk_bf16_f32 v158, v237, v222
    v_cvt_pk_bf16_f32 v182, v237, v223
    v_add_f32 v72, v72, v237
    v_add_f32 v156, v156, v237
    v_add_f32 v180, v180, v237
    v_add_f32 v73, v73, v221
    v_add_f32 v157, v157, v222
    v_add_f32 v181, v181, v223
    v_cvt_pk_bf16_f32 v72, v72, v73
    v_cvt_pk_bf16_f32 v156, v156, v157
    v_cvt_pk_bf16_f32 v180, v180, v181
    v_cmp_ne_u32 s[52:53], v72, v74
    v_cmp_ne_u32 s[54:55], v156, v158
    v_cmp_ne_u32 s[56:57], v180, v182
    v_add_f32 v237, 1.0, v237
    v_lshlrev_b32 v72, 16, v216
    v_lshlrev_b32 v156, 16, v217
    v_lshlrev_b32 v180, 16, v218
    v_and_b32 v73, 0xffff0000, v216
    v_and_b32 v157, 0xffff0000, v217
    v_and_b32 v181, 0xffff0000, v218
    v_cvt_pk_bf16_f32 v74, v237, v221
    v_cvt_pk_bf16_f32 v158, v237, v222
    v_cvt_pk_bf16_f32 v182, v237, v223
    v_add_f32 v72, v72, v237
    v_add_f32 v156, v156, v237
    v_add_f32 v180, v180, v237
    v_add_f32 v73, v73, v221
    v_add_f32 v157, v157, v222
    v_add_f32 v181, v181, v223
    v_cvt_pk_bf16_f32 v72, v72, v73
    v_cvt_pk_bf16_f32 v156, v156, v157
    v_cvt_pk_bf16_f32 v180, v180, v181
    v_cmp_ne_u32 s[58:59], v72, v74
    v_cmp_ne_u32 s[60:61], v156, v158
    v_cmp_ne_u32 s[62:63], v180, v182
    s_mov_b32 exec_hi, -1
    v_mov_b32 v77, 0
    v_mov_b32 v76, 0
    v_addc_co_u32 v77, vcc, 0, v77, s[40:41]
    v_addc_co_u32 v76, vcc, 0, v76, s[42:43]
    v_addc_co_u32 v77, vcc, 0, v77, s[44:45]
    v_addc_co_u32 v76, vcc, 0, v76, s[46:47]
    v_addc_co_u32 v77, vcc, 0, v77, s[48:49]
    v_addc_co_u32 v76, vcc, 0, v76, s[50:51]
    v_addc_co_u32 v77, vcc, 0, v77, s[52:53]
    v_addc_co_u32 v76, vcc, 0, v76, s[54:55]
    v_addc_co_u32 v77, vcc, 0, v77, s[56:57]
    v_addc_co_u32 v76, vcc, 0, v76, s[58:59]
    v_addc_co_u32 v77, vcc, 0, v77, s[60:61]
    v_addc_co_u32 v76, vcc, 0, v76, s[62:63]
    v_add_u32 v77, v77, v76
    v_mov_b32 v78, v77
    s_nop 1
    v_add_u32_dpp v78, v78, v78 row_shr:1 row_mask:0xf bank_mask:0xf bound_ctrl:0
    s_nop 1
    v_add_u32_dpp v78, v78, v78 row_shr:2 row_mask:0xf bank_mask:0xf bound_ctrl:0
    s_nop 1
    v_add_u32_dpp v78, v78, v78 row_shr:4 row_mask:0xf bank_mask:0xf bound_ctrl:0
    s_nop 1
    v_add_u32_dpp v78, v78, v78 row_shr:8 row_mask:0xf bank_mask:0xf bound_ctrl:0
    s_nop 1
    v_add_u32_dpp v78, v78, v78 row_bcast:15 row_mask:0xa bank_mask:0xf
    s_nop 1
    v_add_u32_dpp v78, v78, v78 row_bcast:31 row_mask:0xc bank_mask:0xf
    s_sub_u32 s96, s67, 16
    v_readlane_b32 s27, v78, 63
    v_sub_u32 v78, v78, v77
    v_lshl_add_u32 v81, v78, 4, s96
    s_cmp_gt_u32 s27, s69
    s_cbranch_scc1 L_lfail
    s_cmp_eq_u32 s27, 0
    s_cbranch_scc1 L_lpub
    s_mov_b64 exec, s[40:41]
    s_cbranch_execz L_lb00
    v_add_u32 v80, 0x0, v226
    v_add_u32 v81, 16, v81
    ds_write2_b32 v81, v204, v80 offset1:1
L_lb00:
    s_mov_b64 exec, s[42:43]
    s_cbranch_execz L_lb01
    v_add_u32 v80, 0x1000000, v226
    v_add_u32 v81, 16, v81
    ds_write2_b32 v81, v205, v80 offset1:1
L_lb01:
    s_mov_b64 exec, s[44:45]
    s_cbranch_execz L_lb02
    v_add_u32 v80, 0x2000000, v226
    v_add_u32 v81, 16, v81
    ds_write2_b32 v81, v206, v80 offset1:1
L_lb02:
    s_mov_b64 exec, s[46:47]
    s_cbranch_execz L_lb10
    v_add_u32 v80, 0x10000, v226
    v_add_u32 v81, 16, v81
    ds_write2_b32 v81, v208, v80 offset1:1
L_lb10:
    s_mov_b64 exec, s[48:49]
    s_cbranch_execz L_lb11
    v_add_u32 v80, 0x1010000, v226
    v_add_u32 v81, 16, v81
    ds_write2_b32 v81, v209, v80 offset1:1
L_lb11:
    s_mov_b64 exec, s[50:51]
    s_cbranch_execz L_lb12
    v_add_u32 v80, 0x2010000, v226
    v_add_u32 v81, 16, v81
    ds_write2_b32 v81, v210, v80 offset1:1
L_lb12:
    s_mov_b64 exec, s[52:53]
    s_cbranch_execz L_lb20
    v_add_u32 v80, 0x20000, v226
    v_add_u32 v81, 16, v81
    ds_write2_b32 v81, v212, v80 offset1:1
L_lb20:
    s_mov_b64 exec, s[54:55]
    s_cbranch_execz L_lb21
    v_add_u32 v80, 0x1020000, v226
    v_add_u32 v81, 16, v81
    ds_write2_b32 v81, v213, v80 offset1:1
L_lb21:
    s_mov_b64 exec, s[56:57]
    s_cbranch_execz L_lb22
    v_add_u32 v80, 0x2020000, v226
    v_add_u32 v81, 16, v81
    ds_write2_b32 v81, v214, v80 offset1:1
L_lb22:
    s_mov_b64 exec, s[58:59]
    s_cbranch_execz L_lb30
    v_add_u32 v80, 0x30000, v226
    v_add_u32 v81, 16, v81
    ds_write2_b32 v81, v216, v80 offset1:1
L_lb30:
    s_mov_b64 exec, s[60:61]
    s_cbranch_execz L_lb31
    v_add_u32 v80, 0x1030000, v226
    v_add_u32 v81, 16, v81
    ds_write2_b32 v81, v217, v80 offset1:1
L_lb31:
    s_mov_b64 exec, s[62:63]
    s_cbranch_execz L_lb32
    v_add_u32 v80, 0x2030000, v226
    v_add_u32 v81, 16, v81
    ds_write2_b32 v81, v218, v80 offset1:1
L_lb32:
    s_mov_b64 exec, -1
    s_sub_u32 s96, s27, 1
    v_lshrrev_b32 v80, 4, v16
    v_min_u32 v80, s96, v80
    v_lshl_add_u32 v231, v80, 4, s67
    ds_read_b64 v[158:159], v231
    s_lshr_b32 s96, s68, 4
    v_bfe_u32 v161, v80, 1, 2
    v_mad_u32_u24 v80, v80, 12, s96
    v_add_u32 v161, v161, v80
    s_sub_u32 s97, s32, 1
    s_sub_u32 s98, s74, 1
    s_waitcnt lgkmcnt(0)
    v_bfe_u32 v156, v159, 8, 8
    v_and_b32 v80, 0xff, v159
    v_bfe_u32 v81, v159, 16, 8
    v_lshrrev_b32 v159, 24, v159
    v_mad_u32_u24 v160, v156, 3, v159
    v_lshl_add_u32 v78, v80, 2, v81
    v_add3_u32 v80, v80, v159, s97
    v_add3_u32 v81, v81, v156, s98
    v_lshl_add_u32 v160, v160, 6, v78
    v_cvt_f32_i32 v157, v80
    v_cvt_f32_i32 v237, v81
    v_lshl_add_u32 v160, v160, 1, s66
    v_lshlrev_b32 v77, 16, v158
    v_and_b32 v78, 0xffff0000, v158
    v_add_f32 v77, v77, v237
    v_add_f32 v78, v78, v157
    v_cvt_pk_bf16_f32 v76, v77, v78
    v_pk_max_i16 v76, v76, 0
    v_pk_min_i16 v76, v76, s91
    v_lshlrev_b32 v77, 16, v76
    v_and_b32 v78, 0xffff0000, v76
    v_fract_f32 v79, v77
    v_fract_f32 v80, v78
    v_cvt_u32_f32 v81, v77
    v_cvt_u32_f32 v82, v78
    v_cmp_neq_f32 s[44:45], 0, v80
    v_cmp_neq_f32 s[46:47], 0, v79
    v_sub_f32 v83, 1.0, v79
    v_sub_f32 v84, 1.0, v80
    v_subrev_u32 v81, s33, v81
    v_subrev_u32 v82, s34, v82
    v_cvt_pk_bf16_f32 v77, v83, v84
    v_sub_u32 v89, v81, v229
    v_addc_co_u32 v91, vcc, 0, v82, s[44:45]
    v_lshlrev_b32 v83, 16, v77
    v_and_b32 v84, 0xffff0000, v77
    v_addc_co_u32 v90, vcc, 0, v89, s[46:47]
    v_mul_u32_u24 v92, 960, v81
    v_mul_f32 v85, v83, v84
    v_mul_f32 v86, v83, v80
    v_mul_f32 v87, v79, v84
    v_mul_f32 v88, v79, v80
    v_max_u32 v89, v89, v90
    v_subrev_u32 v77, s100, v82
    v_subrev_u32 v78, s100, v91
    v_mad_u32_u24 v83, v82, 48, v92
    v_mad_u32_u24 v84, v91, 48, v92
    v_and_b32 v82, 12, v82
    v_and_b32 v91, 12, v91
    v_max_u32 v77, v77, v78
    s_andn2_b64 s[48:49], s[46:47], s[44:45]
    v_add_lshl_u32 v83, v83, v82, 2
    v_add_lshl_u32 v84, v84, v91, 2
    v_cndmask_b32 v86, v87, v86, s[44:45]
    v_cndmask_b32 v78, 0, v236, s[48:49]
    s_and_b64 s[48:49], s[46:47], s[44:45]
    v_cndmask_b32 v87, 0, v87, s[44:45]
    v_cmp_lt_u32 s[46:47], v230, v89
    v_cmp_lt_u32 s[44:45], s101, v77
    v_lshl_or_b32 v74, v84, 16, v83
    v_cvt_pk_bf16_f32 v73, v85, v86
    v_cvt_pk_bf16_f32 v75, v87, v88
    v_and_b32 v78, 0xffff0000, v78
    v_cndmask_b32 v77, 0, v236, s[48:49]
    s_or_b64 s[44:45], s[44:45], s[46:47]
    v_add_u32 v72, v74, v78
    v_add_u32 v74, v74, v77
    ds_write_b128 v231, v[72:75]
    ds_write_b16 v160, v161
    s_mov_b32 s38, 1
    s_cmp_eq_u64 s[44:45], 0
    s_cbranch_scc1 L_lpub
L_lfail:
    s_mov_b32 s38, 2
    s_mov_b32 s27, 0
L_lpub:
    s_lshl_b32 s96, s73, 2
    s_add_u32 s96, s96, 163808
    s_lshl_b32 s97, s27, 2
    s_or_b32 s97, s97, s38
    v_mov_b32 v80, s97
    v_mov_b32 v81, s96
    ds_write_b32 v81, v80
    s_cmp_eq_u32 s29, 0
    s_cselect_b32 s27, s27, 0
    s_or_b32 s3, s37, s39
    s_or_b32 s3, s3, s99
    s_or_b32 s3, s3, 512
    s_cmp_eq_u32 s27, 0
    s_cbranch_scc1 L_hf0
    s_mov_b32 s52, 0
    s_mov_b32 s53, s27
    s_mov_b32 s54, 16
    s_sub_u32 s97, s53, 1
    v_add_u32 v17, s52, v251
    v_add_u32 v252, s52, v14
    v_min_u32 v17, s97, v17
    v_min_u32 v252, s97, v252
    v_lshl_add_u32 v17, v17, 4, s67
    v_bfe_u32 v253, v252, 1, 2
    ds_read_b128 v[236:239], v17
    v_mad_u32_u24 v252, v252, 12, v253
    v_and_b32 v253, 3, v15
    s_add_u32 s52, s52, s54
    v_xor_b32 v252, v252, v253
    v_lshl_add_u32 v252, v252, 4, s68
    s_waitcnt lgkmcnt(0)
    v_xor_b32_sdwa v244, v236, v12 dst_sel:DWORD dst_unused:UNUSED_PAD src0_sel:WORD_0 src1_sel:DWORD
    v_xor_b32_sdwa v246, v236, v12 dst_sel:DWORD dst_unused:UNUSED_PAD src0_sel:WORD_1 src1_sel:DWORD
    v_xor_b32_sdwa v245, v236, v13 dst_sel:DWORD dst_unused:UNUSED_PAD src0_sel:WORD_0 src1_sel:DWORD
    v_xor_b32_sdwa v247, v236, v13 dst_sel:DWORD dst_unused:UNUSED_PAD src0_sel:WORD_1 src1_sel:DWORD
    v_cmp_ne_u32 vcc, 0, v239
    v_perm_b32 v228, v237, v237, v8
    v_perm_b32 v229, v237, v237, v9
    v_perm_b32 v230, v237, v237, v10
    v_perm_b32 v231, v237, v237, v11
    s_setprio 3
    s_barrier
    s_call_b64 s[76:77], L_gpb
    s_branch L_hf1
L_hf0:
    s_waitcnt lgkmcnt(0)
    s_barrier
L_hf1:
    v_mov_b32 v17, 163808
    ds_read_b32 v182, v6
    ds_read_b64 v[180:181], v17
    ds_read_b64 v[236:237], v7
    s_waitcnt lgkmcnt(1)
    v_readfirstlane_b32 s38, v182
    v_cmp_ne_u64 vcc, 0, v[180:181]
    s_cbranch_vccz L_nfirst
    s_bitcmp1_b32 s38, 0
    s_cbranch_scc0 L_hf2
    ds_read_b64_tr_b16 v[72:73], v5 offset:0
    ds_read_b64_tr_b16 v[74:75], v5 offset:768
    ds_read_b64_tr_b16 v[76:77], v5 offset:32
    ds_read_b64_tr_b16 v[78:79], v5 offset:800
    ds_read_b64_tr_b16 v[80:81], v5 offset:64
    ds_read_b64_tr_b16 v[82:83], v5 offset:832
    s_waitcnt lgkmcnt(6)
    v_xor_b32 v236, v236, v15
    v_xor_b32 v237, v237, v15
    v_lshlrev_b32_sdwa v240, 4, v236 dst_sel:DWORD dst_unused:UNUSED_PAD src0_sel:DWORD src1_sel:WORD_0
    v_lshlrev_b32_sdwa v241, 4, v236 dst_sel:DWORD dst_unused:UNUSED_PAD src0_sel:DWORD src1_sel:WORD_1
    v_lshlrev_b32_sdwa v242, 4, v237 dst_sel:DWORD dst_unused:UNUSED_PAD src0_sel:DWORD src1_sel:WORD_0
    v_lshlrev_b32_sdwa v243, 4, v237 dst_sel:DWORD dst_unused:UNUSED_PAD src0_sel:DWORD src1_sel:WORD_1
    s_branch L_pf0
L_hf2:
    s_cmp_eq_u32 s38, 0
    s_barrier
    s_cbranch_scc1 L_nfirst
    s_branch L_trip
L_gp:
    s_cmp_ge_u32 s52, s53
    s_cbranch_scc1 L_gpr
    s_setprio 3
L_gpl:
    s_sub_u32 s97, s53, 1
    v_add_u32 v17, s52, v251
    v_add_u32 v252, s52, v14
    v_min_u32 v17, s97, v17
    v_min_u32 v252, s97, v252
    v_lshl_add_u32 v17, v17, 4, s67
    v_bfe_u32 v253, v252, 1, 2
    ds_read_b128 v[236:239], v17
    v_mad_u32_u24 v252, v252, 12, v253
    v_and_b32 v253, 3, v15
    s_add_u32 s52, s52, s54
    v_xor_b32 v252, v252, v253
    v_lshl_add_u32 v252, v252, 4, s68
    s_waitcnt lgkmcnt(0)
    v_xor_b32_sdwa v244, v236, v12 dst_sel:DWORD dst_unused:UNUSED_PAD src0_sel:WORD_0 src1_sel:DWORD
    v_xor_b32_sdwa v246, v236, v12 dst_sel:DWORD dst_unused:UNUSED_PAD src0_sel:WORD_1 src1_sel:DWORD
    v_xor_b32_sdwa v245, v236, v13 dst_sel:DWORD dst_unused:UNUSED_PAD src0_sel:WORD_0 src1_sel:DWORD
    v_xor_b32_sdwa v247, v236, v13 dst_sel:DWORD dst_unused:UNUSED_PAD src0_sel:WORD_1 src1_sel:DWORD
    v_cmp_ne_u32 vcc, 0, v239
    v_perm_b32 v228, v237, v237, v8
    v_perm_b32 v229, v237, v237, v9
    v_perm_b32 v230, v237, v237, v10
    v_perm_b32 v231, v237, v237, v11
L_gpb:
    ds_read_b64_tr_b16 v[156:157], v244 offset:0
    ds_read_b64_tr_b16 v[158:159], v246 offset:0
    ds_read_b64_tr_b16 v[160:161], v245 offset:0
    ds_read_b64_tr_b16 v[162:163], v247 offset:0
    ds_read_b64_tr_b16 v[164:165], v244 offset:64
    ds_read_b64_tr_b16 v[166:167], v246 offset:64
    ds_read_b64_tr_b16 v[168:169], v245 offset:64
    ds_read_b64_tr_b16 v[170:171], v247 offset:64
    ds_read_b64_tr_b16 v[172:173], v244 offset:128
    ds_read_b64_tr_b16 v[174:175], v246 offset:128
    ds_read_b64_tr_b16 v[176:177], v245 offset:128
    ds_read_b64_tr_b16 v[178:179], v247 offset:128
    s_cbranch_vccnz L_gp4
    s_waitcnt lgkmcnt(8)
    v_mfma_f32_16x16x32_bf16 v[204:207], v[156:159], v[228:231], 0
    v_mfma_f32_16x16x32_bf16 v[208:211], v[160:163], v[228:231], 0
    s_waitcnt lgkmcnt(4)
    v_mfma_f32_16x16x32_bf16 v[212:215], v[164:167], v[228:231], 0
    v_mfma_f32_16x16x32_bf16 v[216:219], v[168:171], v[228:231], 0
    s_waitcnt lgkmcnt(0)
    v_mfma_f32_16x16x32_bf16 v[220:223], v[172:175], v[228:231], 0
    v_mfma_f32_16x16x32_bf16 v[224:227], v[176:179], v[228:231], 0
L_gpw:
    s_nop 1
    v_cvt_pk_bf16_f32 v156, v204, v205
    v_cvt_pk_bf16_f32 v157, v206, v207
    v_cvt_pk_bf16_f32 v158, v208, v209
    v_cvt_pk_bf16_f32 v159, v210, v211
    v_cvt_pk_bf16_f32 v160, v212, v213
    v_cvt_pk_bf16_f32 v161, v214, v215
    v_cvt_pk_bf16_f32 v162, v216, v217
    v_cvt_pk_bf16_f32 v163, v218, v219
    v_cvt_pk_bf16_f32 v164, v220, v221
    v_cvt_pk_bf16_f32 v165, v222, v223
    v_cvt_pk_bf16_f32 v166, v224, v225
    v_cvt_pk_bf16_f32 v167, v226, v227
    v_permlane32_swap_b32 v156, v158
    v_permlane32_swap_b32 v157, v159
    v_permlane32_swap_b32 v160, v162
    v_permlane32_swap_b32 v161, v163
    v_permlane32_swap_b32 v164, v166
    v_permlane32_swap_b32 v165, v167
    ds_write_b128 v252, v[156:159] offset:0
    ds_write_b128 v252, v[160:163] offset:64
    ds_write_b128 v252, v[164:167] offset:128
    s_cmp_lt_u32 s52, s53
    s_cbranch_scc1 L_gpl
L_gpr:
    s_setpc_b64 s[76:77]
L_gp4:
    v_xor_b32_sdwa v244, v238, v12 dst_sel:DWORD dst_unused:UNUSED_PAD src0_sel:WORD_0 src1_sel:DWORD
    v_xor_b32_sdwa v246, v238, v12 dst_sel:DWORD dst_unused:UNUSED_PAD src0_sel:WORD_1 src1_sel:DWORD
    v_xor_b32_sdwa v245, v238, v13 dst_sel:DWORD dst_unused:UNUSED_PAD src0_sel:WORD_0 src1_sel:DWORD
    v_xor_b32_sdwa v247, v238, v13 dst_sel:DWORD dst_unused:UNUSED_PAD src0_sel:WORD_1 src1_sel:DWORD
    ds_read_b64_tr_b16 v[180:181], v244 offset:0
    ds_read_b64_tr_b16 v[182:183], v246 offset:0
    ds_read_b64_tr_b16 v[184:185], v245 offset:0
    ds_read_b64_tr_b16 v[186:187], v247 offset:0
    ds_read_b64_tr_b16 v[188:189], v244 offset:64
    ds_read_b64_tr_b16 v[190:191], v246 offset:64
    ds_read_b64_tr_b16 v[192:193], v245 offset:64
    ds_read_b64_tr_b16 v[194:195], v247 offset:64
    ds_read_b64_tr_b16 v[196:197], v244 offset:128
    ds_read_b64_tr_b16 v[198:199], v246 offset:128
    ds_read_b64_tr_b16 v[200:201], v245 offset:128
    ds_read_b64_tr_b16 v[202:203], v247 offset:128
    v_perm_b32 v232, v239, v239, v8
    v_perm_b32 v233, v239, v239, v9
    v_perm_b32 v234, v239, v239, v10
    v_perm_b32 v235, v239, v239, v11
    s_waitcnt lgkmcnt(12)
    v_mfma_f32_16x16x32_bf16 v[204:207], v[156:159], v[228:231], 0
    v_mfma_f32_16x16x32_bf16 v[208:211], v[160:163], v[228:231], 0
    v_mfma_f32_16x16x32_bf16 v[212:215], v[164:167], v[228:231], 0
    v_mfma_f32_16x16x32_bf16 v[216:219], v[168:171], v[228:231], 0
    v_mfma_f32_16x16x32_bf16 v[220:223], v[172:175], v[228:231], 0
    v_mfma_f32_16x16x32_bf16 v[224:227], v[176:179], v[228:231], 0
    s_waitcnt lgkmcnt(0)
    v_mfma_f32_16x16x32_bf16 v[204:207], v[180:183], v[232:235], v[204:207]
    v_mfma_f32_16x16x32_bf16 v[208:211], v[184:187], v[232:235], v[208:211]
    v_mfma_f32_16x16x32_bf16 v[212:215], v[188:191], v[232:235], v[212:215]
    v_mfma_f32_16x16x32_bf16 v[216:219], v[192:195], v[232:235], v[216:219]
    v_mfma_f32_16x16x32_bf16 v[220:223], v[196:199], v[232:235], v[220:223]
    v_mfma_f32_16x16x32_bf16 v[224:227], v[200:203], v[232:235], v[224:227]
    s_branch L_gpw
.p2align 12
L_startBH:
    s_waitcnt lgkmcnt(0)
    s_add_u32 m0, s88, 0
    s_mov_b32 s96, 0
    buffer_load_dwordx4 v19, s[12:15], s96 offen lds
    s_add_u32 m0, s89, 4128
    s_mov_b32 s96, 4096
    buffer_load_dwordx4 v19, s[12:15], s96 offen lds
    s_bfe_u32 s75, s23, 0x1001e
    s_bitset0_b32 s23, 30
    s_lshr_b32 s96, s22, s30
    s_and_b32 s32, s23, 0xff
    s_and_b32 s31, s96, 15
    s_bfe_u32 s30, s96, 0x30004
    s_bfe_u32 s33, s23, 0x80008
    s_add_u32 s0, s33, s31
    s_mul_i32 s3, s0, 224
    s_add_u32 s3, s3, s32
    s_mul_i32 s3, s3, 36
    s_mov_b32 s74, s0
    s_sub_u32 s34, s32, 2
    s_bfe_u32 s100, s23, 0x10011
    s_lshl_b32 s101, s100, 1
    s_sub_u32 s101, 19, s101
    s_bfe_u32 s96, s23, 0x10010
    s_sub_u32 s33, s33, s96
    s_sub_u32 s33, s33, 1
    s_movk_i32 s97, 223
    v_add_u32 v74, s34, v76
    v_subrev_u32 v75, s100, v76
    v_med3_i32 v74, v74, 0, s97
    v_cmp_ge_u32 vcc, s101, v75
    v_mul_u32_u24 v74, 192, v74
    s_and_b64 s[92:93], s[92:93], vcc
    v_add_u32 v20, v74, v20
    s_add_u32 m0, s90, 8256
    s_mov_b32 s96, 8192
    buffer_load_dwordx4 v19, s[12:15], s96 offen lds
    s_add_u32 m0, s88, 12416
    s_mov_b32 s96, 12288
    buffer_load_dwordx4 v19, s[12:15], s96 offen lds
    s_add_u32 m0, s89, 16544
    s_mov_b32 s96, 16384
    buffer_load_dwordx4 v19, s[12:15], s96 offen lds
    s_max_i32 s96, s20, 0
    s_add_u32 m0, s94, 0
    s_mov_b64 exec, s[92:93]
    s_add_u32 s20, s20, 43008
    buffer_load_dwordx4 v20, s[4:7], s96 offen lds
    s_max_i32 s96, s20, 0
    s_addk_i32 m0, 3840
    s_add_u32 s20, s20, 43008
    buffer_load_dwordx4 v20, s[4:7], s96 offen lds
    s_min_i32 s96, s20, s21
    s_addk_i32 m0, 3840
    s_add_u32 s20, s20, 43008
    buffer_load_dwordx4 v20, s[4:7], s96 offen lds
    s_min_i32 s96, s20, s21
    s_addk_i32 m0, 3840
    s_add_u32 s20, s20, 43008
    buffer_load_dwordx4 v20, s[4:7], s96 offen lds
    s_min_i32 s96, s20, s21
    s_addk_i32 m0, 3840
    s_add_u32 s20, s20, 43008
    buffer_load_dwordx4 v20, s[4:7], s96 offen lds
    s_min_i32 s96, s20, s21
    s_addk_i32 m0, 3840
    s_add_u32 s20, s20, 43008
    buffer_load_dwordx4 v20, s[4:7], s96 offen lds
    s_min_i32 s96, s20, s21
    s_addk_i32 m0, 3840
    s_add_u32 s20, s20, 43008
    buffer_load_dwordx4 v20, s[4:7], s96 offen lds
    s_min_i32 s96, s20, s21
    s_addk_i32 m0, 3840
    s_add_u32 s20, s20, 43008
    buffer_load_dwordx4 v20, s[4:7], s96 offen lds
    s_min_i32 s96, s20, s21
    s_addk_i32 m0, 3840
    s_add_u32 s20, s20, 43008
    buffer_load_dwordx4 v20, s[4:7], s96 offen lds
    s_min_i32 s96, s20, s21
    s_addk_i32 m0, 3840
    s_add_u32 s20, s20, 43008
    buffer_load_dwordx4 v20, s[4:7], s96 offen lds
    s_mov_b64 exec, -1
    s_mov_b32 s35, 0
    s_mov_b32 s37, 0
    s_mov_b32 s38, 0
    v_mov_b32 v108, 0
    v_mov_b32 v109, 0
    v_mov_b32 v110, 0
    v_mov_b32 v111, 0
    s_cmp_lt_u32 s28, 4
    s_cselect_b32 s39, 0, 0x3e
    s_cselect_b32 s99, 0, 768
    s_mov_b32 s95, 73728
    s_lshl_b32 s96, s28, 2
    s_add_u32 s96, s96, 163776
    v_mov_b32 v254, s96
    v_mfma_f32_32x32x16_bf16 v[24:39], v[108:111], v[108:111], 0
    v_mfma_f32_32x32x16_bf16 v[40:55], v[108:111], v[108:111], 0
    v_mfma_f32_32x32x16_bf16 v[56:71], v[108:111], v[108:111], 0
    v_xor_b32 v255, 4, v254
    ds_write_b32 v254, v108
    s_waitcnt vmcnt(15)
    s_sub_u32 s96, s0, s33
    s_mul_i32 s97, s29, 96
    s_sub_u32 s96, s96, 1
    s_add_u32 s98, s97, 89280
    s_mul_i32 s96, s96, 3840
    v_add_u32_sdwa v4, s98, v240 dst_sel:DWORD dst_unused:UNUSED_PAD src0_sel:DWORD src1_sel:WORD_0
    v_add_u32_sdwa v5, s98, v240 dst_sel:DWORD dst_unused:UNUSED_PAD src0_sel:DWORD src1_sel:WORD_0
    s_bfe_u32 s98, s23, 0x40014
    v_add_u32_sdwa v1, s96, v240 dst_sel:DWORD dst_unused:UNUSED_PAD src0_sel:DWORD src1_sel:WORD_1
    v_add_u32_sdwa v2, s96, v241 dst_sel:DWORD dst_unused:UNUSED_PAD src0_sel:DWORD src1_sel:WORD_0
    v_add_u32_sdwa v3, s96, v241 dst_sel:DWORD dst_unused:UNUSED_PAD src0_sel:DWORD src1_sel:WORD_1
    s_mul_i32 s98, s98, 3840
    s_sub_u32 s98, 107904, s98
    s_cmp_lt_u32 s28, 4
    s_cselect_b32 s98, 0, s98
    s_mul_i32 s96, s31, 3840
    s_add_u32 s96, s96, s98
    s_add_u32 s97, s97, s96
    v_add_u32_sdwa v21, s97, v242 dst_sel:DWORD dst_unused:UNUSED_PAD src0_sel:DWORD src1_sel:WORD_0
    s_mul_i32 s97, s29, 3840
    s_add_u32 s97, s97, s96
    v_add_u32_sdwa v248, s97, v242 dst_sel:DWORD dst_unused:UNUSED_PAD src0_sel:DWORD src1_sel:WORD_1
    v_add_u32_sdwa v249, s97, v243 dst_sel:DWORD dst_unused:UNUSED_PAD src0_sel:DWORD src1_sel:WORD_0
    v_add_u32_sdwa v250, s97, v243 dst_sel:DWORD dst_unused:UNUSED_PAD src0_sel:DWORD src1_sel:WORD_1
    s_lshr_b32 s97, s28, 1
    s_lshl_b32 s98, s97, 2
    s_lshl_b32 s97, s97, 4
    s_lshr_b64 s[70:71], s[24:25], s97
    s_add_u32 s98, s98, 163808
    s_and_b32 s70, s70, 0x7ff
    v_mov_b32 v6, s98
    s_lshl_b32 s70, s70, 6
    v_lshl_add_u32 v7, v14, 3, s70
    v_and_b32 v251, 0xffff, v235
    s_lshr_b32 s73, s28, 1
    s_lshl_b32 s97, s73, 4
    s_lshr_b64 s[70:71], s[24:25], s97
    s_bfe_u32 s69, s70, 0x5000b
    s_and_b32 s68, s70, 0x7ff
    s_lshl_b32 s69, s69, 2
    s_lshl_b32 s68, s68, 6
    s_mov_b32 s66, s68
    s_add_u32 s67, s68, 1152
    s_lshl_b32 s96, s69, 4
    s_add_u32 s68, s67, s96
    s_add_u32 m0, s90, 20672
    s_mov_b32 s96, 20480
    buffer_load_dwordx4 v19, s[12:15], s96 offen lds
    s_add_u32 m0, s88, 24832
    s_mov_b32 s96, 24576
    buffer_load_dwordx4 v19, s[12:15], s96 offen lds
    s_add_u32 m0, s89, 28960
    s_mov_b32 s96, 28672
    buffer_load_dwordx4 v19, s[12:15], s96 offen lds
    s_add_u32 m0, s90, 33088
    s_mov_b32 s96, 32768
    buffer_load_dwordx4 v19, s[12:15], s96 offen lds
    s_waitcnt vmcnt(4)
    s_waitcnt lgkmcnt(0)
    s_barrier
    v_mov_b32 v17, 163808
    ds_read_b32 v182, v6
    ds_read_b64 v[180:181], v17
    s_min_i32 s96, s20, s21
    s_add_u32 m0, s94, 38400
    s_mov_b64 exec, s[92:93]
    s_add_u32 s20, s20, 43008
    buffer_load_dwordx4 v20, s[4:7], s96 offen lds
    s_min_i32 s96, s20, s21
    s_addk_i32 m0, 3840
    s_add_u32 s20, s20, 43008
    buffer_load_dwordx4 v20, s[4:7], s96 offen lds
    s_min_i32 s96, s20, s21
    s_addk_i32 m0, 3840
    s_add_u32 s20, s20, 43008
    buffer_load_dwordx4 v20, s[4:7], s96 offen lds
    s_min_i32 s96, s20, s21
    s_addk_i32 m0, 3840
    s_add_u32 s20, s20, 43008
    buffer_load_dwordx4 v20, s[4:7], s96 offen lds
    s_min_i32 s96, s20, s21
    s_addk_i32 m0, 3840
    s_add_u32 s20, s20, 43008
    buffer_load_dwordx4 v20, s[4:7], s96 offen lds
    s_mov_b64 exec, -1
    s_cmp_lt_u32 s23, 268435456
    s_cbranch_scc1 L_bh1
    s_min_i32 s96, s20, s21
    s_add_u32 m0, s94, 57600
    s_mov_b64 exec, s[92:93]
    s_add_u32 s20, s20, 43008
    buffer_load_dwordx4 v20, s[4:7], s96 offen lds
    s_mov_b64 exec, -1
    s_cmp_lt_u32 s23, 285212672
    s_cbranch_scc1 L_bh1
    s_min_i32 s96, s20, s21
    s_add_u32 m0, s94, 61440
    s_mov_b64 exec, s[92:93]
    s_add_u32 s20, s20, 43008
    buffer_load_dwordx4 v20, s[4:7], s96 offen lds
    s_mov_b64 exec, -1
L_bh1:
    s_waitcnt lgkmcnt(0)
    v_readfirstlane_b32 s38, v182
    v_cmp_ne_u64 vcc, 0, v[180:181]
    s_cbranch_vccz L_bh0
    s_barrier
L_bh0:
    s_add_u32 m0, s88, 37248
    s_mov_b32 s96, 36864
    buffer_load_dwordx4 v19, s[12:15], s96 offen lds
    s_add_u32 m0, s89, 41376
    s_mov_b32 s96, 40960
    buffer_load_dwordx4 v19, s[12:15], s96 offen lds
    s_add_u32 m0, s90, 45504
    s_mov_b32 s96, 45056
    buffer_load_dwordx4 v19, s[12:15], s96 offen lds
    s_add_u32 m0, s88, 49664
    s_mov_b32 s96, 49152
    buffer_load_dwordx4 v19, s[12:15], s96 offen lds
    s_add_u32 m0, s89, 53792
    s_mov_b32 s96, 53248
    buffer_load_dwordx4 v19, s[12:15], s96 offen lds
    s_add_u32 m0, s90, 57920
    s_mov_b32 s96, 57344
    buffer_load_dwordx4 v19, s[12:15], s96 offen lds
    s_add_u32 m0, s88, 62080
    s_mov_b32 s96, 61440
    buffer_load_dwordx4 v19, s[12:15], s96 offen lds
    s_add_u32 m0, s89, 66208
    s_mov_b32 s96, 65536
    buffer_load_dwordx4 v19, s[12:15], s96 offen lds
    s_add_u32 m0, s90, 70336
    s_mov_b32 s96, 69632
    buffer_load_dwordx4 v19, s[12:15], s96 offen lds
    s_waitcnt vmcnt(14)
    s_barrier
    s_branch L_hB
L_hB:
    s_bitcmp1_b32 s38, 0
    s_cbranch_scc1 L_hB1
    s_waitcnt vmcnt(4)
    s_branch L_first
L_hB1:
    s_or_b32 s3, s37, s39
    s_or_b32 s3, s3, s99
    s_or_b32 s3, s3, 512
    s_lshr_b32 s27, s38, 2
    ds_read_b64 v[236:237], v7
    s_mov_b32 s52, 0
    s_mov_b32 s53, s27
    s_mov_b32 s54, 16
    s_waitcnt lgkmcnt(0)
    v_xor_b32 v236, v236, v15
    v_xor_b32 v237, v237, v15
    v_lshlrev_b32_sdwa v240, 4, v236 dst_sel:DWORD dst_unused:UNUSED_PAD src0_sel:DWORD src1_sel:WORD_0
    v_lshlrev_b32_sdwa v241, 4, v236 dst_sel:DWORD dst_unused:UNUSED_PAD src0_sel:DWORD src1_sel:WORD_1
    v_lshlrev_b32_sdwa v242, 4, v237 dst_sel:DWORD dst_unused:UNUSED_PAD src0_sel:DWORD src1_sel:WORD_0
    v_lshlrev_b32_sdwa v243, 4, v237 dst_sel:DWORD dst_unused:UNUSED_PAD src0_sel:DWORD src1_sel:WORD_1
    s_sub_u32 s97, s53, 1
    v_add_u32 v17, s52, v251
    v_add_u32 v252, s52, v14
    v_min_u32 v17, s97, v17
    v_min_u32 v252, s97, v252
    v_lshl_add_u32 v17, v17, 4, s67
    v_bfe_u32 v253, v252, 1, 2
    ds_read_b128 v[236:239], v17
    v_mad_u32_u24 v252, v252, 12, v253
    v_and_b32 v253, 3, v15
    s_add_u32 s52, s52, s54
    v_xor_b32 v252, v252, v253
    v_lshl_add_u32 v252, v252, 4, s68
    s_waitcnt lgkmcnt(0)
    v_xor_b32_sdwa v244, v236, v12 dst_sel:DWORD dst_unused:UNUSED_PAD src0_sel:WORD_0 src1_sel:DWORD
    v_xor_b32_sdwa v246, v236, v12 dst_sel:DWORD dst_unused:UNUSED_PAD src0_sel:WORD_1 src1_sel:DWORD
    v_xor_b32_sdwa v245, v236, v13 dst_sel:DWORD dst_unused:UNUSED_PAD src0_sel:WORD_0 src1_sel:DWORD
    v_xor_b32_sdwa v247, v236, v13 dst_sel:DWORD dst_unused:UNUSED_PAD src0_sel:WORD_1 src1_sel:DWORD
    v_cmp_ne_u32 vcc, 0, v239
    v_perm_b32 v228, v237, v237, v8
    v_perm_b32 v229, v237, v237, v9
    v_perm_b32 v230, v237, v237, v10
    v_perm_b32 v231, v237, v237, v11
    s_setprio 3
    s_waitcnt vmcnt(4)
    s_barrier
    s_call_b64 s[76:77], L_gpb
    ds_read_b64_tr_b16 v[72:73], v5 offset:0
    ds_read_b64_tr_b16 v[74:75], v5 offset:768
    ds_read_b64_tr_b16 v[76:77], v5 offset:32
    ds_read_b64_tr_b16 v[78:79], v5 offset:800
    ds_read_b64_tr_b16 v[80:81], v5 offset:64
    ds_read_b64_tr_b16 v[82:83], v5 offset:832
    s_branch L_pf1
.p2align 12
L_pf0:
    s_barrier
L_pf1:
    ds_read_b128 v[108:111], v240 offset:0
    ds_read_b128 v[112:115], v241 offset:0
    ds_read_b128 v[116:119], v242 offset:0
    ds_read_b128 v[120:123], v243 offset:0
    s_cmp_eq_u32 s30, 3
    s_cbranch_scc0 L_pf4
    s_waitcnt lgkmcnt(3)
    v_mfma_f32_16x16x32_bf16 v[24:27], v[72:75], v[108:111], v[24:27]
    ds_read_b64_tr_b16 v[84:85], v5 offset:6208
    ds_read_b64_tr_b16 v[86:87], v5 offset:6976
    v_mfma_f32_16x16x32_bf16 v[28:31], v[76:79], v[108:111], v[28:31]
    ds_read_b64_tr_b16 v[88:89], v5 offset:6240
    ds_read_b64_tr_b16 v[90:91], v5 offset:7008
    v_mfma_f32_16x16x32_bf16 v[32:35], v[80:83], v[108:111], v[32:35]
    ds_read_b64_tr_b16 v[92:93], v5 offset:6272
    ds_read_b64_tr_b16 v[94:95], v5 offset:7040
    s_waitcnt lgkmcnt(8)
    v_mfma_f32_16x16x32_bf16 v[44:47], v[80:83], v[112:115], v[44:47]
    ds_read_b128 v[124:127], v240 offset:64
    ds_read_b128 v[128:131], v241 offset:64
    v_mfma_f32_16x16x32_bf16 v[40:43], v[76:79], v[112:115], v[40:43]
    ds_read_b128 v[132:135], v242 offset:64
    ds_read_b128 v[140:143], v240 offset:128
    v_mfma_f32_16x16x32_bf16 v[36:39], v[72:75], v[112:115], v[36:39]
    ds_read_b128 v[144:147], v241 offset:128
    ds_read_b128 v[148:151], v242 offset:128
    s_waitcnt lgkmcnt(13)
    v_mfma_f32_16x16x32_bf16 v[48:51], v[72:75], v[116:119], v[48:51]
    ds_read_b64 v[236:237], v7 offset:128
    ds_read_b64_tr_b16 v[96:97], v5 offset:12416
    v_mfma_f32_16x16x32_bf16 v[52:55], v[76:79], v[116:119], v[52:55]
    ds_read_b64_tr_b16 v[98:99], v5 offset:13184
    ds_read_b64_tr_b16 v[100:101], v5 offset:12448
    v_mfma_f32_16x16x32_bf16 v[56:59], v[80:83], v[116:119], v[56:59]
    ds_read_b64_tr_b16 v[102:103], v5 offset:13216
    ds_read_b64_tr_b16 v[104:105], v5 offset:12480
    ds_read_b64_tr_b16 v[106:107], v5 offset:13248
    s_add_u32 s35, s35, 1
    s_and_b32 s36, s35, 3
    s_mul_i32 s36, s36, 18624
    v_add_u32 v7, 128, v7
    v_add_u32 v5, s36, v4
    s_waitcnt lgkmcnt(6)
    v_xor_b32 v236, v236, v15
    v_xor_b32 v237, v237, v15
    v_lshlrev_b32_sdwa v240, 4, v236 dst_sel:DWORD dst_unused:UNUSED_PAD src0_sel:DWORD src1_sel:WORD_0
    v_lshlrev_b32_sdwa v241, 4, v236 dst_sel:DWORD dst_unused:UNUSED_PAD src0_sel:DWORD src1_sel:WORD_1
    v_lshlrev_b32_sdwa v242, 4, v237 dst_sel:DWORD dst_unused:UNUSED_PAD src0_sel:DWORD src1_sel:WORD_0
    s_branch L_endp3
.p2align 3
L_topp3:
    s_barrier
L_bodyp3:
    s_setprio 2
.p2align 3
    v_mfma_f32_16x16x32_bf16 v[24:27], v[84:87], v[124:127], v[24:27]
    ds_read_b128 v[108:111], v240 offset:0
    v_mfma_f32_16x16x32_bf16 v[28:31], v[88:91], v[124:127], v[28:31]
    ds_read_b64_tr_b16 v[72:73], v5 offset:0
    v_mfma_f32_16x16x32_bf16 v[32:35], v[92:95], v[124:127], v[32:35]
    ds_read_b64_tr_b16 v[74:75], v5 offset:768
    v_mfma_f32_16x16x32_bf16 v[44:47], v[92:95], v[128:131], v[44:47]
    ds_read_b64_tr_b16 v[76:77], v5 offset:32
    v_mfma_f32_16x16x32_bf16 v[40:43], v[88:91], v[128:131], v[40:43]
    ds_read_b64_tr_b16 v[78:79], v5 offset:800
    v_mfma_f32_16x16x32_bf16 v[36:39], v[84:87], v[128:131], v[36:39]
    ds_read_b64_tr_b16 v[80:81], v5 offset:64
    v_mfma_f32_16x16x32_bf16 v[48:51], v[84:87], v[132:135], v[48:51]
    ds_read_b64_tr_b16 v[82:83], v5 offset:832
    v_mfma_f32_16x16x32_bf16 v[52:55], v[88:91], v[132:135], v[52:55]
    ds_read_b128 v[112:115], v241 offset:0
    v_mfma_f32_16x16x32_bf16 v[56:59], v[92:95], v[132:135], v[56:59]
    ds_read_b128 v[116:119], v242 offset:0
    s_setprio 1
.p2align 3
    v_mfma_f32_16x16x32_bf16 v[24:27], v[96:99], v[140:143], v[24:27]
    ds_read_b64_tr_b16 v[84:85], v5 offset:6208
    v_mfma_f32_16x16x32_bf16 v[28:31], v[100:103], v[140:143], v[28:31]
    ds_read_b64_tr_b16 v[86:87], v5 offset:6976
    v_mfma_f32_16x16x32_bf16 v[32:35], v[104:107], v[140:143], v[32:35]
    ds_read_b64_tr_b16 v[88:89], v5 offset:6240
    v_mfma_f32_16x16x32_bf16 v[44:47], v[104:107], v[144:147], v[44:47]
    ds_read_b128 v[140:143], v240 offset:128
    ds_read_b64_tr_b16 v[90:91], v5 offset:7008
    v_mfma_f32_16x16x32_bf16 v[40:43], v[100:103], v[144:147], v[40:43]
    ds_read_b64_tr_b16 v[92:93], v5 offset:6272
    v_mfma_f32_16x16x32_bf16 v[36:39], v[96:99], v[144:147], v[36:39]
    ds_read_b64_tr_b16 v[94:95], v5 offset:7040
    v_mfma_f32_16x16x32_bf16 v[48:51], v[96:99], v[148:151], v[48:51]
    ds_read_b128 v[144:147], v241 offset:128
    ds_read_b128 v[124:127], v240 offset:64
    v_mfma_f32_16x16x32_bf16 v[52:55], v[100:103], v[148:151], v[52:55]
    ds_read_b128 v[128:131], v241 offset:64
    v_mfma_f32_16x16x32_bf16 v[56:59], v[104:107], v[148:151], v[56:59]
    ds_read_b128 v[132:135], v242 offset:64
    ds_read_b128 v[148:151], v242 offset:128
L_midp3:
    s_waitcnt lgkmcnt(12)
    s_setprio 0
.p2align 3
    v_mfma_f32_16x16x32_bf16 v[24:27], v[72:75], v[108:111], v[24:27]
    ds_read_b64 v[236:237], v7 offset:128
    v_mfma_f32_16x16x32_bf16 v[28:31], v[76:79], v[108:111], v[28:31]
    ds_read_b64_tr_b16 v[96:97], v5 offset:12416
    v_mfma_f32_16x16x32_bf16 v[32:35], v[80:83], v[108:111], v[32:35]
    ds_read_b64_tr_b16 v[98:99], v5 offset:13184
    v_mfma_f32_16x16x32_bf16 v[44:47], v[80:83], v[112:115], v[44:47]
    ds_read_b64_tr_b16 v[100:101], v5 offset:12448
    v_mfma_f32_16x16x32_bf16 v[40:43], v[76:79], v[112:115], v[40:43]
    ds_read_b64_tr_b16 v[102:103], v5 offset:13216
    v_mfma_f32_16x16x32_bf16 v[36:39], v[72:75], v[112:115], v[36:39]
    s_add_u32 s35, s35, 1
    s_and_b32 s36, s35, 3
    v_mfma_f32_16x16x32_bf16 v[48:51], v[72:75], v[116:119], v[48:51]
    s_mul_i32 s36, s36, 18624
    ds_read_b64_tr_b16 v[104:105], v5 offset:12480
    v_mfma_f32_16x16x32_bf16 v[52:55], v[76:79], v[116:119], v[52:55]
    ds_read_b64_tr_b16 v[106:107], v5 offset:13248
    v_mfma_f32_16x16x32_bf16 v[56:59], v[80:83], v[116:119], v[56:59]
    v_add_u32 v7, 128, v7
    v_add_u32 v5, s36, v4
    s_waitcnt lgkmcnt(6)
    v_xor_b32 v236, v236, v15
    v_xor_b32 v237, v237, v15
    v_lshlrev_b32_sdwa v240, 4, v236 dst_sel:DWORD dst_unused:UNUSED_PAD src0_sel:DWORD src1_sel:WORD_0
    v_lshlrev_b32_sdwa v241, 4, v236 dst_sel:DWORD dst_unused:UNUSED_PAD src0_sel:DWORD src1_sel:WORD_1
    v_lshlrev_b32_sdwa v242, 4, v237 dst_sel:DWORD dst_unused:UNUSED_PAD src0_sel:DWORD src1_sel:WORD_0
L_endp3:
    s_bitcmp1_b32 s3, s35
    s_waitcnt vmcnt(0) lgkmcnt(0)
    s_cbranch_scc0 L_topp3
    s_bitcmp1_b32 s99, s35
    s_cbranch_scc1 L_spp3
    s_barrier
    s_bitcmp1_b32 s39, s35
    s_cbranch_scc0 L_spp3
    s_call_b64 s[76:77], L_dma
L_spp3:
    s_cmp_lg_u32 s35, 9
    s_cbranch_scc1 L_bodyp3
    s_branch L_last3
.p2align 3
L_topp4:
    s_barrier
L_bodyp4:
    s_setprio 2
.p2align 3
    v_mfma_f32_16x16x32_bf16 v[24:27], v[84:87], v[124:127], v[24:27]
    ds_read_b128 v[108:111], v240 offset:0
    v_mfma_f32_16x16x32_bf16 v[28:31], v[88:91], v[124:127], v[28:31]
    ds_read_b64_tr_b16 v[72:73], v5 offset:0
    v_mfma_f32_16x16x32_bf16 v[32:35], v[92:95], v[124:127], v[32:35]
    ds_read_b64_tr_b16 v[74:75], v5 offset:768
    v_mfma_f32_16x16x32_bf16 v[44:47], v[92:95], v[128:131], v[44:47]
    ds_read_b64_tr_b16 v[76:77], v5 offset:32
    v_mfma_f32_16x16x32_bf16 v[40:43], v[88:91], v[128:131], v[40:43]
    ds_read_b64_tr_b16 v[78:79], v5 offset:800
    v_mfma_f32_16x16x32_bf16 v[36:39], v[84:87], v[128:131], v[36:39]
    ds_read_b64_tr_b16 v[80:81], v5 offset:64
    v_mfma_f32_16x16x32_bf16 v[48:51], v[84:87], v[132:135], v[48:51]
    ds_read_b64_tr_b16 v[82:83], v5 offset:832
    v_mfma_f32_16x16x32_bf16 v[52:55], v[88:91], v[132:135], v[52:55]
    ds_read_b128 v[112:115], v241 offset:0
    v_mfma_f32_16x16x32_bf16 v[56:59], v[92:95], v[132:135], v[56:59]
    ds_read_b128 v[116:119], v242 offset:0
    v_mfma_f32_16x16x32_bf16 v[68:71], v[92:95], v[136:139], v[68:71]
    ds_read_b128 v[120:123], v243 offset:0
    v_mfma_f32_16x16x32_bf16 v[64:67], v[88:91], v[136:139], v[64:67]
    v_mfma_f32_16x16x32_bf16 v[60:63], v[84:87], v[136:139], v[60:63]
    s_setprio 1
.p2align 3
    v_mfma_f32_16x16x32_bf16 v[24:27], v[96:99], v[140:143], v[24:27]
    ds_read_b64_tr_b16 v[84:85], v5 offset:6208
    v_mfma_f32_16x16x32_bf16 v[28:31], v[100:103], v[140:143], v[28:31]
    ds_read_b64_tr_b16 v[86:87], v5 offset:6976
    v_mfma_f32_16x16x32_bf16 v[32:35], v[104:107], v[140:143], v[32:35]
    ds_read_b64_tr_b16 v[88:89], v5 offset:6240
    v_mfma_f32_16x16x32_bf16 v[44:47], v[104:107], v[144:147], v[44:47]
    ds_read_b128 v[140:143], v240 offset:128
    v_mfma_f32_16x16x32_bf16 v[40:43], v[100:103], v[144:147], v[40:43]
    ds_read_b64_tr_b16 v[90:91], v5 offset:7008
    v_mfma_f32_16x16x32_bf16 v[36:39], v[96:99], v[144:147], v[36:39]
    ds_read_b64_tr_b16 v[92:93], v5 offset:6272
    v_mfma_f32_16x16x32_bf16 v[48:51], v[96:99], v[148:151], v[48:51]
    ds_read_b128 v[144:147], v241 offset:128
    v_mfma_f32_16x16x32_bf16 v[52:55], v[100:103], v[148:151], v[52:55]
    ds_read_b64_tr_b16 v[94:95], v5 offset:7040
    v_mfma_f32_16x16x32_bf16 v[56:59], v[104:107], v[148:151], v[56:59]
    ds_read_b128 v[124:127], v240 offset:64
    v_mfma_f32_16x16x32_bf16 v[68:71], v[104:107], v[152:155], v[68:71]
    ds_read_b128 v[148:151], v242 offset:128
    ds_read_b128 v[128:131], v241 offset:64
    v_mfma_f32_16x16x32_bf16 v[64:67], v[100:103], v[152:155], v[64:67]
    ds_read_b128 v[132:135], v242 offset:64
    v_mfma_f32_16x16x32_bf16 v[60:63], v[96:99], v[152:155], v[60:63]
    ds_read_b128 v[136:139], v243 offset:64
    ds_read_b128 v[152:155], v243 offset:128
L_midp4:
    s_waitcnt lgkmcnt(14)
    s_setprio 0
.p2align 3
    v_mfma_f32_16x16x32_bf16 v[24:27], v[72:75], v[108:111], v[24:27]
    ds_read_b64 v[236:237], v7 offset:128
    v_mfma_f32_16x16x32_bf16 v[28:31], v[76:79], v[108:111], v[28:31]
    ds_read_b64_tr_b16 v[96:97], v5 offset:12416
    v_mfma_f32_16x16x32_bf16 v[32:35], v[80:83], v[108:111], v[32:35]
    ds_read_b64_tr_b16 v[98:99], v5 offset:13184
    v_mfma_f32_16x16x32_bf16 v[44:47], v[80:83], v[112:115], v[44:47]
    ds_read_b64_tr_b16 v[100:101], v5 offset:12448
    v_mfma_f32_16x16x32_bf16 v[40:43], v[76:79], v[112:115], v[40:43]
    ds_read_b64_tr_b16 v[102:103], v5 offset:13216
    v_mfma_f32_16x16x32_bf16 v[36:39], v[72:75], v[112:115], v[36:39]
    s_add_u32 s35, s35, 1
    s_and_b32 s36, s35, 3
    v_mfma_f32_16x16x32_bf16 v[48:51], v[72:75], v[116:119], v[48:51]
    s_mul_i32 s36, s36, 18624
    ds_read_b64_tr_b16 v[104:105], v5 offset:12480
    v_mfma_f32_16x16x32_bf16 v[52:55], v[76:79], v[116:119], v[52:55]
    ds_read_b64_tr_b16 v[106:107], v5 offset:13248
    v_mfma_f32_16x16x32_bf16 v[56:59], v[80:83], v[116:119], v[56:59]
    v_add_u32 v7, 128, v7
    v_add_u32 v5, s36, v4
    v_mfma_f32_16x16x32_bf16 v[68:71], v[80:83], v[120:123], v[68:71]
    s_waitcnt lgkmcnt(6)
    v_xor_b32 v236, v236, v15
    v_mfma_f32_16x16x32_bf16 v[64:67], v[76:79], v[120:123], v[64:67]
    v_xor_b32 v237, v237, v15
    v_lshlrev_b32_sdwa v240, 4, v236 dst_sel:DWORD dst_unused:UNUSED_PAD src0_sel:DWORD src1_sel:WORD_0
    v_mfma_f32_16x16x32_bf16 v[60:63], v[72:75], v[120:123], v[60:63]
    v_lshlrev_b32_sdwa v241, 4, v236 dst_sel:DWORD dst_unused:UNUSED_PAD src0_sel:DWORD src1_sel:WORD_1
    v_lshlrev_b32_sdwa v242, 4, v237 dst_sel:DWORD dst_unused:UNUSED_PAD src0_sel:DWORD src1_sel:WORD_0
    v_lshlrev_b32_sdwa v243, 4, v237 dst_sel:DWORD dst_unused:UNUSED_PAD src0_sel:DWORD src1_sel:WORD_1
L_endp4:
    s_bitcmp1_b32 s3, s35
    s_waitcnt vmcnt(0) lgkmcnt(0)
    s_cbranch_scc0 L_topp4
    s_bitcmp1_b32 s99, s35
    s_cbranch_scc1 L_spp4
    s_barrier
    s_bitcmp1_b32 s39, s35
    s_cbranch_scc0 L_spp4
    s_call_b64 s[76:77], L_dma
L_spp4:
    s_cmp_lg_u32 s35, 9
    s_cbranch_scc1 L_bodyp4
    s_branch L_last4
L_pf4:
    s_cmp_eq_u32 s30, 4
    s_cbranch_scc0 L_pf2
    s_waitcnt lgkmcnt(3)
    v_mfma_f32_16x16x32_bf16 v[24:27], v[72:75], v[108:111], v[24:27]
    ds_read_b64_tr_b16 v[84:85], v5 offset:6208
    ds_read_b64_tr_b16 v[86:87], v5 offset:6976
    v_mfma_f32_16x16x32_bf16 v[28:31], v[76:79], v[108:111], v[28:31]
    ds_read_b64_tr_b16 v[88:89], v5 offset:6240
    ds_read_b64_tr_b16 v[90:91], v5 offset:7008
    v_mfma_f32_16x16x32_bf16 v[32:35], v[80:83], v[108:111], v[32:35]
    ds_read_b64_tr_b16 v[92:93], v5 offset:6272
    ds_read_b64_tr_b16 v[94:95], v5 offset:7040
    s_waitcnt lgkmcnt(8)
    v_mfma_f32_16x16x32_bf16 v[44:47], v[80:83], v[112:115], v[44:47]
    ds_read_b128 v[124:127], v240 offset:64
    ds_read_b128 v[128:131], v241 offset:64
    v_mfma_f32_16x16x32_bf16 v[40:43], v[76:79], v[112:115], v[40:43]
    ds_read_b128 v[132:135], v242 offset:64
    ds_read_b128 v[136:139], v243 offset:64
    v_mfma_f32_16x16x32_bf16 v[36:39], v[72:75], v[112:115], v[36:39]
    ds_read_b128 v[140:143], v240 offset:128
    ds_read_b128 v[144:147], v241 offset:128
    s_waitcnt lgkmcnt(13)
    v_mfma_f32_16x16x32_bf16 v[48:51], v[72:75], v[116:119], v[48:51]
    ds_read_b128 v[148:151], v242 offset:128
    ds_read_b128 v[152:155], v243 offset:128
    v_mfma_f32_16x16x32_bf16 v[52:55], v[76:79], v[116:119], v[52:55]
    ds_read_b64 v[236:237], v7 offset:128
    ds_read_b64_tr_b16 v[96:97], v5 offset:12416
    v_mfma_f32_16x16x32_bf16 v[56:59], v[80:83], v[116:119], v[56:59]
    ds_read_b64_tr_b16 v[98:99], v5 offset:13184
    ds_read_b64_tr_b16 v[100:101], v5 offset:12448
    s_waitcnt lgkmcnt(15)
    v_mfma_f32_16x16x32_bf16 v[68:71], v[80:83], v[120:123], v[68:71]
    ds_read_b64_tr_b16 v[102:103], v5 offset:13216
    ds_read_b64_tr_b16 v[104:105], v5 offset:12480
    v_mfma_f32_16x16x32_bf16 v[64:67], v[76:79], v[120:123], v[64:67]
    ds_read_b64_tr_b16 v[106:107], v5 offset:13248
    v_mfma_f32_16x16x32_bf16 v[60:63], v[72:75], v[120:123], v[60:63]
    s_add_u32 s35, s35, 1
    s_and_b32 s36, s35, 3
    s_mul_i32 s36, s36, 18624
    v_add_u32 v7, 128, v7
    v_add_u32 v5, s36, v4
    s_waitcnt lgkmcnt(6)
    v_xor_b32 v236, v236, v15
    v_xor_b32 v237, v237, v15
    v_lshlrev_b32_sdwa v240, 4, v236 dst_sel:DWORD dst_unused:UNUSED_PAD src0_sel:DWORD src1_sel:WORD_0
    v_lshlrev_b32_sdwa v241, 4, v236 dst_sel:DWORD dst_unused:UNUSED_PAD src0_sel:DWORD src1_sel:WORD_1
    v_lshlrev_b32_sdwa v242, 4, v237 dst_sel:DWORD dst_unused:UNUSED_PAD src0_sel:DWORD src1_sel:WORD_0
    v_lshlrev_b32_sdwa v243, 4, v237 dst_sel:DWORD dst_unused:UNUSED_PAD src0_sel:DWORD src1_sel:WORD_1
    s_branch L_endp4
L_pf2:
    s_cmp_eq_u32 s30, 2
    s_cbranch_scc0 L_pf5
    s_waitcnt lgkmcnt(3)
    v_mfma_f32_16x16x32_bf16 v[24:27], v[72:75], v[108:111], v[24:27]
    ds_read_b64_tr_b16 v[84:85], v5 offset:6208
    ds_read_b64_tr_b16 v[86:87], v5 offset:6976
    v_mfma_f32_16x16x32_bf16 v[28:31], v[76:79], v[108:111], v[28:31]
    ds_read_b64_tr_b16 v[88:89], v5 offset:6240
    ds_read_b64_tr_b16 v[90:91], v5 offset:7008
    v_mfma_f32_16x16x32_bf16 v[32:35], v[80:83], v[108:111], v[32:35]
    ds_read_b64_tr_b16 v[92:93], v5 offset:6272
    ds_read_b64_tr_b16 v[94:95], v5 offset:7040
    s_waitcnt lgkmcnt(8)
    v_mfma_f32_16x16x32_bf16 v[44:47], v[80:83], v[112:115], v[44:47]
    ds_read_b128 v[124:127], v240 offset:64
    ds_read_b128 v[128:131], v241 offset:64
    v_mfma_f32_16x16x32_bf16 v[40:43], v[76:79], v[112:115], v[40:43]
    ds_read_b128 v[140:143], v240 offset:128
    ds_read_b128 v[144:147], v241 offset:128
    v_mfma_f32_16x16x32_bf16 v[36:39], v[72:75], v[112:115], v[36:39]
    ds_read_b64 v[236:237], v7 offset:128
    ds_read_b64_tr_b16 v[96:97], v5 offset:12416
    ds_read_b64_tr_b16 v[98:99], v5 offset:13184
    ds_read_b64_tr_b16 v[100:101], v5 offset:12448
    ds_read_b64_tr_b16 v[102:103], v5 offset:13216
    ds_read_b64_tr_b16 v[104:105], v5 offset:12480
    ds_read_b64_tr_b16 v[106:107], v5 offset:13248
    s_add_u32 s35, s35, 1
    s_and_b32 s36, s35, 3
    s_mul_i32 s36, s36, 18624
    v_add_u32 v7, 128, v7
    v_add_u32 v5, s36, v4
    s_waitcnt lgkmcnt(6)
    v_xor_b32 v236, v236, v15
    v_lshlrev_b32_sdwa v240, 4, v236 dst_sel:DWORD dst_unused:UNUSED_PAD src0_sel:DWORD src1_sel:WORD_0
    v_lshlrev_b32_sdwa v241, 4, v236 dst_sel:DWORD dst_unused:UNUSED_PAD src0_sel:DWORD src1_sel:WORD_1
    s_branch L_endp2
L_pf5:
    s_waitcnt lgkmcnt(3)
    v_mfma_f32_16x16x32_bf16 v[24:27], v[72:75], v[108:111], v[24:27]
    ds_read_b64_tr_b16 v[84:85], v5 offset:6208
    ds_read_b64_tr_b16 v[86:87], v5 offset:6976
    v_mfma_f32_16x16x32_bf16 v[28:31], v[76:79], v[108:111], v[28:31]
    ds_read_b64_tr_b16 v[88:89], v5 offset:6240
    ds_read_b64_tr_b16 v[90:91], v5 offset:7008
    v_mfma_f32_16x16x32_bf16 v[32:35], v[80:83], v[108:111], v[32:35]
    ds_read_b64_tr_b16 v[92:93], v5 offset:6272
    ds_read_b64_tr_b16 v[94:95], v5 offset:7040
    ds_read_b128 v[124:127], v240 offset:64
    ds_read_b128 v[140:143], v240 offset:128
    ds_read_b64 v[236:237], v7 offset:128
    ds_read_b64_tr_b16 v[96:97], v5 offset:12416
    ds_read_b64_tr_b16 v[98:99], v5 offset:13184
    ds_read_b64_tr_b16 v[100:101], v5 offset:12448
    ds_read_b64_tr_b16 v[102:103], v5 offset:13216
    ds_read_b64_tr_b16 v[104:105], v5 offset:12480
    ds_read_b64_tr_b16 v[106:107], v5 offset:13248
    s_add_u32 s35, s35, 1
    s_and_b32 s36, s35, 3
    s_mul_i32 s36, s36, 18624
    v_add_u32 v7, 128, v7
    v_add_u32 v5, s36, v4
    s_waitcnt lgkmcnt(6)
    v_xor_b32 v236, v236, v15
    v_lshlrev_b32_sdwa v240, 4, v236 dst_sel:DWORD dst_unused:UNUSED_PAD src0_sel:DWORD src1_sel:WORD_0
    s_branch L_endp1
.p2align 3
L_topp2:
    s_barrier
L_bodyp2:
    s_setprio 2
.p2align 3
    v_mfma_f32_16x16x32_bf16 v[24:27], v[84:87], v[124:127], v[24:27]
    ds_read_b128 v[108:111], v240 offset:0
    v_mfma_f32_16x16x32_bf16 v[28:31], v[88:91], v[124:127], v[28:31]
    ds_read_b64_tr_b16 v[72:73], v5 offset:0
    v_mfma_f32_16x16x32_bf16 v[32:35], v[92:95], v[124:127], v[32:35]
    ds_read_b64_tr_b16 v[74:75], v5 offset:768
    v_mfma_f32_16x16x32_bf16 v[44:47], v[92:95], v[128:131], v[44:47]
    ds_read_b64_tr_b16 v[76:77], v5 offset:32
    v_mfma_f32_16x16x32_bf16 v[40:43], v[88:91], v[128:131], v[40:43]
    ds_read_b64_tr_b16 v[78:79], v5 offset:800
    v_mfma_f32_16x16x32_bf16 v[36:39], v[84:87], v[128:131], v[36:39]
    ds_read_b64_tr_b16 v[80:81], v5 offset:64
    ds_read_b64_tr_b16 v[82:83], v5 offset:832
    ds_read_b128 v[112:115], v241 offset:0
    s_setprio 1
.p2align 3
    v_mfma_f32_16x16x32_bf16 v[24:27], v[96:99], v[140:143], v[24:27]
    ds_read_b64_tr_b16 v[84:85], v5 offset:6208
    ds_read_b64_tr_b16 v[86:87], v5 offset:6976
    v_mfma_f32_16x16x32_bf16 v[28:31], v[100:103], v[140:143], v[28:31]
    ds_read_b64_tr_b16 v[88:89], v5 offset:6240
    ds_read_b64_tr_b16 v[90:91], v5 offset:7008
    v_mfma_f32_16x16x32_bf16 v[32:35], v[104:107], v[140:143], v[32:35]
    ds_read_b64_tr_b16 v[92:93], v5 offset:6272
    ds_read_b64_tr_b16 v[94:95], v5 offset:7040
    v_mfma_f32_16x16x32_bf16 v[44:47], v[104:107], v[144:147], v[44:47]
    ds_read_b128 v[140:143], v240 offset:128
    ds_read_b128 v[124:127], v240 offset:64
    v_mfma_f32_16x16x32_bf16 v[40:43], v[100:103], v[144:147], v[40:43]
    ds_read_b128 v[128:131], v241 offset:64
    v_mfma_f32_16x16x32_bf16 v[36:39], v[96:99], v[144:147], v[36:39]
    ds_read_b128 v[144:147], v241 offset:128
L_midp2:
    s_waitcnt lgkmcnt(10)
    s_setprio 0
.p2align 3
    v_mfma_f32_16x16x32_bf16 v[24:27], v[72:75], v[108:111], v[24:27]
    ds_read_b64 v[236:237], v7 offset:128
    v_mfma_f32_16x16x32_bf16 v[28:31], v[76:79], v[108:111], v[28:31]
    ds_read_b64_tr_b16 v[96:97], v5 offset:12416
    v_mfma_f32_16x16x32_bf16 v[32:35], v[80:83], v[108:111], v[32:35]
    ds_read_b64_tr_b16 v[98:99], v5 offset:13184
    v_mfma_f32_16x16x32_bf16 v[44:47], v[80:83], v[112:115], v[44:47]
    ds_read_b64_tr_b16 v[100:101], v5 offset:12448
    v_mfma_f32_16x16x32_bf16 v[40:43], v[76:79], v[112:115], v[40:43]
    ds_read_b64_tr_b16 v[102:103], v5 offset:13216
    v_mfma_f32_16x16x32_bf16 v[36:39], v[72:75], v[112:115], v[36:39]
    s_add_u32 s35, s35, 1
    s_and_b32 s36, s35, 3
    s_mul_i32 s36, s36, 18624
    ds_read_b64_tr_b16 v[104:105], v5 offset:12480
    ds_read_b64_tr_b16 v[106:107], v5 offset:13248
    v_add_u32 v7, 128, v7
    v_add_u32 v5, s36, v4
    s_waitcnt lgkmcnt(6)
    v_xor_b32 v236, v236, v15
    v_lshlrev_b32_sdwa v240, 4, v236 dst_sel:DWORD dst_unused:UNUSED_PAD src0_sel:DWORD src1_sel:WORD_0
    v_lshlrev_b32_sdwa v241, 4, v236 dst_sel:DWORD dst_unused:UNUSED_PAD src0_sel:DWORD src1_sel:WORD_1
L_endp2:
    s_bitcmp1_b32 s3, s35
    s_waitcnt vmcnt(0) lgkmcnt(0)
    s_cbranch_scc0 L_topp2
    s_bitcmp1_b32 s99, s35
    s_cbranch_scc1 L_spp2
    s_barrier
    s_bitcmp1_b32 s39, s35
    s_cbranch_scc0 L_spp2
    s_call_b64 s[76:77], L_dma
L_spp2:
    s_cmp_lg_u32 s35, 9
    s_cbranch_scc1 L_bodyp2
    s_branch L_last2
.p2align 3
L_topp1:
    s_barrier
L_bodyp1:
    s_setprio 2
.p2align 3
    v_mfma_f32_16x16x32_bf16 v[24:27], v[84:87], v[124:127], v[24:27]
    ds_read_b128 v[108:111], v240 offset:0
    v_mfma_f32_16x16x32_bf16 v[28:31], v[88:91], v[124:127], v[28:31]
    ds_read_b64_tr_b16 v[72:73], v5 offset:0
    v_mfma_f32_16x16x32_bf16 v[32:35], v[92:95], v[124:127], v[32:35]
    ds_read_b64_tr_b16 v[74:75], v5 offset:768
    ds_read_b64_tr_b16 v[76:77], v5 offset:32
    ds_read_b64_tr_b16 v[78:79], v5 offset:800
    ds_read_b64_tr_b16 v[80:81], v5 offset:64
    ds_read_b64_tr_b16 v[82:83], v5 offset:832
    s_setprio 1
.p2align 3
    v_mfma_f32_16x16x32_bf16 v[24:27], v[96:99], v[140:143], v[24:27]
    ds_read_b64_tr_b16 v[84:85], v5 offset:6208
    ds_read_b64_tr_b16 v[86:87], v5 offset:6976
    ds_read_b64_tr_b16 v[88:89], v5 offset:6240
    v_mfma_f32_16x16x32_bf16 v[28:31], v[100:103], v[140:143], v[28:31]
    ds_read_b64_tr_b16 v[90:91], v5 offset:7008
    ds_read_b64_tr_b16 v[92:93], v5 offset:6272
    ds_read_b64_tr_b16 v[94:95], v5 offset:7040
    v_mfma_f32_16x16x32_bf16 v[32:35], v[104:107], v[140:143], v[32:35]
    ds_read_b128 v[124:127], v240 offset:64
    ds_read_b128 v[140:143], v240 offset:128
L_midp1:
    s_waitcnt lgkmcnt(8)
    s_setprio 0
.p2align 3
    v_mfma_f32_16x16x32_bf16 v[24:27], v[72:75], v[108:111], v[24:27]
    ds_read_b64 v[236:237], v7 offset:128
    v_mfma_f32_16x16x32_bf16 v[28:31], v[76:79], v[108:111], v[28:31]
    ds_read_b64_tr_b16 v[96:97], v5 offset:12416
    v_mfma_f32_16x16x32_bf16 v[32:35], v[80:83], v[108:111], v[32:35]
    ds_read_b64_tr_b16 v[98:99], v5 offset:13184
    ds_read_b64_tr_b16 v[100:101], v5 offset:12448
    ds_read_b64_tr_b16 v[102:103], v5 offset:13216
    s_add_u32 s35, s35, 1
    s_and_b32 s36, s35, 3
    s_mul_i32 s36, s36, 18624
    ds_read_b64_tr_b16 v[104:105], v5 offset:12480
    ds_read_b64_tr_b16 v[106:107], v5 offset:13248
    v_add_u32 v7, 128, v7
    v_add_u32 v5, s36, v4
    s_waitcnt lgkmcnt(6)
    v_xor_b32 v236, v236, v15
    v_lshlrev_b32_sdwa v240, 4, v236 dst_sel:DWORD dst_unused:UNUSED_PAD src0_sel:DWORD src1_sel:WORD_0
L_endp1:
    s_bitcmp1_b32 s3, s35
    s_waitcnt vmcnt(0) lgkmcnt(0)
    s_cbranch_scc0 L_topp1
    s_bitcmp1_b32 s99, s35
    s_cbranch_scc1 L_spp1
    s_barrier
    s_bitcmp1_b32 s39, s35
    s_cbranch_scc0 L_spp1
    s_call_b64 s[76:77], L_dma
L_spp1:
    s_cmp_lg_u32 s35, 9
    s_cbranch_scc1 L_bodyp1
    s_branch L_last1
.p2align 12
L_startD:
    s_waitcnt lgkmcnt(0)
    s_bfe_u32 s75, s23, 0x1001e
    s_bitset0_b32 s23, 30
    s_lshr_b32 s96, s22, s30
    s_and_b32 s32, s23, 0xff
    s_and_b32 s31, s96, 15
    s_bfe_u32 s30, s96, 0x30004
    s_bfe_u32 s33, s23, 0x80008
    s_add_u32 s0, s33, s31
    s_mul_i32 s3, s0, 224
    s_add_u32 s3, s3, s32
    s_mul_i32 s3, s3, 36
    s_mov_b32 s74, s0
    s_lshr_b32 s26, s28, 2
    s_lshl_b32 s26, s26, 1
    s_add_u32 s26, s26, s29
    s_mul_i32 s96, s26, 8064
    s_add_u32 s96, s96, s3
    buffer_load_dwordx3 v[204:206], v228, s[8:11], s96 offen
    s_sub_u32 s34, s32, 2
    s_bfe_u32 s100, s23, 0x10011
    s_lshl_b32 s101, s100, 1
    s_sub_u32 s101, 19, s101
    s_bfe_u32 s96, s23, 0x10010
    s_sub_u32 s33, s33, s96
    s_sub_u32 s33, s33, 1
    s_movk_i32 s97, 223
    v_add_u32 v74, s34, v76
    v_subrev_u32 v75, s100, v76
    v_med3_i32 v74, v74, 0, s97
    v_cmp_ge_u32 vcc, s101, v75
    v_mul_u32_u24 v74, 192, v74
    s_and_b64 s[92:93], s[92:93], vcc
    v_add_u32 v20, v74, v20
    s_cmp_lt_u32 s28, 4
    s_cbranch_scc1 L_startAD
    s_max_i32 s96, s20, 0
    s_add_u32 m0, s94, 0
    s_mov_b64 exec, s[92:93]
    s_add_u32 s20, s20, 43008
    buffer_load_dwordx4 v20, s[4:7], s96 offen lds
    s_max_i32 s96, s20, 0
    s_addk_i32 m0, 3840
    s_add_u32 s20, s20, 43008
    buffer_load_dwordx4 v20, s[4:7], s96 offen lds
    s_min_i32 s96, s20, s21
    s_addk_i32 m0, 3840
    s_add_u32 s20, s20, 43008
    buffer_load_dwordx4 v20, s[4:7], s96 offen lds
    s_min_i32 s96, s20, s21
    s_addk_i32 m0, 3840
    s_add_u32 s20, s20, 43008
    buffer_load_dwordx4 v20, s[4:7], s96 offen lds
    s_min_i32 s96, s20, s21
    s_addk_i32 m0, 3840
    s_add_u32 s20, s20, 43008
    buffer_load_dwordx4 v20, s[4:7], s96 offen lds
    s_min_i32 s96, s20, s21
    s_addk_i32 m0, 3840
    s_add_u32 s20, s20, 43008
    buffer_load_dwordx4 v20, s[4:7], s96 offen lds
    s_min_i32 s96, s20, s21
    s_addk_i32 m0, 3840
    s_add_u32 s20, s20, 43008
    buffer_load_dwordx4 v20, s[4:7], s96 offen lds
    s_min_i32 s96, s20, s21
    s_addk_i32 m0, 3840
    s_add_u32 s20, s20, 43008
    buffer_load_dwordx4 v20, s[4:7], s96 offen lds
    s_mov_b64 exec, -1
    s_mov_b32 s35, 0
    s_mov_b32 s37, 0
    s_mov_b32 s38, 0
    v_mov_b32 v108, 0
    v_mov_b32 v109, 0
    v_mov_b32 v110, 0
    v_mov_b32 v111, 0
    s_cmp_lt_u32 s28, 4
    s_cselect_b32 s39, 0, 0x3e
    s_cselect_b32 s99, 0, 768
    s_mov_b32 s95, 73728
    s_lshl_b32 s96, s28, 2
    s_add_u32 s96, s96, 163776
    v_mov_b32 v254, s96
    v_mfma_f32_32x32x16_bf16 v[24:39], v[108:111], v[108:111], 0
    v_mfma_f32_32x32x16_bf16 v[40:55], v[108:111], v[108:111], 0
    v_mfma_f32_32x32x16_bf16 v[56:71], v[108:111], v[108:111], 0
    v_xor_b32 v255, 4, v254
    ds_write_b32 v254, v108
    s_waitcnt vmcnt(9)
    s_sub_u32 s96, s0, s33
    s_mul_i32 s97, s29, 96
    s_sub_u32 s96, s96, 1
    s_add_u32 s98, s97, 89280
    s_mul_i32 s96, s96, 3840
    v_add_u32_sdwa v4, s98, v240 dst_sel:DWORD dst_unused:UNUSED_PAD src0_sel:DWORD src1_sel:WORD_0
    v_add_u32_sdwa v5, s98, v240 dst_sel:DWORD dst_unused:UNUSED_PAD src0_sel:DWORD src1_sel:WORD_0
    s_bfe_u32 s98, s23, 0x40014
    v_add_u32_sdwa v1, s96, v240 dst_sel:DWORD dst_unused:UNUSED_PAD src0_sel:DWORD src1_sel:WORD_1
    v_add_u32_sdwa v2, s96, v241 dst_sel:DWORD dst_unused:UNUSED_PAD src0_sel:DWORD src1_sel:WORD_0
    v_add_u32_sdwa v3, s96, v241 dst_sel:DWORD dst_unused:UNUSED_PAD src0_sel:DWORD src1_sel:WORD_1
    s_mul_i32 s98, s98, 3840
    s_sub_u32 s98, 107904, s98
    s_cmp_lt_u32 s28, 4
    s_cselect_b32 s98, 0, s98
    s_mul_i32 s96, s31, 3840
    s_add_u32 s96, s96, s98
    s_add_u32 s97, s97, s96
    v_add_u32_sdwa v21, s97, v242 dst_sel:DWORD dst_unused:UNUSED_PAD src0_sel:DWORD src1_sel:WORD_0
    s_mul_i32 s97, s29, 3840
    s_add_u32 s97, s97, s96
    v_add_u32_sdwa v248, s97, v242 dst_sel:DWORD dst_unused:UNUSED_PAD src0_sel:DWORD src1_sel:WORD_1
    v_add_u32_sdwa v249, s97, v243 dst_sel:DWORD dst_unused:UNUSED_PAD src0_sel:DWORD src1_sel:WORD_0
    v_add_u32_sdwa v250, s97, v243 dst_sel:DWORD dst_unused:UNUSED_PAD src0_sel:DWORD src1_sel:WORD_1
    s_waitcnt vmcnt(8)
    s_call_b64 s[76:77], L_dsetup
    s_waitcnt vmcnt(0)
    s_branch L_dfirst
L_startAD:
    s_add_u32 s20, s20, 344064
    s_add_u32 m0, s94, 30720
    s_mov_b64 exec, s[92:93]
    s_cmp_lt_u32 s23, 150994944
    s_cbranch_scc1 L_ad1
    s_min_i32 s96, s20, s21
    s_add_u32 s20, s20, 43008
    buffer_load_dwordx4 v20, s[4:7], s96 offen lds
    s_addk_i32 m0, 3840
    s_cmp_lt_u32 s23, 167772160
    s_cbranch_scc1 L_ad1
    s_min_i32 s96, s20, s21
    s_add_u32 s20, s20, 43008
    buffer_load_dwordx4 v20, s[4:7], s96 offen lds
    s_addk_i32 m0, 3840
    s_cmp_lt_u32 s23, 184549376
    s_cbranch_scc1 L_ad1
    s_min_i32 s96, s20, s21
    s_add_u32 s20, s20, 43008
    buffer_load_dwordx4 v20, s[4:7], s96 offen lds
    s_addk_i32 m0, 3840
    s_cmp_lt_u32 s23, 201326592
    s_cbranch_scc1 L_ad1
    s_min_i32 s96, s20, s21
    s_add_u32 s20, s20, 43008
    buffer_load_dwordx4 v20, s[4:7], s96 offen lds
    s_addk_i32 m0, 3840
L_ad1:
    s_mov_b64 exec, -1
    s_lshr_b32 s96, s2, 3
    s_and_b32 s96, s96, 31
    s_lshl_b32 s96, s96, 2
    s_add_u32 s96, s96, s28
    s_mul_i32 s96, s96, 1152
    s_add_u32 s96, s96, 18432
    v_lshlrev_b32 v23, 3, v16
    s_mov_b64 exec, 0x1ff
    buffer_load_dword v23, v23, s[12:15], s96 offen
    s_mov_b64 exec, -1
    s_mov_b32 s35, 0
    s_mov_b32 s37, 0
    s_mov_b32 s38, 0
    v_mov_b32 v108, 0
    v_mov_b32 v109, 0
    v_mov_b32 v110, 0
    v_mov_b32 v111, 0
    s_cmp_lt_u32 s28, 4
    s_cselect_b32 s39, 0, 0x3e
    s_cselect_b32 s99, 0, 768
    s_mov_b32 s95, 73728
    s_lshl_b32 s96, s28, 2
    s_add_u32 s96, s96, 163776
    v_mov_b32 v254, s96
    v_mfma_f32_32x32x16_bf16 v[24:39], v[108:111], v[108:111], 0
    v_mfma_f32_32x32x16_bf16 v[40:55], v[108:111], v[108:111], 0
    v_mfma_f32_32x32x16_bf16 v[56:71], v[108:111], v[108:111], 0
    v_xor_b32 v255, 4, v254
    ds_write_b32 v254, v108
    s_cmp_lt_u32 s23, 167772160
    s_cbranch_scc1 L_ad2
    s_cmp_lt_u32 s23, 201326592
    s_cbranch_scc1 L_ad4
    s_waitcnt vmcnt(5)
    s_branch L_ad3
L_ad2:
    s_waitcnt vmcnt(1)
L_ad4:
    s_waitcnt vmcnt(3)
L_ad3:
    s_sub_u32 s96, s0, s33
    s_mul_i32 s97, s29, 96
    s_sub_u32 s96, s96, 1
    s_add_u32 s98, s97, 89280
    s_mul_i32 s96, s96, 3840
    v_add_u32_sdwa v4, s98, v240 dst_sel:DWORD dst_unused:UNUSED_PAD src0_sel:DWORD src1_sel:WORD_0
    v_add_u32_sdwa v5, s98, v240 dst_sel:DWORD dst_unused:UNUSED_PAD src0_sel:DWORD src1_sel:WORD_0
    s_bfe_u32 s98, s23, 0x40014
    v_add_u32_sdwa v1, s96, v240 dst_sel:DWORD dst_unused:UNUSED_PAD src0_sel:DWORD src1_sel:WORD_1
    v_add_u32_sdwa v2, s96, v241 dst_sel:DWORD dst_unused:UNUSED_PAD src0_sel:DWORD src1_sel:WORD_0
    v_add_u32_sdwa v3, s96, v241 dst_sel:DWORD dst_unused:UNUSED_PAD src0_sel:DWORD src1_sel:WORD_1
    s_mul_i32 s98, s98, 3840
    s_sub_u32 s98, 107904, s98
    s_cmp_lt_u32 s28, 4
    s_cselect_b32 s98, 0, s98
    s_mul_i32 s96, s31, 3840
    s_add_u32 s96, s96, s98
    s_add_u32 s97, s97, s96
    v_add_u32_sdwa v21, s97, v242 dst_sel:DWORD dst_unused:UNUSED_PAD src0_sel:DWORD src1_sel:WORD_0
    s_mul_i32 s97, s29, 3840
    s_add_u32 s97, s97, s96
    v_add_u32_sdwa v248, s97, v242 dst_sel:DWORD dst_unused:UNUSED_PAD src0_sel:DWORD src1_sel:WORD_1
    v_add_u32_sdwa v249, s97, v243 dst_sel:DWORD dst_unused:UNUSED_PAD src0_sel:DWORD src1_sel:WORD_0
    v_add_u32_sdwa v250, s97, v243 dst_sel:DWORD dst_unused:UNUSED_PAD src0_sel:DWORD src1_sel:WORD_1
    s_call_b64 s[76:77], L_dsetup
    s_add_u32 m0, s88, 0
    s_mov_b32 s96, 0
    buffer_load_dwordx4 v19, s[12:15], s96 offen lds
    s_add_u32 m0, s89, 4128
    s_mov_b32 s96, 4096
    buffer_load_dwordx4 v19, s[12:15], s96 offen lds
    s_add_u32 m0, s90, 8256
    s_mov_b32 s96, 8192
    buffer_load_dwordx4 v19, s[12:15], s96 offen lds
    s_add_u32 m0, s88, 12416
    s_mov_b32 s96, 12288
    buffer_load_dwordx4 v19, s[12:15], s96 offen lds
    s_add_u32 m0, s89, 16544
    s_mov_b32 s96, 16384
    buffer_load_dwordx4 v19, s[12:15], s96 offen lds
    s_waitcnt vmcnt(5)
    s_branch L_dfirst
L_dsetup:
    v_cvt_f32_u32 v222, s32
    v_cvt_f32_u32 v220, s74
    v_bfe_u32 v238, v226, 8, 8
    v_add_f32 v221, v222, v224
    v_add_f32 v220, v220, v225
    v_and_b32 v251, 0xffff, v235
    v_add_f32 v222, 1.0, v221
    v_add_f32 v223, 2.0, v221
    v_mov_b32 v236, 0xf000f00
    s_mov_b32 s91, 0x435f435f
    s_mov_b32 s97, 0
    s_lshr_b64 s[70:71], s[24:25], s97
    s_bfe_u32 s69, s70, 0x5000b
    s_and_b32 s68, s70, 0x7ff
    s_lshl_b32 s69, s69, 2
    s_lshl_b32 s68, s68, 6
    s_mov_b32 s25, s68
    s_bfe_u32 s66, s28, 0x10001
    s_mul_i32 s66, s66, 4608
    s_add_u32 s66, s66, 65536
    s_add_u32 s96, s26, s31
    s_mul_i32 s67, s96, 1792
    s_add_u32 s67, s67, 74752
    s_mul_i32 s96, s96, s69
    s_mul_i32 s96, s96, 192
    s_add_u32 s68, s96, s25
    s_mov_b32 s42, s26
    s_bfe_u32 s96, s23, 0x50018
    s_sub_u32 s96, s96, 1
    v_mov_b32 v229, 0
    v_mov_b32 v230, s96
    v_lshrrev_b32 v240, 16, v235
    s_mov_b32 s40, 1
    s_cmp_lt_u32 s26, s30
    s_cbranch_scc1 L_tables1
    s_mul_i32 s96, s26, 1152
    s_add_u32 s96, s96, s66
    v_add_u32 v231, s96, v227
    v_mov_b32 v72, 0x1800180
    v_mov_b32 v73, 0
    s_mov_b32 exec_hi, 0xffff
    ds_write_b64 v231, v[72:73] offset:0
    ds_write_b64 v231, v[72:73] offset:128
    ds_write_b64 v231, v[72:73] offset:256
    s_mov_b32 s40, 0
    s_branch L_tables1
L_tables:
    s_mov_b32 s42, 0
L_tables1:
    s_mov_b32 exec_hi, 0xffff
    s_mov_b32 s43, 0
    s_mov_b32 s27, 0
L_tl:
    s_bitcmp1_b32 s40, 0
    s_cbranch_scc0 L_tn
    s_mul_i32 s96, s42, 1152
    v_cvt_f32_u32 v237, s42
    s_add_u32 s96, s96, s66
    v_add_f32 v237, v237, v220
    v_add_u32 v231, s96, v227
    v_lshlrev_b32 v77, 16, v204
    v_lshlrev_b32 v161, 16, v205
    v_lshlrev_b32 v185, 16, v206
    v_and_b32 v78, 0xffff0000, v204
    v_and_b32 v162, 0xffff0000, v205
    v_and_b32 v186, 0xffff0000, v206
    v_add_f32 v77, v77, v237
    v_add_f32 v161, v161, v237
    v_add_f32 v185, v185, v237
    v_add_f32 v78, v78, v221
    v_add_f32 v162, v162, v222
    v_add_f32 v186, v186, v223
    v_cvt_pk_bf16_f32 v76, v77, v78
    v_cvt_pk_bf16_f32 v160, v161, v162
    v_cvt_pk_bf16_f32 v184, v185, v186
    v_pk_max_i16 v76, v76, 0
    v_pk_max_i16 v160, v160, 0
    v_pk_max_i16 v184, v184, 0
    v_pk_min_i16 v76, v76, s91
    v_pk_min_i16 v160, v160, s91
    v_pk_min_i16 v184, v184, s91
    v_lshlrev_b32 v77, 16, v76
    v_lshlrev_b32 v161, 16, v160
    v_lshlrev_b32 v185, 16, v184
    v_and_b32 v78, 0xffff0000, v76
    v_and_b32 v162, 0xffff0000, v160
    v_and_b32 v186, 0xffff0000, v184
    v_fract_f32 v79, v77
    v_fract_f32 v163, v161
    v_fract_f32 v187, v185
    v_fract_f32 v80, v78
    v_fract_f32 v164, v162
    v_fract_f32 v188, v186
    v_cvt_u32_f32 v81, v77
    v_cvt_u32_f32 v165, v161
    v_cvt_u32_f32 v189, v185
    v_cvt_u32_f32 v82, v78
    v_cvt_u32_f32 v166, v162
    v_cvt_u32_f32 v190, v186
    v_cmp_neq_f32 s[44:45], 0, v80
    v_cmp_neq_f32 s[50:51], 0, v164
    v_cmp_neq_f32 s[56:57], 0, v188
    v_cmp_neq_f32 s[46:47], 0, v79
    v_cmp_neq_f32 s[52:53], 0, v163
    v_cmp_neq_f32 s[58:59], 0, v187
    v_sub_f32 v83, 1.0, v79
    v_sub_f32 v167, 1.0, v163
    v_sub_f32 v191, 1.0, v187
    v_sub_f32 v84, 1.0, v80
    v_sub_f32 v168, 1.0, v164
    v_sub_f32 v192, 1.0, v188
    v_subrev_u32 v81, s33, v81
    v_subrev_u32 v165, s33, v165
    v_subrev_u32 v189, s33, v189
    v_subrev_u32 v82, s34, v82
    v_subrev_u32 v166, s34, v166
    v_subrev_u32 v190, s34, v190
    v_cvt_pk_bf16_f32 v77, v83, v84
    v_cvt_pk_bf16_f32 v161, v167, v168
    v_cvt_pk_bf16_f32 v185, v191, v192
    v_sub_u32 v89, v81, v229
    v_sub_u32 v173, v165, v229
    v_sub_u32 v197, v189, v229
    v_addc_co_u32 v91, vcc, 0, v82, s[44:45]
    v_addc_co_u32 v175, vcc, 0, v166, s[50:51]
    v_addc_co_u32 v199, vcc, 0, v190, s[56:57]
    v_lshlrev_b32 v83, 16, v77
    v_lshlrev_b32 v167, 16, v161
    v_lshlrev_b32 v191, 16, v185
    v_and_b32 v84, 0xffff0000, v77
    v_and_b32 v168, 0xffff0000, v161
    v_and_b32 v192, 0xffff0000, v185
    v_addc_co_u32 v90, vcc, 0, v89, s[46:47]
    v_addc_co_u32 v174, vcc, 0, v173, s[52:53]
    v_addc_co_u32 v198, vcc, 0, v197, s[58:59]
    v_mul_u32_u24 v92, 960, v81
    v_mul_u32_u24 v176, 960, v165
    v_mul_u32_u24 v200, 960, v189
    v_mul_f32 v85, v83, v84
    v_mul_f32 v169, v167, v168
    v_mul_f32 v193, v191, v192
    v_mul_f32 v86, v83, v80
    v_mul_f32 v170, v167, v164
    v_mul_f32 v194, v191, v188
    v_mul_f32 v87, v79, v84
    v_mul_f32 v171, v163, v168
    v_mul_f32 v195, v187, v192
    v_mul_f32 v88, v79, v80
    v_mul_f32 v172, v163, v164
    v_mul_f32 v196, v187, v188
    v_max_u32 v89, v89, v90
    v_max_u32 v173, v173, v174
    v_max_u32 v197, v197, v198
    v_subrev_u32 v77, s100, v82
    v_subrev_u32 v161, s100, v166
    v_subrev_u32 v185, s100, v190
    v_subrev_u32 v78, s100, v91
    v_subrev_u32 v162, s100, v175
    v_subrev_u32 v186, s100, v199
    v_mad_u32_u24 v83, v82, 48, v92
    v_mad_u32_u24 v167, v166, 48, v176
    v_mad_u32_u24 v191, v190, 48, v200
    v_mad_u32_u24 v84, v91, 48, v92
    v_mad_u32_u24 v168, v175, 48, v176
    v_mad_u32_u24 v192, v199, 48, v200
    v_and_b32 v82, 12, v82
    v_and_b32 v166, 12, v166
    v_and_b32 v190, 12, v190
    v_and_b32 v91, 12, v91
    v_and_b32 v175, 12, v175
    v_and_b32 v199, 12, v199
    v_max_u32 v77, v77, v78
    v_max_u32 v161, v161, v162
    v_max_u32 v185, v185, v186
    s_andn2_b64 s[48:49], s[46:47], s[44:45]
    s_andn2_b64 s[54:55], s[52:53], s[50:51]
    s_andn2_b64 s[60:61], s[58:59], s[56:57]
    v_add_lshl_u32 v83, v83, v82, 2
    v_add_lshl_u32 v167, v167, v166, 2
    v_add_lshl_u32 v191, v191, v190, 2
    v_add_lshl_u32 v84, v84, v91, 2
    v_add_lshl_u32 v168, v168, v175, 2
    v_add_lshl_u32 v192, v192, v199, 2
    v_cndmask_b32 v86, v87, v86, s[44:45]
    v_cndmask_b32 v170, v171, v170, s[50:51]
    v_cndmask_b32 v194, v195, v194, s[56:57]
    v_cndmask_b32 v78, 0, v236, s[48:49]
    v_cndmask_b32 v162, 0, v236, s[54:55]
    v_cndmask_b32 v186, 0, v236, s[60:61]
    s_and_b64 s[48:49], s[46:47], s[44:45]
    s_and_b64 s[54:55], s[52:53], s[50:51]
    s_and_b64 s[60:61], s[58:59], s[56:57]
    v_cndmask_b32 v87, 0, v87, s[44:45]
    v_cndmask_b32 v171, 0, v171, s[50:51]
    v_cndmask_b32 v195, 0, v195, s[56:57]
    v_cmp_lt_u32 s[46:47], v230, v89
    v_cmp_lt_u32 s[52:53], v230, v173
    v_cmp_lt_u32 s[58:59], v230, v197
    v_cmp_lt_u32 s[44:45], s101, v77
    v_cmp_lt_u32 s[50:51], s101, v161
    v_cmp_lt_u32 s[56:57], s101, v185
    v_lshl_or_b32 v74, v84, 16, v83
    v_lshl_or_b32 v158, v168, 16, v167
    v_lshl_or_b32 v182, v192, 16, v191
    v_cvt_pk_bf16_f32 v73, v85, v86
    v_cvt_pk_bf16_f32 v157, v169, v170
    v_cvt_pk_bf16_f32 v181, v193, v194
    v_cvt_pk_bf16_f32 v75, v87, v88
    v_cvt_pk_bf16_f32 v159, v171, v172
    v_cvt_pk_bf16_f32 v183, v195, v196
    v_and_b32 v78, 0xffff0000, v78
    v_and_b32 v162, 0xffff0000, v162
    v_and_b32 v186, 0xffff0000, v186
    v_cndmask_b32 v77, 0, v236, s[48:49]
    v_cndmask_b32 v161, 0, v236, s[54:55]
    v_cndmask_b32 v185, 0, v236, s[60:61]
    s_or_b64 s[44:45], s[44:45], s[46:47]
    s_or_b64 s[50:51], s[50:51], s[52:53]
    s_or_b64 s[56:57], s[56:57], s[58:59]
    v_add_u32 v72, v74, v78
    v_add_u32 v156, v158, v162
    v_add_u32 v180, v182, v186
    v_add_u32 v74, v74, v77
    v_add_u32 v158, v158, v161
    v_add_u32 v182, v182, v185
    s_or_b64 s[70:71], s[44:45], s[48:49]
    s_cbranch_scc1 L_tx0
L_tw0:
    ds_write_b64 v231, v[72:73] offset:0
    s_or_b64 s[70:71], s[50:51], s[54:55]
    s_cbranch_scc1 L_tx1
L_tw1:
    ds_write_b64 v231, v[156:157] offset:128
    s_or_b64 s[70:71], s[56:57], s[60:61]
    s_cbranch_scc1 L_tx2
L_tw2:
    ds_write_b64 v231, v[180:181] offset:256
L_tn:
    s_lshr_b32 s40, s40, 1
    s_cbranch_scc1 L_tm
    s_mov_b32 exec_hi, -1
    v_lshl_add_u32 v6, v251, 3, s66
    s_setpc_b64 s[76:77]
L_tm:
    v_mov_b32 v204, v208
    v_mov_b32 v205, v209
    v_mov_b32 v206, v210
    v_mov_b32 v208, v212
    v_mov_b32 v209, v213
    v_mov_b32 v210, v214
    v_mov_b32 v212, v216
    v_mov_b32 v213, v217
    v_mov_b32 v214, v218
    s_add_u32 s42, s42, 1
    s_branch L_tl
L_tx0:
    s_andn2_b64 s[48:49], s[48:49], s[44:45]
    s_bcnt1_i32_b64 s96, s[48:49]
    s_add_u32 s96, s96, s27
    s_cmp_gt_u32 s96, s69
    s_cselect_b64 s[44:45], s[70:71], s[44:45]
    s_cselect_b64 s[48:49], 0, s[48:49]
    s_cselect_b32 s96, s27, s96
    v_mbcnt_lo_u32_b32 v76, s48, 0
    v_mbcnt_hi_u32_b32 v76, s49, v76
    v_add_u32 v76, s27, v76
    s_mov_b32 s27, s96
    v_lshl_add_u32 v77, v76, 4, s67
    v_bfe_u32 v78, v76, 1, 2
    v_mad_u32_u24 v76, v76, 12, v78
    s_mov_b64 exec, s[48:49]
    v_lshl_add_u32 v76, v76, 4, s68
    ds_write_b128 v77, v[72:75]
    v_mul_u32_u24 v72, 0x10001, v76
    v_mov_b32 v73, 0x3f80
    s_mov_b64 exec, s[44:45]
    v_mov_b32 v72, 2
    s_or_b32 s43, s43, s44
    s_or_b32 s43, s43, s45
    s_mov_b32 exec_lo, -1
    s_mov_b32 exec_hi, 0xffff
    s_branch L_tw0
L_tx1:
    s_andn2_b64 s[54:55], s[54:55], s[50:51]
    s_bcnt1_i32_b64 s96, s[54:55]
    s_add_u32 s96, s96, s27
    s_cmp_gt_u32 s96, s69
    s_cselect_b64 s[50:51], s[70:71], s[50:51]
    s_cselect_b64 s[54:55], 0, s[54:55]
    s_cselect_b32 s96, s27, s96
    v_mbcnt_lo_u32_b32 v160, s54, 0
    v_mbcnt_hi_u32_b32 v160, s55, v160
    v_add_u32 v160, s27, v160
    s_mov_b32 s27, s96
    v_lshl_add_u32 v161, v160, 4, s67
    v_bfe_u32 v162, v160, 1, 2
    v_mad_u32_u24 v160, v160, 12, v162
    s_mov_b64 exec, s[54:55]
    v_lshl_add_u32 v160, v160, 4, s68
    ds_write_b128 v161, v[156:159]
    v_mul_u32_u24 v156, 0x10001, v160
    v_mov_b32 v157, 0x3f80
    s_mov_b64 exec, s[50:51]
    v_mov_b32 v156, 2
    s_or_b32 s43, s43, s50
    s_or_b32 s43, s43, s51
    s_mov_b32 exec_lo, -1
    s_mov_b32 exec_hi, 0xffff
    s_branch L_tw1
L_tx2:
    s_andn2_b64 s[60:61], s[60:61], s[56:57]
    s_bcnt1_i32_b64 s96, s[60:61]
    s_add_u32 s96, s96, s27
    s_cmp_gt_u32 s96, s69
    s_cselect_b64 s[56:57], s[70:71], s[56:57]
    s_cselect_b64 s[60:61], 0, s[60:61]
    s_cselect_b32 s96, s27, s96
    v_mbcnt_lo_u32_b32 v184, s60, 0
    v_mbcnt_hi_u32_b32 v184, s61, v184
    v_add_u32 v184, s27, v184
    s_mov_b32 s27, s96
    v_lshl_add_u32 v185, v184, 4, s67
    v_bfe_u32 v186, v184, 1, 2
    v_mad_u32_u24 v184, v184, 12, v186
    s_mov_b64 exec, s[60:61]
    v_lshl_add_u32 v184, v184, 4, s68
    ds_write_b128 v185, v[180:183]
    v_mul_u32_u24 v180, 0x10001, v184
    v_mov_b32 v181, 0x3f80
    s_mov_b64 exec, s[56:57]
    v_mov_b32 v180, 2
    s_or_b32 s43, s43, s56
    s_or_b32 s43, s43, s57
    s_mov_b32 exec_lo, -1
    s_mov_b32 exec_hi, 0xffff
    s_branch L_tw2
.p2align 12
L_dfirst:
    s_cmp_lg_u32 s43, 0
    s_cselect_b32 s96, 0x10000, 0
    s_or_b32 s96, s96, s27
    v_mov_b32 v17, s96
    v_xor_b32 v241, 16, v254
    v_mov_b32 v242, 163808
    ds_write_b32 v254, v17 offset:32
    s_or_b32 s3, s37, s39
    s_or_b32 s3, s3, s99
    s_or_b32 s3, s3, 512
    v_mfma_f32_32x32x16_bf16 v[72:87], v[108:111], v[108:111], 0
    v_mfma_f32_32x32x16_bf16 v[80:95], v[108:111], v[108:111], 0
    v_mov_b32 v112, 0
    v_mov_b32 v113, 0
    v_mov_b32 v114, 0
    v_mov_b32 v115, 0
    v_mov_b32 v116, 0
    v_mov_b32 v117, 0
    v_mov_b32 v118, 0
    v_mov_b32 v119, 0
    s_mul_i32 s96, s29, 1152
    v_add_u32 v7, s96, v6
    s_mov_b32 s52, 0
    s_mov_b32 s53, s27
    s_mov_b32 s54, 32
    s_cmp_lg_u32 s27, 0
    s_cbranch_scc1 L_dp0
    s_waitcnt lgkmcnt(0)
    s_barrier
L_df2:
    ds_read_b128 v[180:183], v242
    ds_read_b128 v[184:187], v242 offset:16
    ds_read_b32 v188, v241 offset:32
    ds_read_b64 v[236:237], v7
    ds_read_b64 v[238:239], v7 offset:2304
    s_waitcnt lgkmcnt(3)
    v_or3_b32 v180, v180, v181, v182
    v_or3_b32 v183, v183, v184, v185
    v_or3_b32 v180, v180, v186, v187
    v_or_b32 v180, v180, v183
    v_cmp_ne_u32 vcc, 0, v180
    s_cbranch_vccnz L_dpatch
L_dgo:
    s_cmp_ge_u32 s28, 4
    s_cbranch_scc1 L_dB
    s_cmp_ge_u32 s29, s30
    s_cbranch_scc1 L_dnone
    v_add_u32 v5, 89280, v240
    s_waitcnt lgkmcnt(0)
    v_xor_b32_sdwa v244, v236, v12 dst_sel:DWORD dst_unused:UNUSED_PAD src0_sel:WORD_0 src1_sel:DWORD
    v_xor_b32_sdwa v246, v236, v12 dst_sel:DWORD dst_unused:UNUSED_PAD src0_sel:WORD_1 src1_sel:DWORD
    v_xor_b32_sdwa v245, v236, v13 dst_sel:DWORD dst_unused:UNUSED_PAD src0_sel:WORD_0 src1_sel:DWORD
    v_xor_b32_sdwa v247, v236, v13 dst_sel:DWORD dst_unused:UNUSED_PAD src0_sel:WORD_1 src1_sel:DWORD
    v_xor_b32_sdwa v152, v238, v12 dst_sel:DWORD dst_unused:UNUSED_PAD src0_sel:WORD_0 src1_sel:DWORD
    v_xor_b32_sdwa v154, v238, v12 dst_sel:DWORD dst_unused:UNUSED_PAD src0_sel:WORD_1 src1_sel:DWORD
    v_xor_b32_sdwa v153, v238, v13 dst_sel:DWORD dst_unused:UNUSED_PAD src0_sel:WORD_0 src1_sel:DWORD
    v_xor_b32_sdwa v155, v238, v13 dst_sel:DWORD dst_unused:UNUSED_PAD src0_sel:WORD_1 src1_sel:DWORD
    ds_read_b64_tr_b16 v[120:121], v244 offset:0
    ds_read_b64_tr_b16 v[122:123], v246 offset:0
    ds_read_b64_tr_b16 v[124:125], v245 offset:0
    ds_read_b64_tr_b16 v[126:127], v247 offset:0
    ds_read_b64_tr_b16 v[128:129], v152 offset:0
    ds_read_b64_tr_b16 v[130:131], v154 offset:0
    ds_read_b64_tr_b16 v[132:133], v153 offset:0
    ds_read_b64_tr_b16 v[134:135], v155 offset:0
    v_perm_b32 v228, v237, v237, v8
    v_perm_b32 v229, v237, v237, v9
    v_perm_b32 v230, v237, v237, v10
    v_perm_b32 v231, v237, v237, v11
    v_perm_b32 v232, v239, v239, v8
    v_perm_b32 v233, v239, v239, v9
    v_perm_b32 v234, v239, v239, v10
    v_perm_b32 v235, v239, v239, v11
    v_add_u32 v7, 128, v7
    s_waitcnt lgkmcnt(0)
    v_mfma_f32_16x16x32_bf16 v[136:139], v[120:123], v[228:231], 0
    v_mfma_f32_16x16x32_bf16 v[140:143], v[124:127], v[228:231], 0
    v_mfma_f32_16x16x32_bf16 v[144:147], v[128:131], v[232:235], 0
    v_mfma_f32_16x16x32_bf16 v[148:151], v[132:135], v[232:235], 0
    ds_read_b64_tr_b16 v[120:121], v244 offset:64
    ds_read_b64_tr_b16 v[122:123], v246 offset:64
    ds_read_b64_tr_b16 v[124:125], v245 offset:64
    ds_read_b64_tr_b16 v[126:127], v247 offset:64
    ds_read_b64_tr_b16 v[128:129], v152 offset:64
    ds_read_b64_tr_b16 v[130:131], v154 offset:64
    ds_read_b64_tr_b16 v[132:133], v153 offset:64
    ds_read_b64_tr_b16 v[134:135], v155 offset:64
    ds_read_b64 v[236:237], v7
    ds_read_b64 v[238:239], v7 offset:2304
    v_cvt_pk_bf16_f32 v96, v136, v137
    v_cvt_pk_bf16_f32 v97, v138, v139
    v_cvt_pk_bf16_f32 v98, v140, v141
    v_cvt_pk_bf16_f32 v99, v142, v143
    v_cvt_pk_bf16_f32 v100, v144, v145
    v_cvt_pk_bf16_f32 v101, v146, v147
    v_cvt_pk_bf16_f32 v102, v148, v149
    v_cvt_pk_bf16_f32 v103, v150, v151
    s_waitcnt lgkmcnt(2)
    v_mfma_f32_16x16x32_bf16 v[136:139], v[120:123], v[228:231], 0
    v_mfma_f32_16x16x32_bf16 v[140:143], v[124:127], v[228:231], 0
    v_mfma_f32_16x16x32_bf16 v[144:147], v[128:131], v[232:235], 0
    v_mfma_f32_16x16x32_bf16 v[148:151], v[132:135], v[232:235], 0
    v_permlane16_swap_b32 v96, v100
    v_permlane16_swap_b32 v97, v101
    v_permlane16_swap_b32 v98, v102
    v_permlane16_swap_b32 v99, v103
    s_waitcnt vmcnt(0) lgkmcnt(0)
    s_barrier
.p2align 3
L_dtop:
    s_waitcnt lgkmcnt(6)
    v_mfma_f32_32x32x16_bf16 v[24:39], v[72:75], v[112:115], v[24:39]
    ds_read_b64_tr_b16 v[120:121], v244 offset:128
    ds_read_b64_tr_b16 v[122:123], v246 offset:128
    ds_read_b64_tr_b16 v[124:125], v245 offset:128
    ds_read_b64_tr_b16 v[126:127], v247 offset:128
    v_mfma_f32_32x32x16_bf16 v[40:55], v[76:79], v[112:115], v[40:55]
    ds_read_b64_tr_b16 v[128:129], v152 offset:128
    ds_read_b64_tr_b16 v[130:131], v154 offset:128
    ds_read_b64_tr_b16 v[132:133], v153 offset:128
    v_cvt_pk_bf16_f32 v104, v136, v137
    v_cvt_pk_bf16_f32 v105, v138, v139
    v_mfma_f32_32x32x16_bf16 v[56:71], v[80:83], v[112:115], v[56:71]
    ds_read_b64_tr_b16 v[134:135], v155 offset:128
    ds_read_b64_tr_b16 v[72:73], v5 offset:0
    ds_read_b64_tr_b16 v[74:75], v5 offset:1536
    v_cvt_pk_bf16_f32 v106, v140, v141
    v_cvt_pk_bf16_f32 v107, v142, v143
    v_cvt_pk_bf16_f32 v108, v144, v145
    s_waitcnt lgkmcnt(10)
    v_mfma_f32_32x32x16_bf16 v[24:39], v[84:87], v[116:119], v[24:39]
    ds_read_b64_tr_b16 v[76:77], v5 offset:64
    ds_read_b64_tr_b16 v[78:79], v5 offset:1600
    ds_read_b64_tr_b16 v[80:81], v5 offset:128
    v_cvt_pk_bf16_f32 v109, v146, v147
    v_cvt_pk_bf16_f32 v110, v148, v149
    v_cvt_pk_bf16_f32 v111, v150, v151
    v_mfma_f32_32x32x16_bf16 v[40:55], v[88:91], v[116:119], v[40:55]
    ds_read_b64_tr_b16 v[82:83], v5 offset:1664
    ds_read_b64_tr_b16 v[84:85], v5 offset:3104
    ds_read_b64_tr_b16 v[86:87], v5 offset:4640
    v_xor_b32_sdwa v244, v236, v12 dst_sel:DWORD dst_unused:UNUSED_PAD src0_sel:WORD_0 src1_sel:DWORD
    v_xor_b32_sdwa v246, v236, v12 dst_sel:DWORD dst_unused:UNUSED_PAD src0_sel:WORD_1 src1_sel:DWORD
    v_xor_b32_sdwa v245, v236, v13 dst_sel:DWORD dst_unused:UNUSED_PAD src0_sel:WORD_0 src1_sel:DWORD
    v_mfma_f32_32x32x16_bf16 v[56:71], v[92:95], v[116:119], v[56:71]
    ds_read_b64_tr_b16 v[88:89], v5 offset:3168
    ds_read_b64_tr_b16 v[90:91], v5 offset:4704
    v_xor_b32_sdwa v247, v236, v13 dst_sel:DWORD dst_unused:UNUSED_PAD src0_sel:WORD_1 src1_sel:DWORD
    v_xor_b32_sdwa v152, v238, v12 dst_sel:DWORD dst_unused:UNUSED_PAD src0_sel:WORD_0 src1_sel:DWORD
    v_xor_b32_sdwa v154, v238, v12 dst_sel:DWORD dst_unused:UNUSED_PAD src0_sel:WORD_1 src1_sel:DWORD
    s_waitcnt lgkmcnt(10)
    v_mfma_f32_16x16x32_bf16 v[136:139], v[120:123], v[228:231], 0
    v_xor_b32_sdwa v153, v238, v13 dst_sel:DWORD dst_unused:UNUSED_PAD src0_sel:WORD_0 src1_sel:DWORD
    v_xor_b32_sdwa v155, v238, v13 dst_sel:DWORD dst_unused:UNUSED_PAD src0_sel:WORD_1 src1_sel:DWORD
    v_mfma_f32_16x16x32_bf16 v[140:143], v[124:127], v[228:231], 0
    ds_read_b64_tr_b16 v[92:93], v5 offset:3232
    v_permlane16_swap_b32 v104, v108
    v_mfma_f32_16x16x32_bf16 v[144:147], v[128:131], v[232:235], 0
    ds_read_b64_tr_b16 v[94:95], v5 offset:4768
    v_permlane16_swap_b32 v105, v109
    v_mfma_f32_16x16x32_bf16 v[148:151], v[132:135], v[232:235], 0
    s_waitcnt lgkmcnt(6)
    v_mfma_f32_32x32x16_bf16 v[24:39], v[72:75], v[96:99], v[24:39]
    ds_read_b64_tr_b16 v[120:121], v244 offset:0
    ds_read_b64_tr_b16 v[122:123], v246 offset:0
    ds_read_b64_tr_b16 v[124:125], v245 offset:0
    ds_read_b64_tr_b16 v[126:127], v247 offset:0
    v_mfma_f32_32x32x16_bf16 v[40:55], v[76:79], v[96:99], v[40:55]
    ds_read_b64_tr_b16 v[128:129], v152 offset:0
    ds_read_b64_tr_b16 v[130:131], v154 offset:0
    ds_read_b64_tr_b16 v[132:133], v153 offset:0
    v_cvt_pk_bf16_f32 v112, v136, v137
    v_cvt_pk_bf16_f32 v113, v138, v139
    v_mfma_f32_32x32x16_bf16 v[56:71], v[80:83], v[96:99], v[56:71]
    ds_read_b64_tr_b16 v[134:135], v155 offset:0
    ds_read_b64_tr_b16 v[72:73], v5 offset:6208
    ds_read_b64_tr_b16 v[74:75], v5 offset:7744
    v_cvt_pk_bf16_f32 v114, v140, v141
    v_cvt_pk_bf16_f32 v115, v142, v143
    v_perm_b32 v228, v237, v237, v8
    s_waitcnt lgkmcnt(10)
    v_mfma_f32_32x32x16_bf16 v[24:39], v[84:87], v[100:103], v[24:39]
    ds_read_b64_tr_b16 v[76:77], v5 offset:6272
    ds_read_b64_tr_b16 v[78:79], v5 offset:7808
    ds_read_b64_tr_b16 v[80:81], v5 offset:6336
    v_perm_b32 v229, v237, v237, v9
    v_perm_b32 v230, v237, v237, v10
    v_perm_b32 v231, v237, v237, v11
    v_mfma_f32_32x32x16_bf16 v[40:55], v[88:91], v[100:103], v[40:55]
    ds_read_b64_tr_b16 v[82:83], v5 offset:7872
    ds_read_b64_tr_b16 v[84:85], v5 offset:9312
    ds_read_b64_tr_b16 v[86:87], v5 offset:10848
    v_cvt_pk_bf16_f32 v116, v144, v145
    v_cvt_pk_bf16_f32 v117, v146, v147
    v_cvt_pk_bf16_f32 v118, v148, v149
    v_mfma_f32_32x32x16_bf16 v[56:71], v[92:95], v[100:103], v[56:71]
    ds_read_b64_tr_b16 v[88:89], v5 offset:9376
    ds_read_b64_tr_b16 v[90:91], v5 offset:10912
    v_cvt_pk_bf16_f32 v119, v150, v151
    v_perm_b32 v232, v239, v239, v8
    v_perm_b32 v233, v239, v239, v9
    s_waitcnt lgkmcnt(10)
    v_mfma_f32_16x16x32_bf16 v[136:139], v[120:123], v[228:231], 0
    v_perm_b32 v234, v239, v239, v10
    v_perm_b32 v235, v239, v239, v11
    v_mfma_f32_16x16x32_bf16 v[140:143], v[124:127], v[228:231], 0
    ds_read_b64_tr_b16 v[92:93], v5 offset:9440
    v_permlane16_swap_b32 v106, v110
    v_mfma_f32_16x16x32_bf16 v[144:147], v[128:131], v[232:235], 0
    ds_read_b64_tr_b16 v[94:95], v5 offset:10976
    v_permlane16_swap_b32 v107, v111
    v_mfma_f32_16x16x32_bf16 v[148:151], v[132:135], v[232:235], 0
    v_add_u32 v7, 128, v7
    s_waitcnt lgkmcnt(6)
    v_mfma_f32_32x32x16_bf16 v[24:39], v[72:75], v[104:107], v[24:39]
    ds_read_b64_tr_b16 v[120:121], v244 offset:64
    ds_read_b64_tr_b16 v[122:123], v246 offset:64
    ds_read_b64_tr_b16 v[124:125], v245 offset:64
    ds_read_b64_tr_b16 v[126:127], v247 offset:64
    v_mfma_f32_32x32x16_bf16 v[40:55], v[76:79], v[104:107], v[40:55]
    ds_read_b64_tr_b16 v[128:129], v152 offset:64
    ds_read_b64_tr_b16 v[130:131], v154 offset:64
    ds_read_b64_tr_b16 v[132:133], v153 offset:64
    ds_read_b64_tr_b16 v[134:135], v155 offset:64
    ds_read_b64 v[236:237], v7
    v_cvt_pk_bf16_f32 v96, v136, v137
    v_cvt_pk_bf16_f32 v97, v138, v139
    v_mfma_f32_32x32x16_bf16 v[56:71], v[80:83], v[104:107], v[56:71]
    ds_read_b64 v[238:239], v7 offset:2304
    ds_read_b64_tr_b16 v[72:73], v5 offset:12416
    ds_read_b64_tr_b16 v[74:75], v5 offset:13952
    v_cvt_pk_bf16_f32 v98, v140, v141
    v_cvt_pk_bf16_f32 v99, v142, v143
    v_cvt_pk_bf16_f32 v100, v144, v145
    s_waitcnt lgkmcnt(12)
    v_mfma_f32_32x32x16_bf16 v[24:39], v[84:87], v[108:111], v[24:39]
    ds_read_b64_tr_b16 v[76:77], v5 offset:12480
    ds_read_b64_tr_b16 v[78:79], v5 offset:14016
    ds_read_b64_tr_b16 v[80:81], v5 offset:12544
    v_cvt_pk_bf16_f32 v101, v146, v147
    v_cvt_pk_bf16_f32 v102, v148, v149
    v_cvt_pk_bf16_f32 v103, v150, v151
    v_mfma_f32_32x32x16_bf16 v[40:55], v[88:91], v[108:111], v[40:55]
    ds_read_b64_tr_b16 v[82:83], v5 offset:14080
    ds_read_b64_tr_b16 v[84:85], v5 offset:15520
    ds_read_b64_tr_b16 v[86:87], v5 offset:17056
    v_permlane16_swap_b32 v112, v116
    v_permlane16_swap_b32 v113, v117
    v_permlane16_swap_b32 v114, v118
    v_mfma_f32_32x32x16_bf16 v[56:71], v[92:95], v[108:111], v[56:71]
    ds_read_b64_tr_b16 v[88:89], v5 offset:15584
    ds_read_b64_tr_b16 v[90:91], v5 offset:17120
    v_permlane16_swap_b32 v115, v119
    v_permlane16_swap_b32 v96, v100
    v_permlane16_swap_b32 v97, v101
    s_waitcnt lgkmcnt(12)
    v_mfma_f32_16x16x32_bf16 v[136:139], v[120:123], v[228:231], 0
    v_permlane16_swap_b32 v98, v102
    v_permlane16_swap_b32 v99, v103
    v_mfma_f32_16x16x32_bf16 v[140:143], v[124:127], v[228:231], 0
    ds_read_b64_tr_b16 v[92:93], v5 offset:15648
    v_mfma_f32_16x16x32_bf16 v[144:147], v[128:131], v[232:235], 0
    ds_read_b64_tr_b16 v[94:95], v5 offset:17184
    v_mfma_f32_16x16x32_bf16 v[148:151], v[132:135], v[232:235], 0
    s_add_u32 s35, s35, 1
    s_bitcmp1_b32 0x3d4, s35
    v_add_u32 v5, 18624, v5
    s_cbranch_scc0 L_dtop
    s_cmp_eq_u32 s35, 7
    s_cbranch_scc1 L_d7
    s_cmp_eq_u32 s35, 9
    s_cbranch_scc1 L_d9
    s_bitcmp1_b32 s35, 1
    s_waitcnt lgkmcnt(0)
    s_barrier
    s_cbranch_scc1 L_dtop
    v_add_u32 v5, 89280, v240
    s_branch L_dtop
L_d9:
    s_waitcnt lgkmcnt(0)
    v_mfma_f32_32x32x16_bf16 v[24:39], v[72:75], v[112:115], v[24:39]
    s_mul_i32 s97, s28, 12288
    v_readfirstlane_b32 s98, v248
    s_add_u32 s97, s97, 107904
    v_bfe_u32 v180, v16, 8, 1
    v_lshrrev_b32 v181, 9, v16
    v_mul_u32_u24 v21, 208, v14
    v_mfma_f32_32x32x16_bf16 v[24:39], v[84:87], v[116:119], v[24:39]
    v_mul_u32_u24 v180, 7680, v180
    s_sub_u32 s98, s97, s98
    v_lshl_add_u32 v21, v181, 3, v21
    v_mov_b32 v255, v254
    v_add3_u32 v21, v21, v180, s97
    v_add_u32 v248, s98, v248
    v_mfma_f32_32x32x16_bf16 v[40:55], v[76:79], v[112:115], v[40:55]
    v_add_u32 v249, s98, v249
    v_add_u32 v250, s98, v250
    s_add_u32 s96, s0, s29
    s_mul_i32 s96, s96, 224
    v_mfma_f32_32x32x16_bf16 v[40:55], v[88:91], v[116:119], v[40:55]
    s_add_u32 s96, s96, s32
    s_mul_i32 s96, s96, 192
    s_add_u32 s97, s96, 86016
    s_add_u32 s98, s29, 2
    v_cvt_pk_bf16_f32 v156, v24, v25
    v_cvt_pk_bf16_f32 v157, v26, v27
    v_cvt_pk_bf16_f32 v158, v28, v29
    v_cvt_pk_bf16_f32 v159, v30, v31
    v_mfma_f32_32x32x16_bf16 v[56:71], v[80:83], v[112:115], v[56:71]
    v_cvt_pk_bf16_f32 v160, v32, v33
    v_cvt_pk_bf16_f32 v161, v34, v35
    v_cvt_pk_bf16_f32 v162, v36, v37
    v_cvt_pk_bf16_f32 v163, v38, v39
    v_mfma_f32_32x32x16_bf16 v[56:71], v[92:95], v[116:119], v[56:71]
    ds_write_b64 v21, v[156:157] offset:0
    ds_write_b64 v21, v[158:159] offset:16
    ds_write_b64 v21, v[160:161] offset:32
    ds_write_b64 v21, v[162:163] offset:48
    v_cvt_pk_bf16_f32 v164, v40, v41
    v_cvt_pk_bf16_f32 v165, v42, v43
    v_cvt_pk_bf16_f32 v166, v44, v45
    v_cvt_pk_bf16_f32 v167, v46, v47
    v_cvt_pk_bf16_f32 v168, v48, v49
    v_cvt_pk_bf16_f32 v169, v50, v51
    v_cvt_pk_bf16_f32 v170, v52, v53
    v_cvt_pk_bf16_f32 v171, v54, v55
    ds_write_b64 v21, v[164:165] offset:64
    ds_write_b64 v21, v[166:167] offset:80
    ds_write_b64 v21, v[168:169] offset:96
    ds_write_b64 v21, v[170:171] offset:112
    v_cvt_pk_bf16_f32 v172, v56, v57
    v_cvt_pk_bf16_f32 v173, v58, v59
    v_cvt_pk_bf16_f32 v174, v60, v61
    v_cvt_pk_bf16_f32 v175, v62, v63
    v_cvt_pk_bf16_f32 v176, v64, v65
    v_cvt_pk_bf16_f32 v177, v66, v67
    v_cvt_pk_bf16_f32 v178, v68, v69
    v_cvt_pk_bf16_f32 v179, v70, v71
    ds_write_b64 v21, v[172:173] offset:128
    ds_write_b64 v21, v[174:175] offset:144
    ds_write_b64 v21, v[176:177] offset:160
    ds_write_b64 v21, v[178:179] offset:176
    s_branch L_epi
L_d7:
    v_add_u32 v7, -256, v7
    s_branch L_dtop
L_dnone:
    s_waitcnt vmcnt(0)
    s_barrier
    s_barrier
    s_barrier
    s_barrier
    s_barrier
    s_branch L_fin
L_dB:
    s_add_u32 m0, s90, 20672
    s_mov_b32 s96, 20480
    buffer_load_dwordx4 v19, s[12:15], s96 offen lds
    s_add_u32 m0, s88, 24832
    s_mov_b32 s96, 24576
    buffer_load_dwordx4 v19, s[12:15], s96 offen lds
    s_add_u32 m0, s89, 28960
    s_mov_b32 s96, 28672
    buffer_load_dwordx4 v19, s[12:15], s96 offen lds
    s_add_u32 m0, s90, 33088
    s_mov_b32 s96, 32768
    buffer_load_dwordx4 v19, s[12:15], s96 offen lds
    s_waitcnt vmcnt(0)
    s_barrier
    s_add_u32 m0, s88, 37248
    s_mov_b32 s96, 36864
    buffer_load_dwordx4 v19, s[12:15], s96 offen lds
    s_add_u32 m0, s89, 41376
    s_mov_b32 s96, 40960
    buffer_load_dwordx4 v19, s[12:15], s96 offen lds
    s_add_u32 m0, s90, 45504
    s_mov_b32 s96, 45056
    buffer_load_dwordx4 v19, s[12:15], s96 offen lds
    s_add_u32 m0, s88, 49664
    s_mov_b32 s96, 49152
    buffer_load_dwordx4 v19, s[12:15], s96 offen lds
    s_add_u32 m0, s89, 53792
    s_mov_b32 s96, 53248
    buffer_load_dwordx4 v19, s[12:15], s96 offen lds
    s_add_u32 m0, s90, 57920
    s_mov_b32 s96, 57344
    buffer_load_dwordx4 v19, s[12:15], s96 offen lds
    s_add_u32 m0, s88, 62080
    s_mov_b32 s96, 61440
    buffer_load_dwordx4 v19, s[12:15], s96 offen lds
    s_add_u32 m0, s89, 66208
    s_mov_b32 s96, 65536
    buffer_load_dwordx4 v19, s[12:15], s96 offen lds
    s_add_u32 m0, s90, 70336
    s_mov_b32 s96, 69632
    buffer_load_dwordx4 v19, s[12:15], s96 offen lds
    s_waitcnt vmcnt(0)
    s_barrier
    s_mov_b32 s98, 0
L_dB1:
    s_add_u32 s97, s88, s98
    s_add_u32 m0, s97, 0
    s_add_u32 s96, s95, 0
    buffer_load_dwordx4 v19, s[12:15], s96 offen lds
    s_add_u32 s97, s89, s98
    s_add_u32 m0, s97, 4128
    s_add_u32 s96, s95, 4096
    buffer_load_dwordx4 v19, s[12:15], s96 offen lds
    s_add_u32 s97, s90, s98
    s_add_u32 m0, s97, 8256
    s_add_u32 s96, s95, 8192
    buffer_load_dwordx4 v19, s[12:15], s96 offen lds
    s_add_u32 s97, s88, s98
    s_add_u32 m0, s97, 12416
    s_add_u32 s96, s95, 12288
    buffer_load_dwordx4 v19, s[12:15], s96 offen lds
    s_add_u32 s97, s89, s98
    s_add_u32 m0, s97, 16544
    s_add_u32 s96, s95, 16384
    buffer_load_dwordx4 v19, s[12:15], s96 offen lds
    s_add_u32 s97, s90, s98
    s_add_u32 m0, s97, 20672
    s_add_u32 s96, s95, 20480
    buffer_load_dwordx4 v19, s[12:15], s96 offen lds
    s_add_u32 s97, s88, s98
    s_add_u32 m0, s97, 24832
    s_add_u32 s96, s95, 24576
    buffer_load_dwordx4 v19, s[12:15], s96 offen lds
    s_add_u32 s97, s89, s98
    s_add_u32 m0, s97, 28960
    s_add_u32 s96, s95, 28672
    buffer_load_dwordx4 v19, s[12:15], s96 offen lds
    s_add_u32 s97, s90, s98
    s_add_u32 m0, s97, 33088
    s_add_u32 s96, s95, 32768
    buffer_load_dwordx4 v19, s[12:15], s96 offen lds
    s_add_u32 s95, s95, 36864
    s_xor_b32 s98, s98, 37248
    s_waitcnt vmcnt(0)
    s_barrier
    s_cbranch_scc1 L_dB1
    s_call_b64 s[76:77], L_dma2
    s_waitcnt vmcnt(0)
    s_barrier
    s_branch L_fin
L_dp0:
    s_sub_u32 s97, s53, 1
    v_add_u32 v17, s52, v251
    v_add_u32 v252, s52, v14
    v_min_u32 v17, s97, v17
    v_min_u32 v252, s97, v252
    v_lshl_add_u32 v17, v17, 4, s67
    v_bfe_u32 v253, v252, 1, 2
    ds_read_b128 v[236:239], v17
    v_mad_u32_u24 v252, v252, 12, v253
    v_and_b32 v253, 3, v15
    s_add_u32 s52, s52, s54
    v_xor_b32 v252, v252, v253
    v_lshl_add_u32 v252, v252, 4, s68
    s_waitcnt lgkmcnt(0)
    v_xor_b32_sdwa v244, v236, v12 dst_sel:DWORD dst_unused:UNUSED_PAD src0_sel:WORD_0 src1_sel:DWORD
    v_xor_b32_sdwa v246, v236, v12 dst_sel:DWORD dst_unused:UNUSED_PAD src0_sel:WORD_1 src1_sel:DWORD
    v_xor_b32_sdwa v245, v236, v13 dst_sel:DWORD dst_unused:UNUSED_PAD src0_sel:WORD_0 src1_sel:DWORD
    v_xor_b32_sdwa v247, v236, v13 dst_sel:DWORD dst_unused:UNUSED_PAD src0_sel:WORD_1 src1_sel:DWORD
    v_cmp_ne_u32 vcc, 0, v239
    v_perm_b32 v228, v237, v237, v8
    v_perm_b32 v229, v237, v237, v9
    v_perm_b32 v230, v237, v237, v10
    v_perm_b32 v231, v237, v237, v11
    s_setprio 3
    s_barrier
    s_call_b64 s[76:77], L_gpb
    s_branch L_df2
L_dpatch:
    v_readfirstlane_b32 s41, v180
    s_waitcnt lgkmcnt(0)
    v_readfirstlane_b32 s42, v188
    s_xor_b32 s97, s26, 2
    s_add_u32 s96, s97, s31
    s_mul_i32 s67, s96, 1792
    s_add_u32 s67, s67, 74752
    s_mul_i32 s96, s96, s69
    s_mul_i32 s96, s96, 192
    s_add_u32 s68, s96, s25
    s_mov_b32 s52, 16
    s_and_b32 s53, s42, 0xffff
    s_cmp_le_u32 s53, 16
    s_cbranch_scc1 L_dp1
    s_call_b64 s[76:77], L_gp
    ds_read_b64 v[236:237], v7
    ds_read_b64 v[238:239], v7 offset:2304
L_dp1:
    s_waitcnt lgkmcnt(0)
    s_setprio 0
    s_barrier
    s_cmp_lt_u32 s41, 0x10000
    s_cbranch_scc1 L_dgo
    s_branch L_dfall
.p2align 3
L_top2:
    s_barrier
L_body2:
    s_setprio 2
.p2align 3
    v_mfma_f32_16x16x32_bf16 v[24:27], v[84:87], v[124:127], v[24:27]
    ds_read_b128 v[108:111], v1 offset:0
    v_mfma_f32_16x16x32_bf16 v[28:31], v[88:91], v[124:127], v[28:31]
    ds_read_b64_tr_b16 v[72:73], v5 offset:0
    v_mfma_f32_16x16x32_bf16 v[32:35], v[92:95], v[124:127], v[32:35]
    ds_read_b64_tr_b16 v[74:75], v5 offset:768
    v_mfma_f32_16x16x32_bf16 v[44:47], v[92:95], v[128:131], v[44:47]
    ds_read_b64_tr_b16 v[76:77], v5 offset:32
    v_mfma_f32_16x16x32_bf16 v[40:43], v[88:91], v[128:131], v[40:43]
    ds_read_b64_tr_b16 v[78:79], v5 offset:800
    v_mfma_f32_16x16x32_bf16 v[36:39], v[84:87], v[128:131], v[36:39]
    ds_read_b64_tr_b16 v[80:81], v5 offset:64
    ds_read_b64_tr_b16 v[82:83], v5 offset:832
    ds_read_b128 v[112:115], v1 offset:3840
    s_setprio 1
.p2align 3
    v_mfma_f32_16x16x32_bf16 v[24:27], v[96:99], v[140:143], v[24:27]
    ds_read_b64_tr_b16 v[84:85], v5 offset:6208
    ds_read_b64_tr_b16 v[86:87], v5 offset:6976
    v_mfma_f32_16x16x32_bf16 v[28:31], v[100:103], v[140:143], v[28:31]
    ds_read_b64_tr_b16 v[88:89], v5 offset:6240
    ds_read_b64_tr_b16 v[90:91], v5 offset:7008
    v_mfma_f32_16x16x32_bf16 v[32:35], v[104:107], v[140:143], v[32:35]
    ds_read_b64_tr_b16 v[92:93], v5 offset:6272
    ds_read_b64_tr_b16 v[94:95], v5 offset:7040
    v_mfma_f32_16x16x32_bf16 v[44:47], v[104:107], v[144:147], v[44:47]
    ds_read_b128 v[140:143], v1 offset:128
    ds_read_b128 v[124:127], v1 offset:64
    v_mfma_f32_16x16x32_bf16 v[40:43], v[100:103], v[144:147], v[40:43]
    ds_read_b128 v[128:131], v1 offset:3904
    v_mfma_f32_16x16x32_bf16 v[36:39], v[96:99], v[144:147], v[36:39]
    ds_read_b128 v[144:147], v1 offset:3968
L_mid2:
    s_waitcnt lgkmcnt(10)
    s_setprio 0
.p2align 3
    v_mfma_f32_16x16x32_bf16 v[24:27], v[72:75], v[108:111], v[24:27]
    ds_read_b64_tr_b16 v[96:97], v5 offset:12416
    v_mfma_f32_16x16x32_bf16 v[28:31], v[76:79], v[108:111], v[28:31]
    ds_read_b64_tr_b16 v[98:99], v5 offset:13184
    v_mfma_f32_16x16x32_bf16 v[32:35], v[80:83], v[108:111], v[32:35]
    ds_read_b64_tr_b16 v[100:101], v5 offset:12448
    v_mfma_f32_16x16x32_bf16 v[44:47], v[80:83], v[112:115], v[44:47]
    ds_read_b64_tr_b16 v[102:103], v5 offset:13216
    v_mfma_f32_16x16x32_bf16 v[40:43], v[76:79], v[112:115], v[40:43]
    ds_read_b64_tr_b16 v[104:105], v5 offset:12480
    v_mfma_f32_16x16x32_bf16 v[36:39], v[72:75], v[112:115], v[36:39]
    ds_read_b64_tr_b16 v[106:107], v5 offset:13248
    s_add_u32 s35, s35, 1
    v_add_u32 v17, 3840, v1
    s_and_b32 s36, s35, 3
    v_mov_b32 v1, v2
    s_mul_i32 s36, s36, 18624
    v_mov_b32 v2, v3
    v_mov_b32 v3, v17
    v_add_u32 v5, s36, v4
L_end2:
    s_bitcmp1_b32 s3, s35
    s_waitcnt vmcnt(0) lgkmcnt(0)
    s_cbranch_scc0 L_top2
    s_bitcmp1_b32 s99, s35
    s_cbranch_scc1 L_sp2
    s_barrier
    s_bitcmp1_b32 s39, s35
    s_cbranch_scc0 L_sp2
    s_call_b64 s[76:77], L_dma
L_sp2:
    s_bitcmp1_b32 s37, s35
    s_cbranch_scc1 L_g2
    s_cmp_lg_u32 s35, 9
    s_cbranch_scc1 L_body2
L_last2:
    s_setprio 3
    v_mfma_f32_16x16x32_bf16 v[24:27], v[84:87], v[124:127], v[24:27]
    s_add_u32 s96, s0, s29
    s_mul_i32 s96, s96, 224
    s_add_u32 s96, s96, s32
    v_mfma_f32_16x16x32_bf16 v[28:31], v[88:91], v[124:127], v[28:31]
    s_mul_i32 s96, s96, 192
    s_add_u32 s97, s96, 86016
    s_add_u32 s98, s29, 2
    v_mfma_f32_16x16x32_bf16 v[32:35], v[92:95], v[124:127], v[32:35]
    v_mfma_f32_16x16x32_bf16 v[24:27], v[96:99], v[140:143], v[24:27]
    v_mfma_f32_16x16x32_bf16 v[28:31], v[100:103], v[140:143], v[28:31]
    v_mfma_f32_16x16x32_bf16 v[32:35], v[104:107], v[140:143], v[32:35]
    v_mfma_f32_16x16x32_bf16 v[36:39], v[84:87], v[128:131], v[36:39]
    v_mfma_f32_16x16x32_bf16 v[40:43], v[88:91], v[128:131], v[40:43]
    v_mfma_f32_16x16x32_bf16 v[44:47], v[92:95], v[128:131], v[44:47]
    s_nop 2
    v_cvt_pk_bf16_f32 v156, v24, v25
    v_cvt_pk_bf16_f32 v157, v26, v27
    ds_write_b64 v21, v[156:157] offset:0
    v_mfma_f32_16x16x32_bf16 v[36:39], v[96:99], v[144:147], v[36:39]
    v_cvt_pk_bf16_f32 v158, v28, v29
    v_cvt_pk_bf16_f32 v159, v30, v31
    ds_write_b64 v21, v[158:159] offset:32
    v_mfma_f32_16x16x32_bf16 v[40:43], v[100:103], v[144:147], v[40:43]
    v_cvt_pk_bf16_f32 v160, v32, v33
    v_cvt_pk_bf16_f32 v161, v34, v35
    ds_write_b64 v21, v[160:161] offset:64
    v_mfma_f32_16x16x32_bf16 v[44:47], v[104:107], v[144:147], v[44:47]
    v_cvt_pk_bf16_f32 v162, v36, v37
    v_cvt_pk_bf16_f32 v163, v38, v39
    ds_write_b64 v21, v[162:163] offset:3840
    s_nop 0
    v_cvt_pk_bf16_f32 v164, v40, v41
    v_cvt_pk_bf16_f32 v165, v42, v43
    ds_write_b64 v21, v[164:165] offset:3872
    s_nop 0
    v_cvt_pk_bf16_f32 v166, v44, v45
    v_cvt_pk_bf16_f32 v167, v46, v47
    ds_write_b64 v21, v[166:167] offset:3904
    s_branch L_epi
.p2align 3
L_top1:
    s_barrier
L_body1:
    s_setprio 2
.p2align 3
    v_mfma_f32_16x16x32_bf16 v[24:27], v[84:87], v[124:127], v[24:27]
    ds_read_b128 v[108:111], v1 offset:0
    v_mfma_f32_16x16x32_bf16 v[28:31], v[88:91], v[124:127], v[28:31]
    ds_read_b64_tr_b16 v[72:73], v5 offset:0
    v_mfma_f32_16x16x32_bf16 v[32:35], v[92:95], v[124:127], v[32:35]
    ds_read_b64_tr_b16 v[74:75], v5 offset:768
    ds_read_b64_tr_b16 v[76:77], v5 offset:32
    ds_read_b64_tr_b16 v[78:79], v5 offset:800
    ds_read_b64_tr_b16 v[80:81], v5 offset:64
    ds_read_b64_tr_b16 v[82:83], v5 offset:832
    s_setprio 1
.p2align 3
    v_mfma_f32_16x16x32_bf16 v[24:27], v[96:99], v[140:143], v[24:27]
    ds_read_b64_tr_b16 v[84:85], v5 offset:6208
    ds_read_b64_tr_b16 v[86:87], v5 offset:6976
    ds_read_b64_tr_b16 v[88:89], v5 offset:6240
    v_mfma_f32_16x16x32_bf16 v[28:31], v[100:103], v[140:143], v[28:31]
    ds_read_b64_tr_b16 v[90:91], v5 offset:7008
    ds_read_b64_tr_b16 v[92:93], v5 offset:6272
    ds_read_b64_tr_b16 v[94:95], v5 offset:7040
    v_mfma_f32_16x16x32_bf16 v[32:35], v[104:107], v[140:143], v[32:35]
    ds_read_b128 v[124:127], v1 offset:64
    ds_read_b128 v[140:143], v1 offset:128
L_mid1:
    s_waitcnt lgkmcnt(8)
    s_setprio 0
.p2align 3
    v_mfma_f32_16x16x32_bf16 v[24:27], v[72:75], v[108:111], v[24:27]
    ds_read_b64_tr_b16 v[96:97], v5 offset:12416
    v_mfma_f32_16x16x32_bf16 v[28:31], v[76:79], v[108:111], v[28:31]
    ds_read_b64_tr_b16 v[98:99], v5 offset:13184
    v_mfma_f32_16x16x32_bf16 v[32:35], v[80:83], v[108:111], v[32:35]
    ds_read_b64_tr_b16 v[100:101], v5 offset:12448
    ds_read_b64_tr_b16 v[102:103], v5 offset:13216
    ds_read_b64_tr_b16 v[104:105], v5 offset:12480
    ds_read_b64_tr_b16 v[106:107], v5 offset:13248
    s_add_u32 s35, s35, 1
    v_add_u32 v17, 3840, v1
    s_and_b32 s36, s35, 3
    v_mov_b32 v1, v2
    s_mul_i32 s36, s36, 18624
    v_mov_b32 v2, v3
    v_mov_b32 v3, v17
    v_add_u32 v5, s36, v4
L_end1:
    s_bitcmp1_b32 s3, s35
    s_waitcnt vmcnt(0) lgkmcnt(0)
    s_cbranch_scc0 L_top1
    s_bitcmp1_b32 s99, s35
    s_cbranch_scc1 L_sp1
    s_barrier
    s_bitcmp1_b32 s39, s35
    s_cbranch_scc0 L_sp1
    s_call_b64 s[76:77], L_dma
L_sp1:
    s_bitcmp1_b32 s37, s35
    s_cbranch_scc1 L_g1
    s_cmp_lg_u32 s35, 9
    s_cbranch_scc1 L_body1
L_last1:
    s_setprio 3
    v_mfma_f32_16x16x32_bf16 v[24:27], v[84:87], v[124:127], v[24:27]
    s_add_u32 s96, s0, s29
    s_mul_i32 s96, s96, 224
    s_add_u32 s96, s96, s32
    v_mfma_f32_16x16x32_bf16 v[28:31], v[88:91], v[124:127], v[28:31]
    s_mul_i32 s96, s96, 192
    s_add_u32 s97, s96, 86016
    s_add_u32 s98, s29, 2
    v_mfma_f32_16x16x32_bf16 v[32:35], v[92:95], v[124:127], v[32:35]
    v_mfma_f32_16x16x32_bf16 v[24:27], v[96:99], v[140:143], v[24:27]
    v_mfma_f32_16x16x32_bf16 v[28:31], v[100:103], v[140:143], v[28:31]
    v_mfma_f32_16x16x32_bf16 v[32:35], v[104:107], v[140:143], v[32:35]
    s_nop 5
    v_cvt_pk_bf16_f32 v156, v24, v25
    v_cvt_pk_bf16_f32 v157, v26, v27
    ds_write_b64 v21, v[156:157] offset:0
    v_cvt_pk_bf16_f32 v158, v28, v29
    v_cvt_pk_bf16_f32 v159, v30, v31
    ds_write_b64 v21, v[158:159] offset:32
    v_cvt_pk_bf16_f32 v160, v32, v33
    v_cvt_pk_bf16_f32 v161, v34, v35
    ds_write_b64 v21, v[160:161] offset:64
    s_branch L_epi
L_cold:
L_dfall:
    s_cmp_lt_u32 s28, 4
    s_cbranch_scc1 L_df1
    s_barrier
    s_mov_b32 s30, 0
    s_add_u32 m0, s90, 20672
    s_mov_b32 s96, 20480
    buffer_load_dwordx4 v19, s[12:15], s96 offen lds
    s_add_u32 m0, s88, 24832
    s_mov_b32 s96, 24576
    buffer_load_dwordx4 v19, s[12:15], s96 offen lds
    s_add_u32 m0, s89, 28960
    s_mov_b32 s96, 28672
    buffer_load_dwordx4 v19, s[12:15], s96 offen lds
    s_add_u32 m0, s90, 33088
    s_mov_b32 s96, 32768
    buffer_load_dwordx4 v19, s[12:15], s96 offen lds
    s_add_u32 m0, s88, 37248
    s_mov_b32 s96, 36864
    buffer_load_dwordx4 v19, s[12:15], s96 offen lds
    s_add_u32 m0, s89, 41376
    s_mov_b32 s96, 40960
    buffer_load_dwordx4 v19, s[12:15], s96 offen lds
    s_add_u32 m0, s90, 45504
    s_mov_b32 s96, 45056
    buffer_load_dwordx4 v19, s[12:15], s96 offen lds
    s_add_u32 m0, s88, 49664
    s_mov_b32 s96, 49152
    buffer_load_dwordx4 v19, s[12:15], s96 offen lds
    s_add_u32 m0, s89, 53792
    s_mov_b32 s96, 53248
    buffer_load_dwordx4 v19, s[12:15], s96 offen lds
    s_add_u32 m0, s90, 57920
    s_mov_b32 s96, 57344
    buffer_load_dwordx4 v19, s[12:15], s96 offen lds
    s_add_u32 m0, s88, 62080
    s_mov_b32 s96, 61440
    buffer_load_dwordx4 v19, s[12:15], s96 offen lds
    s_add_u32 m0, s89, 66208
    s_mov_b32 s96, 65536
    buffer_load_dwordx4 v19, s[12:15], s96 offen lds
    s_add_u32 m0, s90, 70336
    s_mov_b32 s96, 69632
    buffer_load_dwordx4 v19, s[12:15], s96 offen lds
    s_waitcnt vmcnt(0)
    s_barrier
    s_barrier
    s_branch L_mid0
L_df1:
    s_waitcnt vmcnt(0)
    s_barrier
    s_cmp_eq_u32 s30, 0
    s_cbranch_scc1 L_mid0
    s_movk_i32 s37, 0x1ff
    s_or_b32 s3, s3, s37
    s_bfm_b32 s63, s30, 0
    s_mul_i32 s62, s63, 0x11111111
    s_branch L_gfirst
L_trip:
    s_getpc_b64 s[40:41]
L_pc2:
    s_sub_u32 s40, s40, L_pc2-L_pc
    s_subb_u32 s41, s41, 0
    s_waitcnt lgkmcnt(0)
    global_load_dwordx4 v[224:227], v0, s[40:41] offset:-1024
    global_load_dwordx4 v[232:235], v0, s[40:41] offset:0
    global_load_dwordx4 v[12:15], v0, s[40:41] offset:1024
    global_load_dwordx4 v[8:11], v0, s[40:41] offset:2048
    v_lshrrev_b32 v228, 4, v16
    v_mul_u32_u24 v228, 12, v228
    s_mul_i32 s3, s0, 224
    s_add_u32 s3, s3, s32
    s_mul_i32 s3, s3, 36
    s_cmp_gt_u32 s30, 0
    s_cselect_b32 s96, s3, 2130706432
    s_addk_i32 s3, 8064
    buffer_load_dwordx3 v[204:206], v228, s[8:11], s96 offen
    s_cmp_gt_u32 s30, 1
    s_cselect_b32 s96, s3, 2130706432
    s_addk_i32 s3, 8064
    buffer_load_dwordx3 v[208:210], v228, s[8:11], s96 offen
    s_cmp_gt_u32 s30, 2
    s_cselect_b32 s96, s3, 2130706432
    s_addk_i32 s3, 8064
    buffer_load_dwordx3 v[212:214], v228, s[8:11], s96 offen
    s_cmp_gt_u32 s30, 3
    s_cselect_b32 s96, s3, 2130706432
    s_addk_i32 s3, 8064
    buffer_load_dwordx3 v[216:218], v228, s[8:11], s96 offen
    s_mov_b32 s74, s0
    s_lshr_b32 s97, s28, 1
    s_lshl_b32 s97, s97, 4
    s_lshr_b64 s[70:71], s[24:25], s97
    s_bfe_u32 s69, s70, 0x5000b
    s_and_b32 s68, s70, 0x7ff
    s_lshl_b32 s69, s69, 2
    s_lshl_b32 s68, s68, 6
    s_mov_b32 s66, s68
    s_waitcnt vmcnt(0)
    v_cvt_f32_u32 v222, s32
    v_cvt_f32_u32 v220, s74
    v_bfe_u32 v238, v226, 8, 8
    v_add_f32 v221, v222, v224
    v_add_f32 v220, v220, v225
    v_and_b32 v251, 0xffff, v235
    v_add_f32 v222, 1.0, v221
    v_add_f32 v223, 2.0, v221
    v_mov_b32 v236, 0xf000f00
    s_mov_b32 s91, 0x435f435f
    s_mov_b32 exec_hi, 0xffff
    v_mov_b32 v237, v220
    v_lshlrev_b32 v72, 16, v204
    v_lshlrev_b32 v156, 16, v205
    v_lshlrev_b32 v180, 16, v206
    v_and_b32 v73, 0xffff0000, v204
    v_and_b32 v157, 0xffff0000, v205
    v_and_b32 v181, 0xffff0000, v206
    v_cvt_pk_bf16_f32 v74, v237, v221
    v_cvt_pk_bf16_f32 v158, v237, v222
    v_cvt_pk_bf16_f32 v182, v237, v223
    v_add_f32 v72, v72, v237
    v_add_f32 v156, v156, v237
    v_add_f32 v180, v180, v237
    v_add_f32 v73, v73, v221
    v_add_f32 v157, v157, v222
    v_add_f32 v181, v181, v223
    v_cvt_pk_bf16_f32 v72, v72, v73
    v_cvt_pk_bf16_f32 v156, v156, v157
    v_cvt_pk_bf16_f32 v180, v180, v181
    v_cmp_ne_u32 s[40:41], v72, v74
    v_cmp_ne_u32 s[42:43], v156, v158
    v_cmp_ne_u32 s[44:45], v180, v182
    v_add_f32 v237, 1.0, v237
    v_lshlrev_b32 v72, 16, v208
    v_lshlrev_b32 v156, 16, v209
    v_lshlrev_b32 v180, 16, v210
    v_and_b32 v73, 0xffff0000, v208
    v_and_b32 v157, 0xffff0000, v209
    v_and_b32 v181, 0xffff0000, v210
    v_cvt_pk_bf16_f32 v74, v237, v221
    v_cvt_pk_bf16_f32 v158, v237, v222
    v_cvt_pk_bf16_f32 v182, v237, v223
    v_add_f32 v72, v72, v237
    v_add_f32 v156, v156, v237
    v_add_f32 v180, v180, v237
    v_add_f32 v73, v73, v221
    v_add_f32 v157, v157, v222
    v_add_f32 v181, v181, v223
    v_cvt_pk_bf16_f32 v72, v72, v73
    v_cvt_pk_bf16_f32 v156, v156, v157
    v_cvt_pk_bf16_f32 v180, v180, v181
    v_cmp_ne_u32 s[46:47], v72, v74
    v_cmp_ne_u32 s[48:49], v156, v158
    v_cmp_ne_u32 s[50:51], v180, v182
    v_add_f32 v237, 1.0, v237
    v_lshlrev_b32 v72, 16, v212
    v_lshlrev_b32 v156, 16, v213
    v_lshlrev_b32 v180, 16, v214
    v_and_b32 v73, 0xffff0000, v212
    v_and_b32 v157, 0xffff0000, v213
    v_and_b32 v181, 0xffff0000, v214
    v_cvt_pk_bf16_f32 v74, v237, v221
    v_cvt_pk_bf16_f32 v158, v237, v222
    v_cvt_pk_bf16_f32 v182, v237, v223
    v_add_f32 v72, v72, v237
    v_add_f32 v156, v156, v237
    v_add_f32 v180, v180, v237
    v_add_f32 v73, v73, v221
    v_add_f32 v157, v157, v222
    v_add_f32 v181, v181, v223
    v_cvt_pk_bf16_f32 v72, v72, v73
    v_cvt_pk_bf16_f32 v156, v156, v157
    v_cvt_pk_bf16_f32 v180, v180, v181
    v_cmp_ne_u32 s[52:53], v72, v74
    v_cmp_ne_u32 s[54:55], v156, v158
    v_cmp_ne_u32 s[56:57], v180, v182
    v_add_f32 v237, 1.0, v237
    v_lshlrev_b32 v72, 16, v216
    v_lshlrev_b32 v156, 16, v217
    v_lshlrev_b32 v180, 16, v218
    v_and_b32 v73, 0xffff0000, v216
    v_and_b32 v157, 0xffff0000, v217
    v_and_b32 v181, 0xffff0000, v218
    v_cvt_pk_bf16_f32 v74, v237, v221
    v_cvt_pk_bf16_f32 v158, v237, v222
    v_cvt_pk_bf16_f32 v182, v237, v223
    v_add_f32 v72, v72, v237
    v_add_f32 v156, v156, v237
    v_add_f32 v180, v180, v237
    v_add_f32 v73, v73, v221
    v_add_f32 v157, v157, v222
    v_add_f32 v181, v181, v223
    v_cvt_pk_bf16_f32 v72, v72, v73
    v_cvt_pk_bf16_f32 v156, v156, v157
    v_cvt_pk_bf16_f32 v180, v180, v181
    v_cmp_ne_u32 s[58:59], v72, v74
    v_cmp_ne_u32 s[60:61], v156, v158
    v_cmp_ne_u32 s[62:63], v180, v182
    s_mov_b32 exec_hi, -1
    s_mov_b32 s37, 0
    s_mov_b32 s97, 0
    s_mov_b32 s98, 0
    s_mov_b32 s38, 2
    s_mov_b32 s69, 0
    s_mov_b32 s64, 0x24924924
    s_mov_b32 s65, 0x9249
    s_and_b64 s[70:71], s[62:63], s[64:65]
    s_addc_u32 s98, s98, s98
    s_and_b64 s[70:71], s[56:57], s[64:65]
    s_addc_u32 s98, s98, s98
    s_and_b64 s[70:71], s[50:51], s[64:65]
    s_addc_u32 s98, s98, s98
    s_and_b64 s[70:71], s[44:45], s[64:65]
    s_addc_u32 s98, s98, s98
    s_and_b32 s96, s98, 15
    s_addc_u32 s37, s37, s37
    s_and_b64 s[70:71], s[60:61], s[64:65]
    s_addc_u32 s97, s97, s97
    s_and_b64 s[70:71], s[54:55], s[64:65]
    s_addc_u32 s97, s97, s97
    s_and_b64 s[70:71], s[48:49], s[64:65]
    s_addc_u32 s97, s97, s97
    s_and_b64 s[70:71], s[42:43], s[64:65]
    s_addc_u32 s97, s97, s97
    s_and_b32 s96, s97, 15
    s_addc_u32 s37, s37, s37
    s_and_b64 s[70:71], s[58:59], s[64:65]
    s_addc_u32 s97, s97, s97
    s_and_b64 s[70:71], s[52:53], s[64:65]
    s_addc_u32 s97, s97, s97
    s_and_b64 s[70:71], s[46:47], s[64:65]
    s_addc_u32 s97, s97, s97
    s_and_b64 s[70:71], s[40:41], s[64:65]
    s_addc_u32 s97, s97, s97
    s_and_b32 s96, s97, 15
    s_addc_u32 s37, s37, s37
    s_mov_b32 s64, 0x92492492
    s_mov_b32 s65, 0x4924
    s_and_b64 s[70:71], s[62:63], s[64:65]
    s_addc_u32 s97, s97, s97
    s_and_b64 s[70:71], s[56:57], s[64:65]
    s_addc_u32 s97, s97, s97
    s_and_b64 s[70:71], s[50:51], s[64:65]
    s_addc_u32 s97, s97, s97
    s_and_b64 s[70:71], s[44:45], s[64:65]
    s_addc_u32 s97, s97, s97
    s_and_b32 s96, s97, 15
    s_addc_u32 s37, s37, s37
    s_and_b64 s[70:71], s[60:61], s[64:65]
    s_addc_u32 s97, s97, s97
    s_and_b64 s[70:71], s[54:55], s[64:65]
    s_addc_u32 s97, s97, s97
    s_and_b64 s[70:71], s[48:49], s[64:65]
    s_addc_u32 s97, s97, s97
    s_and_b64 s[70:71], s[42:43], s[64:65]
    s_addc_u32 s97, s97, s97
    s_and_b32 s96, s97, 15
    s_addc_u32 s37, s37, s37
    s_and_b64 s[70:71], s[58:59], s[64:65]
    s_addc_u32 s97, s97, s97
    s_and_b64 s[70:71], s[52:53], s[64:65]
    s_addc_u32 s97, s97, s97
    s_and_b64 s[70:71], s[46:47], s[64:65]
    s_addc_u32 s97, s97, s97
    s_and_b64 s[70:71], s[40:41], s[64:65]
    s_addc_u32 s97, s97, s97
    s_and_b32 s96, s97, 15
    s_addc_u32 s37, s37, s37
    s_mov_b32 s64, 0x49249249
    s_mov_b32 s65, 0x2492
    s_and_b64 s[70:71], s[62:63], s[64:65]
    s_addc_u32 s97, s97, s97
    s_and_b64 s[70:71], s[56:57], s[64:65]
    s_addc_u32 s97, s97, s97
    s_and_b64 s[70:71], s[50:51], s[64:65]
    s_addc_u32 s97, s97, s97
    s_and_b64 s[70:71], s[44:45], s[64:65]
    s_addc_u32 s97, s97, s97
    s_and_b32 s96, s97, 15
    s_addc_u32 s37, s37, s37
    s_and_b64 s[70:71], s[60:61], s[64:65]
    s_addc_u32 s97, s97, s97
    s_and_b64 s[70:71], s[54:55], s[64:65]
    s_addc_u32 s97, s97, s97
    s_and_b64 s[70:71], s[48:49], s[64:65]
    s_addc_u32 s97, s97, s97
    s_and_b64 s[70:71], s[42:43], s[64:65]
    s_addc_u32 s97, s97, s97
    s_and_b32 s96, s97, 15
    s_addc_u32 s37, s37, s37
    s_and_b64 s[70:71], s[58:59], s[64:65]
    s_addc_u32 s97, s97, s97
    s_and_b64 s[70:71], s[52:53], s[64:65]
    s_addc_u32 s97, s97, s97
    s_and_b64 s[70:71], s[46:47], s[64:65]
    s_addc_u32 s97, s97, s97
    s_and_b64 s[70:71], s[40:41], s[64:65]
    s_addc_u32 s97, s97, s97
    s_and_b32 s96, s97, 15
    s_addc_u32 s37, s37, s37
    s_mov_b32 s62, s97
    s_mov_b32 s63, s98
    s_bfm_b32 s40, s30, 0
    s_bfe_u32 s96, s23, 0x50018
    s_sub_u32 s96, s96, 1
    s_bfe_u32 s73, s23, 0x40014
    s_cmp_lt_u32 s28, 4
    s_cselect_b32 s70, 7, 14
    s_cselect_b32 s71, 14, 15
    s_cselect_b32 s72, 15, 15
    s_cselect_b32 s73, 0, s73
    s_min_u32 s70, s70, s96
    s_min_u32 s71, s71, s96
    s_min_u32 s72, s72, s96
    s_sub_u32 s72, s72, s73
    v_mov_b32 v230, s70
    v_mov_b32 v229, s71
    v_cmp_eq_u32 vcc, 1, v238
    v_mov_b32 v17, s72
    s_nop 0
    v_cndmask_b32 v230, v230, v229, vcc
    v_cmp_eq_u32 vcc, 2, v238
    v_mov_b32 v229, s73
    s_nop 0
    v_cndmask_b32 v230, v230, v17, vcc
    v_cndmask_b32 v229, 0, v229, vcc
    s_or_b32 s3, s37, s39
    s_or_b32 s3, s3, s99
    s_or_b32 s3, s3, 512
    s_call_b64 s[76:77], L_tables
L_gfirst:
    s_bitcmp1_b32 s37, 0
    s_cbranch_scc0 L_nfirst
    s_call_b64 s[76:77], L_H0
    ds_read_b128 v[108:111], v1 offset:0
    ds_read_b64_tr_b16 v[72:73], v5 offset:0
    ds_read_b64_tr_b16 v[74:75], v5 offset:768
    ds_read_b64_tr_b16 v[76:77], v5 offset:32
    ds_read_b64_tr_b16 v[78:79], v5 offset:800
    ds_read_b64_tr_b16 v[80:81], v5 offset:64
    ds_read_b64_tr_b16 v[82:83], v5 offset:832
    ds_read_b128 v[112:115], v1 offset:3840
    ds_read_b128 v[116:119], v1 offset:7680
    ds_read_b128 v[120:123], v1 offset:11520
    s_waitcnt lgkmcnt(10)
    s_call_b64 s[76:77], L_H1
    ds_read_b64_tr_b16 v[84:85], v5 offset:6208
    ds_read_b64_tr_b16 v[86:87], v5 offset:6976
    ds_read_b64_tr_b16 v[88:89], v5 offset:6240
    ds_read_b64_tr_b16 v[90:91], v5 offset:7008
    ds_read_b64_tr_b16 v[92:93], v5 offset:6272
    ds_read_b64_tr_b16 v[94:95], v5 offset:7040
    ds_read_b128 v[124:127], v1 offset:64
    ds_read_b128 v[128:131], v1 offset:3904
    ds_read_b128 v[132:135], v1 offset:7744
    ds_read_b128 v[136:139], v1 offset:11584
    ds_read_b128 v[140:143], v1 offset:128
    ds_read_b128 v[144:147], v1 offset:3968
    ds_read_b128 v[148:151], v1 offset:7808
    ds_read_b128 v[152:155], v1 offset:11648
    s_waitcnt lgkmcnt(14)
    s_call_b64 s[76:77], L_H2
    s_branch L_fdisp
L_H0:
    s_lshl_b32 s97, s35, 2
    s_lshr_b64 s[70:71], s[62:63], s97
    s_and_b32 s98, s70, 15
    s_lshl_b32 s97, s35, 7
    s_bcnt1_i32_b32 s48, s98
    s_ff1_i32_b32 s44, s98
    s_mul_i32 s96, s44, 1152
    s_add_u32 s96, s96, s97
    v_add_u32 v7, s96, v6
    s_bitset0_b32 s98, s44
    ds_read_b64 v[236:237], v7
    s_cmp_eq_u32 s98, 0
    s_cbranch_scc1 L_H0r
    s_ff1_i32_b32 s45, s98
    s_mul_i32 s96, s45, 1152
    s_add_u32 s96, s96, s97
    v_add_u32 v7, s96, v6
    s_bitset0_b32 s98, s45
    ds_read_b64 v[238:239], v7
    s_cmp_eq_u32 s98, 0
    s_cbranch_scc1 L_H0r
    s_ff1_i32_b32 s46, s98
    s_mul_i32 s96, s46, 1152
    s_add_u32 s96, s96, s97
    v_add_u32 v7, s96, v6
    s_bitset0_b32 s98, s46
    ds_read_b64 v[240:241], v7
    s_cmp_eq_u32 s98, 0
    s_cbranch_scc1 L_H0r
    s_ff1_i32_b32 s47, s98
    s_mul_i32 s96, s47, 1152
    s_add_u32 s96, s96, s97
    v_add_u32 v7, s96, v6
    s_bitset0_b32 s98, s47
    ds_read_b64 v[242:243], v7
L_H0r:
    s_setpc_b64 s[76:77]
L_H1:
    v_cmp_eq_u32 vcc, 2, v236
    v_and_b32 v236, -4, v236
    s_or_b32 s50, vcc_lo, vcc_hi
    v_xor_b32_sdwa v244, v236, v12 dst_sel:DWORD dst_unused:UNUSED_PAD src0_sel:WORD_0 src1_sel:DWORD
    v_xor_b32_sdwa v246, v236, v12 dst_sel:DWORD dst_unused:UNUSED_PAD src0_sel:WORD_1 src1_sel:DWORD
    v_xor_b32_sdwa v245, v236, v13 dst_sel:DWORD dst_unused:UNUSED_PAD src0_sel:WORD_0 src1_sel:DWORD
    v_xor_b32_sdwa v247, v236, v13 dst_sel:DWORD dst_unused:UNUSED_PAD src0_sel:WORD_1 src1_sel:DWORD
    ds_read_b64_tr_b16 v[156:157], v244 offset:0
    ds_read_b64_tr_b16 v[158:159], v246 offset:0
    ds_read_b64_tr_b16 v[160:161], v245 offset:0
    ds_read_b64_tr_b16 v[162:163], v247 offset:0
    ds_read_b64_tr_b16 v[164:165], v244 offset:64
    ds_read_b64_tr_b16 v[166:167], v246 offset:64
    ds_read_b64_tr_b16 v[168:169], v245 offset:64
    ds_read_b64_tr_b16 v[170:171], v247 offset:64
    ds_read_b64_tr_b16 v[172:173], v244 offset:128
    ds_read_b64_tr_b16 v[174:175], v246 offset:128
    ds_read_b64_tr_b16 v[176:177], v245 offset:128
    ds_read_b64_tr_b16 v[178:179], v247 offset:128
    v_perm_b32 v228, v237, v237, v8
    v_perm_b32 v229, v237, v237, v9
    v_perm_b32 v230, v237, v237, v10
    v_perm_b32 v231, v237, v237, v11
    s_cmp_eq_u32 s48, 1
    s_cbranch_scc1 L_H0r
    v_cmp_eq_u32 vcc, 2, v238
    v_and_b32 v238, -4, v238
    s_or_b32 s51, vcc_lo, vcc_hi
    v_xor_b32_sdwa v244, v238, v12 dst_sel:DWORD dst_unused:UNUSED_PAD src0_sel:WORD_0 src1_sel:DWORD
    v_xor_b32_sdwa v246, v238, v12 dst_sel:DWORD dst_unused:UNUSED_PAD src0_sel:WORD_1 src1_sel:DWORD
    v_xor_b32_sdwa v245, v238, v13 dst_sel:DWORD dst_unused:UNUSED_PAD src0_sel:WORD_0 src1_sel:DWORD
    v_xor_b32_sdwa v247, v238, v13 dst_sel:DWORD dst_unused:UNUSED_PAD src0_sel:WORD_1 src1_sel:DWORD
    ds_read_b64_tr_b16 v[180:181], v244 offset:0
    ds_read_b64_tr_b16 v[182:183], v246 offset:0
    ds_read_b64_tr_b16 v[184:185], v245 offset:0
    ds_read_b64_tr_b16 v[186:187], v247 offset:0
    ds_read_b64_tr_b16 v[188:189], v244 offset:64
    ds_read_b64_tr_b16 v[190:191], v246 offset:64
    ds_read_b64_tr_b16 v[192:193], v245 offset:64
    ds_read_b64_tr_b16 v[194:195], v247 offset:64
    ds_read_b64_tr_b16 v[196:197], v244 offset:128
    ds_read_b64_tr_b16 v[198:199], v246 offset:128
    ds_read_b64_tr_b16 v[200:201], v245 offset:128
    ds_read_b64_tr_b16 v[202:203], v247 offset:128
    v_perm_b32 v232, v239, v239, v8
    v_perm_b32 v233, v239, v239, v9
    v_perm_b32 v234, v239, v239, v10
    v_perm_b32 v235, v239, v239, v11
    s_setpc_b64 s[76:77]
L_H2:
    s_mov_b32 s49, s44
    s_cmp_eq_u32 s50, 0
    s_cbranch_scc1 L_in0
    s_call_b64 s[78:79], L_slow0
    s_branch L_ie0
L_in0:
    v_mfma_f32_16x16x32_bf16 v[204:207], v[156:159], v[228:231], 0
    v_mfma_f32_16x16x32_bf16 v[208:211], v[160:163], v[228:231], 0
    v_mfma_f32_16x16x32_bf16 v[212:215], v[164:167], v[228:231], 0
    v_mfma_f32_16x16x32_bf16 v[216:219], v[168:171], v[228:231], 0
    v_mfma_f32_16x16x32_bf16 v[220:223], v[172:175], v[228:231], 0
    v_mfma_f32_16x16x32_bf16 v[224:227], v[176:179], v[228:231], 0
L_ie0:
    s_cmp_le_u32 s48, 2
    s_cbranch_scc1 L_H2a0
    v_cmp_eq_u32 vcc, 2, v240
    v_and_b32 v240, -4, v240
    s_or_b32 s50, vcc_lo, vcc_hi
    v_xor_b32_sdwa v244, v240, v12 dst_sel:DWORD dst_unused:UNUSED_PAD src0_sel:WORD_0 src1_sel:DWORD
    v_xor_b32_sdwa v246, v240, v12 dst_sel:DWORD dst_unused:UNUSED_PAD src0_sel:WORD_1 src1_sel:DWORD
    v_xor_b32_sdwa v245, v240, v13 dst_sel:DWORD dst_unused:UNUSED_PAD src0_sel:WORD_0 src1_sel:DWORD
    v_xor_b32_sdwa v247, v240, v13 dst_sel:DWORD dst_unused:UNUSED_PAD src0_sel:WORD_1 src1_sel:DWORD
    ds_read_b64_tr_b16 v[156:157], v244 offset:0
    ds_read_b64_tr_b16 v[158:159], v246 offset:0
    ds_read_b64_tr_b16 v[160:161], v245 offset:0
    ds_read_b64_tr_b16 v[162:163], v247 offset:0
    ds_read_b64_tr_b16 v[164:165], v244 offset:64
    ds_read_b64_tr_b16 v[166:167], v246 offset:64
    ds_read_b64_tr_b16 v[168:169], v245 offset:64
    ds_read_b64_tr_b16 v[170:171], v247 offset:64
    ds_read_b64_tr_b16 v[172:173], v244 offset:128
    ds_read_b64_tr_b16 v[174:175], v246 offset:128
    ds_read_b64_tr_b16 v[176:177], v245 offset:128
    ds_read_b64_tr_b16 v[178:179], v247 offset:128
    v_perm_b32 v228, v241, v241, v8
    v_perm_b32 v229, v241, v241, v9
    v_perm_b32 v230, v241, v241, v10
    v_perm_b32 v231, v241, v241, v11
    s_waitcnt lgkmcnt(12)
    s_branch L_H2b0
L_H2a0:
    s_waitcnt lgkmcnt(0)
L_H2b0:
    s_call_b64 s[78:79], L_V
    s_cmp_eq_u32 s48, 1
    s_cbranch_scc1 L_H0r
    s_mov_b32 s49, s45
    s_cmp_eq_u32 s51, 0
    s_cbranch_scc1 L_in1
    s_call_b64 s[78:79], L_slow1
    s_branch L_ie1
L_in1:
    v_mfma_f32_16x16x32_bf16 v[204:207], v[180:183], v[232:235], 0
    v_mfma_f32_16x16x32_bf16 v[208:211], v[184:187], v[232:235], 0
    v_mfma_f32_16x16x32_bf16 v[212:215], v[188:191], v[232:235], 0
    v_mfma_f32_16x16x32_bf16 v[216:219], v[192:195], v[232:235], 0
    v_mfma_f32_16x16x32_bf16 v[220:223], v[196:199], v[232:235], 0
    v_mfma_f32_16x16x32_bf16 v[224:227], v[200:203], v[232:235], 0
L_ie1:
    s_cmp_le_u32 s48, 3
    s_cbranch_scc1 L_H2a1
    v_cmp_eq_u32 vcc, 2, v242
    v_and_b32 v242, -4, v242
    s_or_b32 s51, vcc_lo, vcc_hi
    v_xor_b32_sdwa v244, v242, v12 dst_sel:DWORD dst_unused:UNUSED_PAD src0_sel:WORD_0 src1_sel:DWORD
    v_xor_b32_sdwa v246, v242, v12 dst_sel:DWORD dst_unused:UNUSED_PAD src0_sel:WORD_1 src1_sel:DWORD
    v_xor_b32_sdwa v245, v242, v13 dst_sel:DWORD dst_unused:UNUSED_PAD src0_sel:WORD_0 src1_sel:DWORD
    v_xor_b32_sdwa v247, v242, v13 dst_sel:DWORD dst_unused:UNUSED_PAD src0_sel:WORD_1 src1_sel:DWORD
    ds_read_b64_tr_b16 v[180:181], v244 offset:0
    ds_read_b64_tr_b16 v[182:183], v246 offset:0
    ds_read_b64_tr_b16 v[184:185], v245 offset:0
    ds_read_b64_tr_b16 v[186:187], v247 offset:0
    ds_read_b64_tr_b16 v[188:189], v244 offset:64
    ds_read_b64_tr_b16 v[190:191], v246 offset:64
    ds_read_b64_tr_b16 v[192:193], v245 offset:64
    ds_read_b64_tr_b16 v[194:195], v247 offset:64
    ds_read_b64_tr_b16 v[196:197], v244 offset:128
    ds_read_b64_tr_b16 v[198:199], v246 offset:128
    ds_read_b64_tr_b16 v[200:201], v245 offset:128
    ds_read_b64_tr_b16 v[202:203], v247 offset:128
    v_perm_b32 v232, v243, v243, v8
    v_perm_b32 v233, v243, v243, v9
    v_perm_b32 v234, v243, v243, v10
    v_perm_b32 v235, v243, v243, v11
    s_waitcnt lgkmcnt(12)
    s_branch L_H2b1
L_H2a1:
L_H2b1:
    s_call_b64 s[78:79], L_V
    s_cmp_eq_u32 s48, 2
    s_cbranch_scc1 L_H0r
    s_mov_b32 s49, s46
    s_waitcnt lgkmcnt(0)
    s_cmp_eq_u32 s50, 0
    s_cbranch_scc1 L_in2
    s_call_b64 s[78:79], L_slow0
    s_branch L_ie2
L_in2:
    v_mfma_f32_16x16x32_bf16 v[204:207], v[156:159], v[228:231], 0
    v_mfma_f32_16x16x32_bf16 v[208:211], v[160:163], v[228:231], 0
    v_mfma_f32_16x16x32_bf16 v[212:215], v[164:167], v[228:231], 0
    v_mfma_f32_16x16x32_bf16 v[216:219], v[168:171], v[228:231], 0
    v_mfma_f32_16x16x32_bf16 v[220:223], v[172:175], v[228:231], 0
    v_mfma_f32_16x16x32_bf16 v[224:227], v[176:179], v[228:231], 0
L_ie2:
    s_call_b64 s[78:79], L_V
    s_cmp_eq_u32 s48, 3
    s_cbranch_scc1 L_H0r
    s_mov_b32 s49, s47
    s_waitcnt lgkmcnt(0)
    s_cmp_eq_u32 s51, 0
    s_cbranch_scc1 L_in3
    s_call_b64 s[78:79], L_slow1
    s_branch L_ie3
L_in3:
    v_mfma_f32_16x16x32_bf16 v[204:207], v[180:183], v[232:235], 0
    v_mfma_f32_16x16x32_bf16 v[208:211], v[184:187], v[232:235], 0
    v_mfma_f32_16x16x32_bf16 v[212:215], v[188:191], v[232:235], 0
    v_mfma_f32_16x16x32_bf16 v[216:219], v[192:195], v[232:235], 0
    v_mfma_f32_16x16x32_bf16 v[220:223], v[196:199], v[232:235], 0
    v_mfma_f32_16x16x32_bf16 v[224:227], v[200:203], v[232:235], 0
L_ie3:
    s_call_b64 s[78:79], L_V
    s_setpc_b64 s[76:77]
L_V:
    s_cmp_eq_u32 s49, 1
    s_cbranch_scc1 L_V1
    s_cmp_eq_u32 s49, 2
    s_cbranch_scc1 L_V2
    s_cmp_eq_u32 s49, 3
    s_cbranch_scc1 L_V3
L_V0:
    v_cvt_pk_bf16_f32 v108, v204, v205
    v_cvt_pk_bf16_f32 v109, v206, v207
    v_cvt_pk_bf16_f32 v110, v208, v209
    v_cvt_pk_bf16_f32 v111, v210, v211
    v_cvt_pk_bf16_f32 v124, v212, v213
    v_cvt_pk_bf16_f32 v125, v214, v215
    v_permlane32_swap_b32 v108, v110
    v_permlane32_swap_b32 v109, v111
    v_cvt_pk_bf16_f32 v126, v216, v217
    v_cvt_pk_bf16_f32 v127, v218, v219
    v_cvt_pk_bf16_f32 v140, v220, v221
    v_cvt_pk_bf16_f32 v141, v222, v223
    v_permlane32_swap_b32 v124, v126
    v_permlane32_swap_b32 v125, v127
    v_cvt_pk_bf16_f32 v142, v224, v225
    v_cvt_pk_bf16_f32 v143, v226, v227
    s_nop 0
    v_permlane32_swap_b32 v140, v142
    v_permlane32_swap_b32 v141, v143
    s_setpc_b64 s[78:79]
L_V1:
    v_cvt_pk_bf16_f32 v112, v204, v205
    v_cvt_pk_bf16_f32 v113, v206, v207
    v_cvt_pk_bf16_f32 v114, v208, v209
    v_cvt_pk_bf16_f32 v115, v210, v211
    v_cvt_pk_bf16_f32 v128, v212, v213
    v_cvt_pk_bf16_f32 v129, v214, v215
    v_permlane32_swap_b32 v112, v114
    v_permlane32_swap_b32 v113, v115
    v_cvt_pk_bf16_f32 v130, v216, v217
    v_cvt_pk_bf16_f32 v131, v218, v219
    v_cvt_pk_bf16_f32 v144, v220, v221
    v_cvt_pk_bf16_f32 v145, v222, v223
    v_permlane32_swap_b32 v128, v130
    v_permlane32_swap_b32 v129, v131
    v_cvt_pk_bf16_f32 v146, v224, v225
    v_cvt_pk_bf16_f32 v147, v226, v227
    s_nop 0
    v_permlane32_swap_b32 v144, v146
    v_permlane32_swap_b32 v145, v147
    s_setpc_b64 s[78:79]
L_V2:
    v_cvt_pk_bf16_f32 v116, v204, v205
    v_cvt_pk_bf16_f32 v117, v206, v207
    v_cvt_pk_bf16_f32 v118, v208, v209
    v_cvt_pk_bf16_f32 v119, v210, v211
    v_cvt_pk_bf16_f32 v132, v212, v213
    v_cvt_pk_bf16_f32 v133, v214, v215
    v_permlane32_swap_b32 v116, v118
    v_permlane32_swap_b32 v117, v119
    v_cvt_pk_bf16_f32 v134, v216, v217
    v_cvt_pk_bf16_f32 v135, v218, v219
    v_cvt_pk_bf16_f32 v148, v220, v221
    v_cvt_pk_bf16_f32 v149, v222, v223
    v_permlane32_swap_b32 v132, v134
    v_permlane32_swap_b32 v133, v135
    v_cvt_pk_bf16_f32 v150, v224, v225
    v_cvt_pk_bf16_f32 v151, v226, v227
    s_nop 0
    v_permlane32_swap_b32 v148, v150
    v_permlane32_swap_b32 v149, v151
    s_setpc_b64 s[78:79]
L_V3:
    v_cvt_pk_bf16_f32 v120, v204, v205
    v_cvt_pk_bf16_f32 v121, v206, v207
    v_cvt_pk_bf16_f32 v122, v208, v209
    v_cvt_pk_bf16_f32 v123, v210, v211
    v_cvt_pk_bf16_f32 v136, v212, v213
    v_cvt_pk_bf16_f32 v137, v214, v215
    v_permlane32_swap_b32 v120, v122
    v_permlane32_swap_b32 v121, v123
    v_cvt_pk_bf16_f32 v138, v216, v217
    v_cvt_pk_bf16_f32 v139, v218, v219
    v_cvt_pk_bf16_f32 v152, v220, v221
    v_cvt_pk_bf16_f32 v153, v222, v223
    v_permlane32_swap_b32 v136, v138
    v_permlane32_swap_b32 v137, v139
    v_cvt_pk_bf16_f32 v154, v224, v225
    v_cvt_pk_bf16_f32 v155, v226, v227
    s_nop 0
    v_permlane32_swap_b32 v152, v154
    v_permlane32_swap_b32 v153, v155
    s_setpc_b64 s[78:79]
L_g4:
    s_setprio 2
    s_call_b64 s[76:77], L_H0
.p2align 3
    v_mfma_f32_16x16x32_bf16 v[24:27], v[84:87], v[124:127], v[24:27]
    ds_read_b128 v[108:111], v1 offset:0
    v_mfma_f32_16x16x32_bf16 v[28:31], v[88:91], v[124:127], v[28:31]
    ds_read_b64_tr_b16 v[72:73], v5 offset:0
    v_mfma_f32_16x16x32_bf16 v[32:35], v[92:95], v[124:127], v[32:35]
    ds_read_b64_tr_b16 v[74:75], v5 offset:768
    v_mfma_f32_16x16x32_bf16 v[44:47], v[92:95], v[128:131], v[44:47]
    ds_read_b64_tr_b16 v[76:77], v5 offset:32
    v_mfma_f32_16x16x32_bf16 v[40:43], v[88:91], v[128:131], v[40:43]
    ds_read_b64_tr_b16 v[78:79], v5 offset:800
    v_mfma_f32_16x16x32_bf16 v[36:39], v[84:87], v[128:131], v[36:39]
    ds_read_b64_tr_b16 v[80:81], v5 offset:64
    v_mfma_f32_16x16x32_bf16 v[48:51], v[84:87], v[132:135], v[48:51]
    ds_read_b64_tr_b16 v[82:83], v5 offset:832
    v_mfma_f32_16x16x32_bf16 v[52:55], v[88:91], v[132:135], v[52:55]
    ds_read_b128 v[112:115], v1 offset:3840
    v_mfma_f32_16x16x32_bf16 v[56:59], v[92:95], v[132:135], v[56:59]
    ds_read_b128 v[116:119], v1 offset:7680
    v_mfma_f32_16x16x32_bf16 v[68:71], v[92:95], v[136:139], v[68:71]
    ds_read_b128 v[120:123], v1 offset:11520
    v_mfma_f32_16x16x32_bf16 v[64:67], v[88:91], v[136:139], v[64:67]
    v_mfma_f32_16x16x32_bf16 v[60:63], v[84:87], v[136:139], v[60:63]
    s_waitcnt lgkmcnt(10)
    s_call_b64 s[76:77], L_H1
.p2align 3
    v_mfma_f32_16x16x32_bf16 v[24:27], v[96:99], v[140:143], v[24:27]
    ds_read_b64_tr_b16 v[84:85], v5 offset:6208
    v_mfma_f32_16x16x32_bf16 v[28:31], v[100:103], v[140:143], v[28:31]
    ds_read_b64_tr_b16 v[86:87], v5 offset:6976
    v_mfma_f32_16x16x32_bf16 v[32:35], v[104:107], v[140:143], v[32:35]
    ds_read_b64_tr_b16 v[88:89], v5 offset:6240
    v_mfma_f32_16x16x32_bf16 v[44:47], v[104:107], v[144:147], v[44:47]
    ds_read_b128 v[140:143], v1 offset:128
    v_mfma_f32_16x16x32_bf16 v[40:43], v[100:103], v[144:147], v[40:43]
    ds_read_b64_tr_b16 v[90:91], v5 offset:7008
    v_mfma_f32_16x16x32_bf16 v[36:39], v[96:99], v[144:147], v[36:39]
    ds_read_b64_tr_b16 v[92:93], v5 offset:6272
    v_mfma_f32_16x16x32_bf16 v[48:51], v[96:99], v[148:151], v[48:51]
    ds_read_b128 v[144:147], v1 offset:3968
    v_mfma_f32_16x16x32_bf16 v[52:55], v[100:103], v[148:151], v[52:55]
    ds_read_b64_tr_b16 v[94:95], v5 offset:7040
    v_mfma_f32_16x16x32_bf16 v[56:59], v[104:107], v[148:151], v[56:59]
    ds_read_b128 v[124:127], v1 offset:64
    v_mfma_f32_16x16x32_bf16 v[68:71], v[104:107], v[152:155], v[68:71]
    ds_read_b128 v[148:151], v1 offset:7808
    ds_read_b128 v[128:131], v1 offset:3904
    v_mfma_f32_16x16x32_bf16 v[64:67], v[100:103], v[152:155], v[64:67]
    ds_read_b128 v[132:135], v1 offset:7744
    v_mfma_f32_16x16x32_bf16 v[60:63], v[96:99], v[152:155], v[60:63]
    ds_read_b128 v[136:139], v1 offset:11584
    ds_read_b128 v[152:155], v1 offset:11648
    s_waitcnt lgkmcnt(14)
    s_call_b64 s[76:77], L_H2
    s_branch L_mid4
L_g3:
    s_setprio 2
    s_call_b64 s[76:77], L_H0
.p2align 3
    v_mfma_f32_16x16x32_bf16 v[24:27], v[84:87], v[124:127], v[24:27]
    ds_read_b128 v[108:111], v1 offset:0
    v_mfma_f32_16x16x32_bf16 v[28:31], v[88:91], v[124:127], v[28:31]
    ds_read_b64_tr_b16 v[72:73], v5 offset:0
    v_mfma_f32_16x16x32_bf16 v[32:35], v[92:95], v[124:127], v[32:35]
    ds_read_b64_tr_b16 v[74:75], v5 offset:768
    v_mfma_f32_16x16x32_bf16 v[44:47], v[92:95], v[128:131], v[44:47]
    ds_read_b64_tr_b16 v[76:77], v5 offset:32
    v_mfma_f32_16x16x32_bf16 v[40:43], v[88:91], v[128:131], v[40:43]
    ds_read_b64_tr_b16 v[78:79], v5 offset:800
    v_mfma_f32_16x16x32_bf16 v[36:39], v[84:87], v[128:131], v[36:39]
    ds_read_b64_tr_b16 v[80:81], v5 offset:64
    v_mfma_f32_16x16x32_bf16 v[48:51], v[84:87], v[132:135], v[48:51]
    ds_read_b64_tr_b16 v[82:83], v5 offset:832
    v_mfma_f32_16x16x32_bf16 v[52:55], v[88:91], v[132:135], v[52:55]
    ds_read_b128 v[112:115], v1 offset:3840
    v_mfma_f32_16x16x32_bf16 v[56:59], v[92:95], v[132:135], v[56:59]
    ds_read_b128 v[116:119], v1 offset:7680
    s_waitcnt lgkmcnt(9)
    s_call_b64 s[76:77], L_H1
.p2align 3
    v_mfma_f32_16x16x32_bf16 v[24:27], v[96:99], v[140:143], v[24:27]
    ds_read_b64_tr_b16 v[84:85], v5 offset:6208
    v_mfma_f32_16x16x32_bf16 v[28:31], v[100:103], v[140:143], v[28:31]
    ds_read_b64_tr_b16 v[86:87], v5 offset:6976
    v_mfma_f32_16x16x32_bf16 v[32:35], v[104:107], v[140:143], v[32:35]
    ds_read_b64_tr_b16 v[88:89], v5 offset:6240
    v_mfma_f32_16x16x32_bf16 v[44:47], v[104:107], v[144:147], v[44:47]
    ds_read_b128 v[140:143], v1 offset:128
    ds_read_b64_tr_b16 v[90:91], v5 offset:7008
    v_mfma_f32_16x16x32_bf16 v[40:43], v[100:103], v[144:147], v[40:43]
    ds_read_b64_tr_b16 v[92:93], v5 offset:6272
    v_mfma_f32_16x16x32_bf16 v[36:39], v[96:99], v[144:147], v[36:39]
    ds_read_b64_tr_b16 v[94:95], v5 offset:7040
    v_mfma_f32_16x16x32_bf16 v[48:51], v[96:99], v[148:151], v[48:51]
    ds_read_b128 v[144:147], v1 offset:3968
    ds_read_b128 v[124:127], v1 offset:64
    v_mfma_f32_16x16x32_bf16 v[52:55], v[100:103], v[148:151], v[52:55]
    ds_read_b128 v[128:131], v1 offset:3904
    v_mfma_f32_16x16x32_bf16 v[56:59], v[104:107], v[148:151], v[56:59]
    ds_read_b128 v[132:135], v1 offset:7744
    ds_read_b128 v[148:151], v1 offset:7808
    s_waitcnt lgkmcnt(12)
    s_call_b64 s[76:77], L_H2
    s_branch L_mid3
L_g2:
    s_setprio 2
    s_call_b64 s[76:77], L_H0
.p2align 3
    v_mfma_f32_16x16x32_bf16 v[24:27], v[84:87], v[124:127], v[24:27]
    ds_read_b128 v[108:111], v1 offset:0
    v_mfma_f32_16x16x32_bf16 v[28:31], v[88:91], v[124:127], v[28:31]
    ds_read_b64_tr_b16 v[72:73], v5 offset:0
    v_mfma_f32_16x16x32_bf16 v[32:35], v[92:95], v[124:127], v[32:35]
    ds_read_b64_tr_b16 v[74:75], v5 offset:768
    v_mfma_f32_16x16x32_bf16 v[44:47], v[92:95], v[128:131], v[44:47]
    ds_read_b64_tr_b16 v[76:77], v5 offset:32
    v_mfma_f32_16x16x32_bf16 v[40:43], v[88:91], v[128:131], v[40:43]
    ds_read_b64_tr_b16 v[78:79], v5 offset:800
    v_mfma_f32_16x16x32_bf16 v[36:39], v[84:87], v[128:131], v[36:39]
    ds_read_b64_tr_b16 v[80:81], v5 offset:64
    ds_read_b64_tr_b16 v[82:83], v5 offset:832
    ds_read_b128 v[112:115], v1 offset:3840
    s_waitcnt lgkmcnt(8)
    s_call_b64 s[76:77], L_H1
.p2align 3
    v_mfma_f32_16x16x32_bf16 v[24:27], v[96:99], v[140:143], v[24:27]
    ds_read_b64_tr_b16 v[84:85], v5 offset:6208
    ds_read_b64_tr_b16 v[86:87], v5 offset:6976
    v_mfma_f32_16x16x32_bf16 v[28:31], v[100:103], v[140:143], v[28:31]
    ds_read_b64_tr_b16 v[88:89], v5 offset:6240
    ds_read_b64_tr_b16 v[90:91], v5 offset:7008
    v_mfma_f32_16x16x32_bf16 v[32:35], v[104:107], v[140:143], v[32:35]
    ds_read_b64_tr_b16 v[92:93], v5 offset:6272
    ds_read_b64_tr_b16 v[94:95], v5 offset:7040
    v_mfma_f32_16x16x32_bf16 v[44:47], v[104:107], v[144:147], v[44:47]
    ds_read_b128 v[140:143], v1 offset:128
    ds_read_b128 v[124:127], v1 offset:64
    v_mfma_f32_16x16x32_bf16 v[40:43], v[100:103], v[144:147], v[40:43]
    ds_read_b128 v[128:131], v1 offset:3904
    v_mfma_f32_16x16x32_bf16 v[36:39], v[96:99], v[144:147], v[36:39]
    ds_read_b128 v[144:147], v1 offset:3968
    s_waitcnt lgkmcnt(10)
    s_call_b64 s[76:77], L_H2
    s_branch L_mid2
L_g1:
    s_setprio 2
    s_call_b64 s[76:77], L_H0
.p2align 3
    v_mfma_f32_16x16x32_bf16 v[24:27], v[84:87], v[124:127], v[24:27]
    ds_read_b128 v[108:111], v1 offset:0
    v_mfma_f32_16x16x32_bf16 v[28:31], v[88:91], v[124:127], v[28:31]
    ds_read_b64_tr_b16 v[72:73], v5 offset:0
    v_mfma_f32_16x16x32_bf16 v[32:35], v[92:95], v[124:127], v[32:35]
    ds_read_b64_tr_b16 v[74:75], v5 offset:768
    ds_read_b64_tr_b16 v[76:77], v5 offset:32
    ds_read_b64_tr_b16 v[78:79], v5 offset:800
    ds_read_b64_tr_b16 v[80:81], v5 offset:64
    ds_read_b64_tr_b16 v[82:83], v5 offset:832
    s_waitcnt lgkmcnt(7)
    s_call_b64 s[76:77], L_H1
.p2align 3
    v_mfma_f32_16x16x32_bf16 v[24:27], v[96:99], v[140:143], v[24:27]
    ds_read_b64_tr_b16 v[84:85], v5 offset:6208
    ds_read_b64_tr_b16 v[86:87], v5 offset:6976
    ds_read_b64_tr_b16 v[88:89], v5 offset:6240
    v_mfma_f32_16x16x32_bf16 v[28:31], v[100:103], v[140:143], v[28:31]
    ds_read_b64_tr_b16 v[90:91], v5 offset:7008
    ds_read_b64_tr_b16 v[92:93], v5 offset:6272
    ds_read_b64_tr_b16 v[94:95], v5 offset:7040
    v_mfma_f32_16x16x32_bf16 v[32:35], v[104:107], v[140:143], v[32:35]
    ds_read_b128 v[124:127], v1 offset:64
    ds_read_b128 v[140:143], v1 offset:128
    s_waitcnt lgkmcnt(8)
    s_call_b64 s[76:77], L_H2
    s_branch L_mid1
L_slow0:
    s_mul_i32 s96, s35, 11
    s_lshr_b32 s96, s96, 5
    s_mul_i32 s97, s96, 3
    s_sub_u32 s97, s35, s97
    s_add_u32 s98, s0, s49
    s_add_u32 s96, s96, s98
    s_sub_u32 s96, s96, 1
    s_add_u32 s97, s97, s32
    s_sub_u32 s97, s97, 1
    s_mul_i32 s98, s98, 224
    s_add_u32 s98, s98, s32
    s_mul_i32 s98, s98, 9
    s_add_u32 s98, s98, s35
    s_lshl_b32 s98, s98, 2
    v_mul_u32_u24 v177, 36, v14
    buffer_load_dword v168, v177, s[8:11], s98 offen
    v_cvt_f32_i32 v173, s96
    v_add_u32 v174, s97, v14
    v_cvt_f32_i32 v174, v174
    v_mov_b32 v204, 0
    v_mov_b32 v205, 0
    v_mov_b32 v206, 0
    v_mov_b32 v207, 0
    v_mov_b32 v208, 0
    v_mov_b32 v209, 0
    v_mov_b32 v210, 0
    v_mov_b32 v211, 0
    v_mov_b32 v212, 0
    v_mov_b32 v213, 0
    v_mov_b32 v214, 0
    v_mov_b32 v215, 0
    v_mov_b32 v216, 0
    v_mov_b32 v217, 0
    v_mov_b32 v218, 0
    v_mov_b32 v219, 0
    v_mov_b32 v220, 0
    v_mov_b32 v221, 0
    v_mov_b32 v222, 0
    v_mov_b32 v223, 0
    v_mov_b32 v224, 0
    v_mov_b32 v225, 0
    v_mov_b32 v226, 0
    v_mov_b32 v227, 0
    s_waitcnt vmcnt(0)
    v_lshlrev_b32 v169, 16, v168
    v_and_b32 v170, 0xffff0000, v168
    v_add_f32 v169, v169, v173
    v_add_f32 v170, v170, v174
    v_cvt_pk_bf16_f32 v168, v169, v170
    v_pk_max_i16 v168, v168, 0
    v_pk_min_i16 v168, v168, s91
    v_lshlrev_b32 v169, 16, v168
    v_and_b32 v170, 0xffff0000, v168
    v_fract_f32 v171, v169
    v_fract_f32 v172, v170
    v_cvt_u32_f32 v173, v169
    v_cvt_u32_f32 v174, v170
    v_sub_f32 v175, 1.0, v171
    v_sub_f32 v176, 1.0, v172
    v_cvt_pk_bf16_f32 v169, v175, v176
    v_lshlrev_b32 v175, 16, v169
    v_and_b32 v176, 0xffff0000, v169
    v_mul_f32 v228, v175, v176
    v_mul_f32 v229, v175, v172
    v_mul_f32 v230, v171, v176
    v_mul_f32 v231, v171, v172
    v_cvt_pk_bf16_f32 v169, v228, v229
    v_cvt_pk_bf16_f32 v170, v230, v231
    v_lshlrev_b32 v228, 16, v169
    v_and_b32 v229, 0xffff0000, v169
    v_lshlrev_b32 v230, 16, v170
    v_and_b32 v231, 0xffff0000, v170
    v_cmp_neq_f32 vcc, 0, v172
    v_mul_u32_u24 v177, 224, v173
    v_mov_b32 v169, 192
    v_mov_b32 v170, 43008
    v_cndmask_b32 v179, 0, v169, vcc
    v_cmp_neq_f32 vcc, 0, v171
    v_add_u32 v177, v177, v174
    v_mul_u32_u24 v177, 192, v177
    v_cndmask_b32 v178, 0, v170, vcc
    v_bfe_u32 v169, v16, 8, 1
    v_lshrrev_b32 v170, 9, v16
    v_lshl_add_u32 v177, v169, 5, v177
    v_lshl_add_u32 v177, v170, 3, v177
    v_sub_u32 v178, v178, v179
    s_mov_b32 s96, 4
L_sl0:
    buffer_load_dwordx2 v[156:157], v177, s[4:7], 0 offen offset:0
    buffer_load_dwordx2 v[158:159], v177, s[4:7], 0 offen offset:16
    buffer_load_dwordx2 v[160:161], v177, s[4:7], 0 offen offset:64
    buffer_load_dwordx2 v[162:163], v177, s[4:7], 0 offen offset:80
    buffer_load_dwordx2 v[164:165], v177, s[4:7], 0 offen offset:128
    buffer_load_dwordx2 v[166:167], v177, s[4:7], 0 offen offset:144
    v_add_u32 v177, v177, v179
    v_swap_b32 v179, v178
    s_waitcnt vmcnt(0)
    v_lshlrev_b32 v169, 16, v156
    v_and_b32 v170, 0xffff0000, v156
    v_fmac_f32 v204, v228, v169
    v_fmac_f32 v205, v228, v170
    v_lshlrev_b32 v169, 16, v157
    v_and_b32 v170, 0xffff0000, v157
    v_fmac_f32 v206, v228, v169
    v_fmac_f32 v207, v228, v170
    v_lshlrev_b32 v169, 16, v158
    v_and_b32 v170, 0xffff0000, v158
    v_fmac_f32 v208, v228, v169
    v_fmac_f32 v209, v228, v170
    v_lshlrev_b32 v169, 16, v159
    v_and_b32 v170, 0xffff0000, v159
    v_fmac_f32 v210, v228, v169
    v_fmac_f32 v211, v228, v170
    v_lshlrev_b32 v169, 16, v160
    v_and_b32 v170, 0xffff0000, v160
    v_fmac_f32 v212, v228, v169
    v_fmac_f32 v213, v228, v170
    v_lshlrev_b32 v169, 16, v161
    v_and_b32 v170, 0xffff0000, v161
    v_fmac_f32 v214, v228, v169
    v_fmac_f32 v215, v228, v170
    v_lshlrev_b32 v169, 16, v162
    v_and_b32 v170, 0xffff0000, v162
    v_fmac_f32 v216, v228, v169
    v_fmac_f32 v217, v228, v170
    v_lshlrev_b32 v169, 16, v163
    v_and_b32 v170, 0xffff0000, v163
    v_fmac_f32 v218, v228, v169
    v_fmac_f32 v219, v228, v170
    v_lshlrev_b32 v169, 16, v164
    v_and_b32 v170, 0xffff0000, v164
    v_fmac_f32 v220, v228, v169
    v_fmac_f32 v221, v228, v170
    v_lshlrev_b32 v169, 16, v165
    v_and_b32 v170, 0xffff0000, v165
    v_fmac_f32 v222, v228, v169
    v_fmac_f32 v223, v228, v170
    v_lshlrev_b32 v169, 16, v166
    v_and_b32 v170, 0xffff0000, v166
    v_fmac_f32 v224, v228, v169
    v_fmac_f32 v225, v228, v170
    v_lshlrev_b32 v169, 16, v167
    v_and_b32 v170, 0xffff0000, v167
    v_fmac_f32 v226, v228, v169
    v_fmac_f32 v227, v228, v170
    v_mov_b32 v228, v229
    v_mov_b32 v229, v230
    v_mov_b32 v230, v231
    s_sub_u32 s96, s96, 1
    s_cmp_lg_u32 s96, 0
    s_cbranch_scc1 L_sl0
    s_setpc_b64 s[78:79]
L_slow1:
    s_mul_i32 s96, s35, 11
    s_lshr_b32 s96, s96, 5
    s_mul_i32 s97, s96, 3
    s_sub_u32 s97, s35, s97
    s_add_u32 s98, s0, s49
    s_add_u32 s96, s96, s98
    s_sub_u32 s96, s96, 1
    s_add_u32 s97, s97, s32
    s_sub_u32 s97, s97, 1
    s_mul_i32 s98, s98, 224
    s_add_u32 s98, s98, s32
    s_mul_i32 s98, s98, 9
    s_add_u32 s98, s98, s35
    s_lshl_b32 s98, s98, 2
    v_mul_u32_u24 v201, 36, v14
    buffer_load_dword v192, v201, s[8:11], s98 offen
    v_cvt_f32_i32 v197, s96
    v_add_u32 v198, s97, v14
    v_cvt_f32_i32 v198, v198
    v_mov_b32 v204, 0
    v_mov_b32 v205, 0
    v_mov_b32 v206, 0
    v_mov_b32 v207, 0
    v_mov_b32 v208, 0
    v_mov_b32 v209, 0
    v_mov_b32 v210, 0
    v_mov_b32 v211, 0
    v_mov_b32 v212, 0
    v_mov_b32 v213, 0
    v_mov_b32 v214, 0
    v_mov_b32 v215, 0
    v_mov_b32 v216, 0
    v_mov_b32 v217, 0
    v_mov_b32 v218, 0
    v_mov_b32 v219, 0
    v_mov_b32 v220, 0
    v_mov_b32 v221, 0
    v_mov_b32 v222, 0
    v_mov_b32 v223, 0
    v_mov_b32 v224, 0
    v_mov_b32 v225, 0
    v_mov_b32 v226, 0
    v_mov_b32 v227, 0
    s_waitcnt vmcnt(0)
    v_lshlrev_b32 v193, 16, v192
    v_and_b32 v194, 0xffff0000, v192
    v_add_f32 v193, v193, v197
    v_add_f32 v194, v194, v198
    v_cvt_pk_bf16_f32 v192, v193, v194
    v_pk_max_i16 v192, v192, 0
    v_pk_min_i16 v192, v192, s91
    v_lshlrev_b32 v193, 16, v192
    v_and_b32 v194, 0xffff0000, v192
    v_fract_f32 v195, v193
    v_fract_f32 v196, v194
    v_cvt_u32_f32 v197, v193
    v_cvt_u32_f32 v198, v194
    v_sub_f32 v199, 1.0, v195
    v_sub_f32 v200, 1.0, v196
    v_cvt_pk_bf16_f32 v193, v199, v200
    v_lshlrev_b32 v199, 16, v193
    v_and_b32 v200, 0xffff0000, v193
    v_mul_f32 v232, v199, v200
    v_mul_f32 v233, v199, v196
    v_mul_f32 v234, v195, v200
    v_mul_f32 v235, v195, v196
    v_cvt_pk_bf16_f32 v193, v232, v233
    v_cvt_pk_bf16_f32 v194, v234, v235
    v_lshlrev_b32 v232, 16, v193
    v_and_b32 v233, 0xffff0000, v193
    v_lshlrev_b32 v234, 16, v194
    v_and_b32 v235, 0xffff0000, v194
    v_cmp_neq_f32 vcc, 0, v196
    v_mul_u32_u24 v201, 224, v197
    v_mov_b32 v193, 192
    v_mov_b32 v194, 43008
    v_cndmask_b32 v203, 0, v193, vcc
    v_cmp_neq_f32 vcc, 0, v195
    v_add_u32 v201, v201, v198
    v_mul_u32_u24 v201, 192, v201
    v_cndmask_b32 v202, 0, v194, vcc
    v_bfe_u32 v193, v16, 8, 1
    v_lshrrev_b32 v194, 9, v16
    v_lshl_add_u32 v201, v193, 5, v201
    v_lshl_add_u32 v201, v194, 3, v201
    v_sub_u32 v202, v202, v203
    s_mov_b32 s96, 4
L_sl1:
    buffer_load_dwordx2 v[180:181], v201, s[4:7], 0 offen offset:0
    buffer_load_dwordx2 v[182:183], v201, s[4:7], 0 offen offset:16
    buffer_load_dwordx2 v[184:185], v201, s[4:7], 0 offen offset:64
    buffer_load_dwordx2 v[186:187], v201, s[4:7], 0 offen offset:80
    buffer_load_dwordx2 v[188:189], v201, s[4:7], 0 offen offset:128
    buffer_load_dwordx2 v[190:191], v201, s[4:7], 0 offen offset:144
    v_add_u32 v201, v201, v203
    v_swap_b32 v203, v202
    s_waitcnt vmcnt(0)
    v_lshlrev_b32 v193, 16, v180
    v_and_b32 v194, 0xffff0000, v180
    v_fmac_f32 v204, v232, v193
    v_fmac_f32 v205, v232, v194
    v_lshlrev_b32 v193, 16, v181
    v_and_b32 v194, 0xffff0000, v181
    v_fmac_f32 v206, v232, v193
    v_fmac_f32 v207, v232, v194
    v_lshlrev_b32 v193, 16, v182
    v_and_b32 v194, 0xffff0000, v182
    v_fmac_f32 v208, v232, v193
    v_fmac_f32 v209, v232, v194
    v_lshlrev_b32 v193, 16, v183
    v_and_b32 v194, 0xffff0000, v183
    v_fmac_f32 v210, v232, v193
    v_fmac_f32 v211, v232, v194
    v_lshlrev_b32 v193, 16, v184
    v_and_b32 v194, 0xffff0000, v184
    v_fmac_f32 v212, v232, v193
    v_fmac_f32 v213, v232, v194
    v_lshlrev_b32 v193, 16, v185
    v_and_b32 v194, 0xffff0000, v185
    v_fmac_f32 v214, v232, v193
    v_fmac_f32 v215, v232, v194
    v_lshlrev_b32 v193, 16, v186
    v_and_b32 v194, 0xffff0000, v186
    v_fmac_f32 v216, v232, v193
    v_fmac_f32 v217, v232, v194
    v_lshlrev_b32 v193, 16, v187
    v_and_b32 v194, 0xffff0000, v187
    v_fmac_f32 v218, v232, v193
    v_fmac_f32 v219, v232, v194
    v_lshlrev_b32 v193, 16, v188
    v_and_b32 v194, 0xffff0000, v188
    v_fmac_f32 v220, v232, v193
    v_fmac_f32 v221, v232, v194
    v_lshlrev_b32 v193, 16, v189
    v_and_b32 v194, 0xffff0000, v189
    v_fmac_f32 v222, v232, v193
    v_fmac_f32 v223, v232, v194
    v_lshlrev_b32 v193, 16, v190
    v_and_b32 v194, 0xffff0000, v190
    v_fmac_f32 v224, v232, v193
    v_fmac_f32 v225, v232, v194
    v_lshlrev_b32 v193, 16, v191
    v_and_b32 v194, 0xffff0000, v191
    v_fmac_f32 v226, v232, v193
    v_fmac_f32 v227, v232, v194
    v_mov_b32 v232, v233
    v_mov_b32 v233, v234
    v_mov_b32 v234, v235
    s_sub_u32 s96, s96, 1
    s_cmp_lg_u32 s96, 0
    s_cbranch_scc1 L_sl1
    s_setpc_b64 s[78:79]
.p2align 7
L_ctab:
    .long 0xc00000, 0x2400180, 0x0, 0x8a00450
    .long 0x3d00008, 0x5500490, 0x100340, 0x8b00460
    .long 0x6e00010, 0x86007a0, 0x200680, 0x8c00470
    .long 0x9f00018, 0xb700ab0, 0x3009c0, 0x8d00480
    .long 0x18000c0, 0x3100240, 0x4000d0, 0x8f00490
    .long 0x49000c8, 0x6200550, 0x500410, 0x90004a0
    .long 0x7a000d0, 0x9300860, 0x600750, 0x91004b0
    .long 0xab000d8, 0xc000b70, 0x700a90, 0x92004c0
    .long 0x2400180, 0x3d00310, 0x8001a0, 0x93004e0
    .long 0x5500188, 0x6e00620, 0x9004e0, 0x94004f0
    .long 0x8600190, 0x9f00930, 0xa00820, 0x9500500
    .long 0xb700198, 0xcc00c00, 0xb00b60, 0x9600510
    .long 0x3100240, 0x49003d0, 0xd00270, 0x9700520
    .long 0x6200248, 0x7a006e0, 0xe005b0, 0x9800530
    .long 0x9300250, 0xab009f0, 0xf008f0, 0x9900540
    .long 0xc000258, 0xd800cc0, 0x1000c30, 0x9a00550
    .long 0xe00c20, 0x26001a0, 0x1100008, 0x9c00560
    .long 0x3f00c28, 0x57004b0, 0x1200348, 0x9d00570
    .long 0x6c00c30, 0x8400780, 0x1300688, 0x9e00580
    .long 0x9d00c38, 0xb500a90, 0x14009c8, 0x9f00590
    .long 0x1a00ce0, 0x3300260, 0x15000d8, 0xa0005b0
    .long 0x4b00ce8, 0x6000570, 0x1600418, 0xa1005c0
    .long 0x7800cf0, 0x9100840, 0x1700758, 0xa2005d0
    .long 0xa900cf8, 0xc200b50, 0x1800a98, 0xa3005e0
    .long 0x2600da0, 0x3f00330, 0x1a001a8, 0xa4005f0
    .long 0x5700da8, 0x6c00600, 0x1b004e8, 0xa500600
    .long 0x8400db0, 0x9d00910, 0x1c00828, 0xa600610
    .long 0xb500db8, 0xce00c20, 0x1d00b68, 0xa700620
    .long 0x3300e60, 0x4b003f0, 0x1e00278, 0xa900630
    .long 0x6000e68, 0x78006c0, 0x1f005b8, 0xaa00640
    .long 0x9100e70, 0xa9009d0, 0x20008f8, 0xab00650
    .long 0xc200e78, 0xda00ce0, 0x2100c38, 0xac00660
    .long 0xd00600, 0x2500190, 0x2200010, 0xad00680
    .long 0x3c00608, 0x5400480, 0x2300350, 0xae00690
    .long 0x6f00610, 0x87007b0, 0x2400690, 0xaf006a0
    .long 0x9e00618, 0xb600aa0, 0x25009d0, 0xb0006b0
    .long 0x19006c0, 0x3000250, 0x27000e0, 0xb1006c0
    .long 0x48006c8, 0x6300540, 0x2800420, 0xb2006d0
    .long 0x7b006d0, 0x9200870, 0x2900760, 0xb3006e0
    .long 0xaa006d8, 0xc100b60, 0x2a00aa0, 0xb4006f0
    .long 0x2500780, 0x3c00300, 0x2b001b0, 0xb600700
    .long 0x5400788, 0x6f00630, 0x2c004f0, 0xb700710
    .long 0x8700790, 0x9e00920, 0x2d00830, 0xb800720
    .long 0xb600798, 0xcd00c10, 0x2e00b70, 0xb900730
    .long 0x3000840, 0x48003c0, 0x2f00280, 0xba00750
    .long 0x6300848, 0x7b006f0, 0x30005c0, 0xbb00760
    .long 0x9200850, 0xaa009e0, 0x3100900, 0xbc00770
    .long 0xc100858, 0xd900cd0, 0x3200c40, 0xbd00780
    .long 0xf01220, 0x27001b0, 0x3400018, 0xbe00790
    .long 0x3e01228, 0x56004a0, 0x3500358, 0xbf007a0
    .long 0x6d01230, 0x8500790, 0x3600698, 0xc0007b0
    .long 0x9c01238, 0xb400a80, 0x37009d8, 0xc1007c0
    .long 0x1b012e0, 0x3200270, 0x38000e8, 0xc3007d0
    .long 0x4a012e8, 0x6100560, 0x3900428, 0xc4007e0
    .long 0x79012f0, 0x9000850, 0x3a00768, 0xc5007f0
    .long 0xa8012f8, 0xc300b40, 0x3b00aa8, 0xc600800
    .long 0x27013a0, 0x3e00320, 0x3c001b8, 0xc700820
    .long 0x56013a8, 0x6d00610, 0x3d004f8, 0xc800830
    .long 0x85013b0, 0x9c00900, 0x3e00838, 0xc900840
    .long 0xb4013b8, 0xcf00c30, 0x3f00b78, 0xca00850
    .long 0x3201460, 0x4a003e0, 0x4100288, 0xcb00860
    .long 0x6101468, 0x79006d0, 0x42005c8, 0xcc00870
    .long 0x9001470, 0xa8009c0, 0x4300908, 0xcd00880
    .long 0xc301478, 0xdb00cf0, 0x4400c48, 0xce00890
    .long 0xbf800000, 0xbf800000, 0x0, 0x0
    .long 0xbf800000, 0x0, 0x100, 0x180
    .long 0xbf800000, 0x3f800000, 0x200, 0x300
    .long 0x0, 0xbf800000, 0x1, 0x8
    .long 0x0, 0x0, 0x101, 0x188
    .long 0x0, 0x3f800000, 0x201, 0x308
    .long 0x3f800000, 0xbf800000, 0x2, 0x10
    .long 0x3f800000, 0x0, 0x102, 0x190
    .long 0x3f800000, 0x3f800000, 0x202, 0x310
    .long 0x40000000, 0xbf800000, 0x3, 0x18
    .long 0x40000000, 0x0, 0x103, 0x198
    .long 0x40000000, 0x3f800000, 0x203, 0x318
    .long 0x40400000, 0xbf800000, 0x4, 0x20
    .long 0x40400000, 0x0, 0x104, 0x1a0
    .long 0x40400000, 0x3f800000, 0x204, 0x320
    .long 0x40800000, 0xbf800000, 0x5, 0x28
    .long 0x40800000, 0x0, 0x105, 0x1a8
    .long 0x40800000, 0x3f800000, 0x205, 0x328
    .long 0x40a00000, 0xbf800000, 0x6, 0x30
    .long 0x40a00000, 0x0, 0x106, 0x1b0
    .long 0x40a00000, 0x3f800000, 0x206, 0x330
    .long 0x40c00000, 0xbf800000, 0x7, 0x38
    .long 0x40c00000, 0x0, 0x107, 0x1b8
    .long 0x40c00000, 0x3f800000, 0x207, 0x338
    .long 0x40e00000, 0xbf800000, 0x8, 0x40
    .long 0x40e00000, 0x0, 0x108, 0x1c0
    .long 0x40e00000, 0x3f800000, 0x208, 0x340
    .long 0x41000000, 0xbf800000, 0x9, 0x48
    .long 0x41000000, 0x0, 0x109, 0x1c8
    .long 0x41000000, 0x3f800000, 0x209, 0x348
    .long 0x41100000, 0xbf800000, 0xa, 0x50
    .long 0x41100000, 0x0, 0x10a, 0x1d0
    .long 0x41100000, 0x3f800000, 0x20a, 0x350
    .long 0x41200000, 0xbf800000, 0xb, 0x58
    .long 0x41200000, 0x0, 0x10b, 0x1d8
    .long 0x41200000, 0x3f800000, 0x20b, 0x358
    .long 0x41300000, 0xbf800000, 0xc, 0x60
    .long 0x41300000, 0x0, 0x10c, 0x1e0
    .long 0x41300000, 0x3f800000, 0x20c, 0x360
    .long 0x41400000, 0xbf800000, 0xd, 0x68
    .long 0x41400000, 0x0, 0x10d, 0x1e8
    .long 0x41400000, 0x3f800000, 0x20d, 0x368
    .long 0x41500000, 0xbf800000, 0xe, 0x70
    .long 0x41500000, 0x0, 0x10e, 0x1f0
    .long 0x41500000, 0x3f800000, 0x20e, 0x370
    .long 0x41600000, 0xbf800000, 0xf, 0x78
    .long 0x41600000, 0x0, 0x10f, 0x1f8
    .long 0x41600000, 0x3f800000, 0x20f, 0x378
    .long 0x41700000, 0xbf800000, 0x10, 0x80
    .long 0x41700000, 0x0, 0x110, 0x200
    .long 0x41700000, 0x3f800000, 0x210, 0x380
    .long 0x41800000, 0xbf800000, 0x11, 0x88
    .long 0x41800000, 0x0, 0x111, 0x208
    .long 0x41800000, 0x3f800000, 0x211, 0x388
    .long 0x41880000, 0xbf800000, 0x12, 0x90
    .long 0x41880000, 0x0, 0x112, 0x210
    .long 0x41880000, 0x3f800000, 0x212, 0x390
    .long 0x41900000, 0xbf800000, 0x13, 0x98
    .long 0x41900000, 0x0, 0x113, 0x218
    .long 0x41900000, 0x3f800000, 0x213, 0x398
    .long 0x41980000, 0xbf800000, 0x14, 0xa0
    .long 0x41980000, 0x0, 0x114, 0x220
    .long 0x41980000, 0x3f800000, 0x214, 0x3a0
    .long 0x41a00000, 0xbf800000, 0x15, 0xa8
    .long 0xfc000c, 0x1080018, 0x1140024, 0x0
    .long 0x1ec00fc, 0x1f80108, 0x2040114, 0x80000
    .long 0x2dc01ec, 0x2e801f8, 0x2f40204, 0x100000
    .long 0x1080018, 0x1140024, 0x1210031, 0x180000
    .long 0x1f80108, 0x2040114, 0x2110121, 0xc00001
    .long 0x2e801f8, 0x2f40204, 0x3010211, 0xc80001
    .long 0x1140024, 0x1210031, 0x12d003d, 0xd00001
    .long 0x2040114, 0x2110121, 0x21d012d, 0xd80001
    .long 0x2f40204, 0x3010211, 0x30d021d, 0x1800002
    .long 0x1210031, 0x12d003d, 0x1390049, 0x1880002
    .long 0x2110121, 0x21d012d, 0x2290139, 0x1900002
    .long 0x3010211, 0x30d021d, 0x3190229, 0x1980002
    .long 0x12d003d, 0x1390049, 0x1450055, 0x2400003
    .long 0x21d012d, 0x2290139, 0x2350145, 0x2480003
    .long 0x30d021d, 0x3190229, 0x3250235, 0x2500003
    .long 0x1390049, 0x1450055, 0x1520062, 0x2580003
    .long 0x2290139, 0x2350145, 0x2420152, 0x200004
    .long 0x3190229, 0x3250235, 0x3320242, 0x280004
    .long 0x1450055, 0x1520062, 0x15e006e, 0x300004
    .long 0x2350145, 0x2420152, 0x24e015e, 0x380004
    .long 0x3250235, 0x3320242, 0x33e024e, 0xe00005
    .long 0x1520062, 0x15e006e, 0x16a007a, 0xe80005
    .long 0x2420152, 0x24e015e, 0x25a016a, 0xf00005
    .long 0x3320242, 0x33e024e, 0x34a025a, 0xf80005
    .long 0x15e006e, 0x16a007a, 0x1760086, 0x1a00006
    .long 0x24e015e, 0x25a016a, 0x2660176, 0x1a80006
    .long 0x33e024e, 0x34a025a, 0x3560266, 0x1b00006
    .long 0x16a007a, 0x1760086, 0x1830093, 0x1b80006
    .long 0x25a016a, 0x2660176, 0x2730183, 0x2600007
    .long 0x34a025a, 0x3560266, 0x3630273, 0x2680007
    .long 0x1760086, 0x1830093, 0x18f009f, 0x2700007
    .long 0x2660176, 0x2730183, 0x27f018f, 0x2780007
    .long 0x3560266, 0x3630273, 0x36f027f, 0x3000008
    .long 0x1830093, 0x18f009f, 0x19b00ab, 0x3080008
    .long 0x2730183, 0x27f018f, 0x28b019b, 0x3100008
    .long 0x3630273, 0x36f027f, 0x37b028b, 0x3180008
    .long 0x18f009f, 0x19b00ab, 0x1a700b7, 0x3c00009
    .long 0x27f018f, 0x28b019b, 0x29701a7, 0x3c80009
    .long 0x36f027f, 0x37b028b, 0x3870297, 0x3d00009
    .long 0x19b00ab, 0x1a700b7, 0x1b000c0, 0x3d80009
    .long 0x28b019b, 0x29701a7, 0x2a001b0, 0x480000a
    .long 0x37b028b, 0x3870297, 0x39002a0, 0x488000a
    .long 0x1a700b7, 0x1b000c0, 0x1bc00cc, 0x490000a
    .long 0x29701a7, 0x2a001b0, 0x2ac01bc, 0x498000a
    .long 0x3870297, 0x39002a0, 0x39c02ac, 0x540000b
    .long 0x1b000c0, 0x1bc00cc, 0x1c800d8, 0x548000b
    .long 0x2a001b0, 0x2ac01bc, 0x2b801c8, 0x550000b
    .long 0x39002a0, 0x39c02ac, 0x3a802b8, 0x558000b
    .long 0x1bc00cc, 0x1c800d8, 0x1d400e4, 0x320000c
    .long 0x2ac01bc, 0x2b801c8, 0x2c401d4, 0x328000c
    .long 0x39c02ac, 0x3a802b8, 0x3b402c4, 0x330000c
    .long 0x1c800d8, 0x1d400e4, 0x1e100f1, 0x338000c
    .long 0x2b801c8, 0x2c401d4, 0x2d101e1, 0x3e0000d
    .long 0x3a802b8, 0x3b402c4, 0x3c102d1, 0x3e8000d
    .long 0x1d400e4, 0x1e100f1, 0x1ed00fd, 0x3f0000d
    .long 0x2c401d4, 0x2d101e1, 0x2dd01ed, 0x3f8000d
    .long 0x3b402c4, 0x3c102d1, 0x3cd02dd, 0x4a0000e
    .long 0x1e100f1, 0x1ed00fd, 0x1f90109, 0x4a8000e
    .long 0x2d101e1, 0x2dd01ed, 0x2e901f9, 0x4b0000e
    .long 0x3c102d1, 0x3cd02dd, 0x3d902e9, 0x4b8000e
    .long 0x1ed00fd, 0x1f90109, 0x2050115, 0x560000f
    .long 0x2dd01ed, 0x2e901f9, 0x2f50205, 0x568000f
    .long 0x3cd02dd, 0x3d902e9, 0x3e502f5, 0x570000f
    .long 0x1f90109, 0x2050115, 0x2120122, 0x578000f
    .long 0x0, 0x10, 0x0, 0x0
    .long 0x20, 0x30, 0x4, 0x0
    .long 0x8, 0x18, 0x8, 0x0
    .long 0x28, 0x38, 0xc, 0x0
    .long 0x0, 0x10, 0x1, 0x0
    .long 0x20, 0x30, 0x5, 0x0
    .long 0x8, 0x18, 0x9, 0x0
    .long 0x28, 0x38, 0xd, 0x0
    .long 0x0, 0x10, 0x2, 0x0
    .long 0x20, 0x30, 0x6, 0x0
    .long 0x8, 0x18, 0xa, 0x0
    .long 0x28, 0x38, 0xe, 0x0
    .long 0x0, 0x10, 0x3, 0x0
    .long 0x20, 0x30, 0x7, 0x0
    .long 0x8, 0x18, 0xb, 0x0
    .long 0x28, 0x38, 0xf, 0x0
    .long 0x0, 0x10, 0x0, 0x20002
    .long 0x20, 0x30, 0x4, 0x20002
    .long 0x8, 0x18, 0x8, 0x20002
    .long 0x28, 0x38, 0xc, 0x20002
    .long 0x0, 0x10, 0x1, 0x20002
    .long 0x20, 0x30, 0x5, 0x20002
    .long 0x8, 0x18, 0x9, 0x20002
    .long 0x28, 0x38, 0xd, 0x20002
    .long 0x0, 0x10, 0x2, 0x20002
    .long 0x20, 0x30, 0x6, 0x20002
    .long 0x8, 0x18, 0xa, 0x20002
    .long 0x28, 0x38, 0xe, 0x20002
    .long 0x0, 0x10, 0x3, 0x20002
    .long 0x20, 0x30, 0x7, 0x20002
    .long 0x8, 0x18, 0xb, 0x20002
    .long 0x28, 0x38, 0xf, 0x20002
    .long 0x0, 0x10, 0x0, 0x10001
    .long 0x20, 0x30, 0x4, 0x10001
    .long 0x8, 0x18, 0x8, 0x10001
    .long 0x28, 0x38, 0xc, 0x10001
    .long 0x0, 0x10, 0x1, 0x10001
    .long 0x20, 0x30, 0x5, 0x10001
    .long 0x8, 0x18, 0x9, 0x10001
    .long 0x28, 0x38, 0xd, 0x10001
    .long 0x0, 0x10, 0x2, 0x10001
    .long 0x20, 0x30, 0x6, 0x10001
    .long 0x8, 0x18, 0xa, 0x10001
    .long 0x28, 0x38, 0xe, 0x10001
    .long 0x0, 0x10, 0x3, 0x10001
    .long 0x20, 0x30, 0x7, 0x10001
    .long 0x8, 0x18, 0xb, 0x10001
    .long 0x28, 0x38, 0xf, 0x10001
    .long 0x0, 0x10, 0x0, 0x30003
    .long 0x20, 0x30, 0x4, 0x30003
    .long 0x8, 0x18, 0x8, 0x30003
    .long 0x28, 0x38, 0xc, 0x30003
    .long 0x0, 0x10, 0x1, 0x30003
    .long 0x20, 0x30, 0x5, 0x30003
    .long 0x8, 0x18, 0x9, 0x30003
    .long 0x28, 0x38, 0xd, 0x30003
    .long 0x0, 0x10, 0x2, 0x30003
    .long 0x20, 0x30, 0x6, 0x30003
    .long 0x8, 0x18, 0xa, 0x30003
    .long 0x28, 0x38, 0xe, 0x30003
    .long 0x0, 0x10, 0x3, 0x30003
    .long 0x20, 0x30, 0x7, 0x30003
    .long 0x8, 0x18, 0xb, 0x30003
    .long 0x28, 0x38, 0xf, 0x30003
    .long 0xc0c0100, 0xc0c0c0c, 0xc0c0302, 0xc0c0c0c
    .long 0xc0c0c0c, 0xc0c0c0c, 0xc0c0c0c, 0xc0c0c0c
    .long 0xc0c0c0c, 0xc0c0c0c, 0xc0c0c0c, 0xc0c0c0c
    .long 0xc0c0c0c, 0xc0c0c0c, 0xc0c0c0c, 0xc0c0c0c
    .long 0x1000c0c, 0xc0c0c0c, 0x3020c0c, 0xc0c0c0c
    .long 0xc0c0c0c, 0xc0c0c0c, 0xc0c0c0c, 0xc0c0c0c
    .long 0xc0c0c0c, 0xc0c0c0c, 0xc0c0c0c, 0xc0c0c0c
    .long 0xc0c0c0c, 0xc0c0c0c, 0xc0c0c0c, 0xc0c0c0c
    .long 0xc0c0c0c, 0xc0c0100, 0xc0c0c0c, 0xc0c0302
    .long 0xc0c0c0c, 0xc0c0c0c, 0xc0c0c0c, 0xc0c0c0c
    .long 0xc0c0c0c, 0xc0c0c0c, 0xc0c0c0c, 0xc0c0c0c
    .long 0xc0c0c0c, 0xc0c0c0c, 0xc0c0c0c, 0xc0c0c0c
    .long 0xc0c0c0c, 0x1000c0c, 0xc0c0c0c, 0x3020c0c
    .long 0xc0c0c0c, 0xc0c0c0c, 0xc0c0c0c, 0xc0c0c0c
    .long 0xc0c0c0c, 0xc0c0c0c, 0xc0c0c0c, 0xc0c0c0c
    .long 0xc0c0c0c, 0xc0c0c0c, 0xc0c0c0c, 0xc0c0c0c
    .long 0xc0c0c0c, 0xc0c0c0c, 0xc0c0c0c, 0xc0c0c0c
    .long 0xc0c0100, 0xc0c0c0c, 0xc0c0302, 0xc0c0c0c
    .long 0xc0c0c0c, 0xc0c0c0c, 0xc0c0c0c, 0xc0c0c0c
    .long 0xc0c0c0c, 0xc0c0c0c, 0xc0c0c0c, 0xc0c0c0c
    .long 0xc0c0c0c, 0xc0c0c0c, 0xc0c0c0c, 0xc0c0c0c
    .long 0x1000c0c, 0xc0c0c0c, 0x3020c0c, 0xc0c0c0c
    .long 0xc0c0c0c, 0xc0c0c0c, 0xc0c0c0c, 0xc0c0c0c
    .long 0xc0c0c0c, 0xc0c0c0c, 0xc0c0c0c, 0xc0c0c0c
    .long 0xc0c0c0c, 0xc0c0c0c, 0xc0c0c0c, 0xc0c0c0c
    .long 0xc0c0c0c, 0xc0c0100, 0xc0c0c0c, 0xc0c0302
    .long 0xc0c0c0c, 0xc0c0c0c, 0xc0c0c0c, 0xc0c0c0c
    .long 0xc0c0c0c, 0xc0c0c0c, 0xc0c0c0c, 0xc0c0c0c
    .long 0xc0c0c0c, 0xc0c0c0c, 0xc0c0c0c, 0xc0c0c0c
    .long 0xc0c0c0c, 0x1000c0c, 0xc0c0c0c, 0x3020c0c
    .long 0xc0c0c0c, 0xc0c0c0c, 0xc0c0c0c, 0xc0c0c0c
    .long 0xc0c0c0c, 0xc0c0c0c, 0xc0c0c0c, 0xc0c0c0c
    .long 0xc0c0c0c, 0xc0c0c0c, 0xc0c0c0c, 0xc0c0c0c
    .long 0xc0c0c0c, 0xc0c0c0c, 0xc0c0c0c, 0xc0c0c0c
    .long 0xc0c0100, 0xc0c0c0c, 0xc0c0302, 0xc0c0c0c
    .long 0xc0c0c0c, 0xc0c0c0c, 0xc0c0c0c, 0xc0c0c0c
    .long 0xc0c0c0c, 0xc0c0c0c, 0xc0c0c0c, 0xc0c0c0c
    .long 0xc0c0c0c, 0xc0c0c0c, 0xc0c0c0c, 0xc0c0c0c
    .long 0x1000c0c, 0xc0c0c0c, 0x3020c0c, 0xc0c0c0c
    .long 0xc0c0c0c, 0xc0c0c0c, 0xc0c0c0c, 0xc0c0c0c
    .long 0xc0c0c0c, 0xc0c0c0c, 0xc0c0c0c, 0xc0c0c0c
    .long 0xc0c0c0c, 0xc0c0c0c, 0xc0c0c0c, 0xc0c0c0c
    .long 0xc0c0c0c, 0xc0c0100, 0xc0c0c0c, 0xc0c0302
    .long 0xc0c0c0c, 0xc0c0c0c, 0xc0c0c0c, 0xc0c0c0c
    .long 0xc0c0c0c, 0xc0c0c0c, 0xc0c0c0c, 0xc0c0c0c
    .long 0xc0c0c0c, 0xc0c0c0c, 0xc0c0c0c, 0xc0c0c0c
    .long 0xc0c0c0c, 0x1000c0c, 0xc0c0c0c, 0x3020c0c
    .long 0xc0c0c0c, 0xc0c0c0c, 0xc0c0c0c, 0xc0c0c0c
    .long 0xc0c0c0c, 0xc0c0c0c, 0xc0c0c0c, 0xc0c0c0c
    .long 0xc0c0c0c, 0xc0c0c0c, 0xc0c0c0c, 0xc0c0c0c
    .long 0xc0c0c0c, 0xc0c0c0c, 0xc0c0c0c, 0xc0c0c0c
    .long 0xc0c0100, 0xc0c0c0c, 0xc0c0302, 0xc0c0c0c
    .long 0xc0c0c0c, 0xc0c0c0c, 0xc0c0c0c, 0xc0c0c0c
    .long 0xc0c0c0c, 0xc0c0c0c, 0xc0c0c0c, 0xc0c0c0c
    .long 0xc0c0c0c, 0xc0c0c0c, 0xc0c0c0c, 0xc0c0c0c
    .long 0x1000c0c, 0xc0c0c0c, 0x3020c0c, 0xc0c0c0c
    .long 0xc0c0c0c, 0xc0c0c0c, 0xc0c0c0c, 0xc0c0c0c
    .long 0xc0c0c0c, 0xc0c0c0c, 0xc0c0c0c, 0xc0c0c0c
    .long 0xc0c0c0c, 0xc0c0c0c, 0xc0c0c0c, 0xc0c0c0c
    .long 0xc0c0c0c, 0xc0c0100, 0xc0c0c0c, 0xc0c0302
    .long 0xc0c0c0c, 0xc0c0c0c, 0xc0c0c0c, 0xc0c0c0c
    .long 0xc0c0c0c, 0xc0c0c0c, 0xc0c0c0c, 0xc0c0c0c
    .long 0xc0c0c0c, 0xc0c0c0c, 0xc0c0c0c, 0xc0c0c0c
    .long 0xc0c0c0c, 0x1000c0c, 0xc0c0c0c, 0x3020c0c
L_runtab:
    .long 0xfffeb000, 0x1f800, 0x11101110, 0x462d0000, 0xb1e0b1e0, 0xb1e0b1e0, 0x0, 0x3aff
    .long 0x3e5800, 0x444000, 0x44404440, 0xa8c6000, 0x22582258, 0x22582258, 0x3e7f, 0x3e7f
    .long 0x8d1800, 0x925800, 0x44404440, 0xa8cd800, 0x22582258, 0x22582258, 0x3eff, 0x3eff
    .long 0x2d4800, 0x372000, 0x3b384440, 0x10824660, 0x3c2d3bc0, 0x35073c9a, 0x3e7f3e7f, 0x3e7f3e7f
    .long 0xfffeb000, 0x5e800, 0x44404440, 0x4c8f0070, 0x1ad01ad0, 0x1ad01ad0, 0x3e7f0000, 0x3e7f3c7f
    .long 0x241800, 0x2df000, 0x3b384440, 0x108238a0, 0x3c2d3bc0, 0x35073c9a, 0x3eff3dff, 0x3eff3dff
    .long 0xfffeb000, 0x5e800, 0x44404440, 0x4c8f00b0, 0x1ad01ad0, 0x1ad01ad0, 0x3eff0000, 0x3eff3c7f
    .long 0x2d4800, 0x372000, 0x3b384440, 0x108246c0, 0x3c2d3bc0, 0x35073c9a, 0x3eff3e7f, 0x3eff3e7f
    .long 0x0, 0x34800, 0x11101110, 0x462d0200, 0xb1e0b1e0, 0xb1e0b1e0, 0x3aff, 0x3bff
    .long 0x439800, 0x498000, 0x44404440, 0xa8c6800, 0x22582258, 0x22582258, 0x3e7f, 0x3e7f
    .long 0xfffeb000, 0x5e800, 0x44404440, 0x4c8f0030, 0x1ad01ad0, 0x1ad01ad0, 0x3dff0000, 0x3dff3c7f
    .long 0x367800, 0x405000, 0x3b384440, 0x10825430, 0x3c2d3bc0, 0x35073c9a, 0x3dff3e7f, 0x3dff3e7f
    .long 0x3f000, 0xb2800, 0x44404440, 0x4c8f0870, 0x1ad01ad0, 0x1ad01ad0, 0x3e7f3c7f, 0x3e7f3cff
    .long 0x2d4800, 0x372000, 0x3b384440, 0x10824670, 0x3c2d3bc0, 0x35073c9a, 0x3e7f3e7f, 0x3e7f3e7f
    .long 0x3f000, 0xb2800, 0x44404440, 0x4c8f08b0, 0x1ad01ad0, 0x1ad01ad0, 0x3eff3c7f, 0x3eff3cff
    .long 0x2d4800, 0x372000, 0x3b384440, 0x108246d0, 0x3c2d3bc0, 0x35073c9a, 0x3eff3e7f, 0x3eff3e7f
    .long 0x15000, 0x54000, 0x12201220, 0x473d0400, 0x79e079e0, 0x79e079e0, 0x3bff, 0x3c7f
    .long 0x48d800, 0x4ec000, 0x44404440, 0xa8c7000, 0x22582258, 0x22582258, 0x3e7f, 0x3e7f
    .long 0x3f000, 0xb2800, 0x44404440, 0x4c8f0830, 0x1ad01ad0, 0x1ad01ad0, 0x3dff3c7f, 0x3dff3cff
    .long 0x367800, 0x405000, 0x3b384440, 0x10825440, 0x3c2d3bc0, 0x35073c9a, 0x3dff3e7f, 0x3dff3e7f
    .long 0xfffeb000, 0x5e800, 0x44404440, 0x4c8f0080, 0x1ad01ad0, 0x1ad01ad0, 0x3e7f0000, 0x3e7f3c7f
    .long 0x2d4800, 0x372000, 0x3b384440, 0x10824680, 0x3c2d3bc0, 0x35073c9a, 0x3e7f3e7f, 0x3e7f3e7f
    .long 0xfffeb000, 0x5e800, 0x44404440, 0x4c8f00c0, 0x1ad01ad0, 0x1ad01ad0, 0x3eff0000, 0x3eff3c7f
    .long 0x367800, 0x405000, 0x3b384440, 0x108254b0, 0x3c2d3bc0, 0x35073c9a, 0x3eff3e7f, 0x3eff3e7f
    .long 0x34800, 0x73800, 0x12201220, 0x473d0700, 0x79e079e0, 0x79e079e0, 0x3c7f, 0x3cff
    .long 0x4e1800, 0x540000, 0x44404440, 0xa8c7800, 0x22582258, 0x22582258, 0x3e7f, 0x3e7f
    .long 0xfffeb000, 0x5e800, 0x44404440, 0x4c8f0040, 0x1ad01ad0, 0x1ad01ad0, 0x3dff0000, 0x3dff3c7f
    .long 0x367800, 0x405000, 0x3b384440, 0x10825450, 0x3c2d3bc0, 0x35073c9a, 0x3e7f3e7f, 0x3e7f3e7f
    .long 0x3f000, 0xb2800, 0x44404440, 0x4c8f0880, 0x1ad01ad0, 0x1ad01ad0, 0x3e7f3c7f, 0x3e7f3cff
    .long 0x2d4800, 0x372000, 0x3b384440, 0x10824690, 0x3c2d3bc0, 0x35073c9a, 0x3eff3e7f, 0x3eff3e7f
    .long 0x3f000, 0xb2800, 0x44404440, 0x4c8f08c0, 0x1ad01ad0, 0x1ad01ad0, 0x3eff3c7f, 0x3eff3cff
    .long 0x367800, 0x405000, 0x3b384440, 0x108254c0, 0x3c2d3bc0, 0x35073c9a, 0x3eff3e7f, 0x3eff3e7f
    .long 0x54000, 0x9d800, 0x22202220, 0x484d0a00, 0x59e059e0, 0x59e059e0, 0x3cff, 0x3cff
    .long 0x535800, 0x594000, 0x44404440, 0xa8c8000, 0x22582258, 0x22582258, 0x3e7f, 0x3eff
    .long 0x3f000, 0xb2800, 0x44404440, 0x4c8f0840, 0x1ad01ad0, 0x1ad01ad0, 0x3dff3c7f, 0x3dff3cff
    .long 0x367800, 0x405000, 0x3b384440, 0x10825460, 0x3c2d3bc0, 0x35073c9a, 0x3e7f3e7f, 0x3e7f3e7f
    .long 0xfffeb000, 0x5e800, 0x44404440, 0x4c8f0090, 0x1ad01ad0, 0x1ad01ad0, 0x3eff0000, 0x3eff3c7f
    .long 0x2d4800, 0x372000, 0x3b384440, 0x108246a0, 0x3c2d3bc0, 0x35073c9a, 0x3eff3e7f, 0x3eff3e7f
    .long 0xfffeb000, 0x5e800, 0x44404440, 0x4c8f00d0, 0x1ad01ad0, 0x1ad01ad0, 0x3eff0000, 0x3eff3c7f
    .long 0x367800, 0x405000, 0x3b384440, 0x108254d0, 0x3c2d3bc0, 0x35073c9a, 0x3eff3e7f, 0x3eff3e7f
    .long 0xfffeb000, 0x5e800, 0x44404440, 0x4c8d0010, 0x1ad01ad0, 0x1ad01ad0, 0x3cff0000, 0x3cff3c7f
    .long 0x589800, 0x5e8000, 0x44404440, 0xa8c8800, 0x22582258, 0x22582258, 0x3eff, 0x3eff
    .long 0xfffeb000, 0x5e800, 0x44404440, 0x4c8f0050, 0x1ad01ad0, 0x1ad01ad0, 0x3e7f0000, 0x3e7f3c7f
    .long 0x3fa800, 0x498000, 0x3b384440, 0x10826230, 0x3c2d3bc0, 0x35073c9a, 0x3dff3e7f, 0x3dff3e7f
    .long 0x3f000, 0xb2800, 0x44404440, 0x4c8f0890, 0x1ad01ad0, 0x1ad01ad0, 0x3eff3c7f, 0x3eff3cff
    .long 0x367800, 0x405000, 0x3b384440, 0x10825470, 0x3c2d3bc0, 0x35073c9a, 0x3e7f3e7f, 0x3e7f3e7f
    .long 0x3f000, 0xb2800, 0x44404440, 0x4c8f08d0, 0x1ad01ad0, 0x1ad01ad0, 0x3eff3c7f, 0x3eff3cff
    .long 0x3fa800, 0x498000, 0x3b384440, 0x108262b0, 0x3c2d3bc0, 0x35073c9a, 0x3eff3e7f, 0x3eff3e7f
    .long 0x3f000, 0xb2800, 0x44404440, 0x4c8d0810, 0x1ad01ad0, 0x1ad01ad0, 0x3cff3c7f, 0x3cff3cff
    .long 0x5dd800, 0x63c000, 0x44404440, 0xa8c9000, 0x22582258, 0x22582258, 0x3eff, 0x3eff
    .long 0x3f000, 0xb2800, 0x44404440, 0x4c8f0850, 0x1ad01ad0, 0x1ad01ad0, 0x3e7f3c7f, 0x3e7f3cff
    .long 0x3fa800, 0x498000, 0x3b384440, 0x10826240, 0x3c2d3bc0, 0x35073c9a, 0x3dff3e7f, 0x3dff3e7f
    .long 0xfffeb000, 0x5e800, 0x44404440, 0x4c8f00a0, 0x1ad01ad0, 0x1ad01ad0, 0x3eff0000, 0x3eff3c7f
    .long 0x367800, 0x405000, 0x3b384440, 0x10825480, 0x3c2d3bc0, 0x35073c9a, 0x3e7f3e7f, 0x3e7f3e7f
    .long 0x93000, 0x130800, 0x39363330, 0x506b10b0, 0x2c6e63c0, 0x2d142cc1, 0x3eff3cff, 0x3eff3d7f
    .long 0x3fa800, 0x498000, 0x3b384440, 0x108262c0, 0x3c2d3bc0, 0x35073c9a, 0x3eff3e7f, 0x3eff3e7f
    .long 0xfffeb000, 0x5e800, 0x44404440, 0x4c8d0020, 0x1ad01ad0, 0x1ad01ad0, 0x3d7f0000, 0x3d7f3c7f
    .long 0x631800, 0x690000, 0x44404440, 0xa8c9800, 0x22582258, 0x22582258, 0x3eff, 0x3eff
    .long 0xfffeb000, 0x5e800, 0x44404440, 0x4c8f0060, 0x1ad01ad0, 0x1ad01ad0, 0x3e7f0000, 0x3e7f3c7f
    .long 0x3fa800, 0x498000, 0x3b384440, 0x10826250, 0x3c2d3bc0, 0x35073c9a, 0x3e7f3e7f, 0x3e7f3e7f
    .long 0x3f000, 0xb2800, 0x44404440, 0x4c8f08a0, 0x1ad01ad0, 0x1ad01ad0, 0x3eff3c7f, 0x3eff3cff
    .long 0x367800, 0x405000, 0x3b384440, 0x10825490, 0x3c2d3bc0, 0x35073c9a, 0x3eff3e7f, 0x3eff3e7f
    .long 0x93000, 0x130800, 0x39363330, 0x506b10c0, 0x2c6e63c0, 0x2d142cc1, 0x3eff3cff, 0x3eff3d7f
    .long 0x3fa800, 0x498000, 0x3b384440, 0x108262d0, 0x3c2d3bc0, 0x35073c9a, 0x3eff3e7f, 0x3eff3e7f
    .long 0x3f000, 0xb2800, 0x44404440, 0x4c8d0820, 0x1ad01ad0, 0x1ad01ad0, 0x3d7f3c7f, 0x3d7f3cff
    .long 0x685800, 0x6e4000, 0x44404440, 0xa8ca000, 0x22582258, 0x22582258, 0x3eff, 0x3eff
    .long 0x3f000, 0xb2800, 0x44404440, 0x4c8f0860, 0x1ad01ad0, 0x1ad01ad0, 0x3e7f3c7f, 0x3e7f3cff
    .long 0x3fa800, 0x498000, 0x3b384440, 0x10826260, 0x3c2d3bc0, 0x35073c9a, 0x3e7f3e7f, 0x3e7f3e7f
    .long 0x93000, 0x130800, 0x39363330, 0x506b1070, 0x2c7b6bc0, 0x2d1424ce, 0x3e7f3cff, 0x3e7f3d7f
    .long 0x367800, 0x405000, 0x3b384440, 0x108254a0, 0x3c2d3bc0, 0x35073c9a, 0x3eff3e7f, 0x3eff3e7f
    .long 0x93000, 0x130800, 0x39363330, 0x506b10d0, 0x2c7b6bc0, 0x2d1424ce, 0x3eff3cff, 0x3eff3d7f
    .long 0x48d800, 0x52b000, 0x3b384440, 0x108270b0, 0x3c2d3bc0, 0x35073c9a, 0x3eff3e7f, 0x3eff3e7f
    .long 0x7e000, 0xc7800, 0x22202220, 0x484d0e00, 0x59e059e0, 0x59e059e0, 0x3cff, 0x3d7f
    .long 0x6d9800, 0x738000, 0x44404440, 0xa8ca800, 0x22582258, 0x22582258, 0x3eff, 0x3eff
    .long 0x83e800, 0x8c7000, 0x39363330, 0x4e68ca10, 0x43fe4384, 0x44f24478, 0x3cff3eff, 0x3cff3eff
    .long 0x48d800, 0x52b000, 0x3b384440, 0x10827030, 0x3c2d3bc0, 0x35073c9a, 0x3dff3e7f, 0x3dff3e7f
    .long 0x93000, 0x130800, 0x39363330, 0x506b1080, 0x2c6e63c0, 0x2d142cc1, 0x3e7f3cff, 0x3e7f3d7f
    .long 0x3fa800, 0x498000, 0x3b384440, 0x10826270, 0x3c2d3bc0, 0x35073c9a, 0x3e7f3e7f, 0x3e7f3e7f
    .long 0x111000, 0x1b9000, 0x4a463330, 0x116b1cb0, 0x3c7643fc, 0x252b24e3, 0x3eff3d7f, 0x3eff3dff
    .long 0x48d800, 0x52b000, 0x3b384440, 0x108270c0, 0x3c2d3bc0, 0x35073c9a, 0x3eff3e7f, 0x3eff3e7f
    .long 0xa8000, 0x106800, 0x33303330, 0x4a6d1200, 0x2a582a58, 0x2a582a58, 0x3d7f, 0x3d7f
    .long 0x72d800, 0x78c000, 0x44404440, 0xa8cb000, 0x22582258, 0x22582258, 0x3eff, 0x3eff
    .long 0x7ff800, 0x89d000, 0x3b384440, 0x1088c420, 0x3c2d3bc0, 0x35073c9a, 0x3d7f3eff, 0x3d7f3eff
    .long 0x48d800, 0x52b000, 0x3b384440, 0x10827040, 0x3c2d3bc0, 0x35073c9a, 0x3dff3e7f, 0x3dff3e7f
    .long 0x93000, 0x130800, 0x39363330, 0x506b1090, 0x2c6e63c0, 0x2d142cc1, 0x3eff3cff, 0x3eff3d7f
    .long 0x3fa800, 0x498000, 0x3b384440, 0x10826280, 0x3c2d3bc0, 0x35073c9a, 0x3e7f3e7f, 0x3e7f3e7f
    .long 0x111000, 0x1b9000, 0x4a463330, 0x116b1cc0, 0x3c7643fc, 0x252b24e3, 0x3eff3d7f, 0x3eff3dff
    .long 0x48d800, 0x52b000, 0x3b384440, 0x108270d0, 0x3c2d3bc0, 0x35073c9a, 0x3eff3e7f, 0x3eff3e7f
    .long 0xe7000, 0x15a800, 0x44404440, 0x4c8d1800, 0x1ad01ad0, 0x1ad01ad0, 0x3d7f, 0x3d7f
    .long 0x781800, 0x7e0000, 0x44404440, 0xa8cb800, 0x22582258, 0x22582258, 0x3eff, 0x3eff
    .long 0x8bc800, 0x925800, 0x28263330, 0x4c68d610, 0x4c0b4b84, 0x3cff3c92, 0x3cff3eff, 0x3cff3eff
    .long 0x48d800, 0x52b000, 0x3b384440, 0x10827050, 0x3c2d3bc0, 0x35073c9a, 0x3e7f3e7f, 0x3e7f3e7f
    .long 0x93000, 0x130800, 0x39363330, 0x506b10a0, 0x2c7b6bc0, 0x2d1424ce, 0x3eff3cff, 0x3eff3d7f
    .long 0x3fa800, 0x498000, 0x3b384440, 0x10826290, 0x3c2d3bc0, 0x35073c9a, 0x3eff3e7f, 0x3eff3e7f
    .long 0x111000, 0x1b9000, 0x4a463330, 0x116b1cd0, 0x3c7643fc, 0x252b24e3, 0x3eff3d7f, 0x3eff3dff
    .long 0x520800, 0x5be000, 0x3b384440, 0x10827eb0, 0x3c2d3bc0, 0x35073c9a, 0x3eff3e7f, 0x3eff3eff
    .long 0x13b000, 0x1ae800, 0x44404440, 0xc8d2000, 0x1ad01ad0, 0x1ad01ad0, 0x3d7f, 0x3dff
    .long 0x7d5800, 0x834000, 0x44404440, 0xa8cc000, 0x22582258, 0x22582258, 0x3eff, 0x3eff
    .long 0x892800, 0x925800, 0x3b384440, 0x1088d220, 0x3c2d3bc0, 0x35073c9a, 0x3d7f3eff, 0x3d7f3eff
    .long 0x48d800, 0x52b000, 0x3b384440, 0x10827060, 0x3c2d3bc0, 0x35073c9a, 0x3e7f3e7f, 0x3e7f3e7f
    .long 0x111000, 0x1b9000, 0x4a463330, 0x116b1c70, 0x3c7643fc, 0x252b24e3, 0x3e7f3d7f, 0x3e7f3dff
    .long 0x3fa800, 0x498000, 0x3b384440, 0x108262a0, 0x3c2d3bc0, 0x35073c9a, 0x3eff3e7f, 0x3eff3e7f
    .long 0x6d9800, 0x777000, 0x3b384440, 0x1082a8a0, 0x3c2d3bc0, 0x35073c9a, 0x3eff3eff, 0x3eff3eff
    .long 0x520800, 0x5be000, 0x3b384440, 0x10827ec0, 0x3c2d3bc0, 0x35073c9a, 0x3eff3e7f, 0x3eff3eff
    .long 0x199800, 0x1f8000, 0x44404440, 0xa8c2800, 0x22582258, 0x22582258, 0x3dff, 0x3dff
    .long 0x829800, 0x888000, 0x44404440, 0xa8cc800, 0x22582258, 0x22582258, 0x3eff, 0x3eff
    .long 0x93000, 0x130800, 0x39363330, 0x506b1030, 0x2c6e63c0, 0x2d142cc1, 0x3dff3cff, 0x3dff3d7f
    .long 0x520800, 0x5be000, 0x3b384440, 0x10827e30, 0x3c2d3bc0, 0x35073c9a, 0x3dff3e7f, 0x3dff3eff
    .long 0x111000, 0x1b9000, 0x4a463330, 0x116b1c80, 0x3c7643fc, 0x252b24e3, 0x3e7f3d7f, 0x3e7f3dff
    .long 0x48d800, 0x52b000, 0x3b384440, 0x10827070, 0x3c2d3bc0, 0x35073c9a, 0x3e7f3e7f, 0x3e7f3e7f
    .long 0x76c800, 0x80a000, 0x3b384440, 0x1082b670, 0x3c2d3bc0, 0x35073c9a, 0x3e7f3eff, 0x3e7f3eff
    .long 0x520800, 0x5be000, 0x3b384440, 0x10827ed0, 0x3c2d3bc0, 0x35073c9a, 0x3eff3e7f, 0x3eff3eff
    .long 0x1ed800, 0x24c000, 0x44404440, 0xa8c3000, 0x22582258, 0x22582258, 0x3dff, 0x3dff
    .long 0x87d800, 0x8dc000, 0x44404440, 0xa8cd000, 0x22582258, 0x22582258, 0x3eff, 0x3eff
    .long 0x93000, 0x130800, 0x39363330, 0x506b1040, 0x2c6e63c0, 0x2d142cc1, 0x3dff3cff, 0x3dff3d7f
    .long 0x520800, 0x5be000, 0x3b384440, 0x10827e40, 0x3c2d3bc0, 0x35073c9a, 0x3dff3e7f, 0x3dff3eff
    .long 0x111000, 0x1b9000, 0x4a463330, 0x116b1c90, 0x3c7643fc, 0x252b24e3, 0x3eff3d7f, 0x3eff3dff
    .long 0x48d800, 0x52b000, 0x3b384440, 0x10827080, 0x3c2d3bc0, 0x35073c9a, 0x3e7f3e7f, 0x3e7f3e7f
    .long 0x76c800, 0x80a000, 0x3b384440, 0x1082b680, 0x3c2d3bc0, 0x35073c9a, 0x3e7f3eff, 0x3e7f3eff
    .long 0x5b3800, 0x651000, 0x3b384440, 0x10828cb0, 0x3c2d3bc0, 0x35073c9a, 0x3eff3eff, 0x3eff3eff
    .long 0x241800, 0x2a0000, 0x44404440, 0xa8c3800, 0x22582258, 0x22582258, 0x3dff, 0x3dff
    .long 0x3d0800, 0x459000, 0x39363330, 0x4e685e10, 0x43fe4384, 0x44f24478, 0x3cff3e7f, 0x3cff3e7f
    .long 0x93000, 0x130800, 0x39363330, 0x506b1050, 0x2c7b6bc0, 0x25212cce, 0x3e7f3cff, 0x3e7f3d7f
    .long 0x520800, 0x5be000, 0x3b384440, 0x10827e50, 0x3c2d3bc0, 0x35073c9a, 0x3e7f3e7f, 0x3e7f3eff
    .long 0x111000, 0x1b9000, 0x4a463330, 0x116b1ca0, 0x3c7643fc, 0x252b24e3, 0x3eff3d7f, 0x3eff3dff
    .long 0x48d800, 0x52b000, 0x3b384440, 0x10827090, 0x3c2d3bc0, 0x35073c9a, 0x3eff3e7f, 0x3eff3e7f
    .long 0x76c800, 0x80a000, 0x3b384440, 0x1082b690, 0x3c2d3bc0, 0x35073c9a, 0x3eff3eff, 0x3eff3eff
    .long 0x5b3800, 0x651000, 0x3b384440, 0x10828cc0, 0x3c2d3bc0, 0x35073c9a, 0x3eff3eff, 0x3eff3eff
    .long 0x295800, 0x2f4000, 0x44404440, 0xa8c4000, 0x22582258, 0x22582258, 0x3dff, 0x3e7f
    .long 0x367800, 0x405000, 0x3b384440, 0x10885420, 0x3c2d3bc0, 0x35073c9a, 0x3d7f3e7f, 0x3d7f3e7f
    .long 0x93000, 0x130800, 0x39363330, 0x506b1060, 0x2c6e63c0, 0x2d142cc1, 0x3e7f3cff, 0x3e7f3d7f
    .long 0x520800, 0x5be000, 0x3b384440, 0x10827e60, 0x3c2d3bc0, 0x35073c9a, 0x3e7f3e7f, 0x3e7f3eff
    .long 0x76c800, 0x80a000, 0x3b384440, 0x1082b660, 0x3c2d3bc0, 0x35073c9a, 0x3e7f3eff, 0x3e7f3eff
    .long 0x48d800, 0x52b000, 0x3b384440, 0x108270a0, 0x3c2d3bc0, 0x35073c9a, 0x3eff3e7f, 0x3eff3e7f
    .long 0x76c800, 0x80a000, 0x3b384440, 0x1082b6a0, 0x3c2d3bc0, 0x35073c9a, 0x3eff3eff, 0x3eff3eff
    .long 0x5b3800, 0x651000, 0x3b384440, 0x10828cd0, 0x3c2d3bc0, 0x35073c9a, 0x3eff3eff, 0x3eff3eff
    .long 0x2e9800, 0x348000, 0x44404440, 0xa8c4800, 0x22582258, 0x22582258, 0x3e7f, 0x3e7f
    .long 0x44e800, 0x4d7000, 0x39363330, 0x4e686a10, 0x43fe4384, 0x44f24478, 0x3cff3e7f, 0x3cff3e7f
    .long 0x111000, 0x1b9000, 0x4a463330, 0x116b1c30, 0x34834bfc, 0x252b24e3, 0x3dff3d7f, 0x3dff3dff
    .long 0x5b3800, 0x651000, 0x3b384440, 0x10828c30, 0x3c2d3bc0, 0x35073c9a, 0x3dff3eff, 0x3dff3eff
    .long 0x7ff800, 0x89d000, 0x3b384440, 0x1082c430, 0x3c2d3bc0, 0x35073c9a, 0x3dff3eff, 0x3dff3eff
    .long 0x520800, 0x5be000, 0x3b384440, 0x10827e70, 0x3c2d3bc0, 0x35073c9a, 0x3e7f3e7f, 0x3e7f3eff
    .long 0x7ff800, 0x89d000, 0x3b384440, 0x1082c470, 0x3c2d3bc0, 0x35073c9a, 0x3e7f3eff, 0x3e7f3eff
    .long 0x646800, 0x6e4000, 0x3b384440, 0x10829ab0, 0x3c2d3bc0, 0x35073c9a, 0x3eff3eff, 0x3eff3eff
    .long 0x33d800, 0x39c000, 0x44404440, 0xa8c5000, 0x22582258, 0x22582258, 0x3e7f, 0x3e7f
    .long 0x3fa800, 0x498000, 0x3b384440, 0x10886220, 0x3c2d3bc0, 0x3cfa349a, 0x3d7f3e7f, 0x3d7f3e7f
    .long 0x111000, 0x1b9000, 0x4a463330, 0x116b1c40, 0x3c7643fc, 0x252b24e3, 0x3dff3d7f, 0x3dff3dff
    .long 0x5b3800, 0x651000, 0x3b384440, 0x10828c40, 0x3c2d3bc0, 0x35073c9a, 0x3dff3eff, 0x3dff3eff
    .long 0x7ff800, 0x89d000, 0x3b384440, 0x1082c440, 0x3c2d3bc0, 0x35073c9a, 0x3dff3eff, 0x3dff3eff
    .long 0x520800, 0x5be000, 0x3b384440, 0x10827e80, 0x3c2d3bc0, 0x35073c9a, 0x3e7f3e7f, 0x3e7f3eff
    .long 0x7ff800, 0x89d000, 0x3b384440, 0x1082c480, 0x3c2d3bc0, 0x35073c9a, 0x3e7f3eff, 0x3e7f3eff
    .long 0x646800, 0x6e4000, 0x3b384440, 0x10829ac0, 0x3c2d3bc0, 0x35073c9a, 0x3eff3eff, 0x3eff3eff
    .long 0x391800, 0x3f0000, 0x44404440, 0xa8c5800, 0x22582258, 0x22582258, 0x3e7f, 0x3e7f
    .long 0x4cc800, 0x555000, 0x39363330, 0x4e687610, 0x43fe4384, 0x44f24478, 0x3cff3e7f, 0x3cff3e7f
    .long 0x111000, 0x1b9000, 0x4a463330, 0x116b1c50, 0x3c7643fc, 0x252b24e3, 0x3e7f3d7f, 0x3e7f3dff
    .long 0x5b3800, 0x651000, 0x3b384440, 0x10828c50, 0x3c2d3bc0, 0x35073c9a, 0x3e7f3eff, 0x3e7f3eff
    .long 0x7ff800, 0x89d000, 0x3b384440, 0x1082c450, 0x3c2d3bc0, 0x35073c9a, 0x3e7f3eff, 0x3e7f3eff
    .long 0x520800, 0x5be000, 0x3b384440, 0x10827e90, 0x3c2d3bc0, 0x35073c9a, 0x3eff3e7f, 0x3eff3eff
    .long 0x7ff800, 0x89d000, 0x3b384440, 0x1082c490, 0x3c2d3bc0, 0x35073c9a, 0x3eff3eff, 0x3eff3eff
    .long 0x646800, 0x6e4000, 0x3b384440, 0x10829ad0, 0x3c2d3bc0, 0x35073c9a, 0x3eff3eff, 0x3eff3eff
    .long 0x93000, 0x106800, 0x26242220, 0x4c491010, 0x343f6b84, 0x3cff349f, 0x3cff3cff, 0x3cff3d7f
    .long 0x48d800, 0x52b000, 0x3b384440, 0x10887020, 0x3c2d3bc0, 0x35073c9a, 0x3d7f3e7f, 0x3d7f3e7f
    .long 0x111000, 0x1b9000, 0x4a463330, 0x116b1c60, 0x3c7643fc, 0x252b24e3, 0x3e7f3d7f, 0x3e7f3dff
    .long 0x5b3800, 0x651000, 0x3b384440, 0x10828c60, 0x3c2d3bc0, 0x35073c9a, 0x3e7f3eff, 0x3e7f3eff
    .long 0x7ff800, 0x89d000, 0x3b384440, 0x1082c460, 0x3c2d3bc0, 0x35073c9a, 0x3e7f3eff, 0x3e7f3eff
    .long 0x520800, 0x5be000, 0x3b384440, 0x10827ea0, 0x3c2d3bc0, 0x35073c9a, 0x3eff3e7f, 0x3eff3eff
    .long 0x7ff800, 0x89d000, 0x3b384440, 0x1082c4a0, 0x3c2d3bc0, 0x35073c9a, 0x3eff3eff, 0x3eff3eff
    .long 0x6d9800, 0x777000, 0x3b384440, 0x1082a8b0, 0x3c2d3bc0, 0x35073c9a, 0x3eff3eff, 0x3eff3eff
    .long 0xe7000, 0x16f800, 0x28263330, 0x4e691810, 0x4c185384, 0x350c3c9f, 0x3cff3d7f, 0x3cff3d7f
    .long 0x54a800, 0x5d3000, 0x39363330, 0x4e688210, 0x43fe4384, 0x44f24478, 0x3cff3eff, 0x3cff3eff
    .long 0x1ae800, 0x24c000, 0x3b384440, 0x10822a30, 0x3c2d3bc0, 0x35073c9a, 0x3dff3dff, 0x3dff3dff
    .long 0x646800, 0x6e4000, 0x3b384440, 0x10829a30, 0x3c2d3bc0, 0x35073c9a, 0x3dff3eff, 0x3dff3eff
    .long 0x892800, 0x925800, 0x3b384440, 0x1082d230, 0x3c2d3bc0, 0x35073c9a, 0x3dff3eff, 0x3dff3eff
    .long 0x5b3800, 0x651000, 0x3b384440, 0x10828c70, 0x3c2d3bc0, 0x35073c9a, 0x3e7f3eff, 0x3e7f3eff
    .long 0x892800, 0x925800, 0x3b384440, 0x1082d270, 0x3c2d3bc0, 0x35073c9a, 0x3e7f3eff, 0x3e7f3eff
    .long 0x6d9800, 0x777000, 0x3b384440, 0x1082a8c0, 0x3c2d3bc0, 0x35073c9a, 0x3eff3eff, 0x3eff3eff
    .long 0x93000, 0x130800, 0x39363330, 0x50691020, 0x2c7b6bc0, 0x2d1424ce, 0x3d7f3cff, 0x3d7f3d7f
    .long 0x520800, 0x5be000, 0x3b384440, 0x10887e20, 0x3c2d3bc0, 0x3cfa349a, 0x3d7f3e7f, 0x3d7f3eff
    .long 0x1ae800, 0x24c000, 0x3b384440, 0x10822a40, 0x3c2d3bc0, 0x35073c9a, 0x3dff3dff, 0x3dff3dff
    .long 0x646800, 0x6e4000, 0x3b384440, 0x10829a40, 0x3c2d3bc0, 0x35073c9a, 0x3dff3eff, 0x3dff3eff
    .long 0x892800, 0x925800, 0x3b384440, 0x1082d240, 0x3c2d3bc0, 0x35073c9a, 0x3dff3eff, 0x3dff3eff
    .long 0x5b3800, 0x651000, 0x3b384440, 0x10828c80, 0x3c2d3bc0, 0x35073c9a, 0x3e7f3eff, 0x3e7f3eff
    .long 0x892800, 0x925800, 0x3b384440, 0x1082d280, 0x3c2d3bc0, 0x35073c9a, 0x3e7f3eff, 0x3e7f3eff
    .long 0x6d9800, 0x777000, 0x3b384440, 0x1082a8d0, 0x3c2d3bc0, 0x35073c9a, 0x3eff3eff, 0x3eff3eff
    .long 0x150000, 0x1ed800, 0x39363330, 0x50692210, 0x342d3bc0, 0x3cfa3c8d, 0x3cff3dff, 0x3cff3dff
    .long 0x5c8800, 0x651000, 0x39363330, 0x4e688e10, 0x43fe4384, 0x44f24478, 0x3cff3eff, 0x3cff3eff
    .long 0x1ae800, 0x24c000, 0x3b384440, 0x10822a50, 0x3c2d3bc0, 0x35073c9a, 0x3e7f3dff, 0x3e7f3dff
    .long 0x646800, 0x6e4000, 0x3b384440, 0x10829a50, 0x3c2d3bc0, 0x35073c9a, 0x3e7f3eff, 0x3e7f3eff
    .long 0x892800, 0x925800, 0x3b384440, 0x1082d250, 0x3c2d3bc0, 0x35073c9a, 0x3e7f3eff, 0x3e7f3eff
    .long 0x5b3800, 0x651000, 0x3b384440, 0x10828c90, 0x3c2d3bc0, 0x35073c9a, 0x3eff3eff, 0x3eff3eff
    .long 0x892800, 0x925800, 0x3b384440, 0x1082d290, 0x3c2d3bc0, 0x35073c9a, 0x3eff3eff, 0x3eff3eff
    .long 0x76c800, 0x80a000, 0x3b384440, 0x1082b6b0, 0x3c2d3bc0, 0x35073c9a, 0x3eff3eff, 0x3eff3eff
    .long 0x111000, 0x1b9000, 0x4a463330, 0x11691c20, 0x347643fc, 0x25292cd6, 0x3d7f3d7f, 0x3d7f3dff
    .long 0x5b3800, 0x651000, 0x3b384440, 0x10888c20, 0x3c2d3bc0, 0x35073c9a, 0x3d7f3eff, 0x3d7f3eff
    .long 0x1ae800, 0x24c000, 0x3b384440, 0x10822a60, 0x3c2d3bc0, 0x35073c9a, 0x3e7f3dff, 0x3e7f3dff
    .long 0x646800, 0x6e4000, 0x3b384440, 0x10829a60, 0x3c2d3bc0, 0x35073c9a, 0x3e7f3eff, 0x3e7f3eff
    .long 0x892800, 0x925800, 0x3b384440, 0x1082d260, 0x3c2d3bc0, 0x35073c9a, 0x3e7f3eff, 0x3e7f3eff
    .long 0x5b3800, 0x651000, 0x3b384440, 0x10828ca0, 0x3c2d3bc0, 0x35073c9a, 0x3eff3eff, 0x3eff3eff
    .long 0x892800, 0x925800, 0x3b384440, 0x1082d2a0, 0x3c2d3bc0, 0x35073c9a, 0x3eff3eff, 0x3eff3eff
    .long 0x76c800, 0x80a000, 0x3b384440, 0x1082b6c0, 0x3c2d3bc0, 0x35073c9a, 0x3eff3eff, 0x3eff3eff
    .long 0x1d8800, 0x261000, 0x39363330, 0x4e682e10, 0x43fe4384, 0x44f24478, 0x3cff3dff, 0x3cff3dff
    .long 0x646800, 0x6cf000, 0x39363330, 0x4e689a10, 0x43fe4384, 0x44f24478, 0x3cff3eff, 0x3cff3eff
    .long 0x241800, 0x2df000, 0x3b384440, 0x10823830, 0x3c2d3bc0, 0x35073c9a, 0x3dff3dff, 0x3dff3dff
    .long 0x6d9800, 0x777000, 0x3b384440, 0x1082a830, 0x3c2d3bc0, 0x35073c9a, 0x3dff3eff, 0x3dff3eff
    .long 0x1ae800, 0x24c000, 0x3b384440, 0x10822a70, 0x3c2d3bc0, 0x35073c9a, 0x3e7f3dff, 0x3e7f3dff
    .long 0x646800, 0x6e4000, 0x3b384440, 0x10829a70, 0x3c2d3bc0, 0x35073c9a, 0x3e7f3eff, 0x3e7f3eff
    .long 0x1ae800, 0x24c000, 0x3b384440, 0x10822ab0, 0x3c2d3bc0, 0x35073c9a, 0x3eff3dff, 0x3eff3dff
    .long 0x76c800, 0x80a000, 0x3b384440, 0x1082b6d0, 0x3c2d3bc0, 0x35073c9a, 0x3eff3eff, 0x3eff3eff
    .long 0x1ae800, 0x24c000, 0x3b384440, 0x10882a20, 0x3c2d3bc0, 0x3cfa349a, 0x3d7f3dff, 0x3d7f3dff
    .long 0x6c4800, 0x74d000, 0x39363330, 0x4e68a610, 0x43fe4384, 0x44f24478, 0x3cff3eff, 0x3cff3eff
    .long 0x241800, 0x2df000, 0x3b384440, 0x10823840, 0x3c2d3bc0, 0x35073c9a, 0x3dff3dff, 0x3dff3dff
    .long 0x6d9800, 0x777000, 0x3b384440, 0x1082a840, 0x3c2d3bc0, 0x35073c9a, 0x3dff3eff, 0x3dff3eff
    .long 0x1ae800, 0x24c000, 0x3b384440, 0x10822a80, 0x3c2d3bc0, 0x35073c9a, 0x3e7f3dff, 0x3e7f3dff
    .long 0x646800, 0x6e4000, 0x3b384440, 0x10829a80, 0x3c2d3bc0, 0x35073c9a, 0x3e7f3eff, 0x3e7f3eff
    .long 0x1ae800, 0x24c000, 0x3b384440, 0x10822ac0, 0x3c2d3bc0, 0x35073c9a, 0x3eff3dff, 0x3eff3dff
    .long 0x7ff800, 0x89d000, 0x3b384440, 0x1082c4b0, 0x3c2d3bc0, 0x35073c9a, 0x3eff3eff, 0x3eff3eff
    .long 0x256800, 0x2df000, 0x39363330, 0x4e683a10, 0x43fe4384, 0x44f24478, 0x3cff3dff, 0x3cff3dff
    .long 0x646800, 0x6e4000, 0x3b384440, 0x10889a20, 0x3c2d3bc0, 0x35073c9a, 0x3d7f3eff, 0x3d7f3eff
    .long 0x241800, 0x2df000, 0x3b384440, 0x10823850, 0x3c2d3bc0, 0x35073c9a, 0x3e7f3dff, 0x3e7f3dff
    .long 0x6d9800, 0x777000, 0x3b384440, 0x1082a850, 0x3c2d3bc0, 0x35073c9a, 0x3e7f3eff, 0x3e7f3eff
    .long 0x1ae800, 0x24c000, 0x3b384440, 0x10822a90, 0x3c2d3bc0, 0x35073c9a, 0x3eff3dff, 0x3eff3dff
    .long 0x646800, 0x6e4000, 0x3b384440, 0x10829a90, 0x3c2d3bc0, 0x35073c9a, 0x3eff3eff, 0x3eff3eff
    .long 0x1ae800, 0x24c000, 0x3b384440, 0x10822ad0, 0x3c2d3bc0, 0x35073c9a, 0x3eff3dff, 0x3eff3dff
    .long 0x7ff800, 0x89d000, 0x3b384440, 0x1082c4c0, 0x3c2d3bc0, 0x35073c9a, 0x3eff3eff, 0x3eff3eff
    .long 0x241800, 0x2df000, 0x3b384440, 0x10883820, 0x3c2d3bc0, 0x35073c9a, 0x3d7f3dff, 0x3d7f3dff
    .long 0x742800, 0x7cb000, 0x39363330, 0x4e68b210, 0x4bf13b84, 0x44f24478, 0x3cff3eff, 0x3cff3eff
    .long 0x241800, 0x2df000, 0x3b384440, 0x10823860, 0x3c2d3bc0, 0x35073c9a, 0x3e7f3dff, 0x3e7f3dff
    .long 0x6d9800, 0x777000, 0x3b384440, 0x1082a860, 0x3c2d3bc0, 0x35073c9a, 0x3e7f3eff, 0x3e7f3eff
    .long 0x1ae800, 0x24c000, 0x3b384440, 0x10822aa0, 0x3c2d3bc0, 0x35073c9a, 0x3eff3dff, 0x3eff3dff
    .long 0x646800, 0x6e4000, 0x3b384440, 0x10829aa0, 0x3c2d3bc0, 0x35073c9a, 0x3eff3eff, 0x3eff3eff
    .long 0x241800, 0x2df000, 0x3b384440, 0x108238b0, 0x3c2d3bc0, 0x35073c9a, 0x3eff3dff, 0x3eff3dff
    .long 0x7ff800, 0x89d000, 0x3b384440, 0x1082c4d0, 0x3c2d3bc0, 0x35073c9a, 0x3eff3eff, 0x3eff3eff
    .long 0x2d4800, 0x35d000, 0x39363330, 0x4e684610, 0x43fe4384, 0x44f24478, 0x3cff3e7f, 0x3cff3e7f
    .long 0x6d9800, 0x777000, 0x3b384440, 0x1088a820, 0x3c2d3bc0, 0x3cfa349a, 0x3d7f3eff, 0x3d7f3eff
    .long 0x2d4800, 0x372000, 0x3b384440, 0x10824630, 0x3c2d3bc0, 0x35073c9a, 0x3dff3e7f, 0x3dff3e7f
    .long 0x76c800, 0x80a000, 0x3b384440, 0x1082b630, 0x3c2d3bc0, 0x35073c9a, 0x3dff3eff, 0x3dff3eff
    .long 0x241800, 0x2df000, 0x3b384440, 0x10823870, 0x3c2d3bc0, 0x35073c9a, 0x3e7f3dff, 0x3e7f3dff
    .long 0x6d9800, 0x777000, 0x3b384440, 0x1082a870, 0x3c2d3bc0, 0x35073c9a, 0x3e7f3eff, 0x3e7f3eff
    .long 0x241800, 0x2df000, 0x3b384440, 0x108238c0, 0x3c2d3bc0, 0x35073c9a, 0x3eff3dff, 0x3eff3dff
    .long 0x892800, 0x925800, 0x3b384440, 0x1082d2b0, 0x3c2d3bc0, 0x35073c9a, 0x3eff3eff, 0x3eff3eff
    .long 0x352800, 0x3db000, 0x39363330, 0x4e685210, 0x43fe4384, 0x44f24478, 0x3cff3e7f, 0x3cff3e7f
    .long 0x7c0800, 0x849000, 0x39363330, 0x4e68be10, 0x43fe4384, 0x44f24478, 0x3cff3eff, 0x3cff3eff
    .long 0x2d4800, 0x372000, 0x3b384440, 0x10824640, 0x3c2d3bc0, 0x35073c9a, 0x3dff3e7f, 0x3dff3e7f
    .long 0x76c800, 0x80a000, 0x3b384440, 0x1082b640, 0x3c2d3bc0, 0x35073c9a, 0x3dff3eff, 0x3dff3eff
    .long 0x241800, 0x2df000, 0x3b384440, 0x10823880, 0x3c2d3bc0, 0x35073c9a, 0x3e7f3dff, 0x3e7f3dff
    .long 0x6d9800, 0x777000, 0x3b384440, 0x1082a880, 0x3c2d3bc0, 0x35073c9a, 0x3e7f3eff, 0x3e7f3eff
    .long 0x241800, 0x2df000, 0x3b384440, 0x108238d0, 0x3c2d3bc0, 0x35073c9a, 0x3eff3dff, 0x3eff3dff
    .long 0x892800, 0x925800, 0x3b384440, 0x1082d2c0, 0x3c2d3bc0, 0x35073c9a, 0x3eff3eff, 0x3eff3eff
    .long 0x2d4800, 0x372000, 0x3b384440, 0x10884620, 0x3c2d3bc0, 0x3cfa349a, 0x3d7f3e7f, 0x3d7f3e7f
    .long 0x76c800, 0x80a000, 0x3b384440, 0x1088b620, 0x342d3bc0, 0x3cfa3c8d, 0x3d7f3eff, 0x3d7f3eff
    .long 0x2d4800, 0x372000, 0x3b384440, 0x10824650, 0x3c2d3bc0, 0x35073c9a, 0x3e7f3e7f, 0x3e7f3e7f
    .long 0x76c800, 0x80a000, 0x3b384440, 0x1082b650, 0x3c2d3bc0, 0x35073c9a, 0x3e7f3eff, 0x3e7f3eff
    .long 0x241800, 0x2df000, 0x3b384440, 0x10823890, 0x3c2d3bc0, 0x35073c9a, 0x3eff3dff, 0x3eff3dff
    .long 0x6d9800, 0x777000, 0x3b384440, 0x1082a890, 0x3c2d3bc0, 0x35073c9a, 0x3eff3eff, 0x3eff3eff
    .long 0x2d4800, 0x372000, 0x3b384440, 0x108246b0, 0x3c2d3bc0, 0x35073c9a, 0x3eff3e7f, 0x3eff3e7f
    .long 0x892800, 0x925800, 0x3b384440, 0x1082d2d0, 0x3c2d3bc0, 0x35073c9a, 0x3eff3eff, 0x3eff3eff
.section .rodata,"a"
.p2align 6
.amdhsa_kernel standalone__deformable_dcnv1__vision_kernel
  .amdhsa_next_free_vgpr 256
  .amdhsa_next_free_sgpr 102
  .amdhsa_accum_offset 256
  .amdhsa_group_segment_fixed_size 0
  .amdhsa_kernarg_size 48
  .amdhsa_user_sgpr_count 2
  .amdhsa_user_sgpr_kernarg_segment_ptr 1
  .amdhsa_system_sgpr_workgroup_id_x 1
  .amdhsa_float_denorm_mode_32 3
.end_amdhsa_kernel
```

```asm
; @launch grid=(256,1,1) block=(256,1,1) lds=163840
.amdgcn_target "amdgcn-amd-amdhsa--gfx950"
.text
.globl standalone__deformable_dcnv1__vision_kernel
.p2align 12
.p2align 8
.type standalone__deformable_dcnv1__vision_kernel,@function
standalone__deformable_dcnv1__vision_kernel:
    s_cmp_ge_u32 s2, 256
    s_cbranch_scc1 L_end
    s_getpc_b64 s[40:41]
L_pc:
    v_and_b32 v32, 63, v0
    s_lshl_b32 s47, s2, 6
    v_lshlrev_b32 v13, 7, v32
    s_add_u32 s47, s47, L_runtab-L_pc
    s_add_u32 s48, s47, 32
    s_load_dwordx8 s[20:27], s[40:41], s47
    s_load_dwordx8 s[68:75], s[40:41], s48
    s_load_dwordx2 s[12:13], s[0:1], 16
    s_load_dwordx2 s[4:5], s[0:1], 0
    s_load_dwordx2 s[8:9], s[0:1], 8
    s_load_dwordx2 s[16:17], s[0:1], 24
    v_lshrrev_b32 v33, 6, v0
    v_lshlrev_b32 v6, 4, v32
    v_readfirstlane_b32 s28, v33
    v_add_u32 v12, L_ctab-L_pc, v6
    s_lshr_b32 s47, s2, 3
    global_load_dwordx4 v[16:19], v12, s[40:41]
    s_bfe_u32 s48, s2, 0x10007
    s_lshl1_add_u32 s49, s28, s48
    s_lshl_b32 s49, s49, 13
    s_and_b32 s48, s47, 15
    v_add_u32 v33, s49, v13
    v_min_u32 v33, L_cold-L_pc, v33
    s_lshl_b32 exec_lo, 0x10001, s48
    s_mov_b32 exec_hi, exec_lo
    global_load_dword v15, v33, s[40:41]
    s_mov_b64 exec, -1
    s_mov_b32 s6, 9633792
    s_mov_b32 s7, 0x00020000
    s_mov_b32 s10, 1806336
    s_mov_b32 s11, s7
    s_mov_b32 s14, 165888
    s_mov_b32 s15, s7
    s_mov_b32 s18, s6
    s_mov_b32 s19, s7
    s_and_b32 s29, s28, 1
    s_lshr_b32 s30, s28, 1
    s_lshl2_add_u32 s49, s47, s28
    s_mulk_i32 s49, 1280
    s_addk_i32 s49, 12288
    s_cmpk_lt_u32 s2, 38
    s_cselect_b32 s47, 40, 16
    s_cmpk_lt_u32 s2, 113
    s_cselect_b32 s47, s47, 0
    s_cmp_eq_u32 s28, 3
    s_cselect_b32 s47, s47, 0
    v_subrev_u32 v35, s47, v0
    s_lshl_b32 s33, s28, 6
    v_mul_u32_u24 v36, 5462, v35
    s_mul_i32 s44, s28, 3104
    v_lshrrev_b32 v36, 16, v36
    s_sub_u32 s33, s33, s47
    v_mad_i32_i24 v33, v36, -12, v35
    v_bfe_u32 v34, v36, 2, 2
    s_lshl_b32 s33, s33, 4
    v_xor_b32 v33, v33, v34
    s_mul_i32 s46, s28, 3072
    v_lshlrev_b32 v8, 4, v33
    s_movk_i32 s48, 223
    v_mov_b32 v35, 2130706432
    s_cmpk_lt_u32 s2, 113
    v_add_u32 v7, s46, v6
    s_cbranch_scc1 L_X
    v_cmp_gt_u32 vcc, 18, v36
    s_add_u32 s44, s44, 65536
    s_mul_i32 s45, s30, 93120
    s_sub_u32 s45, s44, s45
    s_cmp_eq_u32 s30, 0
    v_cndmask_b32 v8, v35, v8, vcc
    s_waitcnt lgkmcnt(0)
    s_cselect_b32 s31, s26, s27
    s_cselect_b32 s35, s24, s25
    s_mov_b64 exec, 0x3ff
    buffer_load_dword v13, v13, s[12:15], s49 offen
    s_mov_b64 exec, -1
    s_add_u32 m0, s44, 0
    s_mov_b32 s46, 0
    buffer_load_dwordx4 v7, s[12:15], s46 offen offset:0 lds
    buffer_load_dwordx4 v7, s[12:15], s46 offen offset:1024 lds
    buffer_load_dwordx4 v7, s[12:15], s46 offen offset:2048 lds
    s_and_b32 s47, s23, 0xff
    v_add3_u32 v34, v36, s47, -1
    v_min_u32 v34, s48, v34
    v_mul_u32_u24 v34, 192, v34
    v_add_u32 v8, v34, v8
    s_add_u32 m0, s44, 12416
    s_mov_b32 s46, 12288
    buffer_load_dwordx4 v7, s[12:15], s46 offen offset:0 lds
    buffer_load_dwordx4 v7, s[12:15], s46 offen offset:1024 lds
    buffer_load_dwordx4 v7, s[12:15], s46 offen offset:2048 lds
    s_add_u32 m0, s33, 0
    s_add_u32 s56, s20, 0
    buffer_load_dwordx4 v8, s[4:7], s56 offen lds
    s_add_u32 m0, s33, 28672
    s_add_u32 s63, s20, 301056
    buffer_load_dwordx4 v8, s[4:7], s63 offen lds
    s_add_u32 m0, s33, 4096
    s_add_u32 s57, s20, 43008
    buffer_load_dwordx4 v8, s[4:7], s57 offen lds
    s_add_u32 m0, s33, 32768
    s_add_u32 s64, s20, 344064
    buffer_load_dwordx4 v8, s[4:7], s64 offen lds
    s_add_u32 m0, s33, 8192
    s_add_u32 s58, s20, 86016
    buffer_load_dwordx4 v8, s[4:7], s58 offen lds
    s_add_u32 m0, s33, 36864
    s_add_u32 s65, s20, 387072
    buffer_load_dwordx4 v8, s[4:7], s65 offen lds
    s_branch L_N2
L_X:
    s_cmpk_ge_u32 s2, 38
    s_cselect_b32 s60, 1, 0
    s_cselect_b32 s43, 1, 5
    s_cselect_b32 s42, 0, -9
    s_sub_u32 s47, s2, 19
    s_movk_i32 s36, 192
    s_mov_b32 s38, 43008
    s_movk_i32 s39, 8064
    s_cmpk_lt_u32 s47, 40
    s_cselect_b32 s56, 1, 0
    s_cselect_b32 s55, s36, s38
    s_cselect_b32 s2, s38, s36
    s_cselect_b32 s37, 36, s39
    s_cselect_b32 s39, s39, 36
    s_lshl_b32 s47, s60, 10
    v_add_u32 v33, s47, v12
    global_load_dwordx4 v[164:167], v33, s[40:41] offset:1024
    global_load_dwordx4 v[168:171], v33, s[40:41] offset:2048
    v_mul_u32_u24 v40, 86, v32
    s_lshl2_add_u32 s47, s39, -36
    v_mul_u32_u24 v37, 12, v32
    s_mul_i32 s43, s43, s37
    v_lshrrev_b32 v40, 8, v40
    s_lshl_b32 s36, s39, 4
    s_mul_i32 s42, s42, s37
    v_lshrrev_b32 v41, 2, v40
    v_mad_u32_u24 v37, v40, s47, v37
    s_sub_u32 s43, s43, s36
    v_lshrrev_b32 v34, 3, v40
    v_and_b32 v33, 4, v41
    v_mad_i32_i24 v37, v41, s43, v37
    s_lshl_b32 s37, s37, 1
    v_lshl_or_b32 v38, v33, 4, v41
    v_mad_i32_i24 v37, v34, s42, v37
    s_lshl_b32 s37, s37, s60
    v_add_u32 v33, s28, v41
    v_mad_i32_i24 v39, v40, -3, v32
    v_and_b32 v33, 3, v33
    v_and_b32 v40, 3, v40
    v_mad_u32_u24 v37, v33, s39, v37
    v_lshl_add_u32 v40, v40, 2, v33
    s_waitcnt lgkmcnt(0)
    v_cmp_gt_u32 vcc, s75, v38
    v_add_u32 v38, 4, v38
    s_mov_b32 s32, s74
    v_cndmask_b32 v34, v35, v37, vcc
    buffer_load_dwordx3 v[44:46], v34, s[8:11], s32 offen
    v_cmp_gt_u32 vcc, s75, v38
    v_add_u32 v38, 4, v38
    s_add_u32 s32, s32, s37
    v_cndmask_b32 v34, v35, v37, vcc
    buffer_load_dwordx3 v[48:50], v34, s[8:11], s32 offen
    v_cmp_gt_u32 vcc, s75, v38
    v_add_u32 v38, 4, v38
    s_add_u32 s32, s32, s37
    v_cndmask_b32 v34, v35, v37, vcc
    buffer_load_dwordx3 v[52:54], v34, s[8:11], s32 offen
    s_bfe_i32 s43, s23, 0x90014
    s_mov_b64 exec, 0x3ff
    buffer_load_dword v13, v13, s[12:15], s49 offen
    s_mov_b64 exec, -1
    v_add_u32 v34, s43, v36
    s_cmp_eq_u32 s60, 0
    v_med3_i32 v34, v34, 0, s48
    v_mad_u32_u24 v8, v34, s2, v8
    s_cbranch_scc0 L_Xp
    s_add_u32 m0, s44, 88992
    s_bfe_u32 s46, s24, 0x40000
    s_mul_i32 s46, s46, 18432
    buffer_load_dwordx4 v7, s[12:15], s46 offen offset:0 lds
    buffer_load_dwordx4 v7, s[12:15], s46 offen offset:1024 lds
    buffer_load_dwordx4 v7, s[12:15], s46 offen offset:2048 lds
    s_add_u32 m0, s44, 101408
    s_add_u32 s64, s46, 12288
    s_bfe_u32 s65, s24, 0x40004
    s_mul_i32 s65, s65, 18432
    s_sub_u32 s46, s65, 6144
    s_cmp_eq_u32 s30, 0
    s_cselect_b32 s46, s64, s46
    buffer_load_dwordx4 v7, s[12:15], s46 offen offset:0 lds
    buffer_load_dwordx4 v7, s[12:15], s46 offen offset:1024 lds
    buffer_load_dwordx4 v7, s[12:15], s46 offen offset:2048 lds
    s_branch L_S
L_Xp:
    s_add_u32 m0, s33, 0
    s_max_i32 s47, s20, 0
    s_add_u32 s20, s20, s55
    buffer_load_dwordx4 v8, s[4:7], s47 offen lds
    s_add_u32 m0, s33, 3904
    s_max_i32 s47, s20, 0
    s_add_u32 s20, s20, s55
    buffer_load_dwordx4 v8, s[4:7], s47 offen lds
    s_add_u32 m0, s33, 7808
    s_min_i32 s47, s20, s21
    s_add_u32 s20, s20, s55
    buffer_load_dwordx4 v8, s[4:7], s47 offen lds
    s_add_u32 m0, s33, 11712
    s_min_i32 s47, s20, s21
    s_add_u32 s20, s20, s55
    buffer_load_dwordx4 v8, s[4:7], s47 offen lds
    s_add_u32 m0, s33, 15616
    s_min_i32 s47, s20, s21
    s_add_u32 s20, s20, s55
    buffer_load_dwordx4 v8, s[4:7], s47 offen lds
    s_add_u32 m0, s33, 19520
    s_min_i32 s47, s20, s21
    s_add_u32 s20, s20, s55
    buffer_load_dwordx4 v8, s[4:7], s47 offen lds
    s_add_u32 m0, s33, 23424
    s_min_i32 s47, s20, s21
    s_add_u32 s20, s20, s55
    buffer_load_dwordx4 v8, s[4:7], s47 offen lds
    s_branch L_P
L_N2:
    s_add_u32 s59, s20, 129024
    s_add_u32 s60, s20, 172032
    s_add_u32 s61, s20, 215040
    s_add_u32 s62, s20, 258048
    s_add_u32 s66, s20, 430080
    s_add_u32 s67, s20, 473088
    s_add_u32 s68, s20, 516096
    s_add_u32 s69, s20, 559104
    s_add_u32 s70, s20, 602112
    s_add_u32 s71, s20, 645120
    s_min_i32 s71, s71, s21
    s_lshl_b32 s48, s29, 7
    s_lshl_b32 s49, s29, 5
    s_add_u32 s47, s48, 65536
    s_waitcnt vmcnt(14)
    v_add_u32_sdwa v4, s47, v16 dst_sel:DWORD dst_unused:UNUSED_PAD src0_sel:DWORD src1_sel:WORD_0
    s_add_u32 s47, s49, 65536
    v_add_u32_sdwa v5, s47, v16 dst_sel:DWORD dst_unused:UNUSED_PAD src0_sel:DWORD src1_sel:WORD_0
    s_mul_i32 s47, s30, 28672
    v_add_u32_sdwa v1, s47, v16 dst_sel:DWORD dst_unused:UNUSED_PAD src0_sel:DWORD src1_sel:WORD_1
    v_add_u32_sdwa v2, s47, v17 dst_sel:DWORD dst_unused:UNUSED_PAD src0_sel:DWORD src1_sel:WORD_0
    v_add_u32_sdwa v3, s47, v17 dst_sel:DWORD dst_unused:UNUSED_PAD src0_sel:DWORD src1_sel:WORD_1
    v_add_u32_sdwa v9, s48, v18 dst_sel:DWORD dst_unused:UNUSED_PAD src0_sel:DWORD src1_sel:WORD_0
    v_add_u32_sdwa v10, s49, v18 dst_sel:DWORD dst_unused:UNUSED_PAD src0_sel:DWORD src1_sel:WORD_1
    v_mov_b32 v14, v19
    s_mul_i32 s32, s31, 3
    s_lshr_b32 s32, s32, 4
    s_waitcnt vmcnt(6)
    s_barrier
    ds_read_b64_tr_b16 a[0:1], v4 offset:0
    ds_read_b64_tr_b16 a[2:3], v4 offset:768
    ds_read_b64_tr_b16 a[4:5], v4 offset:32
    ds_read_b64_tr_b16 a[6:7], v4 offset:800
    ds_read_b64_tr_b16 a[8:9], v5 offset:64
    ds_read_b64_tr_b16 a[10:11], v5 offset:832
    ds_read_b64_tr_b16 a[12:13], v4 offset:6208
    ds_read_b64_tr_b16 a[14:15], v4 offset:6976
    ds_read_b64_tr_b16 a[16:17], v4 offset:6240
    ds_read_b64_tr_b16 a[18:19], v4 offset:7008
    ds_read_b64_tr_b16 a[20:21], v5 offset:6272
    ds_read_b64_tr_b16 a[22:23], v5 offset:7040
    ds_read_b64_tr_b16 a[24:25], v4 offset:12416
    ds_read_b64_tr_b16 a[26:27], v4 offset:13184
    ds_read_b64_tr_b16 a[28:29], v4 offset:12448
    ds_read_b64_tr_b16 a[30:31], v4 offset:13216
    ds_read_b64_tr_b16 a[32:33], v5 offset:12480
    ds_read_b64_tr_b16 a[34:35], v5 offset:13248
    ds_read_b64_tr_b16 a[36:37], v4 offset:18624
    ds_read_b64_tr_b16 a[38:39], v4 offset:19392
    ds_read_b64_tr_b16 a[40:41], v4 offset:18656
    ds_read_b64_tr_b16 a[42:43], v4 offset:19424
    ds_read_b64_tr_b16 a[44:45], v5 offset:18688
    ds_read_b64_tr_b16 a[46:47], v5 offset:19456
    s_add_u32 m0, s44, 24832
    s_mov_b32 s46, 24576
    buffer_load_dwordx4 v7, s[12:15], s46 offen offset:0 lds
    buffer_load_dwordx4 v7, s[12:15], s46 offen offset:1024 lds
    buffer_load_dwordx4 v7, s[12:15], s46 offen offset:2048 lds
    s_add_u32 m0, s44, 37248
    s_mov_b32 s46, 36864
    buffer_load_dwordx4 v7, s[12:15], s46 offen offset:0 lds
    buffer_load_dwordx4 v7, s[12:15], s46 offen offset:1024 lds
    buffer_load_dwordx4 v7, s[12:15], s46 offen offset:2048 lds
    s_add_u32 m0, s44, 49664
    s_mov_b32 s46, 49152
    buffer_load_dwordx4 v7, s[12:15], s46 offen offset:0 lds
    buffer_load_dwordx4 v7, s[12:15], s46 offen offset:1024 lds
    buffer_load_dwordx4 v7, s[12:15], s46 offen offset:2048 lds
    s_add_u32 m0, s33, 12288
    s_nop 0
    buffer_load_dwordx4 v8, s[4:7], s59 offen lds
    s_add_u32 m0, s33, 40960
    s_nop 0
    buffer_load_dwordx4 v8, s[4:7], s66 offen lds
    s_add_u32 m0, s44, 62080
    s_mov_b32 s46, 61440
    buffer_load_dwordx4 v7, s[12:15], s46 offen offset:0 lds
    s_waitcnt vmcnt(9)
    s_barrier
    ds_read_b128 v[80:83], v1 offset:0
    ds_read_b128 v[116:119], v1 offset:4096
    ds_read_b128 v[152:155], v1 offset:8192
    ds_read_b128 v[84:87], v1 offset:64
    ds_read_b128 v[120:123], v1 offset:4160
    ds_read_b128 v[156:159], v1 offset:8256
    s_waitcnt lgkmcnt(5)
    v_mfma_f32_16x16x32_bf16 v[44:47], a[0:3], v[80:83], 0
    ds_read_b128 v[88:91], v1 offset:128
    v_mfma_f32_16x16x32_bf16 v[48:51], a[4:7], v[80:83], 0
    ds_read_b128 v[124:127], v1 offset:4224
    v_mfma_f32_16x16x32_bf16 v[52:55], a[8:11], v[80:83], 0
    buffer_load_dwordx4 v7, s[12:15], s46 offen offset:1024 lds
    s_waitcnt lgkmcnt(6)
    v_mfma_f32_16x16x32_bf16 v[64:67], a[8:11], v[116:119], 0
    ds_read_b128 v[160:163], v1 offset:8320
    v_mfma_f32_16x16x32_bf16 v[60:63], a[4:7], v[116:119], 0
    ds_read_b128 v[92:95], v2 offset:0
    v_mfma_f32_16x16x32_bf16 v[56:59], a[0:3], v[116:119], 0
    ds_read_b128 v[128:131], v2 offset:4096
    s_waitcnt lgkmcnt(7)
    v_mfma_f32_16x16x32_bf16 v[68:71], a[0:3], v[152:155], 0
    ds_read_b128 v[164:167], v2 offset:8192
    v_mfma_f32_16x16x32_bf16 v[72:75], a[4:7], v[152:155], 0
    buffer_load_dwordx4 v7, s[12:15], s46 offen offset:2048 lds
    v_mfma_f32_16x16x32_bf16 v[76:79], a[8:11], v[152:155], 0
    ds_read_b128 v[96:99], v2 offset:64
    v_mfma_f32_16x16x32_bf16 v[44:47], a[12:15], v[84:87], v[44:47]
    ds_read_b64_tr_b16 a[48:49], v4 offset:24832
    v_mfma_f32_16x16x32_bf16 v[48:51], a[16:19], v[84:87], v[48:51]
    ds_read_b64_tr_b16 a[50:51], v4 offset:25600
    v_mfma_f32_16x16x32_bf16 v[52:55], a[20:23], v[84:87], v[52:55]
    ds_read_b64_tr_b16 a[52:53], v4 offset:24864
    s_waitcnt lgkmcnt(7)
    v_mfma_f32_16x16x32_bf16 v[64:67], a[20:23], v[120:123], v[64:67]
    s_add_u32 m0, s44, 74496
    s_mov_b32 s46, 73728
    v_mfma_f32_16x16x32_bf16 v[60:63], a[16:19], v[120:123], v[60:63]
    buffer_load_dwordx4 v7, s[12:15], s46 offen offset:0 lds
    v_mfma_f32_16x16x32_bf16 v[56:59], a[12:15], v[120:123], v[56:59]
    ds_read_b64_tr_b16 a[54:55], v4 offset:25632
    v_mfma_f32_16x16x32_bf16 v[68:71], a[12:15], v[156:159], v[68:71]
    ds_read_b64_tr_b16 a[56:57], v5 offset:24896
    v_mfma_f32_16x16x32_bf16 v[72:75], a[16:19], v[156:159], v[72:75]
    ds_read_b64_tr_b16 a[58:59], v5 offset:25664
    v_mfma_f32_16x16x32_bf16 v[76:79], a[20:23], v[156:159], v[76:79]
    ds_read_b128 v[132:135], v2 offset:4160
    v_mfma_f32_16x16x32_bf16 v[44:47], a[24:27], v[88:91], v[44:47]
    buffer_load_dwordx4 v7, s[12:15], s46 offen offset:1024 lds
    v_mfma_f32_16x16x32_bf16 v[48:51], a[28:31], v[88:91], v[48:51]
    ds_read_b128 v[168:171], v2 offset:8256
    v_mfma_f32_16x16x32_bf16 v[52:55], a[32:35], v[88:91], v[52:55]
    ds_read_b128 v[100:103], v2 offset:128
    v_mfma_f32_16x16x32_bf16 v[64:67], a[32:35], v[124:127], v[64:67]
    ds_read_b64_tr_b16 a[60:61], v4 offset:31040
    v_mfma_f32_16x16x32_bf16 v[60:63], a[28:31], v[124:127], v[60:63]
    ds_read_b64_tr_b16 a[62:63], v4 offset:31808
    v_mfma_f32_16x16x32_bf16 v[56:59], a[24:27], v[124:127], v[56:59]
    buffer_load_dwordx4 v7, s[12:15], s46 offen offset:2048 lds
    v_mfma_f32_16x16x32_bf16 v[68:71], a[24:27], v[160:163], v[68:71]
    ds_read_b64_tr_b16 a[64:65], v4 offset:31072
    v_mfma_f32_16x16x32_bf16 v[72:75], a[28:31], v[160:163], v[72:75]
    ds_read_b64_tr_b16 a[66:67], v4 offset:31840
    v_mfma_f32_16x16x32_bf16 v[76:79], a[32:35], v[160:163], v[76:79]
    ds_read_b64_tr_b16 a[68:69], v5 offset:31104
    s_waitcnt vmcnt(8)
    s_barrier
    s_waitcnt lgkmcnt(7)
    v_mfma_f32_16x16x32_bf16 v[44:47], a[36:39], v[92:95], v[44:47]
    ds_read_b64_tr_b16 a[70:71], v5 offset:31872
    v_mfma_f32_16x16x32_bf16 v[48:51], a[40:43], v[92:95], v[48:51]
    ds_read_b128 v[136:139], v2 offset:4224
    v_mfma_f32_16x16x32_bf16 v[52:55], a[44:47], v[92:95], v[52:55]
    ds_read_b128 v[172:175], v2 offset:8320
    s_add_u32 m0, s45, 86912
    s_mov_b32 s46, 86016
    v_mfma_f32_16x16x32_bf16 v[64:67], a[44:47], v[128:131], v[64:67]
    buffer_load_dwordx4 v7, s[12:15], s46 offen offset:0 lds
    v_mfma_f32_16x16x32_bf16 v[60:63], a[40:43], v[128:131], v[60:63]
    ds_read_b128 v[104:107], v3 offset:0
    v_mfma_f32_16x16x32_bf16 v[56:59], a[36:39], v[128:131], v[56:59]
    ds_read_b64_tr_b16 a[72:73], v4 offset:37248
    ds_read_b64_tr_b16 a[74:75], v4 offset:38016
    v_mfma_f32_16x16x32_bf16 v[68:71], a[36:39], v[164:167], v[68:71]
    buffer_load_dwordx4 v7, s[12:15], s46 offen offset:1024 lds
    v_mfma_f32_16x16x32_bf16 v[72:75], a[40:43], v[164:167], v[72:75]
    ds_read_b64_tr_b16 a[76:77], v4 offset:37280
    v_mfma_f32_16x16x32_bf16 v[76:79], a[44:47], v[164:167], v[76:79]
    ds_read_b64_tr_b16 a[78:79], v4 offset:38048
    v_mfma_f32_16x16x32_bf16 v[44:47], a[48:51], v[96:99], v[44:47]
    ds_read_b64_tr_b16 a[80:81], v5 offset:37312
    ds_read_b64_tr_b16 a[82:83], v5 offset:38080
    v_mfma_f32_16x16x32_bf16 v[48:51], a[52:55], v[96:99], v[48:51]
    buffer_load_dwordx4 v7, s[12:15], s46 offen offset:2048 lds
    v_mfma_f32_16x16x32_bf16 v[52:55], a[56:59], v[96:99], v[52:55]
    ds_read_b128 v[140:143], v3 offset:4096
    v_mfma_f32_16x16x32_bf16 v[64:67], a[56:59], v[132:135], v[64:67]
    ds_read_b128 v[176:179], v3 offset:8192
    v_mfma_f32_16x16x32_bf16 v[60:63], a[52:55], v[132:135], v[60:63]
    ds_read_b128 v[108:111], v3 offset:64
    ds_read_b64_tr_b16 a[84:85], v4 offset:43456
    v_mfma_f32_16x16x32_bf16 v[56:59], a[48:51], v[132:135], v[56:59]
    s_add_u32 m0, s44, 6208
    s_mov_b32 s46, 98304
    ds_read_b64_tr_b16 a[86:87], v4 offset:44224
    s_waitcnt lgkmcnt(7)
    v_mfma_f32_16x16x32_bf16 v[68:71], a[48:51], v[168:171], v[68:71]
    buffer_load_dwordx4 v7, s[12:15], s46 offen offset:0 lds
    v_mfma_f32_16x16x32_bf16 v[72:75], a[52:55], v[168:171], v[72:75]
    ds_read_b64_tr_b16 a[88:89], v4 offset:43488
    v_mfma_f32_16x16x32_bf16 v[76:79], a[56:59], v[168:171], v[76:79]
    ds_read_b64_tr_b16 a[90:91], v4 offset:44256
    v_mfma_f32_16x16x32_bf16 v[44:47], a[60:63], v[100:103], v[44:47]
    ds_read_b64_tr_b16 a[92:93], v5 offset:43520
    ds_read_b64_tr_b16 a[94:95], v5 offset:44288
    v_mfma_f32_16x16x32_bf16 v[48:51], a[64:67], v[100:103], v[48:51]
    buffer_load_dwordx4 v7, s[12:15], s46 offen offset:1024 lds
    v_mfma_f32_16x16x32_bf16 v[52:55], a[68:71], v[100:103], v[52:55]
    ds_read_b128 v[144:147], v3 offset:4160
    v_mfma_f32_16x16x32_bf16 v[64:67], a[68:71], v[136:139], v[64:67]
    ds_read_b128 v[180:183], v3 offset:8256
    v_mfma_f32_16x16x32_bf16 v[60:63], a[64:67], v[136:139], v[60:63]
    ds_read_b128 v[112:115], v3 offset:128
    ds_read_b64_tr_b16 a[96:97], v4 offset:49664
    v_mfma_f32_16x16x32_bf16 v[56:59], a[60:63], v[136:139], v[56:59]
    buffer_load_dwordx4 v7, s[12:15], s46 offen offset:2048 lds
    v_mfma_f32_16x16x32_bf16 v[68:71], a[60:63], v[172:175], v[68:71]
    ds_read_b64_tr_b16 a[98:99], v4 offset:50432
    v_mfma_f32_16x16x32_bf16 v[72:75], a[64:67], v[172:175], v[72:75]
    ds_read_b64_tr_b16 a[100:101], v4 offset:49696
    v_mfma_f32_16x16x32_bf16 v[76:79], a[68:71], v[172:175], v[76:79]
    ds_read_b64_tr_b16 a[102:103], v4 offset:50464
    s_waitcnt vmcnt(9)
    s_barrier
    v_mfma_f32_16x16x32_bf16 v[44:47], a[72:75], v[104:107], v[44:47]
    ds_read_b64_tr_b16 a[104:105], v5 offset:49728
    v_mfma_f32_16x16x32_bf16 v[48:51], a[76:79], v[104:107], v[48:51]
    ds_read_b64_tr_b16 a[106:107], v5 offset:50496
    s_waitcnt lgkmcnt(7)
    v_mfma_f32_16x16x32_bf16 v[52:55], a[80:83], v[104:107], v[52:55]
    ds_read_b128 v[148:151], v3 offset:4224
    ds_read_b128 v[184:187], v3 offset:8320
    s_add_u32 m0, s33, 16384
    v_mfma_f32_16x16x32_bf16 v[64:67], a[80:83], v[140:143], v[64:67]
    buffer_load_dwordx4 v8, s[4:7], s60 offen lds
    v_mfma_f32_16x16x32_bf16 v[60:63], a[76:79], v[140:143], v[60:63]
    v_add_u32 v4, 55872, v4
    v_add_u32 v5, 55872, v5
    v_mfma_f32_16x16x32_bf16 v[56:59], a[72:75], v[140:143], v[56:59]
    ds_read_b64_tr_b16 a[108:109], v4 offset:0
    v_mfma_f32_16x16x32_bf16 v[68:71], a[72:75], v[176:179], v[68:71]
    s_add_u32 m0, s33, 45056
    v_mfma_f32_16x16x32_bf16 v[72:75], a[76:79], v[176:179], v[72:75]
    buffer_load_dwordx4 v8, s[4:7], s67 offen lds
    v_mfma_f32_16x16x32_bf16 v[76:79], a[80:83], v[176:179], v[76:79]
    ds_read_b64_tr_b16 a[110:111], v4 offset:768
    v_mfma_f32_16x16x32_bf16 v[44:47], a[84:87], v[108:111], v[44:47]
    ds_read_b64_tr_b16 a[112:113], v4 offset:32
    v_mfma_f32_16x16x32_bf16 v[48:51], a[88:91], v[108:111], v[48:51]
    ds_read_b64_tr_b16 a[114:115], v4 offset:800
    v_mfma_f32_16x16x32_bf16 v[52:55], a[92:95], v[108:111], v[52:55]
    ds_read_b64_tr_b16 a[116:117], v5 offset:64
    ds_read_b64_tr_b16 a[118:119], v5 offset:832
    v_mfma_f32_16x16x32_bf16 v[64:67], a[92:95], v[144:147], v[64:67]
    s_add_u32 m0, s44, 18624
    s_mov_b32 s46, 110592
    v_mfma_f32_16x16x32_bf16 v[60:63], a[88:91], v[144:147], v[60:63]
    buffer_load_dwordx4 v7, s[12:15], s46 offen offset:0 lds
    v_mfma_f32_16x16x32_bf16 v[56:59], a[84:87], v[144:147], v[56:59]
    ds_read_b128 v[80:83], v1 offset:12288
    v_mfma_f32_16x16x32_bf16 v[68:71], a[84:87], v[180:183], v[68:71]
    ds_read_b64_tr_b16 a[120:121], v4 offset:6208
    v_mfma_f32_16x16x32_bf16 v[72:75], a[88:91], v[180:183], v[72:75]
    ds_read_b64_tr_b16 a[122:123], v4 offset:6976
    v_mfma_f32_16x16x32_bf16 v[76:79], a[92:95], v[180:183], v[76:79]
    ds_read_b64_tr_b16 a[124:125], v4 offset:6240
    s_waitcnt lgkmcnt(7)
    v_mfma_f32_16x16x32_bf16 v[44:47], a[96:99], v[112:115], v[44:47]
    buffer_load_dwordx4 v7, s[12:15], s46 offen offset:1024 lds
    v_mfma_f32_16x16x32_bf16 v[48:51], a[100:103], v[112:115], v[48:51]
    ds_read_b64_tr_b16 a[126:127], v4 offset:7008
    v_mfma_f32_16x16x32_bf16 v[52:55], a[104:107], v[112:115], v[52:55]
    ds_read_b64_tr_b16 a[128:129], v5 offset:6272
    v_mfma_f32_16x16x32_bf16 v[64:67], a[104:107], v[148:151], v[64:67]
    ds_read_b64_tr_b16 a[130:131], v5 offset:7040
    v_mfma_f32_16x16x32_bf16 v[60:63], a[100:103], v[148:151], v[60:63]
    ds_read_b128 v[84:87], v1 offset:12352
    ds_read_b64_tr_b16 a[132:133], v4 offset:12416
    v_mfma_f32_16x16x32_bf16 v[56:59], a[96:99], v[148:151], v[56:59]
    buffer_load_dwordx4 v7, s[12:15], s46 offen offset:2048 lds
    v_mfma_f32_16x16x32_bf16 v[68:71], a[96:99], v[184:187], v[68:71]
    ds_read_b64_tr_b16 a[134:135], v4 offset:13184
    v_mfma_f32_16x16x32_bf16 v[72:75], a[100:103], v[184:187], v[72:75]
    ds_read_b64_tr_b16 a[136:137], v4 offset:12448
    v_mfma_f32_16x16x32_bf16 v[76:79], a[104:107], v[184:187], v[76:79]
    ds_read_b64_tr_b16 a[138:139], v4 offset:13216
    s_waitcnt vmcnt(8)
    s_barrier
    v_mfma_f32_16x16x32_bf16 v[44:47], a[108:111], v[116:119], v[44:47]
    ds_read_b64_tr_b16 a[140:141], v5 offset:12480
    s_waitcnt lgkmcnt(7)
    v_mfma_f32_16x16x32_bf16 v[48:51], a[112:115], v[116:119], v[48:51]
    ds_read_b64_tr_b16 a[142:143], v5 offset:13248
    v_mfma_f32_16x16x32_bf16 v[52:55], a[116:119], v[116:119], v[52:55]
    ds_read_b128 v[88:91], v1 offset:12416
    s_add_u32 m0, s44, 31040
    s_mov_b32 s46, 122880
    v_mfma_f32_16x16x32_bf16 v[64:67], a[116:119], v[152:155], v[64:67]
    buffer_load_dwordx4 v7, s[12:15], s46 offen offset:0 lds
    v_mfma_f32_16x16x32_bf16 v[60:63], a[112:115], v[152:155], v[60:63]
    ds_read_b64_tr_b16 a[144:145], v4 offset:18624
    v_mfma_f32_16x16x32_bf16 v[56:59], a[108:111], v[152:155], v[56:59]
    ds_read_b64_tr_b16 a[146:147], v4 offset:19392
    v_mfma_f32_16x16x32_bf16 v[68:71], a[108:111], v[80:83], v[68:71]
    buffer_load_dwordx4 v7, s[12:15], s46 offen offset:1024 lds
    v_mfma_f32_16x16x32_bf16 v[72:75], a[112:115], v[80:83], v[72:75]
    ds_read_b64_tr_b16 a[148:149], v4 offset:18656
    v_mfma_f32_16x16x32_bf16 v[76:79], a[116:119], v[80:83], v[76:79]
    ds_read_b64_tr_b16 a[150:151], v4 offset:19424
    v_mfma_f32_16x16x32_bf16 v[44:47], a[120:123], v[120:123], v[44:47]
    ds_read_b64_tr_b16 a[152:153], v5 offset:18688
    v_mfma_f32_16x16x32_bf16 v[48:51], a[124:127], v[120:123], v[48:51]
    buffer_load_dwordx4 v7, s[12:15], s46 offen offset:2048 lds
    s_waitcnt lgkmcnt(7)
    v_mfma_f32_16x16x32_bf16 v[52:55], a[128:131], v[120:123], v[52:55]
    ds_read_b64_tr_b16 a[154:155], v5 offset:19456
    v_mfma_f32_16x16x32_bf16 v[64:67], a[128:131], v[156:159], v[64:67]
    ds_read_b128 v[92:95], v2 offset:12288
    v_mfma_f32_16x16x32_bf16 v[60:63], a[124:127], v[156:159], v[60:63]
    ds_read_b64_tr_b16 a[156:157], v4 offset:24832
    ds_read_b64_tr_b16 a[158:159], v4 offset:25600
    v_mfma_f32_16x16x32_bf16 v[56:59], a[120:123], v[156:159], v[56:59]
    s_add_u32 m0, s44, 43456
    s_mov_b32 s46, 135168
    v_mfma_f32_16x16x32_bf16 v[68:71], a[120:123], v[84:87], v[68:71]
    buffer_load_dwordx4 v7, s[12:15], s46 offen offset:0 lds
    v_mfma_f32_16x16x32_bf16 v[72:75], a[124:127], v[84:87], v[72:75]
    ds_read_b64_tr_b16 a[160:161], v4 offset:24864
    v_mfma_f32_16x16x32_bf16 v[76:79], a[128:131], v[84:87], v[76:79]
    ds_read_b64_tr_b16 a[162:163], v4 offset:25632
    v_mfma_f32_16x16x32_bf16 v[44:47], a[132:135], v[124:127], v[44:47]
    ds_read_b64_tr_b16 a[164:165], v5 offset:24896
    v_mfma_f32_16x16x32_bf16 v[48:51], a[136:139], v[124:127], v[48:51]
    buffer_load_dwordx4 v7, s[12:15], s46 offen offset:1024 lds
    s_waitcnt lgkmcnt(7)
    v_mfma_f32_16x16x32_bf16 v[52:55], a[140:143], v[124:127], v[52:55]
    ds_read_b64_tr_b16 a[166:167], v5 offset:25664
    v_mfma_f32_16x16x32_bf16 v[64:67], a[140:143], v[160:163], v[64:67]
    ds_read_b128 v[96:99], v2 offset:12352
    v_mfma_f32_16x16x32_bf16 v[60:63], a[136:139], v[160:163], v[60:63]
    ds_read_b64_tr_b16 a[168:169], v4 offset:31040
    v_mfma_f32_16x16x32_bf16 v[56:59], a[132:135], v[160:163], v[56:59]
    buffer_load_dwordx4 v7, s[12:15], s46 offen offset:2048 lds
    v_mfma_f32_16x16x32_bf16 v[68:71], a[132:135], v[88:91], v[68:71]
    ds_read_b64_tr_b16 a[170:171], v4 offset:31808
    v_mfma_f32_16x16x32_bf16 v[72:75], a[136:139], v[88:91], v[72:75]
    ds_read_b64_tr_b16 a[172:173], v4 offset:31072
    v_mfma_f32_16x16x32_bf16 v[76:79], a[140:143], v[88:91], v[76:79]
    ds_read_b64_tr_b16 a[174:175], v4 offset:31840
    s_waitcnt vmcnt(11)
    s_barrier
    v_mfma_f32_16x16x32_bf16 v[44:47], a[144:147], v[128:131], v[44:47]
    ds_read_b64_tr_b16 a[176:177], v5 offset:31104
    v_mfma_f32_16x16x32_bf16 v[48:51], a[148:151], v[128:131], v[48:51]
    ds_read_b64_tr_b16 a[178:179], v5 offset:31872
    s_waitcnt lgkmcnt(7)
    v_mfma_f32_16x16x32_bf16 v[52:55], a[152:155], v[128:131], v[52:55]
    ds_read_b128 v[100:103], v2 offset:12416
    v_add_u32 v4, -55872, v4
    v_mfma_f32_16x16x32_bf16 v[64:67], a[152:155], v[164:167], v[64:67]
    s_add_u32 m0, s44, 55872
    s_mov_b32 s46, 147456
    v_mfma_f32_16x16x32_bf16 v[60:63], a[148:151], v[164:167], v[60:63]
    buffer_load_dwordx4 v7, s[12:15], s46 offen offset:0 lds
    v_mfma_f32_16x16x32_bf16 v[56:59], a[144:147], v[164:167], v[56:59]
    v_add_u32 v5, -55872, v5
    v_mfma_f32_16x16x32_bf16 v[68:71], a[144:147], v[92:95], v[68:71]
    ds_read_b64_tr_b16 a[180:181], v4 offset:0
    v_mfma_f32_16x16x32_bf16 v[72:75], a[148:151], v[92:95], v[72:75]
    ds_read_b64_tr_b16 a[182:183], v4 offset:768
    v_mfma_f32_16x16x32_bf16 v[76:79], a[152:155], v[92:95], v[76:79]
    ds_read_b64_tr_b16 a[184:185], v4 offset:32
    v_mfma_f32_16x16x32_bf16 v[44:47], a[156:159], v[132:135], v[44:47]
    ds_read_b64_tr_b16 a[186:187], v4 offset:800
    v_mfma_f32_16x16x32_bf16 v[48:51], a[160:163], v[132:135], v[48:51]
    ds_read_b64_tr_b16 a[188:189], v5 offset:64
    v_mfma_f32_16x16x32_bf16 v[52:55], a[164:167], v[132:135], v[52:55]
    ds_read_b64_tr_b16 a[190:191], v5 offset:832
    v_mfma_f32_16x16x32_bf16 v[64:67], a[164:167], v[168:171], v[64:67]
    ds_read_b128 v[104:107], v3 offset:12288
    v_mfma_f32_16x16x32_bf16 v[60:63], a[160:163], v[168:171], v[60:63]
    buffer_load_dwordx4 v7, s[12:15], s46 offen offset:1024 lds
    v_mfma_f32_16x16x32_bf16 v[56:59], a[156:159], v[168:171], v[56:59]
    ds_read_b64_tr_b16 a[192:193], v4 offset:6208
    s_waitcnt lgkmcnt(7)
    v_mfma_f32_16x16x32_bf16 v[68:71], a[156:159], v[96:99], v[68:71]
    ds_read_b64_tr_b16 a[194:195], v4 offset:6976
    v_mfma_f32_16x16x32_bf16 v[72:75], a[160:163], v[96:99], v[72:75]
    ds_read_b64_tr_b16 a[196:197], v4 offset:6240
    v_mfma_f32_16x16x32_bf16 v[76:79], a[164:167], v[96:99], v[76:79]
    ds_read_b64_tr_b16 a[198:199], v4 offset:7008
    v_mfma_f32_16x16x32_bf16 v[44:47], a[168:171], v[136:139], v[44:47]
    ds_read_b64_tr_b16 a[200:201], v5 offset:6272
    v_mfma_f32_16x16x32_bf16 v[48:51], a[172:175], v[136:139], v[48:51]
    ds_read_b64_tr_b16 a[202:203], v5 offset:7040
    v_mfma_f32_16x16x32_bf16 v[52:55], a[176:179], v[136:139], v[52:55]
    ds_read_b128 v[108:111], v3 offset:12352
    v_mfma_f32_16x16x32_bf16 v[64:67], a[176:179], v[172:175], v[64:67]
    buffer_load_dwordx4 v7, s[12:15], s46 offen offset:2048 lds
    v_mfma_f32_16x16x32_bf16 v[60:63], a[172:175], v[172:175], v[60:63]
    ds_read_b64_tr_b16 a[204:205], v4 offset:12416
    v_mfma_f32_16x16x32_bf16 v[56:59], a[168:171], v[172:175], v[56:59]
    ds_read_b64_tr_b16 a[206:207], v4 offset:13184
    v_mfma_f32_16x16x32_bf16 v[68:71], a[168:171], v[100:103], v[68:71]
    ds_read_b64_tr_b16 a[208:209], v4 offset:12448
    v_mfma_f32_16x16x32_bf16 v[72:75], a[172:175], v[100:103], v[72:75]
    ds_read_b64_tr_b16 a[210:211], v4 offset:13216
    v_mfma_f32_16x16x32_bf16 v[76:79], a[176:179], v[100:103], v[76:79]
    ds_read_b64_tr_b16 a[212:213], v5 offset:12480
    s_waitcnt vmcnt(6)
    s_barrier
    s_waitcnt lgkmcnt(7)
    v_mfma_f32_16x16x32_bf16 v[44:47], a[180:183], v[140:143], v[44:47]
    ds_read_b64_tr_b16 a[214:215], v5 offset:13248
    v_mfma_f32_16x16x32_bf16 v[48:51], a[184:187], v[140:143], v[48:51]
    ds_read_b128 v[112:115], v3 offset:12416
    s_add_u32 m0, s44, 68288
    s_mov_b32 s46, 159744
    v_mfma_f32_16x16x32_bf16 v[52:55], a[188:191], v[140:143], v[52:55]
    buffer_load_dwordx4 v7, s[12:15], s46 offen offset:0 lds
    v_mfma_f32_16x16x32_bf16 v[64:67], a[188:191], v[176:179], v[64:67]
    ds_read_b64_tr_b16 a[216:217], v4 offset:18624
    v_mfma_f32_16x16x32_bf16 v[60:63], a[184:187], v[176:179], v[60:63]
    ds_read_b64_tr_b16 a[218:219], v4 offset:19392
    v_mfma_f32_16x16x32_bf16 v[56:59], a[180:183], v[176:179], v[56:59]
    ds_read_b64_tr_b16 a[220:221], v4 offset:18656
    v_mfma_f32_16x16x32_bf16 v[68:71], a[180:183], v[104:107], v[68:71]
    ds_read_b64_tr_b16 a[222:223], v4 offset:19424
    v_mfma_f32_16x16x32_bf16 v[72:75], a[184:187], v[104:107], v[72:75]
    buffer_load_dwordx4 v7, s[12:15], s46 offen offset:1024 lds
    v_mfma_f32_16x16x32_bf16 v[76:79], a[188:191], v[104:107], v[76:79]
    ds_read_b64_tr_b16 a[224:225], v5 offset:18688
    v_mfma_f32_16x16x32_bf16 v[44:47], a[192:195], v[144:147], v[44:47]
    ds_read_b64_tr_b16 a[226:227], v5 offset:19456
    v_mfma_f32_16x16x32_bf16 v[48:51], a[196:199], v[144:147], v[48:51]
    ds_read_b128 v[116:119], v1 offset:16384
    s_waitcnt lgkmcnt(7)
    v_mfma_f32_16x16x32_bf16 v[52:55], a[200:203], v[144:147], v[52:55]
    ds_read_b64_tr_b16 a[228:229], v4 offset:24832
    v_mfma_f32_16x16x32_bf16 v[64:67], a[200:203], v[180:183], v[64:67]
    ds_read_b64_tr_b16 a[230:231], v4 offset:25600
    v_mfma_f32_16x16x32_bf16 v[60:63], a[196:199], v[180:183], v[60:63]
    buffer_load_dwordx4 v7, s[12:15], s46 offen offset:2048 lds
    v_mfma_f32_16x16x32_bf16 v[56:59], a[192:195], v[180:183], v[56:59]
    ds_read_b64_tr_b16 a[232:233], v4 offset:24864
    v_mfma_f32_16x16x32_bf16 v[68:71], a[192:195], v[108:111], v[68:71]
    ds_read_b64_tr_b16 a[234:235], v4 offset:25632
    v_mfma_f32_16x16x32_bf16 v[72:75], a[196:199], v[108:111], v[72:75]
    ds_read_b64_tr_b16 a[236:237], v5 offset:24896
    v_mfma_f32_16x16x32_bf16 v[76:79], a[200:203], v[108:111], v[76:79]
    s_add_u32 m0, s33, 20480
    v_mfma_f32_16x16x32_bf16 v[44:47], a[204:207], v[148:151], v[44:47]
    buffer_load_dwordx4 v8, s[4:7], s61 offen lds
    v_mfma_f32_16x16x32_bf16 v[48:51], a[208:211], v[148:151], v[48:51]
    ds_read_b64_tr_b16 a[238:239], v5 offset:25664
    v_mfma_f32_16x16x32_bf16 v[52:55], a[212:215], v[148:151], v[52:55]
    ds_read_b128 v[120:123], v1 offset:16448
    v_mfma_f32_16x16x32_bf16 v[64:67], a[212:215], v[184:187], v[64:67]
    ds_read_b64_tr_b16 a[240:241], v4 offset:31040
    v_mfma_f32_16x16x32_bf16 v[60:63], a[208:211], v[184:187], v[60:63]
    s_add_u32 m0, s33, 49152
    v_mfma_f32_16x16x32_bf16 v[56:59], a[204:207], v[184:187], v[56:59]
    buffer_load_dwordx4 v8, s[4:7], s68 offen lds
    v_mfma_f32_16x16x32_bf16 v[68:71], a[204:207], v[112:115], v[68:71]
    ds_read_b64_tr_b16 a[242:243], v4 offset:31808
    v_mfma_f32_16x16x32_bf16 v[72:75], a[208:211], v[112:115], v[72:75]
    ds_read_b64_tr_b16 a[244:245], v4 offset:31072
    v_mfma_f32_16x16x32_bf16 v[76:79], a[212:215], v[112:115], v[76:79]
    ds_read_b64_tr_b16 a[246:247], v4 offset:31840
    s_waitcnt vmcnt(8)
    s_barrier
    s_waitcnt lgkmcnt(7)
    v_mfma_f32_16x16x32_bf16 v[44:47], a[216:219], v[152:155], v[44:47]
    ds_read_b64_tr_b16 a[248:249], v5 offset:31104
    v_mfma_f32_16x16x32_bf16 v[48:51], a[220:223], v[152:155], v[48:51]
    ds_read_b64_tr_b16 a[250:251], v5 offset:31872
    v_mfma_f32_16x16x32_bf16 v[52:55], a[224:227], v[152:155], v[52:55]
    ds_read_b128 v[124:127], v1 offset:16512
    s_add_u32 m0, s33, 24576
    v_mfma_f32_16x16x32_bf16 v[64:67], a[224:227], v[80:83], v[64:67]
    buffer_load_dwordx4 v8, s[4:7], s62 offen lds
    v_mfma_f32_16x16x32_bf16 v[60:63], a[220:223], v[80:83], v[60:63]
    ds_read_b64_tr_b16 a[252:253], v4 offset:37248
    v_mfma_f32_16x16x32_bf16 v[56:59], a[216:219], v[80:83], v[56:59]
    ds_read_b64_tr_b16 a[254:255], v4 offset:38016
    v_mfma_f32_16x16x32_bf16 v[68:71], a[216:219], v[116:119], v[68:71]
    ds_read_b64_tr_b16 v[188:189], v4 offset:37280
    v_mfma_f32_16x16x32_bf16 v[72:75], a[220:223], v[116:119], v[72:75]
    ds_read_b64_tr_b16 v[190:191], v4 offset:38048
    v_mfma_f32_16x16x32_bf16 v[76:79], a[224:227], v[116:119], v[76:79]
    s_add_u32 m0, s33, 53248
    v_mfma_f32_16x16x32_bf16 v[44:47], a[228:231], v[156:159], v[44:47]
    buffer_load_dwordx4 v8, s[4:7], s69 offen lds
    v_mfma_f32_16x16x32_bf16 v[48:51], a[232:235], v[156:159], v[48:51]
    ds_read_b64_tr_b16 v[192:193], v5 offset:37312
    s_waitcnt lgkmcnt(7)
    v_mfma_f32_16x16x32_bf16 v[52:55], a[236:239], v[156:159], v[52:55]
    ds_read_b64_tr_b16 v[194:195], v5 offset:38080
    v_mfma_f32_16x16x32_bf16 v[64:67], a[236:239], v[84:87], v[64:67]
    ds_read_b128 v[128:131], v2 offset:16384
    v_mfma_f32_16x16x32_bf16 v[60:63], a[232:235], v[84:87], v[60:63]
    ds_read_b64_tr_b16 v[196:197], v4 offset:43456
    v_mfma_f32_16x16x32_bf16 v[56:59], a[228:231], v[84:87], v[56:59]
    ds_read_b64_tr_b16 v[198:199], v4 offset:44224
    v_mfma_f32_16x16x32_bf16 v[68:71], a[228:231], v[120:123], v[68:71]
    s_add_u32 m0, s33, 57344
    ds_read_b64_tr_b16 v[200:201], v4 offset:43488
    v_mfma_f32_16x16x32_bf16 v[72:75], a[232:235], v[120:123], v[72:75]
    buffer_load_dwordx4 v8, s[4:7], s70 offen lds
    v_mfma_f32_16x16x32_bf16 v[76:79], a[236:239], v[120:123], v[76:79]
    ds_read_b64_tr_b16 v[202:203], v4 offset:44256
    v_mfma_f32_16x16x32_bf16 v[44:47], a[240:243], v[160:163], v[44:47]
    ds_read_b64_tr_b16 v[204:205], v5 offset:43520
    v_mfma_f32_16x16x32_bf16 v[48:51], a[244:247], v[160:163], v[48:51]
    ds_read_b64_tr_b16 v[206:207], v5 offset:44288
    s_waitcnt lgkmcnt(7)
    v_mfma_f32_16x16x32_bf16 v[52:55], a[248:251], v[160:163], v[52:55]
    ds_read_b128 v[132:135], v2 offset:16448
    v_mfma_f32_16x16x32_bf16 v[64:67], a[248:251], v[88:91], v[64:67]
    s_add_u32 m0, s33, 61440
    v_mfma_f32_16x16x32_bf16 v[60:63], a[244:247], v[88:91], v[60:63]
    buffer_load_dwordx4 v8, s[4:7], s71 offen lds
    v_mfma_f32_16x16x32_bf16 v[56:59], a[240:243], v[88:91], v[56:59]
    ds_read_b64_tr_b16 v[208:209], v4 offset:49664
    v_mfma_f32_16x16x32_bf16 v[68:71], a[240:243], v[124:127], v[68:71]
    ds_read_b64_tr_b16 v[210:211], v4 offset:50432
    v_mfma_f32_16x16x32_bf16 v[72:75], a[244:247], v[124:127], v[72:75]
    ds_read_b64_tr_b16 v[212:213], v4 offset:49696
    v_mfma_f32_16x16x32_bf16 v[76:79], a[248:251], v[124:127], v[76:79]
    ds_read_b64_tr_b16 v[214:215], v4 offset:50464
    s_waitcnt vmcnt(6)
    s_barrier
    v_mfma_f32_16x16x32_bf16 v[44:47], a[252:255], v[164:167], v[44:47]
    ds_read_b64_tr_b16 v[216:217], v5 offset:49728
    v_mfma_f32_16x16x32_bf16 v[48:51], v[188:191], v[164:167], v[48:51]
    ds_read_b64_tr_b16 v[218:219], v5 offset:50496
    v_mfma_f32_16x16x32_bf16 v[52:55], v[192:195], v[164:167], v[52:55]
    ds_read_b128 v[136:139], v2 offset:16512
    v_mfma_f32_16x16x32_bf16 v[64:67], v[192:195], v[92:95], v[64:67]
    v_add_u32 v4, 55872, v4
    v_add_u32 v5, 55872, v5
    v_mfma_f32_16x16x32_bf16 v[60:63], v[188:191], v[92:95], v[60:63]
    ds_read_b64_tr_b16 v[220:221], v4 offset:0
    v_mfma_f32_16x16x32_bf16 v[56:59], a[252:255], v[92:95], v[56:59]
    ds_read_b64_tr_b16 v[222:223], v4 offset:768
    buffer_load_dwordx4 v[16:19], v14, s[8:11], s32 offen offset:0
    s_waitcnt lgkmcnt(7)
    v_mfma_f32_16x16x32_bf16 v[68:71], a[252:255], v[128:131], v[68:71]
    ds_read_b64_tr_b16 v[224:225], v4 offset:32
    v_mfma_f32_16x16x32_bf16 v[72:75], v[188:191], v[128:131], v[72:75]
    ds_read_b64_tr_b16 v[226:227], v4 offset:800
    v_mfma_f32_16x16x32_bf16 v[76:79], v[192:195], v[128:131], v[76:79]
    ds_read_b64_tr_b16 v[228:229], v5 offset:64
    buffer_load_dwordx4 v[20:23], v14, s[8:11], s32 offen offset:144
    v_mfma_f32_16x16x32_bf16 v[44:47], v[196:199], v[168:171], v[44:47]
    ds_read_b64_tr_b16 v[230:231], v5 offset:832
    v_mfma_f32_16x16x32_bf16 v[48:51], v[200:203], v[168:171], v[48:51]
    ds_read_b128 v[140:143], v3 offset:16384
    v_mfma_f32_16x16x32_bf16 v[52:55], v[204:207], v[168:171], v[52:55]
    ds_read_b64_tr_b16 v[232:233], v4 offset:6208
    buffer_load_dwordx4 v[24:27], v14, s[8:11], s32 offen offset:288
    v_mfma_f32_16x16x32_bf16 v[64:67], v[204:207], v[96:99], v[64:67]
    ds_read_b64_tr_b16 v[234:235], v4 offset:6976
    v_mfma_f32_16x16x32_bf16 v[60:63], v[200:203], v[96:99], v[60:63]
    ds_read_b64_tr_b16 v[236:237], v4 offset:6240
    v_mfma_f32_16x16x32_bf16 v[56:59], v[196:199], v[96:99], v[56:59]
    ds_read_b64_tr_b16 v[238:239], v4 offset:7008
    buffer_load_dwordx4 v[28:31], v14, s[8:11], s32 offen offset:432
    v_mfma_f32_16x16x32_bf16 v[68:71], v[196:199], v[132:135], v[68:71]
    ds_read_b64_tr_b16 v[240:241], v5 offset:6272
    v_mfma_f32_16x16x32_bf16 v[72:75], v[200:203], v[132:135], v[72:75]
    ds_read_b64_tr_b16 v[242:243], v5 offset:7040
    v_mfma_f32_16x16x32_bf16 v[76:79], v[204:207], v[132:135], v[76:79]
    ds_read_b128 v[144:147], v3 offset:16448
    v_mfma_f32_16x16x32_bf16 v[44:47], v[208:211], v[172:175], v[44:47]
    ds_read_b64_tr_b16 v[244:245], v4 offset:12416
    s_waitcnt lgkmcnt(7)
    v_mfma_f32_16x16x32_bf16 v[48:51], v[212:215], v[172:175], v[48:51]
    ds_read_b64_tr_b16 v[246:247], v4 offset:13184
    v_mfma_f32_16x16x32_bf16 v[52:55], v[216:219], v[172:175], v[52:55]
    ds_read_b64_tr_b16 v[248:249], v4 offset:12448
    v_mfma_f32_16x16x32_bf16 v[64:67], v[216:219], v[100:103], v[64:67]
    ds_read_b64_tr_b16 v[250:251], v4 offset:13216
    v_mfma_f32_16x16x32_bf16 v[60:63], v[212:215], v[100:103], v[60:63]
    ds_read_b64_tr_b16 v[252:253], v5 offset:12480
    v_mfma_f32_16x16x32_bf16 v[56:59], v[208:211], v[100:103], v[56:59]
    ds_read_b64_tr_b16 v[254:255], v5 offset:13248
    ds_read_b128 v[148:151], v3 offset:16512
    v_mfma_f32_16x16x32_bf16 v[68:71], v[208:211], v[136:139], v[68:71]
    v_mfma_f32_16x16x32_bf16 v[72:75], v[212:215], v[136:139], v[72:75]
    v_mfma_f32_16x16x32_bf16 v[76:79], v[216:219], v[136:139], v[76:79]
    v_mfma_f32_16x16x32_bf16 v[44:47], v[220:223], v[176:179], v[44:47]
    v_mfma_f32_16x16x32_bf16 v[48:51], v[224:227], v[176:179], v[48:51]
    v_mfma_f32_16x16x32_bf16 v[52:55], v[228:231], v[176:179], v[52:55]
    s_waitcnt lgkmcnt(7)
    v_mfma_f32_16x16x32_bf16 v[52:55], v[240:243], v[180:183], v[52:55]
    v_mfma_f32_16x16x32_bf16 v[48:51], v[236:239], v[180:183], v[48:51]
    v_mfma_f32_16x16x32_bf16 v[44:47], v[232:235], v[180:183], v[44:47]
    s_waitcnt lgkmcnt(5)
    v_mfma_f32_16x16x32_bf16 v[44:47], v[244:247], v[184:187], v[44:47]
    s_waitcnt lgkmcnt(3)
    v_mfma_f32_16x16x32_bf16 v[48:51], v[248:251], v[184:187], v[48:51]
    s_waitcnt lgkmcnt(1)
    v_mfma_f32_16x16x32_bf16 v[52:55], v[252:255], v[184:187], v[52:55]
    v_mfma_f32_16x16x32_bf16 v[56:59], v[220:223], v[104:107], v[56:59]
    v_mfma_f32_16x16x32_bf16 v[60:63], v[224:227], v[104:107], v[60:63]
    v_mfma_f32_16x16x32_bf16 v[64:67], v[228:231], v[104:107], v[64:67]
    v_mfma_f32_16x16x32_bf16 v[64:67], v[240:243], v[108:111], v[64:67]
    v_cvt_pk_bf16_f32 v32, v44, v45
    v_cvt_pk_bf16_f32 v33, v46, v47
    v_mfma_f32_16x16x32_bf16 v[60:63], v[236:239], v[108:111], v[60:63]
    v_cvt_pk_bf16_f32 v34, v48, v49
    v_cvt_pk_bf16_f32 v35, v50, v51
    v_mfma_f32_16x16x32_bf16 v[56:59], v[232:235], v[108:111], v[56:59]
    v_cvt_pk_bf16_f32 v36, v52, v53
    v_cvt_pk_bf16_f32 v37, v54, v55
    v_mfma_f32_16x16x32_bf16 v[56:59], v[244:247], v[112:115], v[56:59]
    v_permlane16_swap_b32 v32, v34
    v_permlane16_swap_b32 v33, v35
    v_mfma_f32_16x16x32_bf16 v[60:63], v[248:251], v[112:115], v[60:63]
    v_mfma_f32_16x16x32_bf16 v[64:67], v[252:255], v[112:115], v[64:67]
    v_mfma_f32_16x16x32_bf16 v[68:71], v[220:223], v[140:143], v[68:71]
    buffer_store_dwordx4 v[32:35], v9, s[16:19], s31 offen sc1
    v_mfma_f32_16x16x32_bf16 v[72:75], v[224:227], v[140:143], v[72:75]
    v_mfma_f32_16x16x32_bf16 v[76:79], v[228:231], v[140:143], v[76:79]
    v_mfma_f32_16x16x32_bf16 v[76:79], v[240:243], v[144:147], v[76:79]
    v_mfma_f32_16x16x32_bf16 v[72:75], v[236:239], v[144:147], v[72:75]
    v_mfma_f32_16x16x32_bf16 v[68:71], v[232:235], v[144:147], v[68:71]
    s_waitcnt lgkmcnt(0)
    v_mfma_f32_16x16x32_bf16 v[68:71], v[244:247], v[148:151], v[68:71]
    v_mfma_f32_16x16x32_bf16 v[72:75], v[248:251], v[148:151], v[72:75]
    v_mfma_f32_16x16x32_bf16 v[76:79], v[252:255], v[148:151], v[76:79]
    v_mfma_f32_16x16x32_bf16 v[44:47], a[0:3], v[80:83], 0
    v_cvt_pk_bf16_f32 v38, v56, v57
    v_cvt_pk_bf16_f32 v39, v58, v59
    v_mfma_f32_16x16x32_bf16 v[48:51], a[4:7], v[80:83], 0
    v_cvt_pk_bf16_f32 v40, v60, v61
    v_cvt_pk_bf16_f32 v41, v62, v63
    v_mfma_f32_16x16x32_bf16 v[52:55], a[8:11], v[80:83], 0
    v_cvt_pk_bf16_f32 v42, v64, v65
    v_cvt_pk_bf16_f32 v43, v66, v67
    v_mfma_f32_16x16x32_bf16 v[52:55], a[20:23], v[84:87], v[52:55]
    v_permlane16_swap_b32 v38, v40
    v_permlane16_swap_b32 v39, v41
    v_mfma_f32_16x16x32_bf16 v[48:51], a[16:19], v[84:87], v[48:51]
    v_mfma_f32_16x16x32_bf16 v[44:47], a[12:15], v[84:87], v[44:47]
    v_mfma_f32_16x16x32_bf16 v[44:47], a[24:27], v[88:91], v[44:47]
    v_mfma_f32_16x16x32_bf16 v[48:51], a[28:31], v[88:91], v[48:51]
    buffer_store_dwordx2 v[36:37], v10, s[16:19], s31 offen sc1
    v_mfma_f32_16x16x32_bf16 v[52:55], a[32:35], v[88:91], v[52:55]
    s_add_u32 s31, s31, 43008
    v_mfma_f32_16x16x32_bf16 v[44:47], a[36:39], v[92:95], v[44:47]
    v_mfma_f32_16x16x32_bf16 v[48:51], a[40:43], v[92:95], v[48:51]
    v_cvt_pk_bf16_f32 v32, v68, v69
    v_cvt_pk_bf16_f32 v33, v70, v71
    v_mfma_f32_16x16x32_bf16 v[52:55], a[44:47], v[92:95], v[52:55]
    v_cvt_pk_bf16_f32 v34, v72, v73
    v_cvt_pk_bf16_f32 v35, v74, v75
    v_mfma_f32_16x16x32_bf16 v[52:55], a[56:59], v[96:99], v[52:55]
    v_cvt_pk_bf16_f32 v36, v76, v77
    v_cvt_pk_bf16_f32 v37, v78, v79
    v_mfma_f32_16x16x32_bf16 v[48:51], a[52:55], v[96:99], v[48:51]
    v_permlane16_swap_b32 v32, v34
    v_permlane16_swap_b32 v33, v35
    v_mfma_f32_16x16x32_bf16 v[44:47], a[48:51], v[96:99], v[44:47]
    v_mfma_f32_16x16x32_bf16 v[44:47], a[60:63], v[100:103], v[44:47]
    v_mfma_f32_16x16x32_bf16 v[48:51], a[64:67], v[100:103], v[48:51]
    v_mfma_f32_16x16x32_bf16 v[52:55], a[68:71], v[100:103], v[52:55]
    v_mfma_f32_16x16x32_bf16 v[44:47], a[72:75], v[104:107], v[44:47]
    v_mfma_f32_16x16x32_bf16 v[48:51], a[76:79], v[104:107], v[48:51]
    v_mfma_f32_16x16x32_bf16 v[52:55], a[80:83], v[104:107], v[52:55]
    v_mfma_f32_16x16x32_bf16 v[52:55], a[92:95], v[108:111], v[52:55]
    v_mfma_f32_16x16x32_bf16 v[48:51], a[88:91], v[108:111], v[48:51]
    v_mfma_f32_16x16x32_bf16 v[44:47], a[84:87], v[108:111], v[44:47]
    buffer_store_dwordx4 v[38:41], v9, s[16:19], s31 offen sc1
    v_mfma_f32_16x16x32_bf16 v[44:47], a[96:99], v[112:115], v[44:47]
    v_mfma_f32_16x16x32_bf16 v[48:51], a[100:103], v[112:115], v[48:51]
    v_mfma_f32_16x16x32_bf16 v[52:55], a[104:107], v[112:115], v[52:55]
    v_mfma_f32_16x16x32_bf16 v[44:47], a[108:111], v[116:119], v[44:47]
    v_mfma_f32_16x16x32_bf16 v[48:51], a[112:115], v[116:119], v[48:51]
    v_mfma_f32_16x16x32_bf16 v[52:55], a[116:119], v[116:119], v[52:55]
    v_mfma_f32_16x16x32_bf16 v[52:55], a[128:131], v[120:123], v[52:55]
    v_mfma_f32_16x16x32_bf16 v[48:51], a[124:127], v[120:123], v[48:51]
    v_mfma_f32_16x16x32_bf16 v[44:47], a[120:123], v[120:123], v[44:47]
    v_mfma_f32_16x16x32_bf16 v[44:47], a[132:135], v[124:127], v[44:47]
    v_mfma_f32_16x16x32_bf16 v[48:51], a[136:139], v[124:127], v[48:51]
    v_mfma_f32_16x16x32_bf16 v[52:55], a[140:143], v[124:127], v[52:55]
    v_mfma_f32_16x16x32_bf16 v[44:47], a[144:147], v[128:131], v[44:47]
    s_waitcnt vmcnt(11)
    s_barrier
    v_mfma_f32_16x16x32_bf16 v[48:51], a[148:151], v[128:131], v[48:51]
    ds_read_b128 v[152:155], v1 offset:20480
    v_mfma_f32_16x16x32_bf16 v[52:55], a[152:155], v[128:131], v[52:55]
    ds_read_b128 v[156:159], v1 offset:20544
    v_mfma_f32_16x16x32_bf16 v[52:55], a[164:167], v[132:135], v[52:55]
    buffer_store_dwordx2 v[42:43], v10, s[16:19], s31 offen sc1
    v_mfma_f32_16x16x32_bf16 v[48:51], a[160:163], v[132:135], v[48:51]
    s_add_u32 s31, s31, 43008
    v_mfma_f32_16x16x32_bf16 v[44:47], a[156:159], v[132:135], v[44:47]
    ds_read_b128 v[160:163], v1 offset:20608
    v_mfma_f32_16x16x32_bf16 v[44:47], a[168:171], v[136:139], v[44:47]
    ds_read_b128 v[164:167], v2 offset:20480
    v_mfma_f32_16x16x32_bf16 v[48:51], a[172:175], v[136:139], v[48:51]
    ds_read_b128 v[168:171], v2 offset:20544
    v_mfma_f32_16x16x32_bf16 v[52:55], a[176:179], v[136:139], v[52:55]
    ds_read_b128 v[172:175], v2 offset:20608
    v_mfma_f32_16x16x32_bf16 v[44:47], a[180:183], v[140:143], v[44:47]
    ds_read_b128 v[176:179], v3 offset:20480
    v_mfma_f32_16x16x32_bf16 v[48:51], a[184:187], v[140:143], v[48:51]
    ds_read_b128 v[180:183], v3 offset:20544
    v_mfma_f32_16x16x32_bf16 v[52:55], a[188:191], v[140:143], v[52:55]
    ds_read_b128 v[184:187], v3 offset:20608
    v_mfma_f32_16x16x32_bf16 v[52:55], a[200:203], v[144:147], v[52:55]
    v_mfma_f32_16x16x32_bf16 v[48:51], a[196:199], v[144:147], v[48:51]
    v_mfma_f32_16x16x32_bf16 v[44:47], a[192:195], v[144:147], v[44:47]
    v_mfma_f32_16x16x32_bf16 v[44:47], a[204:207], v[148:151], v[44:47]
    v_mfma_f32_16x16x32_bf16 v[48:51], a[208:211], v[148:151], v[48:51]
    v_mfma_f32_16x16x32_bf16 v[52:55], a[212:215], v[148:151], v[52:55]
    s_waitcnt lgkmcnt(7)
    v_mfma_f32_16x16x32_bf16 v[44:47], a[216:219], v[152:155], v[44:47]
    v_mfma_f32_16x16x32_bf16 v[48:51], a[220:223], v[152:155], v[48:51]
    buffer_store_dwordx4 v[32:35], v9, s[16:19], s31 offen sc1
    v_mfma_f32_16x16x32_bf16 v[52:55], a[224:227], v[152:155], v[52:55]
    v_mfma_f32_16x16x32_bf16 v[52:55], a[236:239], v[156:159], v[52:55]
    v_mfma_f32_16x16x32_bf16 v[48:51], a[232:235], v[156:159], v[48:51]
    v_mfma_f32_16x16x32_bf16 v[44:47], a[228:231], v[156:159], v[44:47]
    s_waitcnt lgkmcnt(6)
    v_mfma_f32_16x16x32_bf16 v[44:47], a[240:243], v[160:163], v[44:47]
    v_mfma_f32_16x16x32_bf16 v[48:51], a[244:247], v[160:163], v[48:51]
    v_mfma_f32_16x16x32_bf16 v[52:55], a[248:251], v[160:163], v[52:55]
    s_waitcnt lgkmcnt(5)
    v_mfma_f32_16x16x32_bf16 v[44:47], a[252:255], v[164:167], v[44:47]
    v_mfma_f32_16x16x32_bf16 v[48:51], v[188:191], v[164:167], v[48:51]
    v_mfma_f32_16x16x32_bf16 v[52:55], v[192:195], v[164:167], v[52:55]
    s_waitcnt lgkmcnt(4)
    v_mfma_f32_16x16x32_bf16 v[52:55], v[204:207], v[168:171], v[52:55]
    v_mfma_f32_16x16x32_bf16 v[48:51], v[200:203], v[168:171], v[48:51]
    v_mfma_f32_16x16x32_bf16 v[44:47], v[196:199], v[168:171], v[44:47]
    s_waitcnt lgkmcnt(3)
    v_mfma_f32_16x16x32_bf16 v[44:47], v[208:211], v[172:175], v[44:47]
    v_mfma_f32_16x16x32_bf16 v[48:51], v[212:215], v[172:175], v[48:51]
    v_mfma_f32_16x16x32_bf16 v[52:55], v[216:219], v[172:175], v[52:55]
    buffer_store_dwordx2 v[36:37], v10, s[16:19], s31 offen sc1
    s_waitcnt lgkmcnt(2)
    v_mfma_f32_16x16x32_bf16 v[44:47], v[220:223], v[176:179], v[44:47]
    s_add_u32 s31, s31, 43008
    v_mfma_f32_16x16x32_bf16 v[48:51], v[224:227], v[176:179], v[48:51]
    v_mfma_f32_16x16x32_bf16 v[52:55], v[228:231], v[176:179], v[52:55]
    s_waitcnt lgkmcnt(1)
    v_mfma_f32_16x16x32_bf16 v[52:55], v[240:243], v[180:183], v[52:55]
    v_mfma_f32_16x16x32_bf16 v[48:51], v[236:239], v[180:183], v[48:51]
    v_mfma_f32_16x16x32_bf16 v[44:47], v[232:235], v[180:183], v[44:47]
    s_waitcnt lgkmcnt(0)
    v_mfma_f32_16x16x32_bf16 v[44:47], v[244:247], v[184:187], v[44:47]
    v_mfma_f32_16x16x32_bf16 v[48:51], v[248:251], v[184:187], v[48:51]
    v_mfma_f32_16x16x32_bf16 v[52:55], v[252:255], v[184:187], v[52:55]
    v_mfma_f32_16x16x32_bf16 v[56:59], a[0:3], v[116:119], 0
    v_mfma_f32_16x16x32_bf16 v[60:63], a[4:7], v[116:119], 0
    v_mfma_f32_16x16x32_bf16 v[64:67], a[8:11], v[116:119], 0
    v_mfma_f32_16x16x32_bf16 v[64:67], a[20:23], v[120:123], v[64:67]
    v_mfma_f32_16x16x32_bf16 v[60:63], a[16:19], v[120:123], v[60:63]
    v_mfma_f32_16x16x32_bf16 v[56:59], a[12:15], v[120:123], v[56:59]
    v_cvt_pk_bf16_f32 v38, v44, v45
    v_cvt_pk_bf16_f32 v39, v46, v47
    v_mfma_f32_16x16x32_bf16 v[56:59], a[24:27], v[124:127], v[56:59]
    v_cvt_pk_bf16_f32 v40, v48, v49
    v_cvt_pk_bf16_f32 v41, v50, v51
    v_mfma_f32_16x16x32_bf16 v[60:63], a[28:31], v[124:127], v[60:63]
    v_cvt_pk_bf16_f32 v42, v52, v53
    v_cvt_pk_bf16_f32 v43, v54, v55
    v_mfma_f32_16x16x32_bf16 v[64:67], a[32:35], v[124:127], v[64:67]
    v_permlane16_swap_b32 v38, v40
    v_permlane16_swap_b32 v39, v41
    v_mfma_f32_16x16x32_bf16 v[56:59], a[36:39], v[128:131], v[56:59]
    v_mfma_f32_16x16x32_bf16 v[60:63], a[40:43], v[128:131], v[60:63]
    buffer_store_dwordx4 v[38:41], v9, s[16:19], s31 offen sc1
    v_mfma_f32_16x16x32_bf16 v[64:67], a[44:47], v[128:131], v[64:67]
    v_mfma_f32_16x16x32_bf16 v[64:67], a[56:59], v[132:135], v[64:67]
    v_mfma_f32_16x16x32_bf16 v[60:63], a[52:55], v[132:135], v[60:63]
    v_mfma_f32_16x16x32_bf16 v[56:59], a[48:51], v[132:135], v[56:59]
    v_mfma_f32_16x16x32_bf16 v[56:59], a[60:63], v[136:139], v[56:59]
    v_mfma_f32_16x16x32_bf16 v[60:63], a[64:67], v[136:139], v[60:63]
    v_mfma_f32_16x16x32_bf16 v[64:67], a[68:71], v[136:139], v[64:67]
    v_mfma_f32_16x16x32_bf16 v[56:59], a[72:75], v[140:143], v[56:59]
    v_mfma_f32_16x16x32_bf16 v[60:63], a[76:79], v[140:143], v[60:63]
    v_mfma_f32_16x16x32_bf16 v[64:67], a[80:83], v[140:143], v[64:67]
    s_waitcnt vmcnt(11)
    s_barrier
    v_mfma_f32_16x16x32_bf16 v[64:67], a[92:95], v[144:147], v[64:67]
    ds_read_b128 v[80:83], v1 offset:24576
    v_mfma_f32_16x16x32_bf16 v[60:63], a[88:91], v[144:147], v[60:63]
    ds_read_b128 v[84:87], v1 offset:24640
    v_mfma_f32_16x16x32_bf16 v[56:59], a[84:87], v[144:147], v[56:59]
    ds_read_b128 v[88:91], v1 offset:24704
    v_mfma_f32_16x16x32_bf16 v[56:59], a[96:99], v[148:151], v[56:59]
    ds_read_b128 v[92:95], v2 offset:24576
    v_mfma_f32_16x16x32_bf16 v[60:63], a[100:103], v[148:151], v[60:63]
    ds_read_b128 v[96:99], v2 offset:24640
    v_mfma_f32_16x16x32_bf16 v[64:67], a[104:107], v[148:151], v[64:67]
    ds_read_b128 v[100:103], v2 offset:24704
    v_mfma_f32_16x16x32_bf16 v[56:59], a[108:111], v[152:155], v[56:59]
    ds_read_b128 v[104:107], v3 offset:24576
    v_mfma_f32_16x16x32_bf16 v[60:63], a[112:115], v[152:155], v[60:63]
    ds_read_b128 v[108:111], v3 offset:24640
    v_mfma_f32_16x16x32_bf16 v[64:67], a[116:119], v[152:155], v[64:67]
    ds_read_b128 v[112:115], v3 offset:24704
    v_mfma_f32_16x16x32_bf16 v[64:67], a[128:131], v[156:159], v[64:67]
    v_mfma_f32_16x16x32_bf16 v[60:63], a[124:127], v[156:159], v[60:63]
    v_mfma_f32_16x16x32_bf16 v[56:59], a[120:123], v[156:159], v[56:59]
    v_mfma_f32_16x16x32_bf16 v[56:59], a[132:135], v[160:163], v[56:59]
    v_mfma_f32_16x16x32_bf16 v[60:63], a[136:139], v[160:163], v[60:63]
    v_mfma_f32_16x16x32_bf16 v[64:67], a[140:143], v[160:163], v[64:67]
    v_mfma_f32_16x16x32_bf16 v[56:59], a[144:147], v[164:167], v[56:59]
    v_mfma_f32_16x16x32_bf16 v[60:63], a[148:151], v[164:167], v[60:63]
    v_mfma_f32_16x16x32_bf16 v[64:67], a[152:155], v[164:167], v[64:67]
    v_mfma_f32_16x16x32_bf16 v[64:67], a[164:167], v[168:171], v[64:67]
    v_mfma_f32_16x16x32_bf16 v[60:63], a[160:163], v[168:171], v[60:63]
    buffer_store_dwordx2 v[42:43], v10, s[16:19], s31 offen sc1
    v_mfma_f32_16x16x32_bf16 v[56:59], a[156:159], v[168:171], v[56:59]
    s_add_u32 s31, s31, 43008
    s_mov_b32 s47, 0x7fff7fff
    v_mfma_f32_16x16x32_bf16 v[56:59], a[168:171], v[172:175], v[56:59]
    s_waitcnt vmcnt(11)
    v_and_b32 v15, s47, v16
    v_and_b32 v0, s47, v17
    v_mfma_f32_16x16x32_bf16 v[60:63], a[172:175], v[172:175], v[60:63]
    v_pk_max_u16 v12, v15, s35
    v_pk_max_u16 v13, v0, s35
    v_mfma_f32_16x16x32_bf16 v[64:67], a[176:179], v[172:175], v[64:67]
    v_and_b32 v15, s47, v18
    v_and_b32 v0, s47, v19
    v_mfma_f32_16x16x32_bf16 v[56:59], a[180:183], v[176:179], v[56:59]
    v_pk_max_u16 v12, v15, v12
    v_pk_max_u16 v13, v0, v13
    v_mfma_f32_16x16x32_bf16 v[60:63], a[184:187], v[176:179], v[60:63]
    s_waitcnt vmcnt(10)
    v_and_b32 v15, s47, v20
    v_and_b32 v0, s47, v21
    v_mfma_f32_16x16x32_bf16 v[64:67], a[188:191], v[176:179], v[64:67]
    v_pk_max_u16 v12, v15, v12
    v_pk_max_u16 v13, v0, v13
    v_mfma_f32_16x16x32_bf16 v[64:67], a[200:203], v[180:183], v[64:67]
    v_and_b32 v15, s47, v22
    v_and_b32 v0, s47, v23
    v_mfma_f32_16x16x32_bf16 v[60:63], a[196:199], v[180:183], v[60:63]
    v_pk_max_u16 v12, v15, v12
    v_pk_max_u16 v13, v0, v13
    v_mfma_f32_16x16x32_bf16 v[56:59], a[192:195], v[180:183], v[56:59]
    s_waitcnt vmcnt(9)
    v_and_b32 v15, s47, v24
    v_and_b32 v0, s47, v25
    v_mfma_f32_16x16x32_bf16 v[56:59], a[204:207], v[184:187], v[56:59]
    v_pk_max_u16 v12, v15, v12
    v_pk_max_u16 v13, v0, v13
    v_mfma_f32_16x16x32_bf16 v[60:63], a[208:211], v[184:187], v[60:63]
    v_and_b32 v15, s47, v26
    v_and_b32 v0, s47, v27
    v_mfma_f32_16x16x32_bf16 v[64:67], a[212:215], v[184:187], v[64:67]
    v_pk_max_u16 v12, v15, v12
    v_pk_max_u16 v13, v0, v13
    s_waitcnt lgkmcnt(7)
    v_mfma_f32_16x16x32_bf16 v[56:59], a[216:219], v[80:83], v[56:59]
    s_waitcnt vmcnt(8)
    v_and_b32 v15, s47, v28
    v_and_b32 v0, s47, v29
    v_mfma_f32_16x16x32_bf16 v[60:63], a[220:223], v[80:83], v[60:63]
    v_pk_max_u16 v12, v15, v12
    v_pk_max_u16 v13, v0, v13
    v_mfma_f32_16x16x32_bf16 v[64:67], a[224:227], v[80:83], v[64:67]
    v_and_b32 v15, s47, v30
    v_and_b32 v0, s47, v31
    v_mfma_f32_16x16x32_bf16 v[64:67], a[236:239], v[84:87], v[64:67]
    v_pk_max_u16 v12, v15, v12
    v_pk_max_u16 v13, v0, v13
    v_mfma_f32_16x16x32_bf16 v[60:63], a[232:235], v[84:87], v[60:63]
    v_pk_max_u16 v12, v12, v13
    v_cmp_ne_u32 vcc, s35, v12
    v_mfma_f32_16x16x32_bf16 v[56:59], a[228:231], v[84:87], v[56:59]
    s_waitcnt lgkmcnt(6)
    v_mfma_f32_16x16x32_bf16 v[56:59], a[240:243], v[88:91], v[56:59]
    v_mfma_f32_16x16x32_bf16 v[60:63], a[244:247], v[88:91], v[60:63]
    v_mfma_f32_16x16x32_bf16 v[64:67], a[248:251], v[88:91], v[64:67]
    s_waitcnt lgkmcnt(5)
    v_mfma_f32_16x16x32_bf16 v[56:59], a[252:255], v[92:95], v[56:59]
    v_mfma_f32_16x16x32_bf16 v[60:63], v[188:191], v[92:95], v[60:63]
    v_mfma_f32_16x16x32_bf16 v[64:67], v[192:195], v[92:95], v[64:67]
    s_waitcnt lgkmcnt(4)
    v_mfma_f32_16x16x32_bf16 v[64:67], v[204:207], v[96:99], v[64:67]
    v_mfma_f32_16x16x32_bf16 v[60:63], v[200:203], v[96:99], v[60:63]
    v_mfma_f32_16x16x32_bf16 v[56:59], v[196:199], v[96:99], v[56:59]
    s_waitcnt lgkmcnt(3)
    v_mfma_f32_16x16x32_bf16 v[56:59], v[208:211], v[100:103], v[56:59]
    v_mfma_f32_16x16x32_bf16 v[60:63], v[212:215], v[100:103], v[60:63]
    v_mfma_f32_16x16x32_bf16 v[64:67], v[216:219], v[100:103], v[64:67]
    s_waitcnt lgkmcnt(2)
    v_mfma_f32_16x16x32_bf16 v[56:59], v[220:223], v[104:107], v[56:59]
    v_mfma_f32_16x16x32_bf16 v[60:63], v[224:227], v[104:107], v[60:63]
    v_mfma_f32_16x16x32_bf16 v[64:67], v[228:231], v[104:107], v[64:67]
    s_waitcnt lgkmcnt(1)
    v_mfma_f32_16x16x32_bf16 v[64:67], v[240:243], v[108:111], v[64:67]
    v_mfma_f32_16x16x32_bf16 v[60:63], v[236:239], v[108:111], v[60:63]
    v_mfma_f32_16x16x32_bf16 v[56:59], v[232:235], v[108:111], v[56:59]
    s_waitcnt lgkmcnt(0)
    v_mfma_f32_16x16x32_bf16 v[56:59], v[244:247], v[112:115], v[56:59]
    v_mfma_f32_16x16x32_bf16 v[60:63], v[248:251], v[112:115], v[60:63]
    v_mfma_f32_16x16x32_bf16 v[64:67], v[252:255], v[112:115], v[64:67]
    v_mfma_f32_16x16x32_bf16 v[68:71], a[0:3], v[152:155], 0
    v_mfma_f32_16x16x32_bf16 v[72:75], a[4:7], v[152:155], 0
    v_mfma_f32_16x16x32_bf16 v[76:79], a[8:11], v[152:155], 0
    v_mfma_f32_16x16x32_bf16 v[76:79], a[20:23], v[156:159], v[76:79]
    v_mfma_f32_16x16x32_bf16 v[72:75], a[16:19], v[156:159], v[72:75]
    v_mfma_f32_16x16x32_bf16 v[68:71], a[12:15], v[156:159], v[68:71]
    v_cvt_pk_bf16_f32 v32, v56, v57
    v_cvt_pk_bf16_f32 v33, v58, v59
    v_mfma_f32_16x16x32_bf16 v[68:71], a[24:27], v[160:163], v[68:71]
    v_cvt_pk_bf16_f32 v34, v60, v61
    v_cvt_pk_bf16_f32 v35, v62, v63
    v_mfma_f32_16x16x32_bf16 v[72:75], a[28:31], v[160:163], v[72:75]
    v_cvt_pk_bf16_f32 v36, v64, v65
    v_cvt_pk_bf16_f32 v37, v66, v67
    v_mfma_f32_16x16x32_bf16 v[76:79], a[32:35], v[160:163], v[76:79]
    v_permlane16_swap_b32 v32, v34
    v_permlane16_swap_b32 v33, v35
    v_mfma_f32_16x16x32_bf16 v[68:71], a[36:39], v[164:167], v[68:71]
    v_mfma_f32_16x16x32_bf16 v[72:75], a[40:43], v[164:167], v[72:75]
    buffer_store_dwordx4 v[32:35], v9, s[16:19], s31 offen sc1
    v_mfma_f32_16x16x32_bf16 v[76:79], a[44:47], v[164:167], v[76:79]
    v_mfma_f32_16x16x32_bf16 v[76:79], a[56:59], v[168:171], v[76:79]
    v_mfma_f32_16x16x32_bf16 v[72:75], a[52:55], v[168:171], v[72:75]
    v_mfma_f32_16x16x32_bf16 v[68:71], a[48:51], v[168:171], v[68:71]
    ds_read_b128 v[116:119], v1 offset:28672
    v_mfma_f32_16x16x32_bf16 v[68:71], a[60:63], v[172:175], v[68:71]
    ds_read_b128 v[120:123], v1 offset:28736
    v_mfma_f32_16x16x32_bf16 v[72:75], a[64:67], v[172:175], v[72:75]
    ds_read_b128 v[124:127], v1 offset:28800
    v_mfma_f32_16x16x32_bf16 v[76:79], a[68:71], v[172:175], v[76:79]
    ds_read_b128 v[128:131], v2 offset:28672
    v_mfma_f32_16x16x32_bf16 v[68:71], a[72:75], v[176:179], v[68:71]
    ds_read_b128 v[132:135], v2 offset:28736
    v_mfma_f32_16x16x32_bf16 v[72:75], a[76:79], v[176:179], v[72:75]
    ds_read_b128 v[136:139], v2 offset:28800
    v_mfma_f32_16x16x32_bf16 v[76:79], a[80:83], v[176:179], v[76:79]
    ds_read_b128 v[140:143], v3 offset:28672
    v_mfma_f32_16x16x32_bf16 v[76:79], a[92:95], v[180:183], v[76:79]
    ds_read_b128 v[144:147], v3 offset:28736
    v_mfma_f32_16x16x32_bf16 v[72:75], a[88:91], v[180:183], v[72:75]
    ds_read_b128 v[148:151], v3 offset:28800
    v_mfma_f32_16x16x32_bf16 v[68:71], a[84:87], v[180:183], v[68:71]
    v_mfma_f32_16x16x32_bf16 v[68:71], a[96:99], v[184:187], v[68:71]
    v_mfma_f32_16x16x32_bf16 v[72:75], a[100:103], v[184:187], v[72:75]
    v_mfma_f32_16x16x32_bf16 v[76:79], a[104:107], v[184:187], v[76:79]
    v_mfma_f32_16x16x32_bf16 v[68:71], a[108:111], v[80:83], v[68:71]
    v_mfma_f32_16x16x32_bf16 v[72:75], a[112:115], v[80:83], v[72:75]
    v_mfma_f32_16x16x32_bf16 v[76:79], a[116:119], v[80:83], v[76:79]
    v_mfma_f32_16x16x32_bf16 v[76:79], a[128:131], v[84:87], v[76:79]
    v_mfma_f32_16x16x32_bf16 v[72:75], a[124:127], v[84:87], v[72:75]
    v_mfma_f32_16x16x32_bf16 v[68:71], a[120:123], v[84:87], v[68:71]
    v_mfma_f32_16x16x32_bf16 v[68:71], a[132:135], v[88:91], v[68:71]
    v_mfma_f32_16x16x32_bf16 v[72:75], a[136:139], v[88:91], v[72:75]
    v_mfma_f32_16x16x32_bf16 v[76:79], a[140:143], v[88:91], v[76:79]
    v_mfma_f32_16x16x32_bf16 v[68:71], a[144:147], v[92:95], v[68:71]
    v_mfma_f32_16x16x32_bf16 v[72:75], a[148:151], v[92:95], v[72:75]
    v_mfma_f32_16x16x32_bf16 v[76:79], a[152:155], v[92:95], v[76:79]
    v_mfma_f32_16x16x32_bf16 v[76:79], a[164:167], v[96:99], v[76:79]
    v_mfma_f32_16x16x32_bf16 v[72:75], a[160:163], v[96:99], v[72:75]
    buffer_store_dwordx2 v[36:37], v10, s[16:19], s31 offen sc1
    v_mfma_f32_16x16x32_bf16 v[68:71], a[156:159], v[96:99], v[68:71]
    s_add_u32 s31, s31, 43008
    v_mfma_f32_16x16x32_bf16 v[68:71], a[168:171], v[100:103], v[68:71]
    v_mfma_f32_16x16x32_bf16 v[72:75], a[172:175], v[100:103], v[72:75]
    v_mfma_f32_16x16x32_bf16 v[76:79], a[176:179], v[100:103], v[76:79]
    v_mfma_f32_16x16x32_bf16 v[68:71], a[180:183], v[104:107], v[68:71]
    v_mfma_f32_16x16x32_bf16 v[72:75], a[184:187], v[104:107], v[72:75]
    v_mfma_f32_16x16x32_bf16 v[76:79], a[188:191], v[104:107], v[76:79]
    v_mfma_f32_16x16x32_bf16 v[76:79], a[200:203], v[108:111], v[76:79]
    v_mfma_f32_16x16x32_bf16 v[72:75], a[196:199], v[108:111], v[72:75]
    v_mfma_f32_16x16x32_bf16 v[68:71], a[192:195], v[108:111], v[68:71]
    v_mfma_f32_16x16x32_bf16 v[68:71], a[204:207], v[112:115], v[68:71]
    v_mfma_f32_16x16x32_bf16 v[72:75], a[208:211], v[112:115], v[72:75]
    v_mfma_f32_16x16x32_bf16 v[76:79], a[212:215], v[112:115], v[76:79]
    s_waitcnt lgkmcnt(7)
    v_mfma_f32_16x16x32_bf16 v[68:71], a[216:219], v[116:119], v[68:71]
    v_mfma_f32_16x16x32_bf16 v[72:75], a[220:223], v[116:119], v[72:75]
    v_mfma_f32_16x16x32_bf16 v[76:79], a[224:227], v[116:119], v[76:79]
    v_mfma_f32_16x16x32_bf16 v[76:79], a[236:239], v[120:123], v[76:79]
    v_mfma_f32_16x16x32_bf16 v[72:75], a[232:235], v[120:123], v[72:75]
    v_mfma_f32_16x16x32_bf16 v[68:71], a[228:231], v[120:123], v[68:71]
    s_waitcnt lgkmcnt(6)
    v_mfma_f32_16x16x32_bf16 v[68:71], a[240:243], v[124:127], v[68:71]
    v_mfma_f32_16x16x32_bf16 v[72:75], a[244:247], v[124:127], v[72:75]
    v_mfma_f32_16x16x32_bf16 v[76:79], a[248:251], v[124:127], v[76:79]
    s_waitcnt lgkmcnt(5)
    v_mfma_f32_16x16x32_bf16 v[68:71], a[252:255], v[128:131], v[68:71]
    v_mfma_f32_16x16x32_bf16 v[72:75], v[188:191], v[128:131], v[72:75]
    v_mfma_f32_16x16x32_bf16 v[76:79], v[192:195], v[128:131], v[76:79]
    s_waitcnt lgkmcnt(4)
    v_mfma_f32_16x16x32_bf16 v[76:79], v[204:207], v[132:135], v[76:79]
    v_mfma_f32_16x16x32_bf16 v[72:75], v[200:203], v[132:135], v[72:75]
    v_mfma_f32_16x16x32_bf16 v[68:71], v[196:199], v[132:135], v[68:71]
    s_waitcnt lgkmcnt(3)
    v_mfma_f32_16x16x32_bf16 v[68:71], v[208:211], v[136:139], v[68:71]
    v_mfma_f32_16x16x32_bf16 v[72:75], v[212:215], v[136:139], v[72:75]
    v_mfma_f32_16x16x32_bf16 v[76:79], v[216:219], v[136:139], v[76:79]
    s_waitcnt lgkmcnt(2)
    v_mfma_f32_16x16x32_bf16 v[68:71], v[220:223], v[140:143], v[68:71]
    v_mfma_f32_16x16x32_bf16 v[72:75], v[224:227], v[140:143], v[72:75]
    v_mfma_f32_16x16x32_bf16 v[76:79], v[228:231], v[140:143], v[76:79]
    s_waitcnt lgkmcnt(1)
    v_mfma_f32_16x16x32_bf16 v[76:79], v[240:243], v[144:147], v[76:79]
    v_mfma_f32_16x16x32_bf16 v[72:75], v[236:239], v[144:147], v[72:75]
    v_mfma_f32_16x16x32_bf16 v[68:71], v[232:235], v[144:147], v[68:71]
    s_waitcnt lgkmcnt(0)
    v_mfma_f32_16x16x32_bf16 v[68:71], v[244:247], v[148:151], v[68:71]
    v_mfma_f32_16x16x32_bf16 v[72:75], v[248:251], v[148:151], v[72:75]
    v_mfma_f32_16x16x32_bf16 v[76:79], v[252:255], v[148:151], v[76:79]
    v_mfma_f32_16x16x32_bf16 v[44:47], a[0:3], v[80:83], 0
    v_mfma_f32_16x16x32_bf16 v[48:51], a[4:7], v[80:83], 0
    v_mfma_f32_16x16x32_bf16 v[52:55], a[8:11], v[80:83], 0
    v_mfma_f32_16x16x32_bf16 v[52:55], a[20:23], v[84:87], v[52:55]
    v_mfma_f32_16x16x32_bf16 v[48:51], a[16:19], v[84:87], v[48:51]
    v_mfma_f32_16x16x32_bf16 v[44:47], a[12:15], v[84:87], v[44:47]
    v_cvt_pk_bf16_f32 v38, v68, v69
    v_cvt_pk_bf16_f32 v39, v70, v71
    v_mfma_f32_16x16x32_bf16 v[44:47], a[24:27], v[88:91], v[44:47]
    v_cvt_pk_bf16_f32 v40, v72, v73
    v_cvt_pk_bf16_f32 v41, v74, v75
    v_mfma_f32_16x16x32_bf16 v[48:51], a[28:31], v[88:91], v[48:51]
    v_cvt_pk_bf16_f32 v42, v76, v77
    v_cvt_pk_bf16_f32 v43, v78, v79
    v_mfma_f32_16x16x32_bf16 v[52:55], a[32:35], v[88:91], v[52:55]
    v_permlane16_swap_b32 v38, v40
    v_permlane16_swap_b32 v39, v41
    v_mfma_f32_16x16x32_bf16 v[44:47], a[36:39], v[92:95], v[44:47]
    v_mfma_f32_16x16x32_bf16 v[48:51], a[40:43], v[92:95], v[48:51]
    buffer_store_dwordx4 v[38:41], v9, s[16:19], s31 offen sc1
    v_mfma_f32_16x16x32_bf16 v[52:55], a[44:47], v[92:95], v[52:55]
    v_mfma_f32_16x16x32_bf16 v[52:55], a[56:59], v[96:99], v[52:55]
    v_mfma_f32_16x16x32_bf16 v[48:51], a[52:55], v[96:99], v[48:51]
    v_mfma_f32_16x16x32_bf16 v[44:47], a[48:51], v[96:99], v[44:47]
    ds_read_b128 v[152:155], v1 offset:32768
    v_mfma_f32_16x16x32_bf16 v[44:47], a[60:63], v[100:103], v[44:47]
    ds_read_b128 v[156:159], v1 offset:32832
    v_mfma_f32_16x16x32_bf16 v[48:51], a[64:67], v[100:103], v[48:51]
    ds_read_b128 v[160:163], v1 offset:32896
    v_mfma_f32_16x16x32_bf16 v[52:55], a[68:71], v[100:103], v[52:55]
    ds_read_b128 v[164:167], v2 offset:32768
    v_mfma_f32_16x16x32_bf16 v[44:47], a[72:75], v[104:107], v[44:47]
    ds_read_b128 v[168:171], v2 offset:32832
    v_mfma_f32_16x16x32_bf16 v[48:51], a[76:79], v[104:107], v[48:51]
    ds_read_b128 v[172:175], v2 offset:32896
    v_mfma_f32_16x16x32_bf16 v[52:55], a[80:83], v[104:107], v[52:55]
    ds_read_b128 v[176:179], v3 offset:32768
    v_mfma_f32_16x16x32_bf16 v[52:55], a[92:95], v[108:111], v[52:55]
    ds_read_b128 v[180:183], v3 offset:32832
    v_mfma_f32_16x16x32_bf16 v[48:51], a[88:91], v[108:111], v[48:51]
    ds_read_b128 v[184:187], v3 offset:32896
    v_mfma_f32_16x16x32_bf16 v[44:47], a[84:87], v[108:111], v[44:47]
    v_mfma_f32_16x16x32_bf16 v[44:47], a[96:99], v[112:115], v[44:47]
    v_mfma_f32_16x16x32_bf16 v[48:51], a[100:103], v[112:115], v[48:51]
    v_mfma_f32_16x16x32_bf16 v[52:55], a[104:107], v[112:115], v[52:55]
    v_mfma_f32_16x16x32_bf16 v[44:47], a[108:111], v[116:119], v[44:47]
    v_mfma_f32_16x16x32_bf16 v[48:51], a[112:115], v[116:119], v[48:51]
    v_mfma_f32_16x16x32_bf16 v[52:55], a[116:119], v[116:119], v[52:55]
    v_mfma_f32_16x16x32_bf16 v[52:55], a[128:131], v[120:123], v[52:55]
    v_mfma_f32_16x16x32_bf16 v[48:51], a[124:127], v[120:123], v[48:51]
    v_mfma_f32_16x16x32_bf16 v[44:47], a[120:123], v[120:123], v[44:47]
    v_mfma_f32_16x16x32_bf16 v[44:47], a[132:135], v[124:127], v[44:47]
    v_mfma_f32_16x16x32_bf16 v[48:51], a[136:139], v[124:127], v[48:51]
    v_mfma_f32_16x16x32_bf16 v[52:55], a[140:143], v[124:127], v[52:55]
    v_mfma_f32_16x16x32_bf16 v[44:47], a[144:147], v[128:131], v[44:47]
    v_mfma_f32_16x16x32_bf16 v[48:51], a[148:151], v[128:131], v[48:51]
    v_mfma_f32_16x16x32_bf16 v[52:55], a[152:155], v[128:131], v[52:55]
    v_mfma_f32_16x16x32_bf16 v[52:55], a[164:167], v[132:135], v[52:55]
    v_mfma_f32_16x16x32_bf16 v[48:51], a[160:163], v[132:135], v[48:51]
    buffer_store_dwordx2 v[42:43], v10, s[16:19], s31 offen sc1
    v_mfma_f32_16x16x32_bf16 v[44:47], a[156:159], v[132:135], v[44:47]
    s_add_u32 s31, s31, 43008
    v_mfma_f32_16x16x32_bf16 v[44:47], a[168:171], v[136:139], v[44:47]
    v_mfma_f32_16x16x32_bf16 v[48:51], a[172:175], v[136:139], v[48:51]
    v_mfma_f32_16x16x32_bf16 v[52:55], a[176:179], v[136:139], v[52:55]
    v_mfma_f32_16x16x32_bf16 v[44:47], a[180:183], v[140:143], v[44:47]
    s_mul_i32 s47, s28, 1792
    s_add_u32 s47, s47, 65536
    v_mfma_f32_16x16x32_bf16 v[48:51], a[184:187], v[140:143], v[48:51]
    v_lshrrev_b32 v21, 6, v6
    v_and_b32 v22, 48, v6
    v_mfma_f32_16x16x32_bf16 v[52:55], a[188:191], v[140:143], v[52:55]
    v_mul_u32_u24 v17, 112, v21
    v_mul_u32_u24 v19, 192, v21
    v_mfma_f32_16x16x32_bf16 v[52:55], a[200:203], v[144:147], v[52:55]
    v_lshrrev_b32 v23, 1, v22
    s_lshl_b32 s48, s29, 7
    v_mfma_f32_16x16x32_bf16 v[48:51], a[196:199], v[144:147], v[48:51]
    s_lshl_b32 s49, s29, 5
    s_add_u32 s49, s49, 64
    v_mfma_f32_16x16x32_bf16 v[44:47], a[192:195], v[144:147], v[44:47]
    v_add3_u32 v20, v19, s49, v23
    v_add3_u32 v19, v19, s48, v22
    v_mfma_f32_16x16x32_bf16 v[44:47], a[204:207], v[148:151], v[44:47]
    s_add_u32 s48, s47, 64
    v_add3_u32 v18, v17, s48, v23
    v_mfma_f32_16x16x32_bf16 v[48:51], a[208:211], v[148:151], v[48:51]
    v_add3_u32 v17, v17, s47, v22
    v_and_b32 v21, 3, v21
    v_mfma_f32_16x16x32_bf16 v[52:55], a[212:215], v[148:151], v[52:55]
    v_lshrrev_b32 v22, 2, v22
    v_add_u32 v21, v21, v22
    s_waitcnt lgkmcnt(7)
    v_mfma_f32_16x16x32_bf16 v[44:47], a[216:219], v[152:155], v[44:47]
    v_lshrrev_b32 v22, 8, v6
    v_mul_u32_u24 v21, 112, v21
    v_mfma_f32_16x16x32_bf16 v[48:51], a[220:223], v[152:155], v[48:51]
    v_lshlrev_b32 v22, 3, v22
    v_add3_u32 v16, v21, s47, v22
    v_mfma_f32_16x16x32_bf16 v[52:55], a[224:227], v[152:155], v[52:55]
    v_mfma_f32_16x16x32_bf16 v[52:55], a[236:239], v[156:159], v[52:55]
    v_mfma_f32_16x16x32_bf16 v[48:51], a[232:235], v[156:159], v[48:51]
    v_mfma_f32_16x16x32_bf16 v[44:47], a[228:231], v[156:159], v[44:47]
    s_waitcnt lgkmcnt(6)
    v_mfma_f32_16x16x32_bf16 v[44:47], a[240:243], v[160:163], v[44:47]
    v_mfma_f32_16x16x32_bf16 v[48:51], a[244:247], v[160:163], v[48:51]
    v_mfma_f32_16x16x32_bf16 v[52:55], a[248:251], v[160:163], v[52:55]
    s_waitcnt lgkmcnt(5)
    v_mfma_f32_16x16x32_bf16 v[44:47], a[252:255], v[164:167], v[44:47]
    v_mfma_f32_16x16x32_bf16 v[48:51], v[188:191], v[164:167], v[48:51]
    v_mfma_f32_16x16x32_bf16 v[52:55], v[192:195], v[164:167], v[52:55]
    s_waitcnt lgkmcnt(4)
    v_mfma_f32_16x16x32_bf16 v[52:55], v[204:207], v[168:171], v[52:55]
    v_mfma_f32_16x16x32_bf16 v[48:51], v[200:203], v[168:171], v[48:51]
    v_mfma_f32_16x16x32_bf16 v[44:47], v[196:199], v[168:171], v[44:47]
    s_waitcnt lgkmcnt(3)
    v_mfma_f32_16x16x32_bf16 v[44:47], v[208:211], v[172:175], v[44:47]
    v_mfma_f32_16x16x32_bf16 v[48:51], v[212:215], v[172:175], v[48:51]
    v_mfma_f32_16x16x32_bf16 v[52:55], v[216:219], v[172:175], v[52:55]
    s_waitcnt lgkmcnt(2)
    v_mfma_f32_16x16x32_bf16 v[44:47], v[220:223], v[176:179], v[44:47]
    v_mfma_f32_16x16x32_bf16 v[48:51], v[224:227], v[176:179], v[48:51]
    v_mfma_f32_16x16x32_bf16 v[52:55], v[228:231], v[176:179], v[52:55]
    s_waitcnt lgkmcnt(1)
    v_mfma_f32_16x16x32_bf16 v[52:55], v[240:243], v[180:183], v[52:55]
    v_mfma_f32_16x16x32_bf16 v[48:51], v[236:239], v[180:183], v[48:51]
    v_mfma_f32_16x16x32_bf16 v[44:47], v[232:235], v[180:183], v[44:47]
    s_waitcnt lgkmcnt(0)
    v_mfma_f32_16x16x32_bf16 v[44:47], v[244:247], v[184:187], v[44:47]
    v_mfma_f32_16x16x32_bf16 v[48:51], v[248:251], v[184:187], v[48:51]
    v_mfma_f32_16x16x32_bf16 v[52:55], v[252:255], v[184:187], v[52:55]
    s_nop 5
    v_cvt_pk_bf16_f32 v32, v44, v45
    v_cvt_pk_bf16_f32 v33, v46, v47
    v_cvt_pk_bf16_f32 v34, v48, v49
    v_cvt_pk_bf16_f32 v35, v50, v51
    ds_write_b64 v16, v[32:33] offset:0
    v_cvt_pk_bf16_f32 v36, v52, v53
    v_cvt_pk_bf16_f32 v37, v54, v55
    ds_write_b64 v16, v[34:35] offset:32
    ds_write_b64 v16, v[36:37] offset:64
    ds_read_b128 v[38:41], v17
    ds_read_b64 v[42:43], v18
    s_waitcnt lgkmcnt(1)
    buffer_store_dwordx4 v[38:41], v19, s[16:19], s31 offen sc1
    s_waitcnt lgkmcnt(0)
    buffer_store_dwordx2 v[42:43], v20, s[16:19], s31 offen sc1
    s_cbranch_vccnz L_gN
L_fin:
L_end:
    s_endpgm
.p2align 12
L_S:
    s_mul_i32 s47, s28, 11872
    v_mov_b32 v100, 0
    v_mov_b32 v101, 0
    v_mov_b32 v102, 0
    v_mov_b32 v103, 0
    v_add_u32 v104, s47, v6
    ds_write_b128 v104, v[100:103] offset:41472
    s_cmp_eq_u32 s56, 0
    s_mov_b32 s59, 0x01000c0c
    s_cselect_b32 s59, 0x03020c0c, s59
    s_cselect_b32 s49, 1.0, 0
    ds_write_b128 v104, v[100:103] offset:42496
    s_movk_i32 s36, 0x102
    s_cselect_b32 s36, 0x832, s36
    s_movk_i32 s37, 0x543
    s_cselect_b32 s37, 0x640, s37
    ds_write_b128 v104, v[100:103] offset:43520
    s_movk_i32 s38, 0x768
    s_cselect_b32 s38, 0x751, s38
    s_lshl_b32 s42, s56, 4
    v_mad_u32_u24 v56, v39, s56, v40
    ds_write_b128 v104, v[100:103] offset:44544
    v_add_u32 v57, 1, v40
    v_cmp_gt_u32 vcc, 14, v40
    v_add_u32 v56, -1, v56
    v_lshrrev_b32 v57, 4, v57
    ds_write_b128 v104, v[100:103] offset:45568
    v_mov_b32 v58, 0x41880000
    v_cvt_f32_i32 v20, v56
    v_lshl_add_u32 v57, v40, 2, v57
    v_mov_b32 v23, 0x416fffff
    ds_write_b128 v104, v[100:103] offset:46592
    v_lshlrev_b32 v56, 2, v39
    v_add_f32 v21, s49, v20
    v_cndmask_b32 v23, v58, v23, vcc
    s_mov_b32 s47, 41472
    ds_write_b128 v104, v[100:103] offset:47616
    v_bfe_u32 v24, s36, v56, 4
    v_bfe_u32 v25, s37, v56, 4
    v_bfe_u32 v26, s38, v56, 4
    v_add_f32 v22, s49, v21
    ds_write_b128 v104, v[100:103] offset:48640
    s_waitcnt vmcnt(11)
    v_add_u32_sdwa v58, s47, v165 dst_sel:DWORD dst_unused:UNUSED_PAD src0_sel:DWORD src1_sel:WORD_1
    s_movk_i32 s48, 528
    v_lshl_add_u32 v57, v57, 3, v58
    s_mul_i32 s61, s30, 23760
    ds_write_b128 v104, v[100:103] offset:49664
    v_mad_u32_u24 v24, v24, s48, v57
    v_mad_u32_u24 v25, v25, s48, v57
    v_mad_u32_u24 v26, v26, s48, v57
    s_add_u32 s61, s61, s47
    ds_write_b128 v104, v[100:103] offset:50688
    s_mul_i32 s47, s30, 17280
    v_add_u32_sdwa v3, s61, v165 dst_sel:DWORD dst_unused:UNUSED_PAD src0_sel:DWORD src1_sel:WORD_0
    v_add_u32_sdwa v9, s61, v166 dst_sel:DWORD dst_unused:UNUSED_PAD src0_sel:DWORD src1_sel:WORD_0
    v_add_u32_sdwa v10, s61, v166 dst_sel:DWORD dst_unused:UNUSED_PAD src0_sel:DWORD src1_sel:WORD_1
    ds_write_b128 v104, v[100:103] offset:51712
    v_add_u32_sdwa v1, s47, v164 dst_sel:DWORD dst_unused:UNUSED_PAD src0_sel:DWORD src1_sel:WORD_0
    v_add_u32_sdwa v2, s47, v164 dst_sel:DWORD dst_unused:UNUSED_PAD src0_sel:DWORD src1_sel:WORD_1
    s_lshl_b32 s48, s29, 7
    s_lshl_b32 s49, s29, 5
    ds_write_b128 v104, v[100:103] offset:52352
    s_add_u32 s47, s48, 88992
    v_add_u32_sdwa v4, s47, v16 dst_sel:DWORD dst_unused:UNUSED_PAD src0_sel:DWORD src1_sel:WORD_0
    s_add_u32 s47, s49, 88992
    v_add_u32_sdwa v5, s47, v16 dst_sel:DWORD dst_unused:UNUSED_PAD src0_sel:DWORD src1_sel:WORD_0
    s_lshl2_add_u32 s47, s28, 163488
    v_mov_b32 v27, s47
    s_mov_b32 s54, 0
    s_cmp_eq_u32 s30, 0
    s_cselect_b32 s31, s26, s27
    s_waitcnt lgkmcnt(0)
    s_barrier
    s_waitcnt vmcnt(7)
    v_mov_b32 v47, v52
    s_add_u32 m0, s44, 113824
    s_add_u32 s46, s65, 6144
    buffer_load_dwordx4 v7, s[12:15], s46 offen offset:0 lds
    v_perm_b32 v56, v44, v44, s59
    v_perm_b32 v60, v45, v45, s59
    v_perm_b32 v64, v46, v46, s59
    v_bfe_u32 v59, v44, s42, 15
    v_bfe_u32 v63, v45, s42, 15
    v_bfe_u32 v67, v46, s42, 15
    v_add_f32 v56, v56, v20
    v_add_f32 v60, v60, v21
    v_add_f32 v64, v64, v22
    v_cvt_pk_bf16_f32 v56, v56, v56
    v_cvt_pk_bf16_f32 v60, v60, v60
    v_cvt_pk_bf16_f32 v64, v64, v64
    v_lshlrev_b32 v44, 16, v56
    v_lshlrev_b32 v45, 16, v60
    buffer_load_dwordx4 v7, s[12:15], s46 offen offset:1024 lds
    v_lshlrev_b32 v46, 16, v64
    v_med3_i32 v56, v44, 0, v23
    v_med3_i32 v60, v45, 0, v23
    v_med3_i32 v64, v46, 0, v23
    v_fract_f32 v57, v56
    v_fract_f32 v61, v60
    v_fract_f32 v65, v64
    v_cvt_u32_f32 v58, v56
    v_cvt_u32_f32 v62, v60
    v_cvt_u32_f32 v66, v64
    v_sub_f32 v56, 1.0, v57
    v_sub_f32 v60, 1.0, v61
    v_sub_f32 v64, 1.0, v65
    v_max3_u32 v59, v59, v63, v67
    buffer_load_dwordx4 v7, s[12:15], s46 offen offset:2048 lds
    v_max3_i32 v44, v44, v45, v46
    v_cmp_lt_u32 vcc, s68, v59
    v_cmp_gt_i32 s[66:67], v44, v23
    v_lshl_add_u32 v58, v58, 1, v24
    v_lshl_add_u32 v62, v62, 1, v25
    v_lshl_add_u32 v66, v66, 1, v26
    v_cvt_pk_bf16_f32 v56, v56, v57
    v_cvt_pk_bf16_f32 v60, v60, v61
    v_cvt_pk_bf16_f32 v64, v64, v65
    s_or_b64 vcc, vcc, s[66:67]
    s_cselect_b32 s47, 3, 0
    s_or_b32 s54, s54, s47
    v_perm_b32 v68, v48, v48, s59
    v_perm_b32 v72, v49, v49, s59
    v_perm_b32 v76, v50, v50, s59
    v_bfe_u32 v71, v48, s42, 15
    s_mul_i32 s48, s55, 0
    s_add_u32 m0, s33, 0
    s_add_u32 s48, s48, s20
    buffer_load_dwordx4 v8, s[4:7], s48 offen lds
    v_bfe_u32 v75, v49, s42, 15
    v_bfe_u32 v79, v50, s42, 15
    v_add_f32 v68, v68, v20
    v_add_f32 v72, v72, v21
    v_add_f32 v76, v76, v22
    v_cvt_pk_bf16_f32 v68, v68, v68
    v_cvt_pk_bf16_f32 v72, v72, v72
    v_cvt_pk_bf16_f32 v76, v76, v76
    v_lshlrev_b32 v48, 16, v68
    v_lshlrev_b32 v49, 16, v72
    v_lshlrev_b32 v50, 16, v76
    v_med3_i32 v68, v48, 0, v23
    v_med3_i32 v72, v49, 0, v23
    v_med3_i32 v76, v50, 0, v23
    s_mul_i32 s48, s55, 5
    s_add_u32 m0, s33, 17280
    s_add_u32 s48, s48, s20
    buffer_load_dwordx4 v8, s[4:7], s48 offen lds
    v_fract_f32 v69, v68
    v_fract_f32 v73, v72
    v_fract_f32 v77, v76
    v_cvt_u32_f32 v70, v68
    v_cvt_u32_f32 v74, v72
    v_cvt_u32_f32 v78, v76
    v_sub_f32 v68, 1.0, v69
    v_sub_f32 v72, 1.0, v73
    v_sub_f32 v76, 1.0, v77
    v_max3_u32 v71, v71, v75, v79
    v_max3_i32 v48, v48, v49, v50
    v_cmp_lt_u32 vcc, s68, v71
    v_cmp_gt_i32 s[66:67], v48, v23
    v_lshl_add_u32 v70, v70, 1, v24
    s_mul_i32 s48, s55, 1
    s_add_u32 m0, s33, 3456
    s_add_u32 s48, s48, s20
    buffer_load_dwordx4 v8, s[4:7], s48 offen lds
    v_lshl_add_u32 v74, v74, 1, v25
    v_lshl_add_u32 v78, v78, 1, v26
    v_cvt_pk_bf16_f32 v68, v68, v69
    v_cvt_pk_bf16_f32 v72, v72, v73
    v_cvt_pk_bf16_f32 v76, v76, v77
    s_or_b64 vcc, vcc, s[66:67]
    s_cselect_b32 s47, 12, 0
    s_or_b32 s54, s54, s47
    v_perm_b32 v80, v52, v52, s59
    v_perm_b32 v84, v53, v53, s59
    v_perm_b32 v88, v54, v54, s59
    v_bfe_u32 v83, v52, s42, 15
    v_bfe_u32 v87, v53, s42, 15
    v_bfe_u32 v91, v54, s42, 15
    v_add_f32 v80, v80, v20
    v_add_f32 v84, v84, v21
    s_mul_i32 s48, s55, 6
    s_add_u32 m0, s33, 20736
    s_add_u32 s48, s48, s20
    buffer_load_dwordx4 v8, s[4:7], s48 offen lds
    v_add_f32 v88, v88, v22
    v_cvt_pk_bf16_f32 v80, v80, v80
    v_cvt_pk_bf16_f32 v84, v84, v84
    v_cvt_pk_bf16_f32 v88, v88, v88
    v_lshlrev_b32 v52, 16, v80
    v_lshlrev_b32 v53, 16, v84
    v_lshlrev_b32 v54, 16, v88
    v_med3_i32 v80, v52, 0, v23
    v_med3_i32 v84, v53, 0, v23
    v_med3_i32 v88, v54, 0, v23
    v_fract_f32 v81, v80
    v_fract_f32 v85, v84
    v_fract_f32 v89, v88
    v_cvt_u32_f32 v82, v80
    v_cvt_u32_f32 v86, v84
    v_cvt_u32_f32 v90, v88
    v_sub_f32 v80, 1.0, v81
    v_sub_f32 v84, 1.0, v85
    v_sub_f32 v88, 1.0, v89
    v_max3_u32 v83, v83, v87, v91
    v_max3_i32 v52, v52, v53, v54
    v_cmp_lt_u32 vcc, s68, v83
    v_cmp_gt_i32 s[66:67], v52, v23
    v_lshl_add_u32 v82, v82, 1, v24
    v_lshl_add_u32 v86, v86, 1, v25
    v_lshl_add_u32 v90, v90, 1, v26
    v_cvt_pk_bf16_f32 v80, v80, v81
    v_cvt_pk_bf16_f32 v84, v84, v85
    v_cvt_pk_bf16_f32 v88, v88, v89
    s_or_b64 vcc, vcc, s[66:67]
    s_cselect_b32 s47, 48, 0
    s_or_b32 s54, s54, s47
    s_mov_b32 exec_hi, 0xffff
    ds_write_b16 v58, v56 offset:0
    ds_write_b16_d16_hi v58, v56 offset:2
    ds_write_b16 v62, v60 offset:0
    ds_write_b16_d16_hi v62, v60 offset:2
    ds_write_b16 v66, v64 offset:0
    ds_write_b16_d16_hi v66, v64 offset:2
    ds_write_b16 v70, v68 offset:9504
    ds_write_b16_d16_hi v70, v68 offset:9506
    ds_write_b16 v74, v72 offset:9504
    ds_write_b16_d16_hi v74, v72 offset:9506
    ds_write_b16 v78, v76 offset:9504
    ds_write_b16_d16_hi v78, v76 offset:9506
    s_mov_b64 exec, 0xffffff
    ds_write_b16 v82, v80 offset:19008
    ds_write_b16_d16_hi v82, v80 offset:19010
    ds_write_b16 v86, v84 offset:19008
    ds_write_b16_d16_hi v86, v84 offset:19010
    ds_write_b16 v90, v88 offset:19008
    ds_write_b16_d16_hi v90, v88 offset:19010
    s_mov_b64 exec, -1
    v_mov_b32 v12, s54
    ds_write_b32 v27, v12
    s_waitcnt vmcnt(4)
    s_barrier
    s_mul_i32 s48, s55, 2
    s_add_u32 m0, s33, 6912
    s_add_u32 s48, s48, s20
    buffer_load_dwordx4 v8, s[4:7], s48 offen lds
    ds_read_b64_tr_b16 a[0:1], v4 offset:0
    ds_read_b64_tr_b16 a[2:3], v4 offset:768
    ds_read_b64_tr_b16 a[4:5], v4 offset:32
    ds_read_b64_tr_b16 a[6:7], v4 offset:800
    ds_read_b64_tr_b16 a[8:9], v5 offset:64
    ds_read_b64_tr_b16 a[10:11], v5 offset:832
    ds_read_b64_tr_b16 a[12:13], v4 offset:6208
    ds_read_b64_tr_b16 a[14:15], v4 offset:6976
    ds_read_b64_tr_b16 a[16:17], v4 offset:6240
    ds_read_b64_tr_b16 a[18:19], v4 offset:7008
    s_mul_i32 s48, s55, 7
    s_add_u32 m0, s33, 24192
    s_add_u32 s48, s48, s20
    buffer_load_dwordx4 v8, s[4:7], s48 offen lds
    ds_read_b64_tr_b16 a[20:21], v5 offset:6272
    ds_read_b64_tr_b16 a[22:23], v5 offset:7040
    ds_read_b64_tr_b16 a[24:25], v4 offset:12416
    ds_read_b64_tr_b16 a[26:27], v4 offset:13184
    ds_read_b64_tr_b16 a[28:29], v4 offset:12448
    ds_read_b64_tr_b16 a[30:31], v4 offset:13216
    ds_read_b64_tr_b16 a[32:33], v5 offset:12480
    ds_read_b64_tr_b16 a[34:35], v5 offset:13248
    ds_read_b64_tr_b16 a[36:37], v4 offset:18624
    ds_read_b64_tr_b16 a[38:39], v4 offset:19392
    s_mul_i32 s48, s55, 3
    s_add_u32 m0, s33, 10368
    s_add_u32 s48, s48, s20
    buffer_load_dwordx4 v8, s[4:7], s48 offen lds
    ds_read_b64_tr_b16 a[40:41], v4 offset:18656
    ds_read_b64_tr_b16 a[42:43], v4 offset:19424
    ds_read_b64_tr_b16 a[44:45], v5 offset:18688
    ds_read_b64_tr_b16 a[46:47], v5 offset:19456
    ds_read_b64_tr_b16 a[48:49], v4 offset:24832
    ds_read_b64_tr_b16 a[50:51], v4 offset:25600
    ds_read_b64_tr_b16 a[52:53], v4 offset:24864
    ds_read_b64_tr_b16 a[54:55], v4 offset:25632
    ds_read_b64_tr_b16 a[56:57], v5 offset:24896
    ds_read_b64_tr_b16 a[58:59], v5 offset:25664
    s_mul_i32 s48, s55, 8
    s_add_u32 m0, s33, 27648
    s_add_u32 s48, s48, s20
    buffer_load_dwordx4 v8, s[4:7], s48 offen lds
    ds_read_b64_tr_b16 a[60:61], v4 offset:31040
    ds_read_b64_tr_b16 a[62:63], v4 offset:31808
    ds_read_b64_tr_b16 a[64:65], v4 offset:31072
    ds_read_b64_tr_b16 a[66:67], v4 offset:31840
    ds_read_b64_tr_b16 a[68:69], v5 offset:31104
    ds_read_b64_tr_b16 a[70:71], v5 offset:31872
    s_mul_i32 s48, s55, 4
    s_add_u32 m0, s33, 13824
    s_add_u32 s48, s48, s20
    buffer_load_dwordx4 v8, s[4:7], s48 offen lds
    s_mul_i32 s48, s55, 9
    s_add_u32 m0, s33, 31104
    s_add_u32 s48, s48, s20
    buffer_load_dwordx4 v8, s[4:7], s48 offen lds
    v_add_u32 v4, 37248, v4
    v_add_u32 v5, 37248, v5
    s_waitcnt vmcnt(6)
    s_waitcnt lgkmcnt(0)
    s_barrier
    ds_read_b128 a[144:147], v1 offset:0
    ds_read_b128 a[148:151], v1 offset:64
    ds_read_b128 a[152:155], v1 offset:128
    ds_read_b128 a[156:159], v1 offset:3456
    ds_read_b128 a[160:163], v1 offset:3520
    ds_read_b128 a[164:167], v1 offset:3584
    s_waitcnt lgkmcnt(5)
    v_mfma_f32_16x16x32_bf16 v[116:119], a[144:147], a[0:3], 0
    v_mfma_f32_16x16x32_bf16 v[120:123], a[144:147], a[4:7], 0
    s_add_u32 m0, s44, 126240
    s_bfe_u32 s46, s24, 0x40008
    s_mul_i32 s46, s46, 18432
    v_mfma_f32_16x16x32_bf16 v[124:127], a[144:147], a[8:11], 0
    buffer_load_dwordx4 v7, s[12:15], s46 offen offset:0 lds
    s_waitcnt lgkmcnt(4)
    v_mfma_f32_16x16x32_bf16 v[116:119], a[148:151], a[12:15], v[116:119]
    v_mfma_f32_16x16x32_bf16 v[120:123], a[148:151], a[16:19], v[120:123]
    v_mfma_f32_16x16x32_bf16 v[124:127], a[148:151], a[20:23], v[124:127]
    s_waitcnt lgkmcnt(3)
    v_mfma_f32_16x16x32_bf16 v[116:119], a[152:155], a[24:27], v[116:119]
    buffer_load_dwordx4 v7, s[12:15], s46 offen offset:1024 lds
    v_mfma_f32_16x16x32_bf16 v[120:123], a[152:155], a[28:31], v[120:123]
    v_mfma_f32_16x16x32_bf16 v[124:127], a[152:155], a[32:35], v[124:127]
    v_mfma_f32_16x16x32_bf16 v[128:131], a[144:147], a[36:39], 0
    v_mfma_f32_16x16x32_bf16 v[132:135], a[144:147], a[40:43], 0
    buffer_load_dwordx4 v7, s[12:15], s46 offen offset:2048 lds
    v_mfma_f32_16x16x32_bf16 v[136:139], a[144:147], a[44:47], 0
    ds_read_b64 v[216:217], v3 offset:0
    v_mfma_f32_16x16x32_bf16 v[128:131], a[148:151], a[48:51], v[128:131]
    v_cvt_pk_bf16_f32 v140, v116, v117
    v_cvt_pk_bf16_f32 v141, v118, v119
    v_mfma_f32_16x16x32_bf16 v[132:135], a[148:151], a[52:55], v[132:135]
    v_cvt_pk_bf16_f32 v144, v120, v121
    v_cvt_pk_bf16_f32 v145, v122, v123
    v_mfma_f32_16x16x32_bf16 v[136:139], a[148:151], a[56:59], v[136:139]
    v_cvt_pk_bf16_f32 v148, v124, v125
    v_cvt_pk_bf16_f32 v149, v126, v127
    v_mfma_f32_16x16x32_bf16 v[128:131], a[152:155], a[60:63], v[128:131]
    ds_read_b64 v[218:219], v3 offset:528
    s_add_u32 m0, s44, 138656
    s_add_u32 s64, s46, 12288
    s_bfe_u32 s65, s24, 0x4000c
    s_mul_i32 s65, s65, 18432
    s_sub_u32 s46, s65, 6144
    s_cmp_eq_u32 s30, 0
    s_cselect_b32 s46, s64, s46
    v_mfma_f32_16x16x32_bf16 v[132:135], a[152:155], a[64:67], v[132:135]
    buffer_load_dwordx4 v7, s[12:15], s46 offen offset:0 lds
    v_mfma_f32_16x16x32_bf16 v[136:139], a[152:155], a[68:71], v[136:139]
    s_waitcnt lgkmcnt(4)
    v_mfma_f32_16x16x32_bf16 v[116:119], a[156:159], a[0:3], 0
    buffer_load_dwordx4 v7, s[12:15], s46 offen offset:1024 lds
    v_mfma_f32_16x16x32_bf16 v[120:123], a[156:159], a[4:7], 0
    v_mfma_f32_16x16x32_bf16 v[124:127], a[156:159], a[8:11], 0
    s_waitcnt lgkmcnt(3)
    v_mfma_f32_16x16x32_bf16 v[116:119], a[160:163], a[12:15], v[116:119]
    v_cvt_pk_bf16_f32 v142, v128, v129
    v_cvt_pk_bf16_f32 v143, v130, v131
    v_mfma_f32_16x16x32_bf16 v[120:123], a[160:163], a[16:19], v[120:123]
    v_cvt_pk_bf16_f32 v146, v132, v133
    v_cvt_pk_bf16_f32 v147, v134, v135
    v_mfma_f32_16x16x32_bf16 v[124:127], a[160:163], a[20:23], v[124:127]
    v_cvt_pk_bf16_f32 v150, v136, v137
    v_cvt_pk_bf16_f32 v151, v138, v139
    s_waitcnt lgkmcnt(2)
    v_mfma_f32_16x16x32_bf16 v[116:119], a[164:167], a[24:27], v[116:119]
    buffer_load_dwordx4 v7, s[12:15], s46 offen offset:2048 lds
    v_mfma_f32_16x16x32_bf16 v[120:123], a[164:167], a[28:31], v[120:123]
    s_waitcnt lgkmcnt(0)
    v_mfma_f32_16x16x32_bf16 v[44:47], v[140:143], v[216:219], 0
    s_waitcnt vmcnt(6)
    s_barrier
    s_add_u32 m0, s44, 151072
    s_add_u32 s46, s65, 6144
    v_mfma_f32_16x16x32_bf16 v[48:51], v[144:147], v[216:219], 0
    buffer_load_dwordx4 v7, s[12:15], s46 offen offset:0 lds
    v_mfma_f32_16x16x32_bf16 v[52:55], v[148:151], v[216:219], 0
    ds_read_b128 a[168:171], v1 offset:6912
    v_mfma_f32_16x16x32_bf16 v[124:127], a[164:167], a[32:35], v[124:127]
    ds_read_b64 v[220:221], v3 offset:4752
    v_mfma_f32_16x16x32_bf16 v[128:131], a[156:159], a[36:39], 0
    ds_read_b64 v[222:223], v3 offset:5280
    v_mfma_f32_16x16x32_bf16 v[132:135], a[156:159], a[40:43], 0
    buffer_load_dwordx4 v7, s[12:15], s46 offen offset:1024 lds
    v_mfma_f32_16x16x32_bf16 v[136:139], a[156:159], a[44:47], 0
    ds_read_b128 a[172:175], v1 offset:6976
    v_mfma_f32_16x16x32_bf16 v[128:131], a[160:163], a[48:51], v[128:131]
    v_cvt_pk_bf16_f32 v140, v116, v117
    v_cvt_pk_bf16_f32 v141, v118, v119
    v_mfma_f32_16x16x32_bf16 v[132:135], a[160:163], a[52:55], v[132:135]
    v_cvt_pk_bf16_f32 v144, v120, v121
    v_cvt_pk_bf16_f32 v145, v122, v123
    v_mfma_f32_16x16x32_bf16 v[136:139], a[160:163], a[56:59], v[136:139]
    v_cvt_pk_bf16_f32 v148, v124, v125
    v_cvt_pk_bf16_f32 v149, v126, v127
    v_mfma_f32_16x16x32_bf16 v[128:131], a[164:167], a[60:63], v[128:131]
    buffer_load_dwordx4 v7, s[12:15], s46 offen offset:2048 lds
    v_mfma_f32_16x16x32_bf16 v[132:135], a[164:167], a[64:67], v[132:135]
    s_mul_i32 s48, s55, 10
    s_add_u32 m0, s33, 34560
    s_add_u32 s48, s48, s20
    v_mfma_f32_16x16x32_bf16 v[136:139], a[164:167], a[68:71], v[136:139]
    buffer_load_dwordx4 v8, s[4:7], s48 offen lds
    s_waitcnt lgkmcnt(3)
    v_mfma_f32_16x16x32_bf16 v[116:119], a[168:171], a[0:3], 0
    ds_read_b128 a[176:179], v1 offset:7040
    v_mfma_f32_16x16x32_bf16 v[120:123], a[168:171], a[4:7], 0
    ds_read_b128 a[180:183], v1 offset:10368
    v_mfma_f32_16x16x32_bf16 v[124:127], a[168:171], a[8:11], 0
    s_mul_i32 s48, s55, 11
    s_add_u32 m0, s33, 38016
    s_add_u32 s48, s48, s20
    s_min_u32 s48, s48, s21
    s_waitcnt lgkmcnt(2)
    v_mfma_f32_16x16x32_bf16 v[116:119], a[172:175], a[12:15], v[116:119]
    v_cvt_pk_bf16_f32 v142, v128, v129
    v_cvt_pk_bf16_f32 v143, v130, v131
    buffer_load_dwordx4 v8, s[4:7], s48 offen lds
    v_mfma_f32_16x16x32_bf16 v[120:123], a[172:175], a[16:19], v[120:123]
    v_cvt_pk_bf16_f32 v146, v132, v133
    v_cvt_pk_bf16_f32 v147, v134, v135
    v_mfma_f32_16x16x32_bf16 v[124:127], a[172:175], a[20:23], v[124:127]
    v_cvt_pk_bf16_f32 v150, v136, v137
    v_cvt_pk_bf16_f32 v151, v138, v139
    s_add_u32 m0, s44, 88992
    s_bfe_u32 s46, s24, 0x40010
    s_mul_i32 s46, s46, 18432
    s_waitcnt lgkmcnt(1)
    v_mfma_f32_16x16x32_bf16 v[116:119], a[176:179], a[24:27], v[116:119]
    buffer_load_dwordx4 v7, s[12:15], s46 offen offset:0 lds
    v_mfma_f32_16x16x32_bf16 v[120:123], a[176:179], a[28:31], v[120:123]
    ds_read_b128 a[184:187], v1 offset:10432
    v_mfma_f32_16x16x32_bf16 v[56:59], v[140:143], v[220:223], 0
    ds_read_b128 a[188:191], v1 offset:10496
    v_mfma_f32_16x16x32_bf16 v[60:63], v[144:147], v[220:223], 0
    ds_read_b128 a[192:195], v1 offset:13824
    v_mfma_f32_16x16x32_bf16 v[64:67], v[148:151], v[220:223], 0
    ds_read_b128 a[196:199], v1 offset:13888
    v_mfma_f32_16x16x32_bf16 v[124:127], a[176:179], a[32:35], v[124:127]
    ds_read_b64 v[216:217], v3 offset:9504
    v_mfma_f32_16x16x32_bf16 v[128:131], a[168:171], a[36:39], 0
    ds_read_b64 v[218:219], v3 offset:10032
    v_mfma_f32_16x16x32_bf16 v[132:135], a[168:171], a[40:43], 0
    buffer_load_dwordx4 v7, s[12:15], s46 offen offset:1024 lds
    v_mfma_f32_16x16x32_bf16 v[136:139], a[168:171], a[44:47], 0
    ds_read_b128 a[200:203], v1 offset:13952
    v_mfma_f32_16x16x32_bf16 v[128:131], a[172:175], a[48:51], v[128:131]
    v_cvt_pk_bf16_f32 v140, v116, v117
    v_cvt_pk_bf16_f32 v141, v118, v119
    v_mfma_f32_16x16x32_bf16 v[132:135], a[172:175], a[52:55], v[132:135]
    v_cvt_pk_bf16_f32 v144, v120, v121
    v_cvt_pk_bf16_f32 v145, v122, v123
    v_mfma_f32_16x16x32_bf16 v[136:139], a[172:175], a[56:59], v[136:139]
    v_cvt_pk_bf16_f32 v148, v124, v125
    v_cvt_pk_bf16_f32 v149, v126, v127
    v_mfma_f32_16x16x32_bf16 v[128:131], a[176:179], a[60:63], v[128:131]
    buffer_load_dwordx4 v7, s[12:15], s46 offen offset:2048 lds
    v_mfma_f32_16x16x32_bf16 v[132:135], a[176:179], a[64:67], v[132:135]
    ds_read_b128 a[228:231], v2 offset:0
    v_mfma_f32_16x16x32_bf16 v[136:139], a[176:179], a[68:71], v[136:139]
    ds_read_b128 a[232:235], v2 offset:64
    s_waitcnt lgkmcnt(7)
    v_mfma_f32_16x16x32_bf16 v[116:119], a[180:183], a[0:3], 0
    ds_read_b128 a[236:239], v2 offset:128
    v_mfma_f32_16x16x32_bf16 v[120:123], a[180:183], a[4:7], 0
    s_add_u32 m0, s44, 101408
    s_add_u32 s64, s46, 12288
    s_bfe_u32 s65, s24, 0x40014
    s_mul_i32 s65, s65, 18432
    s_sub_u32 s46, s65, 6144
    s_cmp_eq_u32 s30, 0
    s_cselect_b32 s46, s64, s46
    v_mfma_f32_16x16x32_bf16 v[124:127], a[180:183], a[8:11], 0
    buffer_load_dwordx4 v7, s[12:15], s46 offen offset:0 lds
    v_mfma_f32_16x16x32_bf16 v[116:119], a[184:187], a[12:15], v[116:119]
    v_cvt_pk_bf16_f32 v142, v128, v129
    v_cvt_pk_bf16_f32 v143, v130, v131
    v_mfma_f32_16x16x32_bf16 v[120:123], a[184:187], a[16:19], v[120:123]
    v_cvt_pk_bf16_f32 v146, v132, v133
    v_cvt_pk_bf16_f32 v147, v134, v135
    v_mfma_f32_16x16x32_bf16 v[124:127], a[184:187], a[20:23], v[124:127]
    v_cvt_pk_bf16_f32 v150, v136, v137
    v_cvt_pk_bf16_f32 v151, v138, v139
    v_mfma_f32_16x16x32_bf16 v[116:119], a[188:191], a[24:27], v[116:119]
    v_mfma_f32_16x16x32_bf16 v[120:123], a[188:191], a[28:31], v[120:123]
    s_waitcnt lgkmcnt(4)
    v_mfma_f32_16x16x32_bf16 v[68:71], v[140:143], v[216:219], 0
    buffer_load_dwordx4 v7, s[12:15], s46 offen offset:1024 lds
    v_mfma_f32_16x16x32_bf16 v[72:75], v[144:147], v[216:219], 0
    v_mfma_f32_16x16x32_bf16 v[76:79], v[148:151], v[216:219], 0
    s_waitcnt vmcnt(5)
    s_barrier
    v_mfma_f32_16x16x32_bf16 v[124:127], a[188:191], a[32:35], v[124:127]
    ds_read_b64 v[220:221], v3 offset:14256
    ds_read_b64_tr_b16 a[72:73], v4 offset:0
    v_mfma_f32_16x16x32_bf16 v[128:131], a[180:183], a[36:39], 0
    ds_read_b64 v[222:223], v3 offset:14784
    v_mfma_f32_16x16x32_bf16 v[132:135], a[180:183], a[40:43], 0
    buffer_load_dwordx4 v7, s[12:15], s46 offen offset:2048 lds
    v_mfma_f32_16x16x32_bf16 v[136:139], a[180:183], a[44:47], 0
    ds_read_b64_tr_b16 a[74:75], v4 offset:768
    ds_read_b64_tr_b16 a[76:77], v4 offset:32
    v_mfma_f32_16x16x32_bf16 v[128:131], a[184:187], a[48:51], v[128:131]
    v_cvt_pk_bf16_f32 v140, v116, v117
    v_cvt_pk_bf16_f32 v141, v118, v119
    ds_read_b64_tr_b16 a[78:79], v4 offset:800
    v_mfma_f32_16x16x32_bf16 v[132:135], a[184:187], a[52:55], v[132:135]
    v_cvt_pk_bf16_f32 v144, v120, v121
    v_cvt_pk_bf16_f32 v145, v122, v123
    v_mfma_f32_16x16x32_bf16 v[136:139], a[184:187], a[56:59], v[136:139]
    v_cvt_pk_bf16_f32 v148, v124, v125
    v_cvt_pk_bf16_f32 v149, v126, v127
    v_mfma_f32_16x16x32_bf16 v[128:131], a[188:191], a[60:63], v[128:131]
    s_add_u32 m0, s44, 113824
    s_add_u32 s46, s65, 6144
    ds_read_b64_tr_b16 a[80:81], v5 offset:64
    v_mfma_f32_16x16x32_bf16 v[132:135], a[188:191], a[64:67], v[132:135]
    buffer_load_dwordx4 v7, s[12:15], s46 offen offset:0 lds
    ds_read_b64_tr_b16 a[82:83], v5 offset:832
    v_mfma_f32_16x16x32_bf16 v[136:139], a[188:191], a[68:71], v[136:139]
    ds_read_b64_tr_b16 a[84:85], v4 offset:6208
    v_mfma_f32_16x16x32_bf16 v[116:119], a[192:195], a[0:3], 0
    ds_read_b64_tr_b16 a[86:87], v4 offset:6976
    v_mfma_f32_16x16x32_bf16 v[120:123], a[192:195], a[4:7], 0
    ds_read_b64_tr_b16 a[88:89], v4 offset:6240
    v_mfma_f32_16x16x32_bf16 v[124:127], a[192:195], a[8:11], 0
    ds_read_b64_tr_b16 a[90:91], v4 offset:7008
    ds_read_b64_tr_b16 a[92:93], v5 offset:6272
    v_mfma_f32_16x16x32_bf16 v[116:119], a[196:199], a[12:15], v[116:119]
    v_cvt_pk_bf16_f32 v142, v128, v129
    v_cvt_pk_bf16_f32 v143, v130, v131
    ds_read_b64_tr_b16 a[94:95], v5 offset:7040
    v_mfma_f32_16x16x32_bf16 v[120:123], a[196:199], a[16:19], v[120:123]
    v_cvt_pk_bf16_f32 v146, v132, v133
    v_cvt_pk_bf16_f32 v147, v134, v135
    ds_read_b64_tr_b16 a[96:97], v4 offset:12416
    v_mfma_f32_16x16x32_bf16 v[124:127], a[196:199], a[20:23], v[124:127]
    v_cvt_pk_bf16_f32 v150, v136, v137
    v_cvt_pk_bf16_f32 v151, v138, v139
    s_waitcnt lgkmcnt(7)
    v_mfma_f32_16x16x32_bf16 v[116:119], a[200:203], a[24:27], v[116:119]
    buffer_load_dwordx4 v7, s[12:15], s46 offen offset:1024 lds
    v_mfma_f32_16x16x32_bf16 v[120:123], a[200:203], a[28:31], v[120:123]
    ds_read_b64_tr_b16 a[98:99], v4 offset:13184
    v_mfma_f32_16x16x32_bf16 v[80:83], v[140:143], v[220:223], 0
    ds_read_b64_tr_b16 a[100:101], v4 offset:12448
    ds_read_b64_tr_b16 a[102:103], v4 offset:13216
    v_mfma_f32_16x16x32_bf16 v[84:87], v[144:147], v[220:223], 0
    buffer_load_dwordx4 v7, s[12:15], s46 offen offset:2048 lds
    v_mfma_f32_16x16x32_bf16 v[88:91], v[148:151], v[220:223], 0
    ds_read_b64_tr_b16 a[104:105], v5 offset:12480
    ds_read_b64_tr_b16 a[106:107], v5 offset:13248
    v_mfma_f32_16x16x32_bf16 v[124:127], a[200:203], a[32:35], v[124:127]
    ds_read_b64 v[216:217], v3 offset:19008
    v_mfma_f32_16x16x32_bf16 v[128:131], a[192:195], a[36:39], 0
    ds_read_b64 v[218:219], v3 offset:19536
    v_mfma_f32_16x16x32_bf16 v[132:135], a[192:195], a[40:43], 0
    ds_read_b64_tr_b16 a[108:109], v4 offset:18624
    v_mfma_f32_16x16x32_bf16 v[136:139], a[192:195], a[44:47], 0
    ds_read_b64_tr_b16 a[110:111], v4 offset:19392
    ds_read_b64_tr_b16 a[112:113], v4 offset:18656
    v_mfma_f32_16x16x32_bf16 v[128:131], a[196:199], a[48:51], v[128:131]
    v_cvt_pk_bf16_f32 v140, v116, v117
    v_cvt_pk_bf16_f32 v141, v118, v119
    ds_read_b64_tr_b16 a[114:115], v4 offset:19424
    v_mfma_f32_16x16x32_bf16 v[132:135], a[196:199], a[52:55], v[132:135]
    v_cvt_pk_bf16_f32 v144, v120, v121
    v_cvt_pk_bf16_f32 v145, v122, v123
    v_mfma_f32_16x16x32_bf16 v[136:139], a[196:199], a[56:59], v[136:139]
    v_cvt_pk_bf16_f32 v148, v124, v125
    v_cvt_pk_bf16_f32 v149, v126, v127
    v_mfma_f32_16x16x32_bf16 v[128:131], a[200:203], a[60:63], v[128:131]
    ds_read_b64_tr_b16 a[116:117], v5 offset:18688
    v_mfma_f32_16x16x32_bf16 v[132:135], a[200:203], a[64:67], v[132:135]
    ds_read_b64_tr_b16 a[118:119], v5 offset:19456
    v_mfma_f32_16x16x32_bf16 v[136:139], a[200:203], a[68:71], v[136:139]
    ds_read_b64_tr_b16 a[120:121], v4 offset:24832
    v_mfma_f32_16x16x32_bf16 v[116:119], a[228:231], a[0:3], 0
    ds_read_b64_tr_b16 a[122:123], v4 offset:25600
    v_mfma_f32_16x16x32_bf16 v[120:123], a[228:231], a[4:7], 0
    ds_read_b64_tr_b16 a[124:125], v4 offset:24864
    v_mfma_f32_16x16x32_bf16 v[124:127], a[228:231], a[8:11], 0
    ds_read_b64_tr_b16 a[126:127], v4 offset:25632
    ds_read_b64_tr_b16 a[128:129], v5 offset:24896
    v_mfma_f32_16x16x32_bf16 v[116:119], a[232:235], a[12:15], v[116:119]
    v_cvt_pk_bf16_f32 v142, v128, v129
    v_cvt_pk_bf16_f32 v143, v130, v131
    ds_read_b64_tr_b16 a[130:131], v5 offset:25664
    v_mfma_f32_16x16x32_bf16 v[120:123], a[232:235], a[16:19], v[120:123]
    v_cvt_pk_bf16_f32 v146, v132, v133
    v_cvt_pk_bf16_f32 v147, v134, v135
    v_mfma_f32_16x16x32_bf16 v[124:127], a[232:235], a[20:23], v[124:127]
    v_cvt_pk_bf16_f32 v150, v136, v137
    v_cvt_pk_bf16_f32 v151, v138, v139
    v_mfma_f32_16x16x32_bf16 v[116:119], a[236:239], a[24:27], v[116:119]
    ds_read_b64_tr_b16 a[132:133], v4 offset:31040
    v_mfma_f32_16x16x32_bf16 v[120:123], a[236:239], a[28:31], v[120:123]
    ds_read_b64_tr_b16 a[134:135], v4 offset:31808
    s_waitcnt lgkmcnt(7)
    v_mfma_f32_16x16x32_bf16 v[92:95], v[140:143], v[216:219], 0
    ds_read_b64_tr_b16 a[136:137], v4 offset:31072
    v_mfma_f32_16x16x32_bf16 v[96:99], v[144:147], v[216:219], 0
    ds_read_b64_tr_b16 a[138:139], v4 offset:31840
    v_mfma_f32_16x16x32_bf16 v[100:103], v[148:151], v[216:219], 0
    ds_read_b64_tr_b16 a[140:141], v5 offset:31104
    ds_read_b64_tr_b16 a[142:143], v5 offset:31872
    v_mfma_f32_16x16x32_bf16 v[124:127], a[236:239], a[32:35], v[124:127]
    ds_read_b32 v220, v9 offset:0
    v_add_u32 v4, -37248, v4
    v_mfma_f32_16x16x32_bf16 v[128:131], a[228:231], a[36:39], 0
    ds_read_b32 v221, v10 offset:0
    v_add_u32 v5, -37248, v5
    v_mfma_f32_16x16x32_bf16 v[132:135], a[228:231], a[40:43], 0
    ds_read_b32 v222, v9 offset:528
    ds_read_b128 a[204:207], v1 offset:17280
    v_mfma_f32_16x16x32_bf16 v[136:139], a[228:231], a[44:47], 0
    ds_read_b32 v223, v10 offset:528
    ds_read_b128 a[208:211], v1 offset:17344
    v_mfma_f32_16x16x32_bf16 v[128:131], a[232:235], a[48:51], v[128:131]
    v_cvt_pk_bf16_f32 v140, v116, v117
    v_cvt_pk_bf16_f32 v141, v118, v119
    ds_read_b128 a[212:215], v1 offset:17408
    v_mfma_f32_16x16x32_bf16 v[132:135], a[232:235], a[52:55], v[132:135]
    v_cvt_pk_bf16_f32 v144, v120, v121
    v_cvt_pk_bf16_f32 v145, v122, v123
    v_mfma_f32_16x16x32_bf16 v[136:139], a[232:235], a[56:59], v[136:139]
    v_cvt_pk_bf16_f32 v148, v124, v125
    v_cvt_pk_bf16_f32 v149, v126, v127
    v_mfma_f32_16x16x32_bf16 v[128:131], a[236:239], a[60:63], v[128:131]
    v_mfma_f32_16x16x32_bf16 v[132:135], a[236:239], a[64:67], v[132:135]
    v_mfma_f32_16x16x32_bf16 v[136:139], a[236:239], a[68:71], v[136:139]
    s_waitcnt vmcnt(0)
    s_waitcnt lgkmcnt(0)
    s_barrier
    v_mfma_f32_16x16x32_bf16 v[116:119], a[144:147], a[72:75], 0
    v_mfma_f32_16x16x32_bf16 v[120:123], a[144:147], a[76:79], 0
    v_mfma_f32_16x16x32_bf16 v[124:127], a[144:147], a[80:83], 0
    v_mfma_f32_16x16x32_bf16 v[116:119], a[148:151], a[84:87], v[116:119]
    v_cvt_pk_bf16_f32 v142, v128, v129
    v_cvt_pk_bf16_f32 v143, v130, v131
    v_mfma_f32_16x16x32_bf16 v[120:123], a[148:151], a[88:91], v[120:123]
    v_cvt_pk_bf16_f32 v146, v132, v133
    v_cvt_pk_bf16_f32 v147, v134, v135
    v_mfma_f32_16x16x32_bf16 v[124:127], a[148:151], a[92:95], v[124:127]
    v_cvt_pk_bf16_f32 v150, v136, v137
    v_cvt_pk_bf16_f32 v151, v138, v139
    s_add_u32 m0, s44, 126240
    s_bfe_u32 s46, s24, 0x40018
    s_mul_i32 s46, s46, 18432
    v_mfma_f32_16x16x32_bf16 v[116:119], a[152:155], a[96:99], v[116:119]
    buffer_load_dwordx4 v7, s[12:15], s46 offen offset:0 lds
    v_mfma_f32_16x16x32_bf16 v[120:123], a[152:155], a[100:103], v[120:123]
    v_mfma_f32_16x16x32_bf16 v[104:107], v[220:223], v[140:143], 0
    v_mfma_f32_16x16x32_bf16 v[108:111], v[220:223], v[144:147], 0
    v_mfma_f32_16x16x32_bf16 v[112:115], v[220:223], v[148:151], 0
    buffer_load_dwordx4 v7, s[12:15], s46 offen offset:1024 lds
    v_mfma_f32_16x16x32_bf16 v[124:127], a[152:155], a[104:107], v[124:127]
    ds_read_b64 v[216:217], v3 offset:1056
    v_mfma_f32_16x16x32_bf16 v[128:131], a[156:159], a[108:111], 0
    ds_read_b64 v[218:219], v3 offset:1584
    v_mfma_f32_16x16x32_bf16 v[132:135], a[156:159], a[112:115], 0
    ds_read_b128 a[216:219], v1 offset:20736
    v_mfma_f32_16x16x32_bf16 v[136:139], a[156:159], a[116:119], 0
    ds_read_b128 a[220:223], v1 offset:20800
    v_mfma_f32_16x16x32_bf16 v[128:131], a[160:163], a[120:123], v[128:131]
    v_cvt_pk_bf16_f32 v140, v116, v117
    v_cvt_pk_bf16_f32 v141, v118, v119
    v_mfma_f32_16x16x32_bf16 v[132:135], a[160:163], a[124:127], v[132:135]
    v_cvt_pk_bf16_f32 v144, v120, v121
    v_cvt_pk_bf16_f32 v145, v122, v123
    v_mfma_f32_16x16x32_bf16 v[136:139], a[160:163], a[128:131], v[136:139]
    v_cvt_pk_bf16_f32 v148, v124, v125
    v_cvt_pk_bf16_f32 v149, v126, v127
    v_mfma_f32_16x16x32_bf16 v[128:131], a[164:167], a[132:135], v[128:131]
    buffer_load_dwordx4 v7, s[12:15], s46 offen offset:2048 lds
    v_mfma_f32_16x16x32_bf16 v[132:135], a[164:167], a[136:139], v[132:135]
    ds_read_b128 a[224:227], v1 offset:20864
    v_mfma_f32_16x16x32_bf16 v[136:139], a[164:167], a[140:143], v[136:139]
    ds_read_b128 a[240:243], v2 offset:3456
    v_mfma_f32_16x16x32_bf16 v[116:119], a[156:159], a[72:75], 0
    ds_read_b128 a[244:247], v2 offset:3520
    v_mfma_f32_16x16x32_bf16 v[120:123], a[156:159], a[76:79], 0
    ds_read_b128 a[248:251], v2 offset:3584
    v_mfma_f32_16x16x32_bf16 v[124:127], a[156:159], a[80:83], 0
    ds_read_b128 a[228:231], v2 offset:6912
    v_mfma_f32_16x16x32_bf16 v[116:119], a[160:163], a[84:87], v[116:119]
    v_cvt_pk_bf16_f32 v142, v128, v129
    v_cvt_pk_bf16_f32 v143, v130, v131
    v_mfma_f32_16x16x32_bf16 v[120:123], a[160:163], a[88:91], v[120:123]
    v_cvt_pk_bf16_f32 v146, v132, v133
    v_cvt_pk_bf16_f32 v147, v134, v135
    v_mfma_f32_16x16x32_bf16 v[124:127], a[160:163], a[92:95], v[124:127]
    v_cvt_pk_bf16_f32 v150, v136, v137
    v_cvt_pk_bf16_f32 v151, v138, v139
    s_add_u32 m0, s44, 138656
    s_add_u32 s64, s46, 12288
    s_bfe_u32 s65, s24, 0x4001c
    s_mul_i32 s65, s65, 18432
    s_sub_u32 s46, s65, 6144
    s_cmp_eq_u32 s30, 0
    s_cselect_b32 s46, s64, s46
    v_mfma_f32_16x16x32_bf16 v[116:119], a[164:167], a[96:99], v[116:119]
    buffer_load_dwordx4 v7, s[12:15], s46 offen offset:0 lds
    v_mfma_f32_16x16x32_bf16 v[120:123], a[164:167], a[100:103], v[120:123]
    ds_read_b128 a[232:235], v2 offset:6976
    s_waitcnt lgkmcnt(7)
    v_mfma_f32_16x16x32_bf16 v[44:47], v[140:143], v[216:219], v[44:47]
    ds_read_b128 a[236:239], v2 offset:7040
    v_mfma_f32_16x16x32_bf16 v[48:51], v[144:147], v[216:219], v[48:51]
    v_mov_b32 v14, 163488
    v_mfma_f32_16x16x32_bf16 v[52:55], v[148:151], v[216:219], v[52:55]
    ds_read_b128 v[228:231], v14
    v_mfma_f32_16x16x32_bf16 v[124:127], a[164:167], a[104:107], v[124:127]
    ds_read_b64 v[220:221], v3 offset:5808
    v_mfma_f32_16x16x32_bf16 v[128:131], a[168:171], a[108:111], 0
    ds_read_b64 v[222:223], v3 offset:6336
    v_mfma_f32_16x16x32_bf16 v[132:135], a[168:171], a[112:115], 0
    buffer_load_dwordx4 v7, s[12:15], s46 offen offset:1024 lds
    v_mfma_f32_16x16x32_bf16 v[136:139], a[168:171], a[116:119], 0
    ds_read_b64_tr_b16 a[0:1], v4 offset:0
    ds_read_b64_tr_b16 a[2:3], v4 offset:768
    v_mfma_f32_16x16x32_bf16 v[128:131], a[172:175], a[120:123], v[128:131]
    v_cvt_pk_bf16_f32 v140, v116, v117
    v_cvt_pk_bf16_f32 v141, v118, v119
    ds_read_b64_tr_b16 a[4:5], v4 offset:32
    v_mfma_f32_16x16x32_bf16 v[132:135], a[172:175], a[124:127], v[132:135]
    v_cvt_pk_bf16_f32 v144, v120, v121
    v_cvt_pk_bf16_f32 v145, v122, v123
    v_mfma_f32_16x16x32_bf16 v[136:139], a[172:175], a[128:131], v[136:139]
    v_cvt_pk_bf16_f32 v148, v124, v125
    v_cvt_pk_bf16_f32 v149, v126, v127
    v_mfma_f32_16x16x32_bf16 v[128:131], a[176:179], a[132:135], v[128:131]
    buffer_load_dwordx4 v7, s[12:15], s46 offen offset:2048 lds
    v_mfma_f32_16x16x32_bf16 v[132:135], a[176:179], a[136:139], v[132:135]
    ds_read_b64_tr_b16 a[6:7], v4 offset:800
    v_mfma_f32_16x16x32_bf16 v[136:139], a[176:179], a[140:143], v[136:139]
    ds_read_b64_tr_b16 a[8:9], v5 offset:64
    v_mfma_f32_16x16x32_bf16 v[116:119], a[168:171], a[72:75], 0
    ds_read_b64_tr_b16 a[10:11], v5 offset:832
    v_mfma_f32_16x16x32_bf16 v[120:123], a[168:171], a[76:79], 0
    ds_read_b64_tr_b16 a[12:13], v4 offset:6208
    v_mfma_f32_16x16x32_bf16 v[124:127], a[168:171], a[80:83], 0
    ds_read_b64_tr_b16 a[14:15], v4 offset:6976
    v_mfma_f32_16x16x32_bf16 v[116:119], a[172:175], a[84:87], v[116:119]
    v_cvt_pk_bf16_f32 v142, v128, v129
    v_cvt_pk_bf16_f32 v143, v130, v131
    v_mfma_f32_16x16x32_bf16 v[120:123], a[172:175], a[88:91], v[120:123]
    v_cvt_pk_bf16_f32 v146, v132, v133
    v_cvt_pk_bf16_f32 v147, v134, v135
    v_mfma_f32_16x16x32_bf16 v[124:127], a[172:175], a[92:95], v[124:127]
    v_cvt_pk_bf16_f32 v150, v136, v137
    v_cvt_pk_bf16_f32 v151, v138, v139
    s_add_u32 m0, s44, 151072
    s_add_u32 s46, s65, 6144
    v_mfma_f32_16x16x32_bf16 v[116:119], a[176:179], a[96:99], v[116:119]
    buffer_load_dwordx4 v7, s[12:15], s46 offen offset:0 lds
    v_mfma_f32_16x16x32_bf16 v[120:123], a[176:179], a[100:103], v[120:123]
    ds_read_b64_tr_b16 a[16:17], v4 offset:6240
    s_waitcnt lgkmcnt(7)
    v_mfma_f32_16x16x32_bf16 v[56:59], v[140:143], v[220:223], v[56:59]
    ds_read_b64_tr_b16 a[18:19], v4 offset:7008
    v_mfma_f32_16x16x32_bf16 v[60:63], v[144:147], v[220:223], v[60:63]
    ds_read_b64_tr_b16 a[20:21], v5 offset:6272
    v_mfma_f32_16x16x32_bf16 v[64:67], v[148:151], v[220:223], v[64:67]
    ds_read_b64_tr_b16 a[22:23], v5 offset:7040
    v_mfma_f32_16x16x32_bf16 v[124:127], a[176:179], a[104:107], v[124:127]
    ds_read_b64 v[216:217], v3 offset:10560
    v_mfma_f32_16x16x32_bf16 v[128:131], a[180:183], a[108:111], 0
    ds_read_b64 v[218:219], v3 offset:11088
    v_mfma_f32_16x16x32_bf16 v[132:135], a[180:183], a[112:115], 0
    buffer_load_dwordx4 v7, s[12:15], s46 offen offset:1024 lds
    v_mfma_f32_16x16x32_bf16 v[136:139], a[180:183], a[116:119], 0
    ds_read_b64_tr_b16 a[24:25], v4 offset:12416
    ds_read_b64_tr_b16 a[26:27], v4 offset:13184
    v_mfma_f32_16x16x32_bf16 v[128:131], a[184:187], a[120:123], v[128:131]
    v_cvt_pk_bf16_f32 v140, v116, v117
    v_cvt_pk_bf16_f32 v141, v118, v119
    v_mfma_f32_16x16x32_bf16 v[132:135], a[184:187], a[124:127], v[132:135]
    v_cvt_pk_bf16_f32 v144, v120, v121
    v_cvt_pk_bf16_f32 v145, v122, v123
    v_mfma_f32_16x16x32_bf16 v[136:139], a[184:187], a[128:131], v[136:139]
    v_cvt_pk_bf16_f32 v148, v124, v125
    v_cvt_pk_bf16_f32 v149, v126, v127
    v_mfma_f32_16x16x32_bf16 v[128:131], a[188:191], a[132:135], v[128:131]
    ds_read_b64_tr_b16 a[28:29], v4 offset:12448
    v_mfma_f32_16x16x32_bf16 v[132:135], a[188:191], a[136:139], v[132:135]
    buffer_load_dwordx4 v7, s[12:15], s46 offen offset:2048 lds
    v_mfma_f32_16x16x32_bf16 v[136:139], a[188:191], a[140:143], v[136:139]
    ds_read_b64_tr_b16 a[30:31], v4 offset:13216
    v_mfma_f32_16x16x32_bf16 v[116:119], a[180:183], a[72:75], 0
    ds_read_b64_tr_b16 a[32:33], v5 offset:12480
    v_mfma_f32_16x16x32_bf16 v[120:123], a[180:183], a[76:79], 0
    ds_read_b64_tr_b16 a[34:35], v5 offset:13248
    v_mfma_f32_16x16x32_bf16 v[124:127], a[180:183], a[80:83], 0
    ds_read_b64_tr_b16 a[36:37], v4 offset:18624
    v_mfma_f32_16x16x32_bf16 v[116:119], a[184:187], a[84:87], v[116:119]
    v_cvt_pk_bf16_f32 v142, v128, v129
    v_cvt_pk_bf16_f32 v143, v130, v131
    v_mfma_f32_16x16x32_bf16 v[120:123], a[184:187], a[88:91], v[120:123]
    v_cvt_pk_bf16_f32 v146, v132, v133
    v_cvt_pk_bf16_f32 v147, v134, v135
    v_mfma_f32_16x16x32_bf16 v[124:127], a[184:187], a[92:95], v[124:127]
    v_cvt_pk_bf16_f32 v150, v136, v137
    v_cvt_pk_bf16_f32 v151, v138, v139
    v_mfma_f32_16x16x32_bf16 v[116:119], a[188:191], a[96:99], v[116:119]
    ds_read_b64_tr_b16 a[38:39], v4 offset:19392
    v_mfma_f32_16x16x32_bf16 v[120:123], a[188:191], a[100:103], v[120:123]
    ds_read_b64_tr_b16 a[40:41], v4 offset:18656
    s_waitcnt lgkmcnt(7)
    v_mfma_f32_16x16x32_bf16 v[68:71], v[140:143], v[216:219], v[68:71]
    ds_read_b64_tr_b16 a[42:43], v4 offset:19424
    v_mfma_f32_16x16x32_bf16 v[72:75], v[144:147], v[216:219], v[72:75]
    ds_read_b64_tr_b16 a[44:45], v5 offset:18688
    v_mfma_f32_16x16x32_bf16 v[76:79], v[148:151], v[216:219], v[76:79]
    ds_read_b64_tr_b16 a[46:47], v5 offset:19456
    v_mfma_f32_16x16x32_bf16 v[124:127], a[188:191], a[104:107], v[124:127]
    ds_read_b64 v[220:221], v3 offset:15312
    v_mfma_f32_16x16x32_bf16 v[128:131], a[192:195], a[108:111], 0
    ds_read_b64 v[222:223], v3 offset:15840
    v_mfma_f32_16x16x32_bf16 v[132:135], a[192:195], a[112:115], 0
    ds_read_b64_tr_b16 a[48:49], v4 offset:24832
    v_mfma_f32_16x16x32_bf16 v[136:139], a[192:195], a[116:119], 0
    ds_read_b64_tr_b16 a[50:51], v4 offset:25600
    v_mfma_f32_16x16x32_bf16 v[128:131], a[196:199], a[120:123], v[128:131]
    v_cvt_pk_bf16_f32 v140, v116, v117
    v_cvt_pk_bf16_f32 v141, v118, v119
    v_mfma_f32_16x16x32_bf16 v[132:135], a[196:199], a[124:127], v[132:135]
    v_cvt_pk_bf16_f32 v144, v120, v121
    v_cvt_pk_bf16_f32 v145, v122, v123
    v_mfma_f32_16x16x32_bf16 v[136:139], a[196:199], a[128:131], v[136:139]
    v_cvt_pk_bf16_f32 v148, v124, v125
    v_cvt_pk_bf16_f32 v149, v126, v127
    v_mfma_f32_16x16x32_bf16 v[128:131], a[200:203], a[132:135], v[128:131]
    ds_read_b64_tr_b16 a[52:53], v4 offset:24864
    v_mfma_f32_16x16x32_bf16 v[132:135], a[200:203], a[136:139], v[132:135]
    ds_read_b64_tr_b16 a[54:55], v4 offset:25632
    v_mfma_f32_16x16x32_bf16 v[136:139], a[200:203], a[140:143], v[136:139]
    ds_read_b64_tr_b16 a[56:57], v5 offset:24896
    v_mfma_f32_16x16x32_bf16 v[116:119], a[192:195], a[72:75], 0
    ds_read_b64_tr_b16 a[58:59], v5 offset:25664
    v_mfma_f32_16x16x32_bf16 v[120:123], a[192:195], a[76:79], 0
    v_mfma_f32_16x16x32_bf16 v[124:127], a[192:195], a[80:83], 0
    ds_read_b64_tr_b16 a[60:61], v4 offset:31040
    v_mfma_f32_16x16x32_bf16 v[116:119], a[196:199], a[84:87], v[116:119]
    v_cvt_pk_bf16_f32 v142, v128, v129
    v_cvt_pk_bf16_f32 v143, v130, v131
    v_mfma_f32_16x16x32_bf16 v[120:123], a[196:199], a[88:91], v[120:123]
    v_cvt_pk_bf16_f32 v146, v132, v133
    v_cvt_pk_bf16_f32 v147, v134, v135
    v_mfma_f32_16x16x32_bf16 v[124:127], a[196:199], a[92:95], v[124:127]
    v_cvt_pk_bf16_f32 v150, v136, v137
    v_cvt_pk_bf16_f32 v151, v138, v139
    v_mfma_f32_16x16x32_bf16 v[116:119], a[200:203], a[96:99], v[116:119]
    ds_read_b64_tr_b16 a[62:63], v4 offset:31808
    v_mfma_f32_16x16x32_bf16 v[120:123], a[200:203], a[100:103], v[120:123]
    ds_read_b64_tr_b16 a[64:65], v4 offset:31072
    s_waitcnt lgkmcnt(7)
    v_mfma_f32_16x16x32_bf16 v[80:83], v[140:143], v[220:223], v[80:83]
    ds_read_b64_tr_b16 a[66:67], v4 offset:31840
    v_mfma_f32_16x16x32_bf16 v[84:87], v[144:147], v[220:223], v[84:87]
    ds_read_b64_tr_b16 a[68:69], v5 offset:31104
    v_mfma_f32_16x16x32_bf16 v[88:91], v[148:151], v[220:223], v[88:91]
    v_mfma_f32_16x16x32_bf16 v[124:127], a[200:203], a[104:107], v[124:127]
    ds_read_b64 v[216:217], v3 offset:20064
    v_mfma_f32_16x16x32_bf16 v[128:131], a[204:207], a[108:111], 0
    ds_read_b64 v[218:219], v3 offset:20592
    v_mfma_f32_16x16x32_bf16 v[132:135], a[204:207], a[112:115], 0
    ds_read_b64_tr_b16 a[70:71], v5 offset:31872
    v_mfma_f32_16x16x32_bf16 v[136:139], a[204:207], a[116:119], 0
    v_add_u32 v4, 37248, v4
    v_mfma_f32_16x16x32_bf16 v[128:131], a[208:211], a[120:123], v[128:131]
    v_cvt_pk_bf16_f32 v140, v116, v117
    v_cvt_pk_bf16_f32 v141, v118, v119
    v_add_u32 v5, 37248, v5
    v_mfma_f32_16x16x32_bf16 v[132:135], a[208:211], a[124:127], v[132:135]
    v_cvt_pk_bf16_f32 v144, v120, v121
    v_cvt_pk_bf16_f32 v145, v122, v123
    v_mfma_f32_16x16x32_bf16 v[136:139], a[208:211], a[128:131], v[136:139]
    v_cvt_pk_bf16_f32 v148, v124, v125
    v_cvt_pk_bf16_f32 v149, v126, v127
    v_mfma_f32_16x16x32_bf16 v[128:131], a[212:215], a[132:135], v[128:131]
    v_mfma_f32_16x16x32_bf16 v[132:135], a[212:215], a[136:139], v[132:135]
    v_mfma_f32_16x16x32_bf16 v[136:139], a[212:215], a[140:143], v[136:139]
    s_waitcnt vmcnt(0)
    s_waitcnt lgkmcnt(0)
    s_barrier
    v_mfma_f32_16x16x32_bf16 v[116:119], a[156:159], a[0:3], 0
    ds_read_b64_tr_b16 a[72:73], v4 offset:0
    v_mfma_f32_16x16x32_bf16 v[120:123], a[156:159], a[4:7], 0
    s_add_u32 m0, s44, 88992
    s_bfe_u32 s46, s25, 0x40000
    s_mul_i32 s46, s46, 18432
    v_mfma_f32_16x16x32_bf16 v[124:127], a[156:159], a[8:11], 0
    buffer_load_dwordx4 v7, s[12:15], s46 offen offset:0 lds
    ds_read_b64_tr_b16 a[74:75], v4 offset:768
    v_mfma_f32_16x16x32_bf16 v[116:119], a[160:163], a[12:15], v[116:119]
    v_cvt_pk_bf16_f32 v142, v128, v129
    v_cvt_pk_bf16_f32 v143, v130, v131
    v_mfma_f32_16x16x32_bf16 v[120:123], a[160:163], a[16:19], v[120:123]
    v_cvt_pk_bf16_f32 v146, v132, v133
    v_cvt_pk_bf16_f32 v147, v134, v135
    v_mfma_f32_16x16x32_bf16 v[124:127], a[160:163], a[20:23], v[124:127]
    v_cvt_pk_bf16_f32 v150, v136, v137
    v_cvt_pk_bf16_f32 v151, v138, v139
    v_mfma_f32_16x16x32_bf16 v[116:119], a[164:167], a[24:27], v[116:119]
    ds_read_b64_tr_b16 a[76:77], v4 offset:32
    v_mfma_f32_16x16x32_bf16 v[120:123], a[164:167], a[28:31], v[120:123]
    buffer_load_dwordx4 v7, s[12:15], s46 offen offset:1024 lds
    v_mfma_f32_16x16x32_bf16 v[92:95], v[140:143], v[216:219], v[92:95]
    ds_read_b64_tr_b16 a[78:79], v4 offset:800
    v_mfma_f32_16x16x32_bf16 v[96:99], v[144:147], v[216:219], v[96:99]
    ds_read_b64_tr_b16 a[80:81], v5 offset:64
    v_mfma_f32_16x16x32_bf16 v[100:103], v[148:151], v[216:219], v[100:103]
    ds_read_b64_tr_b16 a[82:83], v5 offset:832
    ds_read_b64_tr_b16 a[84:85], v4 offset:6208
    v_mfma_f32_16x16x32_bf16 v[124:127], a[164:167], a[32:35], v[124:127]
    ds_read_b64 v[220:221], v3 offset:2112
    v_mfma_f32_16x16x32_bf16 v[128:131], a[156:159], a[36:39], 0
    ds_read_b64 v[222:223], v3 offset:2640
    v_mfma_f32_16x16x32_bf16 v[132:135], a[156:159], a[40:43], 0
    buffer_load_dwordx4 v7, s[12:15], s46 offen offset:2048 lds
    v_mfma_f32_16x16x32_bf16 v[136:139], a[156:159], a[44:47], 0
    ds_read_b64_tr_b16 a[86:87], v4 offset:6976
    ds_read_b64_tr_b16 a[88:89], v4 offset:6240
    v_mfma_f32_16x16x32_bf16 v[128:131], a[160:163], a[48:51], v[128:131]
    v_cvt_pk_bf16_f32 v140, v116, v117
    v_cvt_pk_bf16_f32 v141, v118, v119
    ds_read_b64_tr_b16 a[90:91], v4 offset:7008
    v_mfma_f32_16x16x32_bf16 v[132:135], a[160:163], a[52:55], v[132:135]
    v_cvt_pk_bf16_f32 v144, v120, v121
    v_cvt_pk_bf16_f32 v145, v122, v123
    v_mfma_f32_16x16x32_bf16 v[136:139], a[160:163], a[56:59], v[136:139]
    v_cvt_pk_bf16_f32 v148, v124, v125
    v_cvt_pk_bf16_f32 v149, v126, v127
    s_add_u32 m0, s44, 101408
    s_add_u32 s64, s46, 12288
    s_mov_b32 s46, 2130706432
    s_cmp_eq_u32 s30, 0
    s_cselect_b32 s46, s64, s46
    v_mfma_f32_16x16x32_bf16 v[128:131], a[164:167], a[60:63], v[128:131]
    buffer_load_dwordx4 v7, s[12:15], s46 offen offset:0 lds
    v_mfma_f32_16x16x32_bf16 v[132:135], a[164:167], a[64:67], v[132:135]
    ds_read_b64_tr_b16 a[92:93], v5 offset:6272
    v_mfma_f32_16x16x32_bf16 v[136:139], a[164:167], a[68:71], v[136:139]
    ds_read_b64_tr_b16 a[94:95], v5 offset:7040
    v_mfma_f32_16x16x32_bf16 v[116:119], a[168:171], a[0:3], 0
    ds_read_b64_tr_b16 a[96:97], v4 offset:12416
    v_mfma_f32_16x16x32_bf16 v[120:123], a[168:171], a[4:7], 0
    buffer_load_dwordx4 v7, s[12:15], s46 offen offset:1024 lds
    v_mfma_f32_16x16x32_bf16 v[124:127], a[168:171], a[8:11], 0
    ds_read_b64_tr_b16 a[98:99], v4 offset:13184
    ds_read_b64_tr_b16 a[100:101], v4 offset:12448
    v_mfma_f32_16x16x32_bf16 v[116:119], a[172:175], a[12:15], v[116:119]
    v_cvt_pk_bf16_f32 v142, v128, v129
    v_cvt_pk_bf16_f32 v143, v130, v131
    v_mfma_f32_16x16x32_bf16 v[120:123], a[172:175], a[16:19], v[120:123]
    v_cvt_pk_bf16_f32 v146, v132, v133
    v_cvt_pk_bf16_f32 v147, v134, v135
    v_mfma_f32_16x16x32_bf16 v[124:127], a[172:175], a[20:23], v[124:127]
    v_cvt_pk_bf16_f32 v150, v136, v137
    v_cvt_pk_bf16_f32 v151, v138, v139
    v_mfma_f32_16x16x32_bf16 v[116:119], a[176:179], a[24:27], v[116:119]
    buffer_load_dwordx4 v7, s[12:15], s46 offen offset:2048 lds
    v_mfma_f32_16x16x32_bf16 v[120:123], a[176:179], a[28:31], v[120:123]
    ds_read_b64_tr_b16 a[102:103], v4 offset:13216
    s_waitcnt lgkmcnt(7)
    v_mfma_f32_16x16x32_bf16 v[44:47], v[140:143], v[220:223], v[44:47]
    ds_read_b64_tr_b16 a[104:105], v5 offset:12480
    v_mfma_f32_16x16x32_bf16 v[48:51], v[144:147], v[220:223], v[48:51]
    ds_read_b64_tr_b16 a[106:107], v5 offset:13248
    v_mfma_f32_16x16x32_bf16 v[52:55], v[148:151], v[220:223], v[52:55]
    ds_read_b64_tr_b16 a[108:109], v4 offset:18624
    v_mfma_f32_16x16x32_bf16 v[124:127], a[176:179], a[32:35], v[124:127]
    ds_read_b64 v[216:217], v3 offset:6864
    v_mfma_f32_16x16x32_bf16 v[128:131], a[168:171], a[36:39], 0
    ds_read_b64 v[218:219], v3 offset:7392
    v_mfma_f32_16x16x32_bf16 v[132:135], a[168:171], a[40:43], 0
    ds_read_b64_tr_b16 a[110:111], v4 offset:19392
    v_mfma_f32_16x16x32_bf16 v[136:139], a[168:171], a[44:47], 0
    ds_read_b64_tr_b16 a[112:113], v4 offset:18656
    ds_read_b64_tr_b16 a[114:115], v4 offset:19424
    v_mfma_f32_16x16x32_bf16 v[128:131], a[172:175], a[48:51], v[128:131]
    v_cvt_pk_bf16_f32 v140, v116, v117
    v_cvt_pk_bf16_f32 v141, v118, v119
    v_mfma_f32_16x16x32_bf16 v[132:135], a[172:175], a[52:55], v[132:135]
    v_cvt_pk_bf16_f32 v144, v120, v121
    v_cvt_pk_bf16_f32 v145, v122, v123
    v_mfma_f32_16x16x32_bf16 v[136:139], a[172:175], a[56:59], v[136:139]
    v_cvt_pk_bf16_f32 v148, v124, v125
    v_cvt_pk_bf16_f32 v149, v126, v127
    v_mfma_f32_16x16x32_bf16 v[128:131], a[176:179], a[60:63], v[128:131]
    ds_read_b64_tr_b16 a[116:117], v5 offset:18688
    v_mfma_f32_16x16x32_bf16 v[132:135], a[176:179], a[64:67], v[132:135]
    ds_read_b64_tr_b16 a[118:119], v5 offset:19456
    v_mfma_f32_16x16x32_bf16 v[136:139], a[176:179], a[68:71], v[136:139]
    ds_read_b64_tr_b16 a[120:121], v4 offset:24832
    v_mfma_f32_16x16x32_bf16 v[116:119], a[180:183], a[0:3], 0
    ds_read_b64_tr_b16 a[122:123], v4 offset:25600
    v_mfma_f32_16x16x32_bf16 v[120:123], a[180:183], a[4:7], 0
    ds_read_b64_tr_b16 a[124:125], v4 offset:24864
    v_mfma_f32_16x16x32_bf16 v[124:127], a[180:183], a[8:11], 0
    ds_read_b64_tr_b16 a[126:127], v4 offset:25632
    v_mfma_f32_16x16x32_bf16 v[116:119], a[184:187], a[12:15], v[116:119]
    v_cvt_pk_bf16_f32 v142, v128, v129
    v_cvt_pk_bf16_f32 v143, v130, v131
    v_mfma_f32_16x16x32_bf16 v[120:123], a[184:187], a[16:19], v[120:123]
    v_cvt_pk_bf16_f32 v146, v132, v133
    v_cvt_pk_bf16_f32 v147, v134, v135
    v_mfma_f32_16x16x32_bf16 v[124:127], a[184:187], a[20:23], v[124:127]
    v_cvt_pk_bf16_f32 v150, v136, v137
    v_cvt_pk_bf16_f32 v151, v138, v139
    v_mfma_f32_16x16x32_bf16 v[116:119], a[188:191], a[24:27], v[116:119]
    ds_read_b64_tr_b16 a[128:129], v5 offset:24896
    v_mfma_f32_16x16x32_bf16 v[120:123], a[188:191], a[28:31], v[120:123]
    ds_read_b64_tr_b16 a[130:131], v5 offset:25664
    s_waitcnt lgkmcnt(7)
    v_mfma_f32_16x16x32_bf16 v[56:59], v[140:143], v[216:219], v[56:59]
    ds_read_b64_tr_b16 a[132:133], v4 offset:31040
    v_mfma_f32_16x16x32_bf16 v[60:63], v[144:147], v[216:219], v[60:63]
    ds_read_b64_tr_b16 a[134:135], v4 offset:31808
    v_mfma_f32_16x16x32_bf16 v[64:67], v[148:151], v[216:219], v[64:67]
    v_mfma_f32_16x16x32_bf16 v[124:127], a[188:191], a[32:35], v[124:127]
    ds_read_b64 v[220:221], v3 offset:11616
    v_mfma_f32_16x16x32_bf16 v[128:131], a[180:183], a[36:39], 0
    ds_read_b64 v[222:223], v3 offset:12144
    v_mfma_f32_16x16x32_bf16 v[132:135], a[180:183], a[40:43], 0
    ds_read_b64_tr_b16 a[136:137], v4 offset:31072
    v_mfma_f32_16x16x32_bf16 v[136:139], a[180:183], a[44:47], 0
    ds_read_b64_tr_b16 a[138:139], v4 offset:31840
    ds_read_b64_tr_b16 a[140:141], v5 offset:31104
    v_mfma_f32_16x16x32_bf16 v[128:131], a[184:187], a[48:51], v[128:131]
    v_cvt_pk_bf16_f32 v140, v116, v117
    v_cvt_pk_bf16_f32 v141, v118, v119
    v_mfma_f32_16x16x32_bf16 v[132:135], a[184:187], a[52:55], v[132:135]
    v_cvt_pk_bf16_f32 v144, v120, v121
    v_cvt_pk_bf16_f32 v145, v122, v123
    v_mfma_f32_16x16x32_bf16 v[136:139], a[184:187], a[56:59], v[136:139]
    v_cvt_pk_bf16_f32 v148, v124, v125
    v_cvt_pk_bf16_f32 v149, v126, v127
    v_mfma_f32_16x16x32_bf16 v[128:131], a[188:191], a[60:63], v[128:131]
    ds_read_b64_tr_b16 a[142:143], v5 offset:31872
    v_mfma_f32_16x16x32_bf16 v[132:135], a[188:191], a[64:67], v[132:135]
    v_add_u32 v4, -37248, v4
    v_add_u32 v5, -37248, v5
    v_mfma_f32_16x16x32_bf16 v[136:139], a[188:191], a[68:71], v[136:139]
    v_mfma_f32_16x16x32_bf16 v[116:119], a[192:195], a[0:3], 0
    s_waitcnt vmcnt(0)
    s_barrier
    v_mfma_f32_16x16x32_bf16 v[120:123], a[192:195], a[4:7], 0
    ds_read_b64_tr_b16 v[180:181], v4 offset:0
    v_mfma_f32_16x16x32_bf16 v[124:127], a[192:195], a[8:11], 0
    ds_read_b64_tr_b16 v[182:183], v4 offset:768
    v_mfma_f32_16x16x32_bf16 v[116:119], a[196:199], a[12:15], v[116:119]
    v_cvt_pk_bf16_f32 v142, v128, v129
    v_cvt_pk_bf16_f32 v143, v130, v131
    ds_read_b64_tr_b16 v[184:185], v4 offset:32
    v_mfma_f32_16x16x32_bf16 v[120:123], a[196:199], a[16:19], v[120:123]
    v_cvt_pk_bf16_f32 v146, v132, v133
    v_cvt_pk_bf16_f32 v147, v134, v135
    v_mfma_f32_16x16x32_bf16 v[124:127], a[196:199], a[20:23], v[124:127]
    v_cvt_pk_bf16_f32 v150, v136, v137
    v_cvt_pk_bf16_f32 v151, v138, v139
    v_mfma_f32_16x16x32_bf16 v[116:119], a[200:203], a[24:27], v[116:119]
    ds_read_b64_tr_b16 v[186:187], v4 offset:800
    v_mfma_f32_16x16x32_bf16 v[120:123], a[200:203], a[28:31], v[120:123]
    ds_read_b64_tr_b16 v[188:189], v5 offset:64
    s_waitcnt lgkmcnt(7)
    v_mfma_f32_16x16x32_bf16 v[68:71], v[140:143], v[220:223], v[68:71]
    ds_read_b64_tr_b16 v[190:191], v5 offset:832
    v_mfma_f32_16x16x32_bf16 v[72:75], v[144:147], v[220:223], v[72:75]
    ds_read_b64_tr_b16 v[192:193], v4 offset:6208
    v_mfma_f32_16x16x32_bf16 v[76:79], v[148:151], v[220:223], v[76:79]
    ds_read_b64_tr_b16 v[194:195], v4 offset:6976
    v_mfma_f32_16x16x32_bf16 v[124:127], a[200:203], a[32:35], v[124:127]
    ds_read_b64 v[216:217], v3 offset:16368
    v_mfma_f32_16x16x32_bf16 v[128:131], a[192:195], a[36:39], 0
    ds_read_b64 v[218:219], v3 offset:16896
    v_mfma_f32_16x16x32_bf16 v[132:135], a[192:195], a[40:43], 0
    ds_read_b64_tr_b16 v[196:197], v4 offset:6240
    v_mfma_f32_16x16x32_bf16 v[136:139], a[192:195], a[44:47], 0
    ds_read_b64_tr_b16 v[198:199], v4 offset:7008
    ds_read_b64_tr_b16 v[200:201], v5 offset:6272
    v_mfma_f32_16x16x32_bf16 v[128:131], a[196:199], a[48:51], v[128:131]
    v_cvt_pk_bf16_f32 v140, v116, v117
    v_cvt_pk_bf16_f32 v141, v118, v119
    ds_read_b64_tr_b16 v[202:203], v5 offset:7040
    v_mfma_f32_16x16x32_bf16 v[132:135], a[196:199], a[52:55], v[132:135]
    v_cvt_pk_bf16_f32 v144, v120, v121
    v_cvt_pk_bf16_f32 v145, v122, v123
    v_mfma_f32_16x16x32_bf16 v[136:139], a[196:199], a[56:59], v[136:139]
    v_cvt_pk_bf16_f32 v148, v124, v125
    v_cvt_pk_bf16_f32 v149, v126, v127
    v_mfma_f32_16x16x32_bf16 v[128:131], a[200:203], a[60:63], v[128:131]
    ds_read_b64_tr_b16 v[204:205], v4 offset:12416
    v_mfma_f32_16x16x32_bf16 v[132:135], a[200:203], a[64:67], v[132:135]
    ds_read_b64_tr_b16 v[206:207], v4 offset:13184
    v_mfma_f32_16x16x32_bf16 v[136:139], a[200:203], a[68:71], v[136:139]
    ds_read_b64_tr_b16 v[208:209], v4 offset:12448
    v_mfma_f32_16x16x32_bf16 v[116:119], a[204:207], a[0:3], 0
    ds_read_b64_tr_b16 v[210:211], v4 offset:13216
    v_mfma_f32_16x16x32_bf16 v[120:123], a[204:207], a[4:7], 0
    ds_read_b64_tr_b16 v[212:213], v5 offset:12480
    v_mfma_f32_16x16x32_bf16 v[124:127], a[204:207], a[8:11], 0
    ds_read_b64_tr_b16 v[214:215], v5 offset:13248
    s_mul_i32 s47, s28, 1792
    v_mfma_f32_16x16x32_bf16 v[116:119], a[208:211], a[12:15], v[116:119]
    v_cvt_pk_bf16_f32 v142, v128, v129
    v_cvt_pk_bf16_f32 v143, v130, v131
    s_add_u32 s47, s47, 0
    v_mfma_f32_16x16x32_bf16 v[120:123], a[208:211], a[16:19], v[120:123]
    v_cvt_pk_bf16_f32 v146, v132, v133
    v_cvt_pk_bf16_f32 v147, v134, v135
    v_mfma_f32_16x16x32_bf16 v[124:127], a[208:211], a[20:23], v[124:127]
    v_cvt_pk_bf16_f32 v150, v136, v137
    v_cvt_pk_bf16_f32 v151, v138, v139
    v_mfma_f32_16x16x32_bf16 v[116:119], a[212:215], a[24:27], v[116:119]
    v_lshrrev_b32 v21, 6, v6
    v_and_b32 v22, 48, v6
    v_mfma_f32_16x16x32_bf16 v[120:123], a[212:215], a[28:31], v[120:123]
    v_mul_u32_u24 v17, 112, v21
    s_waitcnt lgkmcnt(7)
    v_mfma_f32_16x16x32_bf16 v[80:83], v[140:143], v[216:219], v[80:83]
    v_mul_u32_u24 v19, s2, v21
    v_mfma_f32_16x16x32_bf16 v[84:87], v[144:147], v[216:219], v[84:87]
    v_lshrrev_b32 v23, 1, v22
    v_mfma_f32_16x16x32_bf16 v[88:91], v[148:151], v[216:219], v[88:91]
    s_lshl_b32 s48, s29, 7
    v_mfma_f32_16x16x32_bf16 v[124:127], a[212:215], a[32:35], v[124:127]
    ds_read_b64 v[220:221], v3 offset:21120
    v_mfma_f32_16x16x32_bf16 v[128:131], a[204:207], a[36:39], 0
    ds_read_b64 v[222:223], v3 offset:21648
    v_mfma_f32_16x16x32_bf16 v[132:135], a[204:207], a[40:43], 0
    s_lshl_b32 s49, s29, 5
    s_add_u32 s49, s49, 64
    v_mfma_f32_16x16x32_bf16 v[136:139], a[204:207], a[44:47], 0
    v_add3_u32 v20, v19, s49, v23
    v_mfma_f32_16x16x32_bf16 v[128:131], a[208:211], a[48:51], v[128:131]
    v_cvt_pk_bf16_f32 v140, v116, v117
    v_cvt_pk_bf16_f32 v141, v118, v119
    v_add3_u32 v19, v19, s48, v22
    v_mfma_f32_16x16x32_bf16 v[132:135], a[208:211], a[52:55], v[132:135]
    v_cvt_pk_bf16_f32 v144, v120, v121
    v_cvt_pk_bf16_f32 v145, v122, v123
    v_mfma_f32_16x16x32_bf16 v[136:139], a[208:211], a[56:59], v[136:139]
    v_cvt_pk_bf16_f32 v148, v124, v125
    v_cvt_pk_bf16_f32 v149, v126, v127
    v_mfma_f32_16x16x32_bf16 v[128:131], a[212:215], a[60:63], v[128:131]
    s_add_u32 s48, s47, 64
    v_add3_u32 v18, v17, s48, v23
    v_mfma_f32_16x16x32_bf16 v[132:135], a[212:215], a[64:67], v[132:135]
    v_add3_u32 v17, v17, s47, v22
    v_mfma_f32_16x16x32_bf16 v[136:139], a[212:215], a[68:71], v[136:139]
    v_bfe_u32 v21, v6, 4, 4
    v_mfma_f32_16x16x32_bf16 v[116:119], a[240:243], a[0:3], 0
    v_lshrrev_b32 v22, 8, v6
    v_mfma_f32_16x16x32_bf16 v[120:123], a[240:243], a[4:7], 0
    v_mul_u32_u24 v21, 112, v21
    v_mfma_f32_16x16x32_bf16 v[124:127], a[240:243], a[8:11], 0
    v_mfma_f32_16x16x32_bf16 v[116:119], a[244:247], a[12:15], v[116:119]
    v_cvt_pk_bf16_f32 v142, v128, v129
    v_cvt_pk_bf16_f32 v143, v130, v131
    v_lshlrev_b32 v22, 3, v22
    v_mfma_f32_16x16x32_bf16 v[120:123], a[244:247], a[16:19], v[120:123]
    v_cvt_pk_bf16_f32 v146, v132, v133
    v_cvt_pk_bf16_f32 v147, v134, v135
    v_mfma_f32_16x16x32_bf16 v[124:127], a[244:247], a[20:23], v[124:127]
    v_cvt_pk_bf16_f32 v150, v136, v137
    v_cvt_pk_bf16_f32 v151, v138, v139
    v_mfma_f32_16x16x32_bf16 v[116:119], a[248:251], a[24:27], v[116:119]
    v_add3_u32 v16, v21, s47, v22
    v_or3_b32 v228, v228, v229, v230
    v_mfma_f32_16x16x32_bf16 v[120:123], a[248:251], a[28:31], v[120:123]
    v_or_b32 v228, v228, v231
    s_nop 0
    s_waitcnt lgkmcnt(0)
    v_mfma_f32_16x16x32_bf16 v[92:95], v[140:143], v[220:223], v[92:95]
    v_mfma_f32_16x16x32_bf16 v[96:99], v[144:147], v[220:223], v[96:99]
    v_readfirstlane_b32 s54, v228
    v_mfma_f32_16x16x32_bf16 v[100:103], v[148:151], v[220:223], v[100:103]
    v_lshrrev_b32 v12, 8, v6
    v_mfma_f32_16x16x32_bf16 v[124:127], a[248:251], a[32:35], v[124:127]
    ds_read_b32 v216, v9 offset:2112
    v_cmp_eq_u32 s[60:61], 0, v12
    v_mfma_f32_16x16x32_bf16 v[128:131], a[240:243], a[36:39], 0
    ds_read_b32 v217, v10 offset:2112
    v_cmp_eq_u32 s[62:63], 1, v12
    v_mfma_f32_16x16x32_bf16 v[132:135], a[240:243], a[40:43], 0
    ds_read_b32 v218, v9 offset:2640
    v_mfma_f32_16x16x32_bf16 v[136:139], a[240:243], a[44:47], 0
    ds_read_b32 v219, v10 offset:2640
    v_cmp_eq_u32 s[64:65], 2, v12
    v_mfma_f32_16x16x32_bf16 v[128:131], a[244:247], a[48:51], v[128:131]
    v_cvt_pk_bf16_f32 v140, v116, v117
    v_cvt_pk_bf16_f32 v141, v118, v119
    v_cndmask_b32 v172, 0, v167, s[60:61]
    v_mfma_f32_16x16x32_bf16 v[132:135], a[244:247], a[52:55], v[132:135]
    v_cvt_pk_bf16_f32 v144, v120, v121
    v_cvt_pk_bf16_f32 v145, v122, v123
    v_mfma_f32_16x16x32_bf16 v[136:139], a[244:247], a[56:59], v[136:139]
    v_cvt_pk_bf16_f32 v148, v124, v125
    v_cvt_pk_bf16_f32 v149, v126, v127
    v_mfma_f32_16x16x32_bf16 v[128:131], a[248:251], a[60:63], v[128:131]
    v_cndmask_b32 v173, 0, v167, s[62:63]
    v_cndmask_b32 v174, 0, v167, s[64:65]
    v_mfma_f32_16x16x32_bf16 v[132:135], a[248:251], a[64:67], v[132:135]
    v_mfma_f32_16x16x32_bf16 v[136:139], a[248:251], a[68:71], v[136:139]
    v_mfma_f32_16x16x32_bf16 v[116:119], a[228:231], a[72:75], 0
    v_mfma_f32_16x16x32_bf16 v[120:123], a[228:231], a[76:79], 0
    v_mfma_f32_16x16x32_bf16 v[124:127], a[228:231], a[80:83], 0
    v_mfma_f32_16x16x32_bf16 v[116:119], a[232:235], a[84:87], v[116:119]
    v_cvt_pk_bf16_f32 v142, v128, v129
    v_cvt_pk_bf16_f32 v143, v130, v131
    v_mfma_f32_16x16x32_bf16 v[120:123], a[232:235], a[88:91], v[120:123]
    v_cvt_pk_bf16_f32 v146, v132, v133
    v_cvt_pk_bf16_f32 v147, v134, v135
    v_mfma_f32_16x16x32_bf16 v[124:127], a[232:235], a[92:95], v[124:127]
    v_cvt_pk_bf16_f32 v150, v136, v137
    v_cvt_pk_bf16_f32 v151, v138, v139
    v_mfma_f32_16x16x32_bf16 v[116:119], a[236:239], a[96:99], v[116:119]
    v_mfma_f32_16x16x32_bf16 v[120:123], a[236:239], a[100:103], v[120:123]
    s_waitcnt lgkmcnt(0)
    v_mfma_f32_16x16x32_bf16 v[104:107], v[216:219], v[140:143], v[104:107]
    v_mfma_f32_16x16x32_bf16 v[108:111], v[216:219], v[144:147], v[108:111]
    v_mfma_f32_16x16x32_bf16 v[112:115], v[216:219], v[148:151], v[112:115]
    v_mfma_f32_16x16x32_bf16 v[124:127], a[236:239], a[104:107], v[124:127]
    ds_read_b32 v220, v9 offset:3168
    v_mfma_f32_16x16x32_bf16 v[128:131], a[228:231], a[108:111], 0
    ds_read_b32 v221, v10 offset:3168
    v_mfma_f32_16x16x32_bf16 v[132:135], a[228:231], a[112:115], 0
    ds_read_b32 v222, v9 offset:3696
    v_mfma_f32_16x16x32_bf16 v[136:139], a[228:231], a[116:119], 0
    ds_read_b32 v223, v10 offset:3696
    v_mfma_f32_16x16x32_bf16 v[128:131], a[232:235], a[120:123], v[128:131]
    v_cvt_pk_bf16_f32 v140, v116, v117
    v_cvt_pk_bf16_f32 v141, v118, v119
    v_mfma_f32_16x16x32_bf16 v[132:135], a[232:235], a[124:127], v[132:135]
    v_cvt_pk_bf16_f32 v144, v120, v121
    v_cvt_pk_bf16_f32 v145, v122, v123
    v_mfma_f32_16x16x32_bf16 v[136:139], a[232:235], a[128:131], v[136:139]
    v_cvt_pk_bf16_f32 v148, v124, v125
    v_cvt_pk_bf16_f32 v149, v126, v127
    v_mfma_f32_16x16x32_bf16 v[128:131], a[236:239], a[132:135], v[128:131]
    v_mfma_f32_16x16x32_bf16 v[132:135], a[236:239], a[136:139], v[132:135]
    v_mfma_f32_16x16x32_bf16 v[136:139], a[236:239], a[140:143], v[136:139]
    v_mfma_f32_16x16x32_bf16 v[116:119], a[168:171], a[72:75], 0
    v_mfma_f32_16x16x32_bf16 v[120:123], a[168:171], a[76:79], 0
    v_mfma_f32_16x16x32_bf16 v[124:127], a[168:171], a[80:83], 0
    v_mfma_f32_16x16x32_bf16 v[116:119], a[172:175], a[84:87], v[116:119]
    s_nop 1
    v_cvt_pk_bf16_f32 v142, v128, v129
    v_cvt_pk_bf16_f32 v143, v130, v131
    v_mfma_f32_16x16x32_bf16 v[120:123], a[172:175], a[88:91], v[120:123]
    v_cvt_pk_bf16_f32 v146, v132, v133
    v_cvt_pk_bf16_f32 v147, v134, v135
    v_mfma_f32_16x16x32_bf16 v[124:127], a[172:175], a[92:95], v[124:127]
    v_cvt_pk_bf16_f32 v150, v136, v137
    v_cvt_pk_bf16_f32 v151, v138, v139
    v_mfma_f32_16x16x32_bf16 v[116:119], a[176:179], a[96:99], v[116:119]
    v_mfma_f32_16x16x32_bf16 v[120:123], a[176:179], a[100:103], v[120:123]
    s_waitcnt lgkmcnt(0)
    v_mfma_f32_16x16x32_bf16 v[104:107], v[220:223], v[140:143], v[104:107]
    v_mfma_f32_16x16x32_bf16 v[108:111], v[220:223], v[144:147], v[108:111]
    v_mfma_f32_16x16x32_bf16 v[112:115], v[220:223], v[148:151], v[112:115]
    v_mfma_f32_16x16x32_bf16 v[124:127], a[176:179], a[104:107], v[124:127]
    ds_read_b64 v[216:217], v3 offset:3168
    v_mfma_f32_16x16x32_bf16 v[128:131], a[168:171], a[108:111], 0
    ds_read_b64 v[218:219], v3 offset:3696
    v_mfma_f32_16x16x32_bf16 v[132:135], a[168:171], a[112:115], 0
    v_mfma_f32_16x16x32_bf16 v[136:139], a[168:171], a[116:119], 0
    v_mfma_f32_16x16x32_bf16 v[128:131], a[172:175], a[120:123], v[128:131]
    v_cvt_pk_bf16_f32 v140, v116, v117
    v_cvt_pk_bf16_f32 v141, v118, v119
    v_mfma_f32_16x16x32_bf16 v[132:135], a[172:175], a[124:127], v[132:135]
    v_cvt_pk_bf16_f32 v144, v120, v121
    v_cvt_pk_bf16_f32 v145, v122, v123
    v_mfma_f32_16x16x32_bf16 v[136:139], a[172:175], a[128:131], v[136:139]
    v_cvt_pk_bf16_f32 v148, v124, v125
    v_cvt_pk_bf16_f32 v149, v126, v127
    v_mfma_f32_16x16x32_bf16 v[128:131], a[176:179], a[132:135], v[128:131]
    v_cvt_pk_bf16_f32 v154, v104, v105
    v_cvt_pk_bf16_f32 v155, v106, v107
    v_mfma_f32_16x16x32_bf16 v[132:135], a[176:179], a[136:139], v[132:135]
    v_cvt_pk_bf16_f32 v158, v108, v109
    v_cvt_pk_bf16_f32 v159, v110, v111
    v_mfma_f32_16x16x32_bf16 v[136:139], a[176:179], a[140:143], v[136:139]
    v_cvt_pk_bf16_f32 v162, v112, v113
    v_cvt_pk_bf16_f32 v163, v114, v115
    v_mfma_f32_16x16x32_bf16 v[116:119], a[168:171], v[180:183], 0
    ds_read_b64 v[224:225], v3 offset:4224
    v_mfma_f32_16x16x32_bf16 v[120:123], a[168:171], v[184:187], 0
    v_mov_b32 v226, v172
    v_mov_b32 v227, 0
    v_mfma_f32_16x16x32_bf16 v[124:127], a[168:171], v[188:191], 0
    v_mfma_f32_16x16x32_bf16 v[116:119], a[172:175], v[192:195], v[116:119]
    v_cvt_pk_bf16_f32 v142, v128, v129
    v_cvt_pk_bf16_f32 v143, v130, v131
    v_mfma_f32_16x16x32_bf16 v[120:123], a[172:175], v[196:199], v[120:123]
    v_cvt_pk_bf16_f32 v146, v132, v133
    v_cvt_pk_bf16_f32 v147, v134, v135
    v_mfma_f32_16x16x32_bf16 v[124:127], a[172:175], v[200:203], v[124:127]
    v_cvt_pk_bf16_f32 v150, v136, v137
    v_cvt_pk_bf16_f32 v151, v138, v139
    v_mfma_f32_16x16x32_bf16 v[116:119], a[176:179], v[204:207], v[116:119]
    v_mfma_f32_16x16x32_bf16 v[120:123], a[176:179], v[208:211], v[120:123]
    s_waitcnt lgkmcnt(1)
    v_mfma_f32_16x16x32_bf16 v[44:47], v[140:143], v[216:219], v[44:47]
    v_mfma_f32_16x16x32_bf16 v[48:51], v[144:147], v[216:219], v[48:51]
    v_mfma_f32_16x16x32_bf16 v[52:55], v[148:151], v[216:219], v[52:55]
    v_mfma_f32_16x16x32_bf16 v[124:127], a[176:179], v[212:215], v[124:127]
    v_mfma_f32_16x16x32_bf16 v[128:131], a[180:183], a[72:75], 0
    v_mfma_f32_16x16x32_bf16 v[132:135], a[180:183], a[76:79], 0
    v_mfma_f32_16x16x32_bf16 v[136:139], a[180:183], a[80:83], 0
    v_mfma_f32_16x16x32_bf16 v[128:131], a[184:187], a[84:87], v[128:131]
    v_cvt_pk_bf16_f32 v152, v116, v117
    v_cvt_pk_bf16_f32 v153, v118, v119
    v_mfma_f32_16x16x32_bf16 v[132:135], a[184:187], a[88:91], v[132:135]
    v_cvt_pk_bf16_f32 v156, v120, v121
    v_cvt_pk_bf16_f32 v157, v122, v123
    v_mfma_f32_16x16x32_bf16 v[136:139], a[184:187], a[92:95], v[136:139]
    v_cvt_pk_bf16_f32 v160, v124, v125
    v_cvt_pk_bf16_f32 v161, v126, v127
    v_mfma_f32_16x16x32_bf16 v[128:131], a[188:191], a[96:99], v[128:131]
    v_mfma_f32_16x16x32_bf16 v[132:135], a[188:191], a[100:103], v[132:135]
    s_waitcnt lgkmcnt(0)
    v_mfma_f32_16x16x32_bf16 v[44:47], v[152:155], v[224:227], v[44:47]
    v_mfma_f32_16x16x32_bf16 v[48:51], v[156:159], v[224:227], v[48:51]
    v_mfma_f32_16x16x32_bf16 v[52:55], v[160:163], v[224:227], v[52:55]
    v_mfma_f32_16x16x32_bf16 v[136:139], a[188:191], a[104:107], v[136:139]
    ds_read_b64 v[220:221], v3 offset:7920
    v_mfma_f32_16x16x32_bf16 v[116:119], a[180:183], a[108:111], 0
    ds_read_b64 v[222:223], v3 offset:8448
    v_mfma_f32_16x16x32_bf16 v[120:123], a[180:183], a[112:115], 0
    v_mfma_f32_16x16x32_bf16 v[124:127], a[180:183], a[116:119], 0
    v_mfma_f32_16x16x32_bf16 v[116:119], a[184:187], a[120:123], v[116:119]
    v_cvt_pk_bf16_f32 v140, v128, v129
    v_cvt_pk_bf16_f32 v141, v130, v131
    v_mfma_f32_16x16x32_bf16 v[120:123], a[184:187], a[124:127], v[120:123]
    v_cvt_pk_bf16_f32 v144, v132, v133
    v_cvt_pk_bf16_f32 v145, v134, v135
    v_mfma_f32_16x16x32_bf16 v[124:127], a[184:187], a[128:131], v[124:127]
    v_cvt_pk_bf16_f32 v148, v136, v137
    v_cvt_pk_bf16_f32 v149, v138, v139
    v_mfma_f32_16x16x32_bf16 v[116:119], a[188:191], a[132:135], v[116:119]
    v_cvt_pk_bf16_f32 v32, v44, v45
    v_cvt_pk_bf16_f32 v33, v46, v47
    v_mfma_f32_16x16x32_bf16 v[120:123], a[188:191], a[136:139], v[120:123]
    v_cvt_pk_bf16_f32 v34, v48, v49
    v_cvt_pk_bf16_f32 v35, v50, v51
    v_mfma_f32_16x16x32_bf16 v[124:127], a[188:191], a[140:143], v[124:127]
    ds_write_b64 v16, v[32:33] offset:0
    v_mfma_f32_16x16x32_bf16 v[128:131], a[180:183], v[180:183], 0
    ds_read_b64 v[224:225], v3 offset:8976
    v_mfma_f32_16x16x32_bf16 v[132:135], a[180:183], v[184:187], 0
    v_mov_b32 v227, v172
    v_mov_b32 v226, 0
    v_mfma_f32_16x16x32_bf16 v[136:139], a[180:183], v[188:191], 0
    v_cvt_pk_bf16_f32 v36, v52, v53
    v_cvt_pk_bf16_f32 v37, v54, v55
    v_mfma_f32_16x16x32_bf16 v[128:131], a[184:187], v[192:195], v[128:131]
    v_cvt_pk_bf16_f32 v142, v116, v117
    v_cvt_pk_bf16_f32 v143, v118, v119
    v_mfma_f32_16x16x32_bf16 v[132:135], a[184:187], v[196:199], v[132:135]
    v_cvt_pk_bf16_f32 v146, v120, v121
    v_cvt_pk_bf16_f32 v147, v122, v123
    v_mfma_f32_16x16x32_bf16 v[136:139], a[184:187], v[200:203], v[136:139]
    v_cvt_pk_bf16_f32 v150, v124, v125
    v_cvt_pk_bf16_f32 v151, v126, v127
    v_mfma_f32_16x16x32_bf16 v[128:131], a[188:191], v[204:207], v[128:131]
    ds_write_b64 v16, v[34:35] offset:32
    v_mfma_f32_16x16x32_bf16 v[132:135], a[188:191], v[208:211], v[132:135]
    ds_write_b64 v16, v[36:37] offset:64
    s_waitcnt lgkmcnt(4)
    v_mfma_f32_16x16x32_bf16 v[56:59], v[140:143], v[220:223], v[56:59]
    ds_read_b128 v[38:41], v17
    v_mfma_f32_16x16x32_bf16 v[60:63], v[144:147], v[220:223], v[60:63]
    ds_read_b64 v[42:43], v18
    v_mfma_f32_16x16x32_bf16 v[64:67], v[148:151], v[220:223], v[64:67]
    v_mfma_f32_16x16x32_bf16 v[136:139], a[188:191], v[212:215], v[136:139]
    v_mfma_f32_16x16x32_bf16 v[116:119], a[192:195], a[72:75], 0
    v_mfma_f32_16x16x32_bf16 v[120:123], a[192:195], a[76:79], 0
    v_mfma_f32_16x16x32_bf16 v[124:127], a[192:195], a[80:83], 0
    v_mfma_f32_16x16x32_bf16 v[116:119], a[196:199], a[84:87], v[116:119]
    v_cvt_pk_bf16_f32 v152, v128, v129
    v_cvt_pk_bf16_f32 v153, v130, v131
    v_mfma_f32_16x16x32_bf16 v[120:123], a[196:199], a[88:91], v[120:123]
    v_cvt_pk_bf16_f32 v156, v132, v133
    v_cvt_pk_bf16_f32 v157, v134, v135
    v_mfma_f32_16x16x32_bf16 v[124:127], a[196:199], a[92:95], v[124:127]
    v_cvt_pk_bf16_f32 v160, v136, v137
    v_cvt_pk_bf16_f32 v161, v138, v139
    v_mfma_f32_16x16x32_bf16 v[116:119], a[200:203], a[96:99], v[116:119]
    s_waitcnt lgkmcnt(1)
    buffer_store_dwordx4 v[38:41], v19, s[16:19], s31 offen sc1
    v_mfma_f32_16x16x32_bf16 v[120:123], a[200:203], a[100:103], v[120:123]
    v_mfma_f32_16x16x32_bf16 v[56:59], v[152:155], v[224:227], v[56:59]
    v_mfma_f32_16x16x32_bf16 v[60:63], v[156:159], v[224:227], v[60:63]
    v_mfma_f32_16x16x32_bf16 v[64:67], v[160:163], v[224:227], v[64:67]
    s_waitcnt lgkmcnt(0)
    buffer_store_dwordx2 v[42:43], v20, s[16:19], s31 offen sc1
    v_mfma_f32_16x16x32_bf16 v[124:127], a[200:203], a[104:107], v[124:127]
    ds_read_b64 v[216:217], v3 offset:12672
    v_mfma_f32_16x16x32_bf16 v[128:131], a[192:195], a[108:111], 0
    ds_read_b64 v[218:219], v3 offset:13200
    v_mfma_f32_16x16x32_bf16 v[132:135], a[192:195], a[112:115], 0
    s_add_u32 s31, s31, s55
    v_mfma_f32_16x16x32_bf16 v[136:139], a[192:195], a[116:119], 0
    v_mfma_f32_16x16x32_bf16 v[128:131], a[196:199], a[120:123], v[128:131]
    v_cvt_pk_bf16_f32 v140, v116, v117
    v_cvt_pk_bf16_f32 v141, v118, v119
    v_mfma_f32_16x16x32_bf16 v[132:135], a[196:199], a[124:127], v[132:135]
    v_cvt_pk_bf16_f32 v144, v120, v121
    v_cvt_pk_bf16_f32 v145, v122, v123
    v_mfma_f32_16x16x32_bf16 v[136:139], a[196:199], a[128:131], v[136:139]
    v_cvt_pk_bf16_f32 v148, v124, v125
    v_cvt_pk_bf16_f32 v149, v126, v127
    v_mfma_f32_16x16x32_bf16 v[128:131], a[200:203], a[132:135], v[128:131]
    v_cvt_pk_bf16_f32 v32, v56, v57
    v_cvt_pk_bf16_f32 v33, v58, v59
    v_mfma_f32_16x16x32_bf16 v[132:135], a[200:203], a[136:139], v[132:135]
    v_cvt_pk_bf16_f32 v34, v60, v61
    v_cvt_pk_bf16_f32 v35, v62, v63
    v_mfma_f32_16x16x32_bf16 v[136:139], a[200:203], a[140:143], v[136:139]
    ds_write_b64 v16, v[32:33] offset:0
    v_mfma_f32_16x16x32_bf16 v[116:119], a[192:195], v[180:183], 0
    ds_read_b64 v[224:225], v3 offset:13728
    v_mfma_f32_16x16x32_bf16 v[120:123], a[192:195], v[184:187], 0
    v_mov_b32 v226, v173
    v_mov_b32 v227, 0
    v_mfma_f32_16x16x32_bf16 v[124:127], a[192:195], v[188:191], 0
    v_cvt_pk_bf16_f32 v36, v64, v65
    v_cvt_pk_bf16_f32 v37, v66, v67
    v_mfma_f32_16x16x32_bf16 v[116:119], a[196:199], v[192:195], v[116:119]
    v_cvt_pk_bf16_f32 v142, v128, v129
    v_cvt_pk_bf16_f32 v143, v130, v131
    v_mfma_f32_16x16x32_bf16 v[120:123], a[196:199], v[196:199], v[120:123]
    v_cvt_pk_bf16_f32 v146, v132, v133
    v_cvt_pk_bf16_f32 v147, v134, v135
    v_mfma_f32_16x16x32_bf16 v[124:127], a[196:199], v[200:203], v[124:127]
    v_cvt_pk_bf16_f32 v150, v136, v137
    v_cvt_pk_bf16_f32 v151, v138, v139
    v_mfma_f32_16x16x32_bf16 v[116:119], a[200:203], v[204:207], v[116:119]
    ds_write_b64 v16, v[34:35] offset:32
    v_mfma_f32_16x16x32_bf16 v[120:123], a[200:203], v[208:211], v[120:123]
    ds_write_b64 v16, v[36:37] offset:64
    s_waitcnt lgkmcnt(4)
    v_mfma_f32_16x16x32_bf16 v[68:71], v[140:143], v[216:219], v[68:71]
    ds_read_b128 v[38:41], v17
    v_mfma_f32_16x16x32_bf16 v[72:75], v[144:147], v[216:219], v[72:75]
    ds_read_b64 v[42:43], v18
    v_mfma_f32_16x16x32_bf16 v[76:79], v[148:151], v[216:219], v[76:79]
    v_mfma_f32_16x16x32_bf16 v[124:127], a[200:203], v[212:215], v[124:127]
    v_mfma_f32_16x16x32_bf16 v[128:131], a[204:207], a[72:75], 0
    v_mfma_f32_16x16x32_bf16 v[132:135], a[204:207], a[76:79], 0
    v_mfma_f32_16x16x32_bf16 v[136:139], a[204:207], a[80:83], 0
    v_mfma_f32_16x16x32_bf16 v[128:131], a[208:211], a[84:87], v[128:131]
    v_cvt_pk_bf16_f32 v152, v116, v117
    v_cvt_pk_bf16_f32 v153, v118, v119
    v_mfma_f32_16x16x32_bf16 v[132:135], a[208:211], a[88:91], v[132:135]
    v_cvt_pk_bf16_f32 v156, v120, v121
    v_cvt_pk_bf16_f32 v157, v122, v123
    v_mfma_f32_16x16x32_bf16 v[136:139], a[208:211], a[92:95], v[136:139]
    v_cvt_pk_bf16_f32 v160, v124, v125
    v_cvt_pk_bf16_f32 v161, v126, v127
    v_mfma_f32_16x16x32_bf16 v[128:131], a[212:215], a[96:99], v[128:131]
    s_waitcnt lgkmcnt(1)
    buffer_store_dwordx4 v[38:41], v19, s[16:19], s31 offen sc1
    v_mfma_f32_16x16x32_bf16 v[132:135], a[212:215], a[100:103], v[132:135]
    v_mfma_f32_16x16x32_bf16 v[68:71], v[152:155], v[224:227], v[68:71]
    v_mfma_f32_16x16x32_bf16 v[72:75], v[156:159], v[224:227], v[72:75]
    v_mfma_f32_16x16x32_bf16 v[76:79], v[160:163], v[224:227], v[76:79]
    s_waitcnt lgkmcnt(0)
    buffer_store_dwordx2 v[42:43], v20, s[16:19], s31 offen sc1
    v_mfma_f32_16x16x32_bf16 v[136:139], a[212:215], a[104:107], v[136:139]
    ds_read_b64 v[220:221], v3 offset:17424
    v_mfma_f32_16x16x32_bf16 v[116:119], a[204:207], a[108:111], 0
    ds_read_b64 v[222:223], v3 offset:17952
    v_mfma_f32_16x16x32_bf16 v[120:123], a[204:207], a[112:115], 0
    s_add_u32 s31, s31, s55
    v_mfma_f32_16x16x32_bf16 v[124:127], a[204:207], a[116:119], 0
    v_mfma_f32_16x16x32_bf16 v[116:119], a[208:211], a[120:123], v[116:119]
    v_cvt_pk_bf16_f32 v140, v128, v129
    v_cvt_pk_bf16_f32 v141, v130, v131
    v_mfma_f32_16x16x32_bf16 v[120:123], a[208:211], a[124:127], v[120:123]
    v_cvt_pk_bf16_f32 v144, v132, v133
    v_cvt_pk_bf16_f32 v145, v134, v135
    v_mfma_f32_16x16x32_bf16 v[124:127], a[208:211], a[128:131], v[124:127]
    v_cvt_pk_bf16_f32 v148, v136, v137
    v_cvt_pk_bf16_f32 v149, v138, v139
    v_mfma_f32_16x16x32_bf16 v[116:119], a[212:215], a[132:135], v[116:119]
    v_cvt_pk_bf16_f32 v32, v68, v69
    v_cvt_pk_bf16_f32 v33, v70, v71
    v_mfma_f32_16x16x32_bf16 v[120:123], a[212:215], a[136:139], v[120:123]
    v_cvt_pk_bf16_f32 v34, v72, v73
    v_cvt_pk_bf16_f32 v35, v74, v75
    v_mfma_f32_16x16x32_bf16 v[124:127], a[212:215], a[140:143], v[124:127]
    ds_write_b64 v16, v[32:33] offset:0
    v_mfma_f32_16x16x32_bf16 v[128:131], a[204:207], v[180:183], 0
    ds_read_b64 v[224:225], v3 offset:18480
    v_mfma_f32_16x16x32_bf16 v[132:135], a[204:207], v[184:187], 0
    v_mov_b32 v227, v173
    v_mov_b32 v226, 0
    v_mfma_f32_16x16x32_bf16 v[136:139], a[204:207], v[188:191], 0
    v_cvt_pk_bf16_f32 v36, v76, v77
    v_cvt_pk_bf16_f32 v37, v78, v79
    v_mfma_f32_16x16x32_bf16 v[128:131], a[208:211], v[192:195], v[128:131]
    v_cvt_pk_bf16_f32 v142, v116, v117
    v_cvt_pk_bf16_f32 v143, v118, v119
    v_mfma_f32_16x16x32_bf16 v[132:135], a[208:211], v[196:199], v[132:135]
    v_cvt_pk_bf16_f32 v146, v120, v121
    v_cvt_pk_bf16_f32 v147, v122, v123
    v_mfma_f32_16x16x32_bf16 v[136:139], a[208:211], v[200:203], v[136:139]
    v_cvt_pk_bf16_f32 v150, v124, v125
    v_cvt_pk_bf16_f32 v151, v126, v127
    v_mfma_f32_16x16x32_bf16 v[128:131], a[212:215], v[204:207], v[128:131]
    ds_write_b64 v16, v[34:35] offset:32
    v_mfma_f32_16x16x32_bf16 v[132:135], a[212:215], v[208:211], v[132:135]
    ds_write_b64 v16, v[36:37] offset:64
    s_waitcnt lgkmcnt(4)
    v_mfma_f32_16x16x32_bf16 v[80:83], v[140:143], v[220:223], v[80:83]
    ds_read_b128 v[38:41], v17
    v_mfma_f32_16x16x32_bf16 v[84:87], v[144:147], v[220:223], v[84:87]
    ds_read_b64 v[42:43], v18
    v_mfma_f32_16x16x32_bf16 v[88:91], v[148:151], v[220:223], v[88:91]
    v_mfma_f32_16x16x32_bf16 v[136:139], a[212:215], v[212:215], v[136:139]
    v_mfma_f32_16x16x32_bf16 v[116:119], a[216:219], a[72:75], 0
    v_mfma_f32_16x16x32_bf16 v[120:123], a[216:219], a[76:79], 0
    v_mfma_f32_16x16x32_bf16 v[124:127], a[216:219], a[80:83], 0
    v_mfma_f32_16x16x32_bf16 v[116:119], a[220:223], a[84:87], v[116:119]
    v_cvt_pk_bf16_f32 v152, v128, v129
    v_cvt_pk_bf16_f32 v153, v130, v131
    v_mfma_f32_16x16x32_bf16 v[120:123], a[220:223], a[88:91], v[120:123]
    v_cvt_pk_bf16_f32 v156, v132, v133
    v_cvt_pk_bf16_f32 v157, v134, v135
    v_mfma_f32_16x16x32_bf16 v[124:127], a[220:223], a[92:95], v[124:127]
    v_cvt_pk_bf16_f32 v160, v136, v137
    v_cvt_pk_bf16_f32 v161, v138, v139
    v_mfma_f32_16x16x32_bf16 v[116:119], a[224:227], a[96:99], v[116:119]
    s_waitcnt lgkmcnt(1)
    buffer_store_dwordx4 v[38:41], v19, s[16:19], s31 offen sc1
    v_mfma_f32_16x16x32_bf16 v[120:123], a[224:227], a[100:103], v[120:123]
    v_mfma_f32_16x16x32_bf16 v[80:83], v[152:155], v[224:227], v[80:83]
    v_mfma_f32_16x16x32_bf16 v[84:87], v[156:159], v[224:227], v[84:87]
    v_mfma_f32_16x16x32_bf16 v[88:91], v[160:163], v[224:227], v[88:91]
    s_waitcnt lgkmcnt(0)
    buffer_store_dwordx2 v[42:43], v20, s[16:19], s31 offen sc1
    v_mfma_f32_16x16x32_bf16 v[124:127], a[224:227], a[104:107], v[124:127]
    ds_read_b64 v[216:217], v3 offset:22176
    v_mfma_f32_16x16x32_bf16 v[128:131], a[216:219], a[108:111], 0
    ds_read_b64 v[218:219], v3 offset:22704
    v_mfma_f32_16x16x32_bf16 v[132:135], a[216:219], a[112:115], 0
    s_add_u32 s31, s31, s55
    v_mfma_f32_16x16x32_bf16 v[136:139], a[216:219], a[116:119], 0
    v_mfma_f32_16x16x32_bf16 v[128:131], a[220:223], a[120:123], v[128:131]
    v_cvt_pk_bf16_f32 v140, v116, v117
    v_cvt_pk_bf16_f32 v141, v118, v119
    v_mfma_f32_16x16x32_bf16 v[132:135], a[220:223], a[124:127], v[132:135]
    v_cvt_pk_bf16_f32 v144, v120, v121
    v_cvt_pk_bf16_f32 v145, v122, v123
    v_mfma_f32_16x16x32_bf16 v[136:139], a[220:223], a[128:131], v[136:139]
    v_cvt_pk_bf16_f32 v148, v124, v125
    v_cvt_pk_bf16_f32 v149, v126, v127
    v_mfma_f32_16x16x32_bf16 v[128:131], a[224:227], a[132:135], v[128:131]
    v_cvt_pk_bf16_f32 v32, v80, v81
    v_cvt_pk_bf16_f32 v33, v82, v83
    v_mfma_f32_16x16x32_bf16 v[132:135], a[224:227], a[136:139], v[132:135]
    v_cvt_pk_bf16_f32 v34, v84, v85
    v_cvt_pk_bf16_f32 v35, v86, v87
    v_mfma_f32_16x16x32_bf16 v[136:139], a[224:227], a[140:143], v[136:139]
    ds_write_b64 v16, v[32:33] offset:0
    v_mfma_f32_16x16x32_bf16 v[116:119], a[216:219], v[180:183], 0
    ds_read_b64 v[224:225], v3 offset:23232
    v_mfma_f32_16x16x32_bf16 v[120:123], a[216:219], v[184:187], 0
    v_mov_b32 v226, v174
    v_mov_b32 v227, 0
    v_mfma_f32_16x16x32_bf16 v[124:127], a[216:219], v[188:191], 0
    v_cvt_pk_bf16_f32 v36, v88, v89
    v_cvt_pk_bf16_f32 v37, v90, v91
    v_mfma_f32_16x16x32_bf16 v[116:119], a[220:223], v[192:195], v[116:119]
    v_cvt_pk_bf16_f32 v142, v128, v129
    v_cvt_pk_bf16_f32 v143, v130, v131
    v_mfma_f32_16x16x32_bf16 v[120:123], a[220:223], v[196:199], v[120:123]
    v_cvt_pk_bf16_f32 v146, v132, v133
    v_cvt_pk_bf16_f32 v147, v134, v135
    v_mfma_f32_16x16x32_bf16 v[124:127], a[220:223], v[200:203], v[124:127]
    v_cvt_pk_bf16_f32 v150, v136, v137
    v_cvt_pk_bf16_f32 v151, v138, v139
    v_mfma_f32_16x16x32_bf16 v[116:119], a[224:227], v[204:207], v[116:119]
    ds_write_b64 v16, v[34:35] offset:32
    v_mfma_f32_16x16x32_bf16 v[120:123], a[224:227], v[208:211], v[120:123]
    ds_write_b64 v16, v[36:37] offset:64
    s_waitcnt lgkmcnt(4)
    v_mfma_f32_16x16x32_bf16 v[92:95], v[140:143], v[216:219], v[92:95]
    ds_read_b128 v[38:41], v17
    v_mfma_f32_16x16x32_bf16 v[96:99], v[144:147], v[216:219], v[96:99]
    ds_read_b64 v[42:43], v18
    v_mfma_f32_16x16x32_bf16 v[100:103], v[148:151], v[216:219], v[100:103]
    s_waitcnt lgkmcnt(1)
    buffer_store_dwordx4 v[38:41], v19, s[16:19], s31 offen sc1
    v_mfma_f32_16x16x32_bf16 v[124:127], a[224:227], v[212:215], v[124:127]
    s_waitcnt lgkmcnt(0)
    buffer_store_dwordx2 v[42:43], v20, s[16:19], s31 offen sc1
    s_add_u32 s31, s31, s55
    v_cvt_pk_bf16_f32 v152, v116, v117
    v_cvt_pk_bf16_f32 v153, v118, v119
    v_cvt_pk_bf16_f32 v156, v120, v121
    v_cvt_pk_bf16_f32 v157, v122, v123
    s_nop 0
    v_cvt_pk_bf16_f32 v160, v124, v125
    v_cvt_pk_bf16_f32 v161, v126, v127
    v_mfma_f32_16x16x32_bf16 v[92:95], v[152:155], v[224:227], v[92:95]
    v_mfma_f32_16x16x32_bf16 v[96:99], v[156:159], v[224:227], v[96:99]
    v_mfma_f32_16x16x32_bf16 v[100:103], v[160:163], v[224:227], v[100:103]
    s_cmp_lg_u32 s54, 0
    s_nop 4
    v_cvt_pk_bf16_f32 v32, v92, v93
    v_cvt_pk_bf16_f32 v33, v94, v95
    v_cvt_pk_bf16_f32 v34, v96, v97
    v_cvt_pk_bf16_f32 v35, v98, v99
    ds_write_b64 v16, v[32:33] offset:0
    v_cvt_pk_bf16_f32 v36, v100, v101
    v_cvt_pk_bf16_f32 v37, v102, v103
    ds_write_b64 v16, v[34:35] offset:32
    ds_write_b64 v16, v[36:37] offset:64
    ds_read_b128 v[38:41], v17
    ds_read_b64 v[42:43], v18
    s_waitcnt lgkmcnt(1)
    buffer_store_dwordx4 v[38:41], v19, s[16:19], s31 offen sc1
    s_waitcnt lgkmcnt(0)
    buffer_store_dwordx2 v[42:43], v20, s[16:19], s31 offen sc1
    s_cbranch_scc0 L_end
L_gS:
    s_barrier
    s_branch L_gW
.p2align 12
L_P:
    v_mov_b32 v34, 163504
    v_mov_b32 v35, 0
    s_cmp_eq_u32 s56, 0
    ds_write_b32 v34, v35
    s_mov_b32 s57, 0x4000002
    s_cselect_b32 s57, 0x40002, s57
    s_cselect_b32 s35, 4.0, 0
    s_cselect_b32 s32, 0, 4.0
    s_cselect_b64 vcc, -1, 0
    s_cselect_b32 s47, 1, 0
    s_mul_i32 s48, s56, 244
    s_movk_i32 s49, 244
    v_mad_u32_u24 v56, v39, s56, v40
    v_mad_u32_u24 v59, v39, s47, v41
    v_cndmask_b32 v104, v40, v41, vcc
    v_add_u32 v56, 1, v56
    v_mul_u32_u24 v59, s49, v59
    v_cndmask_b32 v105, v41, v40, vcc
    v_add_u32 v57, s47, v56
    v_add_u32 v104, v104, v39
    v_add_u32 v58, s47, v57
    v_lshl_or_b32 v24, v105, 8, v104
    v_bfe_u32 v60, v56, 2, 2
    v_bfe_u32 v61, v57, 2, 2
    v_bfe_u32 v62, v58, 2, 2
    v_mad_u32_u24 v56, v56, 12, v60
    v_mad_u32_u24 v57, v57, 12, v61
    v_mad_u32_u24 v58, v58, 12, v62
    v_cvt_f32_u32 v104, v104
    v_cvt_f32_u32 v105, v105
    v_add3_u32 v56, v56, v59, s70
    s_add_u32 s70, s70, s48
    v_add3_u32 v57, v57, v59, s70
    s_add_u32 s70, s70, s48
    v_add3_u32 v58, v58, v59, s70
    s_add_u32 s70, s70, s48
    v_mov_b32 v59, 0x3d00000
    s_mov_b32 s47, 0x10001
    v_add_f32 v104, s68, v104
    v_add_f32 v105, s69, v105
    v_mad_u32_u24 v80, v56, s47, v59
    v_add_u32 v81, 1952, v56
    v_mad_u32_u24 v82, v57, s47, v59
    v_add_u32 v83, 1952, v57
    v_mad_u32_u24 v84, v58, s47, v59
    v_add_u32 v85, 1952, v58
    s_waitcnt vmcnt(11)
    v_lshrrev_b32 v23, 16, v167
    v_and_b32 v25, 0xffff, v167
    v_lshl_add_u32 v23, v40, 4, v23
    v_add_f32 v106, 1.0, v105
    v_lshl_or_b32 v24, v24, 16, v23
    v_add_u32 v23, 103008, v23
    v_add_f32 v107, 2.0, v105
    s_mov_b32 exec_hi, 0xffff
    ds_write_b64 v23, v[80:81] offset:0
    ds_write_b64 v23, v[82:83] offset:256
    ds_write_b64 v23, v[84:85] offset:512
    s_mov_b32 exec_hi, -1
    s_lshl_b32 s42, s56, 4
    s_add_u32 s44, s44, 107616
    s_mul_i32 s45, s30, 3104
    s_lshl_b32 s47, s29, 10
    s_add_u32 s45, s45, s47
    s_add_u32 s45, s45, 120032
    s_mul_i32 s48, s30, 3072
    s_add_u32 s47, s47, s48
    s_add_u32 s47, s47, 12288
    v_add_u32 v26, s47, v6
    s_mul_i32 s47, s30, 2304
    s_add_u32 s47, s47, 103008
    v_lshl_add_u32 v172, v165, 4, s47
    v_add_u32 v173, 16, v164
    v_mov_b32 v174, 0xf400f40
    s_lshl_b32 s48, s29, 7
    s_lshl_b32 s49, s29, 5
    s_add_u32 s47, s48, 107616
    v_add_u32_sdwa v4, s47, v16 dst_sel:DWORD dst_unused:UNUSED_PAD src0_sel:DWORD src1_sel:WORD_0
    s_add_u32 s47, s49, 107616
    v_add_u32_sdwa v5, s47, v16 dst_sel:DWORD dst_unused:UNUSED_PAD src0_sel:DWORD src1_sel:WORD_0
    s_lshl2_add_u32 s47, s28, 163488
    v_mov_b32 v27, s47
    s_mov_b32 s54, 0
    s_lshl_b32 s38, s28, 12
    s_add_u32 s38, s38, 144864
    s_lshl_b32 s47, s30, 2
    s_cselect_b32 s31, s27, s26
    s_lshr_b32 s36, s22, s47
    s_and_b32 s36, s36, 15
    s_mov_b32 s52, 0x435f435f
    s_mov_b32 s46, 0
    s_waitcnt lgkmcnt(0)
    s_barrier
    s_waitcnt vmcnt(8)
    s_cmp_le_u32 s72, 7
    s_cbranch_scc1 L_l1
    s_add_u32 m0, s33, 27328
    s_min_i32 s47, s20, s21
    s_add_u32 s20, s20, s55
    buffer_load_dwordx4 v8, s[4:7], s47 offen lds
L_l1:
    v_lshlrev_b32 v56, 16, v44
    v_lshlrev_b32 v59, 16, v45
    v_lshlrev_b32 v62, 16, v46
    v_and_b32 v57, 0xffff0000, v44
    v_and_b32 v60, 0xffff0000, v45
    v_and_b32 v63, 0xffff0000, v46
    v_cvt_pk_bf16_f32 v58, v104, v105
    v_cvt_pk_bf16_f32 v61, v104, v106
    v_cvt_pk_bf16_f32 v64, v104, v107
    v_add_f32 v56, v56, v104
    v_add_f32 v59, v59, v104
    v_add_f32 v62, v62, v104
    v_add_f32 v57, v57, v105
    v_add_f32 v60, v60, v106
    v_add_f32 v63, v63, v107
    v_pk_max_i16 v58, v58, 0
    v_pk_max_i16 v61, v61, 0
    v_pk_max_i16 v64, v64, 0
    v_cvt_pk_bf16_f32 v56, v56, v57
    v_cvt_pk_bf16_f32 v59, v59, v60
    v_cvt_pk_bf16_f32 v62, v62, v63
    v_pk_max_i16 v56, v56, 0
    v_pk_max_i16 v59, v59, 0
    v_pk_max_i16 v62, v62, 0
    s_cmp_le_u32 s72, 8
    s_cbranch_scc1 L_l2
    s_add_u32 m0, s33, 31232
    s_min_i32 s47, s20, s21
    s_add_u32 s20, s20, s55
    buffer_load_dwordx4 v8, s[4:7], s47 offen lds
L_l2:
    v_cmp_ne_u32 s[58:59], v56, v58
    v_cmp_ne_u32 s[60:61], v59, v61
    v_cmp_ne_u32 s[62:63], v62, v64
    v_add_f32 v104, s35, v104
    v_add_f32 v105, s32, v105
    v_add_f32 v106, s32, v106
    v_add_f32 v107, s32, v107
    v_lshlrev_b32 v56, 16, v48
    v_lshlrev_b32 v59, 16, v49
    v_cndmask_b32 v66, 0, 1, s[58:59]
    v_lshlrev_b32 v62, 16, v50
    v_and_b32 v57, 0xffff0000, v48
    v_and_b32 v60, 0xffff0000, v49
    v_addc_co_u32 v66, vcc, 0, v66, s[60:61]
    v_and_b32 v63, 0xffff0000, v50
    v_cvt_pk_bf16_f32 v58, v104, v105
    v_cvt_pk_bf16_f32 v61, v104, v106
    v_addc_co_u32 v66, vcc, 0, v66, s[62:63]
    v_cvt_pk_bf16_f32 v64, v104, v107
    v_add_f32 v56, v56, v104
    v_add_f32 v59, v59, v104
    v_add_f32 v62, v62, v104
    v_add_f32 v57, v57, v105
    v_add_f32 v60, v60, v106
    s_cmp_le_u32 s72, 9
    s_cbranch_scc1 L_l3
    s_add_u32 m0, s33, 35136
    s_min_i32 s47, s20, s21
    s_add_u32 s20, s20, s55
    buffer_load_dwordx4 v8, s[4:7], s47 offen lds
L_l3:
    v_add_f32 v63, v63, v107
    v_pk_max_i16 v58, v58, 0
    v_pk_max_i16 v61, v61, 0
    v_pk_max_i16 v64, v64, 0
    v_cvt_pk_bf16_f32 v56, v56, v57
    v_cvt_pk_bf16_f32 v59, v59, v60
    v_cvt_pk_bf16_f32 v62, v62, v63
    v_pk_max_i16 v56, v56, 0
    v_pk_max_i16 v59, v59, 0
    v_pk_max_i16 v62, v62, 0
    v_cmp_ne_u32 s[64:65], v56, v58
    v_cmp_ne_u32 s[66:67], v59, v61
    v_cmp_ne_u32 s[76:77], v62, v64
    v_add_f32 v104, s35, v104
    v_add_f32 v105, s32, v105
    v_add_f32 v106, s32, v106
    v_add_f32 v107, s32, v107
    v_lshlrev_b32 v56, 16, v52
    v_lshlrev_b32 v59, 16, v53
    v_addc_co_u32 v66, vcc, 0, v66, s[64:65]
    v_lshlrev_b32 v62, 16, v54
    v_and_b32 v57, 0xffff0000, v52
    v_and_b32 v60, 0xffff0000, v53
    v_addc_co_u32 v66, vcc, 0, v66, s[66:67]
    s_cmp_le_u32 s72, 10
    s_cbranch_scc1 L_l4
    s_add_u32 m0, s33, 39040
    s_min_i32 s47, s20, s21
    s_add_u32 s20, s20, s55
    buffer_load_dwordx4 v8, s[4:7], s47 offen lds
L_l4:
    v_and_b32 v63, 0xffff0000, v54
    v_cvt_pk_bf16_f32 v58, v104, v105
    v_cvt_pk_bf16_f32 v61, v104, v106
    v_addc_co_u32 v66, vcc, 0, v66, s[76:77]
    v_cvt_pk_bf16_f32 v64, v104, v107
    v_add_f32 v56, v56, v104
    v_add_f32 v59, v59, v104
    v_add_f32 v62, v62, v104
    v_add_f32 v57, v57, v105
    v_add_f32 v60, v60, v106
    v_add_f32 v63, v63, v107
    v_pk_max_i16 v58, v58, 0
    v_pk_max_i16 v61, v61, 0
    v_pk_max_i16 v64, v64, 0
    v_cvt_pk_bf16_f32 v56, v56, v57
    v_cvt_pk_bf16_f32 v59, v59, v60
    v_cvt_pk_bf16_f32 v62, v62, v63
    v_pk_max_i16 v56, v56, 0
    v_pk_max_i16 v59, v59, 0
    v_pk_max_i16 v62, v62, 0
    v_cmp_ne_u32 s[78:79], v56, v58
    v_cmp_ne_u32 s[0:1], v59, v61
    v_cmp_ne_u32 s[50:51], v62, v64
    v_addc_co_u32 v66, vcc, 0, v66, s[78:79]
    v_addc_co_u32 v66, vcc, 0, v66, s[0:1]
    v_addc_co_u32 v66, vcc, 0, v66, s[50:51]
    v_mov_b32 v67, v66
    s_add_u32 s49, s38, 2040
    s_nop 0
    v_add_u32_dpp v67, v67, v67 row_shr:1 row_mask:0xf bank_mask:0xf bound_ctrl:0
    v_mov_b32 v69, 163504
    s_nop 0
    v_add_u32_dpp v67, v67, v67 row_shr:2 row_mask:0xf bank_mask:0xf bound_ctrl:0
    v_lshrrev_b32 v82, 4, v6
    s_nop 0
    v_add_u32_dpp v67, v67, v67 row_shr:4 row_mask:0xf bank_mask:0xf bound_ctrl:0
    s_mov_b32 s39, 0
    s_nop 0
    v_add_u32_dpp v67, v67, v67 row_shr:8 row_mask:0xf bank_mask:0xf bound_ctrl:0
    v_mov_b32 v14, 163488
    s_nop 0
    v_add_u32_dpp v67, v67, v67 row_bcast:15 row_mask:0xa bank_mask:0xf
    s_lshr_b32 s35, s24, 4
    s_nop 0
    v_add_u32_dpp v67, v67, v67 row_bcast:31 row_mask:0xc bank_mask:0xf
    s_nop 0
    v_readlane_b32 s37, v67, 63
    v_sub_u32 v67, v67, v66
    v_lshl_add_u32 v68, v67, 3, s49
    s_sub_u32 s32, s37, 1
    v_mov_b32 v78, s37
    s_cmpk_ge_u32 s32, 128
    s_cbranch_scc1 L_Pz
    s_mov_b64 exec, 1
    ds_add_rtn_u32 v78, v69, v78
    s_mov_b64 exec, s[58:59]
    s_cbranch_execz L_Pb00
    v_add_u32 v69, 0x0, v24
    v_add_u32 v68, 8, v68
    ds_write2_b32 v68, v44, v69 offset1:1
L_Pb00:
    s_mov_b64 exec, s[60:61]
    s_cbranch_execz L_Pb01
    v_add_u32 v69, 0x1000100, v24
    v_add_u32 v68, 8, v68
    ds_write2_b32 v68, v45, v69 offset1:1
L_Pb01:
    s_mov_b64 exec, s[62:63]
    s_cbranch_execz L_Pb02
    v_add_u32 v69, 0x2000200, v24
    v_add_u32 v68, 8, v68
    ds_write2_b32 v68, v46, v69 offset1:1
L_Pb02:
    s_mov_b64 exec, -1
    v_add_u32 v24, s57, v24
    s_cmp_le_u32 s72, 11
    s_cbranch_scc1 L_l5
    s_add_u32 m0, s33, 42944
    s_min_i32 s47, s20, s21
    s_add_u32 s20, s20, s55
    buffer_load_dwordx4 v8, s[4:7], s47 offen lds
L_l5:
    s_mov_b64 exec, s[64:65]
    s_cbranch_execz L_Pb10
    v_add_u32 v69, 0x0, v24
    v_add_u32 v68, 8, v68
    ds_write2_b32 v68, v48, v69 offset1:1
L_Pb10:
    s_mov_b64 exec, s[66:67]
    s_cbranch_execz L_Pb11
    v_add_u32 v69, 0x1000100, v24
    v_add_u32 v68, 8, v68
    ds_write2_b32 v68, v49, v69 offset1:1
L_Pb11:
    s_mov_b64 exec, s[76:77]
    s_cbranch_execz L_Pb12
    v_add_u32 v69, 0x2000200, v24
    v_add_u32 v68, 8, v68
    ds_write2_b32 v68, v50, v69 offset1:1
L_Pb12:
    s_mov_b64 exec, -1
    v_add_u32 v24, s57, v24
    s_cmp_le_u32 s72, 12
    s_cbranch_scc1 L_l6
    s_add_u32 m0, s33, 46848
    s_min_i32 s47, s20, s21
    s_add_u32 s20, s20, s55
    buffer_load_dwordx4 v8, s[4:7], s47 offen lds
L_l6:
    s_mov_b64 exec, s[78:79]
    s_cbranch_execz L_Pb20
    v_add_u32 v69, 0x0, v24
    v_add_u32 v68, 8, v68
    ds_write2_b32 v68, v52, v69 offset1:1
L_Pb20:
    s_mov_b64 exec, s[0:1]
    s_cbranch_execz L_Pb21
    v_add_u32 v69, 0x1000100, v24
    v_add_u32 v68, 8, v68
    ds_write2_b32 v68, v53, v69 offset1:1
L_Pb21:
    s_mov_b64 exec, s[50:51]
    s_cbranch_execz L_Pb22
    v_add_u32 v69, 0x2000200, v24
    v_add_u32 v68, 8, v68
    ds_write2_b32 v68, v54, v69 offset1:1
L_Pb22:
    s_mov_b64 exec, -1
    v_min_u32 v85, s32, v82
    v_cmp_ge_u32 s[64:65], s32, v82
    v_lshl_add_u32 v83, v85, 3, s38
    ds_read_b64 v[80:81], v83 offset:2048
    v_add_u32 v82, 64, v82
    s_add_u32 s39, s39, 64
    s_mov_b32 s49, 103008
    s_mov_b32 s50, 0
    s_cmp_le_u32 s72, 13
    s_cbranch_scc1 L_l7
    s_add_u32 m0, s33, 50752
    s_min_i32 s47, s20, s21
    s_add_u32 s20, s20, s55
    buffer_load_dwordx4 v8, s[4:7], s47 offen lds
L_l7:
    s_waitcnt lgkmcnt(0)
    v_readfirstlane_b32 s53, v78
    v_cvt_f32_ubyte2 v86, v81
    v_cvt_f32_ubyte3 v87, v81
    v_add_u32_sdwa v84, s49, v81 dst_sel:DWORD dst_unused:UNUSED_PAD src0_sel:DWORD src1_sel:WORD_0
    v_add_f32 v86, s68, v86
    v_add_f32 v87, s69, v87
    v_mov_b32 v81, s50
    v_lshlrev_b32 v61, 16, v80
    v_and_b32 v62, 0xffff0000, v80
    s_cmp_le_u32 s72, 14
    s_cbranch_scc1 L_l8
    s_add_u32 m0, s33, 54656
    s_min_i32 s47, s20, s21
    s_add_u32 s20, s20, s55
    buffer_load_dwordx4 v8, s[4:7], s47 offen lds
L_l8:
    v_add_f32 v61, v61, v86
    v_add_f32 v62, v62, v87
    v_cvt_pk_bf16_f32 v60, v61, v62
    v_pk_max_i16 v60, v60, 0
    v_pk_min_i16 v60, v60, s52
    v_alignbit_b32 v60, v60, v60, s42
    v_lshlrev_b32 v61, 16, v60
    v_and_b32 v62, 0xffff0000, v60
    v_fract_f32 v63, v61
    v_fract_f32 v64, v62
    s_cmp_le_u32 s72, 15
    s_cbranch_scc1 L_l9
    s_add_u32 m0, s33, 58560
    s_min_i32 s47, s20, s21
    s_add_u32 s20, s20, s55
    buffer_load_dwordx4 v8, s[4:7], s47 offen lds
L_l9:
    v_cvt_u32_f32 v65, v61
    v_cvt_u32_f32 v66, v62
    v_cmp_neq_f32 s[58:59], 0, v64
    v_cmp_neq_f32 s[60:61], 0, v63
    v_sub_f32 v67, 1.0, v63
    v_sub_f32 v68, 1.0, v64
    v_subrev_u32 v65, s71, v65
    v_subrev_u32 v66, s43, v66
    v_cvt_pk_bf16_f32 v61, v67, v68
    v_addc_co_u32 v74, vcc, 0, v66, s[58:59]
    s_add_u32 m0, s44, 0
    s_nop 0
    buffer_load_dwordx4 v7, s[12:15], s46 offen offset:0 lds
    v_addc_co_u32 v73, vcc, 0, v65, s[60:61]
    v_lshlrev_b32 v67, 16, v61
    v_and_b32 v68, 0xffff0000, v61
    v_mul_u32_u24 v75, 976, v65
    v_mul_f32 v69, v67, v68
    v_mul_f32 v70, v67, v64
    v_mul_f32 v71, v63, v68
    v_mul_f32 v72, v63, v64
    v_max_u32 v73, v73, v65
    v_max_u32 v61, v66, v74
    buffer_load_dwordx4 v7, s[12:15], s46 offen offset:1024 lds
    v_mad_u32_u24 v67, v66, 48, v75
    v_mad_u32_u24 v68, v74, 48, v75
    v_and_b32 v66, 12, v66
    v_and_b32 v74, 12, v74
    s_andn2_b64 s[62:63], s[60:61], s[58:59]
    v_add_lshl_u32 v67, v67, v66, 2
    v_add_lshl_u32 v68, v68, v74, 2
    v_cndmask_b32 v70, v71, v70, s[58:59]
    v_cndmask_b32 v62, 0, v174, s[62:63]
    s_and_b64 s[62:63], s[60:61], s[58:59]
    s_and_b64 s[66:67], s[62:63], s[64:65]
    v_cndmask_b32 v71, 0, v71, s[58:59]
    v_mbcnt_lo_u32_b32 v81, s66, v81
    v_cmp_le_u32 s[60:61], s72, v73
    s_bcnt1_i32_b64 s48, s[66:67]
    v_cmp_lt_u32 s[58:59], 19, v61
    v_mbcnt_hi_u32_b32 v81, s67, v81
    v_lshl_or_b32 v58, v68, 16, v67
    s_add_u32 s50, s50, s48
    v_cvt_pk_bf16_f32 v57, v69, v70
    v_sub_u32 v85, v85, v81
    v_cvt_pk_bf16_f32 v59, v71, v72
    v_sub_u32 v81, s32, v81
    v_and_b32 v62, 0xffff0000, v62
    v_cndmask_b32 v85, v85, v81, s[66:67]
    v_cndmask_b32 v61, 0, v174, s[62:63]
    v_lshl_add_u32 v83, v85, 4, s38
    v_add_u32 v56, v58, v62
    v_add_u32 v85, s53, v85
    v_add_u32 v58, v58, v61
    v_bfe_u32 v81, v85, 1, 2
    v_mad_u32_u24 v85, v85, 12, s35
    v_add_u32 v85, v85, v81
    s_mov_b64 exec, s[64:65]
    ds_write_b128 v83, v[56:59]
    ds_write_b16 v84, v85
    s_mov_b64 exec, -1
    s_or_b64 s[58:59], s[58:59], s[60:61]
    s_cbranch_scc1 L_Pfail
    s_add_u32 s47, s53, s37
    s_cmp_gt_u32 s47, s25
    s_cbranch_scc1 L_Pfail
    s_cmp_lt_u32 s39, s37
    s_cbranch_scc1 L_Pr2
L_Ppub:
    v_mov_b32 v12, s54
    s_cmp_eq_u32 s37, 0
    s_mov_b32 s39, 0
    ds_write_b32 v27, v12
    s_cbranch_scc1 L_Pn
    v_add_u32 v12, s39, v25
    v_min_u32 v12, s32, v12
    v_lshl_add_u32 v12, v12, 4, s38
    ds_read_b128 v[28:31], v12
    buffer_load_dwordx4 v7, s[12:15], s46 offen offset:2048 lds
    v_add_u32 v9, s39, v165
    v_min_u32 v9, s32, v9
    s_add_u32 m0, s45, 0
    s_nop 0
    buffer_load_dwordx4 v26, s[12:15], s46 offen offset:0 lds
    v_add_u32 v9, s53, v9
    s_add_u32 s39, s39, 16
    buffer_load_dwordx4 v26, s[12:15], s46 offen offset:1024 lds
    s_add_u32 s46, s46, 18432
    v_bfe_u32 v10, v9, 1, 2
    v_mad_u32_u24 v9, v9, 12, v10
    v_xor_b32_sdwa v9, v166, v9 dst_sel:DWORD dst_unused:UNUSED_PAD src0_sel:WORD_0 src1_sel:DWORD
    v_lshl_add_u32 v9, v9, 4, s24
    s_lshr_b32 s47, s32, 4
    s_waitcnt lgkmcnt(0)
    v_xor_b32_sdwa v0, v28, v164 dst_sel:DWORD dst_unused:UNUSED_PAD src0_sel:WORD_0 src1_sel:DWORD
    v_xor_b32_sdwa v2, v28, v164 dst_sel:DWORD dst_unused:UNUSED_PAD src0_sel:WORD_1 src1_sel:DWORD
    v_xor_b32_sdwa v1, v28, v173 dst_sel:DWORD dst_unused:UNUSED_PAD src0_sel:WORD_0 src1_sel:DWORD
    v_xor_b32_sdwa v3, v28, v173 dst_sel:DWORD dst_unused:UNUSED_PAD src0_sel:WORD_1 src1_sel:DWORD
    v_perm_b32 v32, v29, v29, v168
    v_perm_b32 v33, v29, v29, v169
    v_perm_b32 v34, v29, v29, v170
    v_perm_b32 v35, v29, v29, v171
    s_cmp_lt_u32 s36, 4
    s_addc_u32 s47, s47, s50
    s_cmp_lg_u32 s47, 0
    s_cbranch_scc1 L_Pgl
    s_waitcnt vmcnt(5)
    s_barrier
    ds_read_b64_tr_b16 v[180:181], v0 offset:0
    ds_read_b64_tr_b16 v[182:183], v2 offset:0
    ds_read_b64_tr_b16 v[184:185], v1 offset:0
    ds_read_b64_tr_b16 v[186:187], v3 offset:0
    ds_read_b64_tr_b16 v[188:189], v0 offset:64
    ds_read_b64_tr_b16 v[190:191], v2 offset:64
    ds_read_b64_tr_b16 v[192:193], v1 offset:64
    ds_read_b64_tr_b16 v[194:195], v3 offset:64
    ds_read_b64_tr_b16 v[196:197], v0 offset:128
    ds_read_b64_tr_b16 v[198:199], v2 offset:128
    ds_read_b64_tr_b16 v[200:201], v1 offset:128
    ds_read_b64_tr_b16 v[202:203], v3 offset:128
    ds_read_b128 v[136:139], v172 offset:0
    ds_read_b128 v[144:147], v14
    s_waitcnt lgkmcnt(12)
    v_mfma_f32_16x16x32_bf16 v[56:59], v[180:183], v[32:35], 0
    s_waitcnt lgkmcnt(10)
    v_mfma_f32_16x16x32_bf16 v[60:63], v[184:187], v[32:35], 0
    s_waitcnt lgkmcnt(8)
    v_mfma_f32_16x16x32_bf16 v[64:67], v[188:191], v[32:35], 0
    s_waitcnt lgkmcnt(6)
    v_mfma_f32_16x16x32_bf16 v[68:71], v[192:195], v[32:35], 0
    s_waitcnt lgkmcnt(1)
    v_xor_b32 v136, v136, v166
    v_xor_b32 v137, v137, v166
    v_xor_b32 v138, v138, v166
    v_xor_b32 v139, v139, v166
    v_mfma_f32_16x16x32_bf16 v[72:75], v[196:199], v[32:35], 0
    v_lshlrev_b32_sdwa v116, 4, v136 dst_sel:DWORD dst_unused:UNUSED_PAD src0_sel:DWORD src1_sel:WORD_0
    v_lshlrev_b32_sdwa v117, 4, v138 dst_sel:DWORD dst_unused:UNUSED_PAD src0_sel:DWORD src1_sel:WORD_0
    v_lshlrev_b32_sdwa v118, 4, v136 dst_sel:DWORD dst_unused:UNUSED_PAD src0_sel:DWORD src1_sel:WORD_1
    v_mfma_f32_16x16x32_bf16 v[76:79], v[200:203], v[32:35], 0
    v_lshlrev_b32_sdwa v119, 4, v138 dst_sel:DWORD dst_unused:UNUSED_PAD src0_sel:DWORD src1_sel:WORD_1
    v_lshlrev_b32_sdwa v120, 4, v137 dst_sel:DWORD dst_unused:UNUSED_PAD src0_sel:DWORD src1_sel:WORD_0
    v_lshlrev_b32_sdwa v121, 4, v139 dst_sel:DWORD dst_unused:UNUSED_PAD src0_sel:DWORD src1_sel:WORD_0
    v_cvt_pk_bf16_f32 v80, v56, v57
    v_cvt_pk_bf16_f32 v81, v58, v59
    v_cvt_pk_bf16_f32 v82, v60, v61
    v_cvt_pk_bf16_f32 v83, v62, v63
    v_cvt_pk_bf16_f32 v84, v64, v65
    v_cvt_pk_bf16_f32 v85, v66, v67
    v_cvt_pk_bf16_f32 v86, v68, v69
    v_cvt_pk_bf16_f32 v87, v70, v71
    v_permlane32_swap_b32 v80, v82
    v_permlane32_swap_b32 v81, v83
    ds_write_b128 v9, v[80:83] offset:0
    v_cvt_pk_bf16_f32 v88, v72, v73
    v_cvt_pk_bf16_f32 v89, v74, v75
    v_cvt_pk_bf16_f32 v90, v76, v77
    v_cvt_pk_bf16_f32 v91, v78, v79
    v_permlane32_swap_b32 v84, v86
    v_permlane32_swap_b32 v85, v87
    ds_write_b128 v9, v[84:87] offset:64
    v_permlane32_swap_b32 v88, v90
    v_permlane32_swap_b32 v89, v91
    ds_write_b128 v9, v[88:91] offset:128
    s_waitcnt lgkmcnt(3)
    v_or3_b32 v144, v144, v145, v146
    v_or_b32 v144, v144, v147
    s_nop 0
    v_readfirstlane_b32 s54, v144
L_Pa:
    s_cmp_ge_u32 s36, 4
    s_waitcnt vmcnt(0) lgkmcnt(0)
    s_barrier
    s_cbranch_scc0 L_Pd
    ds_read_b128 v[180:183], v116 offset:0
    ds_read_b64_tr_b16 a[0:1], v4 offset:0
    ds_read_b64_tr_b16 a[2:3], v4 offset:768
    ds_read_b64_tr_b16 a[4:5], v4 offset:32
    ds_read_b64_tr_b16 a[6:7], v4 offset:800
    ds_read_b64_tr_b16 a[8:9], v5 offset:64
    ds_read_b64_tr_b16 a[10:11], v5 offset:832
    ds_read_b128 v[192:195], v117 offset:0
    ds_read_b128 v[204:207], v118 offset:0
    ds_read_b64_tr_b16 a[12:13], v4 offset:6208
    ds_read_b64_tr_b16 a[14:15], v4 offset:6976
    s_waitcnt lgkmcnt(7)
    v_mfma_f32_16x16x32_bf16 v[44:47], a[0:3], v[180:183], 0
    s_add_u32 m0, s44, 18624
    ds_read_b128 v[184:187], v116 offset:64
    s_waitcnt lgkmcnt(7)
    v_mfma_f32_16x16x32_bf16 v[48:51], a[4:7], v[180:183], 0
    buffer_load_dwordx4 v7, s[12:15], s46 offen offset:0 lds
    s_waitcnt lgkmcnt(5)
    v_mfma_f32_16x16x32_bf16 v[52:55], a[8:11], v[180:183], 0
    ds_read_b64_tr_b16 a[16:17], v4 offset:6240
    s_waitcnt lgkmcnt(5)
    v_mfma_f32_16x16x32_bf16 v[56:59], a[0:3], v[192:195], 0
    ds_read_b64_tr_b16 a[18:19], v4 offset:7008
    v_mfma_f32_16x16x32_bf16 v[60:63], a[4:7], v[192:195], 0
    ds_read_b64_tr_b16 a[20:21], v5 offset:6272
    ds_read_b64_tr_b16 a[22:23], v5 offset:7040
    v_mfma_f32_16x16x32_bf16 v[64:67], a[8:11], v[192:195], 0
    buffer_load_dwordx4 v7, s[12:15], s46 offen offset:1024 lds
    s_waitcnt lgkmcnt(7)
    v_mfma_f32_16x16x32_bf16 v[68:71], a[0:3], v[204:207], 0
    ds_read_b128 v[196:199], v117 offset:64
    v_mfma_f32_16x16x32_bf16 v[72:75], a[4:7], v[204:207], 0
    ds_read_b128 v[208:211], v118 offset:64
    ds_read_b128 v[188:191], v116 offset:128
    v_mfma_f32_16x16x32_bf16 v[76:79], a[8:11], v[204:207], 0
    ds_read_b64_tr_b16 a[24:25], v4 offset:12416
    ds_read_b64_tr_b16 a[26:27], v4 offset:13184
    s_waitcnt lgkmcnt(5)
    v_mfma_f32_16x16x32_bf16 v[52:55], a[20:23], v[184:187], v[52:55]
    buffer_load_dwordx4 v7, s[12:15], s46 offen offset:2048 lds
    v_mfma_f32_16x16x32_bf16 v[48:51], a[16:19], v[184:187], v[48:51]
    ds_read_b64_tr_b16 a[28:29], v4 offset:12448
    v_mfma_f32_16x16x32_bf16 v[44:47], a[12:15], v[184:187], v[44:47]
    s_add_u32 m0, s45, 18624
    ds_read_b64_tr_b16 a[30:31], v4 offset:13216
    ds_read_b128 v[136:139], v172 offset:256
    s_waitcnt lgkmcnt(7)
    v_mfma_f32_16x16x32_bf16 v[64:67], a[20:23], v[196:199], v[64:67]
    buffer_load_dwordx4 v26, s[12:15], s46 offen offset:0 lds
    ds_read_b64_tr_b16 a[32:33], v5 offset:12480
    v_mfma_f32_16x16x32_bf16 v[60:63], a[16:19], v[196:199], v[60:63]
    ds_read_b64_tr_b16 a[34:35], v5 offset:13248
    ds_read_b128 v[200:203], v117 offset:128
    ds_read_b128 v[212:215], v118 offset:128
    v_mfma_f32_16x16x32_bf16 v[56:59], a[12:15], v[196:199], v[56:59]
    ds_read_b128 v[216:219], v119 offset:0
    s_waitcnt lgkmcnt(7)
    v_mfma_f32_16x16x32_bf16 v[76:79], a[20:23], v[208:211], v[76:79]
    ds_read_b128 v[220:223], v119 offset:64
    v_mfma_f32_16x16x32_bf16 v[72:75], a[16:19], v[208:211], v[72:75]
    buffer_load_dwordx4 v26, s[12:15], s46 offen offset:1024 lds
    s_add_u32 s46, s46, 18432
    v_mfma_f32_16x16x32_bf16 v[68:71], a[12:15], v[208:211], v[68:71]
    ds_read_b128 v[224:227], v119 offset:128
    v_mfma_f32_16x16x32_bf16 v[44:47], a[24:27], v[188:191], v[44:47]
    s_add_u32 m0, s44, 37248
    s_waitcnt lgkmcnt(7)
    v_xor_b32 v136, v136, v166
    v_xor_b32 v137, v137, v166
    v_mfma_f32_16x16x32_bf16 v[48:51], a[28:31], v[188:191], v[48:51]
    buffer_load_dwordx4 v7, s[12:15], s46 offen offset:0 lds
    s_waitcnt lgkmcnt(5)
    v_mfma_f32_16x16x32_bf16 v[52:55], a[32:35], v[188:191], v[52:55]
    ds_read_b128 v[228:231], v120 offset:0
    v_xor_b32 v138, v138, v166
    v_xor_b32 v139, v139, v166
    s_waitcnt lgkmcnt(5)
    v_mfma_f32_16x16x32_bf16 v[56:59], a[24:27], v[200:203], v[56:59]
    ds_read_b128 v[232:235], v120 offset:64
    v_lshlrev_b32_sdwa v122, 4, v136 dst_sel:DWORD dst_unused:UNUSED_PAD src0_sel:DWORD src1_sel:WORD_0
    v_lshlrev_b32_sdwa v123, 4, v138 dst_sel:DWORD dst_unused:UNUSED_PAD src0_sel:DWORD src1_sel:WORD_0
    v_mfma_f32_16x16x32_bf16 v[60:63], a[28:31], v[200:203], v[60:63]
    ds_read_b128 v[236:239], v120 offset:128
    v_lshlrev_b32_sdwa v124, 4, v136 dst_sel:DWORD dst_unused:UNUSED_PAD src0_sel:DWORD src1_sel:WORD_1
    v_lshlrev_b32_sdwa v125, 4, v138 dst_sel:DWORD dst_unused:UNUSED_PAD src0_sel:DWORD src1_sel:WORD_1
    v_mfma_f32_16x16x32_bf16 v[64:67], a[32:35], v[200:203], v[64:67]
    buffer_load_dwordx4 v7, s[12:15], s46 offen offset:1024 lds
    s_waitcnt lgkmcnt(6)
    v_mfma_f32_16x16x32_bf16 v[68:71], a[24:27], v[212:215], v[68:71]
    ds_read_b128 v[240:243], v121 offset:0
    v_lshlrev_b32_sdwa v126, 4, v137 dst_sel:DWORD dst_unused:UNUSED_PAD src0_sel:DWORD src1_sel:WORD_0
    v_lshlrev_b32_sdwa v127, 4, v139 dst_sel:DWORD dst_unused:UNUSED_PAD src0_sel:DWORD src1_sel:WORD_0
    v_mfma_f32_16x16x32_bf16 v[72:75], a[28:31], v[212:215], v[72:75]
    ds_read_b128 v[244:247], v121 offset:64
    v_mfma_f32_16x16x32_bf16 v[76:79], a[32:35], v[212:215], v[76:79]
    s_waitcnt lgkmcnt(7)
    v_mfma_f32_16x16x32_bf16 v[80:83], a[0:3], v[216:219], 0
    ds_read_b128 v[248:251], v121 offset:128
    v_mfma_f32_16x16x32_bf16 v[84:87], a[4:7], v[216:219], 0
    buffer_load_dwordx4 v7, s[12:15], s46 offen offset:2048 lds
    v_mfma_f32_16x16x32_bf16 v[88:91], a[8:11], v[216:219], 0
    ds_read_b128 v[180:183], v122 offset:0
    s_waitcnt lgkmcnt(7)
    v_mfma_f32_16x16x32_bf16 v[88:91], a[20:23], v[220:223], v[88:91]
    v_mfma_f32_16x16x32_bf16 v[84:87], a[16:19], v[220:223], v[84:87]
    ds_read_b128 v[184:187], v122 offset:64
    s_waitcnt vmcnt(3)
    s_barrier
    v_mfma_f32_16x16x32_bf16 v[80:83], a[12:15], v[220:223], v[80:83]
    s_add_u32 m0, s45, 37248
    ds_read_b64_tr_b16 a[36:37], v4 offset:18624
    v_mfma_f32_16x16x32_bf16 v[80:83], a[24:27], v[224:227], v[80:83]
    buffer_load_dwordx4 v26, s[12:15], s46 offen offset:0 lds
    v_mfma_f32_16x16x32_bf16 v[84:87], a[28:31], v[224:227], v[84:87]
    ds_read_b128 v[188:191], v122 offset:128
    ds_read_b64_tr_b16 a[38:39], v4 offset:19392
    v_mfma_f32_16x16x32_bf16 v[88:91], a[32:35], v[224:227], v[88:91]
    ds_read_b64_tr_b16 a[40:41], v4 offset:18656
    s_waitcnt lgkmcnt(7)
    v_mfma_f32_16x16x32_bf16 v[92:95], a[0:3], v[228:231], 0
    ds_read_b64_tr_b16 a[42:43], v4 offset:19424
    ds_read_b64_tr_b16 a[44:45], v5 offset:18688
    v_mfma_f32_16x16x32_bf16 v[96:99], a[4:7], v[228:231], 0
    buffer_load_dwordx4 v26, s[12:15], s46 offen offset:1024 lds
    s_add_u32 s46, s46, 18432
    v_mfma_f32_16x16x32_bf16 v[100:103], a[8:11], v[228:231], 0
    ds_read_b128 v[192:195], v123 offset:0
    ds_read_b64_tr_b16 a[46:47], v5 offset:19456
    v_mfma_f32_16x16x32_bf16 v[100:103], a[20:23], v[232:235], v[100:103]
    ds_read_b64_tr_b16 a[48:49], v4 offset:24832
    ds_read_b64_tr_b16 a[50:51], v4 offset:25600
    v_mfma_f32_16x16x32_bf16 v[96:99], a[16:19], v[232:235], v[96:99]
    ds_read_b128 v[196:199], v123 offset:64
    v_mfma_f32_16x16x32_bf16 v[92:95], a[12:15], v[232:235], v[92:95]
    ds_read_b64_tr_b16 a[52:53], v4 offset:24864
    v_mfma_f32_16x16x32_bf16 v[92:95], a[24:27], v[236:239], v[92:95]
    ds_read_b64_tr_b16 a[54:55], v4 offset:25632
    ds_read_b64_tr_b16 a[56:57], v5 offset:24896
    v_mfma_f32_16x16x32_bf16 v[96:99], a[28:31], v[236:239], v[96:99]
    ds_read_b128 v[200:203], v123 offset:128
    s_add_u32 m0, s44, 0
    v_mfma_f32_16x16x32_bf16 v[100:103], a[32:35], v[236:239], v[100:103]
    buffer_load_dwordx4 v7, s[12:15], s46 offen offset:0 lds
    ds_read_b64_tr_b16 a[58:59], v5 offset:25664
    v_mfma_f32_16x16x32_bf16 v[104:107], a[0:3], v[240:243], 0
    ds_read_b64_tr_b16 a[60:61], v4 offset:31040
    ds_read_b64_tr_b16 a[62:63], v4 offset:31808
    v_mfma_f32_16x16x32_bf16 v[108:111], a[4:7], v[240:243], 0
    ds_read_b128 v[204:207], v124 offset:0
    ds_read_b64_tr_b16 a[64:65], v4 offset:31072
    v_mfma_f32_16x16x32_bf16 v[112:115], a[8:11], v[240:243], 0
    buffer_load_dwordx4 v7, s[12:15], s46 offen offset:1024 lds
    v_mfma_f32_16x16x32_bf16 v[112:115], a[20:23], v[244:247], v[112:115]
    ds_read_b64_tr_b16 a[66:67], v4 offset:31840
    ds_read_b64_tr_b16 a[68:69], v5 offset:31104
    ds_read_b64_tr_b16 a[70:71], v5 offset:31872
    v_mfma_f32_16x16x32_bf16 v[108:111], a[16:19], v[244:247], v[108:111]
    ds_read_b128 v[208:211], v124 offset:64
    v_mfma_f32_16x16x32_bf16 v[104:107], a[12:15], v[244:247], v[104:107]
    s_waitcnt lgkmcnt(7)
    v_mfma_f32_16x16x32_bf16 v[104:107], a[24:27], v[248:251], v[104:107]
    buffer_load_dwordx4 v7, s[12:15], s46 offen offset:2048 lds
    v_mfma_f32_16x16x32_bf16 v[108:111], a[28:31], v[248:251], v[108:111]
    ds_read_b128 v[212:215], v124 offset:128
    v_mfma_f32_16x16x32_bf16 v[112:115], a[32:35], v[248:251], v[112:115]
    s_waitcnt vmcnt(3)
    s_waitcnt lgkmcnt(2)
    s_barrier
    v_mfma_f32_16x16x32_bf16 v[44:47], a[36:39], v[180:183], v[44:47]
    v_mfma_f32_16x16x32_bf16 v[48:51], a[40:43], v[180:183], v[48:51]
    ds_read_b128 v[216:219], v125 offset:0
    s_add_u32 m0, s45, 0
    v_mfma_f32_16x16x32_bf16 v[52:55], a[44:47], v[180:183], v[52:55]
    buffer_load_dwordx4 v26, s[12:15], s46 offen offset:0 lds
    v_mfma_f32_16x16x32_bf16 v[52:55], a[56:59], v[184:187], v[52:55]
    ds_read_b128 v[136:139], v172 offset:512
    ds_read_b64_tr_b16 a[72:73], v4 offset:37248
    v_mfma_f32_16x16x32_bf16 v[48:51], a[52:55], v[184:187], v[48:51]
    ds_read_b128 v[220:223], v125 offset:64
    v_mfma_f32_16x16x32_bf16 v[44:47], a[48:51], v[184:187], v[44:47]
    buffer_load_dwordx4 v26, s[12:15], s46 offen offset:1024 lds
    s_add_u32 s46, s46, 18432
    v_mfma_f32_16x16x32_bf16 v[44:47], a[60:63], v[188:191], v[44:47]
    ds_read_b64_tr_b16 a[74:75], v4 offset:38016
    v_mfma_f32_16x16x32_bf16 v[48:51], a[64:67], v[188:191], v[48:51]
    ds_read_b128 v[224:227], v125 offset:128
    v_mfma_f32_16x16x32_bf16 v[52:55], a[68:71], v[188:191], v[52:55]
    ds_read_b64_tr_b16 a[76:77], v4 offset:37280
    v_mfma_f32_16x16x32_bf16 v[56:59], a[36:39], v[192:195], v[56:59]
    ds_read_b64_tr_b16 a[78:79], v4 offset:38048
    v_mfma_f32_16x16x32_bf16 v[60:63], a[40:43], v[192:195], v[60:63]
    ds_read_b128 v[228:231], v126 offset:0
    v_mfma_f32_16x16x32_bf16 v[64:67], a[44:47], v[192:195], v[64:67]
    s_add_u32 m0, s44, 18624
    v_mfma_f32_16x16x32_bf16 v[64:67], a[56:59], v[196:199], v[64:67]
    buffer_load_dwordx4 v7, s[12:15], s46 offen offset:0 lds
    v_mfma_f32_16x16x32_bf16 v[60:63], a[52:55], v[196:199], v[60:63]
    ds_read_b128 v[232:235], v126 offset:64
    ds_read_b64_tr_b16 a[80:81], v5 offset:37312
    v_mfma_f32_16x16x32_bf16 v[56:59], a[48:51], v[196:199], v[56:59]
    s_waitcnt lgkmcnt(7)
    v_xor_b32 v136, v136, v166
    v_xor_b32 v137, v137, v166
    v_mfma_f32_16x16x32_bf16 v[56:59], a[60:63], v[200:203], v[56:59]
    v_xor_b32 v138, v138, v166
    v_xor_b32 v139, v139, v166
    v_mfma_f32_16x16x32_bf16 v[60:63], a[64:67], v[200:203], v[60:63]
    ds_read_b128 v[236:239], v126 offset:128
    v_mfma_f32_16x16x32_bf16 v[64:67], a[68:71], v[200:203], v[64:67]
    ds_read_b64_tr_b16 a[82:83], v5 offset:38080
    ds_read_b64_tr_b16 a[84:85], v4 offset:43456
    v_mfma_f32_16x16x32_bf16 v[68:71], a[36:39], v[204:207], v[68:71]
    buffer_load_dwordx4 v7, s[12:15], s46 offen offset:1024 lds
    v_mfma_f32_16x16x32_bf16 v[72:75], a[40:43], v[204:207], v[72:75]
    ds_read_b128 v[240:243], v127 offset:0
    v_mfma_f32_16x16x32_bf16 v[76:79], a[44:47], v[204:207], v[76:79]
    v_lshlrev_b32_sdwa v128, 4, v136 dst_sel:DWORD dst_unused:UNUSED_PAD src0_sel:DWORD src1_sel:WORD_0
    v_lshlrev_b32_sdwa v129, 4, v138 dst_sel:DWORD dst_unused:UNUSED_PAD src0_sel:DWORD src1_sel:WORD_0
    v_mfma_f32_16x16x32_bf16 v[76:79], a[56:59], v[208:211], v[76:79]
    v_lshlrev_b32_sdwa v130, 4, v136 dst_sel:DWORD dst_unused:UNUSED_PAD src0_sel:DWORD src1_sel:WORD_1
    v_lshlrev_b32_sdwa v131, 4, v138 dst_sel:DWORD dst_unused:UNUSED_PAD src0_sel:DWORD src1_sel:WORD_1
    v_mfma_f32_16x16x32_bf16 v[72:75], a[52:55], v[208:211], v[72:75]
    ds_read_b128 v[244:247], v127 offset:64
    v_mfma_f32_16x16x32_bf16 v[68:71], a[48:51], v[208:211], v[68:71]
    ds_read_b64_tr_b16 a[86:87], v4 offset:44224
    v_mfma_f32_16x16x32_bf16 v[68:71], a[60:63], v[212:215], v[68:71]
    buffer_load_dwordx4 v7, s[12:15], s46 offen offset:2048 lds
    v_mfma_f32_16x16x32_bf16 v[72:75], a[64:67], v[212:215], v[72:75]
    ds_read_b128 v[248:251], v127 offset:128
    v_lshlrev_b32_sdwa v132, 4, v137 dst_sel:DWORD dst_unused:UNUSED_PAD src0_sel:DWORD src1_sel:WORD_0
    v_lshlrev_b32_sdwa v133, 4, v139 dst_sel:DWORD dst_unused:UNUSED_PAD src0_sel:DWORD src1_sel:WORD_0
    v_mfma_f32_16x16x32_bf16 v[76:79], a[68:71], v[212:215], v[76:79]
    ds_read_b64_tr_b16 a[88:89], v4 offset:43488
    v_mfma_f32_16x16x32_bf16 v[80:83], a[36:39], v[216:219], v[80:83]
    ds_read_b64_tr_b16 a[90:91], v4 offset:44256
    v_mfma_f32_16x16x32_bf16 v[84:87], a[40:43], v[216:219], v[84:87]
    ds_read_b128 v[180:183], v128 offset:0
    v_mfma_f32_16x16x32_bf16 v[88:91], a[44:47], v[216:219], v[88:91]
    s_add_u32 m0, s45, 18624
    v_mfma_f32_16x16x32_bf16 v[88:91], a[56:59], v[220:223], v[88:91]
    buffer_load_dwordx4 v26, s[12:15], s46 offen offset:0 lds
    v_mfma_f32_16x16x32_bf16 v[84:87], a[52:55], v[220:223], v[84:87]
    ds_read_b128 v[184:187], v128 offset:64
    v_mfma_f32_16x16x32_bf16 v[80:83], a[48:51], v[220:223], v[80:83]
    ds_read_b64_tr_b16 a[92:93], v5 offset:43520
    s_waitcnt lgkmcnt(7)
    v_mfma_f32_16x16x32_bf16 v[80:83], a[60:63], v[224:227], v[80:83]
    ds_read_b64_tr_b16 a[94:95], v5 offset:44288
    v_mfma_f32_16x16x32_bf16 v[84:87], a[64:67], v[224:227], v[84:87]
    ds_read_b128 v[188:191], v128 offset:128
    v_mfma_f32_16x16x32_bf16 v[88:91], a[68:71], v[224:227], v[88:91]
    ds_read_b64_tr_b16 a[96:97], v4 offset:49664
    v_mfma_f32_16x16x32_bf16 v[92:95], a[36:39], v[228:231], v[92:95]
    buffer_load_dwordx4 v26, s[12:15], s46 offen offset:1024 lds
    s_add_u32 s46, s46, 18432
    v_mfma_f32_16x16x32_bf16 v[96:99], a[40:43], v[228:231], v[96:99]
    ds_read_b128 v[192:195], v129 offset:0
    v_mfma_f32_16x16x32_bf16 v[100:103], a[44:47], v[228:231], v[100:103]
    ds_read_b64_tr_b16 a[98:99], v4 offset:50432
    v_mfma_f32_16x16x32_bf16 v[100:103], a[56:59], v[232:235], v[100:103]
    ds_read_b64_tr_b16 a[100:101], v4 offset:49696
    v_mfma_f32_16x16x32_bf16 v[96:99], a[52:55], v[232:235], v[96:99]
    ds_read_b128 v[196:199], v129 offset:64
    v_mfma_f32_16x16x32_bf16 v[92:95], a[48:51], v[232:235], v[92:95]
    v_mfma_f32_16x16x32_bf16 v[92:95], a[60:63], v[236:239], v[92:95]
    ds_read_b64_tr_b16 a[102:103], v4 offset:50464
    v_mfma_f32_16x16x32_bf16 v[96:99], a[64:67], v[236:239], v[96:99]
    ds_read_b128 v[200:203], v129 offset:128
    v_mfma_f32_16x16x32_bf16 v[100:103], a[68:71], v[236:239], v[100:103]
    ds_read_b64_tr_b16 a[104:105], v5 offset:49728
    v_mfma_f32_16x16x32_bf16 v[104:107], a[36:39], v[240:243], v[104:107]
    v_mfma_f32_16x16x32_bf16 v[108:111], a[40:43], v[240:243], v[108:111]
    ds_read_b128 v[204:207], v130 offset:0
    v_mfma_f32_16x16x32_bf16 v[112:115], a[44:47], v[240:243], v[112:115]
    ds_read_b64_tr_b16 a[106:107], v5 offset:50496
    v_mfma_f32_16x16x32_bf16 v[112:115], a[56:59], v[244:247], v[112:115]
    v_mfma_f32_16x16x32_bf16 v[108:111], a[52:55], v[244:247], v[108:111]
    ds_read_b128 v[208:211], v130 offset:64
    v_mfma_f32_16x16x32_bf16 v[104:107], a[48:51], v[244:247], v[104:107]
    s_waitcnt lgkmcnt(7)
    v_mfma_f32_16x16x32_bf16 v[104:107], a[60:63], v[248:251], v[104:107]
    v_mfma_f32_16x16x32_bf16 v[108:111], a[64:67], v[248:251], v[108:111]
    ds_read_b128 v[212:215], v130 offset:128
    v_mfma_f32_16x16x32_bf16 v[112:115], a[68:71], v[248:251], v[112:115]
    s_waitcnt vmcnt(5)
    s_waitcnt lgkmcnt(2)
    s_barrier
    v_mfma_f32_16x16x32_bf16 v[44:47], a[72:75], v[180:183], v[44:47]
    v_mfma_f32_16x16x32_bf16 v[48:51], a[76:79], v[180:183], v[48:51]
    ds_read_b128 v[216:219], v131 offset:0
    v_mfma_f32_16x16x32_bf16 v[52:55], a[80:83], v[180:183], v[52:55]
    ds_read_b64_tr_b16 a[108:109], v4 offset:0
    v_mfma_f32_16x16x32_bf16 v[52:55], a[92:95], v[184:187], v[52:55]
    ds_read_b128 v[136:139], v172 offset:768
    v_mfma_f32_16x16x32_bf16 v[48:51], a[88:91], v[184:187], v[48:51]
    ds_read_b128 v[220:223], v131 offset:64
    s_add_u32 m0, s44, 37248
    v_mfma_f32_16x16x32_bf16 v[44:47], a[84:87], v[184:187], v[44:47]
    buffer_load_dwordx4 v7, s[12:15], s46 offen offset:0 lds
    v_mfma_f32_16x16x32_bf16 v[44:47], a[96:99], v[188:191], v[44:47]
    ds_read_b64_tr_b16 a[110:111], v4 offset:768
    v_mfma_f32_16x16x32_bf16 v[48:51], a[100:103], v[188:191], v[48:51]
    ds_read_b128 v[224:227], v131 offset:128
    v_mfma_f32_16x16x32_bf16 v[52:55], a[104:107], v[188:191], v[52:55]
    ds_read_b64_tr_b16 a[112:113], v4 offset:32
    v_mfma_f32_16x16x32_bf16 v[56:59], a[72:75], v[192:195], v[56:59]
    ds_read_b64_tr_b16 a[114:115], v4 offset:800
    v_mfma_f32_16x16x32_bf16 v[60:63], a[76:79], v[192:195], v[60:63]
    ds_read_b128 v[228:231], v132 offset:0
    v_mfma_f32_16x16x32_bf16 v[64:67], a[80:83], v[192:195], v[64:67]
    s_waitcnt lgkmcnt(6)
    v_xor_b32 v136, v136, v166
    v_xor_b32 v137, v137, v166
    v_mfma_f32_16x16x32_bf16 v[64:67], a[92:95], v[196:199], v[64:67]
    buffer_load_dwordx4 v7, s[12:15], s46 offen offset:1024 lds
    v_mfma_f32_16x16x32_bf16 v[60:63], a[88:91], v[196:199], v[60:63]
    ds_read_b128 v[232:235], v132 offset:64
    v_mfma_f32_16x16x32_bf16 v[56:59], a[84:87], v[196:199], v[56:59]
    v_xor_b32 v138, v138, v166
    v_xor_b32 v139, v139, v166
    v_mfma_f32_16x16x32_bf16 v[56:59], a[96:99], v[200:203], v[56:59]
    ds_read_b64_tr_b16 a[116:117], v5 offset:64
    v_mfma_f32_16x16x32_bf16 v[60:63], a[100:103], v[200:203], v[60:63]
    ds_read_b128 v[236:239], v132 offset:128
    v_mfma_f32_16x16x32_bf16 v[64:67], a[104:107], v[200:203], v[64:67]
    ds_read_b64_tr_b16 a[118:119], v5 offset:832
    ds_read_b64_tr_b16 a[120:121], v4 offset:6208
    v_mfma_f32_16x16x32_bf16 v[68:71], a[72:75], v[204:207], v[68:71]
    v_lshlrev_b32_sdwa v116, 4, v136 dst_sel:DWORD dst_unused:UNUSED_PAD src0_sel:DWORD src1_sel:WORD_0
    v_lshlrev_b32_sdwa v117, 4, v138 dst_sel:DWORD dst_unused:UNUSED_PAD src0_sel:DWORD src1_sel:WORD_0
    v_mfma_f32_16x16x32_bf16 v[72:75], a[76:79], v[204:207], v[72:75]
    ds_read_b128 v[240:243], v133 offset:0
    v_mfma_f32_16x16x32_bf16 v[76:79], a[80:83], v[204:207], v[76:79]
    buffer_load_dwordx4 v7, s[12:15], s46 offen offset:2048 lds
    v_mfma_f32_16x16x32_bf16 v[76:79], a[92:95], v[208:211], v[76:79]
    v_lshlrev_b32_sdwa v118, 4, v136 dst_sel:DWORD dst_unused:UNUSED_PAD src0_sel:DWORD src1_sel:WORD_1
    v_lshlrev_b32_sdwa v119, 4, v138 dst_sel:DWORD dst_unused:UNUSED_PAD src0_sel:DWORD src1_sel:WORD_1
    v_mfma_f32_16x16x32_bf16 v[72:75], a[88:91], v[208:211], v[72:75]
    ds_read_b128 v[244:247], v133 offset:64
    v_mfma_f32_16x16x32_bf16 v[68:71], a[84:87], v[208:211], v[68:71]
    ds_read_b64_tr_b16 a[122:123], v4 offset:6976
    v_mfma_f32_16x16x32_bf16 v[68:71], a[96:99], v[212:215], v[68:71]
    v_lshlrev_b32_sdwa v120, 4, v137 dst_sel:DWORD dst_unused:UNUSED_PAD src0_sel:DWORD src1_sel:WORD_0
    v_lshlrev_b32_sdwa v121, 4, v139 dst_sel:DWORD dst_unused:UNUSED_PAD src0_sel:DWORD src1_sel:WORD_0
    v_mfma_f32_16x16x32_bf16 v[72:75], a[100:103], v[212:215], v[72:75]
    ds_read_b128 v[248:251], v133 offset:128
    v_mfma_f32_16x16x32_bf16 v[76:79], a[104:107], v[212:215], v[76:79]
    ds_read_b64_tr_b16 a[124:125], v4 offset:6240
    v_mfma_f32_16x16x32_bf16 v[80:83], a[72:75], v[216:219], v[80:83]
    ds_read_b64_tr_b16 a[126:127], v4 offset:7008
    v_mfma_f32_16x16x32_bf16 v[84:87], a[76:79], v[216:219], v[84:87]
    ds_read_b128 v[180:183], v116 offset:0
    s_add_u32 m0, s45, 37248
    v_mfma_f32_16x16x32_bf16 v[88:91], a[80:83], v[216:219], v[88:91]
    buffer_load_dwordx4 v26, s[12:15], s46 offen offset:0 lds
    s_waitcnt lgkmcnt(7)
    v_mfma_f32_16x16x32_bf16 v[88:91], a[92:95], v[220:223], v[88:91]
    ds_read_b64_tr_b16 a[128:129], v5 offset:6272
    v_mfma_f32_16x16x32_bf16 v[84:87], a[88:91], v[220:223], v[84:87]
    ds_read_b128 v[184:187], v116 offset:64
    v_mfma_f32_16x16x32_bf16 v[80:83], a[84:87], v[220:223], v[80:83]
    ds_read_b64_tr_b16 a[130:131], v5 offset:7040
    v_mfma_f32_16x16x32_bf16 v[80:83], a[96:99], v[224:227], v[80:83]
    v_mfma_f32_16x16x32_bf16 v[84:87], a[100:103], v[224:227], v[84:87]
    ds_read_b128 v[188:191], v116 offset:128
    v_mfma_f32_16x16x32_bf16 v[88:91], a[104:107], v[224:227], v[88:91]
    ds_read_b64_tr_b16 a[132:133], v4 offset:12416
    v_mfma_f32_16x16x32_bf16 v[92:95], a[72:75], v[228:231], v[92:95]
    buffer_load_dwordx4 v26, s[12:15], s46 offen offset:1024 lds
    s_add_u32 s46, s46, 18432
    v_mfma_f32_16x16x32_bf16 v[96:99], a[76:79], v[228:231], v[96:99]
    ds_read_b128 v[192:195], v117 offset:0
    v_mfma_f32_16x16x32_bf16 v[100:103], a[80:83], v[228:231], v[100:103]
    ds_read_b64_tr_b16 a[134:135], v4 offset:13184
    v_mfma_f32_16x16x32_bf16 v[100:103], a[92:95], v[232:235], v[100:103]
    ds_read_b64_tr_b16 a[136:137], v4 offset:12448
    v_mfma_f32_16x16x32_bf16 v[96:99], a[88:91], v[232:235], v[96:99]
    ds_read_b128 v[196:199], v117 offset:64
    v_mfma_f32_16x16x32_bf16 v[92:95], a[84:87], v[232:235], v[92:95]
    v_mfma_f32_16x16x32_bf16 v[92:95], a[96:99], v[236:239], v[92:95]
    ds_read_b64_tr_b16 a[138:139], v4 offset:13216
    v_mfma_f32_16x16x32_bf16 v[96:99], a[100:103], v[236:239], v[96:99]
    ds_read_b128 v[200:203], v117 offset:128
    v_mfma_f32_16x16x32_bf16 v[100:103], a[104:107], v[236:239], v[100:103]
    ds_read_b64_tr_b16 a[140:141], v5 offset:12480
    s_waitcnt lgkmcnt(7)
    v_mfma_f32_16x16x32_bf16 v[104:107], a[72:75], v[240:243], v[104:107]
    v_mfma_f32_16x16x32_bf16 v[108:111], a[76:79], v[240:243], v[108:111]
    ds_read_b128 v[204:207], v118 offset:0
    v_mfma_f32_16x16x32_bf16 v[112:115], a[80:83], v[240:243], v[112:115]
    ds_read_b64_tr_b16 a[142:143], v5 offset:13248
    v_mfma_f32_16x16x32_bf16 v[112:115], a[92:95], v[244:247], v[112:115]
    v_mfma_f32_16x16x32_bf16 v[108:111], a[88:91], v[244:247], v[108:111]
    ds_read_b128 v[208:211], v118 offset:64
    v_mfma_f32_16x16x32_bf16 v[104:107], a[84:87], v[244:247], v[104:107]
    v_mfma_f32_16x16x32_bf16 v[104:107], a[96:99], v[248:251], v[104:107]
    v_mfma_f32_16x16x32_bf16 v[108:111], a[100:103], v[248:251], v[108:111]
    ds_read_b128 v[212:215], v118 offset:128
    v_mfma_f32_16x16x32_bf16 v[112:115], a[104:107], v[248:251], v[112:115]
    s_waitcnt vmcnt(5)
    s_waitcnt lgkmcnt(2)
    s_barrier
    v_mfma_f32_16x16x32_bf16 v[44:47], a[108:111], v[180:183], v[44:47]
    v_mfma_f32_16x16x32_bf16 v[48:51], a[112:115], v[180:183], v[48:51]
    ds_read_b128 v[216:219], v119 offset:0
    v_mfma_f32_16x16x32_bf16 v[52:55], a[116:119], v[180:183], v[52:55]
    ds_read_b64_tr_b16 a[0:1], v4 offset:18624
    v_mfma_f32_16x16x32_bf16 v[52:55], a[128:131], v[184:187], v[52:55]
    ds_read_b128 v[136:139], v172 offset:1024
    v_mfma_f32_16x16x32_bf16 v[48:51], a[124:127], v[184:187], v[48:51]
    ds_read_b128 v[220:223], v119 offset:64
    s_add_u32 m0, s44, 0
    v_mfma_f32_16x16x32_bf16 v[44:47], a[120:123], v[184:187], v[44:47]
    buffer_load_dwordx4 v7, s[12:15], s46 offen offset:0 lds
    v_mfma_f32_16x16x32_bf16 v[44:47], a[132:135], v[188:191], v[44:47]
    ds_read_b64_tr_b16 a[2:3], v4 offset:19392
    v_mfma_f32_16x16x32_bf16 v[48:51], a[136:139], v[188:191], v[48:51]
    ds_read_b128 v[224:227], v119 offset:128
    v_mfma_f32_16x16x32_bf16 v[52:55], a[140:143], v[188:191], v[52:55]
    ds_read_b64_tr_b16 a[4:5], v4 offset:18656
    v_mfma_f32_16x16x32_bf16 v[56:59], a[108:111], v[192:195], v[56:59]
    ds_read_b64_tr_b16 a[6:7], v4 offset:19424
    v_mfma_f32_16x16x32_bf16 v[60:63], a[112:115], v[192:195], v[60:63]
    ds_read_b128 v[228:231], v120 offset:0
    v_mfma_f32_16x16x32_bf16 v[64:67], a[116:119], v[192:195], v[64:67]
    s_waitcnt lgkmcnt(6)
    v_xor_b32 v136, v136, v166
    v_xor_b32 v137, v137, v166
    v_mfma_f32_16x16x32_bf16 v[64:67], a[128:131], v[196:199], v[64:67]
    buffer_load_dwordx4 v7, s[12:15], s46 offen offset:1024 lds
    v_mfma_f32_16x16x32_bf16 v[60:63], a[124:127], v[196:199], v[60:63]
    ds_read_b128 v[232:235], v120 offset:64
    v_mfma_f32_16x16x32_bf16 v[56:59], a[120:123], v[196:199], v[56:59]
    v_xor_b32 v138, v138, v166
    v_xor_b32 v139, v139, v166
    v_mfma_f32_16x16x32_bf16 v[56:59], a[132:135], v[200:203], v[56:59]
    ds_read_b64_tr_b16 a[8:9], v5 offset:18688
    v_mfma_f32_16x16x32_bf16 v[60:63], a[136:139], v[200:203], v[60:63]
    ds_read_b128 v[236:239], v120 offset:128
    v_mfma_f32_16x16x32_bf16 v[64:67], a[140:143], v[200:203], v[64:67]
    ds_read_b64_tr_b16 a[10:11], v5 offset:19456
    ds_read_b64_tr_b16 a[12:13], v4 offset:24832
    v_mfma_f32_16x16x32_bf16 v[68:71], a[108:111], v[204:207], v[68:71]
    v_lshlrev_b32_sdwa v122, 4, v136 dst_sel:DWORD dst_unused:UNUSED_PAD src0_sel:DWORD src1_sel:WORD_0
    v_lshlrev_b32_sdwa v123, 4, v138 dst_sel:DWORD dst_unused:UNUSED_PAD src0_sel:DWORD src1_sel:WORD_0
    v_mfma_f32_16x16x32_bf16 v[72:75], a[112:115], v[204:207], v[72:75]
    ds_read_b128 v[240:243], v121 offset:0
    v_mfma_f32_16x16x32_bf16 v[76:79], a[116:119], v[204:207], v[76:79]
    buffer_load_dwordx4 v7, s[12:15], s46 offen offset:2048 lds
    v_mfma_f32_16x16x32_bf16 v[76:79], a[128:131], v[208:211], v[76:79]
    v_lshlrev_b32_sdwa v124, 4, v136 dst_sel:DWORD dst_unused:UNUSED_PAD src0_sel:DWORD src1_sel:WORD_1
    v_lshlrev_b32_sdwa v125, 4, v138 dst_sel:DWORD dst_unused:UNUSED_PAD src0_sel:DWORD src1_sel:WORD_1
    v_mfma_f32_16x16x32_bf16 v[72:75], a[124:127], v[208:211], v[72:75]
    ds_read_b128 v[244:247], v121 offset:64
    v_mfma_f32_16x16x32_bf16 v[68:71], a[120:123], v[208:211], v[68:71]
    ds_read_b64_tr_b16 a[14:15], v4 offset:25600
    v_mfma_f32_16x16x32_bf16 v[68:71], a[132:135], v[212:215], v[68:71]
    v_lshlrev_b32_sdwa v126, 4, v137 dst_sel:DWORD dst_unused:UNUSED_PAD src0_sel:DWORD src1_sel:WORD_0
    v_lshlrev_b32_sdwa v127, 4, v139 dst_sel:DWORD dst_unused:UNUSED_PAD src0_sel:DWORD src1_sel:WORD_0
    v_mfma_f32_16x16x32_bf16 v[72:75], a[136:139], v[212:215], v[72:75]
    ds_read_b128 v[248:251], v121 offset:128
    v_mfma_f32_16x16x32_bf16 v[76:79], a[140:143], v[212:215], v[76:79]
    ds_read_b64_tr_b16 a[16:17], v4 offset:24864
    v_mfma_f32_16x16x32_bf16 v[80:83], a[108:111], v[216:219], v[80:83]
    ds_read_b64_tr_b16 a[18:19], v4 offset:25632
    v_mfma_f32_16x16x32_bf16 v[84:87], a[112:115], v[216:219], v[84:87]
    ds_read_b128 v[180:183], v122 offset:0
    s_add_u32 m0, s45, 0
    v_mfma_f32_16x16x32_bf16 v[88:91], a[116:119], v[216:219], v[88:91]
    buffer_load_dwordx4 v26, s[12:15], s46 offen offset:0 lds
    s_waitcnt lgkmcnt(7)
    v_mfma_f32_16x16x32_bf16 v[88:91], a[128:131], v[220:223], v[88:91]
    ds_read_b64_tr_b16 a[20:21], v5 offset:24896
    v_mfma_f32_16x16x32_bf16 v[84:87], a[124:127], v[220:223], v[84:87]
    ds_read_b128 v[184:187], v122 offset:64
    v_mfma_f32_16x16x32_bf16 v[80:83], a[120:123], v[220:223], v[80:83]
    ds_read_b64_tr_b16 a[22:23], v5 offset:25664
    v_mfma_f32_16x16x32_bf16 v[80:83], a[132:135], v[224:227], v[80:83]
    v_mfma_f32_16x16x32_bf16 v[84:87], a[136:139], v[224:227], v[84:87]
    ds_read_b128 v[188:191], v122 offset:128
    v_mfma_f32_16x16x32_bf16 v[88:91], a[140:143], v[224:227], v[88:91]
    ds_read_b64_tr_b16 a[24:25], v4 offset:31040
    v_mfma_f32_16x16x32_bf16 v[92:95], a[108:111], v[228:231], v[92:95]
    buffer_load_dwordx4 v26, s[12:15], s46 offen offset:1024 lds
    s_add_u32 s46, s46, 18432
    v_mfma_f32_16x16x32_bf16 v[96:99], a[112:115], v[228:231], v[96:99]
    ds_read_b128 v[192:195], v123 offset:0
    v_mfma_f32_16x16x32_bf16 v[100:103], a[116:119], v[228:231], v[100:103]
    ds_read_b64_tr_b16 a[26:27], v4 offset:31808
    v_mfma_f32_16x16x32_bf16 v[100:103], a[128:131], v[232:235], v[100:103]
    ds_read_b64_tr_b16 a[28:29], v4 offset:31072
    v_mfma_f32_16x16x32_bf16 v[96:99], a[124:127], v[232:235], v[96:99]
    ds_read_b128 v[196:199], v123 offset:64
    v_mfma_f32_16x16x32_bf16 v[92:95], a[120:123], v[232:235], v[92:95]
    s_lshl_b32 s55, s55, 1
    s_mul_i32 s47, s28, 3104
    v_mfma_f32_16x16x32_bf16 v[92:95], a[132:135], v[236:239], v[92:95]
    ds_read_b64_tr_b16 a[30:31], v4 offset:31840
    v_mfma_f32_16x16x32_bf16 v[96:99], a[136:139], v[236:239], v[96:99]
    ds_read_b128 v[200:203], v123 offset:128
    v_mfma_f32_16x16x32_bf16 v[100:103], a[140:143], v[236:239], v[100:103]
    ds_read_b64_tr_b16 a[32:33], v5 offset:31104
    s_waitcnt lgkmcnt(7)
    v_mfma_f32_16x16x32_bf16 v[104:107], a[108:111], v[240:243], v[104:107]
    s_add_u32 s47, s47, 107616
    v_mfma_f32_16x16x32_bf16 v[108:111], a[112:115], v[240:243], v[108:111]
    ds_read_b128 v[204:207], v124 offset:0
    v_mfma_f32_16x16x32_bf16 v[112:115], a[116:119], v[240:243], v[112:115]
    ds_read_b64_tr_b16 a[34:35], v5 offset:31872
    v_mfma_f32_16x16x32_bf16 v[112:115], a[128:131], v[244:247], v[112:115]
    v_lshrrev_b32 v21, 6, v6
    v_mfma_f32_16x16x32_bf16 v[108:111], a[124:127], v[244:247], v[108:111]
    ds_read_b128 v[208:211], v124 offset:64
    v_mfma_f32_16x16x32_bf16 v[104:107], a[120:123], v[244:247], v[104:107]
    v_and_b32 v22, 48, v6
    v_mfma_f32_16x16x32_bf16 v[104:107], a[132:135], v[248:251], v[104:107]
    v_mfma_f32_16x16x32_bf16 v[108:111], a[136:139], v[248:251], v[108:111]
    ds_read_b128 v[212:215], v124 offset:128
    v_mfma_f32_16x16x32_bf16 v[112:115], a[140:143], v[248:251], v[112:115]
    s_waitcnt vmcnt(5)
    s_waitcnt lgkmcnt(2)
    s_barrier
    v_mul_u32_u24 v17, 112, v21
    v_mfma_f32_16x16x32_bf16 v[44:47], a[0:3], v[180:183], v[44:47]
    v_mul_u32_u24 v19, s2, v21
    v_mfma_f32_16x16x32_bf16 v[48:51], a[4:7], v[180:183], v[48:51]
    ds_read_b128 v[216:219], v125 offset:0
    v_mfma_f32_16x16x32_bf16 v[52:55], a[8:11], v[180:183], v[52:55]
    ds_read_b64_tr_b16 a[36:37], v4 offset:37248
    v_mfma_f32_16x16x32_bf16 v[52:55], a[20:23], v[184:187], v[52:55]
    ds_read_b128 v[136:139], v172 offset:1280
    v_lshrrev_b32 v23, 1, v22
    v_mfma_f32_16x16x32_bf16 v[48:51], a[16:19], v[184:187], v[48:51]
    ds_read_b128 v[220:223], v125 offset:64
    s_add_u32 m0, s44, 18624
    v_mfma_f32_16x16x32_bf16 v[44:47], a[12:15], v[184:187], v[44:47]
    buffer_load_dwordx4 v7, s[12:15], s46 offen offset:0 lds
    v_mfma_f32_16x16x32_bf16 v[44:47], a[24:27], v[188:191], v[44:47]
    ds_read_b64_tr_b16 a[38:39], v4 offset:38016
    s_lshl_b32 s48, s29, 7
    v_mfma_f32_16x16x32_bf16 v[48:51], a[28:31], v[188:191], v[48:51]
    ds_read_b128 v[224:227], v125 offset:128
    v_mfma_f32_16x16x32_bf16 v[52:55], a[32:35], v[188:191], v[52:55]
    ds_read_b64_tr_b16 a[40:41], v4 offset:37280
    s_lshl_b32 s49, s29, 5
    v_mfma_f32_16x16x32_bf16 v[56:59], a[0:3], v[192:195], v[56:59]
    ds_read_b64_tr_b16 a[42:43], v4 offset:38048
    v_mfma_f32_16x16x32_bf16 v[60:63], a[4:7], v[192:195], v[60:63]
    ds_read_b128 v[228:231], v126 offset:0
    v_mfma_f32_16x16x32_bf16 v[64:67], a[8:11], v[192:195], v[64:67]
    s_waitcnt lgkmcnt(6)
    v_xor_b32 v136, v136, v166
    v_xor_b32 v137, v137, v166
    v_mfma_f32_16x16x32_bf16 v[64:67], a[20:23], v[196:199], v[64:67]
    buffer_load_dwordx4 v7, s[12:15], s46 offen offset:1024 lds
    v_mfma_f32_16x16x32_bf16 v[60:63], a[16:19], v[196:199], v[60:63]
    ds_read_b128 v[232:235], v126 offset:64
    s_add_u32 s49, s49, 64
    v_mfma_f32_16x16x32_bf16 v[56:59], a[12:15], v[196:199], v[56:59]
    v_xor_b32 v138, v138, v166
    v_xor_b32 v139, v139, v166
    v_mfma_f32_16x16x32_bf16 v[56:59], a[24:27], v[200:203], v[56:59]
    ds_read_b64_tr_b16 a[44:45], v5 offset:37312
    v_add3_u32 v20, v19, s49, v23
    v_mfma_f32_16x16x32_bf16 v[60:63], a[28:31], v[200:203], v[60:63]
    ds_read_b128 v[236:239], v126 offset:128
    v_add3_u32 v19, v19, s48, v22
    v_mfma_f32_16x16x32_bf16 v[64:67], a[32:35], v[200:203], v[64:67]
    ds_read_b64_tr_b16 a[46:47], v5 offset:38080
    ds_read_b64_tr_b16 a[48:49], v4 offset:43456
    v_mfma_f32_16x16x32_bf16 v[68:71], a[0:3], v[204:207], v[68:71]
    v_lshlrev_b32_sdwa v128, 4, v136 dst_sel:DWORD dst_unused:UNUSED_PAD src0_sel:DWORD src1_sel:WORD_0
    v_lshlrev_b32_sdwa v129, 4, v138 dst_sel:DWORD dst_unused:UNUSED_PAD src0_sel:DWORD src1_sel:WORD_0
    v_mfma_f32_16x16x32_bf16 v[72:75], a[4:7], v[204:207], v[72:75]
    ds_read_b128 v[240:243], v127 offset:0
    s_add_u32 s48, s47, 64
    v_mfma_f32_16x16x32_bf16 v[76:79], a[8:11], v[204:207], v[76:79]
    buffer_load_dwordx4 v7, s[12:15], s46 offen offset:2048 lds
    v_mfma_f32_16x16x32_bf16 v[76:79], a[20:23], v[208:211], v[76:79]
    v_lshlrev_b32_sdwa v130, 4, v136 dst_sel:DWORD dst_unused:UNUSED_PAD src0_sel:DWORD src1_sel:WORD_1
    v_lshlrev_b32_sdwa v131, 4, v138 dst_sel:DWORD dst_unused:UNUSED_PAD src0_sel:DWORD src1_sel:WORD_1
    v_mfma_f32_16x16x32_bf16 v[72:75], a[16:19], v[208:211], v[72:75]
    ds_read_b128 v[244:247], v127 offset:64
    v_add3_u32 v18, v17, s48, v23
    v_mfma_f32_16x16x32_bf16 v[68:71], a[12:15], v[208:211], v[68:71]
    ds_read_b64_tr_b16 a[50:51], v4 offset:44224
    v_mfma_f32_16x16x32_bf16 v[68:71], a[24:27], v[212:215], v[68:71]
    v_lshlrev_b32_sdwa v132, 4, v137 dst_sel:DWORD dst_unused:UNUSED_PAD src0_sel:DWORD src1_sel:WORD_0
    v_lshlrev_b32_sdwa v133, 4, v139 dst_sel:DWORD dst_unused:UNUSED_PAD src0_sel:DWORD src1_sel:WORD_0
    v_mfma_f32_16x16x32_bf16 v[72:75], a[28:31], v[212:215], v[72:75]
    ds_read_b128 v[248:251], v127 offset:128
    v_add3_u32 v17, v17, s47, v22
    v_mfma_f32_16x16x32_bf16 v[76:79], a[32:35], v[212:215], v[76:79]
    ds_read_b64_tr_b16 a[52:53], v4 offset:43488
    v_mfma_f32_16x16x32_bf16 v[80:83], a[0:3], v[216:219], v[80:83]
    ds_read_b64_tr_b16 a[54:55], v4 offset:44256
    v_and_b32 v21, 3, v21
    v_mfma_f32_16x16x32_bf16 v[84:87], a[4:7], v[216:219], v[84:87]
    ds_read_b128 v[180:183], v128 offset:0
    s_add_u32 m0, s45, 18624
    v_mfma_f32_16x16x32_bf16 v[88:91], a[8:11], v[216:219], v[88:91]
    buffer_load_dwordx4 v26, s[12:15], s46 offen offset:0 lds
    s_waitcnt lgkmcnt(7)
    v_mfma_f32_16x16x32_bf16 v[88:91], a[20:23], v[220:223], v[88:91]
    ds_read_b64_tr_b16 a[56:57], v5 offset:43520
    v_mfma_f32_16x16x32_bf16 v[84:87], a[16:19], v[220:223], v[84:87]
    ds_read_b128 v[184:187], v128 offset:64
    v_mfma_f32_16x16x32_bf16 v[80:83], a[12:15], v[220:223], v[80:83]
    ds_read_b64_tr_b16 a[58:59], v5 offset:44288
    v_mfma_f32_16x16x32_bf16 v[80:83], a[24:27], v[224:227], v[80:83]
    v_lshrrev_b32 v22, 2, v22
    v_add_u32 v21, v21, v22
    v_mfma_f32_16x16x32_bf16 v[84:87], a[28:31], v[224:227], v[84:87]
    ds_read_b128 v[188:191], v128 offset:128
    v_lshrrev_b32 v22, 8, v6
    v_mfma_f32_16x16x32_bf16 v[88:91], a[32:35], v[224:227], v[88:91]
    ds_read_b64_tr_b16 a[60:61], v4 offset:49664
    v_mfma_f32_16x16x32_bf16 v[92:95], a[0:3], v[228:231], v[92:95]
    buffer_load_dwordx4 v26, s[12:15], s46 offen offset:1024 lds
    s_add_u32 s46, s46, 18432
    v_mfma_f32_16x16x32_bf16 v[96:99], a[4:7], v[228:231], v[96:99]
    ds_read_b128 v[192:195], v129 offset:0
    v_mfma_f32_16x16x32_bf16 v[100:103], a[8:11], v[228:231], v[100:103]
    ds_read_b64_tr_b16 a[62:63], v4 offset:50432
    v_mfma_f32_16x16x32_bf16 v[100:103], a[20:23], v[232:235], v[100:103]
    ds_read_b64_tr_b16 a[64:65], v4 offset:49696
    v_mfma_f32_16x16x32_bf16 v[96:99], a[16:19], v[232:235], v[96:99]
    ds_read_b128 v[196:199], v129 offset:64
    v_mfma_f32_16x16x32_bf16 v[92:95], a[12:15], v[232:235], v[92:95]
    v_mul_u32_u24 v21, 112, v21
    v_lshlrev_b32 v22, 3, v22
    v_mfma_f32_16x16x32_bf16 v[92:95], a[24:27], v[236:239], v[92:95]
    ds_read_b64_tr_b16 a[66:67], v4 offset:50464
    v_add3_u32 v16, v21, s47, v22
    v_mfma_f32_16x16x32_bf16 v[96:99], a[28:31], v[236:239], v[96:99]
    ds_read_b128 v[200:203], v129 offset:128
    v_mfma_f32_16x16x32_bf16 v[100:103], a[32:35], v[236:239], v[100:103]
    ds_read_b64_tr_b16 a[68:69], v5 offset:49728
    s_waitcnt lgkmcnt(7)
    v_mfma_f32_16x16x32_bf16 v[104:107], a[0:3], v[240:243], v[104:107]
    v_mfma_f32_16x16x32_bf16 v[108:111], a[4:7], v[240:243], v[108:111]
    ds_read_b128 v[204:207], v130 offset:0
    v_mfma_f32_16x16x32_bf16 v[112:115], a[8:11], v[240:243], v[112:115]
    ds_read_b64_tr_b16 a[70:71], v5 offset:50496
    v_mfma_f32_16x16x32_bf16 v[112:115], a[20:23], v[244:247], v[112:115]
    v_mfma_f32_16x16x32_bf16 v[108:111], a[16:19], v[244:247], v[108:111]
    ds_read_b128 v[208:211], v130 offset:64
    v_mfma_f32_16x16x32_bf16 v[104:107], a[12:15], v[244:247], v[104:107]
    v_mfma_f32_16x16x32_bf16 v[104:107], a[24:27], v[248:251], v[104:107]
    v_mfma_f32_16x16x32_bf16 v[108:111], a[28:31], v[248:251], v[108:111]
    ds_read_b128 v[212:215], v130 offset:128
    v_mfma_f32_16x16x32_bf16 v[112:115], a[32:35], v[248:251], v[112:115]
    s_waitcnt vmcnt(5)
    s_waitcnt lgkmcnt(2)
    s_barrier
    v_mfma_f32_16x16x32_bf16 v[44:47], a[36:39], v[180:183], v[44:47]
    ds_read_b64_tr_b16 a[72:73], v4 offset:0
    v_mfma_f32_16x16x32_bf16 v[48:51], a[40:43], v[180:183], v[48:51]
    ds_read_b128 v[216:219], v131 offset:0
    s_add_u32 m0, s44, 37248
    v_mfma_f32_16x16x32_bf16 v[52:55], a[44:47], v[180:183], v[52:55]
    buffer_load_dwordx4 v7, s[12:15], s46 offen offset:0 lds
    v_mfma_f32_16x16x32_bf16 v[52:55], a[56:59], v[184:187], v[52:55]
    ds_read_b128 v[136:139], v172 offset:1536
    ds_read_b64_tr_b16 a[74:75], v4 offset:768
    v_mfma_f32_16x16x32_bf16 v[48:51], a[52:55], v[184:187], v[48:51]
    ds_read_b128 v[220:223], v131 offset:64
    ds_read_b64_tr_b16 a[76:77], v4 offset:32
    v_mfma_f32_16x16x32_bf16 v[44:47], a[48:51], v[184:187], v[44:47]
    ds_read_b64_tr_b16 a[78:79], v4 offset:800
    v_mfma_f32_16x16x32_bf16 v[44:47], a[60:63], v[188:191], v[44:47]
    ds_read_b64_tr_b16 a[80:81], v5 offset:64
    ds_read_b64_tr_b16 a[82:83], v5 offset:832
    v_mfma_f32_16x16x32_bf16 v[48:51], a[64:67], v[188:191], v[48:51]
    ds_read_b128 v[224:227], v131 offset:128
    v_mfma_f32_16x16x32_bf16 v[52:55], a[68:71], v[188:191], v[52:55]
    buffer_load_dwordx4 v7, s[12:15], s46 offen offset:1024 lds
    v_mfma_f32_16x16x32_bf16 v[56:59], a[36:39], v[192:195], v[56:59]
    ds_read_b64_tr_b16 a[84:85], v4 offset:6208
    ds_read_b64_tr_b16 a[86:87], v4 offset:6976
    v_mfma_f32_16x16x32_bf16 v[60:63], a[40:43], v[192:195], v[60:63]
    ds_read_b128 v[228:231], v132 offset:0
    ds_read_b64_tr_b16 a[88:89], v4 offset:6240
    v_mfma_f32_16x16x32_bf16 v[64:67], a[44:47], v[192:195], v[64:67]
    s_waitcnt lgkmcnt(7)
    v_xor_b32 v136, v136, v166
    v_xor_b32 v137, v137, v166
    v_mfma_f32_16x16x32_bf16 v[64:67], a[56:59], v[196:199], v[64:67]
    buffer_load_dwordx4 v7, s[12:15], s46 offen offset:2048 lds
    v_mfma_f32_16x16x32_bf16 v[60:63], a[52:55], v[196:199], v[60:63]
    ds_read_b128 v[232:235], v132 offset:64
    ds_read_b64_tr_b16 a[90:91], v4 offset:7008
    v_mfma_f32_16x16x32_bf16 v[56:59], a[48:51], v[196:199], v[56:59]
    v_xor_b32 v138, v138, v166
    v_xor_b32 v139, v139, v166
    ds_read_b64_tr_b16 a[92:93], v5 offset:6272
    v_mfma_f32_16x16x32_bf16 v[56:59], a[60:63], v[200:203], v[56:59]
    ds_read_b64_tr_b16 a[94:95], v5 offset:7040
    ds_read_b64_tr_b16 a[96:97], v4 offset:12416
    v_mfma_f32_16x16x32_bf16 v[60:63], a[64:67], v[200:203], v[60:63]
    ds_read_b128 v[236:239], v132 offset:128
    s_add_u32 m0, s45, 37248
    v_mfma_f32_16x16x32_bf16 v[64:67], a[68:71], v[200:203], v[64:67]
    buffer_load_dwordx4 v26, s[12:15], s46 offen offset:0 lds
    ds_read_b64_tr_b16 a[98:99], v4 offset:13184
    v_mfma_f32_16x16x32_bf16 v[68:71], a[36:39], v[204:207], v[68:71]
    v_lshlrev_b32_sdwa v116, 4, v136 dst_sel:DWORD dst_unused:UNUSED_PAD src0_sel:DWORD src1_sel:WORD_0
    v_lshlrev_b32_sdwa v117, 4, v138 dst_sel:DWORD dst_unused:UNUSED_PAD src0_sel:DWORD src1_sel:WORD_0
    v_mfma_f32_16x16x32_bf16 v[72:75], a[40:43], v[204:207], v[72:75]
    ds_read_b128 v[240:243], v133 offset:0
    ds_read_b64_tr_b16 a[100:101], v4 offset:12448
    v_mfma_f32_16x16x32_bf16 v[76:79], a[44:47], v[204:207], v[76:79]
    ds_read_b64_tr_b16 a[102:103], v4 offset:13216
    ds_read_b64_tr_b16 a[104:105], v5 offset:12480
    v_mfma_f32_16x16x32_bf16 v[76:79], a[56:59], v[208:211], v[76:79]
    v_lshlrev_b32_sdwa v118, 4, v136 dst_sel:DWORD dst_unused:UNUSED_PAD src0_sel:DWORD src1_sel:WORD_1
    v_lshlrev_b32_sdwa v119, 4, v138 dst_sel:DWORD dst_unused:UNUSED_PAD src0_sel:DWORD src1_sel:WORD_1
    ds_read_b64_tr_b16 a[106:107], v5 offset:13248
    v_mfma_f32_16x16x32_bf16 v[72:75], a[52:55], v[208:211], v[72:75]
    ds_read_b128 v[244:247], v133 offset:64
    v_mfma_f32_16x16x32_bf16 v[68:71], a[48:51], v[208:211], v[68:71]
    buffer_load_dwordx4 v26, s[12:15], s46 offen offset:1024 lds
    s_add_u32 s46, s46, 18432
    v_mfma_f32_16x16x32_bf16 v[68:71], a[60:63], v[212:215], v[68:71]
    v_lshlrev_b32_sdwa v120, 4, v137 dst_sel:DWORD dst_unused:UNUSED_PAD src0_sel:DWORD src1_sel:WORD_0
    v_lshlrev_b32_sdwa v121, 4, v139 dst_sel:DWORD dst_unused:UNUSED_PAD src0_sel:DWORD src1_sel:WORD_0
    v_mfma_f32_16x16x32_bf16 v[72:75], a[64:67], v[212:215], v[72:75]
    ds_read_b128 v[248:251], v133 offset:128
    v_mfma_f32_16x16x32_bf16 v[76:79], a[68:71], v[212:215], v[76:79]
    s_waitcnt vmcnt(5)
    s_waitcnt lgkmcnt(2)
    s_barrier
    v_mfma_f32_16x16x32_bf16 v[80:83], a[36:39], v[216:219], v[80:83]
    ds_read_b128 v[136:139], v172 offset:1792
    v_mfma_f32_16x16x32_bf16 v[84:87], a[40:43], v[216:219], v[84:87]
    ds_read_b128 v[180:183], v116 offset:0
    v_mfma_f32_16x16x32_bf16 v[88:91], a[44:47], v[216:219], v[88:91]
    ds_read_b64_tr_b16 a[108:109], v4 offset:18624
    v_mfma_f32_16x16x32_bf16 v[88:91], a[56:59], v[220:223], v[88:91]
    ds_read_b64_tr_b16 a[110:111], v4 offset:19392
    v_mfma_f32_16x16x32_bf16 v[84:87], a[52:55], v[220:223], v[84:87]
    ds_read_b128 v[184:187], v116 offset:64
    v_mfma_f32_16x16x32_bf16 v[80:83], a[48:51], v[220:223], v[80:83]
    ds_read_b64_tr_b16 a[112:113], v4 offset:18656
    v_mfma_f32_16x16x32_bf16 v[80:83], a[60:63], v[224:227], v[80:83]
    ds_read_b64_tr_b16 a[114:115], v4 offset:19424
    v_mfma_f32_16x16x32_bf16 v[84:87], a[64:67], v[224:227], v[84:87]
    ds_read_b128 v[188:191], v116 offset:128
    v_mfma_f32_16x16x32_bf16 v[88:91], a[68:71], v[224:227], v[88:91]
    s_waitcnt lgkmcnt(7)
    v_xor_b32 v136, v136, v166
    v_xor_b32 v137, v137, v166
    v_mfma_f32_16x16x32_bf16 v[92:95], a[36:39], v[228:231], v[92:95]
    ds_read_b64_tr_b16 a[116:117], v5 offset:18688
    ds_read_b64_tr_b16 a[118:119], v5 offset:19456
    v_mfma_f32_16x16x32_bf16 v[96:99], a[40:43], v[228:231], v[96:99]
    ds_read_b128 v[192:195], v117 offset:0
    ds_read_b64_tr_b16 a[120:121], v4 offset:24832
    v_mfma_f32_16x16x32_bf16 v[100:103], a[44:47], v[228:231], v[100:103]
    v_xor_b32 v138, v138, v166
    v_xor_b32 v139, v139, v166
    v_mfma_f32_16x16x32_bf16 v[100:103], a[56:59], v[232:235], v[100:103]
    v_lshlrev_b32_sdwa v122, 4, v136 dst_sel:DWORD dst_unused:UNUSED_PAD src0_sel:DWORD src1_sel:WORD_0
    v_lshlrev_b32_sdwa v123, 4, v138 dst_sel:DWORD dst_unused:UNUSED_PAD src0_sel:DWORD src1_sel:WORD_0
    v_mfma_f32_16x16x32_bf16 v[96:99], a[52:55], v[232:235], v[96:99]
    ds_read_b128 v[196:199], v117 offset:64
    v_mfma_f32_16x16x32_bf16 v[92:95], a[48:51], v[232:235], v[92:95]
    v_lshlrev_b32_sdwa v124, 4, v136 dst_sel:DWORD dst_unused:UNUSED_PAD src0_sel:DWORD src1_sel:WORD_1
    v_lshlrev_b32_sdwa v125, 4, v138 dst_sel:DWORD dst_unused:UNUSED_PAD src0_sel:DWORD src1_sel:WORD_1
    v_mfma_f32_16x16x32_bf16 v[92:95], a[60:63], v[236:239], v[92:95]
    ds_read_b64_tr_b16 a[122:123], v4 offset:25600
    v_mfma_f32_16x16x32_bf16 v[96:99], a[64:67], v[236:239], v[96:99]
    ds_read_b128 v[200:203], v117 offset:128
    v_lshlrev_b32_sdwa v126, 4, v137 dst_sel:DWORD dst_unused:UNUSED_PAD src0_sel:DWORD src1_sel:WORD_0
    v_lshlrev_b32_sdwa v127, 4, v139 dst_sel:DWORD dst_unused:UNUSED_PAD src0_sel:DWORD src1_sel:WORD_0
    v_mfma_f32_16x16x32_bf16 v[100:103], a[68:71], v[236:239], v[100:103]
    ds_read_b64_tr_b16 a[124:125], v4 offset:24864
    v_mfma_f32_16x16x32_bf16 v[104:107], a[36:39], v[240:243], v[104:107]
    ds_read_b64_tr_b16 a[126:127], v4 offset:25632
    v_mfma_f32_16x16x32_bf16 v[108:111], a[40:43], v[240:243], v[108:111]
    ds_read_b128 v[204:207], v122 offset:0
    v_mfma_f32_16x16x32_bf16 v[112:115], a[44:47], v[240:243], v[112:115]
    ds_read_b64_tr_b16 a[128:129], v5 offset:24896
    ds_read_b128 v[136:139], v172 offset:2048
    v_mfma_f32_16x16x32_bf16 v[112:115], a[56:59], v[244:247], v[112:115]
    ds_read_b64_tr_b16 a[130:131], v5 offset:25664
    v_mfma_f32_16x16x32_bf16 v[108:111], a[52:55], v[244:247], v[108:111]
    ds_read_b128 v[208:211], v122 offset:64
    v_mfma_f32_16x16x32_bf16 v[104:107], a[48:51], v[244:247], v[104:107]
    ds_read_b64_tr_b16 a[132:133], v4 offset:31040
    v_mfma_f32_16x16x32_bf16 v[104:107], a[60:63], v[248:251], v[104:107]
    ds_read_b64_tr_b16 a[134:135], v4 offset:31808
    v_mfma_f32_16x16x32_bf16 v[108:111], a[64:67], v[248:251], v[108:111]
    ds_read_b128 v[212:215], v122 offset:128
    v_mfma_f32_16x16x32_bf16 v[112:115], a[68:71], v[248:251], v[112:115]
    ds_read_b64_tr_b16 a[136:137], v4 offset:31072
    s_waitcnt lgkmcnt(7)
    v_mfma_f32_16x16x32_bf16 v[44:47], a[72:75], v[180:183], v[44:47]
    ds_read_b64_tr_b16 a[138:139], v4 offset:31840
    v_mfma_f32_16x16x32_bf16 v[48:51], a[76:79], v[180:183], v[48:51]
    ds_read_b128 v[216:219], v123 offset:0
    v_mfma_f32_16x16x32_bf16 v[52:55], a[80:83], v[180:183], v[52:55]
    ds_read_b64_tr_b16 a[140:141], v5 offset:31104
    v_mfma_f32_16x16x32_bf16 v[52:55], a[92:95], v[184:187], v[52:55]
    ds_read_b64_tr_b16 a[142:143], v5 offset:31872
    v_mfma_f32_16x16x32_bf16 v[48:51], a[88:91], v[184:187], v[48:51]
    ds_read_b128 v[220:223], v123 offset:64
    v_mfma_f32_16x16x32_bf16 v[44:47], a[84:87], v[184:187], v[44:47]
    s_waitcnt lgkmcnt(7)
    v_xor_b32 v136, v136, v166
    v_xor_b32 v137, v137, v166
    v_mfma_f32_16x16x32_bf16 v[44:47], a[96:99], v[188:191], v[44:47]
    v_xor_b32 v138, v138, v166
    v_xor_b32 v139, v139, v166
    v_mfma_f32_16x16x32_bf16 v[48:51], a[100:103], v[188:191], v[48:51]
    ds_read_b128 v[224:227], v123 offset:128
    v_mfma_f32_16x16x32_bf16 v[52:55], a[104:107], v[188:191], v[52:55]
    s_waitcnt vmcnt(0)
    s_waitcnt lgkmcnt(2)
    s_barrier
    v_mfma_f32_16x16x32_bf16 v[56:59], a[72:75], v[192:195], v[56:59]
    v_lshlrev_b32_sdwa v128, 4, v136 dst_sel:DWORD dst_unused:UNUSED_PAD src0_sel:DWORD src1_sel:WORD_0
    v_lshlrev_b32_sdwa v129, 4, v138 dst_sel:DWORD dst_unused:UNUSED_PAD src0_sel:DWORD src1_sel:WORD_0
    v_mfma_f32_16x16x32_bf16 v[60:63], a[76:79], v[192:195], v[60:63]
    ds_read_b128 v[228:231], v118 offset:0
    v_mfma_f32_16x16x32_bf16 v[64:67], a[80:83], v[192:195], v[64:67]
    v_lshlrev_b32_sdwa v130, 4, v136 dst_sel:DWORD dst_unused:UNUSED_PAD src0_sel:DWORD src1_sel:WORD_1
    v_lshlrev_b32_sdwa v131, 4, v138 dst_sel:DWORD dst_unused:UNUSED_PAD src0_sel:DWORD src1_sel:WORD_1
    v_mfma_f32_16x16x32_bf16 v[64:67], a[92:95], v[196:199], v[64:67]
    ds_read_b64_tr_b16 a[0:1], v4 offset:37248
    v_mfma_f32_16x16x32_bf16 v[60:63], a[88:91], v[196:199], v[60:63]
    ds_read_b128 v[232:235], v118 offset:64
    v_mfma_f32_16x16x32_bf16 v[56:59], a[84:87], v[196:199], v[56:59]
    ds_read_b64_tr_b16 a[2:3], v4 offset:38016
    ds_read_b64_tr_b16 a[4:5], v4 offset:37280
    v_mfma_f32_16x16x32_bf16 v[56:59], a[96:99], v[200:203], v[56:59]
    v_lshlrev_b32_sdwa v132, 4, v137 dst_sel:DWORD dst_unused:UNUSED_PAD src0_sel:DWORD src1_sel:WORD_0
    v_lshlrev_b32_sdwa v133, 4, v139 dst_sel:DWORD dst_unused:UNUSED_PAD src0_sel:DWORD src1_sel:WORD_0
    v_mfma_f32_16x16x32_bf16 v[60:63], a[100:103], v[200:203], v[60:63]
    ds_read_b128 v[236:239], v118 offset:128
    v_mfma_f32_16x16x32_bf16 v[64:67], a[104:107], v[200:203], v[64:67]
    ds_read_b64_tr_b16 a[6:7], v4 offset:38048
    v_mfma_f32_16x16x32_bf16 v[44:47], a[108:111], v[204:207], v[44:47]
    ds_read_b64_tr_b16 a[8:9], v5 offset:37312
    v_mfma_f32_16x16x32_bf16 v[48:51], a[112:115], v[204:207], v[48:51]
    ds_read_b128 v[240:243], v128 offset:0
    v_mfma_f32_16x16x32_bf16 v[52:55], a[116:119], v[204:207], v[52:55]
    ds_read_b64_tr_b16 a[10:11], v5 offset:38080
    v_mfma_f32_16x16x32_bf16 v[52:55], a[128:131], v[208:211], v[52:55]
    ds_read_b64_tr_b16 a[12:13], v4 offset:43456
    v_mfma_f32_16x16x32_bf16 v[48:51], a[124:127], v[208:211], v[48:51]
    ds_read_b128 v[244:247], v128 offset:64
    v_mfma_f32_16x16x32_bf16 v[44:47], a[120:123], v[208:211], v[44:47]
    ds_read_b64_tr_b16 a[14:15], v4 offset:44224
    v_mfma_f32_16x16x32_bf16 v[44:47], a[132:135], v[212:215], v[44:47]
    ds_read_b64_tr_b16 a[16:17], v4 offset:43488
    v_mfma_f32_16x16x32_bf16 v[48:51], a[136:139], v[212:215], v[48:51]
    ds_read_b128 v[248:251], v128 offset:128
    v_mfma_f32_16x16x32_bf16 v[52:55], a[140:143], v[212:215], v[52:55]
    ds_read_b64_tr_b16 a[18:19], v4 offset:44256
    v_mfma_f32_16x16x32_bf16 v[56:59], a[108:111], v[216:219], v[56:59]
    ds_read_b64_tr_b16 a[20:21], v5 offset:43520
    v_mfma_f32_16x16x32_bf16 v[60:63], a[112:115], v[216:219], v[60:63]
    ds_read_b128 v[180:183], v129 offset:0
    v_mfma_f32_16x16x32_bf16 v[64:67], a[116:119], v[216:219], v[64:67]
    ds_read_b64_tr_b16 a[22:23], v5 offset:44288
    s_waitcnt lgkmcnt(7)
    v_mfma_f32_16x16x32_bf16 v[64:67], a[128:131], v[220:223], v[64:67]
    ds_read_b64_tr_b16 a[24:25], v4 offset:49664
    v_mfma_f32_16x16x32_bf16 v[60:63], a[124:127], v[220:223], v[60:63]
    ds_read_b128 v[184:187], v129 offset:64
    v_mfma_f32_16x16x32_bf16 v[56:59], a[120:123], v[220:223], v[56:59]
    ds_read_b64_tr_b16 a[26:27], v4 offset:50432
    v_mfma_f32_16x16x32_bf16 v[56:59], a[132:135], v[224:227], v[56:59]
    ds_read_b64_tr_b16 a[28:29], v4 offset:49696
    v_mfma_f32_16x16x32_bf16 v[60:63], a[136:139], v[224:227], v[60:63]
    ds_read_b128 v[188:191], v129 offset:128
    v_mfma_f32_16x16x32_bf16 v[64:67], a[140:143], v[224:227], v[64:67]
    ds_read_b64_tr_b16 a[30:31], v4 offset:50464
    v_mfma_f32_16x16x32_bf16 v[68:71], a[72:75], v[228:231], v[68:71]
    ds_read_b64_tr_b16 a[32:33], v5 offset:49728
    v_mfma_f32_16x16x32_bf16 v[72:75], a[76:79], v[228:231], v[72:75]
    ds_read_b128 v[192:195], v124 offset:0
    v_mfma_f32_16x16x32_bf16 v[76:79], a[80:83], v[228:231], v[76:79]
    ds_read_b64_tr_b16 a[34:35], v5 offset:50496
    v_mfma_f32_16x16x32_bf16 v[76:79], a[92:95], v[232:235], v[76:79]
    v_mfma_f32_16x16x32_bf16 v[72:75], a[88:91], v[232:235], v[72:75]
    ds_read_b128 v[196:199], v124 offset:64
    v_mfma_f32_16x16x32_bf16 v[68:71], a[84:87], v[232:235], v[68:71]
    v_mfma_f32_16x16x32_bf16 v[68:71], a[96:99], v[236:239], v[68:71]
    v_mfma_f32_16x16x32_bf16 v[72:75], a[100:103], v[236:239], v[72:75]
    ds_read_b128 v[200:203], v124 offset:128
    v_mfma_f32_16x16x32_bf16 v[76:79], a[104:107], v[236:239], v[76:79]
    v_mfma_f32_16x16x32_bf16 v[44:47], a[0:3], v[240:243], v[44:47]
    v_mfma_f32_16x16x32_bf16 v[48:51], a[4:7], v[240:243], v[48:51]
    ds_read_b128 v[204:207], v130 offset:0
    v_mfma_f32_16x16x32_bf16 v[52:55], a[8:11], v[240:243], v[52:55]
    s_waitcnt lgkmcnt(7)
    v_mfma_f32_16x16x32_bf16 v[52:55], a[20:23], v[244:247], v[52:55]
    v_mfma_f32_16x16x32_bf16 v[48:51], a[16:19], v[244:247], v[48:51]
    ds_read_b128 v[208:211], v130 offset:64
    v_mfma_f32_16x16x32_bf16 v[44:47], a[12:15], v[244:247], v[44:47]
    v_mfma_f32_16x16x32_bf16 v[44:47], a[24:27], v[248:251], v[44:47]
    s_waitcnt lgkmcnt(7)
    v_mfma_f32_16x16x32_bf16 v[48:51], a[28:31], v[248:251], v[48:51]
    ds_read_b128 v[212:215], v130 offset:128
    s_waitcnt lgkmcnt(5)
    v_mfma_f32_16x16x32_bf16 v[52:55], a[32:35], v[248:251], v[52:55]
    v_mfma_f32_16x16x32_bf16 v[56:59], a[0:3], v[180:183], v[56:59]
    v_mfma_f32_16x16x32_bf16 v[60:63], a[4:7], v[180:183], v[60:63]
    ds_read_b128 v[216:219], v119 offset:0
    v_mfma_f32_16x16x32_bf16 v[64:67], a[8:11], v[180:183], v[64:67]
    v_mfma_f32_16x16x32_bf16 v[64:67], a[20:23], v[184:187], v[64:67]
    v_mfma_f32_16x16x32_bf16 v[60:63], a[16:19], v[184:187], v[60:63]
    ds_read_b128 v[220:223], v119 offset:64
    v_mfma_f32_16x16x32_bf16 v[56:59], a[12:15], v[184:187], v[56:59]
    v_cvt_pk_bf16_f32 v32, v44, v45
    v_cvt_pk_bf16_f32 v33, v46, v47
    v_mfma_f32_16x16x32_bf16 v[56:59], a[24:27], v[188:191], v[56:59]
    v_cvt_pk_bf16_f32 v34, v48, v49
    v_cvt_pk_bf16_f32 v35, v50, v51
    v_mfma_f32_16x16x32_bf16 v[60:63], a[28:31], v[188:191], v[60:63]
    ds_read_b128 v[224:227], v119 offset:128
    v_mfma_f32_16x16x32_bf16 v[64:67], a[32:35], v[188:191], v[64:67]
    ds_write_b64 v16, v[32:33] offset:0
    v_mfma_f32_16x16x32_bf16 v[68:71], a[108:111], v[192:195], v[68:71]
    v_cvt_pk_bf16_f32 v36, v52, v53
    v_cvt_pk_bf16_f32 v37, v54, v55
    v_mfma_f32_16x16x32_bf16 v[72:75], a[112:115], v[192:195], v[72:75]
    ds_read_b128 v[228:231], v125 offset:0
    v_mfma_f32_16x16x32_bf16 v[76:79], a[116:119], v[192:195], v[76:79]
    ds_write_b64 v16, v[34:35] offset:32
    s_waitcnt lgkmcnt(7)
    v_mfma_f32_16x16x32_bf16 v[76:79], a[128:131], v[196:199], v[76:79]
    ds_write_b64 v16, v[36:37] offset:64
    v_mfma_f32_16x16x32_bf16 v[72:75], a[124:127], v[196:199], v[72:75]
    ds_read_b128 v[232:235], v125 offset:64
    v_mfma_f32_16x16x32_bf16 v[68:71], a[120:123], v[196:199], v[68:71]
    ds_read_b128 v[38:41], v17
    ds_read_b64 v[42:43], v18
    v_mfma_f32_16x16x32_bf16 v[68:71], a[132:135], v[200:203], v[68:71]
    v_mfma_f32_16x16x32_bf16 v[72:75], a[136:139], v[200:203], v[72:75]
    ds_read_b128 v[236:239], v125 offset:128
    v_mfma_f32_16x16x32_bf16 v[76:79], a[140:143], v[200:203], v[76:79]
    v_mfma_f32_16x16x32_bf16 v[68:71], a[0:3], v[204:207], v[68:71]
    v_mfma_f32_16x16x32_bf16 v[72:75], a[4:7], v[204:207], v[72:75]
    ds_read_b128 v[240:243], v131 offset:0
    s_waitcnt lgkmcnt(3)
    buffer_store_dwordx4 v[38:41], v19, s[16:19], s31 offen sc1
    v_mfma_f32_16x16x32_bf16 v[76:79], a[8:11], v[204:207], v[76:79]
    v_mfma_f32_16x16x32_bf16 v[76:79], a[20:23], v[208:211], v[76:79]
    v_cvt_pk_bf16_f32 v32, v56, v57
    v_cvt_pk_bf16_f32 v33, v58, v59
    v_mfma_f32_16x16x32_bf16 v[72:75], a[16:19], v[208:211], v[72:75]
    ds_read_b128 v[244:247], v131 offset:64
    v_mfma_f32_16x16x32_bf16 v[68:71], a[12:15], v[208:211], v[68:71]
    v_cvt_pk_bf16_f32 v34, v60, v61
    v_cvt_pk_bf16_f32 v35, v62, v63
    v_mfma_f32_16x16x32_bf16 v[68:71], a[24:27], v[212:215], v[68:71]
    ds_write_b64 v16, v[32:33] offset:0
    v_mfma_f32_16x16x32_bf16 v[72:75], a[28:31], v[212:215], v[72:75]
    ds_read_b128 v[248:251], v131 offset:128
    v_mfma_f32_16x16x32_bf16 v[76:79], a[32:35], v[212:215], v[76:79]
    s_waitcnt lgkmcnt(5)
    buffer_store_dwordx2 v[42:43], v20, s[16:19], s31 offen sc1
    s_add_u32 s31, s31, s55
    v_mfma_f32_16x16x32_bf16 v[80:83], a[72:75], v[216:219], v[80:83]
    v_cvt_pk_bf16_f32 v36, v64, v65
    v_cvt_pk_bf16_f32 v37, v66, v67
    v_mfma_f32_16x16x32_bf16 v[84:87], a[76:79], v[216:219], v[84:87]
    ds_read_b128 v[180:183], v120 offset:0
    v_mfma_f32_16x16x32_bf16 v[88:91], a[80:83], v[216:219], v[88:91]
    ds_write_b64 v16, v[34:35] offset:32
    v_mfma_f32_16x16x32_bf16 v[88:91], a[92:95], v[220:223], v[88:91]
    ds_write_b64 v16, v[36:37] offset:64
    ds_read_b128 v[24:27], v17
    v_mfma_f32_16x16x32_bf16 v[84:87], a[88:91], v[220:223], v[84:87]
    ds_read_b128 v[184:187], v120 offset:64
    ds_read_b64 v[28:29], v18
    v_mfma_f32_16x16x32_bf16 v[80:83], a[84:87], v[220:223], v[80:83]
    v_mfma_f32_16x16x32_bf16 v[80:83], a[96:99], v[224:227], v[80:83]
    v_mfma_f32_16x16x32_bf16 v[84:87], a[100:103], v[224:227], v[84:87]
    ds_read_b128 v[188:191], v120 offset:128
    v_mfma_f32_16x16x32_bf16 v[88:91], a[104:107], v[224:227], v[88:91]
    v_mfma_f32_16x16x32_bf16 v[80:83], a[108:111], v[228:231], v[80:83]
    s_waitcnt lgkmcnt(3)
    buffer_store_dwordx4 v[24:27], v19, s[16:19], s31 offen sc1
    v_mfma_f32_16x16x32_bf16 v[84:87], a[112:115], v[228:231], v[84:87]
    ds_read_b128 v[192:195], v126 offset:0
    v_mfma_f32_16x16x32_bf16 v[88:91], a[116:119], v[228:231], v[88:91]
    v_cvt_pk_bf16_f32 v32, v68, v69
    v_cvt_pk_bf16_f32 v33, v70, v71
    v_mfma_f32_16x16x32_bf16 v[88:91], a[128:131], v[232:235], v[88:91]
    v_cvt_pk_bf16_f32 v34, v72, v73
    v_cvt_pk_bf16_f32 v35, v74, v75
    v_mfma_f32_16x16x32_bf16 v[84:87], a[124:127], v[232:235], v[84:87]
    ds_read_b128 v[196:199], v126 offset:64
    v_mfma_f32_16x16x32_bf16 v[80:83], a[120:123], v[232:235], v[80:83]
    ds_write_b64 v16, v[32:33] offset:0
    v_mfma_f32_16x16x32_bf16 v[80:83], a[132:135], v[236:239], v[80:83]
    v_cvt_pk_bf16_f32 v36, v76, v77
    v_cvt_pk_bf16_f32 v37, v78, v79
    v_mfma_f32_16x16x32_bf16 v[84:87], a[136:139], v[236:239], v[84:87]
    ds_read_b128 v[200:203], v126 offset:128
    s_waitcnt lgkmcnt(5)
    buffer_store_dwordx2 v[28:29], v20, s[16:19], s31 offen sc1
    s_add_u32 s31, s31, s55
    v_mfma_f32_16x16x32_bf16 v[88:91], a[140:143], v[236:239], v[88:91]
    ds_write_b64 v16, v[34:35] offset:32
    v_mfma_f32_16x16x32_bf16 v[80:83], a[0:3], v[240:243], v[80:83]
    ds_write_b64 v16, v[36:37] offset:64
    v_mfma_f32_16x16x32_bf16 v[84:87], a[4:7], v[240:243], v[84:87]
    ds_read_b128 v[204:207], v132 offset:0
    v_mfma_f32_16x16x32_bf16 v[88:91], a[8:11], v[240:243], v[88:91]
    ds_read_b128 v[38:41], v17
    v_mfma_f32_16x16x32_bf16 v[88:91], a[20:23], v[244:247], v[88:91]
    ds_read_b64 v[42:43], v18
    v_mfma_f32_16x16x32_bf16 v[84:87], a[16:19], v[244:247], v[84:87]
    ds_read_b128 v[208:211], v132 offset:64
    v_mfma_f32_16x16x32_bf16 v[80:83], a[12:15], v[244:247], v[80:83]
    v_mfma_f32_16x16x32_bf16 v[80:83], a[24:27], v[248:251], v[80:83]
    v_mfma_f32_16x16x32_bf16 v[84:87], a[28:31], v[248:251], v[84:87]
    ds_read_b128 v[212:215], v132 offset:128
    v_mfma_f32_16x16x32_bf16 v[88:91], a[32:35], v[248:251], v[88:91]
    s_waitcnt lgkmcnt(3)
    buffer_store_dwordx4 v[38:41], v19, s[16:19], s31 offen sc1
    v_mfma_f32_16x16x32_bf16 v[92:95], a[72:75], v[180:183], v[92:95]
    v_mfma_f32_16x16x32_bf16 v[96:99], a[76:79], v[180:183], v[96:99]
    ds_read_b128 v[216:219], v121 offset:0
    v_mfma_f32_16x16x32_bf16 v[100:103], a[80:83], v[180:183], v[100:103]
    v_mfma_f32_16x16x32_bf16 v[100:103], a[92:95], v[184:187], v[100:103]
    v_mfma_f32_16x16x32_bf16 v[96:99], a[88:91], v[184:187], v[96:99]
    ds_read_b128 v[220:223], v121 offset:64
    v_mfma_f32_16x16x32_bf16 v[92:95], a[84:87], v[184:187], v[92:95]
    v_cvt_pk_bf16_f32 v32, v80, v81
    v_cvt_pk_bf16_f32 v33, v82, v83
    v_mfma_f32_16x16x32_bf16 v[92:95], a[96:99], v[188:191], v[92:95]
    s_waitcnt lgkmcnt(4)
    buffer_store_dwordx2 v[42:43], v20, s[16:19], s31 offen sc1
    s_add_u32 s31, s31, s55
    v_mfma_f32_16x16x32_bf16 v[96:99], a[100:103], v[188:191], v[96:99]
    ds_read_b128 v[224:227], v121 offset:128
    v_mfma_f32_16x16x32_bf16 v[100:103], a[104:107], v[188:191], v[100:103]
    v_cvt_pk_bf16_f32 v34, v84, v85
    v_cvt_pk_bf16_f32 v35, v86, v87
    v_mfma_f32_16x16x32_bf16 v[92:95], a[108:111], v[192:195], v[92:95]
    ds_write_b64 v16, v[32:33] offset:0
    v_cvt_pk_bf16_f32 v36, v88, v89
    v_cvt_pk_bf16_f32 v37, v90, v91
    v_mfma_f32_16x16x32_bf16 v[96:99], a[112:115], v[192:195], v[96:99]
    ds_read_b128 v[228:231], v127 offset:0
    v_mfma_f32_16x16x32_bf16 v[100:103], a[116:119], v[192:195], v[100:103]
    ds_write_b64 v16, v[34:35] offset:32
    v_mfma_f32_16x16x32_bf16 v[100:103], a[128:131], v[196:199], v[100:103]
    ds_write_b64 v16, v[36:37] offset:64
    v_mfma_f32_16x16x32_bf16 v[96:99], a[124:127], v[196:199], v[96:99]
    ds_read_b128 v[232:235], v127 offset:64
    v_mfma_f32_16x16x32_bf16 v[92:95], a[120:123], v[196:199], v[92:95]
    ds_read_b128 v[24:27], v17
    ds_read_b64 v[28:29], v18
    v_mfma_f32_16x16x32_bf16 v[92:95], a[132:135], v[200:203], v[92:95]
    v_mfma_f32_16x16x32_bf16 v[96:99], a[136:139], v[200:203], v[96:99]
    ds_read_b128 v[236:239], v127 offset:128
    v_mfma_f32_16x16x32_bf16 v[100:103], a[140:143], v[200:203], v[100:103]
    v_mfma_f32_16x16x32_bf16 v[92:95], a[0:3], v[204:207], v[92:95]
    v_mfma_f32_16x16x32_bf16 v[96:99], a[4:7], v[204:207], v[96:99]
    ds_read_b128 v[240:243], v133 offset:0
    s_waitcnt lgkmcnt(3)
    buffer_store_dwordx4 v[24:27], v19, s[16:19], s31 offen sc1
    v_mfma_f32_16x16x32_bf16 v[100:103], a[8:11], v[204:207], v[100:103]
    v_mfma_f32_16x16x32_bf16 v[100:103], a[20:23], v[208:211], v[100:103]
    v_mfma_f32_16x16x32_bf16 v[96:99], a[16:19], v[208:211], v[96:99]
    ds_read_b128 v[244:247], v133 offset:64
    v_mfma_f32_16x16x32_bf16 v[92:95], a[12:15], v[208:211], v[92:95]
    v_mfma_f32_16x16x32_bf16 v[92:95], a[24:27], v[212:215], v[92:95]
    v_mfma_f32_16x16x32_bf16 v[96:99], a[28:31], v[212:215], v[96:99]
    ds_read_b128 v[248:251], v133 offset:128
    v_mfma_f32_16x16x32_bf16 v[100:103], a[32:35], v[212:215], v[100:103]
    s_waitcnt lgkmcnt(4)
    buffer_store_dwordx2 v[28:29], v20, s[16:19], s31 offen sc1
    s_add_u32 s31, s31, s55
    s_cmp_eq_u32 s36, 5
    s_cbranch_scc1 L_Pe6
    v_mfma_f32_16x16x32_bf16 v[104:107], a[72:75], v[216:219], v[104:107]
    v_mfma_f32_16x16x32_bf16 v[108:111], a[76:79], v[216:219], v[108:111]
    v_mfma_f32_16x16x32_bf16 v[112:115], a[80:83], v[216:219], v[112:115]
    v_mfma_f32_16x16x32_bf16 v[112:115], a[92:95], v[220:223], v[112:115]
    v_mfma_f32_16x16x32_bf16 v[108:111], a[88:91], v[220:223], v[108:111]
    v_cvt_pk_bf16_f32 v32, v92, v93
    v_cvt_pk_bf16_f32 v33, v94, v95
    v_mfma_f32_16x16x32_bf16 v[104:107], a[84:87], v[220:223], v[104:107]
    v_cvt_pk_bf16_f32 v34, v96, v97
    v_cvt_pk_bf16_f32 v35, v98, v99
    v_mfma_f32_16x16x32_bf16 v[104:107], a[96:99], v[224:227], v[104:107]
    ds_write_b64 v16, v[32:33] offset:0
    v_mfma_f32_16x16x32_bf16 v[108:111], a[100:103], v[224:227], v[108:111]
    v_mfma_f32_16x16x32_bf16 v[112:115], a[104:107], v[224:227], v[112:115]
    v_cvt_pk_bf16_f32 v36, v100, v101
    v_cvt_pk_bf16_f32 v37, v102, v103
    v_mfma_f32_16x16x32_bf16 v[104:107], a[108:111], v[228:231], v[104:107]
    ds_write_b64 v16, v[34:35] offset:32
    v_mfma_f32_16x16x32_bf16 v[108:111], a[112:115], v[228:231], v[108:111]
    ds_write_b64 v16, v[36:37] offset:64
    v_mfma_f32_16x16x32_bf16 v[112:115], a[116:119], v[228:231], v[112:115]
    v_mfma_f32_16x16x32_bf16 v[112:115], a[128:131], v[232:235], v[112:115]
    ds_read_b128 v[38:41], v17
    v_mfma_f32_16x16x32_bf16 v[108:111], a[124:127], v[232:235], v[108:111]
    ds_read_b64 v[42:43], v18
    v_mfma_f32_16x16x32_bf16 v[104:107], a[120:123], v[232:235], v[104:107]
    s_waitcnt lgkmcnt(7)
    v_mfma_f32_16x16x32_bf16 v[104:107], a[132:135], v[236:239], v[104:107]
    v_mfma_f32_16x16x32_bf16 v[108:111], a[136:139], v[236:239], v[108:111]
    v_mfma_f32_16x16x32_bf16 v[112:115], a[140:143], v[236:239], v[112:115]
    v_mfma_f32_16x16x32_bf16 v[104:107], a[0:3], v[240:243], v[104:107]
    v_mfma_f32_16x16x32_bf16 v[108:111], a[4:7], v[240:243], v[108:111]
    s_waitcnt lgkmcnt(1)
    buffer_store_dwordx4 v[38:41], v19, s[16:19], s31 offen sc1
    v_mfma_f32_16x16x32_bf16 v[112:115], a[8:11], v[240:243], v[112:115]
    v_mfma_f32_16x16x32_bf16 v[112:115], a[20:23], v[244:247], v[112:115]
    v_mfma_f32_16x16x32_bf16 v[108:111], a[16:19], v[244:247], v[108:111]
    v_mfma_f32_16x16x32_bf16 v[104:107], a[12:15], v[244:247], v[104:107]
    v_mfma_f32_16x16x32_bf16 v[104:107], a[24:27], v[248:251], v[104:107]
    v_mfma_f32_16x16x32_bf16 v[108:111], a[28:31], v[248:251], v[108:111]
    v_mfma_f32_16x16x32_bf16 v[112:115], a[32:35], v[248:251], v[112:115]
    s_waitcnt lgkmcnt(0)
    buffer_store_dwordx2 v[42:43], v20, s[16:19], s31 offen sc1
    s_add_u32 s31, s31, s55
    s_cmp_lg_u32 s54, 0
    s_nop 1
    v_cvt_pk_bf16_f32 v32, v104, v105
    v_cvt_pk_bf16_f32 v33, v106, v107
    v_cvt_pk_bf16_f32 v34, v108, v109
    v_cvt_pk_bf16_f32 v35, v110, v111
    ds_write_b64 v16, v[32:33] offset:0
    v_cvt_pk_bf16_f32 v36, v112, v113
    v_cvt_pk_bf16_f32 v37, v114, v115
    ds_write_b64 v16, v[34:35] offset:32
    ds_write_b64 v16, v[36:37] offset:64
    ds_read_b128 v[24:27], v17
    ds_read_b64 v[28:29], v18
    s_waitcnt lgkmcnt(1)
    buffer_store_dwordx4 v[24:27], v19, s[16:19], s31 offen sc1
    s_waitcnt lgkmcnt(0)
    buffer_store_dwordx2 v[28:29], v20, s[16:19], s31 offen sc1
    s_cbranch_scc1 L_gS
    s_endpgm
L_Pe6:
    s_cmp_lg_u32 s54, 0
    v_cvt_pk_bf16_f32 v32, v92, v93
    v_cvt_pk_bf16_f32 v33, v94, v95
    v_cvt_pk_bf16_f32 v34, v96, v97
    v_cvt_pk_bf16_f32 v35, v98, v99
    ds_write_b64 v16, v[32:33] offset:0
    v_cvt_pk_bf16_f32 v36, v100, v101
    v_cvt_pk_bf16_f32 v37, v102, v103
    ds_write_b64 v16, v[34:35] offset:32
    ds_write_b64 v16, v[36:37] offset:64
    ds_read_b128 v[38:41], v17
    ds_read_b64 v[42:43], v18
    s_waitcnt lgkmcnt(1)
    buffer_store_dwordx4 v[38:41], v19, s[16:19], s31 offen sc1
    s_waitcnt lgkmcnt(0)
    buffer_store_dwordx2 v[42:43], v20, s[16:19], s31 offen sc1
    s_cbranch_scc1 L_gS
    s_endpgm
L_Pz:
    s_cmp_le_u32 s72, 11
    s_cbranch_scc1 L_l10
    s_add_u32 m0, s33, 42944
    s_min_i32 s47, s20, s21
    s_add_u32 s20, s20, s55
    buffer_load_dwordx4 v8, s[4:7], s47 offen lds
L_l10:
    s_cmp_le_u32 s72, 12
    s_cbranch_scc1 L_l11
    s_add_u32 m0, s33, 46848
    s_min_i32 s47, s20, s21
    s_add_u32 s20, s20, s55
    buffer_load_dwordx4 v8, s[4:7], s47 offen lds
L_l11:
    s_cmp_le_u32 s72, 13
    s_cbranch_scc1 L_l12
    s_add_u32 m0, s33, 50752
    s_min_i32 s47, s20, s21
    s_add_u32 s20, s20, s55
    buffer_load_dwordx4 v8, s[4:7], s47 offen lds
L_l12:
    s_cmp_le_u32 s72, 14
    s_cbranch_scc1 L_l13
    s_add_u32 m0, s33, 54656
    s_min_i32 s47, s20, s21
    s_add_u32 s20, s20, s55
    buffer_load_dwordx4 v8, s[4:7], s47 offen lds
L_l13:
    s_cmp_le_u32 s72, 15
    s_cbranch_scc1 L_l14
    s_add_u32 m0, s33, 58560
    s_min_i32 s47, s20, s21
    s_add_u32 s20, s20, s55
    buffer_load_dwordx4 v8, s[4:7], s47 offen lds
L_l14:
    s_add_u32 m0, s44, 0
    s_nop 0
    buffer_load_dwordx4 v7, s[12:15], s46 offen offset:0 lds
    buffer_load_dwordx4 v7, s[12:15], s46 offen offset:1024 lds
    s_cmp_eq_u32 s37, 0
    s_cbranch_scc1 L_Ppub
L_Pfail:
    s_movk_i32 s54, 0xff
    s_mov_b32 s37, 0
    s_branch L_Ppub
L_Pn:
    buffer_load_dwordx4 v7, s[12:15], s46 offen offset:2048 lds
    s_add_u32 m0, s45, 0
    s_nop 0
    buffer_load_dwordx4 v26, s[12:15], s46 offen offset:0 lds
    buffer_load_dwordx4 v26, s[12:15], s46 offen offset:1024 lds
    s_add_u32 s46, s46, 18432
    s_waitcnt vmcnt(5) lgkmcnt(0)
    s_barrier
    s_cmp_ge_u32 s36, 4
    s_cbranch_scc1 L_l15
    s_add_u32 m0, s44, 18624
    s_nop 0
    buffer_load_dwordx4 v7, s[12:15], s46 offen offset:0 lds
    buffer_load_dwordx4 v7, s[12:15], s46 offen offset:1024 lds
    buffer_load_dwordx4 v7, s[12:15], s46 offen offset:2048 lds
    s_add_u32 m0, s45, 18624
    s_nop 0
    buffer_load_dwordx4 v26, s[12:15], s46 offen offset:0 lds
    buffer_load_dwordx4 v26, s[12:15], s46 offen offset:1024 lds
    s_add_u32 s46, s46, 18432
L_l15:
L_Pn2:
    ds_read_b128 v[136:139], v172 offset:0
    ds_read_b128 v[144:147], v14
    s_waitcnt lgkmcnt(0)
    v_xor_b32 v136, v136, v166
    v_xor_b32 v137, v137, v166
    v_xor_b32 v138, v138, v166
    v_xor_b32 v139, v139, v166
    v_lshlrev_b32_sdwa v116, 4, v136 dst_sel:DWORD dst_unused:UNUSED_PAD src0_sel:DWORD src1_sel:WORD_0
    v_lshlrev_b32_sdwa v117, 4, v138 dst_sel:DWORD dst_unused:UNUSED_PAD src0_sel:DWORD src1_sel:WORD_0
    v_lshlrev_b32_sdwa v118, 4, v136 dst_sel:DWORD dst_unused:UNUSED_PAD src0_sel:DWORD src1_sel:WORD_1
    v_lshlrev_b32_sdwa v119, 4, v138 dst_sel:DWORD dst_unused:UNUSED_PAD src0_sel:DWORD src1_sel:WORD_1
    v_lshlrev_b32_sdwa v120, 4, v137 dst_sel:DWORD dst_unused:UNUSED_PAD src0_sel:DWORD src1_sel:WORD_0
    v_lshlrev_b32_sdwa v121, 4, v139 dst_sel:DWORD dst_unused:UNUSED_PAD src0_sel:DWORD src1_sel:WORD_0
    v_or3_b32 v144, v144, v145, v146
    v_or_b32 v144, v144, v147
    s_nop 0
    v_readfirstlane_b32 s54, v144
    s_branch L_Pa
L_Pr2:
    v_min_u32 v85, s32, v82
    v_cmp_ge_u32 s[64:65], s32, v82
    v_lshl_add_u32 v83, v85, 3, s38
    ds_read_b64 v[80:81], v83 offset:2048
    v_add_u32 v82, 64, v82
    s_add_u32 s39, s39, 64
    s_waitcnt lgkmcnt(0)
    v_readfirstlane_b32 s53, v78
    v_cvt_f32_ubyte2 v86, v81
    v_cvt_f32_ubyte3 v87, v81
    v_add_u32_sdwa v84, s49, v81 dst_sel:DWORD dst_unused:UNUSED_PAD src0_sel:DWORD src1_sel:WORD_0
    v_add_f32 v86, s68, v86
    v_add_f32 v87, s69, v87
    v_mov_b32 v81, s50
    v_lshlrev_b32 v61, 16, v80
    v_and_b32 v62, 0xffff0000, v80
    v_add_f32 v61, v61, v86
    v_add_f32 v62, v62, v87
    v_cvt_pk_bf16_f32 v60, v61, v62
    v_pk_max_i16 v60, v60, 0
    v_pk_min_i16 v60, v60, s52
    v_alignbit_b32 v60, v60, v60, s42
    v_lshlrev_b32 v61, 16, v60
    v_and_b32 v62, 0xffff0000, v60
    v_fract_f32 v63, v61
    v_fract_f32 v64, v62
    v_cvt_u32_f32 v65, v61
    v_cvt_u32_f32 v66, v62
    v_cmp_neq_f32 s[58:59], 0, v64
    v_cmp_neq_f32 s[60:61], 0, v63
    v_sub_f32 v67, 1.0, v63
    v_sub_f32 v68, 1.0, v64
    v_subrev_u32 v65, s71, v65
    v_subrev_u32 v66, s43, v66
    v_cvt_pk_bf16_f32 v61, v67, v68
    v_addc_co_u32 v74, vcc, 0, v66, s[58:59]
    v_addc_co_u32 v73, vcc, 0, v65, s[60:61]
    v_lshlrev_b32 v67, 16, v61
    v_and_b32 v68, 0xffff0000, v61
    v_mul_u32_u24 v75, 976, v65
    v_mul_f32 v69, v67, v68
    v_mul_f32 v70, v67, v64
    v_mul_f32 v71, v63, v68
    v_mul_f32 v72, v63, v64
    v_max_u32 v73, v73, v65
    v_max_u32 v61, v66, v74
    v_mad_u32_u24 v67, v66, 48, v75
    v_mad_u32_u24 v68, v74, 48, v75
    v_and_b32 v66, 12, v66
    v_and_b32 v74, 12, v74
    s_andn2_b64 s[62:63], s[60:61], s[58:59]
    v_add_lshl_u32 v67, v67, v66, 2
    v_add_lshl_u32 v68, v68, v74, 2
    v_cndmask_b32 v70, v71, v70, s[58:59]
    v_cndmask_b32 v62, 0, v174, s[62:63]
    s_and_b64 s[62:63], s[60:61], s[58:59]
    s_and_b64 s[66:67], s[62:63], s[64:65]
    v_cndmask_b32 v71, 0, v71, s[58:59]
    v_mbcnt_lo_u32_b32 v81, s66, v81
    v_cmp_le_u32 s[60:61], s72, v73
    s_bcnt1_i32_b64 s48, s[66:67]
    v_cmp_lt_u32 s[58:59], 19, v61
    v_mbcnt_hi_u32_b32 v81, s67, v81
    v_lshl_or_b32 v58, v68, 16, v67
    s_add_u32 s50, s50, s48
    v_cvt_pk_bf16_f32 v57, v69, v70
    v_sub_u32 v85, v85, v81
    v_cvt_pk_bf16_f32 v59, v71, v72
    v_sub_u32 v81, s32, v81
    v_and_b32 v62, 0xffff0000, v62
    v_cndmask_b32 v85, v85, v81, s[66:67]
    v_cndmask_b32 v61, 0, v174, s[62:63]
    v_lshl_add_u32 v83, v85, 4, s38
    v_add_u32 v56, v58, v62
    v_add_u32 v85, s53, v85
    v_add_u32 v58, v58, v61
    v_bfe_u32 v81, v85, 1, 2
    v_mad_u32_u24 v85, v85, 12, s35
    v_add_u32 v85, v85, v81
    s_mov_b64 exec, s[64:65]
    ds_write_b128 v83, v[56:59]
    ds_write_b16 v84, v85
    s_mov_b64 exec, -1
    s_or_b64 s[58:59], s[58:59], s[60:61]
    s_cbranch_scc1 L_Pfail
    s_cmp_lt_u32 s39, s37
    s_cbranch_scc1 L_Pr2
    s_branch L_Ppub
L_Pgl:
    s_cmp_eq_u32 s50, 0
    s_cselect_b32 s47, 15, 0
    s_sub_u32 s50, s37, s50
    s_add_u32 s50, s50, s47
    s_mov_b32 s39, 0
    s_waitcnt vmcnt(5)
    s_barrier
    ds_read_b64_tr_b16 v[180:181], v0 offset:0
    ds_read_b64_tr_b16 v[182:183], v2 offset:0
    ds_read_b64_tr_b16 v[184:185], v1 offset:0
    ds_read_b64_tr_b16 v[186:187], v3 offset:0
    ds_read_b64_tr_b16 v[188:189], v0 offset:64
    ds_read_b64_tr_b16 v[190:191], v2 offset:64
    ds_read_b64_tr_b16 v[192:193], v1 offset:64
    ds_read_b64_tr_b16 v[194:195], v3 offset:64
    ds_read_b64_tr_b16 v[196:197], v0 offset:128
    ds_read_b64_tr_b16 v[198:199], v2 offset:128
    ds_read_b64_tr_b16 v[200:201], v1 offset:128
    ds_read_b64_tr_b16 v[202:203], v3 offset:128
    s_cmp_ge_u32 s36, 4
    s_cbranch_scc1 L_l16
    s_add_u32 m0, s44, 18624
    s_nop 0
    buffer_load_dwordx4 v7, s[12:15], s46 offen offset:0 lds
    buffer_load_dwordx4 v7, s[12:15], s46 offen offset:1024 lds
    buffer_load_dwordx4 v7, s[12:15], s46 offen offset:2048 lds
    s_add_u32 m0, s45, 18624
    s_nop 0
    buffer_load_dwordx4 v26, s[12:15], s46 offen offset:0 lds
    buffer_load_dwordx4 v26, s[12:15], s46 offen offset:1024 lds
    s_add_u32 s46, s46, 18432
L_l16:
    s_and_b32 s50, s50, -16
    s_cbranch_scc0 L_Pg4
L_Pl2:
    v_add_u32 v9, s39, v165
    v_min_u32 v9, s32, v9
    v_add_u32 v9, s53, v9
    s_add_u32 s39, s39, 16
    v_bfe_u32 v10, v9, 1, 2
    v_add_u32 v12, s39, v25
    v_mad_u32_u24 v9, v9, 12, v10
    v_min_u32 v12, s32, v12
    v_xor_b32_sdwa v9, v166, v9 dst_sel:DWORD dst_unused:UNUSED_PAD src0_sel:WORD_0 src1_sel:DWORD
    v_lshl_add_u32 v12, v12, 4, s38
    v_lshl_add_u32 v9, v9, 4, s24
    ds_read_b128 v[28:31], v12
    s_waitcnt lgkmcnt(11)
    v_mfma_f32_16x16x32_bf16 v[56:59], v[180:183], v[32:35], 0
    s_waitcnt lgkmcnt(9)
    v_mfma_f32_16x16x32_bf16 v[60:63], v[184:187], v[32:35], 0
    s_waitcnt lgkmcnt(7)
    v_mfma_f32_16x16x32_bf16 v[64:67], v[188:191], v[32:35], 0
    s_waitcnt lgkmcnt(5)
    v_mfma_f32_16x16x32_bf16 v[68:71], v[192:195], v[32:35], 0
    s_waitcnt lgkmcnt(3)
    v_mfma_f32_16x16x32_bf16 v[72:75], v[196:199], v[32:35], 0
    s_waitcnt lgkmcnt(0)
    v_xor_b32_sdwa v0, v28, v164 dst_sel:DWORD dst_unused:UNUSED_PAD src0_sel:WORD_0 src1_sel:DWORD
    v_xor_b32_sdwa v2, v28, v164 dst_sel:DWORD dst_unused:UNUSED_PAD src0_sel:WORD_1 src1_sel:DWORD
    v_xor_b32_sdwa v1, v28, v173 dst_sel:DWORD dst_unused:UNUSED_PAD src0_sel:WORD_0 src1_sel:DWORD
    v_xor_b32_sdwa v3, v28, v173 dst_sel:DWORD dst_unused:UNUSED_PAD src0_sel:WORD_1 src1_sel:DWORD
    v_mfma_f32_16x16x32_bf16 v[76:79], v[200:203], v[32:35], 0
    ds_read_b64_tr_b16 v[180:181], v0 offset:0
    ds_read_b64_tr_b16 v[182:183], v2 offset:0
    ds_read_b64_tr_b16 v[184:185], v1 offset:0
    ds_read_b64_tr_b16 v[186:187], v3 offset:0
    ds_read_b64_tr_b16 v[188:189], v0 offset:64
    ds_read_b64_tr_b16 v[190:191], v2 offset:64
    v_perm_b32 v32, v29, v29, v168
    v_perm_b32 v33, v29, v29, v169
    v_perm_b32 v34, v29, v29, v170
    v_perm_b32 v35, v29, v29, v171
    ds_read_b64_tr_b16 v[192:193], v1 offset:64
    v_cvt_pk_bf16_f32 v80, v56, v57
    ds_read_b64_tr_b16 v[194:195], v3 offset:64
    v_cvt_pk_bf16_f32 v81, v58, v59
    ds_read_b64_tr_b16 v[196:197], v0 offset:128
    v_cvt_pk_bf16_f32 v82, v60, v61
    ds_read_b64_tr_b16 v[198:199], v2 offset:128
    v_cvt_pk_bf16_f32 v83, v62, v63
    ds_read_b64_tr_b16 v[200:201], v1 offset:128
    v_cvt_pk_bf16_f32 v84, v64, v65
    ds_read_b64_tr_b16 v[202:203], v3 offset:128
    v_cvt_pk_bf16_f32 v85, v66, v67
    v_cvt_pk_bf16_f32 v86, v68, v69
    v_cvt_pk_bf16_f32 v87, v70, v71
    v_permlane32_swap_b32 v80, v82
    v_permlane32_swap_b32 v81, v83
    ds_write_b128 v9, v[80:83] offset:0
    v_cvt_pk_bf16_f32 v88, v72, v73
    v_cvt_pk_bf16_f32 v89, v74, v75
    v_cvt_pk_bf16_f32 v90, v76, v77
    v_cvt_pk_bf16_f32 v91, v78, v79
    v_permlane32_swap_b32 v84, v86
    v_permlane32_swap_b32 v85, v87
    ds_write_b128 v9, v[84:87] offset:64
    v_permlane32_swap_b32 v88, v90
    v_permlane32_swap_b32 v89, v91
    ds_write_b128 v9, v[88:91] offset:128
    s_cmp_lt_u32 s39, s50
    s_cbranch_scc1 L_Pl2
    s_cmp_ge_u32 s39, s37
    s_cbranch_scc1 L_Pn2
L_Pg4:
    v_xor_b32_sdwa v40, v30, v164 dst_sel:DWORD dst_unused:UNUSED_PAD src0_sel:WORD_0 src1_sel:DWORD
    v_xor_b32_sdwa v42, v30, v164 dst_sel:DWORD dst_unused:UNUSED_PAD src0_sel:WORD_1 src1_sel:DWORD
    v_xor_b32_sdwa v41, v30, v173 dst_sel:DWORD dst_unused:UNUSED_PAD src0_sel:WORD_0 src1_sel:DWORD
    v_xor_b32_sdwa v43, v30, v173 dst_sel:DWORD dst_unused:UNUSED_PAD src0_sel:WORD_1 src1_sel:DWORD
    v_perm_b32 v36, v31, v31, v168
    v_perm_b32 v37, v31, v31, v169
    v_perm_b32 v38, v31, v31, v170
    v_perm_b32 v39, v31, v31, v171
    ds_read_b64_tr_b16 v[204:205], v40 offset:0
    ds_read_b64_tr_b16 v[206:207], v42 offset:0
    ds_read_b64_tr_b16 v[208:209], v41 offset:0
    ds_read_b64_tr_b16 v[210:211], v43 offset:0
    ds_read_b64_tr_b16 v[212:213], v40 offset:64
    ds_read_b64_tr_b16 v[214:215], v42 offset:64
    ds_read_b64_tr_b16 v[216:217], v41 offset:64
    ds_read_b64_tr_b16 v[218:219], v43 offset:64
    ds_read_b64_tr_b16 v[220:221], v40 offset:128
    ds_read_b64_tr_b16 v[222:223], v42 offset:128
    ds_read_b64_tr_b16 v[224:225], v41 offset:128
    ds_read_b64_tr_b16 v[226:227], v43 offset:128
L_Pl4:
    v_add_u32 v9, s39, v165
    v_min_u32 v9, s32, v9
    v_add_u32 v9, s53, v9
    s_add_u32 s39, s39, 16
    v_bfe_u32 v10, v9, 1, 2
    v_add_u32 v12, s39, v25
    v_mad_u32_u24 v9, v9, 12, v10
    v_min_u32 v12, s32, v12
    v_xor_b32_sdwa v9, v166, v9 dst_sel:DWORD dst_unused:UNUSED_PAD src0_sel:WORD_0 src1_sel:DWORD
    v_lshl_add_u32 v12, v12, 4, s38
    v_lshl_add_u32 v9, v9, 4, s24
    ds_read_b128 v[28:31], v12
    s_waitcnt lgkmcnt(15)
    v_mfma_f32_16x16x32_bf16 v[56:59], v[180:183], v[32:35], 0
    v_mfma_f32_16x16x32_bf16 v[60:63], v[184:187], v[32:35], 0
    v_mfma_f32_16x16x32_bf16 v[64:67], v[188:191], v[32:35], 0
    v_mfma_f32_16x16x32_bf16 v[68:71], v[192:195], v[32:35], 0
    v_mfma_f32_16x16x32_bf16 v[72:75], v[196:199], v[32:35], 0
    s_waitcnt lgkmcnt(13)
    v_mfma_f32_16x16x32_bf16 v[76:79], v[200:203], v[32:35], 0
    s_waitcnt lgkmcnt(11)
    v_mfma_f32_16x16x32_bf16 v[56:59], v[204:207], v[36:39], v[56:59]
    s_waitcnt lgkmcnt(9)
    v_mfma_f32_16x16x32_bf16 v[60:63], v[208:211], v[36:39], v[60:63]
    s_waitcnt lgkmcnt(7)
    v_mfma_f32_16x16x32_bf16 v[64:67], v[212:215], v[36:39], v[64:67]
    s_waitcnt lgkmcnt(5)
    v_mfma_f32_16x16x32_bf16 v[68:71], v[216:219], v[36:39], v[68:71]
    s_waitcnt lgkmcnt(3)
    v_mfma_f32_16x16x32_bf16 v[72:75], v[220:223], v[36:39], v[72:75]
    s_waitcnt lgkmcnt(0)
    v_xor_b32_sdwa v0, v28, v164 dst_sel:DWORD dst_unused:UNUSED_PAD src0_sel:WORD_0 src1_sel:DWORD
    v_xor_b32_sdwa v2, v28, v164 dst_sel:DWORD dst_unused:UNUSED_PAD src0_sel:WORD_1 src1_sel:DWORD
    v_xor_b32_sdwa v1, v28, v173 dst_sel:DWORD dst_unused:UNUSED_PAD src0_sel:WORD_0 src1_sel:DWORD
    v_xor_b32_sdwa v3, v28, v173 dst_sel:DWORD dst_unused:UNUSED_PAD src0_sel:WORD_1 src1_sel:DWORD
    v_mfma_f32_16x16x32_bf16 v[76:79], v[224:227], v[36:39], v[76:79]
    v_xor_b32_sdwa v40, v30, v164 dst_sel:DWORD dst_unused:UNUSED_PAD src0_sel:WORD_0 src1_sel:DWORD
    v_xor_b32_sdwa v42, v30, v164 dst_sel:DWORD dst_unused:UNUSED_PAD src0_sel:WORD_1 src1_sel:DWORD
    v_xor_b32_sdwa v41, v30, v173 dst_sel:DWORD dst_unused:UNUSED_PAD src0_sel:WORD_0 src1_sel:DWORD
    v_xor_b32_sdwa v43, v30, v173 dst_sel:DWORD dst_unused:UNUSED_PAD src0_sel:WORD_1 src1_sel:DWORD
    ds_read_b64_tr_b16 v[180:181], v0 offset:0
    ds_read_b64_tr_b16 v[182:183], v2 offset:0
    ds_read_b64_tr_b16 v[184:185], v1 offset:0
    ds_read_b64_tr_b16 v[186:187], v3 offset:0
    ds_read_b64_tr_b16 v[188:189], v0 offset:64
    ds_read_b64_tr_b16 v[190:191], v2 offset:64
    v_perm_b32 v32, v29, v29, v168
    v_perm_b32 v33, v29, v29, v169
    v_perm_b32 v34, v29, v29, v170
    v_perm_b32 v35, v29, v29, v171
    ds_read_b64_tr_b16 v[192:193], v1 offset:64
    v_cvt_pk_bf16_f32 v80, v56, v57
    ds_read_b64_tr_b16 v[194:195], v3 offset:64
    v_cvt_pk_bf16_f32 v81, v58, v59
    ds_read_b64_tr_b16 v[196:197], v0 offset:128
    v_cvt_pk_bf16_f32 v82, v60, v61
    ds_read_b64_tr_b16 v[198:199], v2 offset:128
    v_cvt_pk_bf16_f32 v83, v62, v63
    ds_read_b64_tr_b16 v[200:201], v1 offset:128
    v_cvt_pk_bf16_f32 v84, v64, v65
    ds_read_b64_tr_b16 v[202:203], v3 offset:128
    v_cvt_pk_bf16_f32 v85, v66, v67
    ds_read_b64_tr_b16 v[204:205], v40 offset:0
    v_cvt_pk_bf16_f32 v86, v68, v69
    ds_read_b64_tr_b16 v[206:207], v42 offset:0
    v_cvt_pk_bf16_f32 v87, v70, v71
    ds_read_b64_tr_b16 v[208:209], v41 offset:0
    v_permlane32_swap_b32 v80, v82
    ds_read_b64_tr_b16 v[210:211], v43 offset:0
    v_permlane32_swap_b32 v81, v83
    ds_read_b64_tr_b16 v[212:213], v40 offset:64
    ds_write_b128 v9, v[80:83] offset:0
    ds_read_b64_tr_b16 v[214:215], v42 offset:64
    v_cvt_pk_bf16_f32 v88, v72, v73
    ds_read_b64_tr_b16 v[216:217], v41 offset:64
    v_cvt_pk_bf16_f32 v89, v74, v75
    ds_read_b64_tr_b16 v[218:219], v43 offset:64
    v_cvt_pk_bf16_f32 v90, v76, v77
    ds_read_b64_tr_b16 v[220:221], v40 offset:128
    v_cvt_pk_bf16_f32 v91, v78, v79
    ds_read_b64_tr_b16 v[222:223], v42 offset:128
    v_permlane32_swap_b32 v84, v86
    ds_read_b64_tr_b16 v[224:225], v41 offset:128
    v_permlane32_swap_b32 v85, v87
    ds_read_b64_tr_b16 v[226:227], v43 offset:128
    ds_write_b128 v9, v[84:87] offset:64
    v_perm_b32 v36, v31, v31, v168
    v_permlane32_swap_b32 v88, v90
    v_perm_b32 v37, v31, v31, v169
    v_permlane32_swap_b32 v89, v91
    v_perm_b32 v38, v31, v31, v170
    ds_write_b128 v9, v[88:91] offset:128
    v_perm_b32 v39, v31, v31, v171
    s_cmp_lt_u32 s39, s37
    s_cbranch_scc1 L_Pl4
    s_branch L_Pn2
L_Pd:
    s_cmp_eq_u32 s36, 3
    s_cbranch_scc1 L_Pj3
    ds_read_b128 v[180:183], v116 offset:0
    ds_read_b64_tr_b16 a[0:1], v4 offset:0
    ds_read_b64_tr_b16 a[2:3], v4 offset:768
    ds_read_b64_tr_b16 a[4:5], v4 offset:32
    ds_read_b64_tr_b16 a[6:7], v4 offset:800
    ds_read_b64_tr_b16 a[8:9], v5 offset:64
    ds_read_b64_tr_b16 a[10:11], v5 offset:832
    ds_read_b128 v[192:195], v117 offset:0
    ds_read_b64_tr_b16 a[12:13], v4 offset:6208
    ds_read_b64_tr_b16 a[14:15], v4 offset:6976
    ds_read_b128 v[136:139], v172 offset:256
    ds_read_b128 v[184:187], v116 offset:64
    ds_read_b64_tr_b16 a[16:17], v4 offset:6240
    s_add_u32 m0, s44, 37248
    s_nop 0
    buffer_load_dwordx4 v7, s[12:15], s46 offen offset:0 lds
    ds_read_b64_tr_b16 a[18:19], v4 offset:7008
    ds_read_b64_tr_b16 a[20:21], v5 offset:6272
    ds_read_b64_tr_b16 a[22:23], v5 offset:7040
    ds_read_b128 v[196:199], v117 offset:64
    buffer_load_dwordx4 v7, s[12:15], s46 offen offset:1024 lds
    ds_read_b128 v[188:191], v116 offset:128
    ds_read_b64_tr_b16 a[24:25], v4 offset:12416
    ds_read_b64_tr_b16 a[26:27], v4 offset:13184
    ds_read_b64_tr_b16 a[28:29], v4 offset:12448
    buffer_load_dwordx4 v7, s[12:15], s46 offen offset:2048 lds
    ds_read_b64_tr_b16 a[30:31], v4 offset:13216
    ds_read_b64_tr_b16 a[32:33], v5 offset:12480
    ds_read_b64_tr_b16 a[34:35], v5 offset:13248
    ds_read_b128 v[200:203], v117 offset:128
    s_add_u32 m0, s45, 37248
    s_nop 0
    buffer_load_dwordx4 v26, s[12:15], s46 offen offset:0 lds
    s_waitcnt lgkmcnt(7)
    v_xor_b32 v136, v136, v166
    v_xor_b32 v138, v138, v166
    v_lshlrev_b32_sdwa v122, 4, v136 dst_sel:DWORD dst_unused:UNUSED_PAD src0_sel:DWORD src1_sel:WORD_0
    v_lshlrev_b32_sdwa v123, 4, v138 dst_sel:DWORD dst_unused:UNUSED_PAD src0_sel:DWORD src1_sel:WORD_0
    buffer_load_dwordx4 v26, s[12:15], s46 offen offset:1024 lds
    s_add_u32 s46, s46, 18432
    v_mfma_f32_16x16x32_bf16 v[44:47], a[0:3], v[180:183], 0
    s_waitcnt lgkmcnt(1)
    s_barrier
    v_mfma_f32_16x16x32_bf16 v[48:51], a[4:7], v[180:183], 0
    ds_read_b128 v[204:207], v122 offset:0
    s_add_u32 m0, s44, 0
    ds_read_b128 v[136:139], v172 offset:512
    v_mfma_f32_16x16x32_bf16 v[52:55], a[8:11], v[180:183], 0
    buffer_load_dwordx4 v7, s[12:15], s46 offen offset:0 lds
    ds_read_b64_tr_b16 a[36:37], v4 offset:18624
    v_mfma_f32_16x16x32_bf16 v[56:59], a[0:3], v[192:195], 0
    ds_read_b64_tr_b16 a[38:39], v4 offset:19392
    ds_read_b64_tr_b16 a[40:41], v4 offset:18656
    v_mfma_f32_16x16x32_bf16 v[60:63], a[4:7], v[192:195], 0
    ds_read_b128 v[208:211], v122 offset:64
    ds_read_b64_tr_b16 a[42:43], v4 offset:19424
    v_mfma_f32_16x16x32_bf16 v[64:67], a[8:11], v[192:195], 0
    buffer_load_dwordx4 v7, s[12:15], s46 offen offset:1024 lds
    v_mfma_f32_16x16x32_bf16 v[52:55], a[20:23], v[184:187], v[52:55]
    ds_read_b64_tr_b16 a[44:45], v5 offset:18688
    ds_read_b64_tr_b16 a[46:47], v5 offset:19456
    v_mfma_f32_16x16x32_bf16 v[48:51], a[16:19], v[184:187], v[48:51]
    ds_read_b128 v[212:215], v122 offset:128
    ds_read_b64_tr_b16 a[48:49], v4 offset:24832
    v_mfma_f32_16x16x32_bf16 v[44:47], a[12:15], v[184:187], v[44:47]
    buffer_load_dwordx4 v7, s[12:15], s46 offen offset:2048 lds
    ds_read_b64_tr_b16 a[50:51], v4 offset:25600
    v_mfma_f32_16x16x32_bf16 v[64:67], a[20:23], v[196:199], v[64:67]
    ds_read_b64_tr_b16 a[52:53], v4 offset:24864
    ds_read_b64_tr_b16 a[54:55], v4 offset:25632
    v_mfma_f32_16x16x32_bf16 v[60:63], a[16:19], v[196:199], v[60:63]
    ds_read_b128 v[216:219], v123 offset:0
    s_add_u32 m0, s45, 0
    v_mfma_f32_16x16x32_bf16 v[56:59], a[12:15], v[196:199], v[56:59]
    buffer_load_dwordx4 v26, s[12:15], s46 offen offset:0 lds
    ds_read_b64_tr_b16 a[56:57], v5 offset:24896
    ds_read_b64_tr_b16 a[58:59], v5 offset:25664
    v_mfma_f32_16x16x32_bf16 v[44:47], a[24:27], v[188:191], v[44:47]
    ds_read_b64_tr_b16 a[60:61], v4 offset:31040
    ds_read_b64_tr_b16 a[62:63], v4 offset:31808
    v_mfma_f32_16x16x32_bf16 v[48:51], a[28:31], v[188:191], v[48:51]
    ds_read_b128 v[220:223], v123 offset:64
    ds_read_b64_tr_b16 a[64:65], v4 offset:31072
    v_mfma_f32_16x16x32_bf16 v[52:55], a[32:35], v[188:191], v[52:55]
    buffer_load_dwordx4 v26, s[12:15], s46 offen offset:1024 lds
    s_add_u32 s46, s46, 18432
    s_waitcnt lgkmcnt(7)
    v_mfma_f32_16x16x32_bf16 v[56:59], a[24:27], v[200:203], v[56:59]
    ds_read_b64_tr_b16 a[66:67], v4 offset:31840
    ds_read_b64_tr_b16 a[68:69], v5 offset:31104
    ds_read_b64_tr_b16 a[70:71], v5 offset:31872
    v_mfma_f32_16x16x32_bf16 v[60:63], a[28:31], v[200:203], v[60:63]
    ds_read_b128 v[224:227], v123 offset:128
    v_xor_b32 v136, v136, v166
    v_xor_b32 v138, v138, v166
    v_lshlrev_b32_sdwa v128, 4, v136 dst_sel:DWORD dst_unused:UNUSED_PAD src0_sel:DWORD src1_sel:WORD_0
    v_lshlrev_b32_sdwa v129, 4, v138 dst_sel:DWORD dst_unused:UNUSED_PAD src0_sel:DWORD src1_sel:WORD_0
    v_mfma_f32_16x16x32_bf16 v[64:67], a[32:35], v[200:203], v[64:67]
    s_waitcnt vmcnt(5)
    s_waitcnt lgkmcnt(1)
    s_barrier
    v_mfma_f32_16x16x32_bf16 v[44:47], a[36:39], v[204:207], v[44:47]
    ds_read_b64_tr_b16 a[72:73], v4 offset:37248
    ds_read_b64_tr_b16 a[74:75], v4 offset:38016
    v_mfma_f32_16x16x32_bf16 v[48:51], a[40:43], v[204:207], v[48:51]
    ds_read_b128 v[228:231], v128 offset:0
    s_add_u32 m0, s44, 18624
    ds_read_b128 v[136:139], v172 offset:768
    v_mfma_f32_16x16x32_bf16 v[52:55], a[44:47], v[204:207], v[52:55]
    buffer_load_dwordx4 v7, s[12:15], s46 offen offset:0 lds
    v_mfma_f32_16x16x32_bf16 v[52:55], a[56:59], v[208:211], v[52:55]
    ds_read_b64_tr_b16 a[76:77], v4 offset:37280
    ds_read_b64_tr_b16 a[78:79], v4 offset:38048
    v_mfma_f32_16x16x32_bf16 v[48:51], a[52:55], v[208:211], v[48:51]
    ds_read_b128 v[232:235], v128 offset:64
    ds_read_b64_tr_b16 a[80:81], v5 offset:37312
    v_mfma_f32_16x16x32_bf16 v[44:47], a[48:51], v[208:211], v[44:47]
    buffer_load_dwordx4 v7, s[12:15], s46 offen offset:1024 lds
    v_mfma_f32_16x16x32_bf16 v[44:47], a[60:63], v[212:215], v[44:47]
    ds_read_b64_tr_b16 a[82:83], v5 offset:38080
    ds_read_b64_tr_b16 a[84:85], v4 offset:43456
    v_mfma_f32_16x16x32_bf16 v[48:51], a[64:67], v[212:215], v[48:51]
    ds_read_b128 v[236:239], v128 offset:128
    ds_read_b64_tr_b16 a[86:87], v4 offset:44224
    v_mfma_f32_16x16x32_bf16 v[52:55], a[68:71], v[212:215], v[52:55]
    buffer_load_dwordx4 v7, s[12:15], s46 offen offset:2048 lds
    ds_read_b64_tr_b16 a[88:89], v4 offset:43488
    v_mfma_f32_16x16x32_bf16 v[56:59], a[36:39], v[216:219], v[56:59]
    ds_read_b64_tr_b16 a[90:91], v4 offset:44256
    ds_read_b64_tr_b16 a[92:93], v5 offset:43520
    v_mfma_f32_16x16x32_bf16 v[60:63], a[40:43], v[216:219], v[60:63]
    ds_read_b128 v[240:243], v129 offset:0
    s_add_u32 m0, s45, 18624
    v_mfma_f32_16x16x32_bf16 v[64:67], a[44:47], v[216:219], v[64:67]
    buffer_load_dwordx4 v26, s[12:15], s46 offen offset:0 lds
    ds_read_b64_tr_b16 a[94:95], v5 offset:44288
    v_mfma_f32_16x16x32_bf16 v[64:67], a[56:59], v[220:223], v[64:67]
    ds_read_b64_tr_b16 a[96:97], v4 offset:49664
    ds_read_b64_tr_b16 a[98:99], v4 offset:50432
    v_mfma_f32_16x16x32_bf16 v[60:63], a[52:55], v[220:223], v[60:63]
    ds_read_b128 v[244:247], v129 offset:64
    ds_read_b64_tr_b16 a[100:101], v4 offset:49696
    v_mfma_f32_16x16x32_bf16 v[56:59], a[48:51], v[220:223], v[56:59]
    buffer_load_dwordx4 v26, s[12:15], s46 offen offset:1024 lds
    s_add_u32 s46, s46, 18432
    s_waitcnt lgkmcnt(7)
    v_mfma_f32_16x16x32_bf16 v[56:59], a[60:63], v[224:227], v[56:59]
    ds_read_b64_tr_b16 a[102:103], v4 offset:50464
    ds_read_b64_tr_b16 a[104:105], v5 offset:49728
    ds_read_b64_tr_b16 a[106:107], v5 offset:50496
    v_mfma_f32_16x16x32_bf16 v[60:63], a[64:67], v[224:227], v[60:63]
    ds_read_b128 v[248:251], v129 offset:128
    v_xor_b32 v136, v136, v166
    v_xor_b32 v138, v138, v166
    v_lshlrev_b32_sdwa v116, 4, v136 dst_sel:DWORD dst_unused:UNUSED_PAD src0_sel:DWORD src1_sel:WORD_0
    v_lshlrev_b32_sdwa v117, 4, v138 dst_sel:DWORD dst_unused:UNUSED_PAD src0_sel:DWORD src1_sel:WORD_0
    v_mfma_f32_16x16x32_bf16 v[64:67], a[68:71], v[224:227], v[64:67]
    s_waitcnt vmcnt(5)
    s_waitcnt lgkmcnt(1)
    s_barrier
    v_mfma_f32_16x16x32_bf16 v[44:47], a[72:75], v[228:231], v[44:47]
    ds_read_b64_tr_b16 a[108:109], v4 offset:0
    ds_read_b64_tr_b16 a[110:111], v4 offset:768
    v_mfma_f32_16x16x32_bf16 v[48:51], a[76:79], v[228:231], v[48:51]
    ds_read_b128 v[180:183], v116 offset:0
    s_add_u32 m0, s44, 37248
    ds_read_b128 v[136:139], v172 offset:1024
    v_mfma_f32_16x16x32_bf16 v[52:55], a[80:83], v[228:231], v[52:55]
    buffer_load_dwordx4 v7, s[12:15], s46 offen offset:0 lds
    v_mfma_f32_16x16x32_bf16 v[52:55], a[92:95], v[232:235], v[52:55]
    ds_read_b64_tr_b16 a[112:113], v4 offset:32
    ds_read_b64_tr_b16 a[114:115], v4 offset:800
    v_mfma_f32_16x16x32_bf16 v[48:51], a[88:91], v[232:235], v[48:51]
    ds_read_b128 v[184:187], v116 offset:64
    ds_read_b64_tr_b16 a[116:117], v5 offset:64
    v_mfma_f32_16x16x32_bf16 v[44:47], a[84:87], v[232:235], v[44:47]
    buffer_load_dwordx4 v7, s[12:15], s46 offen offset:1024 lds
    v_mfma_f32_16x16x32_bf16 v[44:47], a[96:99], v[236:239], v[44:47]
    ds_read_b64_tr_b16 a[118:119], v5 offset:832
    ds_read_b64_tr_b16 a[120:121], v4 offset:6208
    v_mfma_f32_16x16x32_bf16 v[48:51], a[100:103], v[236:239], v[48:51]
    ds_read_b128 v[188:191], v116 offset:128
    ds_read_b64_tr_b16 a[122:123], v4 offset:6976
    v_mfma_f32_16x16x32_bf16 v[52:55], a[104:107], v[236:239], v[52:55]
    buffer_load_dwordx4 v7, s[12:15], s46 offen offset:2048 lds
    ds_read_b64_tr_b16 a[124:125], v4 offset:6240
    v_mfma_f32_16x16x32_bf16 v[56:59], a[72:75], v[240:243], v[56:59]
    ds_read_b64_tr_b16 a[126:127], v4 offset:7008
    ds_read_b64_tr_b16 a[128:129], v5 offset:6272
    v_mfma_f32_16x16x32_bf16 v[60:63], a[76:79], v[240:243], v[60:63]
    ds_read_b128 v[192:195], v117 offset:0
    s_add_u32 m0, s45, 37248
    v_mfma_f32_16x16x32_bf16 v[64:67], a[80:83], v[240:243], v[64:67]
    buffer_load_dwordx4 v26, s[12:15], s46 offen offset:0 lds
    ds_read_b64_tr_b16 a[130:131], v5 offset:7040
    v_mfma_f32_16x16x32_bf16 v[64:67], a[92:95], v[244:247], v[64:67]
    ds_read_b64_tr_b16 a[132:133], v4 offset:12416
    ds_read_b64_tr_b16 a[134:135], v4 offset:13184
    v_mfma_f32_16x16x32_bf16 v[60:63], a[88:91], v[244:247], v[60:63]
    ds_read_b128 v[196:199], v117 offset:64
    ds_read_b64_tr_b16 a[136:137], v4 offset:12448
    v_mfma_f32_16x16x32_bf16 v[56:59], a[84:87], v[244:247], v[56:59]
    buffer_load_dwordx4 v26, s[12:15], s46 offen offset:1024 lds
    s_add_u32 s46, s46, 18432
    s_waitcnt lgkmcnt(7)
    v_mfma_f32_16x16x32_bf16 v[56:59], a[96:99], v[248:251], v[56:59]
    ds_read_b64_tr_b16 a[138:139], v4 offset:13216
    ds_read_b64_tr_b16 a[140:141], v5 offset:12480
    ds_read_b64_tr_b16 a[142:143], v5 offset:13248
    v_mfma_f32_16x16x32_bf16 v[60:63], a[100:103], v[248:251], v[60:63]
    ds_read_b128 v[200:203], v117 offset:128
    v_xor_b32 v136, v136, v166
    v_xor_b32 v138, v138, v166
    v_lshlrev_b32_sdwa v122, 4, v136 dst_sel:DWORD dst_unused:UNUSED_PAD src0_sel:DWORD src1_sel:WORD_0
    v_lshlrev_b32_sdwa v123, 4, v138 dst_sel:DWORD dst_unused:UNUSED_PAD src0_sel:DWORD src1_sel:WORD_0
    v_mfma_f32_16x16x32_bf16 v[64:67], a[104:107], v[248:251], v[64:67]
    s_waitcnt vmcnt(5)
    s_waitcnt lgkmcnt(1)
    s_barrier
    v_mfma_f32_16x16x32_bf16 v[44:47], a[108:111], v[180:183], v[44:47]
    ds_read_b64_tr_b16 a[0:1], v4 offset:18624
    ds_read_b64_tr_b16 a[2:3], v4 offset:19392
    v_mfma_f32_16x16x32_bf16 v[48:51], a[112:115], v[180:183], v[48:51]
    ds_read_b128 v[204:207], v122 offset:0
    s_add_u32 m0, s44, 0
    ds_read_b128 v[136:139], v172 offset:1280
    v_mfma_f32_16x16x32_bf16 v[52:55], a[116:119], v[180:183], v[52:55]
    buffer_load_dwordx4 v7, s[12:15], s46 offen offset:0 lds
    v_mfma_f32_16x16x32_bf16 v[52:55], a[128:131], v[184:187], v[52:55]
    ds_read_b64_tr_b16 a[4:5], v4 offset:18656
    ds_read_b64_tr_b16 a[6:7], v4 offset:19424
    v_mfma_f32_16x16x32_bf16 v[48:51], a[124:127], v[184:187], v[48:51]
    ds_read_b128 v[208:211], v122 offset:64
    ds_read_b64_tr_b16 a[8:9], v5 offset:18688
    v_mfma_f32_16x16x32_bf16 v[44:47], a[120:123], v[184:187], v[44:47]
    buffer_load_dwordx4 v7, s[12:15], s46 offen offset:1024 lds
    v_mfma_f32_16x16x32_bf16 v[44:47], a[132:135], v[188:191], v[44:47]
    ds_read_b64_tr_b16 a[10:11], v5 offset:19456
    ds_read_b64_tr_b16 a[12:13], v4 offset:24832
    v_mfma_f32_16x16x32_bf16 v[48:51], a[136:139], v[188:191], v[48:51]
    ds_read_b128 v[212:215], v122 offset:128
    ds_read_b64_tr_b16 a[14:15], v4 offset:25600
    v_mfma_f32_16x16x32_bf16 v[52:55], a[140:143], v[188:191], v[52:55]
    buffer_load_dwordx4 v7, s[12:15], s46 offen offset:2048 lds
    ds_read_b64_tr_b16 a[16:17], v4 offset:24864
    v_mfma_f32_16x16x32_bf16 v[56:59], a[108:111], v[192:195], v[56:59]
    ds_read_b64_tr_b16 a[18:19], v4 offset:25632
    ds_read_b64_tr_b16 a[20:21], v5 offset:24896
    v_mfma_f32_16x16x32_bf16 v[60:63], a[112:115], v[192:195], v[60:63]
    ds_read_b128 v[216:219], v123 offset:0
    s_add_u32 m0, s45, 0
    v_mfma_f32_16x16x32_bf16 v[64:67], a[116:119], v[192:195], v[64:67]
    buffer_load_dwordx4 v26, s[12:15], s46 offen offset:0 lds
    ds_read_b64_tr_b16 a[22:23], v5 offset:25664
    v_mfma_f32_16x16x32_bf16 v[64:67], a[128:131], v[196:199], v[64:67]
    ds_read_b64_tr_b16 a[24:25], v4 offset:31040
    ds_read_b64_tr_b16 a[26:27], v4 offset:31808
    v_mfma_f32_16x16x32_bf16 v[60:63], a[124:127], v[196:199], v[60:63]
    ds_read_b128 v[220:223], v123 offset:64
    ds_read_b64_tr_b16 a[28:29], v4 offset:31072
    v_mfma_f32_16x16x32_bf16 v[56:59], a[120:123], v[196:199], v[56:59]
    buffer_load_dwordx4 v26, s[12:15], s46 offen offset:1024 lds
    s_add_u32 s46, s46, 18432
    s_waitcnt lgkmcnt(7)
    v_mfma_f32_16x16x32_bf16 v[56:59], a[132:135], v[200:203], v[56:59]
    ds_read_b64_tr_b16 a[30:31], v4 offset:31840
    ds_read_b64_tr_b16 a[32:33], v5 offset:31104
    ds_read_b64_tr_b16 a[34:35], v5 offset:31872
    v_mfma_f32_16x16x32_bf16 v[60:63], a[136:139], v[200:203], v[60:63]
    ds_read_b128 v[224:227], v123 offset:128
    v_xor_b32 v136, v136, v166
    v_xor_b32 v138, v138, v166
    v_lshlrev_b32_sdwa v128, 4, v136 dst_sel:DWORD dst_unused:UNUSED_PAD src0_sel:DWORD src1_sel:WORD_0
    v_lshlrev_b32_sdwa v129, 4, v138 dst_sel:DWORD dst_unused:UNUSED_PAD src0_sel:DWORD src1_sel:WORD_0
    v_mfma_f32_16x16x32_bf16 v[64:67], a[140:143], v[200:203], v[64:67]
    s_waitcnt vmcnt(5)
    s_waitcnt lgkmcnt(1)
    s_barrier
    v_mfma_f32_16x16x32_bf16 v[44:47], a[0:3], v[204:207], v[44:47]
    ds_read_b64_tr_b16 a[36:37], v4 offset:37248
    ds_read_b64_tr_b16 a[38:39], v4 offset:38016
    v_mfma_f32_16x16x32_bf16 v[48:51], a[4:7], v[204:207], v[48:51]
    ds_read_b128 v[228:231], v128 offset:0
    s_add_u32 m0, s44, 18624
    ds_read_b128 v[136:139], v172 offset:1536
    v_mfma_f32_16x16x32_bf16 v[52:55], a[8:11], v[204:207], v[52:55]
    buffer_load_dwordx4 v7, s[12:15], s46 offen offset:0 lds
    v_mfma_f32_16x16x32_bf16 v[52:55], a[20:23], v[208:211], v[52:55]
    ds_read_b64_tr_b16 a[40:41], v4 offset:37280
    ds_read_b64_tr_b16 a[42:43], v4 offset:38048
    v_mfma_f32_16x16x32_bf16 v[48:51], a[16:19], v[208:211], v[48:51]
    ds_read_b128 v[232:235], v128 offset:64
    ds_read_b64_tr_b16 a[44:45], v5 offset:37312
    v_mfma_f32_16x16x32_bf16 v[44:47], a[12:15], v[208:211], v[44:47]
    buffer_load_dwordx4 v7, s[12:15], s46 offen offset:1024 lds
    v_mfma_f32_16x16x32_bf16 v[44:47], a[24:27], v[212:215], v[44:47]
    ds_read_b64_tr_b16 a[46:47], v5 offset:38080
    ds_read_b64_tr_b16 a[48:49], v4 offset:43456
    v_mfma_f32_16x16x32_bf16 v[48:51], a[28:31], v[212:215], v[48:51]
    ds_read_b128 v[236:239], v128 offset:128
    ds_read_b64_tr_b16 a[50:51], v4 offset:44224
    v_mfma_f32_16x16x32_bf16 v[52:55], a[32:35], v[212:215], v[52:55]
    buffer_load_dwordx4 v7, s[12:15], s46 offen offset:2048 lds
    ds_read_b64_tr_b16 a[52:53], v4 offset:43488
    v_mfma_f32_16x16x32_bf16 v[56:59], a[0:3], v[216:219], v[56:59]
    ds_read_b64_tr_b16 a[54:55], v4 offset:44256
    ds_read_b64_tr_b16 a[56:57], v5 offset:43520
    v_mfma_f32_16x16x32_bf16 v[60:63], a[4:7], v[216:219], v[60:63]
    ds_read_b128 v[240:243], v129 offset:0
    s_add_u32 m0, s45, 18624
    v_mfma_f32_16x16x32_bf16 v[64:67], a[8:11], v[216:219], v[64:67]
    buffer_load_dwordx4 v26, s[12:15], s46 offen offset:0 lds
    ds_read_b64_tr_b16 a[58:59], v5 offset:44288
    v_mfma_f32_16x16x32_bf16 v[64:67], a[20:23], v[220:223], v[64:67]
    ds_read_b64_tr_b16 a[60:61], v4 offset:49664
    ds_read_b64_tr_b16 a[62:63], v4 offset:50432
    v_mfma_f32_16x16x32_bf16 v[60:63], a[16:19], v[220:223], v[60:63]
    ds_read_b128 v[244:247], v129 offset:64
    ds_read_b64_tr_b16 a[64:65], v4 offset:49696
    v_mfma_f32_16x16x32_bf16 v[56:59], a[12:15], v[220:223], v[56:59]
    buffer_load_dwordx4 v26, s[12:15], s46 offen offset:1024 lds
    s_add_u32 s46, s46, 18432
    s_waitcnt lgkmcnt(7)
    v_mfma_f32_16x16x32_bf16 v[56:59], a[24:27], v[224:227], v[56:59]
    ds_read_b64_tr_b16 a[66:67], v4 offset:50464
    ds_read_b64_tr_b16 a[68:69], v5 offset:49728
    ds_read_b64_tr_b16 a[70:71], v5 offset:50496
    v_mfma_f32_16x16x32_bf16 v[60:63], a[28:31], v[224:227], v[60:63]
    ds_read_b128 v[248:251], v129 offset:128
    v_xor_b32 v136, v136, v166
    v_xor_b32 v138, v138, v166
    v_lshlrev_b32_sdwa v116, 4, v136 dst_sel:DWORD dst_unused:UNUSED_PAD src0_sel:DWORD src1_sel:WORD_0
    v_lshlrev_b32_sdwa v117, 4, v138 dst_sel:DWORD dst_unused:UNUSED_PAD src0_sel:DWORD src1_sel:WORD_0
    v_mfma_f32_16x16x32_bf16 v[64:67], a[32:35], v[224:227], v[64:67]
    s_waitcnt vmcnt(5)
    s_waitcnt lgkmcnt(1)
    s_barrier
    v_mfma_f32_16x16x32_bf16 v[44:47], a[36:39], v[228:231], v[44:47]
    ds_read_b64_tr_b16 a[72:73], v4 offset:0
    ds_read_b64_tr_b16 a[74:75], v4 offset:768
    v_mfma_f32_16x16x32_bf16 v[48:51], a[40:43], v[228:231], v[48:51]
    ds_read_b128 v[180:183], v116 offset:0
    s_add_u32 m0, s44, 37248
    ds_read_b128 v[136:139], v172 offset:1792
    v_mfma_f32_16x16x32_bf16 v[52:55], a[44:47], v[228:231], v[52:55]
    buffer_load_dwordx4 v7, s[12:15], s46 offen offset:0 lds
    v_mfma_f32_16x16x32_bf16 v[52:55], a[56:59], v[232:235], v[52:55]
    ds_read_b64_tr_b16 a[76:77], v4 offset:32
    ds_read_b64_tr_b16 a[78:79], v4 offset:800
    v_mfma_f32_16x16x32_bf16 v[48:51], a[52:55], v[232:235], v[48:51]
    ds_read_b128 v[184:187], v116 offset:64
    ds_read_b64_tr_b16 a[80:81], v5 offset:64
    v_mfma_f32_16x16x32_bf16 v[44:47], a[48:51], v[232:235], v[44:47]
    buffer_load_dwordx4 v7, s[12:15], s46 offen offset:1024 lds
    v_mfma_f32_16x16x32_bf16 v[44:47], a[60:63], v[236:239], v[44:47]
    ds_read_b64_tr_b16 a[82:83], v5 offset:832
    ds_read_b64_tr_b16 a[84:85], v4 offset:6208
    v_mfma_f32_16x16x32_bf16 v[48:51], a[64:67], v[236:239], v[48:51]
    ds_read_b128 v[188:191], v116 offset:128
    ds_read_b64_tr_b16 a[86:87], v4 offset:6976
    v_mfma_f32_16x16x32_bf16 v[52:55], a[68:71], v[236:239], v[52:55]
    buffer_load_dwordx4 v7, s[12:15], s46 offen offset:2048 lds
    ds_read_b64_tr_b16 a[88:89], v4 offset:6240
    v_mfma_f32_16x16x32_bf16 v[56:59], a[36:39], v[240:243], v[56:59]
    ds_read_b64_tr_b16 a[90:91], v4 offset:7008
    ds_read_b64_tr_b16 a[92:93], v5 offset:6272
    v_mfma_f32_16x16x32_bf16 v[60:63], a[40:43], v[240:243], v[60:63]
    ds_read_b128 v[192:195], v117 offset:0
    s_add_u32 m0, s45, 37248
    v_mfma_f32_16x16x32_bf16 v[64:67], a[44:47], v[240:243], v[64:67]
    buffer_load_dwordx4 v26, s[12:15], s46 offen offset:0 lds
    ds_read_b64_tr_b16 a[94:95], v5 offset:7040
    v_mfma_f32_16x16x32_bf16 v[64:67], a[56:59], v[244:247], v[64:67]
    ds_read_b64_tr_b16 a[96:97], v4 offset:12416
    ds_read_b64_tr_b16 a[98:99], v4 offset:13184
    v_mfma_f32_16x16x32_bf16 v[60:63], a[52:55], v[244:247], v[60:63]
    ds_read_b128 v[196:199], v117 offset:64
    ds_read_b64_tr_b16 a[100:101], v4 offset:12448
    v_mfma_f32_16x16x32_bf16 v[56:59], a[48:51], v[244:247], v[56:59]
    buffer_load_dwordx4 v26, s[12:15], s46 offen offset:1024 lds
    s_add_u32 s46, s46, 18432
    s_waitcnt lgkmcnt(7)
    v_mfma_f32_16x16x32_bf16 v[56:59], a[60:63], v[248:251], v[56:59]
    ds_read_b64_tr_b16 a[102:103], v4 offset:13216
    ds_read_b64_tr_b16 a[104:105], v5 offset:12480
    ds_read_b64_tr_b16 a[106:107], v5 offset:13248
    v_mfma_f32_16x16x32_bf16 v[60:63], a[64:67], v[248:251], v[60:63]
    ds_read_b128 v[200:203], v117 offset:128
    v_xor_b32 v136, v136, v166
    v_xor_b32 v138, v138, v166
    v_lshlrev_b32_sdwa v122, 4, v136 dst_sel:DWORD dst_unused:UNUSED_PAD src0_sel:DWORD src1_sel:WORD_0
    v_lshlrev_b32_sdwa v123, 4, v138 dst_sel:DWORD dst_unused:UNUSED_PAD src0_sel:DWORD src1_sel:WORD_0
    v_mfma_f32_16x16x32_bf16 v[64:67], a[68:71], v[248:251], v[64:67]
    s_waitcnt vmcnt(5)
    s_waitcnt lgkmcnt(1)
    s_barrier
    v_mfma_f32_16x16x32_bf16 v[44:47], a[72:75], v[180:183], v[44:47]
    ds_read_b64_tr_b16 a[108:109], v4 offset:18624
    v_mfma_f32_16x16x32_bf16 v[48:51], a[76:79], v[180:183], v[48:51]
    ds_read_b128 v[204:207], v122 offset:0
    ds_read_b128 v[136:139], v172 offset:2048
    v_mfma_f32_16x16x32_bf16 v[52:55], a[80:83], v[180:183], v[52:55]
    ds_read_b64_tr_b16 a[110:111], v4 offset:19392
    v_mfma_f32_16x16x32_bf16 v[52:55], a[92:95], v[184:187], v[52:55]
    ds_read_b64_tr_b16 a[112:113], v4 offset:18656
    ds_read_b64_tr_b16 a[114:115], v4 offset:19424
    v_mfma_f32_16x16x32_bf16 v[48:51], a[88:91], v[184:187], v[48:51]
    ds_read_b128 v[208:211], v122 offset:64
    v_mfma_f32_16x16x32_bf16 v[44:47], a[84:87], v[184:187], v[44:47]
    ds_read_b64_tr_b16 a[116:117], v5 offset:18688
    v_mfma_f32_16x16x32_bf16 v[44:47], a[96:99], v[188:191], v[44:47]
    ds_read_b64_tr_b16 a[118:119], v5 offset:19456
    ds_read_b64_tr_b16 a[120:121], v4 offset:24832
    v_mfma_f32_16x16x32_bf16 v[48:51], a[100:103], v[188:191], v[48:51]
    ds_read_b128 v[212:215], v122 offset:128
    v_mfma_f32_16x16x32_bf16 v[52:55], a[104:107], v[188:191], v[52:55]
    ds_read_b64_tr_b16 a[122:123], v4 offset:25600
    ds_read_b64_tr_b16 a[124:125], v4 offset:24864
    v_mfma_f32_16x16x32_bf16 v[56:59], a[72:75], v[192:195], v[56:59]
    ds_read_b64_tr_b16 a[126:127], v4 offset:25632
    ds_read_b64_tr_b16 a[128:129], v5 offset:24896
    v_mfma_f32_16x16x32_bf16 v[60:63], a[76:79], v[192:195], v[60:63]
    ds_read_b128 v[216:219], v123 offset:0
    s_waitcnt lgkmcnt(7)
    v_xor_b32 v136, v136, v166
    v_xor_b32 v138, v138, v166
    v_mfma_f32_16x16x32_bf16 v[64:67], a[80:83], v[192:195], v[64:67]
    ds_read_b64_tr_b16 a[130:131], v5 offset:25664
    v_mfma_f32_16x16x32_bf16 v[64:67], a[92:95], v[196:199], v[64:67]
    ds_read_b64_tr_b16 a[132:133], v4 offset:31040
    ds_read_b64_tr_b16 a[134:135], v4 offset:31808
    v_mfma_f32_16x16x32_bf16 v[60:63], a[88:91], v[196:199], v[60:63]
    ds_read_b128 v[220:223], v123 offset:64
    v_mfma_f32_16x16x32_bf16 v[56:59], a[84:87], v[196:199], v[56:59]
    ds_read_b64_tr_b16 a[136:137], v4 offset:31072
    v_lshlrev_b32_sdwa v128, 4, v136 dst_sel:DWORD dst_unused:UNUSED_PAD src0_sel:DWORD src1_sel:WORD_0
    v_lshlrev_b32_sdwa v129, 4, v138 dst_sel:DWORD dst_unused:UNUSED_PAD src0_sel:DWORD src1_sel:WORD_0
    v_mfma_f32_16x16x32_bf16 v[56:59], a[96:99], v[200:203], v[56:59]
    ds_read_b64_tr_b16 a[138:139], v4 offset:31840
    ds_read_b64_tr_b16 a[140:141], v5 offset:31104
    ds_read_b64_tr_b16 a[142:143], v5 offset:31872
    v_mfma_f32_16x16x32_bf16 v[60:63], a[100:103], v[200:203], v[60:63]
    ds_read_b128 v[224:227], v123 offset:128
    v_mfma_f32_16x16x32_bf16 v[64:67], a[104:107], v[200:203], v[64:67]
    s_waitcnt vmcnt(0)
    s_waitcnt lgkmcnt(1)
    s_barrier
    v_mfma_f32_16x16x32_bf16 v[44:47], a[108:111], v[204:207], v[44:47]
    ds_read_b64_tr_b16 a[0:1], v4 offset:37248
    s_lshl_b32 s55, s55, 1
    v_mfma_f32_16x16x32_bf16 v[48:51], a[112:115], v[204:207], v[48:51]
    ds_read_b128 v[228:231], v128 offset:0
    s_mul_i32 s47, s28, 3104
    v_mfma_f32_16x16x32_bf16 v[52:55], a[116:119], v[204:207], v[52:55]
    ds_read_b64_tr_b16 a[2:3], v4 offset:38016
    s_add_u32 s47, s47, 107616
    v_mfma_f32_16x16x32_bf16 v[52:55], a[128:131], v[208:211], v[52:55]
    ds_read_b64_tr_b16 a[4:5], v4 offset:37280
    ds_read_b64_tr_b16 a[6:7], v4 offset:38048
    v_mfma_f32_16x16x32_bf16 v[48:51], a[124:127], v[208:211], v[48:51]
    ds_read_b128 v[232:235], v128 offset:64
    v_lshrrev_b32 v21, 6, v6
    v_mfma_f32_16x16x32_bf16 v[44:47], a[120:123], v[208:211], v[44:47]
    ds_read_b64_tr_b16 a[8:9], v5 offset:37312
    v_and_b32 v22, 48, v6
    v_mfma_f32_16x16x32_bf16 v[44:47], a[132:135], v[212:215], v[44:47]
    ds_read_b64_tr_b16 a[10:11], v5 offset:38080
    ds_read_b64_tr_b16 a[12:13], v4 offset:43456
    v_mfma_f32_16x16x32_bf16 v[48:51], a[136:139], v[212:215], v[48:51]
    ds_read_b128 v[236:239], v128 offset:128
    v_mul_u32_u24 v17, 112, v21
    v_mul_u32_u24 v19, s2, v21
    v_mfma_f32_16x16x32_bf16 v[52:55], a[140:143], v[212:215], v[52:55]
    ds_read_b64_tr_b16 a[14:15], v4 offset:44224
    ds_read_b64_tr_b16 a[16:17], v4 offset:43488
    v_mfma_f32_16x16x32_bf16 v[56:59], a[108:111], v[216:219], v[56:59]
    ds_read_b64_tr_b16 a[18:19], v4 offset:44256
    ds_read_b64_tr_b16 a[20:21], v5 offset:43520
    v_mfma_f32_16x16x32_bf16 v[60:63], a[112:115], v[216:219], v[60:63]
    ds_read_b128 v[240:243], v129 offset:0
    v_lshrrev_b32 v23, 1, v22
    v_mfma_f32_16x16x32_bf16 v[64:67], a[116:119], v[216:219], v[64:67]
    ds_read_b64_tr_b16 a[22:23], v5 offset:44288
    s_lshl_b32 s48, s29, 7
    s_lshl_b32 s49, s29, 5
    v_mfma_f32_16x16x32_bf16 v[64:67], a[128:131], v[220:223], v[64:67]
    ds_read_b64_tr_b16 a[24:25], v4 offset:49664
    ds_read_b64_tr_b16 a[26:27], v4 offset:50432
    v_mfma_f32_16x16x32_bf16 v[60:63], a[124:127], v[220:223], v[60:63]
    ds_read_b128 v[244:247], v129 offset:64
    s_add_u32 s49, s49, 64
    v_mfma_f32_16x16x32_bf16 v[56:59], a[120:123], v[220:223], v[56:59]
    ds_read_b64_tr_b16 a[28:29], v4 offset:49696
    v_add3_u32 v20, v19, s49, v23
    s_waitcnt lgkmcnt(7)
    v_mfma_f32_16x16x32_bf16 v[56:59], a[132:135], v[224:227], v[56:59]
    ds_read_b64_tr_b16 a[30:31], v4 offset:50464
    ds_read_b64_tr_b16 a[32:33], v5 offset:49728
    ds_read_b64_tr_b16 a[34:35], v5 offset:50496
    v_mfma_f32_16x16x32_bf16 v[60:63], a[136:139], v[224:227], v[60:63]
    ds_read_b128 v[248:251], v129 offset:128
    v_add3_u32 v19, v19, s48, v22
    v_mfma_f32_16x16x32_bf16 v[64:67], a[140:143], v[224:227], v[64:67]
    s_add_u32 s48, s47, 64
    v_add3_u32 v18, v17, s48, v23
    v_mfma_f32_16x16x32_bf16 v[44:47], a[0:3], v[228:231], v[44:47]
    v_add3_u32 v17, v17, s47, v22
    v_and_b32 v21, 3, v21
    v_mfma_f32_16x16x32_bf16 v[48:51], a[4:7], v[228:231], v[48:51]
    v_lshrrev_b32 v22, 2, v22
    v_mfma_f32_16x16x32_bf16 v[52:55], a[8:11], v[228:231], v[52:55]
    s_waitcnt lgkmcnt(7)
    v_mfma_f32_16x16x32_bf16 v[52:55], a[20:23], v[232:235], v[52:55]
    v_add_u32 v21, v21, v22
    v_mfma_f32_16x16x32_bf16 v[48:51], a[16:19], v[232:235], v[48:51]
    v_lshrrev_b32 v22, 8, v6
    v_mfma_f32_16x16x32_bf16 v[44:47], a[12:15], v[232:235], v[44:47]
    v_mul_u32_u24 v21, 112, v21
    s_waitcnt lgkmcnt(6)
    v_mfma_f32_16x16x32_bf16 v[44:47], a[24:27], v[236:239], v[44:47]
    v_lshlrev_b32 v22, 3, v22
    s_waitcnt lgkmcnt(3)
    v_mfma_f32_16x16x32_bf16 v[48:51], a[28:31], v[236:239], v[48:51]
    v_add3_u32 v16, v21, s47, v22
    s_waitcnt lgkmcnt(1)
    v_mfma_f32_16x16x32_bf16 v[52:55], a[32:35], v[236:239], v[52:55]
    s_cmp_eq_u32 s36, 1
    s_cbranch_scc1 L_Pe2
    v_mfma_f32_16x16x32_bf16 v[56:59], a[0:3], v[240:243], v[56:59]
    v_mfma_f32_16x16x32_bf16 v[60:63], a[4:7], v[240:243], v[60:63]
    v_mfma_f32_16x16x32_bf16 v[64:67], a[8:11], v[240:243], v[64:67]
    v_mfma_f32_16x16x32_bf16 v[64:67], a[20:23], v[244:247], v[64:67]
    v_cvt_pk_bf16_f32 v32, v44, v45
    v_cvt_pk_bf16_f32 v33, v46, v47
    v_mfma_f32_16x16x32_bf16 v[60:63], a[16:19], v[244:247], v[60:63]
    v_cvt_pk_bf16_f32 v34, v48, v49
    v_cvt_pk_bf16_f32 v35, v50, v51
    v_mfma_f32_16x16x32_bf16 v[56:59], a[12:15], v[244:247], v[56:59]
    ds_write_b64 v16, v[32:33] offset:0
    s_waitcnt lgkmcnt(1)
    v_mfma_f32_16x16x32_bf16 v[56:59], a[24:27], v[248:251], v[56:59]
    v_cvt_pk_bf16_f32 v36, v52, v53
    v_cvt_pk_bf16_f32 v37, v54, v55
    v_mfma_f32_16x16x32_bf16 v[60:63], a[28:31], v[248:251], v[60:63]
    ds_write_b64 v16, v[34:35] offset:32
    v_mfma_f32_16x16x32_bf16 v[64:67], a[32:35], v[248:251], v[64:67]
    ds_write_b64 v16, v[36:37] offset:64
    ds_read_b128 v[38:41], v17
    ds_read_b64 v[42:43], v18
    s_waitcnt lgkmcnt(1)
    buffer_store_dwordx4 v[38:41], v19, s[16:19], s31 offen sc1
    s_waitcnt lgkmcnt(0)
    buffer_store_dwordx2 v[42:43], v20, s[16:19], s31 offen sc1
    s_add_u32 s31, s31, s55
    s_cmp_lg_u32 s54, 0
    v_cvt_pk_bf16_f32 v32, v56, v57
    v_cvt_pk_bf16_f32 v33, v58, v59
    v_cvt_pk_bf16_f32 v34, v60, v61
    v_cvt_pk_bf16_f32 v35, v62, v63
    ds_write_b64 v16, v[32:33] offset:0
    v_cvt_pk_bf16_f32 v36, v64, v65
    v_cvt_pk_bf16_f32 v37, v66, v67
    ds_write_b64 v16, v[34:35] offset:32
    ds_write_b64 v16, v[36:37] offset:64
    ds_read_b128 v[24:27], v17
    ds_read_b64 v[28:29], v18
    s_waitcnt lgkmcnt(1)
    buffer_store_dwordx4 v[24:27], v19, s[16:19], s31 offen sc1
    s_waitcnt lgkmcnt(0)
    buffer_store_dwordx2 v[28:29], v20, s[16:19], s31 offen sc1
    s_cbranch_scc1 L_gS
    s_endpgm
L_Pe2:
    s_cmp_lg_u32 s54, 0
    v_cvt_pk_bf16_f32 v32, v44, v45
    v_cvt_pk_bf16_f32 v33, v46, v47
    v_cvt_pk_bf16_f32 v34, v48, v49
    v_cvt_pk_bf16_f32 v35, v50, v51
    ds_write_b64 v16, v[32:33] offset:0
    v_cvt_pk_bf16_f32 v36, v52, v53
    v_cvt_pk_bf16_f32 v37, v54, v55
    ds_write_b64 v16, v[34:35] offset:32
    ds_write_b64 v16, v[36:37] offset:64
    ds_read_b128 v[38:41], v17
    ds_read_b64 v[42:43], v18
    s_waitcnt lgkmcnt(1)
    buffer_store_dwordx4 v[38:41], v19, s[16:19], s31 offen sc1
    s_waitcnt lgkmcnt(0)
    buffer_store_dwordx2 v[42:43], v20, s[16:19], s31 offen sc1
    s_cbranch_scc1 L_gS
    s_endpgm
L_Pj3:
    ds_read_b128 v[180:183], v116 offset:0
    ds_read_b64_tr_b16 a[0:1], v4 offset:0
    ds_read_b64_tr_b16 a[2:3], v4 offset:768
    ds_read_b64_tr_b16 a[4:5], v4 offset:32
    ds_read_b64_tr_b16 a[6:7], v4 offset:800
    ds_read_b64_tr_b16 a[8:9], v5 offset:64
    ds_read_b64_tr_b16 a[10:11], v5 offset:832
    ds_read_b128 v[192:195], v117 offset:0
    ds_read_b128 v[204:207], v118 offset:0
    ds_read_b64_tr_b16 a[12:13], v4 offset:6208
    ds_read_b64_tr_b16 a[14:15], v4 offset:6976
    ds_read_b128 v[136:139], v172 offset:256
    ds_read_b128 v[184:187], v116 offset:64
    ds_read_b64_tr_b16 a[16:17], v4 offset:6240
    s_add_u32 m0, s44, 37248
    s_nop 0
    buffer_load_dwordx4 v7, s[12:15], s46 offen offset:0 lds
    ds_read_b64_tr_b16 a[18:19], v4 offset:7008
    ds_read_b64_tr_b16 a[20:21], v5 offset:6272
    ds_read_b64_tr_b16 a[22:23], v5 offset:7040
    ds_read_b128 v[196:199], v117 offset:64
    buffer_load_dwordx4 v7, s[12:15], s46 offen offset:1024 lds
    ds_read_b128 v[208:211], v118 offset:64
    ds_read_b128 v[188:191], v116 offset:128
    ds_read_b64_tr_b16 a[24:25], v4 offset:12416
    ds_read_b64_tr_b16 a[26:27], v4 offset:13184
    buffer_load_dwordx4 v7, s[12:15], s46 offen offset:2048 lds
    ds_read_b64_tr_b16 a[28:29], v4 offset:12448
    ds_read_b64_tr_b16 a[30:31], v4 offset:13216
    ds_read_b64_tr_b16 a[32:33], v5 offset:12480
    ds_read_b64_tr_b16 a[34:35], v5 offset:13248
    s_add_u32 m0, s45, 37248
    s_nop 0
    buffer_load_dwordx4 v26, s[12:15], s46 offen offset:0 lds
    ds_read_b128 v[200:203], v117 offset:128
    ds_read_b128 v[212:215], v118 offset:128
    s_waitcnt lgkmcnt(7)
    v_xor_b32 v136, v136, v166
    v_xor_b32 v138, v138, v166
    buffer_load_dwordx4 v26, s[12:15], s46 offen offset:1024 lds
    v_lshlrev_b32_sdwa v122, 4, v136 dst_sel:DWORD dst_unused:UNUSED_PAD src0_sel:DWORD src1_sel:WORD_0
    v_lshlrev_b32_sdwa v123, 4, v138 dst_sel:DWORD dst_unused:UNUSED_PAD src0_sel:DWORD src1_sel:WORD_0
    v_lshlrev_b32_sdwa v124, 4, v136 dst_sel:DWORD dst_unused:UNUSED_PAD src0_sel:DWORD src1_sel:WORD_1
    s_add_u32 s46, s46, 18432
    v_mfma_f32_16x16x32_bf16 v[44:47], a[0:3], v[180:183], 0
    s_waitcnt lgkmcnt(2)
    s_barrier
    v_mfma_f32_16x16x32_bf16 v[48:51], a[4:7], v[180:183], 0
    ds_read_b128 v[216:219], v122 offset:0
    ds_read_b128 v[136:139], v172 offset:512
    v_mfma_f32_16x16x32_bf16 v[52:55], a[8:11], v[180:183], 0
    s_add_u32 m0, s44, 0
    ds_read_b64_tr_b16 a[36:37], v4 offset:18624
    v_mfma_f32_16x16x32_bf16 v[56:59], a[0:3], v[192:195], 0
    buffer_load_dwordx4 v7, s[12:15], s46 offen offset:0 lds
    v_mfma_f32_16x16x32_bf16 v[60:63], a[4:7], v[192:195], 0
    ds_read_b128 v[220:223], v122 offset:64
    v_mfma_f32_16x16x32_bf16 v[64:67], a[8:11], v[192:195], 0
    ds_read_b64_tr_b16 a[38:39], v4 offset:19392
    v_mfma_f32_16x16x32_bf16 v[68:71], a[0:3], v[204:207], 0
    ds_read_b64_tr_b16 a[40:41], v4 offset:18656
    ds_read_b64_tr_b16 a[42:43], v4 offset:19424
    v_mfma_f32_16x16x32_bf16 v[72:75], a[4:7], v[204:207], 0
    ds_read_b128 v[224:227], v122 offset:128
    v_mfma_f32_16x16x32_bf16 v[76:79], a[8:11], v[204:207], 0
    buffer_load_dwordx4 v7, s[12:15], s46 offen offset:1024 lds
    v_mfma_f32_16x16x32_bf16 v[52:55], a[20:23], v[184:187], v[52:55]
    ds_read_b64_tr_b16 a[44:45], v5 offset:18688
    ds_read_b64_tr_b16 a[46:47], v5 offset:19456
    v_mfma_f32_16x16x32_bf16 v[48:51], a[16:19], v[184:187], v[48:51]
    ds_read_b128 v[228:231], v123 offset:0
    v_mfma_f32_16x16x32_bf16 v[44:47], a[12:15], v[184:187], v[44:47]
    ds_read_b64_tr_b16 a[48:49], v4 offset:24832
    s_waitcnt lgkmcnt(7)
    v_xor_b32 v136, v136, v166
    v_xor_b32 v138, v138, v166
    v_mfma_f32_16x16x32_bf16 v[64:67], a[20:23], v[196:199], v[64:67]
    ds_read_b64_tr_b16 a[50:51], v4 offset:25600
    ds_read_b64_tr_b16 a[52:53], v4 offset:24864
    v_mfma_f32_16x16x32_bf16 v[60:63], a[16:19], v[196:199], v[60:63]
    ds_read_b128 v[232:235], v123 offset:64
    v_mfma_f32_16x16x32_bf16 v[56:59], a[12:15], v[196:199], v[56:59]
    buffer_load_dwordx4 v7, s[12:15], s46 offen offset:2048 lds
    v_mfma_f32_16x16x32_bf16 v[76:79], a[20:23], v[208:211], v[76:79]
    ds_read_b64_tr_b16 a[54:55], v4 offset:25632
    ds_read_b64_tr_b16 a[56:57], v5 offset:24896
    v_mfma_f32_16x16x32_bf16 v[72:75], a[16:19], v[208:211], v[72:75]
    ds_read_b128 v[236:239], v123 offset:128
    s_add_u32 m0, s45, 0
    v_mfma_f32_16x16x32_bf16 v[68:71], a[12:15], v[208:211], v[68:71]
    buffer_load_dwordx4 v26, s[12:15], s46 offen offset:0 lds
    v_mfma_f32_16x16x32_bf16 v[44:47], a[24:27], v[188:191], v[44:47]
    ds_read_b64_tr_b16 a[58:59], v5 offset:25664
    ds_read_b64_tr_b16 a[60:61], v4 offset:31040
    v_mfma_f32_16x16x32_bf16 v[48:51], a[28:31], v[188:191], v[48:51]
    ds_read_b128 v[240:243], v124 offset:0
    v_lshlrev_b32_sdwa v128, 4, v136 dst_sel:DWORD dst_unused:UNUSED_PAD src0_sel:DWORD src1_sel:WORD_0
    v_lshlrev_b32_sdwa v129, 4, v138 dst_sel:DWORD dst_unused:UNUSED_PAD src0_sel:DWORD src1_sel:WORD_0
    v_mfma_f32_16x16x32_bf16 v[52:55], a[32:35], v[188:191], v[52:55]
    ds_read_b64_tr_b16 a[62:63], v4 offset:31808
    v_mfma_f32_16x16x32_bf16 v[56:59], a[24:27], v[200:203], v[56:59]
    ds_read_b64_tr_b16 a[64:65], v4 offset:31072
    ds_read_b64_tr_b16 a[66:67], v4 offset:31840
    v_mfma_f32_16x16x32_bf16 v[60:63], a[28:31], v[200:203], v[60:63]
    ds_read_b128 v[244:247], v124 offset:64
    v_mfma_f32_16x16x32_bf16 v[64:67], a[32:35], v[200:203], v[64:67]
    buffer_load_dwordx4 v26, s[12:15], s46 offen offset:1024 lds
    s_add_u32 s46, s46, 18432
    v_mfma_f32_16x16x32_bf16 v[68:71], a[24:27], v[212:215], v[68:71]
    ds_read_b64_tr_b16 a[68:69], v5 offset:31104
    ds_read_b64_tr_b16 a[70:71], v5 offset:31872
    v_mfma_f32_16x16x32_bf16 v[72:75], a[28:31], v[212:215], v[72:75]
    ds_read_b128 v[248:251], v124 offset:128
    v_lshlrev_b32_sdwa v130, 4, v136 dst_sel:DWORD dst_unused:UNUSED_PAD src0_sel:DWORD src1_sel:WORD_1
    v_mfma_f32_16x16x32_bf16 v[76:79], a[32:35], v[212:215], v[76:79]
    s_waitcnt vmcnt(5)
    s_waitcnt lgkmcnt(1)
    s_barrier
    v_mfma_f32_16x16x32_bf16 v[44:47], a[36:39], v[216:219], v[44:47]
    ds_read_b64_tr_b16 a[72:73], v4 offset:37248
    v_mfma_f32_16x16x32_bf16 v[48:51], a[40:43], v[216:219], v[48:51]
    ds_read_b128 v[180:183], v128 offset:0
    s_add_u32 m0, s44, 18624
    ds_read_b128 v[136:139], v172 offset:768
    v_mfma_f32_16x16x32_bf16 v[52:55], a[44:47], v[216:219], v[52:55]
    buffer_load_dwordx4 v7, s[12:15], s46 offen offset:0 lds
    v_mfma_f32_16x16x32_bf16 v[52:55], a[56:59], v[220:223], v[52:55]
    ds_read_b64_tr_b16 a[74:75], v4 offset:38016
    v_mfma_f32_16x16x32_bf16 v[48:51], a[52:55], v[220:223], v[48:51]
    ds_read_b128 v[184:187], v128 offset:64
    v_mfma_f32_16x16x32_bf16 v[44:47], a[48:51], v[220:223], v[44:47]
    ds_read_b64_tr_b16 a[76:77], v4 offset:37280
    v_mfma_f32_16x16x32_bf16 v[44:47], a[60:63], v[224:227], v[44:47]
    ds_read_b64_tr_b16 a[78:79], v4 offset:38048
    ds_read_b64_tr_b16 a[80:81], v5 offset:37312
    v_mfma_f32_16x16x32_bf16 v[48:51], a[64:67], v[224:227], v[48:51]
    ds_read_b128 v[188:191], v128 offset:128
    v_mfma_f32_16x16x32_bf16 v[52:55], a[68:71], v[224:227], v[52:55]
    buffer_load_dwordx4 v7, s[12:15], s46 offen offset:1024 lds
    v_mfma_f32_16x16x32_bf16 v[56:59], a[36:39], v[228:231], v[56:59]
    ds_read_b64_tr_b16 a[82:83], v5 offset:38080
    v_mfma_f32_16x16x32_bf16 v[60:63], a[40:43], v[228:231], v[60:63]
    ds_read_b128 v[192:195], v129 offset:0
    v_mfma_f32_16x16x32_bf16 v[64:67], a[44:47], v[228:231], v[64:67]
    ds_read_b64_tr_b16 a[84:85], v4 offset:43456
    ds_read_b64_tr_b16 a[86:87], v4 offset:44224
    v_mfma_f32_16x16x32_bf16 v[64:67], a[56:59], v[232:235], v[64:67]
    buffer_load_dwordx4 v7, s[12:15], s46 offen offset:2048 lds
    v_mfma_f32_16x16x32_bf16 v[60:63], a[52:55], v[232:235], v[60:63]
    ds_read_b128 v[196:199], v129 offset:64
    ds_read_b64_tr_b16 a[88:89], v4 offset:43488
    v_mfma_f32_16x16x32_bf16 v[56:59], a[48:51], v[232:235], v[56:59]
    ds_read_b64_tr_b16 a[90:91], v4 offset:44256
    s_waitcnt lgkmcnt(7)
    v_xor_b32 v136, v136, v166
    v_xor_b32 v138, v138, v166
    v_mfma_f32_16x16x32_bf16 v[56:59], a[60:63], v[236:239], v[56:59]
    ds_read_b64_tr_b16 a[92:93], v5 offset:43520
    v_mfma_f32_16x16x32_bf16 v[60:63], a[64:67], v[236:239], v[60:63]
    ds_read_b128 v[200:203], v129 offset:128
    s_add_u32 m0, s45, 18624
    v_mfma_f32_16x16x32_bf16 v[64:67], a[68:71], v[236:239], v[64:67]
    buffer_load_dwordx4 v26, s[12:15], s46 offen offset:0 lds
    v_mfma_f32_16x16x32_bf16 v[68:71], a[36:39], v[240:243], v[68:71]
    ds_read_b64_tr_b16 a[94:95], v5 offset:44288
    ds_read_b64_tr_b16 a[96:97], v4 offset:49664
    v_mfma_f32_16x16x32_bf16 v[72:75], a[40:43], v[240:243], v[72:75]
    ds_read_b128 v[204:207], v130 offset:0
    v_lshlrev_b32_sdwa v116, 4, v136 dst_sel:DWORD dst_unused:UNUSED_PAD src0_sel:DWORD src1_sel:WORD_0
    v_lshlrev_b32_sdwa v117, 4, v138 dst_sel:DWORD dst_unused:UNUSED_PAD src0_sel:DWORD src1_sel:WORD_0
    v_mfma_f32_16x16x32_bf16 v[76:79], a[44:47], v[240:243], v[76:79]
    ds_read_b64_tr_b16 a[98:99], v4 offset:50432
    v_mfma_f32_16x16x32_bf16 v[76:79], a[56:59], v[244:247], v[76:79]
    ds_read_b64_tr_b16 a[100:101], v4 offset:49696
    ds_read_b64_tr_b16 a[102:103], v4 offset:50464
    v_mfma_f32_16x16x32_bf16 v[72:75], a[52:55], v[244:247], v[72:75]
    ds_read_b128 v[208:211], v130 offset:64
    v_mfma_f32_16x16x32_bf16 v[68:71], a[48:51], v[244:247], v[68:71]
    buffer_load_dwordx4 v26, s[12:15], s46 offen offset:1024 lds
    s_add_u32 s46, s46, 18432
    v_mfma_f32_16x16x32_bf16 v[68:71], a[60:63], v[248:251], v[68:71]
    ds_read_b64_tr_b16 a[104:105], v5 offset:49728
    ds_read_b64_tr_b16 a[106:107], v5 offset:50496
    v_mfma_f32_16x16x32_bf16 v[72:75], a[64:67], v[248:251], v[72:75]
    ds_read_b128 v[212:215], v130 offset:128
    v_lshlrev_b32_sdwa v118, 4, v136 dst_sel:DWORD dst_unused:UNUSED_PAD src0_sel:DWORD src1_sel:WORD_1
    v_mfma_f32_16x16x32_bf16 v[76:79], a[68:71], v[248:251], v[76:79]
    s_waitcnt vmcnt(5)
    s_waitcnt lgkmcnt(1)
    s_barrier
    v_mfma_f32_16x16x32_bf16 v[44:47], a[72:75], v[180:183], v[44:47]
    ds_read_b64_tr_b16 a[108:109], v4 offset:0
    v_mfma_f32_16x16x32_bf16 v[48:51], a[76:79], v[180:183], v[48:51]
    ds_read_b128 v[216:219], v116 offset:0
    s_add_u32 m0, s44, 37248
    ds_read_b128 v[136:139], v172 offset:1024
    v_mfma_f32_16x16x32_bf16 v[52:55], a[80:83], v[180:183], v[52:55]
    buffer_load_dwordx4 v7, s[12:15], s46 offen offset:0 lds
    v_mfma_f32_16x16x32_bf16 v[52:55], a[92:95], v[184:187], v[52:55]
    ds_read_b64_tr_b16 a[110:111], v4 offset:768
    v_mfma_f32_16x16x32_bf16 v[48:51], a[88:91], v[184:187], v[48:51]
    ds_read_b128 v[220:223], v116 offset:64
    v_mfma_f32_16x16x32_bf16 v[44:47], a[84:87], v[184:187], v[44:47]
    ds_read_b64_tr_b16 a[112:113], v4 offset:32
    v_mfma_f32_16x16x32_bf16 v[44:47], a[96:99], v[188:191], v[44:47]
    ds_read_b64_tr_b16 a[114:115], v4 offset:800
    ds_read_b64_tr_b16 a[116:117], v5 offset:64
    v_mfma_f32_16x16x32_bf16 v[48:51], a[100:103], v[188:191], v[48:51]
    ds_read_b128 v[224:227], v116 offset:128
    v_mfma_f32_16x16x32_bf16 v[52:55], a[104:107], v[188:191], v[52:55]
    buffer_load_dwordx4 v7, s[12:15], s46 offen offset:1024 lds
    v_mfma_f32_16x16x32_bf16 v[56:59], a[72:75], v[192:195], v[56:59]
    ds_read_b64_tr_b16 a[118:119], v5 offset:832
    v_mfma_f32_16x16x32_bf16 v[60:63], a[76:79], v[192:195], v[60:63]
    ds_read_b128 v[228:231], v117 offset:0
    v_mfma_f32_16x16x32_bf16 v[64:67], a[80:83], v[192:195], v[64:67]
    ds_read_b64_tr_b16 a[120:121], v4 offset:6208
    ds_read_b64_tr_b16 a[122:123], v4 offset:6976
    v_mfma_f32_16x16x32_bf16 v[64:67], a[92:95], v[196:199], v[64:67]
    buffer_load_dwordx4 v7, s[12:15], s46 offen offset:2048 lds
    v_mfma_f32_16x16x32_bf16 v[60:63], a[88:91], v[196:199], v[60:63]
    ds_read_b128 v[232:235], v117 offset:64
    ds_read_b64_tr_b16 a[124:125], v4 offset:6240
    v_mfma_f32_16x16x32_bf16 v[56:59], a[84:87], v[196:199], v[56:59]
    ds_read_b64_tr_b16 a[126:127], v4 offset:7008
    s_waitcnt lgkmcnt(7)
    v_xor_b32 v136, v136, v166
    v_xor_b32 v138, v138, v166
    v_mfma_f32_16x16x32_bf16 v[56:59], a[96:99], v[200:203], v[56:59]
    ds_read_b64_tr_b16 a[128:129], v5 offset:6272
    v_mfma_f32_16x16x32_bf16 v[60:63], a[100:103], v[200:203], v[60:63]
    ds_read_b128 v[236:239], v117 offset:128
    s_add_u32 m0, s45, 37248
    v_mfma_f32_16x16x32_bf16 v[64:67], a[104:107], v[200:203], v[64:67]
    buffer_load_dwordx4 v26, s[12:15], s46 offen offset:0 lds
    v_mfma_f32_16x16x32_bf16 v[68:71], a[72:75], v[204:207], v[68:71]
    ds_read_b64_tr_b16 a[130:131], v5 offset:7040
    ds_read_b64_tr_b16 a[132:133], v4 offset:12416
    v_mfma_f32_16x16x32_bf16 v[72:75], a[76:79], v[204:207], v[72:75]
    ds_read_b128 v[240:243], v118 offset:0
    v_lshlrev_b32_sdwa v122, 4, v136 dst_sel:DWORD dst_unused:UNUSED_PAD src0_sel:DWORD src1_sel:WORD_0
    v_lshlrev_b32_sdwa v123, 4, v138 dst_sel:DWORD dst_unused:UNUSED_PAD src0_sel:DWORD src1_sel:WORD_0
    v_mfma_f32_16x16x32_bf16 v[76:79], a[80:83], v[204:207], v[76:79]
    ds_read_b64_tr_b16 a[134:135], v4 offset:13184
    v_mfma_f32_16x16x32_bf16 v[76:79], a[92:95], v[208:211], v[76:79]
    ds_read_b64_tr_b16 a[136:137], v4 offset:12448
    ds_read_b64_tr_b16 a[138:139], v4 offset:13216
    v_mfma_f32_16x16x32_bf16 v[72:75], a[88:91], v[208:211], v[72:75]
    ds_read_b128 v[244:247], v118 offset:64
    v_mfma_f32_16x16x32_bf16 v[68:71], a[84:87], v[208:211], v[68:71]
    buffer_load_dwordx4 v26, s[12:15], s46 offen offset:1024 lds
    s_add_u32 s46, s46, 18432
    v_mfma_f32_16x16x32_bf16 v[68:71], a[96:99], v[212:215], v[68:71]
    ds_read_b64_tr_b16 a[140:141], v5 offset:12480
    ds_read_b64_tr_b16 a[142:143], v5 offset:13248
    v_mfma_f32_16x16x32_bf16 v[72:75], a[100:103], v[212:215], v[72:75]
    ds_read_b128 v[248:251], v118 offset:128
    v_lshlrev_b32_sdwa v124, 4, v136 dst_sel:DWORD dst_unused:UNUSED_PAD src0_sel:DWORD src1_sel:WORD_1
    v_mfma_f32_16x16x32_bf16 v[76:79], a[104:107], v[212:215], v[76:79]
    s_waitcnt vmcnt(5)
    s_waitcnt lgkmcnt(1)
    s_barrier
    v_mfma_f32_16x16x32_bf16 v[44:47], a[108:111], v[216:219], v[44:47]
    ds_read_b64_tr_b16 a[0:1], v4 offset:18624
    v_mfma_f32_16x16x32_bf16 v[48:51], a[112:115], v[216:219], v[48:51]
    ds_read_b128 v[180:183], v122 offset:0
    s_add_u32 m0, s44, 0
    ds_read_b128 v[136:139], v172 offset:1280
    v_mfma_f32_16x16x32_bf16 v[52:55], a[116:119], v[216:219], v[52:55]
    buffer_load_dwordx4 v7, s[12:15], s46 offen offset:0 lds
    v_mfma_f32_16x16x32_bf16 v[52:55], a[128:131], v[220:223], v[52:55]
    ds_read_b64_tr_b16 a[2:3], v4 offset:19392
    v_mfma_f32_16x16x32_bf16 v[48:51], a[124:127], v[220:223], v[48:51]
    ds_read_b128 v[184:187], v122 offset:64
    v_mfma_f32_16x16x32_bf16 v[44:47], a[120:123], v[220:223], v[44:47]
    ds_read_b64_tr_b16 a[4:5], v4 offset:18656
    v_mfma_f32_16x16x32_bf16 v[44:47], a[132:135], v[224:227], v[44:47]
    ds_read_b64_tr_b16 a[6:7], v4 offset:19424
    ds_read_b64_tr_b16 a[8:9], v5 offset:18688
    v_mfma_f32_16x16x32_bf16 v[48:51], a[136:139], v[224:227], v[48:51]
    ds_read_b128 v[188:191], v122 offset:128
    v_mfma_f32_16x16x32_bf16 v[52:55], a[140:143], v[224:227], v[52:55]
    buffer_load_dwordx4 v7, s[12:15], s46 offen offset:1024 lds
    v_mfma_f32_16x16x32_bf16 v[56:59], a[108:111], v[228:231], v[56:59]
    ds_read_b64_tr_b16 a[10:11], v5 offset:19456
    v_mfma_f32_16x16x32_bf16 v[60:63], a[112:115], v[228:231], v[60:63]
    ds_read_b128 v[192:195], v123 offset:0
    v_mfma_f32_16x16x32_bf16 v[64:67], a[116:119], v[228:231], v[64:67]
    ds_read_b64_tr_b16 a[12:13], v4 offset:24832
    ds_read_b64_tr_b16 a[14:15], v4 offset:25600
    v_mfma_f32_16x16x32_bf16 v[64:67], a[128:131], v[232:235], v[64:67]
    buffer_load_dwordx4 v7, s[12:15], s46 offen offset:2048 lds
    v_mfma_f32_16x16x32_bf16 v[60:63], a[124:127], v[232:235], v[60:63]
    ds_read_b128 v[196:199], v123 offset:64
    ds_read_b64_tr_b16 a[16:17], v4 offset:24864
    v_mfma_f32_16x16x32_bf16 v[56:59], a[120:123], v[232:235], v[56:59]
    ds_read_b64_tr_b16 a[18:19], v4 offset:25632
    s_waitcnt lgkmcnt(7)
    v_xor_b32 v136, v136, v166
    v_xor_b32 v138, v138, v166
    v_mfma_f32_16x16x32_bf16 v[56:59], a[132:135], v[236:239], v[56:59]
    ds_read_b64_tr_b16 a[20:21], v5 offset:24896
    v_mfma_f32_16x16x32_bf16 v[60:63], a[136:139], v[236:239], v[60:63]
    ds_read_b128 v[200:203], v123 offset:128
    s_add_u32 m0, s45, 0
    v_mfma_f32_16x16x32_bf16 v[64:67], a[140:143], v[236:239], v[64:67]
    buffer_load_dwordx4 v26, s[12:15], s46 offen offset:0 lds
    v_mfma_f32_16x16x32_bf16 v[68:71], a[108:111], v[240:243], v[68:71]
    ds_read_b64_tr_b16 a[22:23], v5 offset:25664
    ds_read_b64_tr_b16 a[24:25], v4 offset:31040
    v_mfma_f32_16x16x32_bf16 v[72:75], a[112:115], v[240:243], v[72:75]
    ds_read_b128 v[204:207], v124 offset:0
    v_lshlrev_b32_sdwa v128, 4, v136 dst_sel:DWORD dst_unused:UNUSED_PAD src0_sel:DWORD src1_sel:WORD_0
    v_lshlrev_b32_sdwa v129, 4, v138 dst_sel:DWORD dst_unused:UNUSED_PAD src0_sel:DWORD src1_sel:WORD_0
    v_mfma_f32_16x16x32_bf16 v[76:79], a[116:119], v[240:243], v[76:79]
    ds_read_b64_tr_b16 a[26:27], v4 offset:31808
    v_mfma_f32_16x16x32_bf16 v[76:79], a[128:131], v[244:247], v[76:79]
    ds_read_b64_tr_b16 a[28:29], v4 offset:31072
    ds_read_b64_tr_b16 a[30:31], v4 offset:31840
    v_mfma_f32_16x16x32_bf16 v[72:75], a[124:127], v[244:247], v[72:75]
    ds_read_b128 v[208:211], v124 offset:64
    v_mfma_f32_16x16x32_bf16 v[68:71], a[120:123], v[244:247], v[68:71]
    buffer_load_dwordx4 v26, s[12:15], s46 offen offset:1024 lds
    s_add_u32 s46, s46, 18432
    v_mfma_f32_16x16x32_bf16 v[68:71], a[132:135], v[248:251], v[68:71]
    ds_read_b64_tr_b16 a[32:33], v5 offset:31104
    ds_read_b64_tr_b16 a[34:35], v5 offset:31872
    v_mfma_f32_16x16x32_bf16 v[72:75], a[136:139], v[248:251], v[72:75]
    ds_read_b128 v[212:215], v124 offset:128
    v_lshlrev_b32_sdwa v130, 4, v136 dst_sel:DWORD dst_unused:UNUSED_PAD src0_sel:DWORD src1_sel:WORD_1
    v_mfma_f32_16x16x32_bf16 v[76:79], a[140:143], v[248:251], v[76:79]
    s_waitcnt vmcnt(5)
    s_waitcnt lgkmcnt(1)
    s_barrier
    v_mfma_f32_16x16x32_bf16 v[44:47], a[0:3], v[180:183], v[44:47]
    ds_read_b64_tr_b16 a[36:37], v4 offset:37248
    v_mfma_f32_16x16x32_bf16 v[48:51], a[4:7], v[180:183], v[48:51]
    ds_read_b128 v[216:219], v128 offset:0
    s_add_u32 m0, s44, 18624
    ds_read_b128 v[136:139], v172 offset:1536
    v_mfma_f32_16x16x32_bf16 v[52:55], a[8:11], v[180:183], v[52:55]
    buffer_load_dwordx4 v7, s[12:15], s46 offen offset:0 lds
    v_mfma_f32_16x16x32_bf16 v[52:55], a[20:23], v[184:187], v[52:55]
    ds_read_b64_tr_b16 a[38:39], v4 offset:38016
    v_mfma_f32_16x16x32_bf16 v[48:51], a[16:19], v[184:187], v[48:51]
    ds_read_b128 v[220:223], v128 offset:64
    v_mfma_f32_16x16x32_bf16 v[44:47], a[12:15], v[184:187], v[44:47]
    ds_read_b64_tr_b16 a[40:41], v4 offset:37280
    v_mfma_f32_16x16x32_bf16 v[44:47], a[24:27], v[188:191], v[44:47]
    ds_read_b64_tr_b16 a[42:43], v4 offset:38048
    ds_read_b64_tr_b16 a[44:45], v5 offset:37312
    v_mfma_f32_16x16x32_bf16 v[48:51], a[28:31], v[188:191], v[48:51]
    ds_read_b128 v[224:227], v128 offset:128
    v_mfma_f32_16x16x32_bf16 v[52:55], a[32:35], v[188:191], v[52:55]
    buffer_load_dwordx4 v7, s[12:15], s46 offen offset:1024 lds
    v_mfma_f32_16x16x32_bf16 v[56:59], a[0:3], v[192:195], v[56:59]
    ds_read_b64_tr_b16 a[46:47], v5 offset:38080
    v_mfma_f32_16x16x32_bf16 v[60:63], a[4:7], v[192:195], v[60:63]
    ds_read_b128 v[228:231], v129 offset:0
    v_mfma_f32_16x16x32_bf16 v[64:67], a[8:11], v[192:195], v[64:67]
    ds_read_b64_tr_b16 a[48:49], v4 offset:43456
    ds_read_b64_tr_b16 a[50:51], v4 offset:44224
    v_mfma_f32_16x16x32_bf16 v[64:67], a[20:23], v[196:199], v[64:67]
    buffer_load_dwordx4 v7, s[12:15], s46 offen offset:2048 lds
    v_mfma_f32_16x16x32_bf16 v[60:63], a[16:19], v[196:199], v[60:63]
    ds_read_b128 v[232:235], v129 offset:64
    ds_read_b64_tr_b16 a[52:53], v4 offset:43488
    v_mfma_f32_16x16x32_bf16 v[56:59], a[12:15], v[196:199], v[56:59]
    ds_read_b64_tr_b16 a[54:55], v4 offset:44256
    s_waitcnt lgkmcnt(7)
    v_xor_b32 v136, v136, v166
    v_xor_b32 v138, v138, v166
    v_mfma_f32_16x16x32_bf16 v[56:59], a[24:27], v[200:203], v[56:59]
    ds_read_b64_tr_b16 a[56:57], v5 offset:43520
    v_mfma_f32_16x16x32_bf16 v[60:63], a[28:31], v[200:203], v[60:63]
    ds_read_b128 v[236:239], v129 offset:128
    s_add_u32 m0, s45, 18624
    v_mfma_f32_16x16x32_bf16 v[64:67], a[32:35], v[200:203], v[64:67]
    buffer_load_dwordx4 v26, s[12:15], s46 offen offset:0 lds
    v_mfma_f32_16x16x32_bf16 v[68:71], a[0:3], v[204:207], v[68:71]
    ds_read_b64_tr_b16 a[58:59], v5 offset:44288
    ds_read_b64_tr_b16 a[60:61], v4 offset:49664
    v_mfma_f32_16x16x32_bf16 v[72:75], a[4:7], v[204:207], v[72:75]
    ds_read_b128 v[240:243], v130 offset:0
    v_lshlrev_b32_sdwa v116, 4, v136 dst_sel:DWORD dst_unused:UNUSED_PAD src0_sel:DWORD src1_sel:WORD_0
    v_lshlrev_b32_sdwa v117, 4, v138 dst_sel:DWORD dst_unused:UNUSED_PAD src0_sel:DWORD src1_sel:WORD_0
    v_mfma_f32_16x16x32_bf16 v[76:79], a[8:11], v[204:207], v[76:79]
    ds_read_b64_tr_b16 a[62:63], v4 offset:50432
    v_mfma_f32_16x16x32_bf16 v[76:79], a[20:23], v[208:211], v[76:79]
    ds_read_b64_tr_b16 a[64:65], v4 offset:49696
    ds_read_b64_tr_b16 a[66:67], v4 offset:50464
    v_mfma_f32_16x16x32_bf16 v[72:75], a[16:19], v[208:211], v[72:75]
    ds_read_b128 v[244:247], v130 offset:64
    v_mfma_f32_16x16x32_bf16 v[68:71], a[12:15], v[208:211], v[68:71]
    buffer_load_dwordx4 v26, s[12:15], s46 offen offset:1024 lds
    s_add_u32 s46, s46, 18432
    v_mfma_f32_16x16x32_bf16 v[68:71], a[24:27], v[212:215], v[68:71]
    ds_read_b64_tr_b16 a[68:69], v5 offset:49728
    ds_read_b64_tr_b16 a[70:71], v5 offset:50496
    v_mfma_f32_16x16x32_bf16 v[72:75], a[28:31], v[212:215], v[72:75]
    ds_read_b128 v[248:251], v130 offset:128
    v_lshlrev_b32_sdwa v118, 4, v136 dst_sel:DWORD dst_unused:UNUSED_PAD src0_sel:DWORD src1_sel:WORD_1
    v_mfma_f32_16x16x32_bf16 v[76:79], a[32:35], v[212:215], v[76:79]
    s_waitcnt vmcnt(5)
    s_waitcnt lgkmcnt(1)
    s_barrier
    v_mfma_f32_16x16x32_bf16 v[44:47], a[36:39], v[216:219], v[44:47]
    ds_read_b64_tr_b16 a[72:73], v4 offset:0
    v_mfma_f32_16x16x32_bf16 v[48:51], a[40:43], v[216:219], v[48:51]
    ds_read_b128 v[180:183], v116 offset:0
    s_add_u32 m0, s44, 37248
    ds_read_b128 v[136:139], v172 offset:1792
    v_mfma_f32_16x16x32_bf16 v[52:55], a[44:47], v[216:219], v[52:55]
    buffer_load_dwordx4 v7, s[12:15], s46 offen offset:0 lds
    v_mfma_f32_16x16x32_bf16 v[52:55], a[56:59], v[220:223], v[52:55]
    ds_read_b64_tr_b16 a[74:75], v4 offset:768
    v_mfma_f32_16x16x32_bf16 v[48:51], a[52:55], v[220:223], v[48:51]
    ds_read_b128 v[184:187], v116 offset:64
    v_mfma_f32_16x16x32_bf16 v[44:47], a[48:51], v[220:223], v[44:47]
    ds_read_b64_tr_b16 a[76:77], v4 offset:32
    v_mfma_f32_16x16x32_bf16 v[44:47], a[60:63], v[224:227], v[44:47]
    ds_read_b64_tr_b16 a[78:79], v4 offset:800
    ds_read_b64_tr_b16 a[80:81], v5 offset:64
    v_mfma_f32_16x16x32_bf16 v[48:51], a[64:67], v[224:227], v[48:51]
    ds_read_b128 v[188:191], v116 offset:128
    v_mfma_f32_16x16x32_bf16 v[52:55], a[68:71], v[224:227], v[52:55]
    buffer_load_dwordx4 v7, s[12:15], s46 offen offset:1024 lds
    v_mfma_f32_16x16x32_bf16 v[56:59], a[36:39], v[228:231], v[56:59]
    ds_read_b64_tr_b16 a[82:83], v5 offset:832
    v_mfma_f32_16x16x32_bf16 v[60:63], a[40:43], v[228:231], v[60:63]
    ds_read_b128 v[192:195], v117 offset:0
    v_mfma_f32_16x16x32_bf16 v[64:67], a[44:47], v[228:231], v[64:67]
    ds_read_b64_tr_b16 a[84:85], v4 offset:6208
    ds_read_b64_tr_b16 a[86:87], v4 offset:6976
    v_mfma_f32_16x16x32_bf16 v[64:67], a[56:59], v[232:235], v[64:67]
    buffer_load_dwordx4 v7, s[12:15], s46 offen offset:2048 lds
    v_mfma_f32_16x16x32_bf16 v[60:63], a[52:55], v[232:235], v[60:63]
    ds_read_b128 v[196:199], v117 offset:64
    ds_read_b64_tr_b16 a[88:89], v4 offset:6240
    v_mfma_f32_16x16x32_bf16 v[56:59], a[48:51], v[232:235], v[56:59]
    ds_read_b64_tr_b16 a[90:91], v4 offset:7008
    s_waitcnt lgkmcnt(7)
    v_xor_b32 v136, v136, v166
    v_xor_b32 v138, v138, v166
    v_mfma_f32_16x16x32_bf16 v[56:59], a[60:63], v[236:239], v[56:59]
    ds_read_b64_tr_b16 a[92:93], v5 offset:6272
    v_mfma_f32_16x16x32_bf16 v[60:63], a[64:67], v[236:239], v[60:63]
    ds_read_b128 v[200:203], v117 offset:128
    s_add_u32 m0, s45, 37248
    v_mfma_f32_16x16x32_bf16 v[64:67], a[68:71], v[236:239], v[64:67]
    buffer_load_dwordx4 v26, s[12:15], s46 offen offset:0 lds
    v_mfma_f32_16x16x32_bf16 v[68:71], a[36:39], v[240:243], v[68:71]
    ds_read_b64_tr_b16 a[94:95], v5 offset:7040
    ds_read_b64_tr_b16 a[96:97], v4 offset:12416
    v_mfma_f32_16x16x32_bf16 v[72:75], a[40:43], v[240:243], v[72:75]
    ds_read_b128 v[204:207], v118 offset:0
    v_lshlrev_b32_sdwa v122, 4, v136 dst_sel:DWORD dst_unused:UNUSED_PAD src0_sel:DWORD src1_sel:WORD_0
    v_lshlrev_b32_sdwa v123, 4, v138 dst_sel:DWORD dst_unused:UNUSED_PAD src0_sel:DWORD src1_sel:WORD_0
    v_mfma_f32_16x16x32_bf16 v[76:79], a[44:47], v[240:243], v[76:79]
    ds_read_b64_tr_b16 a[98:99], v4 offset:13184
    v_mfma_f32_16x16x32_bf16 v[76:79], a[56:59], v[244:247], v[76:79]
    ds_read_b64_tr_b16 a[100:101], v4 offset:12448
    ds_read_b64_tr_b16 a[102:103], v4 offset:13216
    v_mfma_f32_16x16x32_bf16 v[72:75], a[52:55], v[244:247], v[72:75]
    ds_read_b128 v[208:211], v118 offset:64
    v_mfma_f32_16x16x32_bf16 v[68:71], a[48:51], v[244:247], v[68:71]
    buffer_load_dwordx4 v26, s[12:15], s46 offen offset:1024 lds
    s_add_u32 s46, s46, 18432
    v_mfma_f32_16x16x32_bf16 v[68:71], a[60:63], v[248:251], v[68:71]
    ds_read_b64_tr_b16 a[104:105], v5 offset:12480
    ds_read_b64_tr_b16 a[106:107], v5 offset:13248
    v_mfma_f32_16x16x32_bf16 v[72:75], a[64:67], v[248:251], v[72:75]
    ds_read_b128 v[212:215], v118 offset:128
    v_lshlrev_b32_sdwa v124, 4, v136 dst_sel:DWORD dst_unused:UNUSED_PAD src0_sel:DWORD src1_sel:WORD_1
    v_mfma_f32_16x16x32_bf16 v[76:79], a[68:71], v[248:251], v[76:79]
    s_waitcnt vmcnt(5)
    s_waitcnt lgkmcnt(1)
    s_barrier
    v_mfma_f32_16x16x32_bf16 v[44:47], a[72:75], v[180:183], v[44:47]
    ds_read_b64_tr_b16 a[108:109], v4 offset:18624
    v_mfma_f32_16x16x32_bf16 v[48:51], a[76:79], v[180:183], v[48:51]
    ds_read_b128 v[216:219], v122 offset:0
    ds_read_b128 v[136:139], v172 offset:2048
    v_mfma_f32_16x16x32_bf16 v[52:55], a[80:83], v[180:183], v[52:55]
    ds_read_b64_tr_b16 a[110:111], v4 offset:19392
    v_mfma_f32_16x16x32_bf16 v[52:55], a[92:95], v[184:187], v[52:55]
    ds_read_b64_tr_b16 a[112:113], v4 offset:18656
    v_mfma_f32_16x16x32_bf16 v[48:51], a[88:91], v[184:187], v[48:51]
    ds_read_b128 v[220:223], v122 offset:64
    v_mfma_f32_16x16x32_bf16 v[44:47], a[84:87], v[184:187], v[44:47]
    ds_read_b64_tr_b16 a[114:115], v4 offset:19424
    v_mfma_f32_16x16x32_bf16 v[44:47], a[96:99], v[188:191], v[44:47]
    ds_read_b64_tr_b16 a[116:117], v5 offset:18688
    v_mfma_f32_16x16x32_bf16 v[48:51], a[100:103], v[188:191], v[48:51]
    ds_read_b128 v[224:227], v122 offset:128
    v_mfma_f32_16x16x32_bf16 v[52:55], a[104:107], v[188:191], v[52:55]
    ds_read_b64_tr_b16 a[118:119], v5 offset:19456
    v_mfma_f32_16x16x32_bf16 v[56:59], a[72:75], v[192:195], v[56:59]
    ds_read_b64_tr_b16 a[120:121], v4 offset:24832
    v_mfma_f32_16x16x32_bf16 v[60:63], a[76:79], v[192:195], v[60:63]
    ds_read_b128 v[228:231], v123 offset:0
    v_mfma_f32_16x16x32_bf16 v[64:67], a[80:83], v[192:195], v[64:67]
    ds_read_b64_tr_b16 a[122:123], v4 offset:25600
    s_waitcnt lgkmcnt(7)
    v_xor_b32 v136, v136, v166
    v_xor_b32 v138, v138, v166
    v_mfma_f32_16x16x32_bf16 v[64:67], a[92:95], v[196:199], v[64:67]
    ds_read_b64_tr_b16 a[124:125], v4 offset:24864
    v_mfma_f32_16x16x32_bf16 v[60:63], a[88:91], v[196:199], v[60:63]
    ds_read_b128 v[232:235], v123 offset:64
    v_mfma_f32_16x16x32_bf16 v[56:59], a[84:87], v[196:199], v[56:59]
    ds_read_b64_tr_b16 a[126:127], v4 offset:25632
    v_mfma_f32_16x16x32_bf16 v[56:59], a[96:99], v[200:203], v[56:59]
    ds_read_b64_tr_b16 a[128:129], v5 offset:24896
    v_mfma_f32_16x16x32_bf16 v[60:63], a[100:103], v[200:203], v[60:63]
    ds_read_b128 v[236:239], v123 offset:128
    v_mfma_f32_16x16x32_bf16 v[64:67], a[104:107], v[200:203], v[64:67]
    ds_read_b64_tr_b16 a[130:131], v5 offset:25664
    v_lshlrev_b32_sdwa v128, 4, v136 dst_sel:DWORD dst_unused:UNUSED_PAD src0_sel:DWORD src1_sel:WORD_0
    v_lshlrev_b32_sdwa v129, 4, v138 dst_sel:DWORD dst_unused:UNUSED_PAD src0_sel:DWORD src1_sel:WORD_0
    v_mfma_f32_16x16x32_bf16 v[68:71], a[72:75], v[204:207], v[68:71]
    ds_read_b64_tr_b16 a[132:133], v4 offset:31040
    v_mfma_f32_16x16x32_bf16 v[72:75], a[76:79], v[204:207], v[72:75]
    ds_read_b128 v[240:243], v124 offset:0
    v_mfma_f32_16x16x32_bf16 v[76:79], a[80:83], v[204:207], v[76:79]
    ds_read_b64_tr_b16 a[134:135], v4 offset:31808
    v_mfma_f32_16x16x32_bf16 v[76:79], a[92:95], v[208:211], v[76:79]
    ds_read_b64_tr_b16 a[136:137], v4 offset:31072
    v_mfma_f32_16x16x32_bf16 v[72:75], a[88:91], v[208:211], v[72:75]
    ds_read_b128 v[244:247], v124 offset:64
    v_mfma_f32_16x16x32_bf16 v[68:71], a[84:87], v[208:211], v[68:71]
    ds_read_b64_tr_b16 a[138:139], v4 offset:31840
    v_lshlrev_b32_sdwa v130, 4, v136 dst_sel:DWORD dst_unused:UNUSED_PAD src0_sel:DWORD src1_sel:WORD_1
    v_mfma_f32_16x16x32_bf16 v[68:71], a[96:99], v[212:215], v[68:71]
    ds_read_b64_tr_b16 a[140:141], v5 offset:31104
    ds_read_b64_tr_b16 a[142:143], v5 offset:31872
    v_mfma_f32_16x16x32_bf16 v[72:75], a[100:103], v[212:215], v[72:75]
    ds_read_b128 v[248:251], v124 offset:128
    v_mfma_f32_16x16x32_bf16 v[76:79], a[104:107], v[212:215], v[76:79]
    s_waitcnt vmcnt(0)
    s_waitcnt lgkmcnt(1)
    s_barrier
    v_mfma_f32_16x16x32_bf16 v[44:47], a[108:111], v[216:219], v[44:47]
    ds_read_b64_tr_b16 a[0:1], v4 offset:37248
    s_lshl_b32 s55, s55, 1
    v_mfma_f32_16x16x32_bf16 v[48:51], a[112:115], v[216:219], v[48:51]
    ds_read_b128 v[180:183], v128 offset:0
    s_mul_i32 s47, s28, 3104
    v_mfma_f32_16x16x32_bf16 v[52:55], a[116:119], v[216:219], v[52:55]
    ds_read_b64_tr_b16 a[2:3], v4 offset:38016
    v_mfma_f32_16x16x32_bf16 v[52:55], a[128:131], v[220:223], v[52:55]
    ds_read_b64_tr_b16 a[4:5], v4 offset:37280
    s_add_u32 s47, s47, 107616
    v_mfma_f32_16x16x32_bf16 v[48:51], a[124:127], v[220:223], v[48:51]
    ds_read_b128 v[184:187], v128 offset:64
    v_lshrrev_b32 v21, 6, v6
    v_mfma_f32_16x16x32_bf16 v[44:47], a[120:123], v[220:223], v[44:47]
    ds_read_b64_tr_b16 a[6:7], v4 offset:38048
    v_mfma_f32_16x16x32_bf16 v[44:47], a[132:135], v[224:227], v[44:47]
    ds_read_b64_tr_b16 a[8:9], v5 offset:37312
    v_and_b32 v22, 48, v6
    v_mfma_f32_16x16x32_bf16 v[48:51], a[136:139], v[224:227], v[48:51]
    ds_read_b128 v[188:191], v128 offset:128
    v_mul_u32_u24 v17, 112, v21
    v_mfma_f32_16x16x32_bf16 v[52:55], a[140:143], v[224:227], v[52:55]
    ds_read_b64_tr_b16 a[10:11], v5 offset:38080
    v_mfma_f32_16x16x32_bf16 v[56:59], a[108:111], v[228:231], v[56:59]
    ds_read_b64_tr_b16 a[12:13], v4 offset:43456
    v_mul_u32_u24 v19, s2, v21
    v_mfma_f32_16x16x32_bf16 v[60:63], a[112:115], v[228:231], v[60:63]
    ds_read_b128 v[192:195], v129 offset:0
    v_lshrrev_b32 v23, 1, v22
    v_mfma_f32_16x16x32_bf16 v[64:67], a[116:119], v[228:231], v[64:67]
    ds_read_b64_tr_b16 a[14:15], v4 offset:44224
    v_mfma_f32_16x16x32_bf16 v[64:67], a[128:131], v[232:235], v[64:67]
    ds_read_b64_tr_b16 a[16:17], v4 offset:43488
    s_lshl_b32 s48, s29, 7
    v_mfma_f32_16x16x32_bf16 v[60:63], a[124:127], v[232:235], v[60:63]
    ds_read_b128 v[196:199], v129 offset:64
    v_mfma_f32_16x16x32_bf16 v[56:59], a[120:123], v[232:235], v[56:59]
    ds_read_b64_tr_b16 a[18:19], v4 offset:44256
    s_lshl_b32 s49, s29, 5
    v_mfma_f32_16x16x32_bf16 v[56:59], a[132:135], v[236:239], v[56:59]
    ds_read_b64_tr_b16 a[20:21], v5 offset:43520
    s_add_u32 s49, s49, 64
    v_mfma_f32_16x16x32_bf16 v[60:63], a[136:139], v[236:239], v[60:63]
    ds_read_b128 v[200:203], v129 offset:128
    v_mfma_f32_16x16x32_bf16 v[64:67], a[140:143], v[236:239], v[64:67]
    ds_read_b64_tr_b16 a[22:23], v5 offset:44288
    v_add3_u32 v20, v19, s49, v23
    v_mfma_f32_16x16x32_bf16 v[68:71], a[108:111], v[240:243], v[68:71]
    ds_read_b64_tr_b16 a[24:25], v4 offset:49664
    v_add3_u32 v19, v19, s48, v22
    v_mfma_f32_16x16x32_bf16 v[72:75], a[112:115], v[240:243], v[72:75]
    ds_read_b128 v[204:207], v130 offset:0
    v_mfma_f32_16x16x32_bf16 v[76:79], a[116:119], v[240:243], v[76:79]
    ds_read_b64_tr_b16 a[26:27], v4 offset:50432
    s_add_u32 s48, s47, 64
    v_mfma_f32_16x16x32_bf16 v[76:79], a[128:131], v[244:247], v[76:79]
    ds_read_b64_tr_b16 a[28:29], v4 offset:49696
    v_add3_u32 v18, v17, s48, v23
    v_mfma_f32_16x16x32_bf16 v[72:75], a[124:127], v[244:247], v[72:75]
    ds_read_b128 v[208:211], v130 offset:64
    v_mfma_f32_16x16x32_bf16 v[68:71], a[120:123], v[244:247], v[68:71]
    ds_read_b64_tr_b16 a[30:31], v4 offset:50464
    s_waitcnt lgkmcnt(7)
    v_mfma_f32_16x16x32_bf16 v[68:71], a[132:135], v[248:251], v[68:71]
    ds_read_b64_tr_b16 a[32:33], v5 offset:49728
    ds_read_b64_tr_b16 a[34:35], v5 offset:50496
    v_mfma_f32_16x16x32_bf16 v[72:75], a[136:139], v[248:251], v[72:75]
    ds_read_b128 v[212:215], v130 offset:128
    v_mfma_f32_16x16x32_bf16 v[76:79], a[140:143], v[248:251], v[76:79]
    v_add3_u32 v17, v17, s47, v22
    v_and_b32 v21, 3, v21
    v_mfma_f32_16x16x32_bf16 v[44:47], a[0:3], v[180:183], v[44:47]
    v_lshrrev_b32 v22, 2, v22
    v_mfma_f32_16x16x32_bf16 v[48:51], a[4:7], v[180:183], v[48:51]
    v_add_u32 v21, v21, v22
    v_mfma_f32_16x16x32_bf16 v[52:55], a[8:11], v[180:183], v[52:55]
    v_lshrrev_b32 v22, 8, v6
    s_waitcnt lgkmcnt(7)
    v_mfma_f32_16x16x32_bf16 v[52:55], a[20:23], v[184:187], v[52:55]
    v_mfma_f32_16x16x32_bf16 v[48:51], a[16:19], v[184:187], v[48:51]
    v_mul_u32_u24 v21, 112, v21
    v_mfma_f32_16x16x32_bf16 v[44:47], a[12:15], v[184:187], v[44:47]
    v_lshlrev_b32 v22, 3, v22
    s_waitcnt lgkmcnt(6)
    v_mfma_f32_16x16x32_bf16 v[44:47], a[24:27], v[188:191], v[44:47]
    s_waitcnt lgkmcnt(3)
    v_mfma_f32_16x16x32_bf16 v[48:51], a[28:31], v[188:191], v[48:51]
    v_add3_u32 v16, v21, s47, v22
    s_waitcnt lgkmcnt(1)
    v_mfma_f32_16x16x32_bf16 v[52:55], a[32:35], v[188:191], v[52:55]
    v_mfma_f32_16x16x32_bf16 v[56:59], a[0:3], v[192:195], v[56:59]
    v_mfma_f32_16x16x32_bf16 v[60:63], a[4:7], v[192:195], v[60:63]
    v_mfma_f32_16x16x32_bf16 v[64:67], a[8:11], v[192:195], v[64:67]
    v_mfma_f32_16x16x32_bf16 v[64:67], a[20:23], v[196:199], v[64:67]
    v_cvt_pk_bf16_f32 v32, v44, v45
    v_cvt_pk_bf16_f32 v33, v46, v47
    v_mfma_f32_16x16x32_bf16 v[60:63], a[16:19], v[196:199], v[60:63]
    v_cvt_pk_bf16_f32 v34, v48, v49
    v_cvt_pk_bf16_f32 v35, v50, v51
    v_mfma_f32_16x16x32_bf16 v[56:59], a[12:15], v[196:199], v[56:59]
    ds_write_b64 v16, v[32:33] offset:0
    v_mfma_f32_16x16x32_bf16 v[56:59], a[24:27], v[200:203], v[56:59]
    v_cvt_pk_bf16_f32 v36, v52, v53
    v_cvt_pk_bf16_f32 v37, v54, v55
    ds_write_b64 v16, v[34:35] offset:32
    v_mfma_f32_16x16x32_bf16 v[60:63], a[28:31], v[200:203], v[60:63]
    ds_write_b64 v16, v[36:37] offset:64
    ds_read_b128 v[38:41], v17
    v_mfma_f32_16x16x32_bf16 v[64:67], a[32:35], v[200:203], v[64:67]
    ds_read_b64 v[42:43], v18
    s_waitcnt lgkmcnt(1)
    buffer_store_dwordx4 v[38:41], v19, s[16:19], s31 offen sc1
    s_waitcnt lgkmcnt(0)
    buffer_store_dwordx2 v[42:43], v20, s[16:19], s31 offen sc1
    s_add_u32 s31, s31, s55
    v_mfma_f32_16x16x32_bf16 v[68:71], a[0:3], v[204:207], v[68:71]
    v_mfma_f32_16x16x32_bf16 v[72:75], a[4:7], v[204:207], v[72:75]
    v_mfma_f32_16x16x32_bf16 v[76:79], a[8:11], v[204:207], v[76:79]
    v_mfma_f32_16x16x32_bf16 v[76:79], a[20:23], v[208:211], v[76:79]
    v_cvt_pk_bf16_f32 v32, v56, v57
    v_cvt_pk_bf16_f32 v33, v58, v59
    v_mfma_f32_16x16x32_bf16 v[72:75], a[16:19], v[208:211], v[72:75]
    v_cvt_pk_bf16_f32 v34, v60, v61
    v_cvt_pk_bf16_f32 v35, v62, v63
    v_mfma_f32_16x16x32_bf16 v[68:71], a[12:15], v[208:211], v[68:71]
    ds_write_b64 v16, v[32:33] offset:0
    v_mfma_f32_16x16x32_bf16 v[68:71], a[24:27], v[212:215], v[68:71]
    v_cvt_pk_bf16_f32 v36, v64, v65
    v_cvt_pk_bf16_f32 v37, v66, v67
    v_mfma_f32_16x16x32_bf16 v[72:75], a[28:31], v[212:215], v[72:75]
    ds_write_b64 v16, v[34:35] offset:32
    v_mfma_f32_16x16x32_bf16 v[76:79], a[32:35], v[212:215], v[76:79]
    ds_write_b64 v16, v[36:37] offset:64
    ds_read_b128 v[24:27], v17
    ds_read_b64 v[28:29], v18
    s_waitcnt lgkmcnt(1)
    buffer_store_dwordx4 v[24:27], v19, s[16:19], s31 offen sc1
    s_waitcnt lgkmcnt(0)
    buffer_store_dwordx2 v[28:29], v20, s[16:19], s31 offen sc1
    s_add_u32 s31, s31, s55
    s_cmp_lg_u32 s54, 0
    v_cvt_pk_bf16_f32 v32, v68, v69
    v_cvt_pk_bf16_f32 v33, v70, v71
    v_cvt_pk_bf16_f32 v34, v72, v73
    v_cvt_pk_bf16_f32 v35, v74, v75
    ds_write_b64 v16, v[32:33] offset:0
    v_cvt_pk_bf16_f32 v36, v76, v77
    v_cvt_pk_bf16_f32 v37, v78, v79
    ds_write_b64 v16, v[34:35] offset:32
    ds_write_b64 v16, v[36:37] offset:64
    ds_read_b128 v[38:41], v17
    ds_read_b64 v[42:43], v18
    s_waitcnt lgkmcnt(1)
    buffer_store_dwordx4 v[38:41], v19, s[16:19], s31 offen sc1
    s_waitcnt lgkmcnt(0)
    buffer_store_dwordx2 v[42:43], v20, s[16:19], s31 offen sc1
    s_cbranch_scc1 L_gS
    s_endpgm
L_cold:
L_gW:
    s_waitcnt vmcnt(0) lgkmcnt(0)
    v_mbcnt_lo_u32_b32 v16, -1, 0
    v_mbcnt_hi_u32_b32 v16, -1, v16
    v_lshlrev_b32 v6, 4, v16
    v_lshrrev_b32 v17, 4, v16
    v_and_b32 v16, 15, v16
    v_and_b32 v4, 1, v17
    v_mul_u32_u24 v4, 3104, v4
    v_lshrrev_b32 v5, 1, v17
    v_lshlrev_b32 v5, 3, v5
    v_lshrrev_b32 v12, 2, v16
    v_add_u32 v5, v5, v12
    v_mul_u32_u24 v5, 192, v5
    v_and_b32 v12, 3, v16
    v_lshl_add_u32 v4, v12, 3, v4
    v_add_u32 v4, v4, v5
    s_mul_i32 s44, s28, 18624
    s_lshl_b32 s48, s29, 5
    s_add_u32 s48, s48, s44
    v_add_u32 v5, s48, v4
    s_lshl_b32 s48, s29, 7
    s_add_u32 s48, s48, s44
    v_add_u32 v4, s48, v4
    s_mov_b32 s46, 0
    s_call_b64 s[52:53], L_gD
    ds_read_b64_tr_b16 a[0:1], v4 offset:0
    ds_read_b64_tr_b16 a[2:3], v4 offset:768
    ds_read_b64_tr_b16 a[4:5], v4 offset:32
    ds_read_b64_tr_b16 a[6:7], v4 offset:800
    ds_read_b64_tr_b16 a[8:9], v5 offset:64
    ds_read_b64_tr_b16 a[10:11], v5 offset:832
    ds_read_b64_tr_b16 a[12:13], v4 offset:6208
    ds_read_b64_tr_b16 a[14:15], v4 offset:6976
    ds_read_b64_tr_b16 a[16:17], v4 offset:6240
    ds_read_b64_tr_b16 a[18:19], v4 offset:7008
    ds_read_b64_tr_b16 a[20:21], v5 offset:6272
    ds_read_b64_tr_b16 a[22:23], v5 offset:7040
    ds_read_b64_tr_b16 a[24:25], v4 offset:12416
    ds_read_b64_tr_b16 a[26:27], v4 offset:13184
    ds_read_b64_tr_b16 a[28:29], v4 offset:12448
    ds_read_b64_tr_b16 a[30:31], v4 offset:13216
    ds_read_b64_tr_b16 a[32:33], v5 offset:12480
    ds_read_b64_tr_b16 a[34:35], v5 offset:13248
    s_call_b64 s[52:53], L_gD
    ds_read_b64_tr_b16 a[36:37], v4 offset:0
    ds_read_b64_tr_b16 a[38:39], v4 offset:768
    ds_read_b64_tr_b16 a[40:41], v4 offset:32
    ds_read_b64_tr_b16 a[42:43], v4 offset:800
    ds_read_b64_tr_b16 a[44:45], v5 offset:64
    ds_read_b64_tr_b16 a[46:47], v5 offset:832
    ds_read_b64_tr_b16 a[48:49], v4 offset:6208
    ds_read_b64_tr_b16 a[50:51], v4 offset:6976
    ds_read_b64_tr_b16 a[52:53], v4 offset:6240
    ds_read_b64_tr_b16 a[54:55], v4 offset:7008
    ds_read_b64_tr_b16 a[56:57], v5 offset:6272
    ds_read_b64_tr_b16 a[58:59], v5 offset:7040
    ds_read_b64_tr_b16 a[60:61], v4 offset:12416
    ds_read_b64_tr_b16 a[62:63], v4 offset:13184
    ds_read_b64_tr_b16 a[64:65], v4 offset:12448
    ds_read_b64_tr_b16 a[66:67], v4 offset:13216
    ds_read_b64_tr_b16 a[68:69], v5 offset:12480
    ds_read_b64_tr_b16 a[70:71], v5 offset:13248
    s_call_b64 s[52:53], L_gD
    ds_read_b64_tr_b16 a[72:73], v4 offset:0
    ds_read_b64_tr_b16 a[74:75], v4 offset:768
    ds_read_b64_tr_b16 a[76:77], v4 offset:32
    ds_read_b64_tr_b16 a[78:79], v4 offset:800
    ds_read_b64_tr_b16 a[80:81], v5 offset:64
    ds_read_b64_tr_b16 a[82:83], v5 offset:832
    ds_read_b64_tr_b16 a[84:85], v4 offset:6208
    ds_read_b64_tr_b16 a[86:87], v4 offset:6976
    ds_read_b64_tr_b16 a[88:89], v4 offset:6240
    ds_read_b64_tr_b16 a[90:91], v4 offset:7008
    ds_read_b64_tr_b16 a[92:93], v5 offset:6272
    ds_read_b64_tr_b16 a[94:95], v5 offset:7040
    ds_read_b64_tr_b16 a[96:97], v4 offset:12416
    ds_read_b64_tr_b16 a[98:99], v4 offset:13184
    ds_read_b64_tr_b16 a[100:101], v4 offset:12448
    ds_read_b64_tr_b16 a[102:103], v4 offset:13216
    ds_read_b64_tr_b16 a[104:105], v5 offset:12480
    ds_read_b64_tr_b16 a[106:107], v5 offset:13248
    s_call_b64 s[52:53], L_gD
    ds_read_b64_tr_b16 a[108:109], v4 offset:0
    ds_read_b64_tr_b16 a[110:111], v4 offset:768
    ds_read_b64_tr_b16 a[112:113], v4 offset:32
    ds_read_b64_tr_b16 a[114:115], v4 offset:800
    ds_read_b64_tr_b16 a[116:117], v5 offset:64
    ds_read_b64_tr_b16 a[118:119], v5 offset:832
    ds_read_b64_tr_b16 a[120:121], v4 offset:6208
    ds_read_b64_tr_b16 a[122:123], v4 offset:6976
    ds_read_b64_tr_b16 a[124:125], v4 offset:6240
    ds_read_b64_tr_b16 a[126:127], v4 offset:7008
    ds_read_b64_tr_b16 a[128:129], v5 offset:6272
    ds_read_b64_tr_b16 a[130:131], v5 offset:7040
    ds_read_b64_tr_b16 a[132:133], v4 offset:12416
    ds_read_b64_tr_b16 a[134:135], v4 offset:13184
    ds_read_b64_tr_b16 a[136:137], v4 offset:12448
    ds_read_b64_tr_b16 a[138:139], v4 offset:13216
    ds_read_b64_tr_b16 a[140:141], v5 offset:12480
    ds_read_b64_tr_b16 a[142:143], v5 offset:13248
    s_call_b64 s[52:53], L_gD
    ds_read_b64_tr_b16 a[144:145], v4 offset:0
    ds_read_b64_tr_b16 a[146:147], v4 offset:768
    ds_read_b64_tr_b16 a[148:149], v4 offset:32
    ds_read_b64_tr_b16 a[150:151], v4 offset:800
    ds_read_b64_tr_b16 a[152:153], v5 offset:64
    ds_read_b64_tr_b16 a[154:155], v5 offset:832
    ds_read_b64_tr_b16 a[156:157], v4 offset:6208
    ds_read_b64_tr_b16 a[158:159], v4 offset:6976
    ds_read_b64_tr_b16 a[160:161], v4 offset:6240
    ds_read_b64_tr_b16 a[162:163], v4 offset:7008
    ds_read_b64_tr_b16 a[164:165], v5 offset:6272
    ds_read_b64_tr_b16 a[166:167], v5 offset:7040
    ds_read_b64_tr_b16 a[168:169], v4 offset:12416
    ds_read_b64_tr_b16 a[170:171], v4 offset:13184
    ds_read_b64_tr_b16 a[172:173], v4 offset:12448
    ds_read_b64_tr_b16 a[174:175], v4 offset:13216
    ds_read_b64_tr_b16 a[176:177], v5 offset:12480
    ds_read_b64_tr_b16 a[178:179], v5 offset:13248
    s_call_b64 s[52:53], L_gD
    ds_read_b64_tr_b16 a[180:181], v4 offset:0
    ds_read_b64_tr_b16 a[182:183], v4 offset:768
    ds_read_b64_tr_b16 a[184:185], v4 offset:32
    ds_read_b64_tr_b16 a[186:187], v4 offset:800
    ds_read_b64_tr_b16 a[188:189], v5 offset:64
    ds_read_b64_tr_b16 a[190:191], v5 offset:832
    ds_read_b64_tr_b16 a[192:193], v4 offset:6208
    ds_read_b64_tr_b16 a[194:195], v4 offset:6976
    ds_read_b64_tr_b16 a[196:197], v4 offset:6240
    ds_read_b64_tr_b16 a[198:199], v4 offset:7008
    ds_read_b64_tr_b16 a[200:201], v5 offset:6272
    ds_read_b64_tr_b16 a[202:203], v5 offset:7040
    ds_read_b64_tr_b16 a[204:205], v4 offset:12416
    ds_read_b64_tr_b16 a[206:207], v4 offset:13184
    ds_read_b64_tr_b16 a[208:209], v4 offset:12448
    ds_read_b64_tr_b16 a[210:211], v4 offset:13216
    ds_read_b64_tr_b16 a[212:213], v5 offset:12480
    ds_read_b64_tr_b16 a[214:215], v5 offset:13248
    s_call_b64 s[52:53], L_gD
    ds_read_b64_tr_b16 a[216:217], v4 offset:0
    ds_read_b64_tr_b16 a[218:219], v4 offset:768
    ds_read_b64_tr_b16 a[220:221], v4 offset:32
    ds_read_b64_tr_b16 a[222:223], v4 offset:800
    ds_read_b64_tr_b16 a[224:225], v5 offset:64
    ds_read_b64_tr_b16 a[226:227], v5 offset:832
    ds_read_b64_tr_b16 a[228:229], v4 offset:6208
    ds_read_b64_tr_b16 a[230:231], v4 offset:6976
    ds_read_b64_tr_b16 a[232:233], v4 offset:6240
    ds_read_b64_tr_b16 a[234:235], v4 offset:7008
    ds_read_b64_tr_b16 a[236:237], v5 offset:6272
    ds_read_b64_tr_b16 a[238:239], v5 offset:7040
    ds_read_b64_tr_b16 a[240:241], v4 offset:12416
    ds_read_b64_tr_b16 a[242:243], v4 offset:13184
    ds_read_b64_tr_b16 a[244:245], v4 offset:12448
    ds_read_b64_tr_b16 a[246:247], v4 offset:13216
    ds_read_b64_tr_b16 a[248:249], v5 offset:12480
    ds_read_b64_tr_b16 a[250:251], v5 offset:13248
    s_call_b64 s[52:53], L_gD
    ds_read_b64_tr_b16 a[252:253], v4 offset:0
    ds_read_b64_tr_b16 a[254:255], v4 offset:768
    ds_read_b64_tr_b16 v[188:189], v4 offset:32
    ds_read_b64_tr_b16 v[190:191], v4 offset:800
    ds_read_b64_tr_b16 v[192:193], v5 offset:64
    ds_read_b64_tr_b16 v[194:195], v5 offset:832
    ds_read_b64_tr_b16 v[196:197], v4 offset:6208
    ds_read_b64_tr_b16 v[198:199], v4 offset:6976
    ds_read_b64_tr_b16 v[200:201], v4 offset:6240
    ds_read_b64_tr_b16 v[202:203], v4 offset:7008
    ds_read_b64_tr_b16 v[204:205], v5 offset:6272
    ds_read_b64_tr_b16 v[206:207], v5 offset:7040
    ds_read_b64_tr_b16 v[208:209], v4 offset:12416
    ds_read_b64_tr_b16 v[210:211], v4 offset:13184
    ds_read_b64_tr_b16 v[212:213], v4 offset:12448
    ds_read_b64_tr_b16 v[214:215], v4 offset:13216
    ds_read_b64_tr_b16 v[216:217], v5 offset:12480
    ds_read_b64_tr_b16 v[218:219], v5 offset:13248
    s_call_b64 s[52:53], L_gD
    ds_read_b64_tr_b16 v[220:221], v4 offset:0
    ds_read_b64_tr_b16 v[222:223], v4 offset:768
    ds_read_b64_tr_b16 v[224:225], v4 offset:32
    ds_read_b64_tr_b16 v[226:227], v4 offset:800
    ds_read_b64_tr_b16 v[228:229], v5 offset:64
    ds_read_b64_tr_b16 v[230:231], v5 offset:832
    ds_read_b64_tr_b16 v[232:233], v4 offset:6208
    ds_read_b64_tr_b16 v[234:235], v4 offset:6976
    ds_read_b64_tr_b16 v[236:237], v4 offset:6240
    ds_read_b64_tr_b16 v[238:239], v4 offset:7008
    ds_read_b64_tr_b16 v[240:241], v5 offset:6272
    ds_read_b64_tr_b16 v[242:243], v5 offset:7040
    ds_read_b64_tr_b16 v[244:245], v4 offset:12416
    ds_read_b64_tr_b16 v[246:247], v4 offset:13184
    ds_read_b64_tr_b16 v[248:249], v4 offset:12448
    ds_read_b64_tr_b16 v[250:251], v4 offset:13216
    ds_read_b64_tr_b16 v[252:253], v5 offset:12480
    ds_read_b64_tr_b16 v[254:255], v5 offset:13248
    s_branch L_g0
L_gD:
    s_waitcnt lgkmcnt(0)
    s_add_u32 m0, s44, 0
    s_nop 0
    buffer_load_dwordx4 v6, s[12:15], s46 offen offset:0 lds
    buffer_load_dwordx4 v6, s[12:15], s46 offen offset:1024 lds
    buffer_load_dwordx4 v6, s[12:15], s46 offen offset:2048 lds
    s_add_u32 s46, s46, 3072
    s_add_u32 m0, s44, 3104
    s_nop 0
    buffer_load_dwordx4 v6, s[12:15], s46 offen offset:0 lds
    buffer_load_dwordx4 v6, s[12:15], s46 offen offset:1024 lds
    buffer_load_dwordx4 v6, s[12:15], s46 offen offset:2048 lds
    s_add_u32 s46, s46, 3072
    s_add_u32 m0, s44, 6208
    s_nop 0
    buffer_load_dwordx4 v6, s[12:15], s46 offen offset:0 lds
    buffer_load_dwordx4 v6, s[12:15], s46 offen offset:1024 lds
    buffer_load_dwordx4 v6, s[12:15], s46 offen offset:2048 lds
    s_add_u32 s46, s46, 3072
    s_add_u32 m0, s44, 9312
    s_nop 0
    buffer_load_dwordx4 v6, s[12:15], s46 offen offset:0 lds
    buffer_load_dwordx4 v6, s[12:15], s46 offen offset:1024 lds
    buffer_load_dwordx4 v6, s[12:15], s46 offen offset:2048 lds
    s_add_u32 s46, s46, 3072
    s_add_u32 m0, s44, 12416
    s_nop 0
    buffer_load_dwordx4 v6, s[12:15], s46 offen offset:0 lds
    buffer_load_dwordx4 v6, s[12:15], s46 offen offset:1024 lds
    buffer_load_dwordx4 v6, s[12:15], s46 offen offset:2048 lds
    s_add_u32 s46, s46, 3072
    s_add_u32 m0, s44, 15520
    s_nop 0
    buffer_load_dwordx4 v6, s[12:15], s46 offen offset:0 lds
    buffer_load_dwordx4 v6, s[12:15], s46 offen offset:1024 lds
    buffer_load_dwordx4 v6, s[12:15], s46 offen offset:2048 lds
    s_add_u32 s46, s46, 3072
    s_waitcnt vmcnt(0)
    s_setpc_b64 s[52:53]
L_gN:
    s_movk_i32 s54, 0x7f
L_g0:
    v_mbcnt_lo_u32_b32 v16, -1, 0
    v_mbcnt_hi_u32_b32 v16, -1, v16
    v_lshlrev_b32 v6, 4, v16
    v_lshrrev_b32 v17, 4, v16
    v_and_b32 v16, 15, v16
    s_bfe_u32 s56, s23, 0x10010
    s_and_b32 s59, s23, 0xff
    s_bfe_u32 s58, s23, 0x80008
    s_and_b32 s47, s22, 15
    s_bfe_u32 s57, s22, 0x40004
    s_bfe_u32 s64, s23, 0x10011
    s_cselect_b32 s48, 1, s47
    s_cselect_b32 s65, 2.0, 1.0
    s_cmp_eq_u32 s30, 0
    s_cselect_b32 s57, s47, s57
    s_cselect_b32 s47, 0, s48
    s_cselect_b32 s31, s26, s27
    s_add_u32 s58, s58, s47
    v_add_u32 v32, s59, v16
    v_mov_b32 v33, s58
    v_cvt_f32_u32 v32, v32
    v_cvt_f32_u32 v33, v33
    s_cmp_eq_u32 s56, 0
    s_cselect_b32 s60, 224, 1
    s_cselect_b32 s61, 1, 224
    s_cselect_b32 s62, s65, 0
    s_cselect_b32 s63, 0, s65
    s_cselect_b64 vcc, -1, 0
    s_lshl_b32 s60, s60, s64
    v_cndmask_b32 v19, v32, v33, vcc
    v_cndmask_b32 v20, v33, v32, vcc
    v_mul_u32_u24 v32, s61, v16
    v_mul_u32_u24 v21, 36, v32
    v_mul_u32_u24 v32, 192, v32
    v_and_b32 v18, 1, v17
    v_lshrrev_b32 v33, 1, v17
    v_lshl_add_u32 v18, v18, 1, v33
    v_lshlrev_b32 v22, 4, v18
    s_lshl_b32 s48, s29, 7
    v_add3_u32 v9, v32, s48, v22
    s_lshl_b32 s48, s29, 5
    s_add_u32 s48, s48, 64
    v_lshlrev_b32 v33, 3, v17
    v_add3_u32 v10, v32, s48, v33
    s_mul_i32 s32, s31, 3
    s_lshr_b32 s32, s32, 4
    s_mov_b32 s65, 0x435f435f
    s_bfm_b32 s47, s57, 0
    s_bitset1_b32 s47, 31
    s_and_b32 s54, s54, s47
L_gt:
    s_and_b32 s47, s54, 0xff
    s_cbranch_scc0 L_end
    s_bitcmp1_b32 s54, 0
    s_cbranch_scc0 L_gn
    buffer_load_dwordx4 v[24:27], v21, s[8:11], s32 offen offset:4
    buffer_load_dwordx4 v[28:31], v21, s[8:11], s32 offen offset:20
    buffer_load_dword v23, v21, s[8:11], s32 offen
    s_lshr_b32 s66, s54, 31
    s_mov_b32 s67, 0
    s_mov_b32 s64, 0
    s_waitcnt vmcnt(0) lgkmcnt(0)
    v_add_f32 v34, -1.0, v19
    v_add_f32 v35, -1.0, v20
    v_lshlrev_b32 v32, 16, v23
    v_and_b32 v33, 0xffff0000, v23
    v_add_f32 v32, v32, v34
    v_add_f32 v33, v33, v35
    v_cvt_pk_bf16_f32 v34, v34, v35
    v_cvt_pk_bf16_f32 v23, v32, v33
    v_cmp_ne_u32 vcc, v34, v23
    v_pk_max_i16 v23, v23, 0
    v_pk_min_i16 v23, v23, s65
    s_or_b64 s[66:67], s[66:67], vcc
    v_add_f32 v34, -1.0, v19
    v_add_f32 v35, 0.0, v20
    v_lshlrev_b32 v32, 16, v24
    v_and_b32 v33, 0xffff0000, v24
    v_add_f32 v32, v32, v34
    v_add_f32 v33, v33, v35
    v_cvt_pk_bf16_f32 v34, v34, v35
    v_cvt_pk_bf16_f32 v24, v32, v33
    v_cmp_ne_u32 vcc, v34, v24
    v_pk_max_i16 v24, v24, 0
    v_pk_min_i16 v24, v24, s65
    s_or_b64 s[66:67], s[66:67], vcc
    v_add_f32 v34, -1.0, v19
    v_add_f32 v35, 1.0, v20
    v_lshlrev_b32 v32, 16, v25
    v_and_b32 v33, 0xffff0000, v25
    v_add_f32 v32, v32, v34
    v_add_f32 v33, v33, v35
    v_cvt_pk_bf16_f32 v34, v34, v35
    v_cvt_pk_bf16_f32 v25, v32, v33
    v_cmp_ne_u32 vcc, v34, v25
    v_pk_max_i16 v25, v25, 0
    v_pk_min_i16 v25, v25, s65
    s_or_b64 s[66:67], s[66:67], vcc
    v_add_f32 v34, 0.0, v19
    v_add_f32 v35, -1.0, v20
    v_lshlrev_b32 v32, 16, v26
    v_and_b32 v33, 0xffff0000, v26
    v_add_f32 v32, v32, v34
    v_add_f32 v33, v33, v35
    v_cvt_pk_bf16_f32 v34, v34, v35
    v_cvt_pk_bf16_f32 v26, v32, v33
    v_cmp_ne_u32 vcc, v34, v26
    v_pk_max_i16 v26, v26, 0
    v_pk_min_i16 v26, v26, s65
    s_or_b64 s[66:67], s[66:67], vcc
    v_add_f32 v34, 0.0, v19
    v_add_f32 v35, 0.0, v20
    v_lshlrev_b32 v32, 16, v27
    v_and_b32 v33, 0xffff0000, v27
    v_add_f32 v32, v32, v34
    v_add_f32 v33, v33, v35
    v_cvt_pk_bf16_f32 v34, v34, v35
    v_cvt_pk_bf16_f32 v27, v32, v33
    v_cmp_ne_u32 vcc, v34, v27
    v_pk_max_i16 v27, v27, 0
    v_pk_min_i16 v27, v27, s65
    s_or_b64 s[66:67], s[66:67], vcc
    v_add_f32 v34, 0.0, v19
    v_add_f32 v35, 1.0, v20
    v_lshlrev_b32 v32, 16, v28
    v_and_b32 v33, 0xffff0000, v28
    v_add_f32 v32, v32, v34
    v_add_f32 v33, v33, v35
    v_cvt_pk_bf16_f32 v34, v34, v35
    v_cvt_pk_bf16_f32 v28, v32, v33
    v_cmp_ne_u32 vcc, v34, v28
    v_pk_max_i16 v28, v28, 0
    v_pk_min_i16 v28, v28, s65
    s_or_b64 s[66:67], s[66:67], vcc
    v_add_f32 v34, 1.0, v19
    v_add_f32 v35, -1.0, v20
    v_lshlrev_b32 v32, 16, v29
    v_and_b32 v33, 0xffff0000, v29
    v_add_f32 v32, v32, v34
    v_add_f32 v33, v33, v35
    v_cvt_pk_bf16_f32 v34, v34, v35
    v_cvt_pk_bf16_f32 v29, v32, v33
    v_cmp_ne_u32 vcc, v34, v29
    v_pk_max_i16 v29, v29, 0
    v_pk_min_i16 v29, v29, s65
    s_or_b64 s[66:67], s[66:67], vcc
    v_add_f32 v34, 1.0, v19
    v_add_f32 v35, 0.0, v20
    v_lshlrev_b32 v32, 16, v30
    v_and_b32 v33, 0xffff0000, v30
    v_add_f32 v32, v32, v34
    v_add_f32 v33, v33, v35
    v_cvt_pk_bf16_f32 v34, v34, v35
    v_cvt_pk_bf16_f32 v30, v32, v33
    v_cmp_ne_u32 vcc, v34, v30
    v_pk_max_i16 v30, v30, 0
    v_pk_min_i16 v30, v30, s65
    s_or_b64 s[66:67], s[66:67], vcc
    v_add_f32 v34, 1.0, v19
    v_add_f32 v35, 1.0, v20
    v_lshlrev_b32 v32, 16, v31
    v_and_b32 v33, 0xffff0000, v31
    v_add_f32 v32, v32, v34
    v_add_f32 v33, v33, v35
    v_cvt_pk_bf16_f32 v34, v34, v35
    v_cvt_pk_bf16_f32 v31, v32, v33
    v_cmp_ne_u32 vcc, v34, v31
    v_pk_max_i16 v31, v31, 0
    v_pk_min_i16 v31, v31, s65
    s_or_b64 s[66:67], s[66:67], vcc
    s_cbranch_scc0 L_gn
    s_movk_i32 s49, 224
    v_lshlrev_b32 v32, 16, v31
    v_and_b32 v33, 0xffff0000, v31
    v_fract_f32 v36, v32
    v_fract_f32 v37, v33
    v_cvt_u32_f32 v32, v32
    v_cvt_u32_f32 v33, v33
    v_mad_u32_u24 v40, v32, s49, v33
    v_mul_u32_u24 v40, 192, v40
    v_add_u32 v40, v40, v22
    v_or_b32 v36, v36, v37
    v_cmp_ne_u32 vcc, 0, v36
    buffer_load_dwordx4 v[176:179], v40, s[4:7], 0 offen offset:0
    buffer_load_dwordx4 v[180:183], v40, s[4:7], 0 offen offset:64
    buffer_load_dwordx4 v[184:187], v40, s[4:7], 0 offen offset:128
    s_cmp_lg_u64 vcc, 0
    s_addc_u32 s64, s64, s64
    v_lshlrev_b32 v32, 16, v30
    v_and_b32 v33, 0xffff0000, v30
    v_fract_f32 v36, v32
    v_fract_f32 v37, v33
    v_cvt_u32_f32 v32, v32
    v_cvt_u32_f32 v33, v33
    v_mad_u32_u24 v40, v32, s49, v33
    v_mul_u32_u24 v40, 192, v40
    v_add_u32 v40, v40, v22
    v_or_b32 v36, v36, v37
    v_cmp_ne_u32 vcc, 0, v36
    buffer_load_dwordx4 v[164:167], v40, s[4:7], 0 offen offset:0
    buffer_load_dwordx4 v[168:171], v40, s[4:7], 0 offen offset:64
    buffer_load_dwordx4 v[172:175], v40, s[4:7], 0 offen offset:128
    s_cmp_lg_u64 vcc, 0
    s_addc_u32 s64, s64, s64
    v_lshlrev_b32 v32, 16, v29
    v_and_b32 v33, 0xffff0000, v29
    v_fract_f32 v36, v32
    v_fract_f32 v37, v33
    v_cvt_u32_f32 v32, v32
    v_cvt_u32_f32 v33, v33
    v_mad_u32_u24 v40, v32, s49, v33
    v_mul_u32_u24 v40, 192, v40
    v_add_u32 v40, v40, v22
    v_or_b32 v36, v36, v37
    v_cmp_ne_u32 vcc, 0, v36
    buffer_load_dwordx4 v[152:155], v40, s[4:7], 0 offen offset:0
    buffer_load_dwordx4 v[156:159], v40, s[4:7], 0 offen offset:64
    buffer_load_dwordx4 v[160:163], v40, s[4:7], 0 offen offset:128
    s_cmp_lg_u64 vcc, 0
    s_addc_u32 s64, s64, s64
    v_lshlrev_b32 v32, 16, v28
    v_and_b32 v33, 0xffff0000, v28
    v_fract_f32 v36, v32
    v_fract_f32 v37, v33
    v_cvt_u32_f32 v32, v32
    v_cvt_u32_f32 v33, v33
    v_mad_u32_u24 v40, v32, s49, v33
    v_mul_u32_u24 v40, 192, v40
    v_add_u32 v40, v40, v22
    v_or_b32 v36, v36, v37
    v_cmp_ne_u32 vcc, 0, v36
    buffer_load_dwordx4 v[140:143], v40, s[4:7], 0 offen offset:0
    buffer_load_dwordx4 v[144:147], v40, s[4:7], 0 offen offset:64
    buffer_load_dwordx4 v[148:151], v40, s[4:7], 0 offen offset:128
    s_cmp_lg_u64 vcc, 0
    s_addc_u32 s64, s64, s64
    v_lshlrev_b32 v32, 16, v27
    v_and_b32 v33, 0xffff0000, v27
    v_fract_f32 v36, v32
    v_fract_f32 v37, v33
    v_cvt_u32_f32 v32, v32
    v_cvt_u32_f32 v33, v33
    v_mad_u32_u24 v40, v32, s49, v33
    v_mul_u32_u24 v40, 192, v40
    v_add_u32 v40, v40, v22
    v_or_b32 v36, v36, v37
    v_cmp_ne_u32 vcc, 0, v36
    buffer_load_dwordx4 v[128:131], v40, s[4:7], 0 offen offset:0
    buffer_load_dwordx4 v[132:135], v40, s[4:7], 0 offen offset:64
    buffer_load_dwordx4 v[136:139], v40, s[4:7], 0 offen offset:128
    s_cmp_lg_u64 vcc, 0
    s_addc_u32 s64, s64, s64
    v_lshlrev_b32 v32, 16, v26
    v_and_b32 v33, 0xffff0000, v26
    v_fract_f32 v36, v32
    v_fract_f32 v37, v33
    v_cvt_u32_f32 v32, v32
    v_cvt_u32_f32 v33, v33
    v_mad_u32_u24 v40, v32, s49, v33
    v_mul_u32_u24 v40, 192, v40
    v_add_u32 v40, v40, v22
    v_or_b32 v36, v36, v37
    v_cmp_ne_u32 vcc, 0, v36
    buffer_load_dwordx4 v[116:119], v40, s[4:7], 0 offen offset:0
    buffer_load_dwordx4 v[120:123], v40, s[4:7], 0 offen offset:64
    buffer_load_dwordx4 v[124:127], v40, s[4:7], 0 offen offset:128
    s_cmp_lg_u64 vcc, 0
    s_addc_u32 s64, s64, s64
    v_lshlrev_b32 v32, 16, v25
    v_and_b32 v33, 0xffff0000, v25
    v_fract_f32 v36, v32
    v_fract_f32 v37, v33
    v_cvt_u32_f32 v32, v32
    v_cvt_u32_f32 v33, v33
    v_mad_u32_u24 v40, v32, s49, v33
    v_mul_u32_u24 v40, 192, v40
    v_add_u32 v40, v40, v22
    v_or_b32 v36, v36, v37
    v_cmp_ne_u32 vcc, 0, v36
    buffer_load_dwordx4 v[104:107], v40, s[4:7], 0 offen offset:0
    buffer_load_dwordx4 v[108:111], v40, s[4:7], 0 offen offset:64
    buffer_load_dwordx4 v[112:115], v40, s[4:7], 0 offen offset:128
    s_cmp_lg_u64 vcc, 0
    s_addc_u32 s64, s64, s64
    v_lshlrev_b32 v32, 16, v24
    v_and_b32 v33, 0xffff0000, v24
    v_fract_f32 v36, v32
    v_fract_f32 v37, v33
    v_cvt_u32_f32 v32, v32
    v_cvt_u32_f32 v33, v33
    v_mad_u32_u24 v40, v32, s49, v33
    v_mul_u32_u24 v40, 192, v40
    v_add_u32 v40, v40, v22
    v_or_b32 v36, v36, v37
    v_cmp_ne_u32 vcc, 0, v36
    buffer_load_dwordx4 v[92:95], v40, s[4:7], 0 offen offset:0
    buffer_load_dwordx4 v[96:99], v40, s[4:7], 0 offen offset:64
    buffer_load_dwordx4 v[100:103], v40, s[4:7], 0 offen offset:128
    s_cmp_lg_u64 vcc, 0
    s_addc_u32 s64, s64, s64
    v_lshlrev_b32 v32, 16, v23
    v_and_b32 v33, 0xffff0000, v23
    v_fract_f32 v36, v32
    v_fract_f32 v37, v33
    v_cvt_u32_f32 v32, v32
    v_cvt_u32_f32 v33, v33
    v_mad_u32_u24 v40, v32, s49, v33
    v_mul_u32_u24 v40, 192, v40
    v_add_u32 v40, v40, v22
    v_or_b32 v36, v36, v37
    v_cmp_ne_u32 vcc, 0, v36
    buffer_load_dwordx4 v[80:83], v40, s[4:7], 0 offen offset:0
    buffer_load_dwordx4 v[84:87], v40, s[4:7], 0 offen offset:64
    buffer_load_dwordx4 v[88:91], v40, s[4:7], 0 offen offset:128
    s_cmp_lg_u64 vcc, 0
    s_addc_u32 s64, s64, s64
    s_bitcmp1_b32 s64, 0
    s_cbranch_scc0 L_gs0
    v_mov_b32 v43, v23
    s_call_b64 s[52:53], L_gI
    v_cvt_pk_bf16_f32 v80, v44, v45
    v_cvt_pk_bf16_f32 v81, v46, v47
    v_cvt_pk_bf16_f32 v82, v48, v49
    v_cvt_pk_bf16_f32 v83, v50, v51
    v_cvt_pk_bf16_f32 v84, v52, v53
    v_cvt_pk_bf16_f32 v85, v54, v55
    v_cvt_pk_bf16_f32 v86, v56, v57
    v_cvt_pk_bf16_f32 v87, v58, v59
    v_cvt_pk_bf16_f32 v88, v60, v61
    v_cvt_pk_bf16_f32 v89, v62, v63
    v_cvt_pk_bf16_f32 v90, v64, v65
    v_cvt_pk_bf16_f32 v91, v66, v67
L_gs0:
    s_bitcmp1_b32 s64, 1
    s_cbranch_scc0 L_gs1
    v_mov_b32 v43, v24
    s_call_b64 s[52:53], L_gI
    v_cvt_pk_bf16_f32 v92, v44, v45
    v_cvt_pk_bf16_f32 v93, v46, v47
    v_cvt_pk_bf16_f32 v94, v48, v49
    v_cvt_pk_bf16_f32 v95, v50, v51
    v_cvt_pk_bf16_f32 v96, v52, v53
    v_cvt_pk_bf16_f32 v97, v54, v55
    v_cvt_pk_bf16_f32 v98, v56, v57
    v_cvt_pk_bf16_f32 v99, v58, v59
    v_cvt_pk_bf16_f32 v100, v60, v61
    v_cvt_pk_bf16_f32 v101, v62, v63
    v_cvt_pk_bf16_f32 v102, v64, v65
    v_cvt_pk_bf16_f32 v103, v66, v67
L_gs1:
    s_bitcmp1_b32 s64, 2
    s_cbranch_scc0 L_gs2
    v_mov_b32 v43, v25
    s_call_b64 s[52:53], L_gI
    v_cvt_pk_bf16_f32 v104, v44, v45
    v_cvt_pk_bf16_f32 v105, v46, v47
    v_cvt_pk_bf16_f32 v106, v48, v49
    v_cvt_pk_bf16_f32 v107, v50, v51
    v_cvt_pk_bf16_f32 v108, v52, v53
    v_cvt_pk_bf16_f32 v109, v54, v55
    v_cvt_pk_bf16_f32 v110, v56, v57
    v_cvt_pk_bf16_f32 v111, v58, v59
    v_cvt_pk_bf16_f32 v112, v60, v61
    v_cvt_pk_bf16_f32 v113, v62, v63
    v_cvt_pk_bf16_f32 v114, v64, v65
    v_cvt_pk_bf16_f32 v115, v66, v67
L_gs2:
    s_bitcmp1_b32 s64, 3
    s_cbranch_scc0 L_gs3
    v_mov_b32 v43, v26
    s_call_b64 s[52:53], L_gI
    v_cvt_pk_bf16_f32 v116, v44, v45
    v_cvt_pk_bf16_f32 v117, v46, v47
    v_cvt_pk_bf16_f32 v118, v48, v49
    v_cvt_pk_bf16_f32 v119, v50, v51
    v_cvt_pk_bf16_f32 v120, v52, v53
    v_cvt_pk_bf16_f32 v121, v54, v55
    v_cvt_pk_bf16_f32 v122, v56, v57
    v_cvt_pk_bf16_f32 v123, v58, v59
    v_cvt_pk_bf16_f32 v124, v60, v61
    v_cvt_pk_bf16_f32 v125, v62, v63
    v_cvt_pk_bf16_f32 v126, v64, v65
    v_cvt_pk_bf16_f32 v127, v66, v67
L_gs3:
    s_bitcmp1_b32 s64, 4
    s_cbranch_scc0 L_gs4
    v_mov_b32 v43, v27
    s_call_b64 s[52:53], L_gI
    v_cvt_pk_bf16_f32 v128, v44, v45
    v_cvt_pk_bf16_f32 v129, v46, v47
    v_cvt_pk_bf16_f32 v130, v48, v49
    v_cvt_pk_bf16_f32 v131, v50, v51
    v_cvt_pk_bf16_f32 v132, v52, v53
    v_cvt_pk_bf16_f32 v133, v54, v55
    v_cvt_pk_bf16_f32 v134, v56, v57
    v_cvt_pk_bf16_f32 v135, v58, v59
    v_cvt_pk_bf16_f32 v136, v60, v61
    v_cvt_pk_bf16_f32 v137, v62, v63
    v_cvt_pk_bf16_f32 v138, v64, v65
    v_cvt_pk_bf16_f32 v139, v66, v67
L_gs4:
    s_bitcmp1_b32 s64, 5
    s_cbranch_scc0 L_gs5
    v_mov_b32 v43, v28
    s_call_b64 s[52:53], L_gI
    v_cvt_pk_bf16_f32 v140, v44, v45
    v_cvt_pk_bf16_f32 v141, v46, v47
    v_cvt_pk_bf16_f32 v142, v48, v49
    v_cvt_pk_bf16_f32 v143, v50, v51
    v_cvt_pk_bf16_f32 v144, v52, v53
    v_cvt_pk_bf16_f32 v145, v54, v55
    v_cvt_pk_bf16_f32 v146, v56, v57
    v_cvt_pk_bf16_f32 v147, v58, v59
    v_cvt_pk_bf16_f32 v148, v60, v61
    v_cvt_pk_bf16_f32 v149, v62, v63
    v_cvt_pk_bf16_f32 v150, v64, v65
    v_cvt_pk_bf16_f32 v151, v66, v67
L_gs5:
    s_bitcmp1_b32 s64, 6
    s_cbranch_scc0 L_gs6
    v_mov_b32 v43, v29
    s_call_b64 s[52:53], L_gI
    v_cvt_pk_bf16_f32 v152, v44, v45
    v_cvt_pk_bf16_f32 v153, v46, v47
    v_cvt_pk_bf16_f32 v154, v48, v49
    v_cvt_pk_bf16_f32 v155, v50, v51
    v_cvt_pk_bf16_f32 v156, v52, v53
    v_cvt_pk_bf16_f32 v157, v54, v55
    v_cvt_pk_bf16_f32 v158, v56, v57
    v_cvt_pk_bf16_f32 v159, v58, v59
    v_cvt_pk_bf16_f32 v160, v60, v61
    v_cvt_pk_bf16_f32 v161, v62, v63
    v_cvt_pk_bf16_f32 v162, v64, v65
    v_cvt_pk_bf16_f32 v163, v66, v67
L_gs6:
    s_bitcmp1_b32 s64, 7
    s_cbranch_scc0 L_gs7
    v_mov_b32 v43, v30
    s_call_b64 s[52:53], L_gI
    v_cvt_pk_bf16_f32 v164, v44, v45
    v_cvt_pk_bf16_f32 v165, v46, v47
    v_cvt_pk_bf16_f32 v166, v48, v49
    v_cvt_pk_bf16_f32 v167, v50, v51
    v_cvt_pk_bf16_f32 v168, v52, v53
    v_cvt_pk_bf16_f32 v169, v54, v55
    v_cvt_pk_bf16_f32 v170, v56, v57
    v_cvt_pk_bf16_f32 v171, v58, v59
    v_cvt_pk_bf16_f32 v172, v60, v61
    v_cvt_pk_bf16_f32 v173, v62, v63
    v_cvt_pk_bf16_f32 v174, v64, v65
    v_cvt_pk_bf16_f32 v175, v66, v67
L_gs7:
    s_bitcmp1_b32 s64, 8
    s_cbranch_scc0 L_gs8
    v_mov_b32 v43, v31
    s_call_b64 s[52:53], L_gI
    v_cvt_pk_bf16_f32 v176, v44, v45
    v_cvt_pk_bf16_f32 v177, v46, v47
    v_cvt_pk_bf16_f32 v178, v48, v49
    v_cvt_pk_bf16_f32 v179, v50, v51
    v_cvt_pk_bf16_f32 v180, v52, v53
    v_cvt_pk_bf16_f32 v181, v54, v55
    v_cvt_pk_bf16_f32 v182, v56, v57
    v_cvt_pk_bf16_f32 v183, v58, v59
    v_cvt_pk_bf16_f32 v184, v60, v61
    v_cvt_pk_bf16_f32 v185, v62, v63
    v_cvt_pk_bf16_f32 v186, v64, v65
    v_cvt_pk_bf16_f32 v187, v66, v67
L_gs8:
    s_waitcnt vmcnt(0)
    v_mfma_f32_16x16x32_bf16 v[44:47], a[0:3], v[80:83], 0
    v_mfma_f32_16x16x32_bf16 v[48:51], a[4:7], v[80:83], 0
    v_mfma_f32_16x16x32_bf16 v[52:55], a[8:11], v[80:83], 0
    v_mfma_f32_16x16x32_bf16 v[52:55], a[20:23], v[84:87], v[52:55]
    v_mfma_f32_16x16x32_bf16 v[48:51], a[16:19], v[84:87], v[48:51]
    v_mfma_f32_16x16x32_bf16 v[44:47], a[12:15], v[84:87], v[44:47]
    v_mfma_f32_16x16x32_bf16 v[44:47], a[24:27], v[88:91], v[44:47]
    v_mfma_f32_16x16x32_bf16 v[48:51], a[28:31], v[88:91], v[48:51]
    v_mfma_f32_16x16x32_bf16 v[52:55], a[32:35], v[88:91], v[52:55]
    v_mfma_f32_16x16x32_bf16 v[44:47], a[36:39], v[92:95], v[44:47]
    v_mfma_f32_16x16x32_bf16 v[48:51], a[40:43], v[92:95], v[48:51]
    v_mfma_f32_16x16x32_bf16 v[52:55], a[44:47], v[92:95], v[52:55]
    v_mfma_f32_16x16x32_bf16 v[52:55], a[56:59], v[96:99], v[52:55]
    v_mfma_f32_16x16x32_bf16 v[48:51], a[52:55], v[96:99], v[48:51]
    v_mfma_f32_16x16x32_bf16 v[44:47], a[48:51], v[96:99], v[44:47]
    v_mfma_f32_16x16x32_bf16 v[44:47], a[60:63], v[100:103], v[44:47]
    v_mfma_f32_16x16x32_bf16 v[48:51], a[64:67], v[100:103], v[48:51]
    v_mfma_f32_16x16x32_bf16 v[52:55], a[68:71], v[100:103], v[52:55]
    v_mfma_f32_16x16x32_bf16 v[44:47], a[72:75], v[104:107], v[44:47]
    v_mfma_f32_16x16x32_bf16 v[48:51], a[76:79], v[104:107], v[48:51]
    v_mfma_f32_16x16x32_bf16 v[52:55], a[80:83], v[104:107], v[52:55]
    v_mfma_f32_16x16x32_bf16 v[52:55], a[92:95], v[108:111], v[52:55]
    v_mfma_f32_16x16x32_bf16 v[48:51], a[88:91], v[108:111], v[48:51]
    v_mfma_f32_16x16x32_bf16 v[44:47], a[84:87], v[108:111], v[44:47]
    v_mfma_f32_16x16x32_bf16 v[44:47], a[96:99], v[112:115], v[44:47]
    v_mfma_f32_16x16x32_bf16 v[48:51], a[100:103], v[112:115], v[48:51]
    v_mfma_f32_16x16x32_bf16 v[52:55], a[104:107], v[112:115], v[52:55]
    v_mfma_f32_16x16x32_bf16 v[44:47], a[108:111], v[116:119], v[44:47]
    v_mfma_f32_16x16x32_bf16 v[48:51], a[112:115], v[116:119], v[48:51]
    v_mfma_f32_16x16x32_bf16 v[52:55], a[116:119], v[116:119], v[52:55]
    v_mfma_f32_16x16x32_bf16 v[52:55], a[128:131], v[120:123], v[52:55]
    v_mfma_f32_16x16x32_bf16 v[48:51], a[124:127], v[120:123], v[48:51]
    v_mfma_f32_16x16x32_bf16 v[44:47], a[120:123], v[120:123], v[44:47]
    v_mfma_f32_16x16x32_bf16 v[44:47], a[132:135], v[124:127], v[44:47]
    v_mfma_f32_16x16x32_bf16 v[48:51], a[136:139], v[124:127], v[48:51]
    v_mfma_f32_16x16x32_bf16 v[52:55], a[140:143], v[124:127], v[52:55]
    v_mfma_f32_16x16x32_bf16 v[44:47], a[144:147], v[128:131], v[44:47]
    v_mfma_f32_16x16x32_bf16 v[48:51], a[148:151], v[128:131], v[48:51]
    v_mfma_f32_16x16x32_bf16 v[52:55], a[152:155], v[128:131], v[52:55]
    v_mfma_f32_16x16x32_bf16 v[52:55], a[164:167], v[132:135], v[52:55]
    v_mfma_f32_16x16x32_bf16 v[48:51], a[160:163], v[132:135], v[48:51]
    v_mfma_f32_16x16x32_bf16 v[44:47], a[156:159], v[132:135], v[44:47]
    v_mfma_f32_16x16x32_bf16 v[44:47], a[168:171], v[136:139], v[44:47]
    v_mfma_f32_16x16x32_bf16 v[48:51], a[172:175], v[136:139], v[48:51]
    v_mfma_f32_16x16x32_bf16 v[52:55], a[176:179], v[136:139], v[52:55]
    v_mfma_f32_16x16x32_bf16 v[44:47], a[180:183], v[140:143], v[44:47]
    v_mfma_f32_16x16x32_bf16 v[48:51], a[184:187], v[140:143], v[48:51]
    v_mfma_f32_16x16x32_bf16 v[52:55], a[188:191], v[140:143], v[52:55]
    v_mfma_f32_16x16x32_bf16 v[52:55], a[200:203], v[144:147], v[52:55]
    v_mfma_f32_16x16x32_bf16 v[48:51], a[196:199], v[144:147], v[48:51]
    v_mfma_f32_16x16x32_bf16 v[44:47], a[192:195], v[144:147], v[44:47]
    v_mfma_f32_16x16x32_bf16 v[44:47], a[204:207], v[148:151], v[44:47]
    v_mfma_f32_16x16x32_bf16 v[48:51], a[208:211], v[148:151], v[48:51]
    v_mfma_f32_16x16x32_bf16 v[52:55], a[212:215], v[148:151], v[52:55]
    v_mfma_f32_16x16x32_bf16 v[44:47], a[216:219], v[152:155], v[44:47]
    v_mfma_f32_16x16x32_bf16 v[48:51], a[220:223], v[152:155], v[48:51]
    v_mfma_f32_16x16x32_bf16 v[52:55], a[224:227], v[152:155], v[52:55]
    v_mfma_f32_16x16x32_bf16 v[52:55], a[236:239], v[156:159], v[52:55]
    v_mfma_f32_16x16x32_bf16 v[48:51], a[232:235], v[156:159], v[48:51]
    v_mfma_f32_16x16x32_bf16 v[44:47], a[228:231], v[156:159], v[44:47]
    v_mfma_f32_16x16x32_bf16 v[44:47], a[240:243], v[160:163], v[44:47]
    v_mfma_f32_16x16x32_bf16 v[48:51], a[244:247], v[160:163], v[48:51]
    v_mfma_f32_16x16x32_bf16 v[52:55], a[248:251], v[160:163], v[52:55]
    v_mfma_f32_16x16x32_bf16 v[44:47], a[252:255], v[164:167], v[44:47]
    v_mfma_f32_16x16x32_bf16 v[48:51], v[188:191], v[164:167], v[48:51]
    v_mfma_f32_16x16x32_bf16 v[52:55], v[192:195], v[164:167], v[52:55]
    v_mfma_f32_16x16x32_bf16 v[52:55], v[204:207], v[168:171], v[52:55]
    v_mfma_f32_16x16x32_bf16 v[48:51], v[200:203], v[168:171], v[48:51]
    v_mfma_f32_16x16x32_bf16 v[44:47], v[196:199], v[168:171], v[44:47]
    v_mfma_f32_16x16x32_bf16 v[44:47], v[208:211], v[172:175], v[44:47]
    v_mfma_f32_16x16x32_bf16 v[48:51], v[212:215], v[172:175], v[48:51]
    v_mfma_f32_16x16x32_bf16 v[52:55], v[216:219], v[172:175], v[52:55]
    v_mfma_f32_16x16x32_bf16 v[44:47], v[220:223], v[176:179], v[44:47]
    v_mfma_f32_16x16x32_bf16 v[48:51], v[224:227], v[176:179], v[48:51]
    v_mfma_f32_16x16x32_bf16 v[52:55], v[228:231], v[176:179], v[52:55]
    v_mfma_f32_16x16x32_bf16 v[52:55], v[240:243], v[180:183], v[52:55]
    v_mfma_f32_16x16x32_bf16 v[48:51], v[236:239], v[180:183], v[48:51]
    v_mfma_f32_16x16x32_bf16 v[44:47], v[232:235], v[180:183], v[44:47]
    v_mfma_f32_16x16x32_bf16 v[44:47], v[244:247], v[184:187], v[44:47]
    v_mfma_f32_16x16x32_bf16 v[48:51], v[248:251], v[184:187], v[48:51]
    v_mfma_f32_16x16x32_bf16 v[52:55], v[252:255], v[184:187], v[52:55]
    s_nop 5
    v_cvt_pk_bf16_f32 v32, v44, v45
    v_cvt_pk_bf16_f32 v33, v46, v47
    v_cvt_pk_bf16_f32 v34, v48, v49
    v_cvt_pk_bf16_f32 v35, v50, v51
    v_cvt_pk_bf16_f32 v36, v52, v53
    v_cvt_pk_bf16_f32 v37, v54, v55
    v_permlane16_swap_b32 v32, v34
    v_permlane16_swap_b32 v33, v35
    buffer_store_dwordx4 v[32:35], v9, s[16:19], s31 offen sc1
    buffer_store_dwordx2 v[36:37], v10, s[16:19], s31 offen sc1
L_gn:
    s_ashr_i32 s54, s54, 1
    s_bitset0_b32 s54, 30
    s_mul_i32 s47, s60, 36
    s_add_u32 s32, s32, s47
    s_mul_i32 s47, s60, 192
    s_add_u32 s31, s31, s47
    v_add_f32 v19, s62, v19
    v_add_f32 v20, s63, v20
    s_branch L_gt
L_gI:
    v_lshlrev_b32 v32, 16, v43
    v_and_b32 v33, 0xffff0000, v43
    v_fract_f32 v36, v32
    v_fract_f32 v37, v33
    v_cvt_u32_f32 v32, v32
    v_cvt_u32_f32 v33, v33
    v_mad_u32_u24 v40, v32, s49, v33
    v_mul_u32_u24 v40, 192, v40
    v_add_u32 v40, v40, v22
    v_sub_f32 v38, 1.0, v36
    v_sub_f32 v39, 1.0, v37
    v_cvt_pk_bf16_f32 v32, v38, v39
    v_lshlrev_b32 v38, 16, v32
    v_and_b32 v39, 0xffff0000, v32
    v_mul_f32 v1, v38, v39
    v_mul_f32 v2, v38, v37
    v_mul_f32 v3, v36, v39
    v_mul_f32 v15, v36, v37
    v_cvt_pk_bf16_f32 v32, v1, v2
    v_cvt_pk_bf16_f32 v33, v3, v15
    v_lshlrev_b32 v1, 16, v32
    v_and_b32 v2, 0xffff0000, v32
    v_lshlrev_b32 v3, 16, v33
    v_and_b32 v15, 0xffff0000, v33
    v_cmp_neq_f32 vcc, 0, v37
    v_mov_b32 v32, 192
    v_mov_b32 v33, 43008
    v_cndmask_b32 v41, 0, v32, vcc
    v_cmp_neq_f32 vcc, 0, v36
    v_mov_b32 v44, 0
    v_mov_b32 v45, 0
    v_mov_b32 v46, 0
    v_mov_b32 v47, 0
    v_mov_b32 v48, 0
    v_mov_b32 v49, 0
    v_mov_b32 v50, 0
    v_mov_b32 v51, 0
    v_mov_b32 v52, 0
    v_mov_b32 v53, 0
    v_mov_b32 v54, 0
    v_mov_b32 v55, 0
    v_mov_b32 v56, 0
    v_mov_b32 v57, 0
    v_mov_b32 v58, 0
    v_mov_b32 v59, 0
    v_mov_b32 v60, 0
    v_mov_b32 v61, 0
    v_mov_b32 v62, 0
    v_mov_b32 v63, 0
    v_mov_b32 v64, 0
    v_mov_b32 v65, 0
    v_mov_b32 v66, 0
    v_mov_b32 v67, 0
    v_cndmask_b32 v42, 0, v33, vcc
    v_sub_u32 v42, v42, v41
    s_mov_b32 s47, 4
L_gl:
    buffer_load_dwordx4 v[68:71], v40, s[4:7], 0 offen offset:0
    buffer_load_dwordx4 v[72:75], v40, s[4:7], 0 offen offset:64
    buffer_load_dwordx4 v[76:79], v40, s[4:7], 0 offen offset:128
    v_add_u32 v40, v40, v41
    v_swap_b32 v41, v42
    s_waitcnt vmcnt(0)
    v_lshlrev_b32 v32, 16, v68
    v_and_b32 v33, 0xffff0000, v68
    v_fmac_f32 v44, v1, v32
    v_fmac_f32 v45, v1, v33
    v_lshlrev_b32 v32, 16, v69
    v_and_b32 v33, 0xffff0000, v69
    v_fmac_f32 v46, v1, v32
    v_fmac_f32 v47, v1, v33
    v_lshlrev_b32 v32, 16, v70
    v_and_b32 v33, 0xffff0000, v70
    v_fmac_f32 v48, v1, v32
    v_fmac_f32 v49, v1, v33
    v_lshlrev_b32 v32, 16, v71
    v_and_b32 v33, 0xffff0000, v71
    v_fmac_f32 v50, v1, v32
    v_fmac_f32 v51, v1, v33
    v_lshlrev_b32 v32, 16, v72
    v_and_b32 v33, 0xffff0000, v72
    v_fmac_f32 v52, v1, v32
    v_fmac_f32 v53, v1, v33
    v_lshlrev_b32 v32, 16, v73
    v_and_b32 v33, 0xffff0000, v73
    v_fmac_f32 v54, v1, v32
    v_fmac_f32 v55, v1, v33
    v_lshlrev_b32 v32, 16, v74
    v_and_b32 v33, 0xffff0000, v74
    v_fmac_f32 v56, v1, v32
    v_fmac_f32 v57, v1, v33
    v_lshlrev_b32 v32, 16, v75
    v_and_b32 v33, 0xffff0000, v75
    v_fmac_f32 v58, v1, v32
    v_fmac_f32 v59, v1, v33
    v_lshlrev_b32 v32, 16, v76
    v_and_b32 v33, 0xffff0000, v76
    v_fmac_f32 v60, v1, v32
    v_fmac_f32 v61, v1, v33
    v_lshlrev_b32 v32, 16, v77
    v_and_b32 v33, 0xffff0000, v77
    v_fmac_f32 v62, v1, v32
    v_fmac_f32 v63, v1, v33
    v_lshlrev_b32 v32, 16, v78
    v_and_b32 v33, 0xffff0000, v78
    v_fmac_f32 v64, v1, v32
    v_fmac_f32 v65, v1, v33
    v_lshlrev_b32 v32, 16, v79
    v_and_b32 v33, 0xffff0000, v79
    v_fmac_f32 v66, v1, v32
    v_fmac_f32 v67, v1, v33
    v_mov_b32 v1, v2
    v_mov_b32 v2, v3
    v_mov_b32 v3, v15
    s_sub_u32 s47, s47, 1
    s_cmp_lg_u32 s47, 0
    s_cbranch_scc1 L_gl
    s_setpc_b64 s[52:53]
.p2align 7
L_ctab:
    .long 0x0, 0x18000c0, 0x400000, 0x0
    .long 0x3100008, 0x49003d0, 0x3400300, 0x10
    .long 0x6200010, 0x7a006e0, 0x6400600, 0x20
    .long 0x9300018, 0xab009f0, 0x9400900, 0x30
    .long 0xc000c0, 0x2400180, 0x10000c0, 0x40
    .long 0x3d000c8, 0x5500490, 0x40003c0, 0x50
    .long 0x6e000d0, 0x86007a0, 0x70006c0, 0x60
    .long 0x9f000d8, 0xb700ab0, 0xa0009c0, 0x70
    .long 0x1800180, 0x3100240, 0x1c00180, 0x80
    .long 0x4900188, 0x6200550, 0x4c00480, 0x1f80
    .long 0x7a00190, 0x9300860, 0x7c00780, 0x1f90
    .long 0xab00198, 0xc000b70, 0xac00a80, 0x1fa0
    .long 0x2400240, 0x3d00310, 0x2800240, 0x1fb0
    .long 0x5500248, 0x6e00620, 0x5800540, 0x1fc0
    .long 0x8600250, 0x9f00930, 0x8800840, 0x1fd0
    .long 0xb700258, 0xcc00c00, 0xb800b40, 0x1fe0
    .long 0x200c20, 0x1a000e0, 0x480020, 0x1ff0
    .long 0x3300c28, 0x4b003f0, 0x3480320, 0x2000
    .long 0x6000c30, 0x78006c0, 0x6480620, 0x3f00
    .long 0x9100c38, 0xa9009d0, 0x9480920, 0x3f10
    .long 0xe00ce0, 0x26001a0, 0x10800e0, 0x3f20
    .long 0x3f00ce8, 0x57004b0, 0x40803e0, 0x3f30
    .long 0x6c00cf0, 0x8400780, 0x70806e0, 0x3f40
    .long 0x9d00cf8, 0xb500a90, 0xa0809e0, 0x3f50
    .long 0x1a00da0, 0x3300260, 0x1c801a0, 0x3f60
    .long 0x4b00da8, 0x6000570, 0x4c804a0, 0x3f70
    .long 0x7800db0, 0x9100840, 0x7c807a0, 0x3f80
    .long 0xa900db8, 0xc200b50, 0xac80aa0, 0x5e80
    .long 0x2600e60, 0x3f00330, 0x2880260, 0x5e90
    .long 0x5700e68, 0x6c00600, 0x5880560, 0x5ea0
    .long 0x8400e70, 0x9d00910, 0x8880860, 0x5eb0
    .long 0xb500e78, 0xce00c20, 0xb880b60, 0x5ec0
    .long 0x100600, 0x19000d0, 0x500010, 0x5ed0
    .long 0x3000608, 0x48003c0, 0x3500310, 0x5ee0
    .long 0x6300610, 0x7b006f0, 0x6500610, 0x5ef0
    .long 0x9200618, 0xaa009e0, 0x9500910, 0x5f00
    .long 0xd006c0, 0x2500190, 0x11000d0, 0x7e00
    .long 0x3c006c8, 0x5400480, 0x41003d0, 0x7e10
    .long 0x6f006d0, 0x87007b0, 0x71006d0, 0x7e20
    .long 0x9e006d8, 0xb600aa0, 0xa1009d0, 0x7e30
    .long 0x1900780, 0x3000250, 0x1d00190, 0x7e40
    .long 0x4800788, 0x6300540, 0x4d00490, 0x7e50
    .long 0x7b00790, 0x9200870, 0x7d00790, 0x7e60
    .long 0xaa00798, 0xc100b60, 0xad00a90, 0x7e70
    .long 0x2500840, 0x3c00300, 0x2900250, 0x7e80
    .long 0x5400848, 0x6f00630, 0x5900550, 0x9d80
    .long 0x8700850, 0x9e00920, 0x8900850, 0x9d90
    .long 0xb600858, 0xcd00c10, 0xb900b50, 0x9da0
    .long 0x301220, 0x1b000f0, 0x580030, 0x9db0
    .long 0x3201228, 0x4a003e0, 0x3580330, 0x9dc0
    .long 0x6101230, 0x79006d0, 0x6580630, 0x9dd0
    .long 0x9001238, 0xa8009c0, 0x9580930, 0x9de0
    .long 0xf012e0, 0x27001b0, 0x11800f0, 0x9df0
    .long 0x3e012e8, 0x56004a0, 0x41803f0, 0x9e00
    .long 0x6d012f0, 0x8500790, 0x71806f0, 0xbd00
    .long 0x9c012f8, 0xb400a80, 0xa1809f0, 0xbd10
    .long 0x1b013a0, 0x3200270, 0x1d801b0, 0xbd20
    .long 0x4a013a8, 0x6100560, 0x4d804b0, 0xbd30
    .long 0x79013b0, 0x9000850, 0x7d807b0, 0xbd40
    .long 0xa8013b8, 0xc300b40, 0xad80ab0, 0xbd50
    .long 0x2701460, 0x3e00320, 0x2980270, 0xbd60
    .long 0x5601468, 0x6d00610, 0x5980570, 0xbd70
    .long 0x8501470, 0x9c00900, 0x8980870, 0xbd80
    .long 0xb401478, 0xcf00c30, 0xb980b70, 0xbd80
    .long 0xc000000, 0x0, 0x1e401e0, 0x0
    .long 0xcc000c0, 0x20, 0x1e40208, 0x0
    .long 0x19800180, 0x40, 0x147001e4, 0x0
    .long 0x1a400240, 0x60, 0x149801e4, 0x0
    .long 0x27000310, 0x80, 0x1e401e4, 0x0
    .long 0x27c003d0, 0xa0, 0x1e401e4, 0x0
    .long 0x34800490, 0xc0, 0x1e401e4, 0x0
    .long 0x35400550, 0xe0, 0x1e401e4, 0x0
    .long 0x42000620, 0x100, 0x1e401e4, 0x0
    .long 0x42c006e0, 0x120, 0x1e401e4, 0x0
    .long 0x420007a0, 0x140, 0x1e401e4, 0x0
    .long 0x42c00860, 0x160, 0x1e401e4, 0x0
    .long 0x42000930, 0x5cd00180, 0x1e401e4, 0x0
    .long 0x42c009f0, 0x5cd001a0, 0x1e401e4, 0x0
    .long 0x42000ab0, 0x5cd001c0, 0x1e401e4, 0x3f80
    .long 0x42c00b70, 0x5cd001e8, 0x1e401e4, 0x3f800000
    .long 0xc200020, 0x5cd00008, 0x1e401e4, 0x0
    .long 0xce000e0, 0x5cd00028, 0x1e401e4, 0x0
    .long 0x19a001a0, 0x5cd00048, 0x1e401e4, 0x0
    .long 0x1a600260, 0x5cd00068, 0x1e401e4, 0x0
    .long 0x27200330, 0x5cd00088, 0x1e42700, 0x0
    .long 0x27e003f0, 0x5cd000a8, 0x1e42728, 0x0
    .long 0x34a004b0, 0x5cd000c8, 0x399001e4, 0x0
    .long 0x35600570, 0x5cd000e8, 0x39b801e4, 0x0
    .long 0x42200600, 0x12900108, 0x1e401e4, 0x0
    .long 0x42e006c0, 0x12900128, 0x1e401e4, 0x0
    .long 0x42200780, 0x12900148, 0x1e401e4, 0x0
    .long 0x42e00840, 0x12900168, 0x1e401e4, 0x0
    .long 0x42200910, 0x12900188, 0x1e401e4, 0x0
    .long 0x42e009d0, 0x129001a8, 0x1e401e4, 0x0
    .long 0x42200a90, 0x129001c8, 0x1e401e4, 0x3f80
    .long 0x42e00b50, 0x129001f0, 0x1e401e4, 0x3f800000
    .long 0xc100010, 0x12900010, 0x1e401e4, 0x0
    .long 0xcd000d0, 0x12900030, 0x1e401e4, 0x0
    .long 0x19900190, 0x12900050, 0x1e401e4, 0x0
    .long 0x1a500250, 0x12900070, 0x1e401e4, 0x0
    .long 0x27100300, 0x6f600090, 0x1e401e4, 0x0
    .long 0x27d003c0, 0x6f6000b0, 0x1e401e4, 0x0
    .long 0x34900480, 0x6f6000d0, 0x1e401e4, 0x0
    .long 0x35500540, 0x6f6000f0, 0x1e401e4, 0x0
    .long 0x42100630, 0x6f600110, 0x1e44c20, 0x0
    .long 0x42d006f0, 0x6f600130, 0x1e44c48, 0x0
    .long 0x421007b0, 0x6f600150, 0x1e401e4, 0x0
    .long 0x42d00870, 0x6f600170, 0x1e401e4, 0x0
    .long 0x42100920, 0x6f600190, 0x1e401e4, 0x0
    .long 0x42d009e0, 0x6f6001b0, 0x1e401e4, 0x0
    .long 0x42100aa0, 0x6f6001d0, 0x1e401e4, 0x3f80
    .long 0x42d00b60, 0x6f6001f8, 0x1e401e4, 0x3f800000
    .long 0xc300030, 0x25200018, 0x1e401e4, 0x0
    .long 0xcf000f0, 0x25200038, 0x1e401e4, 0x0
    .long 0x19b001b0, 0x25200058, 0x1e401e4, 0x0
    .long 0x1a700270, 0x25200078, 0x1e401e4, 0x0
    .long 0x27300320, 0x25200098, 0x1e401e4, 0x0
    .long 0x27f003e0, 0x252000b8, 0x1e401e4, 0x0
    .long 0x34b004a0, 0x252000d8, 0x1e401e4, 0x0
    .long 0x35700560, 0x252000f8, 0x1e401e4, 0x0
    .long 0x42300610, 0x25200118, 0x1e401e4, 0x0
    .long 0x42f006d0, 0x25200138, 0x1e401e4, 0x0
    .long 0x42300790, 0x25200158, 0x1e401e4, 0x0
    .long 0x42f00850, 0x25200178, 0x1e401e4, 0x0
    .long 0x42300900, 0x81f00198, 0x1e401e4, 0x0
    .long 0x42f009c0, 0x81f001b8, 0x1e401e4, 0x0
    .long 0x42300a80, 0x81f001d8, 0x1e401e4, 0x3f80
    .long 0x42f00b40, 0x81f00200, 0x1e401e4, 0x3f800000
    .long 0x0, 0x0, 0x0, 0x0
    .long 0x20, 0x4, 0x0, 0x3000000
    .long 0x8, 0x8, 0x0, 0x6000000
    .long 0x28, 0xc, 0x0, 0x0
    .long 0x0, 0x1, 0x0, 0x3000001
    .long 0x20, 0x5, 0x0, 0x6000001
    .long 0x8, 0x9, 0x0, 0x1
    .long 0x28, 0xd, 0x0, 0x3000001
    .long 0x0, 0x2, 0x0, 0x6000002
    .long 0x20, 0x6, 0x0, 0x2
    .long 0x8, 0xa, 0x0, 0x3000002
    .long 0x28, 0xe, 0x0, 0x6000002
    .long 0x0, 0x3, 0x0, 0x9000003
    .long 0x20, 0x7, 0x0, 0xc000003
    .long 0x8, 0xb, 0x0, 0xf000003
    .long 0x28, 0xf, 0x0, 0x9000003
    .long 0x0, 0x0, 0x20002, 0xc000004
    .long 0x20, 0x4, 0x20002, 0xf000004
    .long 0x8, 0x8, 0x20002, 0x9000004
    .long 0x28, 0xc, 0x20002, 0xc000004
    .long 0x0, 0x1, 0x20002, 0xf000005
    .long 0x20, 0x5, 0x20002, 0x9000005
    .long 0x8, 0x9, 0x20002, 0xc000005
    .long 0x28, 0xd, 0x20002, 0xf000005
    .long 0x0, 0x2, 0x20002, 0x80006
    .long 0x20, 0x6, 0x20002, 0x3080006
    .long 0x8, 0xa, 0x20002, 0x6080006
    .long 0x28, 0xe, 0x20002, 0x80006
    .long 0x0, 0x3, 0x20002, 0x3080007
    .long 0x20, 0x7, 0x20002, 0x6080007
    .long 0x8, 0xb, 0x20002, 0x80007
    .long 0x28, 0xf, 0x20002, 0x3080007
    .long 0x0, 0x0, 0x10001, 0x6080008
    .long 0x20, 0x4, 0x10001, 0x80008
    .long 0x8, 0x8, 0x10001, 0x3080008
    .long 0x28, 0xc, 0x10001, 0x6080008
    .long 0x0, 0x1, 0x10001, 0x9080009
    .long 0x20, 0x5, 0x10001, 0xc080009
    .long 0x8, 0x9, 0x10001, 0xf080009
    .long 0x28, 0xd, 0x10001, 0x9080009
    .long 0x0, 0x2, 0x10001, 0xc08000a
    .long 0x20, 0x6, 0x10001, 0xf08000a
    .long 0x8, 0xa, 0x10001, 0x908000a
    .long 0x28, 0xe, 0x10001, 0xc08000a
    .long 0x0, 0x3, 0x10001, 0xf08000b
    .long 0x20, 0x7, 0x10001, 0x908000b
    .long 0x8, 0xb, 0x10001, 0xc08000b
    .long 0x28, 0xf, 0x10001, 0xf08000b
    .long 0x0, 0x0, 0x30003, 0x10000c
    .long 0x20, 0x4, 0x30003, 0x310000c
    .long 0x8, 0x8, 0x30003, 0x610000c
    .long 0x28, 0xc, 0x30003, 0x10000c
    .long 0x0, 0x1, 0x30003, 0x310000d
    .long 0x20, 0x5, 0x30003, 0x610000d
    .long 0x8, 0x9, 0x30003, 0x10000d
    .long 0x28, 0xd, 0x30003, 0x310000d
    .long 0x0, 0x2, 0x30003, 0x610000e
    .long 0x20, 0x6, 0x30003, 0x10000e
    .long 0x8, 0xa, 0x30003, 0x310000e
    .long 0x28, 0xe, 0x30003, 0x610000e
    .long 0x0, 0x3, 0x30003, 0x910000f
    .long 0x20, 0x7, 0x30003, 0xc10000f
    .long 0x8, 0xb, 0x30003, 0xf10000f
    .long 0x28, 0xf, 0x30003, 0x910000f
    .long 0xc0c0100, 0xc0c0c0c, 0xc0c0302, 0xc0c0c0c
    .long 0xc0c0c0c, 0xc0c0c0c, 0xc0c0c0c, 0xc0c0c0c
    .long 0xc0c0c0c, 0xc0c0c0c, 0xc0c0c0c, 0xc0c0c0c
    .long 0xc0c0c0c, 0xc0c0c0c, 0xc0c0c0c, 0xc0c0c0c
    .long 0x1000c0c, 0xc0c0c0c, 0x3020c0c, 0xc0c0c0c
    .long 0xc0c0c0c, 0xc0c0c0c, 0xc0c0c0c, 0xc0c0c0c
    .long 0xc0c0c0c, 0xc0c0c0c, 0xc0c0c0c, 0xc0c0c0c
    .long 0xc0c0c0c, 0xc0c0c0c, 0xc0c0c0c, 0xc0c0c0c
    .long 0xc0c0c0c, 0xc0c0100, 0xc0c0c0c, 0xc0c0302
    .long 0xc0c0c0c, 0xc0c0c0c, 0xc0c0c0c, 0xc0c0c0c
    .long 0xc0c0c0c, 0xc0c0c0c, 0xc0c0c0c, 0xc0c0c0c
    .long 0xc0c0c0c, 0xc0c0c0c, 0xc0c0c0c, 0xc0c0c0c
    .long 0xc0c0c0c, 0x1000c0c, 0xc0c0c0c, 0x3020c0c
    .long 0xc0c0c0c, 0xc0c0c0c, 0xc0c0c0c, 0xc0c0c0c
    .long 0xc0c0c0c, 0xc0c0c0c, 0xc0c0c0c, 0xc0c0c0c
    .long 0xc0c0c0c, 0xc0c0c0c, 0xc0c0c0c, 0xc0c0c0c
    .long 0xc0c0c0c, 0xc0c0c0c, 0xc0c0c0c, 0xc0c0c0c
    .long 0xc0c0100, 0xc0c0c0c, 0xc0c0302, 0xc0c0c0c
    .long 0xc0c0c0c, 0xc0c0c0c, 0xc0c0c0c, 0xc0c0c0c
    .long 0xc0c0c0c, 0xc0c0c0c, 0xc0c0c0c, 0xc0c0c0c
    .long 0xc0c0c0c, 0xc0c0c0c, 0xc0c0c0c, 0xc0c0c0c
    .long 0x1000c0c, 0xc0c0c0c, 0x3020c0c, 0xc0c0c0c
    .long 0xc0c0c0c, 0xc0c0c0c, 0xc0c0c0c, 0xc0c0c0c
    .long 0xc0c0c0c, 0xc0c0c0c, 0xc0c0c0c, 0xc0c0c0c
    .long 0xc0c0c0c, 0xc0c0c0c, 0xc0c0c0c, 0xc0c0c0c
    .long 0xc0c0c0c, 0xc0c0100, 0xc0c0c0c, 0xc0c0302
    .long 0xc0c0c0c, 0xc0c0c0c, 0xc0c0c0c, 0xc0c0c0c
    .long 0xc0c0c0c, 0xc0c0c0c, 0xc0c0c0c, 0xc0c0c0c
    .long 0xc0c0c0c, 0xc0c0c0c, 0xc0c0c0c, 0xc0c0c0c
    .long 0xc0c0c0c, 0x1000c0c, 0xc0c0c0c, 0x3020c0c
    .long 0xc0c0c0c, 0xc0c0c0c, 0xc0c0c0c, 0xc0c0c0c
    .long 0xc0c0c0c, 0xc0c0c0c, 0xc0c0c0c, 0xc0c0c0c
    .long 0xc0c0c0c, 0xc0c0c0c, 0xc0c0c0c, 0xc0c0c0c
    .long 0xc0c0c0c, 0xc0c0c0c, 0xc0c0c0c, 0xc0c0c0c
    .long 0xc0c0100, 0xc0c0c0c, 0xc0c0302, 0xc0c0c0c
    .long 0xc0c0c0c, 0xc0c0c0c, 0xc0c0c0c, 0xc0c0c0c
    .long 0xc0c0c0c, 0xc0c0c0c, 0xc0c0c0c, 0xc0c0c0c
    .long 0xc0c0c0c, 0xc0c0c0c, 0xc0c0c0c, 0xc0c0c0c
    .long 0x1000c0c, 0xc0c0c0c, 0x3020c0c, 0xc0c0c0c
    .long 0xc0c0c0c, 0xc0c0c0c, 0xc0c0c0c, 0xc0c0c0c
    .long 0xc0c0c0c, 0xc0c0c0c, 0xc0c0c0c, 0xc0c0c0c
    .long 0xc0c0c0c, 0xc0c0c0c, 0xc0c0c0c, 0xc0c0c0c
    .long 0xc0c0c0c, 0xc0c0100, 0xc0c0c0c, 0xc0c0302
    .long 0xc0c0c0c, 0xc0c0c0c, 0xc0c0c0c, 0xc0c0c0c
    .long 0xc0c0c0c, 0xc0c0c0c, 0xc0c0c0c, 0xc0c0c0c
    .long 0xc0c0c0c, 0xc0c0c0c, 0xc0c0c0c, 0xc0c0c0c
    .long 0xc0c0c0c, 0x1000c0c, 0xc0c0c0c, 0x3020c0c
    .long 0xc0c0c0c, 0xc0c0c0c, 0xc0c0c0c, 0xc0c0c0c
    .long 0xc0c0c0c, 0xc0c0c0c, 0xc0c0c0c, 0xc0c0c0c
    .long 0xc0c0c0c, 0xc0c0c0c, 0xc0c0c0c, 0xc0c0c0c
    .long 0xc0c0c0c, 0xc0c0c0c, 0xc0c0c0c, 0xc0c0c0c
    .long 0xc0c0100, 0xc0c0c0c, 0xc0c0302, 0xc0c0c0c
    .long 0xc0c0c0c, 0xc0c0c0c, 0xc0c0c0c, 0xc0c0c0c
    .long 0xc0c0c0c, 0xc0c0c0c, 0xc0c0c0c, 0xc0c0c0c
    .long 0xc0c0c0c, 0xc0c0c0c, 0xc0c0c0c, 0xc0c0c0c
    .long 0x1000c0c, 0xc0c0c0c, 0x3020c0c, 0xc0c0c0c
    .long 0xc0c0c0c, 0xc0c0c0c, 0xc0c0c0c, 0xc0c0c0c
    .long 0xc0c0c0c, 0xc0c0c0c, 0xc0c0c0c, 0xc0c0c0c
    .long 0xc0c0c0c, 0xc0c0c0c, 0xc0c0c0c, 0xc0c0c0c
    .long 0xc0c0c0c, 0xc0c0100, 0xc0c0c0c, 0xc0c0302
    .long 0xc0c0c0c, 0xc0c0c0c, 0xc0c0c0c, 0xc0c0c0c
    .long 0xc0c0c0c, 0xc0c0c0c, 0xc0c0c0c, 0xc0c0c0c
    .long 0xc0c0c0c, 0xc0c0c0c, 0xc0c0c0c, 0xc0c0c0c
    .long 0xc0c0c0c, 0x1000c0c, 0xc0c0c0c, 0x3020c0c
.p2align 6
L_runtab:
    .long 0x15a800, 0x925800, 0x55, 0x2200, 0x87543021, 0x6, 0x165000, 0x199800, 0x3dff, 0x0, 0x0, 0x0, 0x0, 0x0, 0x42f00, 0xa
    .long 0x295800, 0x925800, 0x55, 0x4000, 0x87543021, 0x6, 0x2a0000, 0x2d4800, 0x3dff, 0x0, 0x0, 0x0, 0x0, 0x0, 0x7e000, 0xa
    .long 0x3d0800, 0x925800, 0x55, 0x5e00, 0x87543021, 0x6, 0x3db000, 0x40f800, 0x3e7f, 0x0, 0x0, 0x0, 0x0, 0x0, 0xb9100, 0xa
    .long 0x50b800, 0x925800, 0x55, 0x7c00, 0x87543021, 0x6, 0x516000, 0x54a800, 0x3e7f, 0x0, 0x0, 0x0, 0x0, 0x0, 0xf4200, 0xa
    .long 0x5dd800, 0x925800, 0x55, 0x9000, 0x87543021, 0x6, 0x5e8000, 0x61c800, 0x3eff, 0x0, 0x0, 0x0, 0x0, 0x0, 0x11b800, 0xa
    .long 0x6af800, 0x925800, 0x55, 0xa400, 0x87543021, 0x6, 0x6ba000, 0x6ee800, 0x3eff, 0x0, 0x0, 0x0, 0x0, 0x0, 0x142e00, 0xa
    .long 0x781800, 0x925800, 0x55, 0xb800, 0x87543021, 0x6, 0x78c000, 0x7c0800, 0x3eff, 0x0, 0x0, 0x0, 0x0, 0x0, 0x16a400, 0xa
    .long 0x853800, 0x925800, 0x55, 0xcc00, 0x87543021, 0x6, 0x85e000, 0x892800, 0x3eff, 0x0, 0x0, 0x0, 0x0, 0x0, 0x191a00, 0xa
    .long 0x1c3800, 0x925800, 0x55, 0x2c00, 0x87543021, 0x6, 0x1ce000, 0x202800, 0x3dff, 0x0, 0x0, 0x0, 0x0, 0x0, 0x56a00, 0xa
    .long 0x2fe800, 0x925800, 0x55, 0x4a00, 0x87543021, 0x6, 0x309000, 0x33d800, 0x3e7f, 0x0, 0x0, 0x0, 0x0, 0x0, 0x91b00, 0xa
    .long 0x439800, 0x925800, 0x55, 0x6800, 0x87543021, 0x6, 0x444000, 0x478800, 0x3e7f, 0x0, 0x0, 0x0, 0x0, 0x0, 0xccc00, 0xa
    .long 0x574800, 0x925800, 0x55, 0x8600, 0x87543021, 0x6, 0x57f000, 0x5b3800, 0x3eff, 0x0, 0x0, 0x0, 0x0, 0x0, 0x107d00, 0xa
    .long 0x646800, 0x925800, 0x55, 0x9a00, 0x87543021, 0x6, 0x651000, 0x685800, 0x3eff, 0x0, 0x0, 0x0, 0x0, 0x0, 0x12f300, 0xa
    .long 0x718800, 0x925800, 0x55, 0xae00, 0x87543021, 0x6, 0x723000, 0x757800, 0x3eff, 0x0, 0x0, 0x0, 0x0, 0x0, 0x156900, 0xa
    .long 0x7ea800, 0x925800, 0x55, 0xc200, 0x87543021, 0x6, 0x7f5000, 0x829800, 0x3eff, 0x0, 0x0, 0x0, 0x0, 0x0, 0x17df00, 0xa
    .long 0x8bc800, 0x925800, 0x55, 0xd600, 0x87543021, 0x6, 0x8c7000, 0x8fb800, 0x3eff, 0x0, 0x0, 0x0, 0x0, 0x0, 0x1a5500, 0xa
    .long 0x22c800, 0x925800, 0x55, 0x3600, 0x87543021, 0x6, 0x237000, 0x26b800, 0x3dff, 0x0, 0x0, 0x0, 0x0, 0x0, 0x6a500, 0xa
    .long 0x367800, 0x925800, 0x55, 0x5400, 0x87543021, 0x6, 0x372000, 0x3a6800, 0x3e7f, 0x0, 0x0, 0x0, 0x0, 0x0, 0xa5600, 0xa
    .long 0x4a2800, 0x925800, 0x55, 0x7200, 0x87543021, 0x6, 0x4ad000, 0x4e1800, 0x3e7f, 0x0, 0x0, 0x0, 0x0, 0x0, 0xe0700, 0xa
    .long 0x45c0, 0xa740, 0x55, 0x15e00, 0x85741063, 0x2, 0x4680, 0x4a40, 0x3e7f, 0x0, 0x0, 0x0, 0x0, 0x0, 0xd38, 0xa
    .long 0x5c40, 0xa740, 0x55, 0x17c00, 0x85741063, 0x2, 0x5d00, 0x60c0, 0x3e7f, 0x0, 0x0, 0x0, 0x0, 0x0, 0x1170, 0xa
    .long 0x72c0, 0xa740, 0x55, 0x19a00, 0x85741063, 0x2, 0x7380, 0x7740, 0x3eff, 0x0, 0x0, 0x0, 0x0, 0x0, 0x15a8, 0xa
    .long 0x8940, 0xa740, 0x55, 0x1b800, 0x85741063, 0x2, 0x8a00, 0x8dc0, 0x3eff, 0x0, 0x0, 0x0, 0x0, 0x0, 0x19e0, 0xa
    .long 0x9840, 0xa740, 0x55, 0x1cc00, 0x85741063, 0x2, 0x9900, 0x9cc0, 0x3eff, 0x0, 0x0, 0x0, 0x0, 0x0, 0x1cb0, 0xa
    .long 0x18c0, 0xa740, 0x55, 0x12200, 0x85741063, 0x2, 0x1980, 0x1d40, 0x3dff, 0x0, 0x0, 0x0, 0x0, 0x0, 0x4c8, 0xa
    .long 0x27c0, 0xa740, 0x55, 0x13600, 0x85741063, 0x2, 0x2880, 0x2c40, 0x3dff, 0x0, 0x0, 0x0, 0x0, 0x0, 0x798, 0xa
    .long 0x36c0, 0xa740, 0x55, 0x14a00, 0x85741063, 0x2, 0x3780, 0x3b40, 0x3e7f, 0x0, 0x0, 0x0, 0x0, 0x0, 0xa68, 0xa
    .long 0x4d40, 0xa740, 0x55, 0x16800, 0x85741063, 0x2, 0x4e00, 0x51c0, 0x3e7f, 0x0, 0x0, 0x0, 0x0, 0x0, 0xea0, 0xa
    .long 0x63c0, 0xa740, 0x55, 0x18600, 0x85741063, 0x2, 0x6480, 0x6840, 0x3eff, 0x0, 0x0, 0x0, 0x0, 0x0, 0x12d8, 0xa
    .long 0x7a40, 0xa740, 0x55, 0x1a400, 0x85741063, 0x2, 0x7b00, 0x7ec0, 0x3eff, 0x0, 0x0, 0x0, 0x0, 0x0, 0x1710, 0xa
    .long 0x90c0, 0xa740, 0x55, 0x1c200, 0x85741063, 0x2, 0x9180, 0x9540, 0x3eff, 0x0, 0x0, 0x0, 0x0, 0x0, 0x1b48, 0xa
    .long 0x9fc0, 0xa740, 0x55, 0x1d600, 0x85741063, 0x2, 0xa080, 0xa440, 0x3eff, 0x0, 0x0, 0x0, 0x0, 0x0, 0x1e18, 0xa
    .long 0x2040, 0xa740, 0x55, 0x12c00, 0x85741063, 0x2, 0x2100, 0x24c0, 0x3dff, 0x0, 0x0, 0x0, 0x0, 0x0, 0x630, 0xa
    .long 0x2f40, 0xa740, 0x55, 0x14000, 0x85741063, 0x2, 0x3000, 0x33c0, 0x3dff, 0x0, 0x0, 0x0, 0x0, 0x0, 0x900, 0xa
    .long 0x3e40, 0xa740, 0x55, 0x15400, 0x85741063, 0x2, 0x3f00, 0x42c0, 0x3e7f, 0x0, 0x0, 0x0, 0x0, 0x0, 0xbd0, 0xa
    .long 0x54c0, 0xa740, 0x55, 0x17200, 0x85741063, 0x2, 0x5580, 0x5940, 0x3e7f, 0x0, 0x0, 0x0, 0x0, 0x0, 0x1008, 0xa
    .long 0x6b40, 0xa740, 0x55, 0x19000, 0x85741063, 0x2, 0x6c00, 0x6fc0, 0x3eff, 0x0, 0x0, 0x0, 0x0, 0x0, 0x1440, 0xa
    .long 0x81c0, 0xa740, 0x55, 0x1ae00, 0x85741063, 0x2, 0x8280, 0x8640, 0x3eff, 0x0, 0x0, 0x0, 0x0, 0x0, 0x1878, 0xa
    .long 0xa80, 0xf00, 0x12, 0x1fe31000, 0x6ac0, 0x18a, 0xc00, 0xcc0, 0xbf800000, 0x41700000, 0xf4, 0xe, 0x7, 0x5b80, 0x240, 0x3
    .long 0xcc0, 0x1140, 0x12, 0x1fe31300, 0x6ac0, 0x18a, 0xe40, 0xf00, 0xbf800000, 0x41900000, 0xf4, 0x11, 0x7, 0x5b80, 0x2ac, 0x3
    .long 0xf00, 0x1440, 0x22, 0x1fe31600, 0x7a00, 0x175, 0x1080, 0x1140, 0xbf800000, 0x41a80000, 0xf4, 0x14, 0x8, 0x6ac0, 0x318, 0x4
    .long 0x1200, 0x1740, 0x22, 0x1fe31a00, 0x7a00, 0x175, 0x1380, 0x1440, 0xbf800000, 0x41c80000, 0xf4, 0x18, 0x8, 0x6ac0, 0x3a8, 0x4
    .long 0x1500, 0x1a40, 0x22, 0x1fe31e00, 0x7a00, 0x175, 0x1680, 0x1740, 0xbf800000, 0x41e80000, 0xf4, 0x1c, 0x8, 0x6ac0, 0x438, 0x4
    .long 0x4d40, 0x5700, 0x66, 0xe36810, 0xd580, 0xfb, 0xace00, 0xacec0, 0x41700000, 0x42ce0000, 0x0, 0x67, 0xe, 0xc640, 0x206a0, 0xc
    .long 0x5f40, 0x6900, 0x66, 0xe38010, 0xd580, 0xfb, 0xae000, 0xae0c0, 0x41700000, 0x42fe0000, 0x0, 0x7f, 0xe, 0xc640, 0x20a00, 0xc
    .long 0x7140, 0x7b00, 0x66, 0xe39810, 0xd580, 0xfb, 0xaf200, 0xaf2c0, 0x41700000, 0x43170000, 0x0, 0x97, 0xe, 0xc640, 0x20d60, 0xc
    .long 0x8340, 0x8d00, 0x66, 0xe3b010, 0xd580, 0xfb, 0xb0400, 0xb04c0, 0x41700000, 0x432f0000, 0x0, 0xaf, 0xe, 0xc640, 0x210c0, 0xc
    .long 0x9540, 0x9f00, 0x66, 0xe3c810, 0xd580, 0xfb, 0xb1600, 0xb16c0, 0x41700000, 0x43470000, 0x0, 0xc7, 0xe, 0xc640, 0x21420, 0xc
    .long 0x1680, 0x21c0, 0x66, 0xe32010, 0xf400, 0xd3, 0xa9800, 0xa98c0, 0x41700000, 0x41f80000, 0xf4, 0x1e, 0x10, 0xe4c0, 0x1fc80, 0xc
    .long 0x2940, 0x3300, 0x66, 0xe33810, 0xd580, 0xfb, 0xaaa00, 0xaaac0, 0x41700000, 0x425c0000, 0x0, 0x37, 0xe, 0xc640, 0x1ffe0, 0xc
    .long 0x3b40, 0x4500, 0x66, 0xe35010, 0xd580, 0xfb, 0xabc00, 0xabcc0, 0x41700000, 0x429e0000, 0x0, 0x4f, 0xe, 0xc640, 0x20340, 0xc
    .long 0x5640, 0x6000, 0x66, 0xe37410, 0xd580, 0xfb, 0xad700, 0xad7c0, 0x41700000, 0x42e60000, 0x0, 0x73, 0xe, 0xc640, 0x20850, 0xc
    .long 0x6840, 0x7200, 0x66, 0xe38c10, 0xd580, 0xfb, 0xae900, 0xae9c0, 0x41700000, 0x430b0000, 0x0, 0x8b, 0xe, 0xc640, 0x20bb0, 0xc
    .long 0x7a40, 0x8400, 0x66, 0xe3a410, 0xd580, 0xfb, 0xafb00, 0xafbc0, 0x41700000, 0x43230000, 0x0, 0xa3, 0xe, 0xc640, 0x20f10, 0xc
    .long 0x8c40, 0x9600, 0x66, 0xe3bc10, 0xd580, 0xfb, 0xb0d00, 0xb0dc0, 0x41700000, 0x433b0000, 0x0, 0xbb, 0xe, 0xc640, 0x21270, 0xc
    .long 0x9e40, 0xa740, 0x66, 0xe3d410, 0xd580, 0xfb, 0xb1f00, 0xb1fc0, 0x41700000, 0x43530000, 0x0, 0xd3, 0xe, 0xc640, 0x215d0, 0xc
    .long 0x2040, 0x2a00, 0x66, 0xe32c10, 0xd580, 0xfb, 0xaa100, 0xaa1c0, 0x41700000, 0x422c0000, 0x0, 0x2b, 0xe, 0xc640, 0x1fe30, 0xc
    .long 0x3240, 0x3c00, 0x66, 0xe34410, 0xd580, 0xfb, 0xab300, 0xab3c0, 0x41700000, 0x42860000, 0x0, 0x43, 0xe, 0xc640, 0x20190, 0xc
    .long 0x4440, 0x4e00, 0x66, 0xe35c10, 0xd580, 0xfb, 0xac500, 0xac5c0, 0x41700000, 0x42b60000, 0x0, 0x5b, 0xe, 0xc640, 0x204f0, 0xc
    .long 0xfffeb000, 0x2a000, 0x12, 0x1fe20000, 0x6ac0, 0x18a, 0x0, 0xa800, 0xbf800000, 0xbf800000, 0xf4, 0xfffffffe, 0x7, 0x5b80, 0x0, 0x3
    .long 0xa800, 0x49800, 0x12, 0x1fe20300, 0x6ac0, 0x18a, 0x1f800, 0x2a000, 0x40000000, 0xbf800000, 0xf4, 0x1, 0x7, 0x5b80, 0x5e80, 0x3
    .long 0x2a000, 0x69000, 0x12, 0x1fe20600, 0x6ac0, 0x18a, 0x3f000, 0x49800, 0x40a00000, 0xbf800000, 0xf4, 0x4, 0x7, 0x5b80, 0xbd00, 0x3
    .long 0x49800, 0x93000, 0x22, 0x1fe20900, 0x7a00, 0x175, 0x5e800, 0x69000, 0x41000000, 0xbf800000, 0xf4, 0x7, 0x8, 0x6ac0, 0x11b80, 0x4
    .long 0x73800, 0xbd000, 0x22, 0x1fe20d00, 0x7a00, 0x175, 0x88800, 0x93000, 0x41400000, 0xbf800000, 0xf4, 0xb, 0x8, 0x6ac0, 0x19980, 0x4
    .long 0x9d800, 0xe7000, 0x22, 0x1fe21100, 0x7a00, 0x175, 0xb2800, 0xbd000, 0x41800000, 0xbf800000, 0xf4, 0xf, 0x8, 0x6ac0, 0x21780, 0x4
    .long 0xc7800, 0x111000, 0x22, 0x1fe21500, 0x7a00, 0x175, 0xdc800, 0xe7000, 0x41a00000, 0xbf800000, 0xf4, 0x13, 0x8, 0x6ac0, 0x29580, 0x4
    .long 0xf1800, 0x13b000, 0x22, 0x1fe21900, 0x7a00, 0x175, 0x106800, 0x111000, 0x41c00000, 0xbf800000, 0xf4, 0x17, 0x8, 0x6ac0, 0x31380, 0x4
    .long 0x11b800, 0x16f800, 0x23, 0x1fe21d00, 0x8940, 0x161, 0x130800, 0x13b000, 0x41e00000, 0xbf800000, 0xf4, 0x1b, 0x9, 0x7a00, 0x39180, 0x5
    .long 0x5b3800, 0x63c000, 0x66, 0x1e28c20, 0xd580, 0xfb, 0x5bf800, 0x5ca000, 0x430b0000, 0x41f80000, 0x0, 0x8b, 0xe, 0xc640, 0x113e80, 0xc
    .long 0x7ab800, 0x834000, 0x66, 0xe2bc10, 0xd580, 0xfb, 0x7b6c00, 0x7c1400, 0x433b0000, 0x41700000, 0x0, 0xbb, 0xe, 0xc640, 0x172440, 0xc
    .long 0x8a7800, 0x925800, 0x66, 0x1e2d420, 0xd580, 0xfb, 0x8b3800, 0x8be000, 0x43530000, 0x41f80000, 0x0, 0xd3, 0xe, 0xc640, 0x1a1a80, 0xc
    .long 0x13b000, 0x1c3800, 0x55, 0x7e22080, 0xd580, 0xfb, 0x156000, 0x160800, 0x41f80000, 0x42fe0000, 0xf4, 0x1e, 0xe, 0xc640, 0x40200, 0xa
    .long 0x93000, 0x11b800, 0x55, 0xe21010, 0xd580, 0xfb, 0xa8c00, 0xb3400, 0x41700000, 0x41700000, 0xf4, 0xe, 0xe, 0xc640, 0x1fa40, 0xa
    .long 0x241800, 0x2ca000, 0x66, 0xe23810, 0xd580, 0xfb, 0x24cc00, 0x257400, 0x425c0000, 0x41700000, 0x0, 0x37, 0xe, 0xc640, 0x6e640, 0xc
    .long 0x33d800, 0x3c6000, 0x66, 0x1e25020, 0xd580, 0xfb, 0x349800, 0x354000, 0x429e0000, 0x41f80000, 0x0, 0x4f, 0xe, 0xc640, 0x9dc80, 0xc
    .long 0x4b7800, 0x540000, 0x66, 0xe27410, 0xd580, 0xfb, 0x4c2c00, 0x4cd400, 0x42e60000, 0x41700000, 0x0, 0x73, 0xe, 0xc640, 0xe4840, 0xc
    .long 0x631800, 0x6ba000, 0x66, 0xe29810, 0xd580, 0xfb, 0x63cc00, 0x647400, 0x43170000, 0x41700000, 0x0, 0x97, 0xe, 0xc640, 0x12b640, 0xc
    .long 0x72d800, 0x7b6000, 0x66, 0x1e2b020, 0xd580, 0xfb, 0x739800, 0x744000, 0x432f0000, 0x41f80000, 0x0, 0xaf, 0xe, 0xc640, 0x15ac80, 0xc
    .long 0x13b000, 0x1c3800, 0x55, 0x2e22030, 0xd580, 0xfb, 0x152400, 0x15cc00, 0x41f80000, 0x423c0000, 0xf4, 0x1e, 0xe, 0xc640, 0x3f6c0, 0xa
    .long 0x13b000, 0x1c3800, 0x55, 0x8e22090, 0xd580, 0xfb, 0x156c00, 0x161400, 0x41f80000, 0x430f0000, 0xf4, 0x1e, 0xe, 0xc640, 0x40440, 0xa
    .long 0xfc000, 0x184800, 0x55, 0xe21a10, 0xd580, 0xfb, 0x111c00, 0x11c400, 0x41c80000, 0x41700000, 0xf4, 0x18, 0xe, 0xc640, 0x33540, 0xa
    .long 0x241800, 0x2ca000, 0x66, 0x1e23820, 0xd580, 0xfb, 0x24d800, 0x258000, 0x425c0000, 0x41f80000, 0x0, 0x37, 0xe, 0xc640, 0x6e880, 0xc
    .long 0x3bb800, 0x444000, 0x66, 0xe25c10, 0xd580, 0xfb, 0x3c6c00, 0x3d1400, 0x42b60000, 0x41700000, 0x0, 0x5b, 0xe, 0xc640, 0xb5440, 0xc
    .long 0x4b7800, 0x540000, 0x66, 0x1e27420, 0xd580, 0xfb, 0x4c3800, 0x4ce000, 0x42e60000, 0x41f80000, 0x0, 0x73, 0xe, 0xc640, 0xe4a80, 0xc
    .long 0x631800, 0x6ba000, 0x66, 0x1e29820, 0xd580, 0xfb, 0x63d800, 0x648000, 0x43170000, 0x41f80000, 0x0, 0x97, 0xe, 0xc640, 0x12b880, 0xc
    .long 0x7ab800, 0x834000, 0x66, 0x1e2bc20, 0xd580, 0xfb, 0x7b7800, 0x7c2000, 0x433b0000, 0x41f80000, 0x0, 0xbb, 0xe, 0xc640, 0x172680, 0xc
    .long 0x13b000, 0x1c3800, 0x55, 0x3e22040, 0xd580, 0xfb, 0x153000, 0x15d800, 0x41f80000, 0x427c0000, 0xf4, 0x1e, 0xe, 0xc640, 0x3f900, 0xa
    .long 0x13b000, 0x1c3800, 0x55, 0x9e220a0, 0xd580, 0xfb, 0x157800, 0x162000, 0x41f80000, 0x431f0000, 0xf4, 0x1e, 0xe, 0xc640, 0x40680, 0xa
    .long 0x16f800, 0x1e3000, 0x55, 0xe22410, 0xb700, 0x124, 0x17ac00, 0x185400, 0x420c0000, 0x41700000, 0x0, 0x23, 0xc, 0xa7c0, 0x47040, 0xa
    .long 0x2bf800, 0x348000, 0x66, 0xe24410, 0xd580, 0xfb, 0x2cac00, 0x2d5400, 0x42860000, 0x41700000, 0x0, 0x43, 0xe, 0xc640, 0x86040, 0xc
    .long 0x439800, 0x4c2000, 0x66, 0xe26810, 0xd580, 0xfb, 0x444c00, 0x44f400, 0x42ce0000, 0x41700000, 0x0, 0x67, 0xe, 0xc640, 0xcce40, 0xc
    .long 0x535800, 0x5be000, 0x66, 0xe28010, 0xd580, 0xfb, 0x540c00, 0x54b400, 0x42fe0000, 0x41700000, 0x0, 0x7f, 0xe, 0xc640, 0xfc240, 0xc
    .long 0x6af800, 0x738000, 0x66, 0xe2a410, 0xd580, 0xfb, 0x6bac00, 0x6c5400, 0x43230000, 0x41700000, 0x0, 0xa3, 0xe, 0xc640, 0x143040, 0xc
    .long 0x829800, 0x8b2000, 0x66, 0xe2c810, 0xd580, 0xfb, 0x834c00, 0x83f400, 0x43470000, 0x41700000, 0x0, 0xc7, 0xe, 0xc640, 0x189e40, 0xc
    .long 0x13b000, 0x1c3800, 0x55, 0x4e22050, 0xd580, 0xfb, 0x153c00, 0x15e400, 0x41f80000, 0x429e0000, 0xf4, 0x1e, 0xe, 0xc640, 0x3fb40, 0xa
    .long 0x13b000, 0x1c3800, 0x55, 0xae220b0, 0xd580, 0xfb, 0x158400, 0x162c00, 0x41f80000, 0x432f0000, 0xf4, 0x1e, 0xe, 0xc640, 0x408c0, 0xa
    .long 0x13b000, 0x1d8800, 0x66, 0x1e22020, 0xf400, 0xd3, 0x151800, 0x15c000, 0x41f80000, 0x41f80000, 0xf4, 0x1e, 0x10, 0xe4c0, 0x3f480, 0xc
    .long 0x2bf800, 0x348000, 0x66, 0x1e24420, 0xd580, 0xfb, 0x2cb800, 0x2d6000, 0x42860000, 0x41f80000, 0x0, 0x43, 0xe, 0xc640, 0x86280, 0xc
    .long 0x3bb800, 0x444000, 0x66, 0x1e25c20, 0xd580, 0xfb, 0x3c7800, 0x3d2000, 0x42b60000, 0x41f80000, 0x0, 0x5b, 0xe, 0xc640, 0xb5680, 0xc
    .long 0x535800, 0x5be000, 0x66, 0x1e28020, 0xd580, 0xfb, 0x541800, 0x54c000, 0x42fe0000, 0x41f80000, 0x0, 0x7f, 0xe, 0xc640, 0xfc480, 0xc
    .long 0x6af800, 0x738000, 0x66, 0x1e2a420, 0xd580, 0xfb, 0x6bb800, 0x6c6000, 0x43230000, 0x41f80000, 0x0, 0xa3, 0xe, 0xc640, 0x143280, 0xc
    .long 0x829800, 0x8b2000, 0x66, 0x1e2c820, 0xd580, 0xfb, 0x835800, 0x840000, 0x43470000, 0x41f80000, 0x0, 0xc7, 0xe, 0xc640, 0x18a080, 0xc
    .long 0x13b000, 0x1c3800, 0x55, 0x5e22060, 0xd580, 0xfb, 0x154800, 0x15f000, 0x41f80000, 0x42be0000, 0xf4, 0x1e, 0xe, 0xc640, 0x3fd80, 0xa
    .long 0x13b000, 0x1c3800, 0x55, 0xbe220c0, 0xd580, 0xfb, 0x159000, 0x163800, 0x41f80000, 0x433f0000, 0xf4, 0x1e, 0xe, 0xc640, 0x40b00, 0xa
    .long 0x1d8800, 0x24c000, 0x55, 0xe22e10, 0xb700, 0x124, 0x1e3c00, 0x1ee400, 0x42340000, 0x41700000, 0x0, 0x2d, 0xc, 0xa7c0, 0x5ab40, 0xa
    .long 0x33d800, 0x3c6000, 0x66, 0xe25010, 0xd580, 0xfb, 0x348c00, 0x353400, 0x429e0000, 0x41700000, 0x0, 0x4f, 0xe, 0xc640, 0x9da40, 0xc
    .long 0x439800, 0x4c2000, 0x66, 0x1e26820, 0xd580, 0xfb, 0x445800, 0x450000, 0x42ce0000, 0x41f80000, 0x0, 0x67, 0xe, 0xc640, 0xcd080, 0xc
    .long 0x5b3800, 0x63c000, 0x66, 0xe28c10, 0xd580, 0xfb, 0x5bec00, 0x5c9400, 0x430b0000, 0x41700000, 0x0, 0x8b, 0xe, 0xc640, 0x113c40, 0xc
    .long 0x72d800, 0x7b6000, 0x66, 0xe2b010, 0xd580, 0xfb, 0x738c00, 0x743400, 0x432f0000, 0x41700000, 0x0, 0xaf, 0xe, 0xc640, 0x15aa40, 0xc
    .long 0x8a7800, 0x925800, 0x66, 0xe2d410, 0xd580, 0xfb, 0x8b2c00, 0x8bd400, 0x43530000, 0x41700000, 0x0, 0xd3, 0xe, 0xc640, 0x1a1840, 0xc
    .long 0x13b000, 0x1c3800, 0x55, 0x6e22070, 0xd580, 0xfb, 0x155400, 0x15fc00, 0x41f80000, 0x42de0000, 0xf4, 0x1e, 0xe, 0xc640, 0x3ffc0, 0xa
    .long 0x13b000, 0x1c3800, 0x55, 0xce220d0, 0xd580, 0xfb, 0x159c00, 0x164400, 0x41f80000, 0x434f0000, 0xf4, 0x1e, 0xe, 0xc640, 0x40d40, 0xa
    .long 0x1c3800, 0x24c000, 0x66, 0x1e22c20, 0xd580, 0xfb, 0x1cf800, 0x1da000, 0x422c0000, 0x41f80000, 0x0, 0x2b, 0xe, 0xc640, 0x56e80, 0xc
    .long 0x3fa800, 0x925800, 0x77, 0x6240, 0x3dff3e7f, 0x3dff3e7f, 0x408000, 0x451800, 0x0, 0x0, 0x0, 0x0, 0x0, 0x0, 0x0, 0x0
    .long 0x646800, 0x925800, 0x77, 0x9a60, 0x3e7f3eff, 0x3e7f3eff, 0x655800, 0x69f000, 0x0, 0x0, 0x0, 0x0, 0x0, 0x0, 0x0, 0x0
    .long 0x1ae800, 0x925800, 0x77, 0x2a80, 0x3e7f3dff, 0x3e7f3dff, 0x1bf000, 0x208800, 0x0, 0x0, 0x0, 0x0, 0x0, 0x0, 0x0, 0x0
    .long 0x3fa800, 0x925800, 0x77, 0x62a0, 0x3eff3e7f, 0x3eff3e7f, 0x40c800, 0x456000, 0x0, 0x0, 0x0, 0x0, 0x0, 0x0, 0x0, 0x0
    .long 0x6d9800, 0x925800, 0x77, 0xa880, 0x3e7f3eff, 0x3e7f3eff, 0x6ea000, 0x733800, 0x0, 0x0, 0x0, 0x0, 0x0, 0x0, 0x0, 0x0
    .long 0x241800, 0x925800, 0x77, 0x38b0, 0x3eff3dff, 0x3eff3dff, 0x254400, 0x29dc00, 0x0, 0x0, 0x0, 0x0, 0x0, 0x0, 0x0, 0x0
    .long 0x5b3800, 0x925800, 0x77, 0x8cb0, 0x3eff3eff, 0x3eff3eff, 0x5c6400, 0x60fc00, 0x0, 0x0, 0x0, 0x0, 0x0, 0x0, 0x0, 0x0
    .long 0x1ae800, 0x925800, 0x77, 0x2a30, 0x3dff3dff, 0x3dff3dff, 0x1bb400, 0x204c00, 0x0, 0x0, 0x0, 0x0, 0x0, 0x0, 0x0, 0x0
    .long 0x3fa800, 0x925800, 0x77, 0x6250, 0x3e7f3e7f, 0x3e7f3e7f, 0x408c00, 0x452400, 0x0, 0x0, 0x0, 0x0, 0x0, 0x0, 0x0, 0x0
    .long 0x6d9800, 0x925800, 0x77, 0xa830, 0x3dff3eff, 0x3dff3eff, 0x6e6400, 0x72fc00, 0x0, 0x0, 0x0, 0x0, 0x0, 0x0, 0x0, 0x0
    .long 0x1ae800, 0x925800, 0x77, 0x2a90, 0x3eff3dff, 0x3eff3dff, 0x1bfc00, 0x209400, 0x0, 0x0, 0x0, 0x0, 0x0, 0x0, 0x0, 0x0
    .long 0x48d800, 0x925800, 0x77, 0x7070, 0x3e7f3e7f, 0x3e7f3e7f, 0x49d400, 0x4e6c00, 0x0, 0x0, 0x0, 0x0, 0x0, 0x0, 0x0, 0x0
    .long 0x6d9800, 0x925800, 0x77, 0xa890, 0x3eff3eff, 0x3eff3eff, 0x6eac00, 0x734400, 0x0, 0x0, 0x0, 0x0, 0x0, 0x0, 0x0, 0x0
    .long 0x241800, 0x925800, 0x77, 0x38c0, 0x3eff3dff, 0x3eff3dff, 0x255000, 0x29e800, 0x0, 0x0, 0x0, 0x0, 0x0, 0x0, 0x0, 0x0
    .long 0x5b3800, 0x925800, 0x77, 0x8cc0, 0x3eff3eff, 0x3eff3eff, 0x5c7000, 0x610800, 0x0, 0x0, 0x0, 0x0, 0x0, 0x0, 0x0, 0x0
    .long 0x1ae800, 0x925800, 0x77, 0x2a40, 0x3dff3dff, 0x3dff3dff, 0x1bc000, 0x205800, 0x0, 0x0, 0x0, 0x0, 0x0, 0x0, 0x0, 0x0
    .long 0x3fa800, 0x925800, 0x77, 0x6260, 0x3e7f3e7f, 0x3e7f3e7f, 0x409800, 0x453000, 0x0, 0x0, 0x0, 0x0, 0x0, 0x0, 0x0, 0x0
    .long 0x6d9800, 0x925800, 0x77, 0xa840, 0x3dff3eff, 0x3dff3eff, 0x6e7000, 0x730800, 0x0, 0x0, 0x0, 0x0, 0x0, 0x0, 0x0, 0x0
    .long 0x1ae800, 0x925800, 0x77, 0x2aa0, 0x3eff3dff, 0x3eff3dff, 0x1c0800, 0x20a000, 0x0, 0x0, 0x0, 0x0, 0x0, 0x0, 0x0, 0x0
    .long 0x48d800, 0x925800, 0x77, 0x7080, 0x3e7f3e7f, 0x3e7f3e7f, 0x49e000, 0x4e7800, 0x0, 0x0, 0x0, 0x0, 0x0, 0x0, 0x0, 0x0
    .long 0x6d9800, 0x925800, 0x77, 0xa8a0, 0x3eff3eff, 0x3eff3eff, 0x6eb800, 0x735000, 0x0, 0x0, 0x0, 0x0, 0x0, 0x0, 0x0, 0x0
    .long 0x241800, 0x925800, 0x77, 0x38d0, 0x3eff3dff, 0x3eff3dff, 0x255c00, 0x29f400, 0x0, 0x0, 0x0, 0x0, 0x0, 0x0, 0x0, 0x0
    .long 0x5b3800, 0x925800, 0x77, 0x8cd0, 0x3eff3eff, 0x3eff3eff, 0x5c7c00, 0x611400, 0x0, 0x0, 0x0, 0x0, 0x0, 0x0, 0x0, 0x0
    .long 0x1ae800, 0x925800, 0x77, 0x2a50, 0x3e7f3dff, 0x3e7f3dff, 0x1bcc00, 0x206400, 0x0, 0x0, 0x0, 0x0, 0x0, 0x0, 0x0, 0x0
    .long 0x48d800, 0x925800, 0x77, 0x7030, 0x3dff3e7f, 0x3dff3e7f, 0x49a400, 0x4e3c00, 0x0, 0x0, 0x0, 0x0, 0x0, 0x0, 0x0, 0x0
    .long 0x6d9800, 0x925800, 0x77, 0xa850, 0x3e7f3eff, 0x3e7f3eff, 0x6e7c00, 0x731400, 0x0, 0x0, 0x0, 0x0, 0x0, 0x0, 0x0, 0x0
    .long 0x241800, 0x925800, 0x77, 0x3870, 0x3e7f3dff, 0x3e7f3dff, 0x251400, 0x29ac00, 0x0, 0x0, 0x0, 0x0, 0x0, 0x0, 0x0, 0x0
    .long 0x48d800, 0x925800, 0x77, 0x7090, 0x3eff3e7f, 0x3eff3e7f, 0x49ec00, 0x4e8400, 0x0, 0x0, 0x0, 0x0, 0x0, 0x0, 0x0, 0x0
    .long 0x76c800, 0x925800, 0x77, 0xb670, 0x3e7f3eff, 0x3e7f3eff, 0x77c400, 0x7c5c00, 0x0, 0x0, 0x0, 0x0, 0x0, 0x0, 0x0, 0x0
    .long 0x2d4800, 0x925800, 0x77, 0x46b0, 0x3eff3e7f, 0x3eff3e7f, 0x2e7400, 0x330c00, 0x0, 0x0, 0x0, 0x0, 0x0, 0x0, 0x0, 0x0
    .long 0x646800, 0x925800, 0x77, 0x9ab0, 0x3eff3eff, 0x3eff3eff, 0x659400, 0x6a2c00, 0x0, 0x0, 0x0, 0x0, 0x0, 0x0, 0x0, 0x0
    .long 0x1ae800, 0x925800, 0x77, 0x2a60, 0x3e7f3dff, 0x3e7f3dff, 0x1bd800, 0x207000, 0x0, 0x0, 0x0, 0x0, 0x0, 0x0, 0x0, 0x0
    .long 0x48d800, 0x925800, 0x77, 0x7040, 0x3dff3e7f, 0x3dff3e7f, 0x49b000, 0x4e4800, 0x0, 0x0, 0x0, 0x0, 0x0, 0x0, 0x0, 0x0
    .long 0x6d9800, 0x925800, 0x77, 0xa860, 0x3e7f3eff, 0x3e7f3eff, 0x6e8800, 0x732000, 0x0, 0x0, 0x0, 0x0, 0x0, 0x0, 0x0, 0x0
    .long 0x241800, 0x925800, 0x77, 0x3880, 0x3e7f3dff, 0x3e7f3dff, 0x252000, 0x29b800, 0x0, 0x0, 0x0, 0x0, 0x0, 0x0, 0x0, 0x0
    .long 0x48d800, 0x925800, 0x77, 0x70a0, 0x3eff3e7f, 0x3eff3e7f, 0x49f800, 0x4e9000, 0x0, 0x0, 0x0, 0x0, 0x0, 0x0, 0x0, 0x0
    .long 0x76c800, 0x925800, 0x77, 0xb680, 0x3e7f3eff, 0x3e7f3eff, 0x77d000, 0x7c6800, 0x0, 0x0, 0x0, 0x0, 0x0, 0x0, 0x0, 0x0
    .long 0x2d4800, 0x925800, 0x77, 0x46c0, 0x3eff3e7f, 0x3eff3e7f, 0x2e8000, 0x331800, 0x0, 0x0, 0x0, 0x0, 0x0, 0x0, 0x0, 0x0
    .long 0x646800, 0x925800, 0x77, 0x9ac0, 0x3eff3eff, 0x3eff3eff, 0x65a000, 0x6a3800, 0x0, 0x0, 0x0, 0x0, 0x0, 0x0, 0x0, 0x0
    .long 0x241800, 0x925800, 0x77, 0x3830, 0x3dff3dff, 0x3dff3dff, 0x24e400, 0x297c00, 0x0, 0x0, 0x0, 0x0, 0x0, 0x0, 0x0, 0x0
    .long 0x48d800, 0x925800, 0x77, 0x7050, 0x3e7f3e7f, 0x3e7f3e7f, 0x49bc00, 0x4e5400, 0x0, 0x0, 0x0, 0x0, 0x0, 0x0, 0x0, 0x0
    .long 0x76c800, 0x925800, 0x77, 0xb630, 0x3dff3eff, 0x3dff3eff, 0x779400, 0x7c2c00, 0x0, 0x0, 0x0, 0x0, 0x0, 0x0, 0x0, 0x0
    .long 0x241800, 0x925800, 0x77, 0x3890, 0x3eff3dff, 0x3eff3dff, 0x252c00, 0x29c400, 0x0, 0x0, 0x0, 0x0, 0x0, 0x0, 0x0, 0x0
    .long 0x520800, 0x925800, 0x77, 0x7e70, 0x3e7f3e7f, 0x3e7f3eff, 0x530400, 0x579c00, 0x0, 0x0, 0x0, 0x0, 0x0, 0x0, 0x0, 0x0
    .long 0x76c800, 0x925800, 0x77, 0xb690, 0x3eff3eff, 0x3eff3eff, 0x77dc00, 0x7c7400, 0x0, 0x0, 0x0, 0x0, 0x0, 0x0, 0x0, 0x0
    .long 0x2d4800, 0x925800, 0x77, 0x46d0, 0x3eff3e7f, 0x3eff3e7f, 0x2e8c00, 0x332400, 0x0, 0x0, 0x0, 0x0, 0x0, 0x0, 0x0, 0x0
    .long 0x646800, 0x925800, 0x77, 0x9ad0, 0x3eff3eff, 0x3eff3eff, 0x65ac00, 0x6a4400, 0x0, 0x0, 0x0, 0x0, 0x0, 0x0, 0x0, 0x0
    .long 0x241800, 0x925800, 0x77, 0x3840, 0x3dff3dff, 0x3dff3dff, 0x24f000, 0x298800, 0x0, 0x0, 0x0, 0x0, 0x0, 0x0, 0x0, 0x0
    .long 0x48d800, 0x925800, 0x77, 0x7060, 0x3e7f3e7f, 0x3e7f3e7f, 0x49c800, 0x4e6000, 0x0, 0x0, 0x0, 0x0, 0x0, 0x0, 0x0, 0x0
    .long 0x76c800, 0x925800, 0x77, 0xb640, 0x3dff3eff, 0x3dff3eff, 0x77a000, 0x7c3800, 0x0, 0x0, 0x0, 0x0, 0x0, 0x0, 0x0, 0x0
    .long 0x241800, 0x925800, 0x77, 0x38a0, 0x3eff3dff, 0x3eff3dff, 0x253800, 0x29d000, 0x0, 0x0, 0x0, 0x0, 0x0, 0x0, 0x0, 0x0
    .long 0x520800, 0x925800, 0x77, 0x7e80, 0x3e7f3e7f, 0x3e7f3eff, 0x531000, 0x57a800, 0x0, 0x0, 0x0, 0x0, 0x0, 0x0, 0x0, 0x0
    .long 0x76c800, 0x925800, 0x77, 0xb6a0, 0x3eff3eff, 0x3eff3eff, 0x77e800, 0x7c8000, 0x0, 0x0, 0x0, 0x0, 0x0, 0x0, 0x0, 0x0
    .long 0x367800, 0x925800, 0x77, 0x54b0, 0x3eff3e7f, 0x3eff3e7f, 0x37a400, 0x3c3c00, 0x0, 0x0, 0x0, 0x0, 0x0, 0x0, 0x0, 0x0
    .long 0x6d9800, 0x925800, 0x77, 0xa8b0, 0x3eff3eff, 0x3eff3eff, 0x6ec400, 0x735c00, 0x0, 0x0, 0x0, 0x0, 0x0, 0x0, 0x0, 0x0
    .long 0x241800, 0x925800, 0x77, 0x3850, 0x3e7f3dff, 0x3e7f3dff, 0x24fc00, 0x299400, 0x0, 0x0, 0x0, 0x0, 0x0, 0x0, 0x0, 0x0
    .long 0x520800, 0x925800, 0x77, 0x7e30, 0x3dff3e7f, 0x3dff3eff, 0x52d400, 0x576c00, 0x0, 0x0, 0x0, 0x0, 0x0, 0x0, 0x0, 0x0
    .long 0x76c800, 0x925800, 0x77, 0xb650, 0x3e7f3eff, 0x3e7f3eff, 0x77ac00, 0x7c4400, 0x0, 0x0, 0x0, 0x0, 0x0, 0x0, 0x0, 0x0
    .long 0x2d4800, 0x925800, 0x77, 0x4670, 0x3e7f3e7f, 0x3e7f3e7f, 0x2e4400, 0x32dc00, 0x0, 0x0, 0x0, 0x0, 0x0, 0x0, 0x0, 0x0
    .long 0x520800, 0x925800, 0x77, 0x7e90, 0x3eff3e7f, 0x3eff3eff, 0x531c00, 0x57b400, 0x0, 0x0, 0x0, 0x0, 0x0, 0x0, 0x0, 0x0
    .long 0x7ff800, 0x925800, 0x77, 0xc470, 0x3e7f3eff, 0x3e7f3eff, 0x80f400, 0x858c00, 0x0, 0x0, 0x0, 0x0, 0x0, 0x0, 0x0, 0x0
    .long 0x367800, 0x925800, 0x77, 0x54c0, 0x3eff3e7f, 0x3eff3e7f, 0x37b000, 0x3c4800, 0x0, 0x0, 0x0, 0x0, 0x0, 0x0, 0x0, 0x0
    .long 0x6d9800, 0x925800, 0x77, 0xa8c0, 0x3eff3eff, 0x3eff3eff, 0x6ed000, 0x736800, 0x0, 0x0, 0x0, 0x0, 0x0, 0x0, 0x0, 0x0
    .long 0x241800, 0x925800, 0x77, 0x3860, 0x3e7f3dff, 0x3e7f3dff, 0x250800, 0x29a000, 0x0, 0x0, 0x0, 0x0, 0x0, 0x0, 0x0, 0x0
    .long 0x520800, 0x925800, 0x77, 0x7e40, 0x3dff3e7f, 0x3dff3eff, 0x52e000, 0x577800, 0x0, 0x0, 0x0, 0x0, 0x0, 0x0, 0x0, 0x0
    .long 0x76c800, 0x925800, 0x77, 0xb660, 0x3e7f3eff, 0x3e7f3eff, 0x77b800, 0x7c5000, 0x0, 0x0, 0x0, 0x0, 0x0, 0x0, 0x0, 0x0
    .long 0x2d4800, 0x925800, 0x77, 0x4680, 0x3e7f3e7f, 0x3e7f3e7f, 0x2e5000, 0x32e800, 0x0, 0x0, 0x0, 0x0, 0x0, 0x0, 0x0, 0x0
    .long 0x520800, 0x925800, 0x77, 0x7ea0, 0x3eff3e7f, 0x3eff3eff, 0x532800, 0x57c000, 0x0, 0x0, 0x0, 0x0, 0x0, 0x0, 0x0, 0x0
    .long 0x7ff800, 0x925800, 0x77, 0xc480, 0x3e7f3eff, 0x3e7f3eff, 0x810000, 0x859800, 0x0, 0x0, 0x0, 0x0, 0x0, 0x0, 0x0, 0x0
    .long 0x367800, 0x925800, 0x77, 0x54d0, 0x3eff3e7f, 0x3eff3e7f, 0x37bc00, 0x3c5400, 0x0, 0x0, 0x0, 0x0, 0x0, 0x0, 0x0, 0x0
    .long 0x6d9800, 0x925800, 0x77, 0xa8d0, 0x3eff3eff, 0x3eff3eff, 0x6edc00, 0x737400, 0x0, 0x0, 0x0, 0x0, 0x0, 0x0, 0x0, 0x0
    .long 0x2d4800, 0x925800, 0x77, 0x4630, 0x3dff3e7f, 0x3dff3e7f, 0x2e1400, 0x32ac00, 0x0, 0x0, 0x0, 0x0, 0x0, 0x0, 0x0, 0x0
    .long 0x520800, 0x925800, 0x77, 0x7e50, 0x3e7f3e7f, 0x3e7f3eff, 0x52ec00, 0x578400, 0x0, 0x0, 0x0, 0x0, 0x0, 0x0, 0x0, 0x0
    .long 0x7ff800, 0x925800, 0x77, 0xc430, 0x3dff3eff, 0x3dff3eff, 0x80c400, 0x855c00, 0x0, 0x0, 0x0, 0x0, 0x0, 0x0, 0x0, 0x0
    .long 0x2d4800, 0x925800, 0x77, 0x4690, 0x3eff3e7f, 0x3eff3e7f, 0x2e5c00, 0x32f400, 0x0, 0x0, 0x0, 0x0, 0x0, 0x0, 0x0, 0x0
    .long 0x5b3800, 0x925800, 0x77, 0x8c70, 0x3e7f3eff, 0x3e7f3eff, 0x5c3400, 0x60cc00, 0x0, 0x0, 0x0, 0x0, 0x0, 0x0, 0x0, 0x0
    .long 0x7ff800, 0x925800, 0x77, 0xc490, 0x3eff3eff, 0x3eff3eff, 0x810c00, 0x85a400, 0x0, 0x0, 0x0, 0x0, 0x0, 0x0, 0x0, 0x0
    .long 0x3fa800, 0x925800, 0x77, 0x62b0, 0x3eff3e7f, 0x3eff3e7f, 0x40d400, 0x456c00, 0x0, 0x0, 0x0, 0x0, 0x0, 0x0, 0x0, 0x0
    .long 0x76c800, 0x925800, 0x77, 0xb6b0, 0x3eff3eff, 0x3eff3eff, 0x77f400, 0x7c8c00, 0x0, 0x0, 0x0, 0x0, 0x0, 0x0, 0x0, 0x0
    .long 0x2d4800, 0x925800, 0x77, 0x4640, 0x3dff3e7f, 0x3dff3e7f, 0x2e2000, 0x32b800, 0x0, 0x0, 0x0, 0x0, 0x0, 0x0, 0x0, 0x0
    .long 0x520800, 0x925800, 0x77, 0x7e60, 0x3e7f3e7f, 0x3e7f3eff, 0x52f800, 0x579000, 0x0, 0x0, 0x0, 0x0, 0x0, 0x0, 0x0, 0x0
    .long 0x7ff800, 0x925800, 0x77, 0xc440, 0x3dff3eff, 0x3dff3eff, 0x80d000, 0x856800, 0x0, 0x0, 0x0, 0x0, 0x0, 0x0, 0x0, 0x0
    .long 0x2d4800, 0x925800, 0x77, 0x46a0, 0x3eff3e7f, 0x3eff3e7f, 0x2e6800, 0x330000, 0x0, 0x0, 0x0, 0x0, 0x0, 0x0, 0x0, 0x0
    .long 0x5b3800, 0x925800, 0x77, 0x8c80, 0x3e7f3eff, 0x3e7f3eff, 0x5c4000, 0x60d800, 0x0, 0x0, 0x0, 0x0, 0x0, 0x0, 0x0, 0x0
    .long 0x7ff800, 0x925800, 0x77, 0xc4a0, 0x3eff3eff, 0x3eff3eff, 0x811800, 0x85b000, 0x0, 0x0, 0x0, 0x0, 0x0, 0x0, 0x0, 0x0
    .long 0x3fa800, 0x925800, 0x77, 0x62c0, 0x3eff3e7f, 0x3eff3e7f, 0x40e000, 0x457800, 0x0, 0x0, 0x0, 0x0, 0x0, 0x0, 0x0, 0x0
    .long 0x76c800, 0x925800, 0x77, 0xb6c0, 0x3eff3eff, 0x3eff3eff, 0x780000, 0x7c9800, 0x0, 0x0, 0x0, 0x0, 0x0, 0x0, 0x0, 0x0
    .long 0x2d4800, 0x925800, 0x77, 0x4650, 0x3e7f3e7f, 0x3e7f3e7f, 0x2e2c00, 0x32c400, 0x0, 0x0, 0x0, 0x0, 0x0, 0x0, 0x0, 0x0
    .long 0x5b3800, 0x925800, 0x77, 0x8c30, 0x3dff3eff, 0x3dff3eff, 0x5c0400, 0x609c00, 0x0, 0x0, 0x0, 0x0, 0x0, 0x0, 0x0, 0x0
    .long 0x7ff800, 0x925800, 0x77, 0xc450, 0x3e7f3eff, 0x3e7f3eff, 0x80dc00, 0x857400, 0x0, 0x0, 0x0, 0x0, 0x0, 0x0, 0x0, 0x0
    .long 0x367800, 0x925800, 0x77, 0x5470, 0x3e7f3e7f, 0x3e7f3e7f, 0x377400, 0x3c0c00, 0x0, 0x0, 0x0, 0x0, 0x0, 0x0, 0x0, 0x0
    .long 0x5b3800, 0x925800, 0x77, 0x8c90, 0x3eff3eff, 0x3eff3eff, 0x5c4c00, 0x60e400, 0x0, 0x0, 0x0, 0x0, 0x0, 0x0, 0x0, 0x0
    .long 0x892800, 0x925800, 0x77, 0xd270, 0x3e7f3eff, 0x3e7f3eff, 0x8a2400, 0x8ebc00, 0x0, 0x0, 0x0, 0x0, 0x0, 0x0, 0x0, 0x0
    .long 0x3fa800, 0x925800, 0x77, 0x62d0, 0x3eff3e7f, 0x3eff3e7f, 0x40ec00, 0x458400, 0x0, 0x0, 0x0, 0x0, 0x0, 0x0, 0x0, 0x0
    .long 0x76c800, 0x925800, 0x77, 0xb6d0, 0x3eff3eff, 0x3eff3eff, 0x780c00, 0x7ca400, 0x0, 0x0, 0x0, 0x0, 0x0, 0x0, 0x0, 0x0
    .long 0x2d4800, 0x925800, 0x77, 0x4660, 0x3e7f3e7f, 0x3e7f3e7f, 0x2e3800, 0x32d000, 0x0, 0x0, 0x0, 0x0, 0x0, 0x0, 0x0, 0x0
    .long 0x5b3800, 0x925800, 0x77, 0x8c40, 0x3dff3eff, 0x3dff3eff, 0x5c1000, 0x60a800, 0x0, 0x0, 0x0, 0x0, 0x0, 0x0, 0x0, 0x0
    .long 0x7ff800, 0x925800, 0x77, 0xc460, 0x3e7f3eff, 0x3e7f3eff, 0x80e800, 0x858000, 0x0, 0x0, 0x0, 0x0, 0x0, 0x0, 0x0, 0x0
    .long 0x367800, 0x925800, 0x77, 0x5480, 0x3e7f3e7f, 0x3e7f3e7f, 0x378000, 0x3c1800, 0x0, 0x0, 0x0, 0x0, 0x0, 0x0, 0x0, 0x0
    .long 0x5b3800, 0x925800, 0x77, 0x8ca0, 0x3eff3eff, 0x3eff3eff, 0x5c5800, 0x60f000, 0x0, 0x0, 0x0, 0x0, 0x0, 0x0, 0x0, 0x0
    .long 0x892800, 0x925800, 0x77, 0xd280, 0x3e7f3eff, 0x3e7f3eff, 0x8a3000, 0x8ec800, 0x0, 0x0, 0x0, 0x0, 0x0, 0x0, 0x0, 0x0
    .long 0x48d800, 0x925800, 0x77, 0x70b0, 0x3eff3e7f, 0x3eff3e7f, 0x4a0400, 0x4e9c00, 0x0, 0x0, 0x0, 0x0, 0x0, 0x0, 0x0, 0x0
    .long 0x7ff800, 0x925800, 0x77, 0xc4b0, 0x3eff3eff, 0x3eff3eff, 0x812400, 0x85bc00, 0x0, 0x0, 0x0, 0x0, 0x0, 0x0, 0x0, 0x0
    .long 0x367800, 0x925800, 0x77, 0x5430, 0x3dff3e7f, 0x3dff3e7f, 0x374400, 0x3bdc00, 0x0, 0x0, 0x0, 0x0, 0x0, 0x0, 0x0, 0x0
    .long 0x5b3800, 0x925800, 0x77, 0x8c50, 0x3e7f3eff, 0x3e7f3eff, 0x5c1c00, 0x60b400, 0x0, 0x0, 0x0, 0x0, 0x0, 0x0, 0x0, 0x0
    .long 0x892800, 0x925800, 0x77, 0xd230, 0x3dff3eff, 0x3dff3eff, 0x89f400, 0x8e8c00, 0x0, 0x0, 0x0, 0x0, 0x0, 0x0, 0x0, 0x0
    .long 0x367800, 0x925800, 0x77, 0x5490, 0x3eff3e7f, 0x3eff3e7f, 0x378c00, 0x3c2400, 0x0, 0x0, 0x0, 0x0, 0x0, 0x0, 0x0, 0x0
    .long 0x646800, 0x925800, 0x77, 0x9a70, 0x3e7f3eff, 0x3e7f3eff, 0x656400, 0x69fc00, 0x0, 0x0, 0x0, 0x0, 0x0, 0x0, 0x0, 0x0
    .long 0x892800, 0x925800, 0x77, 0xd290, 0x3eff3eff, 0x3eff3eff, 0x8a3c00, 0x8ed400, 0x0, 0x0, 0x0, 0x0, 0x0, 0x0, 0x0, 0x0
    .long 0x48d800, 0x925800, 0x77, 0x70c0, 0x3eff3e7f, 0x3eff3e7f, 0x4a1000, 0x4ea800, 0x0, 0x0, 0x0, 0x0, 0x0, 0x0, 0x0, 0x0
    .long 0x7ff800, 0x925800, 0x77, 0xc4c0, 0x3eff3eff, 0x3eff3eff, 0x813000, 0x85c800, 0x0, 0x0, 0x0, 0x0, 0x0, 0x0, 0x0, 0x0
    .long 0x367800, 0x925800, 0x77, 0x5440, 0x3dff3e7f, 0x3dff3e7f, 0x375000, 0x3be800, 0x0, 0x0, 0x0, 0x0, 0x0, 0x0, 0x0, 0x0
    .long 0x5b3800, 0x925800, 0x77, 0x8c60, 0x3e7f3eff, 0x3e7f3eff, 0x5c2800, 0x60c000, 0x0, 0x0, 0x0, 0x0, 0x0, 0x0, 0x0, 0x0
    .long 0x892800, 0x925800, 0x77, 0xd240, 0x3dff3eff, 0x3dff3eff, 0x8a0000, 0x8e9800, 0x0, 0x0, 0x0, 0x0, 0x0, 0x0, 0x0, 0x0
    .long 0x367800, 0x925800, 0x77, 0x54a0, 0x3eff3e7f, 0x3eff3e7f, 0x379800, 0x3c3000, 0x0, 0x0, 0x0, 0x0, 0x0, 0x0, 0x0, 0x0
    .long 0x646800, 0x925800, 0x77, 0x9a80, 0x3e7f3eff, 0x3e7f3eff, 0x657000, 0x6a0800, 0x0, 0x0, 0x0, 0x0, 0x0, 0x0, 0x0, 0x0
    .long 0x892800, 0x925800, 0x77, 0xd2a0, 0x3eff3eff, 0x3eff3eff, 0x8a4800, 0x8ee000, 0x0, 0x0, 0x0, 0x0, 0x0, 0x0, 0x0, 0x0
    .long 0x48d800, 0x925800, 0x77, 0x70d0, 0x3eff3e7f, 0x3eff3e7f, 0x4a1c00, 0x4eb400, 0x0, 0x0, 0x0, 0x0, 0x0, 0x0, 0x0, 0x0
    .long 0x7ff800, 0x925800, 0x77, 0xc4d0, 0x3eff3eff, 0x3eff3eff, 0x813c00, 0x85d400, 0x0, 0x0, 0x0, 0x0, 0x0, 0x0, 0x0, 0x0
    .long 0x367800, 0x925800, 0x77, 0x5450, 0x3e7f3e7f, 0x3e7f3e7f, 0x375c00, 0x3bf400, 0x0, 0x0, 0x0, 0x0, 0x0, 0x0, 0x0, 0x0
    .long 0x646800, 0x925800, 0x77, 0x9a30, 0x3dff3eff, 0x3dff3eff, 0x653400, 0x69cc00, 0x0, 0x0, 0x0, 0x0, 0x0, 0x0, 0x0, 0x0
    .long 0x892800, 0x925800, 0x77, 0xd250, 0x3e7f3eff, 0x3e7f3eff, 0x8a0c00, 0x8ea400, 0x0, 0x0, 0x0, 0x0, 0x0, 0x0, 0x0, 0x0
    .long 0x3fa800, 0x925800, 0x77, 0x6270, 0x3e7f3e7f, 0x3e7f3e7f, 0x40a400, 0x453c00, 0x0, 0x0, 0x0, 0x0, 0x0, 0x0, 0x0, 0x0
    .long 0x646800, 0x925800, 0x77, 0x9a90, 0x3eff3eff, 0x3eff3eff, 0x657c00, 0x6a1400, 0x0, 0x0, 0x0, 0x0, 0x0, 0x0, 0x0, 0x0
    .long 0x1ae800, 0x925800, 0x77, 0x2ab0, 0x3eff3dff, 0x3eff3dff, 0x1c1400, 0x20ac00, 0x0, 0x0, 0x0, 0x0, 0x0, 0x0, 0x0, 0x0
    .long 0x520800, 0x925800, 0x77, 0x7eb0, 0x3eff3e7f, 0x3eff3eff, 0x533400, 0x57cc00, 0x0, 0x0, 0x0, 0x0, 0x0, 0x0, 0x0, 0x0
    .long 0x892800, 0x925800, 0x77, 0xd2b0, 0x3eff3eff, 0x3eff3eff, 0x8a5400, 0x8eec00, 0x0, 0x0, 0x0, 0x0, 0x0, 0x0, 0x0, 0x0
    .long 0x367800, 0x925800, 0x77, 0x5460, 0x3e7f3e7f, 0x3e7f3e7f, 0x376800, 0x3c0000, 0x0, 0x0, 0x0, 0x0, 0x0, 0x0, 0x0, 0x0
    .long 0x646800, 0x925800, 0x77, 0x9a40, 0x3dff3eff, 0x3dff3eff, 0x654000, 0x69d800, 0x0, 0x0, 0x0, 0x0, 0x0, 0x0, 0x0, 0x0
    .long 0x892800, 0x925800, 0x77, 0xd260, 0x3e7f3eff, 0x3e7f3eff, 0x8a1800, 0x8eb000, 0x0, 0x0, 0x0, 0x0, 0x0, 0x0, 0x0, 0x0
    .long 0x3fa800, 0x925800, 0x77, 0x6280, 0x3e7f3e7f, 0x3e7f3e7f, 0x40b000, 0x454800, 0x0, 0x0, 0x0, 0x0, 0x0, 0x0, 0x0, 0x0
    .long 0x646800, 0x925800, 0x77, 0x9aa0, 0x3eff3eff, 0x3eff3eff, 0x658800, 0x6a2000, 0x0, 0x0, 0x0, 0x0, 0x0, 0x0, 0x0, 0x0
    .long 0x1ae800, 0x925800, 0x77, 0x2ac0, 0x3eff3dff, 0x3eff3dff, 0x1c2000, 0x20b800, 0x0, 0x0, 0x0, 0x0, 0x0, 0x0, 0x0, 0x0
    .long 0x520800, 0x925800, 0x77, 0x7ec0, 0x3eff3e7f, 0x3eff3eff, 0x534000, 0x57d800, 0x0, 0x0, 0x0, 0x0, 0x0, 0x0, 0x0, 0x0
    .long 0x892800, 0x925800, 0x77, 0xd2c0, 0x3eff3eff, 0x3eff3eff, 0x8a6000, 0x8ef800, 0x0, 0x0, 0x0, 0x0, 0x0, 0x0, 0x0, 0x0
    .long 0x3fa800, 0x925800, 0x77, 0x6230, 0x3dff3e7f, 0x3dff3e7f, 0x407400, 0x450c00, 0x0, 0x0, 0x0, 0x0, 0x0, 0x0, 0x0, 0x0
    .long 0x646800, 0x925800, 0x77, 0x9a50, 0x3e7f3eff, 0x3e7f3eff, 0x654c00, 0x69e400, 0x0, 0x0, 0x0, 0x0, 0x0, 0x0, 0x0, 0x0
    .long 0x1ae800, 0x925800, 0x77, 0x2a70, 0x3e7f3dff, 0x3e7f3dff, 0x1be400, 0x207c00, 0x0, 0x0, 0x0, 0x0, 0x0, 0x0, 0x0, 0x0
    .long 0x3fa800, 0x925800, 0x77, 0x6290, 0x3eff3e7f, 0x3eff3e7f, 0x40bc00, 0x455400, 0x0, 0x0, 0x0, 0x0, 0x0, 0x0, 0x0, 0x0
    .long 0x6d9800, 0x925800, 0x77, 0xa870, 0x3e7f3eff, 0x3e7f3eff, 0x6e9400, 0x732c00, 0x0, 0x0, 0x0, 0x0, 0x0, 0x0, 0x0, 0x0
    .long 0x1ae800, 0x925800, 0x77, 0x2ad0, 0x3eff3dff, 0x3eff3dff, 0x1c2c00, 0x20c400, 0x0, 0x0, 0x0, 0x0, 0x0, 0x0, 0x0, 0x0
    .long 0x520800, 0x925800, 0x77, 0x7ed0, 0x3eff3e7f, 0x3eff3eff, 0x534c00, 0x57e400, 0x0, 0x0, 0x0, 0x0, 0x0, 0x0, 0x0, 0x0
    .long 0x892800, 0x925800, 0x77, 0xd2d0, 0x3eff3eff, 0x3eff3eff, 0x8a6c00, 0x8f0400, 0x0, 0x0, 0x0, 0x0, 0x0, 0x0, 0x0, 0x0
.section .rodata,"a"
.p2align 6
.amdhsa_kernel standalone__deformable_dcnv1__vision_kernel
  .amdhsa_next_free_vgpr 512
  .amdhsa_next_free_sgpr 102
  .amdhsa_accum_offset 256
  .amdhsa_group_segment_fixed_size 0
  .amdhsa_kernarg_size 48
  .amdhsa_user_sgpr_count 2
  .amdhsa_user_sgpr_kernarg_segment_ptr 1
  .amdhsa_system_sgpr_workgroup_id_x 1
  .amdhsa_float_denorm_mode_32 3
.end_amdhsa_kernel
```

```asm
; @launch grid=(256,1,1) block=(256,1,1) lds=163840
.amdgcn_target "amdgcn-amd-amdhsa--gfx950"
.text
.globl standalone__deformable_dcnv1__vision_kernel
.p2align 12
.p2align 8
.type standalone__deformable_dcnv1__vision_kernel,@function
standalone__deformable_dcnv1__vision_kernel:
    s_cmp_ge_u32 s2, 256
    s_cbranch_scc1 L_end
    s_getpc_b64 s[40:41]
L_pc:
    v_and_b32 v32, 63, v0
    s_lshl_b32 s47, s2, 6
    v_lshlrev_b32 v13, 7, v32
    s_add_u32 s47, s47, L_runtab-L_pc
    s_add_u32 s54, s47, 32
    s_load_dwordx8 s[20:27], s[40:41], s47
    s_load_dwordx8 s[68:75], s[40:41], s54
    s_load_dwordx2 s[12:13], s[0:1], 16
    s_load_dwordx2 s[4:5], s[0:1], 0
    s_load_dwordx2 s[8:9], s[0:1], 8
    s_load_dwordx2 s[16:17], s[0:1], 24
    v_lshrrev_b32 v33, 6, v0
    v_lshlrev_b32 v6, 4, v32
    v_readfirstlane_b32 s28, v33
    v_add_u32 v12, L_ctab-L_pc, v6
    s_lshr_b32 s47, s2, 3
    global_load_dwordx4 v[16:19], v12, s[40:41]
    s_bfe_u32 s48, s2, 0x10007
    s_lshl1_add_u32 s49, s28, s48
    s_lshl_b32 s49, s49, 13
    s_and_b32 s48, s47, 15
    v_add_u32 v33, s49, v13
    v_min_u32 v33, L_cold-L_pc, v33
    s_lshl_b32 exec_lo, 0x10001, s48
    s_mov_b32 exec_hi, exec_lo
    global_load_dword v15, v33, s[40:41]
    s_mov_b64 exec, -1
    s_mov_b32 s6, 9633792
    s_mov_b32 s7, 0x00020000
    s_mov_b32 s10, 1806336
    s_mov_b32 s11, s7
    s_mov_b32 s14, 165888
    s_mov_b32 s15, s7
    s_mov_b32 s18, s6
    s_mov_b32 s19, s7
    s_and_b32 s29, s28, 1
    s_lshr_b32 s30, s28, 1
    s_lshl2_add_u32 s49, s47, s28
    s_mulk_i32 s49, 1280
    s_addk_i32 s49, 12288
    s_cmpk_lt_u32 s2, 38
    s_cselect_b32 s47, 40, 16
    s_cmpk_lt_u32 s2, 113
    s_cselect_b32 s47, s47, 0
    s_cmp_eq_u32 s28, 3
    s_cselect_b32 s47, s47, 0
    v_subrev_u32 v35, s47, v0
    s_lshl_b32 s33, s28, 6
    v_mul_u32_u24 v36, 5462, v35
    s_mul_i32 s44, s28, 3104
    v_lshrrev_b32 v36, 16, v36
    s_sub_u32 s33, s33, s47
    v_mad_i32_i24 v33, v36, -12, v35
    v_bfe_u32 v34, v36, 2, 2
    s_lshl_b32 s33, s33, 4
    v_xor_b32 v33, v33, v34
    s_mul_i32 s46, s28, 3072
    v_lshlrev_b32 v8, 4, v33
    s_movk_i32 s48, 223
    v_mov_b32 v35, 2130706432
    s_cmpk_lt_u32 s2, 113
    v_add_u32 v7, s46, v6
    s_cbranch_scc1 L_X
    v_cmp_gt_u32 vcc, 18, v36
    s_add_u32 s44, s44, 65536
    s_mul_i32 s45, s30, 93120
    s_sub_u32 s45, s44, s45
    s_cmp_eq_u32 s30, 0
    v_cndmask_b32 v8, v35, v8, vcc
    s_waitcnt lgkmcnt(0)
    s_cselect_b32 s31, s26, s27
    s_cselect_b32 s35, s24, s25
    s_mov_b64 exec, 0x3ff
    buffer_load_dword v13, v13, s[12:15], s49 offen
    s_mov_b64 exec, -1
    s_add_u32 m0, s44, 0
    s_mov_b32 s46, 0
    buffer_load_dwordx4 v7, s[12:15], s46 offen offset:0 lds
    buffer_load_dwordx4 v7, s[12:15], s46 offen offset:1024 lds
    buffer_load_dwordx4 v7, s[12:15], s46 offen offset:2048 lds
    s_and_b32 s47, s23, 0xff
    v_add3_u32 v34, v36, s47, -1
    v_min_u32 v34, s48, v34
    v_mul_u32_u24 v34, 192, v34
    v_add_u32 v8, v34, v8
    s_add_u32 m0, s44, 12416
    s_mov_b32 s46, 12288
    buffer_load_dwordx4 v7, s[12:15], s46 offen offset:0 lds
    buffer_load_dwordx4 v7, s[12:15], s46 offen offset:1024 lds
    buffer_load_dwordx4 v7, s[12:15], s46 offen offset:2048 lds
    s_add_u32 m0, s33, 0
    s_add_u32 s56, s20, 0
    buffer_load_dwordx4 v8, s[4:7], s56 offen lds
    s_add_u32 m0, s33, 28672
    s_add_u32 s63, s20, 301056
    buffer_load_dwordx4 v8, s[4:7], s63 offen lds
    s_add_u32 m0, s33, 4096
    s_add_u32 s57, s20, 43008
    buffer_load_dwordx4 v8, s[4:7], s57 offen lds
    s_add_u32 m0, s33, 32768
    s_add_u32 s64, s20, 344064
    buffer_load_dwordx4 v8, s[4:7], s64 offen lds
    s_add_u32 m0, s33, 8192
    s_add_u32 s58, s20, 86016
    buffer_load_dwordx4 v8, s[4:7], s58 offen lds
    s_add_u32 m0, s33, 36864
    s_add_u32 s65, s20, 387072
    buffer_load_dwordx4 v8, s[4:7], s65 offen lds
    s_branch L_N2
L_X:
    s_cmpk_ge_u32 s2, 38
    s_cselect_b32 s60, 1, 0
    s_cselect_b32 s43, 1, 5
    s_cselect_b32 s42, 0, -9
    s_sub_u32 s47, s2, 19
    s_movk_i32 s36, 192
    s_mov_b32 s38, 43008
    s_movk_i32 s39, 8064
    s_cmpk_lt_u32 s47, 40
    s_cselect_b32 s56, 1, 0
    s_cselect_b32 s55, s36, s38
    s_cselect_b32 s2, s38, s36
    s_cselect_b32 s37, 36, s39
    s_cselect_b32 s39, s39, 36
    s_lshl_b32 s47, s60, 10
    v_add_u32 v42, s47, v12
    global_load_dwordx4 v[164:167], v42, s[40:41] offset:1024
    global_load_dwordx4 v[168:171], v42, s[40:41] offset:2048
    v_mul_u32_u24 v40, 86, v32
    s_lshl2_add_u32 s47, s39, -36
    v_mul_u32_u24 v37, 12, v32
    s_mul_i32 s43, s43, s37
    v_lshrrev_b32 v40, 8, v40
    s_lshl_b32 s36, s39, 4
    s_mul_i32 s42, s42, s37
    v_lshrrev_b32 v41, 2, v40
    v_mad_u32_u24 v37, v40, s47, v37
    s_sub_u32 s43, s43, s36
    v_lshrrev_b32 v34, 3, v40
    v_and_b32 v33, 4, v41
    v_mad_i32_i24 v37, v41, s43, v37
    s_lshl_b32 s37, s37, 1
    v_lshl_or_b32 v38, v33, 4, v41
    v_mad_i32_i24 v37, v34, s42, v37
    s_lshl_b32 s37, s37, s60
    v_add_u32 v33, s28, v41
    v_mad_i32_i24 v39, v40, -3, v32
    v_and_b32 v33, 3, v33
    v_and_b32 v40, 3, v40
    v_mad_u32_u24 v37, v33, s39, v37
    v_lshl_add_u32 v40, v40, 2, v33
    s_waitcnt lgkmcnt(0)
    v_cmp_gt_u32 vcc, s75, v38
    v_add_u32 v38, 4, v38
    s_mov_b32 s32, s74
    v_cndmask_b32 v34, v35, v37, vcc
    buffer_load_dwordx3 v[232:234], v34, s[8:11], s32 offen
    v_cmp_gt_u32 vcc, s75, v38
    v_add_u32 v38, 4, v38
    s_add_u32 s32, s32, s37
    v_cndmask_b32 v34, v35, v37, vcc
    buffer_load_dwordx3 v[236:238], v34, s[8:11], s32 offen
    v_cmp_gt_u32 vcc, s75, v38
    v_add_u32 v38, 4, v38
    s_add_u32 s32, s32, s37
    v_cndmask_b32 v34, v35, v37, vcc
    buffer_load_dwordx3 v[240:242], v34, s[8:11], s32 offen
    s_bfe_i32 s43, s23, 0x90014
    s_mov_b64 exec, 0x3ff
    buffer_load_dword v13, v13, s[12:15], s49 offen
    s_mov_b64 exec, -1
    v_add_u32 v34, s43, v36
    s_cmp_eq_u32 s60, 0
    v_med3_i32 v34, v34, 0, s48
    v_mad_u32_u24 v8, v34, s2, v8
    s_cbranch_scc0 L_Xp
    s_add_u32 m0, s44, 88992
    s_bfe_u32 s46, s24, 0x40000
    s_mul_i32 s46, s46, 18432
    buffer_load_dwordx4 v7, s[12:15], s46 offen offset:0 lds
    s_branch L_S
L_Xp:
    s_add_u32 m0, s33, 0
    s_max_i32 s47, s20, 0
    s_add_u32 s20, s20, s55
    buffer_load_dwordx4 v8, s[4:7], s47 offen lds
    s_add_u32 m0, s33, 3904
    s_max_i32 s47, s20, 0
    s_add_u32 s20, s20, s55
    buffer_load_dwordx4 v8, s[4:7], s47 offen lds
    s_branch L_P
L_N2:
    s_add_u32 s59, s20, 129024
    s_add_u32 s60, s20, 172032
    s_add_u32 s61, s20, 215040
    s_add_u32 s62, s20, 258048
    s_add_u32 s66, s20, 430080
    s_add_u32 s67, s20, 473088
    s_add_u32 s68, s20, 516096
    s_add_u32 s69, s20, 559104
    s_add_u32 s70, s20, 602112
    s_add_u32 s71, s20, 645120
    s_min_i32 s71, s71, s21
    s_lshl_b32 s48, s29, 7
    s_lshl_b32 s49, s29, 5
    s_add_u32 s47, s48, 65536
    s_waitcnt vmcnt(14)
    v_add_u32_sdwa v4, s47, v16 dst_sel:DWORD dst_unused:UNUSED_PAD src0_sel:DWORD src1_sel:WORD_0
    s_add_u32 s47, s49, 65536
    v_add_u32_sdwa v5, s47, v16 dst_sel:DWORD dst_unused:UNUSED_PAD src0_sel:DWORD src1_sel:WORD_0
    s_mul_i32 s47, s30, 28672
    v_add_u32_sdwa v1, s47, v16 dst_sel:DWORD dst_unused:UNUSED_PAD src0_sel:DWORD src1_sel:WORD_1
    v_add_u32_sdwa v2, s47, v17 dst_sel:DWORD dst_unused:UNUSED_PAD src0_sel:DWORD src1_sel:WORD_0
    v_add_u32_sdwa v3, s47, v17 dst_sel:DWORD dst_unused:UNUSED_PAD src0_sel:DWORD src1_sel:WORD_1
    v_mov_b32 v14, v19
    s_mul_i32 s32, s31, 3
    s_lshr_b32 s32, s32, 4
    s_cmp_eq_u32 s28, 1
    s_cbranch_scc0 L_N2_n0
    s_call_b64 s[78:79], L_N2_t0
L_N2_n0:
    s_cmp_eq_u32 s28, 2
    s_cbranch_scc0 L_N2_n1
    s_call_b64 s[78:79], L_N2_t1
L_N2_n1:
    s_waitcnt vmcnt(6)
    s_barrier
    ds_read_b64_tr_b16 a[0:1], v4 offset:0
    ds_read_b64_tr_b16 a[2:3], v4 offset:768
    ds_read_b64_tr_b16 a[4:5], v4 offset:32
    ds_read_b64_tr_b16 a[6:7], v4 offset:800
    ds_read_b64_tr_b16 a[8:9], v5 offset:64
    ds_read_b64_tr_b16 a[10:11], v5 offset:832
    ds_read_b64_tr_b16 a[12:13], v4 offset:6208
    ds_read_b64_tr_b16 a[14:15], v4 offset:6976
    ds_read_b64_tr_b16 a[16:17], v4 offset:6240
    ds_read_b64_tr_b16 a[18:19], v4 offset:7008
    ds_read_b64_tr_b16 a[20:21], v5 offset:6272
    ds_read_b64_tr_b16 a[22:23], v5 offset:7040
    ds_read_b64_tr_b16 a[24:25], v4 offset:12416
    ds_read_b64_tr_b16 a[26:27], v4 offset:13184
    ds_read_b64_tr_b16 a[28:29], v4 offset:12448
    ds_read_b64_tr_b16 a[30:31], v4 offset:13216
    ds_read_b64_tr_b16 a[32:33], v5 offset:12480
    ds_read_b64_tr_b16 a[34:35], v5 offset:13248
    ds_read_b64_tr_b16 a[36:37], v4 offset:18624
    ds_read_b64_tr_b16 a[38:39], v4 offset:19392
    ds_read_b64_tr_b16 a[40:41], v4 offset:18656
    ds_read_b64_tr_b16 a[42:43], v4 offset:19424
    ds_read_b64_tr_b16 a[44:45], v5 offset:18688
    ds_read_b64_tr_b16 a[46:47], v5 offset:19456
    s_add_u32 m0, s44, 24832
    s_mov_b32 s46, 24576
    buffer_load_dwordx4 v7, s[12:15], s46 offen offset:0 lds
    buffer_load_dwordx4 v7, s[12:15], s46 offen offset:1024 lds
    buffer_load_dwordx4 v7, s[12:15], s46 offen offset:2048 lds
    s_add_u32 m0, s44, 37248
    s_mov_b32 s46, 36864
    buffer_load_dwordx4 v7, s[12:15], s46 offen offset:0 lds
    buffer_load_dwordx4 v7, s[12:15], s46 offen offset:1024 lds
    buffer_load_dwordx4 v7, s[12:15], s46 offen offset:2048 lds
    s_add_u32 m0, s44, 49664
    s_mov_b32 s46, 49152
    buffer_load_dwordx4 v7, s[12:15], s46 offen offset:0 lds
    buffer_load_dwordx4 v7, s[12:15], s46 offen offset:1024 lds
    buffer_load_dwordx4 v7, s[12:15], s46 offen offset:2048 lds
    s_waitcnt vmcnt(9)
    s_barrier
    ds_read_b128 v[80:83], v1 offset:0
    ds_read_b128 v[116:119], v1 offset:4096
    ds_read_b128 v[152:155], v1 offset:8192
    ds_read_b128 v[84:87], v1 offset:64
    ds_read_b128 v[120:123], v1 offset:4160
    ds_read_b128 v[156:159], v1 offset:8256
    s_waitcnt lgkmcnt(5)
    v_mfma_f32_16x16x32_bf16 v[44:47], a[0:3], v[80:83], 0
    ds_read_b128 v[88:91], v1 offset:128
    v_mfma_f32_16x16x32_bf16 v[48:51], a[4:7], v[80:83], 0
    s_add_u32 m0, s33, 12288
    v_mfma_f32_16x16x32_bf16 v[52:55], a[8:11], v[80:83], 0
    buffer_load_dwordx4 v8, s[4:7], s59 offen lds
    s_waitcnt lgkmcnt(5)
    v_mfma_f32_16x16x32_bf16 v[64:67], a[8:11], v[116:119], 0
    ds_read_b128 v[124:127], v1 offset:4224
    v_mfma_f32_16x16x32_bf16 v[60:63], a[4:7], v[116:119], 0
    ds_read_b128 v[160:163], v1 offset:8320
    v_mfma_f32_16x16x32_bf16 v[56:59], a[0:3], v[116:119], 0
    s_add_u32 m0, s33, 40960
    ds_read_b128 v[92:95], v2 offset:0
    ds_read_b128 v[128:131], v2 offset:4096
    ds_read_b128 v[164:167], v2 offset:8192
    s_waitcnt lgkmcnt(7)
    v_mfma_f32_16x16x32_bf16 v[68:71], a[0:3], v[152:155], 0
    buffer_load_dwordx4 v8, s[4:7], s66 offen lds
    s_waitcnt vmcnt(8)
    s_barrier
    v_mfma_f32_16x16x32_bf16 v[72:75], a[4:7], v[152:155], 0
    ds_read_b128 v[96:99], v2 offset:64
    v_mfma_f32_16x16x32_bf16 v[76:79], a[8:11], v[152:155], 0
    ds_read_b64_tr_b16 a[48:49], v4 offset:24832
    v_mfma_f32_16x16x32_bf16 v[44:47], a[12:15], v[84:87], v[44:47]
    s_add_u32 m0, s44, 62080
    s_mov_b32 s46, 61440
    v_mfma_f32_16x16x32_bf16 v[48:51], a[16:19], v[84:87], v[48:51]
    buffer_load_dwordx4 v7, s[12:15], s46 offen offset:0 lds
    v_mfma_f32_16x16x32_bf16 v[52:55], a[20:23], v[84:87], v[52:55]
    ds_read_b64_tr_b16 a[50:51], v4 offset:25600
    v_mfma_f32_16x16x32_bf16 v[64:67], a[20:23], v[120:123], v[64:67]
    ds_read_b64_tr_b16 a[52:53], v4 offset:24864
    v_mfma_f32_16x16x32_bf16 v[60:63], a[16:19], v[120:123], v[60:63]
    ds_read_b64_tr_b16 a[54:55], v4 offset:25632
    v_mfma_f32_16x16x32_bf16 v[56:59], a[12:15], v[120:123], v[56:59]
    ds_read_b64_tr_b16 a[56:57], v5 offset:24896
    s_waitcnt lgkmcnt(7)
    v_mfma_f32_16x16x32_bf16 v[68:71], a[12:15], v[156:159], v[68:71]
    buffer_load_dwordx4 v7, s[12:15], s46 offen offset:1024 lds
    v_mfma_f32_16x16x32_bf16 v[72:75], a[16:19], v[156:159], v[72:75]
    ds_read_b64_tr_b16 a[58:59], v5 offset:25664
    v_mfma_f32_16x16x32_bf16 v[76:79], a[20:23], v[156:159], v[76:79]
    ds_read_b128 v[132:135], v2 offset:4160
    v_mfma_f32_16x16x32_bf16 v[44:47], a[24:27], v[88:91], v[44:47]
    ds_read_b128 v[168:171], v2 offset:8256
    v_mfma_f32_16x16x32_bf16 v[48:51], a[28:31], v[88:91], v[48:51]
    buffer_load_dwordx4 v7, s[12:15], s46 offen offset:2048 lds
    v_mfma_f32_16x16x32_bf16 v[52:55], a[32:35], v[88:91], v[52:55]
    ds_read_b128 v[100:103], v2 offset:128
    v_mfma_f32_16x16x32_bf16 v[64:67], a[32:35], v[124:127], v[64:67]
    ds_read_b64_tr_b16 a[60:61], v4 offset:31040
    ds_read_b64_tr_b16 a[62:63], v4 offset:31808
    v_mfma_f32_16x16x32_bf16 v[60:63], a[28:31], v[124:127], v[60:63]
    s_add_u32 m0, s44, 74496
    s_mov_b32 s46, 73728
    v_mfma_f32_16x16x32_bf16 v[56:59], a[24:27], v[124:127], v[56:59]
    buffer_load_dwordx4 v7, s[12:15], s46 offen offset:0 lds
    v_mfma_f32_16x16x32_bf16 v[68:71], a[24:27], v[160:163], v[68:71]
    ds_read_b64_tr_b16 a[64:65], v4 offset:31072
    v_mfma_f32_16x16x32_bf16 v[72:75], a[28:31], v[160:163], v[72:75]
    ds_read_b64_tr_b16 a[66:67], v4 offset:31840
    v_mfma_f32_16x16x32_bf16 v[76:79], a[32:35], v[160:163], v[76:79]
    ds_read_b64_tr_b16 a[68:69], v5 offset:31104
    s_waitcnt vmcnt(6)
    s_barrier
    v_mfma_f32_16x16x32_bf16 v[44:47], a[36:39], v[92:95], v[44:47]
    ds_read_b64_tr_b16 a[70:71], v5 offset:31872
    v_mfma_f32_16x16x32_bf16 v[48:51], a[40:43], v[92:95], v[48:51]
    ds_read_b128 v[136:139], v2 offset:4224
    v_mfma_f32_16x16x32_bf16 v[52:55], a[44:47], v[92:95], v[52:55]
    ds_read_b128 v[172:175], v2 offset:8320
    v_mfma_f32_16x16x32_bf16 v[64:67], a[44:47], v[128:131], v[64:67]
    buffer_load_dwordx4 v7, s[12:15], s46 offen offset:1024 lds
    v_mfma_f32_16x16x32_bf16 v[60:63], a[40:43], v[128:131], v[60:63]
    ds_read_b128 v[104:107], v3 offset:0
    v_mfma_f32_16x16x32_bf16 v[56:59], a[36:39], v[128:131], v[56:59]
    ds_read_b64_tr_b16 a[72:73], v4 offset:37248
    ds_read_b64_tr_b16 a[74:75], v4 offset:38016
    s_waitcnt lgkmcnt(7)
    v_mfma_f32_16x16x32_bf16 v[68:71], a[36:39], v[164:167], v[68:71]
    buffer_load_dwordx4 v7, s[12:15], s46 offen offset:2048 lds
    v_mfma_f32_16x16x32_bf16 v[72:75], a[40:43], v[164:167], v[72:75]
    ds_read_b64_tr_b16 a[76:77], v4 offset:37280
    v_mfma_f32_16x16x32_bf16 v[76:79], a[44:47], v[164:167], v[76:79]
    ds_read_b64_tr_b16 a[78:79], v4 offset:38048
    ds_read_b64_tr_b16 a[80:81], v5 offset:37312
    v_mfma_f32_16x16x32_bf16 v[44:47], a[48:51], v[96:99], v[44:47]
    s_add_u32 m0, s45, 86912
    s_mov_b32 s46, 86016
    ds_read_b64_tr_b16 a[82:83], v5 offset:38080
    v_mfma_f32_16x16x32_bf16 v[48:51], a[52:55], v[96:99], v[48:51]
    buffer_load_dwordx4 v7, s[12:15], s46 offen offset:0 lds
    v_mfma_f32_16x16x32_bf16 v[52:55], a[56:59], v[96:99], v[52:55]
    ds_read_b128 v[140:143], v3 offset:4096
    v_mfma_f32_16x16x32_bf16 v[64:67], a[56:59], v[132:135], v[64:67]
    ds_read_b128 v[176:179], v3 offset:8192
    v_mfma_f32_16x16x32_bf16 v[60:63], a[52:55], v[132:135], v[60:63]
    ds_read_b128 v[108:111], v3 offset:64
    v_mfma_f32_16x16x32_bf16 v[56:59], a[48:51], v[132:135], v[56:59]
    ds_read_b64_tr_b16 a[84:85], v4 offset:43456
    ds_read_b64_tr_b16 a[86:87], v4 offset:44224
    v_mfma_f32_16x16x32_bf16 v[68:71], a[48:51], v[168:171], v[68:71]
    buffer_load_dwordx4 v7, s[12:15], s46 offen offset:1024 lds
    v_mfma_f32_16x16x32_bf16 v[72:75], a[52:55], v[168:171], v[72:75]
    ds_read_b64_tr_b16 a[88:89], v4 offset:43488
    v_mfma_f32_16x16x32_bf16 v[76:79], a[56:59], v[168:171], v[76:79]
    ds_read_b64_tr_b16 a[90:91], v4 offset:44256
    v_mfma_f32_16x16x32_bf16 v[44:47], a[60:63], v[100:103], v[44:47]
    ds_read_b64_tr_b16 a[92:93], v5 offset:43520
    ds_read_b64_tr_b16 a[94:95], v5 offset:44288
    v_mfma_f32_16x16x32_bf16 v[48:51], a[64:67], v[100:103], v[48:51]
    buffer_load_dwordx4 v7, s[12:15], s46 offen offset:2048 lds
    s_waitcnt lgkmcnt(7)
    v_mfma_f32_16x16x32_bf16 v[52:55], a[68:71], v[100:103], v[52:55]
    ds_read_b128 v[144:147], v3 offset:4160
    v_mfma_f32_16x16x32_bf16 v[64:67], a[68:71], v[136:139], v[64:67]
    ds_read_b128 v[180:183], v3 offset:8256
    ds_read_b128 v[112:115], v3 offset:128
    v_mfma_f32_16x16x32_bf16 v[60:63], a[64:67], v[136:139], v[60:63]
    s_add_u32 m0, s44, 6208
    s_mov_b32 s46, 98304
    ds_read_b64_tr_b16 a[96:97], v4 offset:49664
    v_mfma_f32_16x16x32_bf16 v[56:59], a[60:63], v[136:139], v[56:59]
    buffer_load_dwordx4 v7, s[12:15], s46 offen offset:0 lds
    v_mfma_f32_16x16x32_bf16 v[68:71], a[60:63], v[172:175], v[68:71]
    ds_read_b64_tr_b16 a[98:99], v4 offset:50432
    v_mfma_f32_16x16x32_bf16 v[72:75], a[64:67], v[172:175], v[72:75]
    ds_read_b64_tr_b16 a[100:101], v4 offset:49696
    v_mfma_f32_16x16x32_bf16 v[76:79], a[68:71], v[172:175], v[76:79]
    ds_read_b64_tr_b16 a[102:103], v4 offset:50464
    s_waitcnt vmcnt(7)
    s_barrier
    v_mfma_f32_16x16x32_bf16 v[44:47], a[72:75], v[104:107], v[44:47]
    ds_read_b64_tr_b16 a[104:105], v5 offset:49728
    v_mfma_f32_16x16x32_bf16 v[48:51], a[76:79], v[104:107], v[48:51]
    ds_read_b64_tr_b16 a[106:107], v5 offset:50496
    v_mfma_f32_16x16x32_bf16 v[52:55], a[80:83], v[104:107], v[52:55]
    ds_read_b128 v[148:151], v3 offset:4224
    ds_read_b128 v[184:187], v3 offset:8320
    v_mfma_f32_16x16x32_bf16 v[64:67], a[80:83], v[140:143], v[64:67]
    buffer_load_dwordx4 v7, s[12:15], s46 offen offset:1024 lds
    v_mfma_f32_16x16x32_bf16 v[60:63], a[76:79], v[140:143], v[60:63]
    v_add_u32 v4, 55872, v4
    v_add_u32 v5, 55872, v5
    v_mfma_f32_16x16x32_bf16 v[56:59], a[72:75], v[140:143], v[56:59]
    ds_read_b64_tr_b16 a[108:109], v4 offset:0
    v_mfma_f32_16x16x32_bf16 v[68:71], a[72:75], v[176:179], v[68:71]
    buffer_load_dwordx4 v7, s[12:15], s46 offen offset:2048 lds
    v_mfma_f32_16x16x32_bf16 v[72:75], a[76:79], v[176:179], v[72:75]
    ds_read_b64_tr_b16 a[110:111], v4 offset:768
    v_mfma_f32_16x16x32_bf16 v[76:79], a[80:83], v[176:179], v[76:79]
    ds_read_b64_tr_b16 a[112:113], v4 offset:32
    s_waitcnt lgkmcnt(7)
    v_mfma_f32_16x16x32_bf16 v[44:47], a[84:87], v[108:111], v[44:47]
    s_add_u32 m0, s33, 16384
    ds_read_b64_tr_b16 a[114:115], v4 offset:800
    v_mfma_f32_16x16x32_bf16 v[48:51], a[88:91], v[108:111], v[48:51]
    buffer_load_dwordx4 v8, s[4:7], s60 offen lds
    v_mfma_f32_16x16x32_bf16 v[52:55], a[92:95], v[108:111], v[52:55]
    ds_read_b64_tr_b16 a[116:117], v5 offset:64
    v_mfma_f32_16x16x32_bf16 v[64:67], a[92:95], v[144:147], v[64:67]
    ds_read_b64_tr_b16 a[118:119], v5 offset:832
    v_mfma_f32_16x16x32_bf16 v[60:63], a[88:91], v[144:147], v[60:63]
    ds_read_b128 v[80:83], v1 offset:12288
    v_mfma_f32_16x16x32_bf16 v[56:59], a[84:87], v[144:147], v[56:59]
    s_add_u32 m0, s33, 45056
    ds_read_b64_tr_b16 a[120:121], v4 offset:6208
    v_mfma_f32_16x16x32_bf16 v[68:71], a[84:87], v[180:183], v[68:71]
    buffer_load_dwordx4 v8, s[4:7], s67 offen lds
    v_mfma_f32_16x16x32_bf16 v[72:75], a[88:91], v[180:183], v[72:75]
    ds_read_b64_tr_b16 a[122:123], v4 offset:6976
    v_mfma_f32_16x16x32_bf16 v[76:79], a[92:95], v[180:183], v[76:79]
    ds_read_b64_tr_b16 a[124:125], v4 offset:6240
    ds_read_b64_tr_b16 a[126:127], v4 offset:7008
    v_mfma_f32_16x16x32_bf16 v[44:47], a[96:99], v[112:115], v[44:47]
    s_add_u32 m0, s44, 18624
    s_mov_b32 s46, 110592
    v_mfma_f32_16x16x32_bf16 v[48:51], a[100:103], v[112:115], v[48:51]
    buffer_load_dwordx4 v7, s[12:15], s46 offen offset:0 lds
    s_waitcnt lgkmcnt(7)
    v_mfma_f32_16x16x32_bf16 v[52:55], a[104:107], v[112:115], v[52:55]
    ds_read_b64_tr_b16 a[128:129], v5 offset:6272
    v_mfma_f32_16x16x32_bf16 v[64:67], a[104:107], v[148:151], v[64:67]
    ds_read_b64_tr_b16 a[130:131], v5 offset:7040
    v_mfma_f32_16x16x32_bf16 v[60:63], a[100:103], v[148:151], v[60:63]
    ds_read_b128 v[84:87], v1 offset:12352
    ds_read_b64_tr_b16 a[132:133], v4 offset:12416
    v_mfma_f32_16x16x32_bf16 v[56:59], a[96:99], v[148:151], v[56:59]
    buffer_load_dwordx4 v7, s[12:15], s46 offen offset:1024 lds
    v_mfma_f32_16x16x32_bf16 v[68:71], a[96:99], v[184:187], v[68:71]
    ds_read_b64_tr_b16 a[134:135], v4 offset:13184
    v_mfma_f32_16x16x32_bf16 v[72:75], a[100:103], v[184:187], v[72:75]
    ds_read_b64_tr_b16 a[136:137], v4 offset:12448
    v_mfma_f32_16x16x32_bf16 v[76:79], a[104:107], v[184:187], v[76:79]
    ds_read_b64_tr_b16 a[138:139], v4 offset:13216
    s_waitcnt vmcnt(7)
    s_barrier
    v_mfma_f32_16x16x32_bf16 v[44:47], a[108:111], v[116:119], v[44:47]
    ds_read_b64_tr_b16 a[140:141], v5 offset:12480
    v_mfma_f32_16x16x32_bf16 v[48:51], a[112:115], v[116:119], v[48:51]
    ds_read_b64_tr_b16 a[142:143], v5 offset:13248
    s_waitcnt lgkmcnt(7)
    v_mfma_f32_16x16x32_bf16 v[52:55], a[116:119], v[116:119], v[52:55]
    ds_read_b128 v[88:91], v1 offset:12416
    v_mfma_f32_16x16x32_bf16 v[64:67], a[116:119], v[152:155], v[64:67]
    buffer_load_dwordx4 v7, s[12:15], s46 offen offset:2048 lds
    v_mfma_f32_16x16x32_bf16 v[60:63], a[112:115], v[152:155], v[60:63]
    ds_read_b64_tr_b16 a[144:145], v4 offset:18624
    ds_read_b64_tr_b16 a[146:147], v4 offset:19392
    v_mfma_f32_16x16x32_bf16 v[56:59], a[108:111], v[152:155], v[56:59]
    s_add_u32 m0, s44, 31040
    s_mov_b32 s46, 122880
    v_mfma_f32_16x16x32_bf16 v[68:71], a[108:111], v[80:83], v[68:71]
    buffer_load_dwordx4 v7, s[12:15], s46 offen offset:0 lds
    s_branch L_N2_s0
L_N2_t0:
    s_setpc_b64 s[78:79]
L_N2_s0:
    v_mfma_f32_16x16x32_bf16 v[72:75], a[112:115], v[80:83], v[72:75]
    ds_read_b64_tr_b16 a[148:149], v4 offset:18656
    v_mfma_f32_16x16x32_bf16 v[76:79], a[116:119], v[80:83], v[76:79]
    ds_read_b64_tr_b16 a[150:151], v4 offset:19424
    v_mfma_f32_16x16x32_bf16 v[44:47], a[120:123], v[120:123], v[44:47]
    ds_read_b64_tr_b16 a[152:153], v5 offset:18688
    v_mfma_f32_16x16x32_bf16 v[48:51], a[124:127], v[120:123], v[48:51]
    buffer_load_dwordx4 v7, s[12:15], s46 offen offset:1024 lds
    v_mfma_f32_16x16x32_bf16 v[52:55], a[128:131], v[120:123], v[52:55]
    ds_read_b64_tr_b16 a[154:155], v5 offset:19456
    v_mfma_f32_16x16x32_bf16 v[64:67], a[128:131], v[156:159], v[64:67]
    ds_read_b128 v[92:95], v2 offset:12288
    v_mfma_f32_16x16x32_bf16 v[60:63], a[124:127], v[156:159], v[60:63]
    ds_read_b64_tr_b16 a[156:157], v4 offset:24832
    v_mfma_f32_16x16x32_bf16 v[56:59], a[120:123], v[156:159], v[56:59]
    ds_read_b64_tr_b16 a[158:159], v4 offset:25600
    s_waitcnt lgkmcnt(7)
    v_mfma_f32_16x16x32_bf16 v[68:71], a[120:123], v[84:87], v[68:71]
    buffer_load_dwordx4 v7, s[12:15], s46 offen offset:2048 lds
    v_mfma_f32_16x16x32_bf16 v[72:75], a[124:127], v[84:87], v[72:75]
    ds_read_b64_tr_b16 a[160:161], v4 offset:24864
    v_mfma_f32_16x16x32_bf16 v[76:79], a[128:131], v[84:87], v[76:79]
    ds_read_b64_tr_b16 a[162:163], v4 offset:25632
    ds_read_b64_tr_b16 a[164:165], v5 offset:24896
    v_mfma_f32_16x16x32_bf16 v[44:47], a[132:135], v[124:127], v[44:47]
    s_add_u32 m0, s44, 43456
    s_mov_b32 s46, 135168
    v_mfma_f32_16x16x32_bf16 v[48:51], a[136:139], v[124:127], v[48:51]
    buffer_load_dwordx4 v7, s[12:15], s46 offen offset:0 lds
    v_mfma_f32_16x16x32_bf16 v[52:55], a[140:143], v[124:127], v[52:55]
    ds_read_b64_tr_b16 a[166:167], v5 offset:25664
    v_mfma_f32_16x16x32_bf16 v[64:67], a[140:143], v[160:163], v[64:67]
    ds_read_b128 v[96:99], v2 offset:12352
    v_mfma_f32_16x16x32_bf16 v[60:63], a[136:139], v[160:163], v[60:63]
    ds_read_b64_tr_b16 a[168:169], v4 offset:31040
    v_mfma_f32_16x16x32_bf16 v[56:59], a[132:135], v[160:163], v[56:59]
    buffer_load_dwordx4 v7, s[12:15], s46 offen offset:1024 lds
    v_mfma_f32_16x16x32_bf16 v[68:71], a[132:135], v[88:91], v[68:71]
    ds_read_b64_tr_b16 a[170:171], v4 offset:31808
    v_mfma_f32_16x16x32_bf16 v[72:75], a[136:139], v[88:91], v[72:75]
    ds_read_b64_tr_b16 a[172:173], v4 offset:31072
    v_mfma_f32_16x16x32_bf16 v[76:79], a[140:143], v[88:91], v[76:79]
    ds_read_b64_tr_b16 a[174:175], v4 offset:31840
    s_waitcnt vmcnt(10)
    s_barrier
    v_mfma_f32_16x16x32_bf16 v[44:47], a[144:147], v[128:131], v[44:47]
    ds_read_b64_tr_b16 a[176:177], v5 offset:31104
    s_waitcnt lgkmcnt(7)
    v_mfma_f32_16x16x32_bf16 v[48:51], a[148:151], v[128:131], v[48:51]
    ds_read_b64_tr_b16 a[178:179], v5 offset:31872
    v_mfma_f32_16x16x32_bf16 v[52:55], a[152:155], v[128:131], v[52:55]
    ds_read_b128 v[100:103], v2 offset:12416
    v_mfma_f32_16x16x32_bf16 v[64:67], a[152:155], v[164:167], v[64:67]
    buffer_load_dwordx4 v7, s[12:15], s46 offen offset:2048 lds
    v_mfma_f32_16x16x32_bf16 v[60:63], a[148:151], v[164:167], v[60:63]
    v_add_u32 v4, -55872, v4
    v_add_u32 v5, -55872, v5
    v_mfma_f32_16x16x32_bf16 v[56:59], a[144:147], v[164:167], v[56:59]
    ds_read_b64_tr_b16 a[180:181], v4 offset:0
    v_mfma_f32_16x16x32_bf16 v[68:71], a[144:147], v[92:95], v[68:71]
    ds_read_b64_tr_b16 a[182:183], v4 offset:768
    v_mfma_f32_16x16x32_bf16 v[72:75], a[148:151], v[92:95], v[72:75]
    ds_read_b64_tr_b16 a[184:185], v4 offset:32
    v_mfma_f32_16x16x32_bf16 v[76:79], a[152:155], v[92:95], v[76:79]
    s_add_u32 m0, s44, 55872
    s_mov_b32 s46, 147456
    v_mfma_f32_16x16x32_bf16 v[44:47], a[156:159], v[132:135], v[44:47]
    buffer_load_dwordx4 v7, s[12:15], s46 offen offset:0 lds
    v_mfma_f32_16x16x32_bf16 v[48:51], a[160:163], v[132:135], v[48:51]
    ds_read_b64_tr_b16 a[186:187], v4 offset:800
    s_waitcnt lgkmcnt(7)
    v_mfma_f32_16x16x32_bf16 v[52:55], a[164:167], v[132:135], v[52:55]
    ds_read_b64_tr_b16 a[188:189], v5 offset:64
    v_mfma_f32_16x16x32_bf16 v[64:67], a[164:167], v[168:171], v[64:67]
    ds_read_b64_tr_b16 a[190:191], v5 offset:832
    v_mfma_f32_16x16x32_bf16 v[60:63], a[160:163], v[168:171], v[60:63]
    ds_read_b128 v[104:107], v3 offset:12288
    v_mfma_f32_16x16x32_bf16 v[56:59], a[156:159], v[168:171], v[56:59]
    ds_read_b64_tr_b16 a[192:193], v4 offset:6208
    v_mfma_f32_16x16x32_bf16 v[68:71], a[156:159], v[96:99], v[68:71]
    ds_read_b64_tr_b16 a[194:195], v4 offset:6976
    v_mfma_f32_16x16x32_bf16 v[72:75], a[160:163], v[96:99], v[72:75]
    buffer_load_dwordx4 v7, s[12:15], s46 offen offset:1024 lds
    v_mfma_f32_16x16x32_bf16 v[76:79], a[164:167], v[96:99], v[76:79]
    ds_read_b64_tr_b16 a[196:197], v4 offset:6240
    v_mfma_f32_16x16x32_bf16 v[44:47], a[168:171], v[136:139], v[44:47]
    ds_read_b64_tr_b16 a[198:199], v4 offset:7008
    v_mfma_f32_16x16x32_bf16 v[48:51], a[172:175], v[136:139], v[48:51]
    ds_read_b64_tr_b16 a[200:201], v5 offset:6272
    s_waitcnt lgkmcnt(7)
    v_mfma_f32_16x16x32_bf16 v[52:55], a[176:179], v[136:139], v[52:55]
    ds_read_b64_tr_b16 a[202:203], v5 offset:7040
    v_mfma_f32_16x16x32_bf16 v[64:67], a[176:179], v[172:175], v[64:67]
    ds_read_b128 v[108:111], v3 offset:12352
    v_mfma_f32_16x16x32_bf16 v[60:63], a[172:175], v[172:175], v[60:63]
    buffer_load_dwordx4 v7, s[12:15], s46 offen offset:2048 lds
    v_mfma_f32_16x16x32_bf16 v[56:59], a[168:171], v[172:175], v[56:59]
    ds_read_b64_tr_b16 a[204:205], v4 offset:12416
    v_mfma_f32_16x16x32_bf16 v[68:71], a[168:171], v[100:103], v[68:71]
    ds_read_b64_tr_b16 a[206:207], v4 offset:13184
    v_mfma_f32_16x16x32_bf16 v[72:75], a[172:175], v[100:103], v[72:75]
    ds_read_b64_tr_b16 a[208:209], v4 offset:12448
    v_mfma_f32_16x16x32_bf16 v[76:79], a[176:179], v[100:103], v[76:79]
    ds_read_b64_tr_b16 a[210:211], v4 offset:13216
    s_waitcnt vmcnt(6)
    s_barrier
    v_mfma_f32_16x16x32_bf16 v[44:47], a[180:183], v[140:143], v[44:47]
    ds_read_b64_tr_b16 a[212:213], v5 offset:12480
    v_mfma_f32_16x16x32_bf16 v[48:51], a[184:187], v[140:143], v[48:51]
    ds_read_b64_tr_b16 a[214:215], v5 offset:13248
    s_waitcnt lgkmcnt(7)
    v_mfma_f32_16x16x32_bf16 v[52:55], a[188:191], v[140:143], v[52:55]
    ds_read_b128 v[112:115], v3 offset:12416
    s_add_u32 m0, s44, 68288
    s_mov_b32 s46, 159744
    v_mfma_f32_16x16x32_bf16 v[64:67], a[188:191], v[176:179], v[64:67]
    buffer_load_dwordx4 v7, s[12:15], s46 offen offset:0 lds
    v_mfma_f32_16x16x32_bf16 v[60:63], a[184:187], v[176:179], v[60:63]
    ds_read_b64_tr_b16 a[216:217], v4 offset:18624
    v_mfma_f32_16x16x32_bf16 v[56:59], a[180:183], v[176:179], v[56:59]
    ds_read_b64_tr_b16 a[218:219], v4 offset:19392
    v_mfma_f32_16x16x32_bf16 v[68:71], a[180:183], v[104:107], v[68:71]
    ds_read_b64_tr_b16 a[220:221], v4 offset:18656
    v_mfma_f32_16x16x32_bf16 v[72:75], a[184:187], v[104:107], v[72:75]
    buffer_load_dwordx4 v7, s[12:15], s46 offen offset:1024 lds
    v_mfma_f32_16x16x32_bf16 v[76:79], a[188:191], v[104:107], v[76:79]
    ds_read_b64_tr_b16 a[222:223], v4 offset:19424
    v_mfma_f32_16x16x32_bf16 v[44:47], a[192:195], v[144:147], v[44:47]
    ds_read_b64_tr_b16 a[224:225], v5 offset:18688
    v_mfma_f32_16x16x32_bf16 v[48:51], a[196:199], v[144:147], v[48:51]
    ds_read_b64_tr_b16 a[226:227], v5 offset:19456
    v_mfma_f32_16x16x32_bf16 v[52:55], a[200:203], v[144:147], v[52:55]
    ds_read_b128 v[116:119], v1 offset:16384
    v_mfma_f32_16x16x32_bf16 v[64:67], a[200:203], v[180:183], v[64:67]
    ds_read_b64_tr_b16 a[228:229], v4 offset:24832
    v_mfma_f32_16x16x32_bf16 v[60:63], a[196:199], v[180:183], v[60:63]
    buffer_load_dwordx4 v7, s[12:15], s46 offen offset:2048 lds
    v_mfma_f32_16x16x32_bf16 v[56:59], a[192:195], v[180:183], v[56:59]
    ds_read_b64_tr_b16 a[230:231], v4 offset:25600
    s_waitcnt lgkmcnt(7)
    v_mfma_f32_16x16x32_bf16 v[68:71], a[192:195], v[108:111], v[68:71]
    ds_read_b64_tr_b16 a[232:233], v4 offset:24864
    v_mfma_f32_16x16x32_bf16 v[72:75], a[196:199], v[108:111], v[72:75]
    ds_read_b64_tr_b16 a[234:235], v4 offset:25632
    v_mfma_f32_16x16x32_bf16 v[76:79], a[200:203], v[108:111], v[76:79]
    s_add_u32 m0, s33, 20480
    v_mfma_f32_16x16x32_bf16 v[44:47], a[204:207], v[148:151], v[44:47]
    buffer_load_dwordx4 v8, s[4:7], s61 offen lds
    v_mfma_f32_16x16x32_bf16 v[48:51], a[208:211], v[148:151], v[48:51]
    ds_read_b64_tr_b16 a[236:237], v5 offset:24896
    v_mfma_f32_16x16x32_bf16 v[52:55], a[212:215], v[148:151], v[52:55]
    ds_read_b64_tr_b16 a[238:239], v5 offset:25664
    v_mfma_f32_16x16x32_bf16 v[64:67], a[212:215], v[184:187], v[64:67]
    ds_read_b128 v[120:123], v1 offset:16448
    v_mfma_f32_16x16x32_bf16 v[60:63], a[208:211], v[184:187], v[60:63]
    s_add_u32 m0, s33, 49152
    ds_read_b64_tr_b16 a[240:241], v4 offset:31040
    v_mfma_f32_16x16x32_bf16 v[56:59], a[204:207], v[184:187], v[56:59]
    buffer_load_dwordx4 v8, s[4:7], s68 offen lds
    v_mfma_f32_16x16x32_bf16 v[68:71], a[204:207], v[112:115], v[68:71]
    ds_read_b64_tr_b16 a[242:243], v4 offset:31808
    v_mfma_f32_16x16x32_bf16 v[72:75], a[208:211], v[112:115], v[72:75]
    ds_read_b64_tr_b16 a[244:245], v4 offset:31072
    v_mfma_f32_16x16x32_bf16 v[76:79], a[212:215], v[112:115], v[76:79]
    ds_read_b64_tr_b16 a[246:247], v4 offset:31840
    s_waitcnt vmcnt(8)
    s_barrier
    v_mfma_f32_16x16x32_bf16 v[44:47], a[216:219], v[152:155], v[44:47]
    ds_read_b64_tr_b16 a[248:249], v5 offset:31104
    s_waitcnt lgkmcnt(7)
    v_mfma_f32_16x16x32_bf16 v[48:51], a[220:223], v[152:155], v[48:51]
    ds_read_b64_tr_b16 a[250:251], v5 offset:31872
    v_mfma_f32_16x16x32_bf16 v[52:55], a[224:227], v[152:155], v[52:55]
    ds_read_b128 v[124:127], v1 offset:16512
    s_add_u32 m0, s33, 24576
    v_mfma_f32_16x16x32_bf16 v[64:67], a[224:227], v[80:83], v[64:67]
    buffer_load_dwordx4 v8, s[4:7], s62 offen lds
    v_mfma_f32_16x16x32_bf16 v[60:63], a[220:223], v[80:83], v[60:63]
    ds_read_b64_tr_b16 a[252:253], v4 offset:37248
    v_mfma_f32_16x16x32_bf16 v[56:59], a[216:219], v[80:83], v[56:59]
    ds_read_b64_tr_b16 a[254:255], v4 offset:38016
    v_mfma_f32_16x16x32_bf16 v[68:71], a[216:219], v[116:119], v[68:71]
    ds_read_b64_tr_b16 v[188:189], v4 offset:37280
    v_mfma_f32_16x16x32_bf16 v[72:75], a[220:223], v[116:119], v[72:75]
    ds_read_b64_tr_b16 v[190:191], v4 offset:38048
    v_mfma_f32_16x16x32_bf16 v[76:79], a[224:227], v[116:119], v[76:79]
    s_add_u32 m0, s33, 53248
    v_mfma_f32_16x16x32_bf16 v[44:47], a[228:231], v[156:159], v[44:47]
    buffer_load_dwordx4 v8, s[4:7], s69 offen lds
    v_mfma_f32_16x16x32_bf16 v[48:51], a[232:235], v[156:159], v[48:51]
    ds_read_b64_tr_b16 v[192:193], v5 offset:37312
    s_waitcnt lgkmcnt(7)
    v_mfma_f32_16x16x32_bf16 v[52:55], a[236:239], v[156:159], v[52:55]
    ds_read_b64_tr_b16 v[194:195], v5 offset:38080
    v_mfma_f32_16x16x32_bf16 v[64:67], a[236:239], v[84:87], v[64:67]
    ds_read_b128 v[128:131], v2 offset:16384
    v_mfma_f32_16x16x32_bf16 v[60:63], a[232:235], v[84:87], v[60:63]
    ds_read_b64_tr_b16 v[196:197], v4 offset:43456
    v_mfma_f32_16x16x32_bf16 v[56:59], a[228:231], v[84:87], v[56:59]
    ds_read_b64_tr_b16 v[198:199], v4 offset:44224
    v_mfma_f32_16x16x32_bf16 v[68:71], a[228:231], v[120:123], v[68:71]
    s_add_u32 m0, s33, 57344
    ds_read_b64_tr_b16 v[200:201], v4 offset:43488
    v_mfma_f32_16x16x32_bf16 v[72:75], a[232:235], v[120:123], v[72:75]
    buffer_load_dwordx4 v8, s[4:7], s70 offen lds
    v_mfma_f32_16x16x32_bf16 v[76:79], a[236:239], v[120:123], v[76:79]
    ds_read_b64_tr_b16 v[202:203], v4 offset:44256
    v_mfma_f32_16x16x32_bf16 v[44:47], a[240:243], v[160:163], v[44:47]
    ds_read_b64_tr_b16 v[204:205], v5 offset:43520
    v_mfma_f32_16x16x32_bf16 v[48:51], a[244:247], v[160:163], v[48:51]
    ds_read_b64_tr_b16 v[206:207], v5 offset:44288
    s_waitcnt lgkmcnt(7)
    v_mfma_f32_16x16x32_bf16 v[52:55], a[248:251], v[160:163], v[52:55]
    ds_read_b128 v[132:135], v2 offset:16448
    v_mfma_f32_16x16x32_bf16 v[64:67], a[248:251], v[88:91], v[64:67]
    s_add_u32 m0, s33, 61440
    v_mfma_f32_16x16x32_bf16 v[60:63], a[244:247], v[88:91], v[60:63]
    buffer_load_dwordx4 v8, s[4:7], s71 offen lds
    v_mfma_f32_16x16x32_bf16 v[56:59], a[240:243], v[88:91], v[56:59]
    ds_read_b64_tr_b16 v[208:209], v4 offset:49664
    v_mfma_f32_16x16x32_bf16 v[68:71], a[240:243], v[124:127], v[68:71]
    ds_read_b64_tr_b16 v[210:211], v4 offset:50432
    v_mfma_f32_16x16x32_bf16 v[72:75], a[244:247], v[124:127], v[72:75]
    ds_read_b64_tr_b16 v[212:213], v4 offset:49696
    v_mfma_f32_16x16x32_bf16 v[76:79], a[248:251], v[124:127], v[76:79]
    ds_read_b64_tr_b16 v[214:215], v4 offset:50464
    s_waitcnt vmcnt(6)
    s_barrier
    v_mfma_f32_16x16x32_bf16 v[44:47], a[252:255], v[164:167], v[44:47]
    ds_read_b64_tr_b16 v[216:217], v5 offset:49728
    v_mfma_f32_16x16x32_bf16 v[48:51], v[188:191], v[164:167], v[48:51]
    ds_read_b64_tr_b16 v[218:219], v5 offset:50496
    v_mfma_f32_16x16x32_bf16 v[52:55], v[192:195], v[164:167], v[52:55]
    ds_read_b128 v[136:139], v2 offset:16512
    v_mfma_f32_16x16x32_bf16 v[64:67], v[192:195], v[92:95], v[64:67]
    v_add_u32 v4, 55872, v4
    v_add_u32 v5, 55872, v5
    v_mfma_f32_16x16x32_bf16 v[60:63], v[188:191], v[92:95], v[60:63]
    ds_read_b64_tr_b16 v[220:221], v4 offset:0
    v_mfma_f32_16x16x32_bf16 v[56:59], a[252:255], v[92:95], v[56:59]
    ds_read_b64_tr_b16 v[222:223], v4 offset:768
    buffer_load_dwordx4 v[16:19], v14, s[8:11], s32 offen offset:0
    s_waitcnt lgkmcnt(7)
    v_mfma_f32_16x16x32_bf16 v[68:71], a[252:255], v[128:131], v[68:71]
    ds_read_b64_tr_b16 v[224:225], v4 offset:32
    v_mfma_f32_16x16x32_bf16 v[72:75], v[188:191], v[128:131], v[72:75]
    ds_read_b64_tr_b16 v[226:227], v4 offset:800
    v_mfma_f32_16x16x32_bf16 v[76:79], v[192:195], v[128:131], v[76:79]
    ds_read_b64_tr_b16 v[228:229], v5 offset:64
    buffer_load_dwordx4 v[20:23], v14, s[8:11], s32 offen offset:144
    v_mfma_f32_16x16x32_bf16 v[44:47], v[196:199], v[168:171], v[44:47]
    ds_read_b64_tr_b16 v[230:231], v5 offset:832
    v_mfma_f32_16x16x32_bf16 v[48:51], v[200:203], v[168:171], v[48:51]
    ds_read_b128 v[140:143], v3 offset:16384
    v_mfma_f32_16x16x32_bf16 v[52:55], v[204:207], v[168:171], v[52:55]
    ds_read_b64_tr_b16 v[232:233], v4 offset:6208
    buffer_load_dwordx4 v[24:27], v14, s[8:11], s32 offen offset:288
    v_mfma_f32_16x16x32_bf16 v[64:67], v[204:207], v[96:99], v[64:67]
    ds_read_b64_tr_b16 v[234:235], v4 offset:6976
    v_mfma_f32_16x16x32_bf16 v[60:63], v[200:203], v[96:99], v[60:63]
    ds_read_b64_tr_b16 v[236:237], v4 offset:6240
    v_mfma_f32_16x16x32_bf16 v[56:59], v[196:199], v[96:99], v[56:59]
    ds_read_b64_tr_b16 v[238:239], v4 offset:7008
    buffer_load_dwordx4 v[28:31], v14, s[8:11], s32 offen offset:432
    v_mfma_f32_16x16x32_bf16 v[68:71], v[196:199], v[132:135], v[68:71]
    ds_read_b64_tr_b16 v[240:241], v5 offset:6272
    v_mfma_f32_16x16x32_bf16 v[72:75], v[200:203], v[132:135], v[72:75]
    ds_read_b64_tr_b16 v[242:243], v5 offset:7040
    v_mfma_f32_16x16x32_bf16 v[76:79], v[204:207], v[132:135], v[76:79]
    ds_read_b128 v[144:147], v3 offset:16448
    v_mfma_f32_16x16x32_bf16 v[44:47], v[208:211], v[172:175], v[44:47]
    ds_read_b64_tr_b16 v[244:245], v4 offset:12416
    s_waitcnt lgkmcnt(7)
    v_mfma_f32_16x16x32_bf16 v[48:51], v[212:215], v[172:175], v[48:51]
    ds_read_b64_tr_b16 v[246:247], v4 offset:13184
    v_mfma_f32_16x16x32_bf16 v[52:55], v[216:219], v[172:175], v[52:55]
    ds_read_b64_tr_b16 v[248:249], v4 offset:12448
    v_mfma_f32_16x16x32_bf16 v[64:67], v[216:219], v[100:103], v[64:67]
    ds_read_b64_tr_b16 v[250:251], v4 offset:13216
    v_mfma_f32_16x16x32_bf16 v[60:63], v[212:215], v[100:103], v[60:63]
    ds_read_b64_tr_b16 v[252:253], v5 offset:12480
    v_mfma_f32_16x16x32_bf16 v[56:59], v[208:211], v[100:103], v[56:59]
    ds_read_b64_tr_b16 v[254:255], v5 offset:13248
    ds_read_b128 v[148:151], v3 offset:16512
    v_mfma_f32_16x16x32_bf16 v[68:71], v[208:211], v[136:139], v[68:71]
    v_mfma_f32_16x16x32_bf16 v[72:75], v[212:215], v[136:139], v[72:75]
    v_mfma_f32_16x16x32_bf16 v[76:79], v[216:219], v[136:139], v[76:79]
    v_mfma_f32_16x16x32_bf16 v[44:47], v[220:223], v[176:179], v[44:47]
    s_mul_i32 s47, s30, 8064
    s_lshl_b32 s48, s29, 3
    v_mfma_f32_16x16x32_bf16 v[48:51], v[224:227], v[176:179], v[48:51]
    v_bfe_u32 v38, v6, 4, 2
    v_bfe_u32 v39, v6, 6, 2
    v_mfma_f32_16x16x32_bf16 v[52:55], v[228:231], v[176:179], v[52:55]
    v_lshl_add_u32 v38, v38, 2, v39
    s_add_u32 s47, s47, 65536
    s_waitcnt lgkmcnt(7)
    v_mfma_f32_16x16x32_bf16 v[52:55], v[240:243], v[180:183], v[52:55]
    v_lshrrev_b32 v39, 8, v6
    v_mul_u32_u24 v10, 72, v38
    v_mfma_f32_16x16x32_bf16 v[48:51], v[236:239], v[180:183], v[48:51]
    v_mul_u32_u24 v9, 192, v38
    s_lshl2_add_u32 s49, s48, s47
    v_mfma_f32_16x16x32_bf16 v[44:47], v[232:235], v[180:183], v[44:47]
    v_lshl_add_u32 v10, v39, 3, v10
    v_and_b32 v38, 1, v39
    s_waitcnt lgkmcnt(5)
    v_mfma_f32_16x16x32_bf16 v[44:47], v[244:247], v[184:187], v[44:47]
    v_lshrrev_b32 v39, 1, v39
    v_add_u32 v10, s49, v10
    s_waitcnt lgkmcnt(3)
    v_mfma_f32_16x16x32_bf16 v[48:51], v[248:251], v[184:187], v[48:51]
    v_lshl_add_u32 v38, v38, 1, v39
    v_lshrrev_b32 v39, 7, v6
    s_waitcnt lgkmcnt(1)
    v_mfma_f32_16x16x32_bf16 v[52:55], v[252:255], v[184:187], v[52:55]
    v_add_u32 v38, s48, v38
    v_add_u32 v39, s48, v39
    v_mfma_f32_16x16x32_bf16 v[56:59], v[220:223], v[104:107], v[56:59]
    v_lshl_add_u32 v9, v38, 4, v9
    v_bfe_u32 v38, v6, 1, 6
    v_mfma_f32_16x16x32_bf16 v[60:63], v[224:227], v[104:107], v[60:63]
    v_mul_u32_u24 v4, 72, v39
    v_mul_u32_u24 v5, 192, v39
    v_mfma_f32_16x16x32_bf16 v[64:67], v[228:231], v[104:107], v[64:67]
    v_add3_u32 v4, v4, s47, v38
    v_add3_u32 v5, v5, 64, v38
    v_mfma_f32_16x16x32_bf16 v[64:67], v[240:243], v[108:111], v[64:67]
    s_mov_b32 s46, s31
    v_mfma_f32_16x16x32_bf16 v[60:63], v[236:239], v[108:111], v[60:63]
    v_mfma_f32_16x16x32_bf16 v[56:59], v[232:235], v[108:111], v[56:59]
    v_mfma_f32_16x16x32_bf16 v[56:59], v[244:247], v[112:115], v[56:59]
    v_mfma_f32_16x16x32_bf16 v[60:63], v[248:251], v[112:115], v[60:63]
    v_cvt_pk_bf16_f32 v32, v44, v45
    v_cvt_pk_bf16_f32 v33, v46, v47
    v_mfma_f32_16x16x32_bf16 v[64:67], v[252:255], v[112:115], v[64:67]
    v_cvt_pk_bf16_f32 v34, v48, v49
    v_cvt_pk_bf16_f32 v35, v50, v51
    v_mfma_f32_16x16x32_bf16 v[68:71], v[220:223], v[140:143], v[68:71]
    v_cvt_pk_bf16_f32 v36, v52, v53
    v_cvt_pk_bf16_f32 v37, v54, v55
    v_mfma_f32_16x16x32_bf16 v[72:75], v[224:227], v[140:143], v[72:75]
    v_permlane16_swap_b32 v32, v34
    v_permlane16_swap_b32 v33, v35
    v_mfma_f32_16x16x32_bf16 v[76:79], v[228:231], v[140:143], v[76:79]
    ds_write_b64 v10, v[36:37] offset:0
    v_mfma_f32_16x16x32_bf16 v[76:79], v[240:243], v[144:147], v[76:79]
    buffer_store_dwordx4 v[32:35], v9, s[16:19], s31 offen sc1
    s_add_u32 s31, s31, 43008
    v_mfma_f32_16x16x32_bf16 v[72:75], v[236:239], v[144:147], v[72:75]
    v_mfma_f32_16x16x32_bf16 v[68:71], v[232:235], v[144:147], v[68:71]
    s_waitcnt lgkmcnt(1)
    v_mfma_f32_16x16x32_bf16 v[68:71], v[244:247], v[148:151], v[68:71]
    v_mfma_f32_16x16x32_bf16 v[72:75], v[248:251], v[148:151], v[72:75]
    v_mfma_f32_16x16x32_bf16 v[76:79], v[252:255], v[148:151], v[76:79]
    v_mfma_f32_16x16x32_bf16 v[44:47], a[0:3], v[80:83], 0
    v_mfma_f32_16x16x32_bf16 v[48:51], a[4:7], v[80:83], 0
    v_mfma_f32_16x16x32_bf16 v[52:55], a[8:11], v[80:83], 0
    v_mfma_f32_16x16x32_bf16 v[52:55], a[20:23], v[84:87], v[52:55]
    v_mfma_f32_16x16x32_bf16 v[48:51], a[16:19], v[84:87], v[48:51]
    v_mfma_f32_16x16x32_bf16 v[44:47], a[12:15], v[84:87], v[44:47]
    v_mfma_f32_16x16x32_bf16 v[44:47], a[24:27], v[88:91], v[44:47]
    v_mfma_f32_16x16x32_bf16 v[48:51], a[28:31], v[88:91], v[48:51]
    v_mfma_f32_16x16x32_bf16 v[52:55], a[32:35], v[88:91], v[52:55]
    v_mfma_f32_16x16x32_bf16 v[44:47], a[36:39], v[92:95], v[44:47]
    v_mfma_f32_16x16x32_bf16 v[48:51], a[40:43], v[92:95], v[48:51]
    v_mfma_f32_16x16x32_bf16 v[52:55], a[44:47], v[92:95], v[52:55]
    v_mfma_f32_16x16x32_bf16 v[52:55], a[56:59], v[96:99], v[52:55]
    v_mfma_f32_16x16x32_bf16 v[48:51], a[52:55], v[96:99], v[48:51]
    v_mfma_f32_16x16x32_bf16 v[44:47], a[48:51], v[96:99], v[44:47]
    v_cvt_pk_bf16_f32 v32, v56, v57
    v_cvt_pk_bf16_f32 v33, v58, v59
    v_mfma_f32_16x16x32_bf16 v[44:47], a[60:63], v[100:103], v[44:47]
    v_cvt_pk_bf16_f32 v34, v60, v61
    v_cvt_pk_bf16_f32 v35, v62, v63
    v_mfma_f32_16x16x32_bf16 v[48:51], a[64:67], v[100:103], v[48:51]
    v_cvt_pk_bf16_f32 v36, v64, v65
    v_cvt_pk_bf16_f32 v37, v66, v67
    v_mfma_f32_16x16x32_bf16 v[52:55], a[68:71], v[100:103], v[52:55]
    v_permlane16_swap_b32 v32, v34
    v_permlane16_swap_b32 v33, v35
    v_mfma_f32_16x16x32_bf16 v[44:47], a[72:75], v[104:107], v[44:47]
    ds_write_b64 v10, v[36:37] offset:1152
    v_mfma_f32_16x16x32_bf16 v[48:51], a[76:79], v[104:107], v[48:51]
    buffer_store_dwordx4 v[32:35], v9, s[16:19], s31 offen sc1
    s_add_u32 s31, s31, 43008
    v_mfma_f32_16x16x32_bf16 v[52:55], a[80:83], v[104:107], v[52:55]
    v_mfma_f32_16x16x32_bf16 v[52:55], a[92:95], v[108:111], v[52:55]
    v_mfma_f32_16x16x32_bf16 v[48:51], a[88:91], v[108:111], v[48:51]
    v_mfma_f32_16x16x32_bf16 v[44:47], a[84:87], v[108:111], v[44:47]
    v_mfma_f32_16x16x32_bf16 v[44:47], a[96:99], v[112:115], v[44:47]
    v_mfma_f32_16x16x32_bf16 v[48:51], a[100:103], v[112:115], v[48:51]
    v_mfma_f32_16x16x32_bf16 v[52:55], a[104:107], v[112:115], v[52:55]
    v_mfma_f32_16x16x32_bf16 v[44:47], a[108:111], v[116:119], v[44:47]
    v_mfma_f32_16x16x32_bf16 v[48:51], a[112:115], v[116:119], v[48:51]
    v_mfma_f32_16x16x32_bf16 v[52:55], a[116:119], v[116:119], v[52:55]
    v_mfma_f32_16x16x32_bf16 v[52:55], a[128:131], v[120:123], v[52:55]
    v_mfma_f32_16x16x32_bf16 v[48:51], a[124:127], v[120:123], v[48:51]
    v_mfma_f32_16x16x32_bf16 v[44:47], a[120:123], v[120:123], v[44:47]
    v_mfma_f32_16x16x32_bf16 v[44:47], a[132:135], v[124:127], v[44:47]
    v_mfma_f32_16x16x32_bf16 v[48:51], a[136:139], v[124:127], v[48:51]
    v_mfma_f32_16x16x32_bf16 v[52:55], a[140:143], v[124:127], v[52:55]
    v_mfma_f32_16x16x32_bf16 v[44:47], a[144:147], v[128:131], v[44:47]
    v_mfma_f32_16x16x32_bf16 v[48:51], a[148:151], v[128:131], v[48:51]
    v_mfma_f32_16x16x32_bf16 v[52:55], a[152:155], v[128:131], v[52:55]
    s_waitcnt vmcnt(10)
    s_waitcnt lgkmcnt(0)
    s_barrier
    v_mfma_f32_16x16x32_bf16 v[52:55], a[164:167], v[132:135], v[52:55]
    ds_read_b128 v[152:155], v1 offset:20480
    v_mfma_f32_16x16x32_bf16 v[48:51], a[160:163], v[132:135], v[48:51]
    ds_read_b128 v[156:159], v1 offset:20544
    v_mfma_f32_16x16x32_bf16 v[44:47], a[156:159], v[132:135], v[44:47]
    ds_read_b128 v[160:163], v1 offset:20608
    v_mfma_f32_16x16x32_bf16 v[44:47], a[168:171], v[136:139], v[44:47]
    ds_read_b128 v[164:167], v2 offset:20480
    v_mfma_f32_16x16x32_bf16 v[48:51], a[172:175], v[136:139], v[48:51]
    ds_read_b128 v[168:171], v2 offset:20544
    v_mfma_f32_16x16x32_bf16 v[52:55], a[176:179], v[136:139], v[52:55]
    ds_read_b128 v[172:175], v2 offset:20608
    v_mfma_f32_16x16x32_bf16 v[44:47], a[180:183], v[140:143], v[44:47]
    ds_read_b128 v[176:179], v3 offset:20480
    v_mfma_f32_16x16x32_bf16 v[48:51], a[184:187], v[140:143], v[48:51]
    ds_read_b128 v[180:183], v3 offset:20544
    v_mfma_f32_16x16x32_bf16 v[52:55], a[188:191], v[140:143], v[52:55]
    ds_read_b128 v[184:187], v3 offset:20608
    v_mfma_f32_16x16x32_bf16 v[52:55], a[200:203], v[144:147], v[52:55]
    ds_read_b64 v[38:39], v4 offset:0
    v_mfma_f32_16x16x32_bf16 v[48:51], a[196:199], v[144:147], v[48:51]
    ds_read_b64 v[40:41], v4 offset:1152
    v_mfma_f32_16x16x32_bf16 v[44:47], a[192:195], v[144:147], v[44:47]
    v_mfma_f32_16x16x32_bf16 v[44:47], a[204:207], v[148:151], v[44:47]
    v_mfma_f32_16x16x32_bf16 v[48:51], a[208:211], v[148:151], v[48:51]
    v_mfma_f32_16x16x32_bf16 v[52:55], a[212:215], v[148:151], v[52:55]
    s_waitcnt lgkmcnt(7)
    v_mfma_f32_16x16x32_bf16 v[44:47], a[216:219], v[152:155], v[44:47]
    v_mfma_f32_16x16x32_bf16 v[48:51], a[220:223], v[152:155], v[48:51]
    v_mfma_f32_16x16x32_bf16 v[52:55], a[224:227], v[152:155], v[52:55]
    v_mfma_f32_16x16x32_bf16 v[52:55], a[236:239], v[156:159], v[52:55]
    s_waitcnt lgkmcnt(1)
    buffer_store_dwordx2 v[38:39], v5, s[16:19], s46 offen sc1
    s_add_u32 s46, s46, 43008
    v_mfma_f32_16x16x32_bf16 v[48:51], a[232:235], v[156:159], v[48:51]
    v_mfma_f32_16x16x32_bf16 v[44:47], a[228:231], v[156:159], v[44:47]
    v_mfma_f32_16x16x32_bf16 v[44:47], a[240:243], v[160:163], v[44:47]
    v_mfma_f32_16x16x32_bf16 v[48:51], a[244:247], v[160:163], v[48:51]
    v_mfma_f32_16x16x32_bf16 v[52:55], a[248:251], v[160:163], v[52:55]
    v_mfma_f32_16x16x32_bf16 v[44:47], a[252:255], v[164:167], v[44:47]
    v_mfma_f32_16x16x32_bf16 v[48:51], v[188:191], v[164:167], v[48:51]
    s_waitcnt lgkmcnt(0)
    buffer_store_dwordx2 v[40:41], v5, s[16:19], s46 offen sc1
    s_add_u32 s46, s46, 43008
    v_mfma_f32_16x16x32_bf16 v[52:55], v[192:195], v[164:167], v[52:55]
    v_mfma_f32_16x16x32_bf16 v[52:55], v[204:207], v[168:171], v[52:55]
    v_cvt_pk_bf16_f32 v32, v68, v69
    v_cvt_pk_bf16_f32 v33, v70, v71
    v_mfma_f32_16x16x32_bf16 v[48:51], v[200:203], v[168:171], v[48:51]
    v_cvt_pk_bf16_f32 v34, v72, v73
    v_cvt_pk_bf16_f32 v35, v74, v75
    v_mfma_f32_16x16x32_bf16 v[44:47], v[196:199], v[168:171], v[44:47]
    v_cvt_pk_bf16_f32 v36, v76, v77
    v_cvt_pk_bf16_f32 v37, v78, v79
    v_mfma_f32_16x16x32_bf16 v[44:47], v[208:211], v[172:175], v[44:47]
    v_permlane16_swap_b32 v32, v34
    v_permlane16_swap_b32 v33, v35
    v_mfma_f32_16x16x32_bf16 v[48:51], v[212:215], v[172:175], v[48:51]
    ds_write_b64 v10, v[36:37] offset:2304
    v_mfma_f32_16x16x32_bf16 v[52:55], v[216:219], v[172:175], v[52:55]
    buffer_store_dwordx4 v[32:35], v9, s[16:19], s31 offen sc1
    s_add_u32 s31, s31, 43008
    v_mfma_f32_16x16x32_bf16 v[44:47], v[220:223], v[176:179], v[44:47]
    v_mfma_f32_16x16x32_bf16 v[48:51], v[224:227], v[176:179], v[48:51]
    v_mfma_f32_16x16x32_bf16 v[52:55], v[228:231], v[176:179], v[52:55]
    v_mfma_f32_16x16x32_bf16 v[52:55], v[240:243], v[180:183], v[52:55]
    v_mfma_f32_16x16x32_bf16 v[48:51], v[236:239], v[180:183], v[48:51]
    v_mfma_f32_16x16x32_bf16 v[44:47], v[232:235], v[180:183], v[44:47]
    v_mfma_f32_16x16x32_bf16 v[44:47], v[244:247], v[184:187], v[44:47]
    v_mfma_f32_16x16x32_bf16 v[48:51], v[248:251], v[184:187], v[48:51]
    v_mfma_f32_16x16x32_bf16 v[52:55], v[252:255], v[184:187], v[52:55]
    v_mfma_f32_16x16x32_bf16 v[56:59], a[0:3], v[116:119], 0
    v_mfma_f32_16x16x32_bf16 v[60:63], a[4:7], v[116:119], 0
    v_mfma_f32_16x16x32_bf16 v[64:67], a[8:11], v[116:119], 0
    v_mfma_f32_16x16x32_bf16 v[64:67], a[20:23], v[120:123], v[64:67]
    v_mfma_f32_16x16x32_bf16 v[60:63], a[16:19], v[120:123], v[60:63]
    v_mfma_f32_16x16x32_bf16 v[56:59], a[12:15], v[120:123], v[56:59]
    v_mfma_f32_16x16x32_bf16 v[56:59], a[24:27], v[124:127], v[56:59]
    v_mfma_f32_16x16x32_bf16 v[60:63], a[28:31], v[124:127], v[60:63]
    v_mfma_f32_16x16x32_bf16 v[64:67], a[32:35], v[124:127], v[64:67]
    v_mfma_f32_16x16x32_bf16 v[56:59], a[36:39], v[128:131], v[56:59]
    v_mfma_f32_16x16x32_bf16 v[60:63], a[40:43], v[128:131], v[60:63]
    v_mfma_f32_16x16x32_bf16 v[64:67], a[44:47], v[128:131], v[64:67]
    v_mfma_f32_16x16x32_bf16 v[64:67], a[56:59], v[132:135], v[64:67]
    v_cvt_pk_bf16_f32 v32, v44, v45
    v_cvt_pk_bf16_f32 v33, v46, v47
    v_mfma_f32_16x16x32_bf16 v[60:63], a[52:55], v[132:135], v[60:63]
    v_cvt_pk_bf16_f32 v34, v48, v49
    v_cvt_pk_bf16_f32 v35, v50, v51
    v_mfma_f32_16x16x32_bf16 v[56:59], a[48:51], v[132:135], v[56:59]
    v_cvt_pk_bf16_f32 v36, v52, v53
    v_cvt_pk_bf16_f32 v37, v54, v55
    v_mfma_f32_16x16x32_bf16 v[56:59], a[60:63], v[136:139], v[56:59]
    v_permlane16_swap_b32 v32, v34
    v_permlane16_swap_b32 v33, v35
    v_mfma_f32_16x16x32_bf16 v[60:63], a[64:67], v[136:139], v[60:63]
    ds_write_b64 v10, v[36:37] offset:3456
    v_mfma_f32_16x16x32_bf16 v[64:67], a[68:71], v[136:139], v[64:67]
    buffer_store_dwordx4 v[32:35], v9, s[16:19], s31 offen sc1
    s_add_u32 s31, s31, 43008
    v_mfma_f32_16x16x32_bf16 v[56:59], a[72:75], v[140:143], v[56:59]
    v_mfma_f32_16x16x32_bf16 v[60:63], a[76:79], v[140:143], v[60:63]
    v_mfma_f32_16x16x32_bf16 v[64:67], a[80:83], v[140:143], v[64:67]
    v_mfma_f32_16x16x32_bf16 v[64:67], a[92:95], v[144:147], v[64:67]
    v_mfma_f32_16x16x32_bf16 v[60:63], a[88:91], v[144:147], v[60:63]
    v_mfma_f32_16x16x32_bf16 v[56:59], a[84:87], v[144:147], v[56:59]
    v_mfma_f32_16x16x32_bf16 v[56:59], a[96:99], v[148:151], v[56:59]
    v_mfma_f32_16x16x32_bf16 v[60:63], a[100:103], v[148:151], v[60:63]
    v_mfma_f32_16x16x32_bf16 v[64:67], a[104:107], v[148:151], v[64:67]
    v_mfma_f32_16x16x32_bf16 v[56:59], a[108:111], v[152:155], v[56:59]
    v_mfma_f32_16x16x32_bf16 v[60:63], a[112:115], v[152:155], v[60:63]
    v_mfma_f32_16x16x32_bf16 v[64:67], a[116:119], v[152:155], v[64:67]
    v_mfma_f32_16x16x32_bf16 v[64:67], a[128:131], v[156:159], v[64:67]
    v_mfma_f32_16x16x32_bf16 v[60:63], a[124:127], v[156:159], v[60:63]
    v_mfma_f32_16x16x32_bf16 v[56:59], a[120:123], v[156:159], v[56:59]
    v_mfma_f32_16x16x32_bf16 v[56:59], a[132:135], v[160:163], v[56:59]
    v_mfma_f32_16x16x32_bf16 v[60:63], a[136:139], v[160:163], v[60:63]
    v_mfma_f32_16x16x32_bf16 v[64:67], a[140:143], v[160:163], v[64:67]
    v_mfma_f32_16x16x32_bf16 v[56:59], a[144:147], v[164:167], v[56:59]
    s_waitcnt vmcnt(10)
    s_waitcnt lgkmcnt(0)
    s_barrier
    v_mfma_f32_16x16x32_bf16 v[60:63], a[148:151], v[164:167], v[60:63]
    ds_read_b128 v[80:83], v1 offset:24576
    v_mfma_f32_16x16x32_bf16 v[64:67], a[152:155], v[164:167], v[64:67]
    ds_read_b128 v[84:87], v1 offset:24640
    v_mfma_f32_16x16x32_bf16 v[64:67], a[164:167], v[168:171], v[64:67]
    ds_read_b128 v[88:91], v1 offset:24704
    s_branch L_N2_s1
L_N2_t1:
    s_setpc_b64 s[78:79]
L_N2_s1:
    v_mfma_f32_16x16x32_bf16 v[60:63], a[160:163], v[168:171], v[60:63]
    ds_read_b128 v[92:95], v2 offset:24576
    v_mfma_f32_16x16x32_bf16 v[56:59], a[156:159], v[168:171], v[56:59]
    ds_read_b128 v[96:99], v2 offset:24640
    v_mfma_f32_16x16x32_bf16 v[56:59], a[168:171], v[172:175], v[56:59]
    ds_read_b128 v[100:103], v2 offset:24704
    v_mfma_f32_16x16x32_bf16 v[60:63], a[172:175], v[172:175], v[60:63]
    ds_read_b128 v[104:107], v3 offset:24576
    v_mfma_f32_16x16x32_bf16 v[64:67], a[176:179], v[172:175], v[64:67]
    ds_read_b128 v[108:111], v3 offset:24640
    v_mfma_f32_16x16x32_bf16 v[56:59], a[180:183], v[176:179], v[56:59]
    ds_read_b128 v[112:115], v3 offset:24704
    v_mfma_f32_16x16x32_bf16 v[60:63], a[184:187], v[176:179], v[60:63]
    ds_read_b64 v[38:39], v4 offset:2304
    v_mfma_f32_16x16x32_bf16 v[64:67], a[188:191], v[176:179], v[64:67]
    ds_read_b64 v[40:41], v4 offset:3456
    v_mfma_f32_16x16x32_bf16 v[64:67], a[200:203], v[180:183], v[64:67]
    v_mfma_f32_16x16x32_bf16 v[60:63], a[196:199], v[180:183], v[60:63]
    v_mfma_f32_16x16x32_bf16 v[56:59], a[192:195], v[180:183], v[56:59]
    v_mfma_f32_16x16x32_bf16 v[56:59], a[204:207], v[184:187], v[56:59]
    v_mfma_f32_16x16x32_bf16 v[60:63], a[208:211], v[184:187], v[60:63]
    v_mfma_f32_16x16x32_bf16 v[64:67], a[212:215], v[184:187], v[64:67]
    s_waitcnt lgkmcnt(7)
    v_mfma_f32_16x16x32_bf16 v[56:59], a[216:219], v[80:83], v[56:59]
    v_mfma_f32_16x16x32_bf16 v[60:63], a[220:223], v[80:83], v[60:63]
    s_waitcnt lgkmcnt(1)
    buffer_store_dwordx2 v[38:39], v5, s[16:19], s46 offen sc1
    s_add_u32 s46, s46, 43008
    v_mfma_f32_16x16x32_bf16 v[64:67], a[224:227], v[80:83], v[64:67]
    v_mfma_f32_16x16x32_bf16 v[64:67], a[236:239], v[84:87], v[64:67]
    v_mfma_f32_16x16x32_bf16 v[60:63], a[232:235], v[84:87], v[60:63]
    v_mfma_f32_16x16x32_bf16 v[56:59], a[228:231], v[84:87], v[56:59]
    v_mfma_f32_16x16x32_bf16 v[56:59], a[240:243], v[88:91], v[56:59]
    v_mfma_f32_16x16x32_bf16 v[60:63], a[244:247], v[88:91], v[60:63]
    v_mfma_f32_16x16x32_bf16 v[64:67], a[248:251], v[88:91], v[64:67]
    s_waitcnt lgkmcnt(0)
    buffer_store_dwordx2 v[40:41], v5, s[16:19], s46 offen sc1
    s_add_u32 s46, s46, 43008
    v_mfma_f32_16x16x32_bf16 v[56:59], a[252:255], v[92:95], v[56:59]
    v_mfma_f32_16x16x32_bf16 v[60:63], v[188:191], v[92:95], v[60:63]
    v_mfma_f32_16x16x32_bf16 v[64:67], v[192:195], v[92:95], v[64:67]
    v_mfma_f32_16x16x32_bf16 v[64:67], v[204:207], v[96:99], v[64:67]
    v_mfma_f32_16x16x32_bf16 v[60:63], v[200:203], v[96:99], v[60:63]
    v_mfma_f32_16x16x32_bf16 v[56:59], v[196:199], v[96:99], v[56:59]
    v_mfma_f32_16x16x32_bf16 v[56:59], v[208:211], v[100:103], v[56:59]
    v_mfma_f32_16x16x32_bf16 v[60:63], v[212:215], v[100:103], v[60:63]
    v_mfma_f32_16x16x32_bf16 v[64:67], v[216:219], v[100:103], v[64:67]
    v_mfma_f32_16x16x32_bf16 v[56:59], v[220:223], v[104:107], v[56:59]
    v_mfma_f32_16x16x32_bf16 v[60:63], v[224:227], v[104:107], v[60:63]
    v_mfma_f32_16x16x32_bf16 v[64:67], v[228:231], v[104:107], v[64:67]
    v_mfma_f32_16x16x32_bf16 v[64:67], v[240:243], v[108:111], v[64:67]
    v_mfma_f32_16x16x32_bf16 v[60:63], v[236:239], v[108:111], v[60:63]
    v_mfma_f32_16x16x32_bf16 v[56:59], v[232:235], v[108:111], v[56:59]
    v_mfma_f32_16x16x32_bf16 v[56:59], v[244:247], v[112:115], v[56:59]
    v_mfma_f32_16x16x32_bf16 v[60:63], v[248:251], v[112:115], v[60:63]
    v_mfma_f32_16x16x32_bf16 v[64:67], v[252:255], v[112:115], v[64:67]
    v_mfma_f32_16x16x32_bf16 v[68:71], a[0:3], v[152:155], 0
    v_mfma_f32_16x16x32_bf16 v[72:75], a[4:7], v[152:155], 0
    v_mfma_f32_16x16x32_bf16 v[76:79], a[8:11], v[152:155], 0
    v_mfma_f32_16x16x32_bf16 v[76:79], a[20:23], v[156:159], v[76:79]
    v_mfma_f32_16x16x32_bf16 v[72:75], a[16:19], v[156:159], v[72:75]
    v_mfma_f32_16x16x32_bf16 v[68:71], a[12:15], v[156:159], v[68:71]
    v_mfma_f32_16x16x32_bf16 v[68:71], a[24:27], v[160:163], v[68:71]
    v_cvt_pk_bf16_f32 v32, v56, v57
    v_cvt_pk_bf16_f32 v33, v58, v59
    v_mfma_f32_16x16x32_bf16 v[72:75], a[28:31], v[160:163], v[72:75]
    v_cvt_pk_bf16_f32 v34, v60, v61
    v_cvt_pk_bf16_f32 v35, v62, v63
    v_mfma_f32_16x16x32_bf16 v[76:79], a[32:35], v[160:163], v[76:79]
    v_cvt_pk_bf16_f32 v36, v64, v65
    v_cvt_pk_bf16_f32 v37, v66, v67
    v_mfma_f32_16x16x32_bf16 v[68:71], a[36:39], v[164:167], v[68:71]
    v_permlane16_swap_b32 v32, v34
    v_permlane16_swap_b32 v33, v35
    v_mfma_f32_16x16x32_bf16 v[72:75], a[40:43], v[164:167], v[72:75]
    ds_write_b64 v10, v[36:37] offset:4608
    v_mfma_f32_16x16x32_bf16 v[76:79], a[44:47], v[164:167], v[76:79]
    buffer_store_dwordx4 v[32:35], v9, s[16:19], s31 offen sc1
    s_add_u32 s31, s31, 43008
    v_mfma_f32_16x16x32_bf16 v[76:79], a[56:59], v[168:171], v[76:79]
    v_mfma_f32_16x16x32_bf16 v[72:75], a[52:55], v[168:171], v[72:75]
    v_mfma_f32_16x16x32_bf16 v[68:71], a[48:51], v[168:171], v[68:71]
    ds_read_b128 v[116:119], v1 offset:28672
    v_mfma_f32_16x16x32_bf16 v[68:71], a[60:63], v[172:175], v[68:71]
    ds_read_b128 v[120:123], v1 offset:28736
    v_mfma_f32_16x16x32_bf16 v[72:75], a[64:67], v[172:175], v[72:75]
    ds_read_b128 v[124:127], v1 offset:28800
    v_mfma_f32_16x16x32_bf16 v[76:79], a[68:71], v[172:175], v[76:79]
    ds_read_b128 v[128:131], v2 offset:28672
    v_mfma_f32_16x16x32_bf16 v[68:71], a[72:75], v[176:179], v[68:71]
    ds_read_b128 v[132:135], v2 offset:28736
    v_mfma_f32_16x16x32_bf16 v[72:75], a[76:79], v[176:179], v[72:75]
    ds_read_b128 v[136:139], v2 offset:28800
    v_mfma_f32_16x16x32_bf16 v[76:79], a[80:83], v[176:179], v[76:79]
    ds_read_b128 v[140:143], v3 offset:28672
    v_mfma_f32_16x16x32_bf16 v[76:79], a[92:95], v[180:183], v[76:79]
    ds_read_b128 v[144:147], v3 offset:28736
    v_mfma_f32_16x16x32_bf16 v[72:75], a[88:91], v[180:183], v[72:75]
    ds_read_b128 v[148:151], v3 offset:28800
    v_mfma_f32_16x16x32_bf16 v[68:71], a[84:87], v[180:183], v[68:71]
    v_mfma_f32_16x16x32_bf16 v[68:71], a[96:99], v[184:187], v[68:71]
    v_mfma_f32_16x16x32_bf16 v[72:75], a[100:103], v[184:187], v[72:75]
    v_mfma_f32_16x16x32_bf16 v[76:79], a[104:107], v[184:187], v[76:79]
    v_mfma_f32_16x16x32_bf16 v[68:71], a[108:111], v[80:83], v[68:71]
    v_mfma_f32_16x16x32_bf16 v[72:75], a[112:115], v[80:83], v[72:75]
    s_mov_b32 s47, 0x7fff7fff
    s_waitcnt vmcnt(12)
    v_and_b32 v15, s47, v16
    v_mfma_f32_16x16x32_bf16 v[76:79], a[116:119], v[80:83], v[76:79]
    v_and_b32 v0, s47, v17
    v_pk_max_u16 v12, v15, s35
    v_mfma_f32_16x16x32_bf16 v[76:79], a[128:131], v[84:87], v[76:79]
    v_pk_max_u16 v13, v0, s35
    v_and_b32 v15, s47, v18
    v_mfma_f32_16x16x32_bf16 v[72:75], a[124:127], v[84:87], v[72:75]
    v_and_b32 v0, s47, v19
    v_pk_max_u16 v12, v15, v12
    v_mfma_f32_16x16x32_bf16 v[68:71], a[120:123], v[84:87], v[68:71]
    v_pk_max_u16 v13, v0, v13
    s_waitcnt vmcnt(11)
    v_and_b32 v15, s47, v20
    v_mfma_f32_16x16x32_bf16 v[68:71], a[132:135], v[88:91], v[68:71]
    v_and_b32 v0, s47, v21
    v_pk_max_u16 v12, v15, v12
    v_mfma_f32_16x16x32_bf16 v[72:75], a[136:139], v[88:91], v[72:75]
    v_pk_max_u16 v13, v0, v13
    v_and_b32 v15, s47, v22
    v_mfma_f32_16x16x32_bf16 v[76:79], a[140:143], v[88:91], v[76:79]
    v_and_b32 v0, s47, v23
    v_pk_max_u16 v12, v15, v12
    v_mfma_f32_16x16x32_bf16 v[68:71], a[144:147], v[92:95], v[68:71]
    v_pk_max_u16 v13, v0, v13
    s_waitcnt vmcnt(10)
    v_and_b32 v15, s47, v24
    v_mfma_f32_16x16x32_bf16 v[72:75], a[148:151], v[92:95], v[72:75]
    v_and_b32 v0, s47, v25
    v_pk_max_u16 v12, v15, v12
    v_mfma_f32_16x16x32_bf16 v[76:79], a[152:155], v[92:95], v[76:79]
    v_pk_max_u16 v13, v0, v13
    v_and_b32 v15, s47, v26
    v_mfma_f32_16x16x32_bf16 v[76:79], a[164:167], v[96:99], v[76:79]
    v_and_b32 v0, s47, v27
    v_pk_max_u16 v12, v15, v12
    v_mfma_f32_16x16x32_bf16 v[72:75], a[160:163], v[96:99], v[72:75]
    v_pk_max_u16 v13, v0, v13
    s_waitcnt vmcnt(9)
    v_and_b32 v15, s47, v28
    v_mfma_f32_16x16x32_bf16 v[68:71], a[156:159], v[96:99], v[68:71]
    v_and_b32 v0, s47, v29
    v_pk_max_u16 v12, v15, v12
    v_mfma_f32_16x16x32_bf16 v[68:71], a[168:171], v[100:103], v[68:71]
    v_pk_max_u16 v13, v0, v13
    v_and_b32 v15, s47, v30
    v_mfma_f32_16x16x32_bf16 v[72:75], a[172:175], v[100:103], v[72:75]
    v_and_b32 v0, s47, v31
    v_pk_max_u16 v12, v15, v12
    v_mfma_f32_16x16x32_bf16 v[76:79], a[176:179], v[100:103], v[76:79]
    v_pk_max_u16 v13, v0, v13
    v_pk_max_u16 v12, v12, v13
    v_mfma_f32_16x16x32_bf16 v[68:71], a[180:183], v[104:107], v[68:71]
    v_cmp_ne_u32 vcc, s35, v12
    v_mfma_f32_16x16x32_bf16 v[72:75], a[184:187], v[104:107], v[72:75]
    v_mfma_f32_16x16x32_bf16 v[76:79], a[188:191], v[104:107], v[76:79]
    v_mfma_f32_16x16x32_bf16 v[76:79], a[200:203], v[108:111], v[76:79]
    v_mfma_f32_16x16x32_bf16 v[72:75], a[196:199], v[108:111], v[72:75]
    v_mfma_f32_16x16x32_bf16 v[68:71], a[192:195], v[108:111], v[68:71]
    v_mfma_f32_16x16x32_bf16 v[68:71], a[204:207], v[112:115], v[68:71]
    v_mfma_f32_16x16x32_bf16 v[72:75], a[208:211], v[112:115], v[72:75]
    v_mfma_f32_16x16x32_bf16 v[76:79], a[212:215], v[112:115], v[76:79]
    s_waitcnt lgkmcnt(7)
    v_mfma_f32_16x16x32_bf16 v[68:71], a[216:219], v[116:119], v[68:71]
    v_mfma_f32_16x16x32_bf16 v[72:75], a[220:223], v[116:119], v[72:75]
    v_mfma_f32_16x16x32_bf16 v[76:79], a[224:227], v[116:119], v[76:79]
    v_mfma_f32_16x16x32_bf16 v[76:79], a[236:239], v[120:123], v[76:79]
    v_mfma_f32_16x16x32_bf16 v[72:75], a[232:235], v[120:123], v[72:75]
    v_mfma_f32_16x16x32_bf16 v[68:71], a[228:231], v[120:123], v[68:71]
    s_waitcnt lgkmcnt(6)
    v_mfma_f32_16x16x32_bf16 v[68:71], a[240:243], v[124:127], v[68:71]
    v_mfma_f32_16x16x32_bf16 v[72:75], a[244:247], v[124:127], v[72:75]
    v_mfma_f32_16x16x32_bf16 v[76:79], a[248:251], v[124:127], v[76:79]
    s_waitcnt lgkmcnt(5)
    v_mfma_f32_16x16x32_bf16 v[68:71], a[252:255], v[128:131], v[68:71]
    v_mfma_f32_16x16x32_bf16 v[72:75], v[188:191], v[128:131], v[72:75]
    v_mfma_f32_16x16x32_bf16 v[76:79], v[192:195], v[128:131], v[76:79]
    s_waitcnt lgkmcnt(4)
    v_mfma_f32_16x16x32_bf16 v[76:79], v[204:207], v[132:135], v[76:79]
    v_mfma_f32_16x16x32_bf16 v[72:75], v[200:203], v[132:135], v[72:75]
    v_mfma_f32_16x16x32_bf16 v[68:71], v[196:199], v[132:135], v[68:71]
    s_waitcnt lgkmcnt(3)
    v_mfma_f32_16x16x32_bf16 v[68:71], v[208:211], v[136:139], v[68:71]
    v_mfma_f32_16x16x32_bf16 v[72:75], v[212:215], v[136:139], v[72:75]
    v_mfma_f32_16x16x32_bf16 v[76:79], v[216:219], v[136:139], v[76:79]
    s_waitcnt lgkmcnt(2)
    v_mfma_f32_16x16x32_bf16 v[68:71], v[220:223], v[140:143], v[68:71]
    v_mfma_f32_16x16x32_bf16 v[72:75], v[224:227], v[140:143], v[72:75]
    v_mfma_f32_16x16x32_bf16 v[76:79], v[228:231], v[140:143], v[76:79]
    s_waitcnt lgkmcnt(1)
    v_mfma_f32_16x16x32_bf16 v[76:79], v[240:243], v[144:147], v[76:79]
    v_mfma_f32_16x16x32_bf16 v[72:75], v[236:239], v[144:147], v[72:75]
    v_mfma_f32_16x16x32_bf16 v[68:71], v[232:235], v[144:147], v[68:71]
    s_waitcnt lgkmcnt(0)
    v_mfma_f32_16x16x32_bf16 v[68:71], v[244:247], v[148:151], v[68:71]
    v_mfma_f32_16x16x32_bf16 v[72:75], v[248:251], v[148:151], v[72:75]
    v_mfma_f32_16x16x32_bf16 v[76:79], v[252:255], v[148:151], v[76:79]
    v_mfma_f32_16x16x32_bf16 v[44:47], a[0:3], v[80:83], 0
    v_mfma_f32_16x16x32_bf16 v[48:51], a[4:7], v[80:83], 0
    v_mfma_f32_16x16x32_bf16 v[52:55], a[8:11], v[80:83], 0
    v_mfma_f32_16x16x32_bf16 v[52:55], a[20:23], v[84:87], v[52:55]
    v_mfma_f32_16x16x32_bf16 v[48:51], a[16:19], v[84:87], v[48:51]
    v_mfma_f32_16x16x32_bf16 v[44:47], a[12:15], v[84:87], v[44:47]
    v_mfma_f32_16x16x32_bf16 v[44:47], a[24:27], v[88:91], v[44:47]
    v_cvt_pk_bf16_f32 v32, v68, v69
    v_cvt_pk_bf16_f32 v33, v70, v71
    v_mfma_f32_16x16x32_bf16 v[48:51], a[28:31], v[88:91], v[48:51]
    v_cvt_pk_bf16_f32 v34, v72, v73
    v_cvt_pk_bf16_f32 v35, v74, v75
    v_mfma_f32_16x16x32_bf16 v[52:55], a[32:35], v[88:91], v[52:55]
    v_cvt_pk_bf16_f32 v36, v76, v77
    v_cvt_pk_bf16_f32 v37, v78, v79
    v_mfma_f32_16x16x32_bf16 v[44:47], a[36:39], v[92:95], v[44:47]
    v_permlane16_swap_b32 v32, v34
    v_permlane16_swap_b32 v33, v35
    v_mfma_f32_16x16x32_bf16 v[48:51], a[40:43], v[92:95], v[48:51]
    ds_write_b64 v10, v[36:37] offset:5760
    v_mfma_f32_16x16x32_bf16 v[52:55], a[44:47], v[92:95], v[52:55]
    buffer_store_dwordx4 v[32:35], v9, s[16:19], s31 offen sc1
    s_add_u32 s31, s31, 43008
    v_mfma_f32_16x16x32_bf16 v[52:55], a[56:59], v[96:99], v[52:55]
    v_mfma_f32_16x16x32_bf16 v[48:51], a[52:55], v[96:99], v[48:51]
    v_mfma_f32_16x16x32_bf16 v[44:47], a[48:51], v[96:99], v[44:47]
    ds_read_b128 v[152:155], v1 offset:32768
    v_mfma_f32_16x16x32_bf16 v[44:47], a[60:63], v[100:103], v[44:47]
    ds_read_b128 v[156:159], v1 offset:32832
    v_mfma_f32_16x16x32_bf16 v[48:51], a[64:67], v[100:103], v[48:51]
    ds_read_b128 v[160:163], v1 offset:32896
    v_mfma_f32_16x16x32_bf16 v[52:55], a[68:71], v[100:103], v[52:55]
    ds_read_b128 v[164:167], v2 offset:32768
    v_mfma_f32_16x16x32_bf16 v[44:47], a[72:75], v[104:107], v[44:47]
    ds_read_b128 v[168:171], v2 offset:32832
    v_mfma_f32_16x16x32_bf16 v[48:51], a[76:79], v[104:107], v[48:51]
    ds_read_b128 v[172:175], v2 offset:32896
    v_mfma_f32_16x16x32_bf16 v[52:55], a[80:83], v[104:107], v[52:55]
    ds_read_b128 v[176:179], v3 offset:32768
    v_mfma_f32_16x16x32_bf16 v[52:55], a[92:95], v[108:111], v[52:55]
    ds_read_b128 v[180:183], v3 offset:32832
    v_mfma_f32_16x16x32_bf16 v[48:51], a[88:91], v[108:111], v[48:51]
    ds_read_b128 v[184:187], v3 offset:32896
    v_mfma_f32_16x16x32_bf16 v[44:47], a[84:87], v[108:111], v[44:47]
    v_mfma_f32_16x16x32_bf16 v[44:47], a[96:99], v[112:115], v[44:47]
    s_mul_i32 s47, s30, 6656
    v_lshrrev_b32 v26, 4, v6
    v_mfma_f32_16x16x32_bf16 v[48:51], a[100:103], v[112:115], v[48:51]
    s_add_u32 s47, s47, 81664
    v_mul_u32_u24 v27, 43, v26
    v_mfma_f32_16x16x32_bf16 v[52:55], a[104:107], v[112:115], v[52:55]
    v_add_u32 v28, 128, v26
    s_lshl_b32 s48, s29, 3
    v_mfma_f32_16x16x32_bf16 v[44:47], a[108:111], v[116:119], v[44:47]
    v_lshrrev_b32 v27, 9, v27
    v_mul_u32_u24 v29, 2731, v28
    v_mfma_f32_16x16x32_bf16 v[48:51], a[112:115], v[116:119], v[48:51]
    v_mad_i32_i24 v26, v27, -12, v26
    v_lshrrev_b32 v29, 16, v29
    v_mfma_f32_16x16x32_bf16 v[52:55], a[116:119], v[116:119], v[52:55]
    v_add_u32 v27, s48, v27
    v_mul_u32_u24 v30, 24, v29
    v_mfma_f32_16x16x32_bf16 v[52:55], a[128:131], v[120:123], v[52:55]
    v_mul_u32_u24 v22, 208, v27
    v_sub_u32 v28, v28, v30
    v_mfma_f32_16x16x32_bf16 v[48:51], a[124:127], v[120:123], v[48:51]
    v_add_u32 v29, s48, v29
    v_mul_u32_u24 v24, 192, v27
    v_mfma_f32_16x16x32_bf16 v[44:47], a[120:123], v[120:123], v[44:47]
    v_lshlrev_b32 v26, 4, v26
    v_mul_u32_u24 v23, 208, v29
    v_mfma_f32_16x16x32_bf16 v[44:47], a[132:135], v[124:127], v[44:47]
    v_mul_u32_u24 v25, 192, v29
    v_lshlrev_b32 v28, 3, v28
    v_mfma_f32_16x16x32_bf16 v[48:51], a[136:139], v[124:127], v[48:51]
    s_waitcnt lgkmcnt(9)
    s_barrier
    v_add3_u32 v22, v22, s47, v26
    v_mfma_f32_16x16x32_bf16 v[52:55], a[140:143], v[124:127], v[52:55]
    ds_read_b64 v[38:39], v4 offset:4608
    v_mfma_f32_16x16x32_bf16 v[44:47], a[144:147], v[128:131], v[44:47]
    ds_read_b64 v[40:41], v4 offset:5760
    v_mfma_f32_16x16x32_bf16 v[48:51], a[148:151], v[128:131], v[48:51]
    v_add_u32 v24, v24, v26
    v_add3_u32 v23, v23, s47, v28
    v_mfma_f32_16x16x32_bf16 v[52:55], a[152:155], v[128:131], v[52:55]
    v_add_u32 v25, v25, v28
    v_bfe_u32 v26, v6, 4, 2
    v_mfma_f32_16x16x32_bf16 v[52:55], a[164:167], v[132:135], v[52:55]
    v_bfe_u32 v27, v6, 6, 2
    v_lshl_add_u32 v26, v26, 2, v27
    v_mfma_f32_16x16x32_bf16 v[48:51], a[160:163], v[132:135], v[48:51]
    v_lshrrev_b32 v27, 8, v6
    v_mul_u32_u24 v26, 208, v26
    v_mfma_f32_16x16x32_bf16 v[44:47], a[156:159], v[132:135], v[44:47]
    s_lshl4_add_u32 s49, s48, s47
    v_lshl_add_u32 v26, v27, 3, v26
    v_mfma_f32_16x16x32_bf16 v[44:47], a[168:171], v[136:139], v[44:47]
    s_lshl2_add_u32 s48, s48, s47
    v_add_u32 v20, s49, v26
    v_mfma_f32_16x16x32_bf16 v[48:51], a[172:175], v[136:139], v[48:51]
    v_add_u32 v21, s48, v26
    v_mfma_f32_16x16x32_bf16 v[52:55], a[176:179], v[136:139], v[52:55]
    s_waitcnt lgkmcnt(1)
    buffer_store_dwordx2 v[38:39], v5, s[16:19], s46 offen sc1
    s_add_u32 s46, s46, 43008
    v_mfma_f32_16x16x32_bf16 v[44:47], a[180:183], v[140:143], v[44:47]
    v_mfma_f32_16x16x32_bf16 v[48:51], a[184:187], v[140:143], v[48:51]
    v_mfma_f32_16x16x32_bf16 v[52:55], a[188:191], v[140:143], v[52:55]
    v_mfma_f32_16x16x32_bf16 v[52:55], a[200:203], v[144:147], v[52:55]
    v_mfma_f32_16x16x32_bf16 v[48:51], a[196:199], v[144:147], v[48:51]
    v_mfma_f32_16x16x32_bf16 v[44:47], a[192:195], v[144:147], v[44:47]
    v_mfma_f32_16x16x32_bf16 v[44:47], a[204:207], v[148:151], v[44:47]
    s_waitcnt lgkmcnt(0)
    buffer_store_dwordx2 v[40:41], v5, s[16:19], s46 offen sc1
    s_add_u32 s46, s46, 43008
    v_mfma_f32_16x16x32_bf16 v[48:51], a[208:211], v[148:151], v[48:51]
    v_mfma_f32_16x16x32_bf16 v[52:55], a[212:215], v[148:151], v[52:55]
    v_mfma_f32_16x16x32_bf16 v[44:47], a[216:219], v[152:155], v[44:47]
    v_mfma_f32_16x16x32_bf16 v[48:51], a[220:223], v[152:155], v[48:51]
    v_mfma_f32_16x16x32_bf16 v[52:55], a[224:227], v[152:155], v[52:55]
    v_mfma_f32_16x16x32_bf16 v[52:55], a[236:239], v[156:159], v[52:55]
    v_mfma_f32_16x16x32_bf16 v[48:51], a[232:235], v[156:159], v[48:51]
    v_mfma_f32_16x16x32_bf16 v[44:47], a[228:231], v[156:159], v[44:47]
    v_mfma_f32_16x16x32_bf16 v[44:47], a[240:243], v[160:163], v[44:47]
    v_mfma_f32_16x16x32_bf16 v[48:51], a[244:247], v[160:163], v[48:51]
    v_mfma_f32_16x16x32_bf16 v[52:55], a[248:251], v[160:163], v[52:55]
    v_mfma_f32_16x16x32_bf16 v[44:47], a[252:255], v[164:167], v[44:47]
    v_mfma_f32_16x16x32_bf16 v[48:51], v[188:191], v[164:167], v[48:51]
    v_mfma_f32_16x16x32_bf16 v[52:55], v[192:195], v[164:167], v[52:55]
    v_mfma_f32_16x16x32_bf16 v[52:55], v[204:207], v[168:171], v[52:55]
    v_mfma_f32_16x16x32_bf16 v[48:51], v[200:203], v[168:171], v[48:51]
    v_mfma_f32_16x16x32_bf16 v[44:47], v[196:199], v[168:171], v[44:47]
    v_mfma_f32_16x16x32_bf16 v[44:47], v[208:211], v[172:175], v[44:47]
    v_mfma_f32_16x16x32_bf16 v[48:51], v[212:215], v[172:175], v[48:51]
    v_mfma_f32_16x16x32_bf16 v[52:55], v[216:219], v[172:175], v[52:55]
    v_mfma_f32_16x16x32_bf16 v[44:47], v[220:223], v[176:179], v[44:47]
    v_mfma_f32_16x16x32_bf16 v[48:51], v[224:227], v[176:179], v[48:51]
    v_mfma_f32_16x16x32_bf16 v[52:55], v[228:231], v[176:179], v[52:55]
    v_mfma_f32_16x16x32_bf16 v[52:55], v[240:243], v[180:183], v[52:55]
    v_mfma_f32_16x16x32_bf16 v[48:51], v[236:239], v[180:183], v[48:51]
    v_mfma_f32_16x16x32_bf16 v[44:47], v[232:235], v[180:183], v[44:47]
    v_mfma_f32_16x16x32_bf16 v[44:47], v[244:247], v[184:187], v[44:47]
    v_mfma_f32_16x16x32_bf16 v[48:51], v[248:251], v[184:187], v[48:51]
    v_mfma_f32_16x16x32_bf16 v[52:55], v[252:255], v[184:187], v[52:55]
    s_nop 5
    v_cvt_pk_bf16_f32 v32, v44, v45
    v_cvt_pk_bf16_f32 v33, v46, v47
    v_cvt_pk_bf16_f32 v34, v48, v49
    v_cvt_pk_bf16_f32 v35, v50, v51
    ds_write_b64 v20, v[32:33] offset:0
    v_cvt_pk_bf16_f32 v36, v52, v53
    v_cvt_pk_bf16_f32 v37, v54, v55
    ds_write_b64 v20, v[34:35] offset:32
    ds_write_b64 v21, v[36:37] offset:64
    s_waitcnt lgkmcnt(0)
    s_barrier
    ds_read_b128 v[26:29], v22 offset:0
    ds_read_b64 v[30:31], v23 offset:0
    s_waitcnt lgkmcnt(1)
    buffer_store_dwordx4 v[26:29], v24, s[16:19], s31 offen sc1
    s_waitcnt lgkmcnt(0)
    buffer_store_dwordx2 v[30:31], v25, s[16:19], s31 offen sc1
    s_cbranch_vccnz L_gN
L_fin:
L_end:
    s_endpgm
.p2align 6
L_S:
    s_mul_i32 s47, s28, 11872
    v_mov_b32 v100, 0
    v_mov_b32 v101, 0
    v_mov_b32 v102, 0
    v_mov_b32 v103, 0
    v_add_u32 v104, s47, v6
    ds_write_b128 v104, v[100:103] offset:41472
    buffer_load_dwordx4 v7, s[12:15], s46 offen offset:1024 lds
    s_cmp_eq_u32 s56, 0
    s_mov_b32 s59, 0x01000c0c
    s_cselect_b32 s59, 0x03020c0c, s59
    s_cselect_b32 s49, 1.0, 0
    ds_write_b128 v104, v[100:103] offset:42496
    s_movk_i32 s36, 0x102
    s_cselect_b32 s36, 0x832, s36
    s_movk_i32 s37, 0x543
    s_cselect_b32 s37, 0x640, s37
    ds_write_b128 v104, v[100:103] offset:43520
    s_movk_i32 s38, 0x768
    s_cselect_b32 s38, 0x751, s38
    s_lshl_b32 s42, s56, 4
    v_mad_u32_u24 v180, v39, s56, v40
    ds_write_b128 v104, v[100:103] offset:44544
    v_add_u32 v181, 1, v40
    v_cmp_gt_u32 vcc, 14, v40
    v_add_u32 v180, -1, v180
    v_lshrrev_b32 v181, 4, v181
    ds_write_b128 v104, v[100:103] offset:45568
    v_mov_b32 v182, 0x41880000
    buffer_load_dwordx4 v7, s[12:15], s46 offen offset:2048 lds
    v_cvt_f32_i32 v20, v180
    v_lshl_add_u32 v181, v40, 2, v181
    v_mov_b32 v23, 0x416fffff
    ds_write_b128 v104, v[100:103] offset:46592
    v_lshlrev_b32 v180, 2, v39
    v_add_f32 v21, s49, v20
    v_cndmask_b32 v23, v182, v23, vcc
    s_mov_b32 s47, 41472
    ds_write_b128 v104, v[100:103] offset:47616
    v_bfe_u32 v24, s36, v180, 4
    s_add_u32 m0, s44, 101408
    s_add_u32 s64, s46, 12288
    s_bfe_u32 s65, s24, 0x40004
    s_mul_i32 s65, s65, 18432
    s_sub_u32 s46, s65, 6144
    s_cmp_eq_u32 s30, 0
    s_cselect_b32 s46, s64, s46
    buffer_load_dwordx4 v7, s[12:15], s46 offen offset:0 lds
    v_bfe_u32 v25, s37, v180, 4
    v_bfe_u32 v26, s38, v180, 4
    v_add_f32 v22, s49, v21
    ds_write_b128 v104, v[100:103] offset:48640
    s_waitcnt vmcnt(9)
    v_add_u32_sdwa v182, s47, v165 dst_sel:DWORD dst_unused:UNUSED_PAD src0_sel:DWORD src1_sel:WORD_1
    s_movk_i32 s48, 528
    v_lshl_add_u32 v181, v181, 3, v182
    s_mul_i32 s61, s30, 23760
    ds_write_b128 v104, v[100:103] offset:49664
    v_mad_u32_u24 v24, v24, s48, v181
    buffer_load_dwordx4 v7, s[12:15], s46 offen offset:1024 lds
    v_mad_u32_u24 v25, v25, s48, v181
    v_mad_u32_u24 v26, v26, s48, v181
    s_add_u32 s61, s61, s47
    ds_write_b128 v104, v[100:103] offset:50688
    s_mul_i32 s47, s30, 17280
    v_add_u32_sdwa v3, s61, v165 dst_sel:DWORD dst_unused:UNUSED_PAD src0_sel:DWORD src1_sel:WORD_0
    v_add_u32_sdwa v9, s61, v166 dst_sel:DWORD dst_unused:UNUSED_PAD src0_sel:DWORD src1_sel:WORD_0
    v_add_u32_sdwa v10, s61, v166 dst_sel:DWORD dst_unused:UNUSED_PAD src0_sel:DWORD src1_sel:WORD_1
    ds_write_b128 v104, v[100:103] offset:51712
    v_add_u32_sdwa v1, s47, v164 dst_sel:DWORD dst_unused:UNUSED_PAD src0_sel:DWORD src1_sel:WORD_0
    buffer_load_dwordx4 v7, s[12:15], s46 offen offset:2048 lds
    v_add_u32_sdwa v2, s47, v164 dst_sel:DWORD dst_unused:UNUSED_PAD src0_sel:DWORD src1_sel:WORD_1
    s_lshl_b32 s48, s29, 7
    s_lshl_b32 s49, s29, 5
    ds_write_b128 v104, v[100:103] offset:52352
    s_add_u32 s47, s48, 88992
    v_add_u32_sdwa v4, s47, v16 dst_sel:DWORD dst_unused:UNUSED_PAD src0_sel:DWORD src1_sel:WORD_0
    s_add_u32 s47, s49, 88992
    v_add_u32_sdwa v5, s47, v16 dst_sel:DWORD dst_unused:UNUSED_PAD src0_sel:DWORD src1_sel:WORD_0
    s_lshl2_add_u32 s47, s28, 163488
    v_mov_b32 v27, s47
    s_mov_b32 s54, 0
    s_cmp_eq_u32 s30, 0
    s_cselect_b32 s31, s26, s27
    s_branch L_S1
.p2align 12
L_S1:
    s_waitcnt lgkmcnt(0)
    s_barrier
    s_waitcnt vmcnt(7)
    v_mov_b32 v235, v240
    s_add_u32 m0, s44, 113824
    s_add_u32 s46, s65, 6144
    buffer_load_dwordx4 v7, s[12:15], s46 offen offset:0 lds
    v_perm_b32 v180, v232, v232, s59
    v_perm_b32 v184, v233, v233, s59
    v_perm_b32 v188, v234, v234, s59
    v_bfe_u32 v183, v232, s42, 15
    v_bfe_u32 v187, v233, s42, 15
    v_bfe_u32 v191, v234, s42, 15
    v_add_f32 v180, v180, v20
    v_add_f32 v184, v184, v21
    v_add_f32 v188, v188, v22
    v_cvt_pk_bf16_f32 v180, v180, v180
    v_cvt_pk_bf16_f32 v184, v184, v184
    v_cvt_pk_bf16_f32 v188, v188, v188
    v_lshlrev_b32 v232, 16, v180
    v_lshlrev_b32 v233, 16, v184
    buffer_load_dwordx4 v7, s[12:15], s46 offen offset:1024 lds
    v_lshlrev_b32 v234, 16, v188
    v_med3_i32 v180, v232, 0, v23
    v_med3_i32 v184, v233, 0, v23
    v_med3_i32 v188, v234, 0, v23
    v_fract_f32 v181, v180
    v_fract_f32 v185, v184
    v_fract_f32 v189, v188
    v_cvt_u32_f32 v182, v180
    v_cvt_u32_f32 v186, v184
    v_cvt_u32_f32 v190, v188
    v_sub_f32 v180, 1.0, v181
    v_sub_f32 v184, 1.0, v185
    v_sub_f32 v188, 1.0, v189
    v_max3_u32 v183, v183, v187, v191
    buffer_load_dwordx4 v7, s[12:15], s46 offen offset:2048 lds
    v_max3_i32 v232, v232, v233, v234
    v_cmp_lt_u32 vcc, s68, v183
    v_cmp_gt_i32 s[66:67], v232, v23
    v_lshl_add_u32 v182, v182, 1, v24
    v_lshl_add_u32 v186, v186, 1, v25
    v_lshl_add_u32 v190, v190, 1, v26
    v_cvt_pk_bf16_f32 v180, v180, v181
    v_cvt_pk_bf16_f32 v184, v184, v185
    v_cvt_pk_bf16_f32 v188, v188, v189
    s_or_b64 vcc, vcc, s[66:67]
    s_cselect_b32 s47, 3, 0
    s_or_b32 s54, s54, s47
    v_perm_b32 v192, v236, v236, s59
    v_perm_b32 v196, v237, v237, s59
    v_perm_b32 v200, v238, v238, s59
    v_bfe_u32 v195, v236, s42, 15
    s_mul_i32 s48, s55, 0
    s_add_u32 m0, s33, 0
    s_add_u32 s48, s48, s20
    buffer_load_dwordx4 v8, s[4:7], s48 offen lds
    v_bfe_u32 v199, v237, s42, 15
    v_bfe_u32 v203, v238, s42, 15
    v_add_f32 v192, v192, v20
    v_add_f32 v196, v196, v21
    v_add_f32 v200, v200, v22
    v_cvt_pk_bf16_f32 v192, v192, v192
    v_cvt_pk_bf16_f32 v196, v196, v196
    v_cvt_pk_bf16_f32 v200, v200, v200
    v_lshlrev_b32 v236, 16, v192
    v_lshlrev_b32 v237, 16, v196
    v_lshlrev_b32 v238, 16, v200
    v_med3_i32 v192, v236, 0, v23
    v_med3_i32 v196, v237, 0, v23
    v_med3_i32 v200, v238, 0, v23
    s_mul_i32 s48, s55, 5
    s_add_u32 m0, s33, 17280
    s_add_u32 s48, s48, s20
    buffer_load_dwordx4 v8, s[4:7], s48 offen lds
    v_fract_f32 v193, v192
    v_fract_f32 v197, v196
    v_fract_f32 v201, v200
    v_cvt_u32_f32 v194, v192
    v_cvt_u32_f32 v198, v196
    v_cvt_u32_f32 v202, v200
    v_sub_f32 v192, 1.0, v193
    v_sub_f32 v196, 1.0, v197
    v_sub_f32 v200, 1.0, v201
    v_max3_u32 v195, v195, v199, v203
    v_max3_i32 v236, v236, v237, v238
    v_cmp_lt_u32 vcc, s68, v195
    v_cmp_gt_i32 s[66:67], v236, v23
    v_lshl_add_u32 v194, v194, 1, v24
    s_mul_i32 s48, s55, 1
    s_add_u32 m0, s33, 3456
    s_add_u32 s48, s48, s20
    buffer_load_dwordx4 v8, s[4:7], s48 offen lds
    v_lshl_add_u32 v198, v198, 1, v25
    v_lshl_add_u32 v202, v202, 1, v26
    v_cvt_pk_bf16_f32 v192, v192, v193
    v_cvt_pk_bf16_f32 v196, v196, v197
    v_cvt_pk_bf16_f32 v200, v200, v201
    s_or_b64 vcc, vcc, s[66:67]
    s_cselect_b32 s47, 12, 0
    s_or_b32 s54, s54, s47
    v_perm_b32 v204, v240, v240, s59
    v_perm_b32 v208, v241, v241, s59
    v_perm_b32 v212, v242, v242, s59
    v_bfe_u32 v207, v240, s42, 15
    v_bfe_u32 v211, v241, s42, 15
    v_bfe_u32 v215, v242, s42, 15
    v_add_f32 v204, v204, v20
    v_add_f32 v208, v208, v21
    s_mul_i32 s48, s55, 6
    s_add_u32 m0, s33, 20736
    s_add_u32 s48, s48, s20
    buffer_load_dwordx4 v8, s[4:7], s48 offen lds
    v_add_f32 v212, v212, v22
    v_cvt_pk_bf16_f32 v204, v204, v204
    v_cvt_pk_bf16_f32 v208, v208, v208
    v_cvt_pk_bf16_f32 v212, v212, v212
    v_lshlrev_b32 v240, 16, v204
    v_lshlrev_b32 v241, 16, v208
    v_lshlrev_b32 v242, 16, v212
    v_med3_i32 v204, v240, 0, v23
    v_med3_i32 v208, v241, 0, v23
    v_med3_i32 v212, v242, 0, v23
    v_fract_f32 v205, v204
    v_fract_f32 v209, v208
    v_fract_f32 v213, v212
    v_cvt_u32_f32 v206, v204
    v_cvt_u32_f32 v210, v208
    v_cvt_u32_f32 v214, v212
    v_sub_f32 v204, 1.0, v205
    v_sub_f32 v208, 1.0, v209
    v_sub_f32 v212, 1.0, v213
    v_max3_u32 v207, v207, v211, v215
    v_max3_i32 v240, v240, v241, v242
    v_cmp_lt_u32 vcc, s68, v207
    v_cmp_gt_i32 s[66:67], v240, v23
    v_lshl_add_u32 v206, v206, 1, v24
    v_lshl_add_u32 v210, v210, 1, v25
    v_lshl_add_u32 v214, v214, 1, v26
    v_cvt_pk_bf16_f32 v204, v204, v205
    v_cvt_pk_bf16_f32 v208, v208, v209
    v_cvt_pk_bf16_f32 v212, v212, v213
    s_or_b64 vcc, vcc, s[66:67]
    s_cselect_b32 s47, 48, 0
    s_or_b32 s54, s54, s47
    s_mov_b32 exec_hi, 0xffff
    ds_write_b16 v182, v180 offset:0
    ds_write_b16_d16_hi v182, v180 offset:2
    ds_write_b16 v186, v184 offset:0
    ds_write_b16_d16_hi v186, v184 offset:2
    ds_write_b16 v190, v188 offset:0
    ds_write_b16_d16_hi v190, v188 offset:2
    s_mov_b64 exec, -1
    s_mov_b32 exec_hi, 0xffff
    ds_write_b16 v194, v192 offset:9504
    ds_write_b16_d16_hi v194, v192 offset:9506
    ds_write_b16 v198, v196 offset:9504
    ds_write_b16_d16_hi v198, v196 offset:9506
    ds_write_b16 v202, v200 offset:9504
    ds_write_b16_d16_hi v202, v200 offset:9506
    s_mov_b64 exec, -1
    s_mov_b64 exec, 0xffffff
    ds_write_b16 v206, v204 offset:19008
    ds_write_b16_d16_hi v206, v204 offset:19010
    ds_write_b16 v210, v208 offset:19008
    ds_write_b16_d16_hi v210, v208 offset:19010
    ds_write_b16 v214, v212 offset:19008
    ds_write_b16_d16_hi v214, v212 offset:19010
    s_mov_b64 exec, -1
    v_mov_b32 v12, s54
    ds_write_b32 v27, v12
    s_waitcnt vmcnt(4)
    s_barrier
    s_mul_i32 s48, s55, 2
    s_add_u32 m0, s33, 6912
    s_add_u32 s48, s48, s20
    buffer_load_dwordx4 v8, s[4:7], s48 offen lds
    ds_read_b64_tr_b16 a[0:1], v4 offset:0
    ds_read_b64_tr_b16 a[2:3], v4 offset:768
    ds_read_b64_tr_b16 a[4:5], v4 offset:32
    ds_read_b64_tr_b16 a[6:7], v4 offset:800
    ds_read_b64_tr_b16 a[8:9], v5 offset:64
    ds_read_b64_tr_b16 a[10:11], v5 offset:832
    ds_read_b64_tr_b16 a[12:13], v4 offset:6208
    ds_read_b64_tr_b16 a[14:15], v4 offset:6976
    ds_read_b64_tr_b16 a[16:17], v4 offset:6240
    ds_read_b64_tr_b16 a[18:19], v4 offset:7008
    s_mul_i32 s48, s55, 7
    s_add_u32 m0, s33, 24192
    s_add_u32 s48, s48, s20
    buffer_load_dwordx4 v8, s[4:7], s48 offen lds
    ds_read_b64_tr_b16 a[20:21], v5 offset:6272
    ds_read_b64_tr_b16 a[22:23], v5 offset:7040
    ds_read_b64_tr_b16 a[24:25], v4 offset:12416
    ds_read_b64_tr_b16 a[26:27], v4 offset:13184
    ds_read_b64_tr_b16 a[28:29], v4 offset:12448
    ds_read_b64_tr_b16 a[30:31], v4 offset:13216
    ds_read_b64_tr_b16 a[32:33], v5 offset:12480
    ds_read_b64_tr_b16 a[34:35], v5 offset:13248
    ds_read_b64_tr_b16 a[36:37], v4 offset:18624
    ds_read_b64_tr_b16 a[38:39], v4 offset:19392
    s_mul_i32 s48, s55, 3
    s_add_u32 m0, s33, 10368
    s_add_u32 s48, s48, s20
    buffer_load_dwordx4 v8, s[4:7], s48 offen lds
    ds_read_b64_tr_b16 a[40:41], v4 offset:18656
    ds_read_b64_tr_b16 a[42:43], v4 offset:19424
    ds_read_b64_tr_b16 a[44:45], v5 offset:18688
    ds_read_b64_tr_b16 a[46:47], v5 offset:19456
    ds_read_b64_tr_b16 a[48:49], v4 offset:24832
    ds_read_b64_tr_b16 a[50:51], v4 offset:25600
    ds_read_b64_tr_b16 a[52:53], v4 offset:24864
    ds_read_b64_tr_b16 a[54:55], v4 offset:25632
    ds_read_b64_tr_b16 a[56:57], v5 offset:24896
    ds_read_b64_tr_b16 a[58:59], v5 offset:25664
    s_mul_i32 s48, s55, 8
    s_add_u32 m0, s33, 27648
    s_add_u32 s48, s48, s20
    buffer_load_dwordx4 v8, s[4:7], s48 offen lds
    ds_read_b64_tr_b16 a[60:61], v4 offset:31040
    ds_read_b64_tr_b16 a[62:63], v4 offset:31808
    ds_read_b64_tr_b16 a[64:65], v4 offset:31072
    ds_read_b64_tr_b16 a[66:67], v4 offset:31840
    ds_read_b64_tr_b16 a[68:69], v5 offset:31104
    ds_read_b64_tr_b16 a[70:71], v5 offset:31872
    s_mul_i32 s48, s55, 4
    s_add_u32 m0, s33, 13824
    s_add_u32 s48, s48, s20
    buffer_load_dwordx4 v8, s[4:7], s48 offen lds
    s_mul_i32 s48, s55, 9
    s_add_u32 m0, s33, 31104
    s_add_u32 s48, s48, s20
    buffer_load_dwordx4 v8, s[4:7], s48 offen lds
    v_add_u32 v4, 37248, v4
    v_add_u32 v5, 37248, v5
    s_cmp_eq_u32 s28, 1
    s_cbranch_scc0 L_S1_n0
    s_call_b64 s[78:79], L_S1_t0
L_S1_n0:
    s_cmp_eq_u32 s28, 2
    s_cbranch_scc0 L_S1_n1
    s_call_b64 s[78:79], L_S1_t1
L_S1_n1:
    s_waitcnt vmcnt(6)
    s_waitcnt lgkmcnt(0)
    s_barrier
    ds_read_b128 a[144:147], v1 offset:0
    ds_read_b128 a[148:151], v1 offset:64
    ds_read_b128 a[152:155], v1 offset:128
    ds_read_b128 a[156:159], v1 offset:3456
    ds_read_b128 a[160:163], v1 offset:3520
    ds_read_b128 a[164:167], v1 offset:3584
    s_waitcnt lgkmcnt(5)
    v_mfma_f32_16x16x32_bf16 v[116:119], a[144:147], a[0:3], 0
    v_mfma_f32_16x16x32_bf16 v[120:123], a[144:147], a[4:7], 0
    s_add_u32 m0, s44, 126240
    s_bfe_u32 s46, s24, 0x40008
    s_mul_i32 s46, s46, 18432
    v_mfma_f32_16x16x32_bf16 v[124:127], a[144:147], a[8:11], 0
    buffer_load_dwordx4 v7, s[12:15], s46 offen offset:0 lds
    s_waitcnt lgkmcnt(4)
    v_mfma_f32_16x16x32_bf16 v[116:119], a[148:151], a[12:15], v[116:119]
    v_mfma_f32_16x16x32_bf16 v[120:123], a[148:151], a[16:19], v[120:123]
    v_mfma_f32_16x16x32_bf16 v[124:127], a[148:151], a[20:23], v[124:127]
    s_waitcnt lgkmcnt(3)
    v_mfma_f32_16x16x32_bf16 v[116:119], a[152:155], a[24:27], v[116:119]
    buffer_load_dwordx4 v7, s[12:15], s46 offen offset:1024 lds
    v_mfma_f32_16x16x32_bf16 v[120:123], a[152:155], a[28:31], v[120:123]
    v_mfma_f32_16x16x32_bf16 v[124:127], a[152:155], a[32:35], v[124:127]
    v_mfma_f32_16x16x32_bf16 v[128:131], a[144:147], a[36:39], 0
    v_mfma_f32_16x16x32_bf16 v[132:135], a[144:147], a[40:43], 0
    buffer_load_dwordx4 v7, s[12:15], s46 offen offset:2048 lds
    v_mfma_f32_16x16x32_bf16 v[136:139], a[144:147], a[44:47], 0
    ds_read_b64 v[216:217], v3 offset:0
    v_mfma_f32_16x16x32_bf16 v[128:131], a[148:151], a[48:51], v[128:131]
    v_cvt_pk_bf16_f32 v140, v116, v117
    v_cvt_pk_bf16_f32 v141, v118, v119
    v_mfma_f32_16x16x32_bf16 v[132:135], a[148:151], a[52:55], v[132:135]
    v_cvt_pk_bf16_f32 v144, v120, v121
    v_cvt_pk_bf16_f32 v145, v122, v123
    v_mfma_f32_16x16x32_bf16 v[136:139], a[148:151], a[56:59], v[136:139]
    v_cvt_pk_bf16_f32 v148, v124, v125
    v_cvt_pk_bf16_f32 v149, v126, v127
    v_mfma_f32_16x16x32_bf16 v[128:131], a[152:155], a[60:63], v[128:131]
    ds_read_b64 v[218:219], v3 offset:528
    s_add_u32 m0, s44, 138656
    s_add_u32 s64, s46, 12288
    s_bfe_u32 s65, s24, 0x4000c
    s_mul_i32 s65, s65, 18432
    s_sub_u32 s46, s65, 6144
    s_cmp_eq_u32 s30, 0
    s_cselect_b32 s46, s64, s46
    v_mfma_f32_16x16x32_bf16 v[132:135], a[152:155], a[64:67], v[132:135]
    buffer_load_dwordx4 v7, s[12:15], s46 offen offset:0 lds
    v_mfma_f32_16x16x32_bf16 v[136:139], a[152:155], a[68:71], v[136:139]
    s_waitcnt lgkmcnt(4)
    v_mfma_f32_16x16x32_bf16 v[116:119], a[156:159], a[0:3], 0
    buffer_load_dwordx4 v7, s[12:15], s46 offen offset:1024 lds
    v_mfma_f32_16x16x32_bf16 v[120:123], a[156:159], a[4:7], 0
    v_mfma_f32_16x16x32_bf16 v[124:127], a[156:159], a[8:11], 0
    s_waitcnt lgkmcnt(3)
    v_mfma_f32_16x16x32_bf16 v[116:119], a[160:163], a[12:15], v[116:119]
    v_cvt_pk_bf16_f32 v142, v128, v129
    v_cvt_pk_bf16_f32 v143, v130, v131
    v_mfma_f32_16x16x32_bf16 v[120:123], a[160:163], a[16:19], v[120:123]
    v_cvt_pk_bf16_f32 v146, v132, v133
    v_cvt_pk_bf16_f32 v147, v134, v135
    v_mfma_f32_16x16x32_bf16 v[124:127], a[160:163], a[20:23], v[124:127]
    v_cvt_pk_bf16_f32 v150, v136, v137
    v_cvt_pk_bf16_f32 v151, v138, v139
    s_waitcnt lgkmcnt(2)
    v_mfma_f32_16x16x32_bf16 v[116:119], a[164:167], a[24:27], v[116:119]
    buffer_load_dwordx4 v7, s[12:15], s46 offen offset:2048 lds
    v_mfma_f32_16x16x32_bf16 v[120:123], a[164:167], a[28:31], v[120:123]
    s_waitcnt lgkmcnt(0)
    v_mfma_f32_16x16x32_bf16 v[44:47], v[140:143], v[216:219], 0
    s_waitcnt vmcnt(6)
    s_barrier
    s_add_u32 m0, s44, 151072
    s_add_u32 s46, s65, 6144
    v_mfma_f32_16x16x32_bf16 v[48:51], v[144:147], v[216:219], 0
    buffer_load_dwordx4 v7, s[12:15], s46 offen offset:0 lds
    v_mfma_f32_16x16x32_bf16 v[52:55], v[148:151], v[216:219], 0
    ds_read_b128 a[168:171], v1 offset:6912
    v_mfma_f32_16x16x32_bf16 v[124:127], a[164:167], a[32:35], v[124:127]
    ds_read_b64 v[220:221], v3 offset:4752
    v_mfma_f32_16x16x32_bf16 v[128:131], a[156:159], a[36:39], 0
    ds_read_b64 v[222:223], v3 offset:5280
    v_mfma_f32_16x16x32_bf16 v[132:135], a[156:159], a[40:43], 0
    buffer_load_dwordx4 v7, s[12:15], s46 offen offset:1024 lds
    v_mfma_f32_16x16x32_bf16 v[136:139], a[156:159], a[44:47], 0
    ds_read_b128 a[172:175], v1 offset:6976
    v_mfma_f32_16x16x32_bf16 v[128:131], a[160:163], a[48:51], v[128:131]
    v_cvt_pk_bf16_f32 v140, v116, v117
    v_cvt_pk_bf16_f32 v141, v118, v119
    v_mfma_f32_16x16x32_bf16 v[132:135], a[160:163], a[52:55], v[132:135]
    v_cvt_pk_bf16_f32 v144, v120, v121
    v_cvt_pk_bf16_f32 v145, v122, v123
    v_mfma_f32_16x16x32_bf16 v[136:139], a[160:163], a[56:59], v[136:139]
    v_cvt_pk_bf16_f32 v148, v124, v125
    v_cvt_pk_bf16_f32 v149, v126, v127
    v_mfma_f32_16x16x32_bf16 v[128:131], a[164:167], a[60:63], v[128:131]
    buffer_load_dwordx4 v7, s[12:15], s46 offen offset:2048 lds
    v_mfma_f32_16x16x32_bf16 v[132:135], a[164:167], a[64:67], v[132:135]
    s_mul_i32 s48, s55, 10
    s_add_u32 m0, s33, 34560
    s_add_u32 s48, s48, s20
    v_mfma_f32_16x16x32_bf16 v[136:139], a[164:167], a[68:71], v[136:139]
    buffer_load_dwordx4 v8, s[4:7], s48 offen lds
    s_waitcnt lgkmcnt(3)
    v_mfma_f32_16x16x32_bf16 v[116:119], a[168:171], a[0:3], 0
    ds_read_b128 a[176:179], v1 offset:7040
    v_mfma_f32_16x16x32_bf16 v[120:123], a[168:171], a[4:7], 0
    ds_read_b128 a[180:183], v1 offset:10368
    v_mfma_f32_16x16x32_bf16 v[124:127], a[168:171], a[8:11], 0
    s_mul_i32 s48, s55, 11
    s_add_u32 m0, s33, 38016
    s_add_u32 s48, s48, s20
    s_min_u32 s48, s48, s21
    s_waitcnt lgkmcnt(2)
    v_mfma_f32_16x16x32_bf16 v[116:119], a[172:175], a[12:15], v[116:119]
    v_cvt_pk_bf16_f32 v142, v128, v129
    v_cvt_pk_bf16_f32 v143, v130, v131
    buffer_load_dwordx4 v8, s[4:7], s48 offen lds
    v_mfma_f32_16x16x32_bf16 v[120:123], a[172:175], a[16:19], v[120:123]
    v_cvt_pk_bf16_f32 v146, v132, v133
    v_cvt_pk_bf16_f32 v147, v134, v135
    v_mfma_f32_16x16x32_bf16 v[124:127], a[172:175], a[20:23], v[124:127]
    v_cvt_pk_bf16_f32 v150, v136, v137
    v_cvt_pk_bf16_f32 v151, v138, v139
    s_add_u32 m0, s44, 88992
    s_bfe_u32 s46, s24, 0x40010
    s_mul_i32 s46, s46, 18432
    s_waitcnt lgkmcnt(1)
    v_mfma_f32_16x16x32_bf16 v[116:119], a[176:179], a[24:27], v[116:119]
    buffer_load_dwordx4 v7, s[12:15], s46 offen offset:0 lds
    v_mfma_f32_16x16x32_bf16 v[120:123], a[176:179], a[28:31], v[120:123]
    ds_read_b128 a[184:187], v1 offset:10432
    v_mfma_f32_16x16x32_bf16 v[56:59], v[140:143], v[220:223], 0
    ds_read_b128 a[188:191], v1 offset:10496
    v_mfma_f32_16x16x32_bf16 v[60:63], v[144:147], v[220:223], 0
    ds_read_b128 a[192:195], v1 offset:13824
    v_mfma_f32_16x16x32_bf16 v[64:67], v[148:151], v[220:223], 0
    ds_read_b128 a[196:199], v1 offset:13888
    v_mfma_f32_16x16x32_bf16 v[124:127], a[176:179], a[32:35], v[124:127]
    ds_read_b64 v[216:217], v3 offset:9504
    v_mfma_f32_16x16x32_bf16 v[128:131], a[168:171], a[36:39], 0
    ds_read_b64 v[218:219], v3 offset:10032
    v_mfma_f32_16x16x32_bf16 v[132:135], a[168:171], a[40:43], 0
    buffer_load_dwordx4 v7, s[12:15], s46 offen offset:1024 lds
    v_mfma_f32_16x16x32_bf16 v[136:139], a[168:171], a[44:47], 0
    ds_read_b128 a[200:203], v1 offset:13952
    v_mfma_f32_16x16x32_bf16 v[128:131], a[172:175], a[48:51], v[128:131]
    v_cvt_pk_bf16_f32 v140, v116, v117
    v_cvt_pk_bf16_f32 v141, v118, v119
    v_mfma_f32_16x16x32_bf16 v[132:135], a[172:175], a[52:55], v[132:135]
    v_cvt_pk_bf16_f32 v144, v120, v121
    v_cvt_pk_bf16_f32 v145, v122, v123
    v_mfma_f32_16x16x32_bf16 v[136:139], a[172:175], a[56:59], v[136:139]
    v_cvt_pk_bf16_f32 v148, v124, v125
    v_cvt_pk_bf16_f32 v149, v126, v127
    v_mfma_f32_16x16x32_bf16 v[128:131], a[176:179], a[60:63], v[128:131]
    buffer_load_dwordx4 v7, s[12:15], s46 offen offset:2048 lds
    v_mfma_f32_16x16x32_bf16 v[132:135], a[176:179], a[64:67], v[132:135]
    ds_read_b128 a[228:231], v2 offset:0
    v_mfma_f32_16x16x32_bf16 v[136:139], a[176:179], a[68:71], v[136:139]
    ds_read_b128 a[232:235], v2 offset:64
    s_waitcnt lgkmcnt(7)
    v_mfma_f32_16x16x32_bf16 v[116:119], a[180:183], a[0:3], 0
    ds_read_b128 a[236:239], v2 offset:128
    v_mfma_f32_16x16x32_bf16 v[120:123], a[180:183], a[4:7], 0
    s_add_u32 m0, s44, 101408
    s_add_u32 s64, s46, 12288
    s_bfe_u32 s65, s24, 0x40014
    s_mul_i32 s65, s65, 18432
    s_sub_u32 s46, s65, 6144
    s_cmp_eq_u32 s30, 0
    s_cselect_b32 s46, s64, s46
    v_mfma_f32_16x16x32_bf16 v[124:127], a[180:183], a[8:11], 0
    buffer_load_dwordx4 v7, s[12:15], s46 offen offset:0 lds
    v_mfma_f32_16x16x32_bf16 v[116:119], a[184:187], a[12:15], v[116:119]
    v_cvt_pk_bf16_f32 v142, v128, v129
    v_cvt_pk_bf16_f32 v143, v130, v131
    v_mfma_f32_16x16x32_bf16 v[120:123], a[184:187], a[16:19], v[120:123]
    v_cvt_pk_bf16_f32 v146, v132, v133
    v_cvt_pk_bf16_f32 v147, v134, v135
    v_mfma_f32_16x16x32_bf16 v[124:127], a[184:187], a[20:23], v[124:127]
    v_cvt_pk_bf16_f32 v150, v136, v137
    v_cvt_pk_bf16_f32 v151, v138, v139
    v_mfma_f32_16x16x32_bf16 v[116:119], a[188:191], a[24:27], v[116:119]
    v_mfma_f32_16x16x32_bf16 v[120:123], a[188:191], a[28:31], v[120:123]
    s_waitcnt lgkmcnt(4)
    v_mfma_f32_16x16x32_bf16 v[68:71], v[140:143], v[216:219], 0
    buffer_load_dwordx4 v7, s[12:15], s46 offen offset:1024 lds
    v_mfma_f32_16x16x32_bf16 v[72:75], v[144:147], v[216:219], 0
    v_mfma_f32_16x16x32_bf16 v[76:79], v[148:151], v[216:219], 0
    s_waitcnt vmcnt(5)
    s_barrier
    v_mfma_f32_16x16x32_bf16 v[124:127], a[188:191], a[32:35], v[124:127]
    ds_read_b64 v[220:221], v3 offset:14256
    ds_read_b64_tr_b16 a[72:73], v4 offset:0
    v_mfma_f32_16x16x32_bf16 v[128:131], a[180:183], a[36:39], 0
    ds_read_b64 v[222:223], v3 offset:14784
    v_mfma_f32_16x16x32_bf16 v[132:135], a[180:183], a[40:43], 0
    buffer_load_dwordx4 v7, s[12:15], s46 offen offset:2048 lds
    v_mfma_f32_16x16x32_bf16 v[136:139], a[180:183], a[44:47], 0
    ds_read_b64_tr_b16 a[74:75], v4 offset:768
    ds_read_b64_tr_b16 a[76:77], v4 offset:32
    v_mfma_f32_16x16x32_bf16 v[128:131], a[184:187], a[48:51], v[128:131]
    v_cvt_pk_bf16_f32 v140, v116, v117
    v_cvt_pk_bf16_f32 v141, v118, v119
    ds_read_b64_tr_b16 a[78:79], v4 offset:800
    v_mfma_f32_16x16x32_bf16 v[132:135], a[184:187], a[52:55], v[132:135]
    v_cvt_pk_bf16_f32 v144, v120, v121
    v_cvt_pk_bf16_f32 v145, v122, v123
    v_mfma_f32_16x16x32_bf16 v[136:139], a[184:187], a[56:59], v[136:139]
    v_cvt_pk_bf16_f32 v148, v124, v125
    v_cvt_pk_bf16_f32 v149, v126, v127
    v_mfma_f32_16x16x32_bf16 v[128:131], a[188:191], a[60:63], v[128:131]
    s_add_u32 m0, s44, 113824
    s_add_u32 s46, s65, 6144
    ds_read_b64_tr_b16 a[80:81], v5 offset:64
    v_mfma_f32_16x16x32_bf16 v[132:135], a[188:191], a[64:67], v[132:135]
    buffer_load_dwordx4 v7, s[12:15], s46 offen offset:0 lds
    ds_read_b64_tr_b16 a[82:83], v5 offset:832
    v_mfma_f32_16x16x32_bf16 v[136:139], a[188:191], a[68:71], v[136:139]
    ds_read_b64_tr_b16 a[84:85], v4 offset:6208
    v_mfma_f32_16x16x32_bf16 v[116:119], a[192:195], a[0:3], 0
    ds_read_b64_tr_b16 a[86:87], v4 offset:6976
    v_mfma_f32_16x16x32_bf16 v[120:123], a[192:195], a[4:7], 0
    ds_read_b64_tr_b16 a[88:89], v4 offset:6240
    v_mfma_f32_16x16x32_bf16 v[124:127], a[192:195], a[8:11], 0
    ds_read_b64_tr_b16 a[90:91], v4 offset:7008
    ds_read_b64_tr_b16 a[92:93], v5 offset:6272
    v_mfma_f32_16x16x32_bf16 v[116:119], a[196:199], a[12:15], v[116:119]
    v_cvt_pk_bf16_f32 v142, v128, v129
    v_cvt_pk_bf16_f32 v143, v130, v131
    ds_read_b64_tr_b16 a[94:95], v5 offset:7040
    v_mfma_f32_16x16x32_bf16 v[120:123], a[196:199], a[16:19], v[120:123]
    v_cvt_pk_bf16_f32 v146, v132, v133
    v_cvt_pk_bf16_f32 v147, v134, v135
    ds_read_b64_tr_b16 a[96:97], v4 offset:12416
    v_mfma_f32_16x16x32_bf16 v[124:127], a[196:199], a[20:23], v[124:127]
    v_cvt_pk_bf16_f32 v150, v136, v137
    v_cvt_pk_bf16_f32 v151, v138, v139
    s_waitcnt lgkmcnt(7)
    v_mfma_f32_16x16x32_bf16 v[116:119], a[200:203], a[24:27], v[116:119]
    buffer_load_dwordx4 v7, s[12:15], s46 offen offset:1024 lds
    v_mfma_f32_16x16x32_bf16 v[120:123], a[200:203], a[28:31], v[120:123]
    ds_read_b64_tr_b16 a[98:99], v4 offset:13184
    v_mfma_f32_16x16x32_bf16 v[80:83], v[140:143], v[220:223], 0
    ds_read_b64_tr_b16 a[100:101], v4 offset:12448
    ds_read_b64_tr_b16 a[102:103], v4 offset:13216
    v_mfma_f32_16x16x32_bf16 v[84:87], v[144:147], v[220:223], 0
    buffer_load_dwordx4 v7, s[12:15], s46 offen offset:2048 lds
    v_mfma_f32_16x16x32_bf16 v[88:91], v[148:151], v[220:223], 0
    ds_read_b64_tr_b16 a[104:105], v5 offset:12480
    ds_read_b64_tr_b16 a[106:107], v5 offset:13248
    v_mfma_f32_16x16x32_bf16 v[124:127], a[200:203], a[32:35], v[124:127]
    ds_read_b64 v[216:217], v3 offset:19008
    v_mfma_f32_16x16x32_bf16 v[128:131], a[192:195], a[36:39], 0
    ds_read_b64 v[218:219], v3 offset:19536
    v_mfma_f32_16x16x32_bf16 v[132:135], a[192:195], a[40:43], 0
    ds_read_b64_tr_b16 a[108:109], v4 offset:18624
    v_mfma_f32_16x16x32_bf16 v[136:139], a[192:195], a[44:47], 0
    ds_read_b64_tr_b16 a[110:111], v4 offset:19392
    ds_read_b64_tr_b16 a[112:113], v4 offset:18656
    v_mfma_f32_16x16x32_bf16 v[128:131], a[196:199], a[48:51], v[128:131]
    v_cvt_pk_bf16_f32 v140, v116, v117
    v_cvt_pk_bf16_f32 v141, v118, v119
    ds_read_b64_tr_b16 a[114:115], v4 offset:19424
    v_mfma_f32_16x16x32_bf16 v[132:135], a[196:199], a[52:55], v[132:135]
    v_cvt_pk_bf16_f32 v144, v120, v121
    v_cvt_pk_bf16_f32 v145, v122, v123
    v_mfma_f32_16x16x32_bf16 v[136:139], a[196:199], a[56:59], v[136:139]
    v_cvt_pk_bf16_f32 v148, v124, v125
    v_cvt_pk_bf16_f32 v149, v126, v127
    v_mfma_f32_16x16x32_bf16 v[128:131], a[200:203], a[60:63], v[128:131]
    ds_read_b64_tr_b16 a[116:117], v5 offset:18688
    v_mfma_f32_16x16x32_bf16 v[132:135], a[200:203], a[64:67], v[132:135]
    ds_read_b64_tr_b16 a[118:119], v5 offset:19456
    v_mfma_f32_16x16x32_bf16 v[136:139], a[200:203], a[68:71], v[136:139]
    ds_read_b64_tr_b16 a[120:121], v4 offset:24832
    v_mfma_f32_16x16x32_bf16 v[116:119], a[228:231], a[0:3], 0
    ds_read_b64_tr_b16 a[122:123], v4 offset:25600
    v_mfma_f32_16x16x32_bf16 v[120:123], a[228:231], a[4:7], 0
    ds_read_b64_tr_b16 a[124:125], v4 offset:24864
    v_mfma_f32_16x16x32_bf16 v[124:127], a[228:231], a[8:11], 0
    ds_read_b64_tr_b16 a[126:127], v4 offset:25632
    ds_read_b64_tr_b16 a[128:129], v5 offset:24896
    v_mfma_f32_16x16x32_bf16 v[116:119], a[232:235], a[12:15], v[116:119]
    v_cvt_pk_bf16_f32 v142, v128, v129
    v_cvt_pk_bf16_f32 v143, v130, v131
    ds_read_b64_tr_b16 a[130:131], v5 offset:25664
    v_mfma_f32_16x16x32_bf16 v[120:123], a[232:235], a[16:19], v[120:123]
    v_cvt_pk_bf16_f32 v146, v132, v133
    v_cvt_pk_bf16_f32 v147, v134, v135
    v_mfma_f32_16x16x32_bf16 v[124:127], a[232:235], a[20:23], v[124:127]
    v_cvt_pk_bf16_f32 v150, v136, v137
    v_cvt_pk_bf16_f32 v151, v138, v139
    v_mfma_f32_16x16x32_bf16 v[116:119], a[236:239], a[24:27], v[116:119]
    ds_read_b64_tr_b16 a[132:133], v4 offset:31040
    v_mfma_f32_16x16x32_bf16 v[120:123], a[236:239], a[28:31], v[120:123]
    ds_read_b64_tr_b16 a[134:135], v4 offset:31808
    s_waitcnt lgkmcnt(7)
    v_mfma_f32_16x16x32_bf16 v[92:95], v[140:143], v[216:219], 0
    ds_read_b64_tr_b16 a[136:137], v4 offset:31072
    v_mfma_f32_16x16x32_bf16 v[96:99], v[144:147], v[216:219], 0
    ds_read_b64_tr_b16 a[138:139], v4 offset:31840
    v_mfma_f32_16x16x32_bf16 v[100:103], v[148:151], v[216:219], 0
    ds_read_b64_tr_b16 a[140:141], v5 offset:31104
    ds_read_b64_tr_b16 a[142:143], v5 offset:31872
    v_mfma_f32_16x16x32_bf16 v[124:127], a[236:239], a[32:35], v[124:127]
    ds_read_b32 v220, v9 offset:0
    v_add_u32 v4, -37248, v4
    v_mfma_f32_16x16x32_bf16 v[128:131], a[228:231], a[36:39], 0
    ds_read_b32 v221, v10 offset:0
    v_add_u32 v5, -37248, v5
    v_mfma_f32_16x16x32_bf16 v[132:135], a[228:231], a[40:43], 0
    ds_read_b32 v222, v9 offset:528
    ds_read_b128 a[204:207], v1 offset:17280
    v_mfma_f32_16x16x32_bf16 v[136:139], a[228:231], a[44:47], 0
    ds_read_b32 v223, v10 offset:528
    ds_read_b128 a[208:211], v1 offset:17344
    v_mfma_f32_16x16x32_bf16 v[128:131], a[232:235], a[48:51], v[128:131]
    v_cvt_pk_bf16_f32 v140, v116, v117
    v_cvt_pk_bf16_f32 v141, v118, v119
    ds_read_b128 a[212:215], v1 offset:17408
    v_mfma_f32_16x16x32_bf16 v[132:135], a[232:235], a[52:55], v[132:135]
    v_cvt_pk_bf16_f32 v144, v120, v121
    v_cvt_pk_bf16_f32 v145, v122, v123
    v_mfma_f32_16x16x32_bf16 v[136:139], a[232:235], a[56:59], v[136:139]
    v_cvt_pk_bf16_f32 v148, v124, v125
    v_cvt_pk_bf16_f32 v149, v126, v127
    v_mfma_f32_16x16x32_bf16 v[128:131], a[236:239], a[60:63], v[128:131]
    v_mfma_f32_16x16x32_bf16 v[132:135], a[236:239], a[64:67], v[132:135]
    s_branch L_S1_s0
L_S1_t0:
    s_setpc_b64 s[78:79]
L_S1_s0:
    v_mfma_f32_16x16x32_bf16 v[136:139], a[236:239], a[68:71], v[136:139]
    s_waitcnt vmcnt(0)
    s_waitcnt lgkmcnt(0)
    s_barrier
    v_mfma_f32_16x16x32_bf16 v[116:119], a[144:147], a[72:75], 0
    v_mfma_f32_16x16x32_bf16 v[120:123], a[144:147], a[76:79], 0
    v_mfma_f32_16x16x32_bf16 v[124:127], a[144:147], a[80:83], 0
    v_mfma_f32_16x16x32_bf16 v[116:119], a[148:151], a[84:87], v[116:119]
    v_cvt_pk_bf16_f32 v142, v128, v129
    v_cvt_pk_bf16_f32 v143, v130, v131
    v_mfma_f32_16x16x32_bf16 v[120:123], a[148:151], a[88:91], v[120:123]
    v_cvt_pk_bf16_f32 v146, v132, v133
    v_cvt_pk_bf16_f32 v147, v134, v135
    v_mfma_f32_16x16x32_bf16 v[124:127], a[148:151], a[92:95], v[124:127]
    v_cvt_pk_bf16_f32 v150, v136, v137
    v_cvt_pk_bf16_f32 v151, v138, v139
    s_add_u32 m0, s44, 126240
    s_bfe_u32 s46, s24, 0x40018
    s_mul_i32 s46, s46, 18432
    v_mfma_f32_16x16x32_bf16 v[116:119], a[152:155], a[96:99], v[116:119]
    buffer_load_dwordx4 v7, s[12:15], s46 offen offset:0 lds
    v_mfma_f32_16x16x32_bf16 v[120:123], a[152:155], a[100:103], v[120:123]
    v_mfma_f32_16x16x32_bf16 v[104:107], v[220:223], v[140:143], 0
    v_mfma_f32_16x16x32_bf16 v[108:111], v[220:223], v[144:147], 0
    v_mfma_f32_16x16x32_bf16 v[112:115], v[220:223], v[148:151], 0
    buffer_load_dwordx4 v7, s[12:15], s46 offen offset:1024 lds
    v_mfma_f32_16x16x32_bf16 v[124:127], a[152:155], a[104:107], v[124:127]
    ds_read_b64 v[216:217], v3 offset:1056
    v_mfma_f32_16x16x32_bf16 v[128:131], a[156:159], a[108:111], 0
    ds_read_b64 v[218:219], v3 offset:1584
    v_mfma_f32_16x16x32_bf16 v[132:135], a[156:159], a[112:115], 0
    ds_read_b128 a[216:219], v1 offset:20736
    v_mfma_f32_16x16x32_bf16 v[136:139], a[156:159], a[116:119], 0
    ds_read_b128 a[220:223], v1 offset:20800
    v_mfma_f32_16x16x32_bf16 v[128:131], a[160:163], a[120:123], v[128:131]
    v_cvt_pk_bf16_f32 v140, v116, v117
    v_cvt_pk_bf16_f32 v141, v118, v119
    v_mfma_f32_16x16x32_bf16 v[132:135], a[160:163], a[124:127], v[132:135]
    v_cvt_pk_bf16_f32 v144, v120, v121
    v_cvt_pk_bf16_f32 v145, v122, v123
    v_mfma_f32_16x16x32_bf16 v[136:139], a[160:163], a[128:131], v[136:139]
    v_cvt_pk_bf16_f32 v148, v124, v125
    v_cvt_pk_bf16_f32 v149, v126, v127
    v_mfma_f32_16x16x32_bf16 v[128:131], a[164:167], a[132:135], v[128:131]
    buffer_load_dwordx4 v7, s[12:15], s46 offen offset:2048 lds
    v_mfma_f32_16x16x32_bf16 v[132:135], a[164:167], a[136:139], v[132:135]
    ds_read_b128 a[224:227], v1 offset:20864
    v_mfma_f32_16x16x32_bf16 v[136:139], a[164:167], a[140:143], v[136:139]
    ds_read_b128 a[240:243], v2 offset:3456
    v_mfma_f32_16x16x32_bf16 v[116:119], a[156:159], a[72:75], 0
    ds_read_b128 a[244:247], v2 offset:3520
    v_mfma_f32_16x16x32_bf16 v[120:123], a[156:159], a[76:79], 0
    ds_read_b128 a[248:251], v2 offset:3584
    v_mfma_f32_16x16x32_bf16 v[124:127], a[156:159], a[80:83], 0
    ds_read_b128 a[228:231], v2 offset:6912
    v_mfma_f32_16x16x32_bf16 v[116:119], a[160:163], a[84:87], v[116:119]
    v_cvt_pk_bf16_f32 v142, v128, v129
    v_cvt_pk_bf16_f32 v143, v130, v131
    v_mfma_f32_16x16x32_bf16 v[120:123], a[160:163], a[88:91], v[120:123]
    v_cvt_pk_bf16_f32 v146, v132, v133
    v_cvt_pk_bf16_f32 v147, v134, v135
    v_mfma_f32_16x16x32_bf16 v[124:127], a[160:163], a[92:95], v[124:127]
    v_cvt_pk_bf16_f32 v150, v136, v137
    v_cvt_pk_bf16_f32 v151, v138, v139
    s_add_u32 m0, s44, 138656
    s_add_u32 s64, s46, 12288
    s_bfe_u32 s65, s24, 0x4001c
    s_mul_i32 s65, s65, 18432
    s_sub_u32 s46, s65, 6144
    s_cmp_eq_u32 s30, 0
    s_cselect_b32 s46, s64, s46
    v_mfma_f32_16x16x32_bf16 v[116:119], a[164:167], a[96:99], v[116:119]
    buffer_load_dwordx4 v7, s[12:15], s46 offen offset:0 lds
    v_mfma_f32_16x16x32_bf16 v[120:123], a[164:167], a[100:103], v[120:123]
    ds_read_b128 a[232:235], v2 offset:6976
    s_waitcnt lgkmcnt(7)
    v_mfma_f32_16x16x32_bf16 v[44:47], v[140:143], v[216:219], v[44:47]
    ds_read_b128 a[236:239], v2 offset:7040
    v_mfma_f32_16x16x32_bf16 v[48:51], v[144:147], v[216:219], v[48:51]
    v_mov_b32 v14, 163488
    v_mfma_f32_16x16x32_bf16 v[52:55], v[148:151], v[216:219], v[52:55]
    ds_read_b128 v[228:231], v14
    v_mfma_f32_16x16x32_bf16 v[124:127], a[164:167], a[104:107], v[124:127]
    ds_read_b64 v[220:221], v3 offset:5808
    v_mfma_f32_16x16x32_bf16 v[128:131], a[168:171], a[108:111], 0
    ds_read_b64 v[222:223], v3 offset:6336
    v_mfma_f32_16x16x32_bf16 v[132:135], a[168:171], a[112:115], 0
    buffer_load_dwordx4 v7, s[12:15], s46 offen offset:1024 lds
    v_mfma_f32_16x16x32_bf16 v[136:139], a[168:171], a[116:119], 0
    ds_read_b64_tr_b16 a[0:1], v4 offset:0
    ds_read_b64_tr_b16 a[2:3], v4 offset:768
    v_mfma_f32_16x16x32_bf16 v[128:131], a[172:175], a[120:123], v[128:131]
    v_cvt_pk_bf16_f32 v140, v116, v117
    v_cvt_pk_bf16_f32 v141, v118, v119
    ds_read_b64_tr_b16 a[4:5], v4 offset:32
    v_mfma_f32_16x16x32_bf16 v[132:135], a[172:175], a[124:127], v[132:135]
    v_cvt_pk_bf16_f32 v144, v120, v121
    v_cvt_pk_bf16_f32 v145, v122, v123
    v_mfma_f32_16x16x32_bf16 v[136:139], a[172:175], a[128:131], v[136:139]
    v_cvt_pk_bf16_f32 v148, v124, v125
    v_cvt_pk_bf16_f32 v149, v126, v127
    v_mfma_f32_16x16x32_bf16 v[128:131], a[176:179], a[132:135], v[128:131]
    buffer_load_dwordx4 v7, s[12:15], s46 offen offset:2048 lds
    v_mfma_f32_16x16x32_bf16 v[132:135], a[176:179], a[136:139], v[132:135]
    ds_read_b64_tr_b16 a[6:7], v4 offset:800
    v_mfma_f32_16x16x32_bf16 v[136:139], a[176:179], a[140:143], v[136:139]
    ds_read_b64_tr_b16 a[8:9], v5 offset:64
    v_mfma_f32_16x16x32_bf16 v[116:119], a[168:171], a[72:75], 0
    ds_read_b64_tr_b16 a[10:11], v5 offset:832
    v_mfma_f32_16x16x32_bf16 v[120:123], a[168:171], a[76:79], 0
    ds_read_b64_tr_b16 a[12:13], v4 offset:6208
    v_mfma_f32_16x16x32_bf16 v[124:127], a[168:171], a[80:83], 0
    ds_read_b64_tr_b16 a[14:15], v4 offset:6976
    v_mfma_f32_16x16x32_bf16 v[116:119], a[172:175], a[84:87], v[116:119]
    v_cvt_pk_bf16_f32 v142, v128, v129
    v_cvt_pk_bf16_f32 v143, v130, v131
    v_mfma_f32_16x16x32_bf16 v[120:123], a[172:175], a[88:91], v[120:123]
    v_cvt_pk_bf16_f32 v146, v132, v133
    v_cvt_pk_bf16_f32 v147, v134, v135
    v_mfma_f32_16x16x32_bf16 v[124:127], a[172:175], a[92:95], v[124:127]
    v_cvt_pk_bf16_f32 v150, v136, v137
    v_cvt_pk_bf16_f32 v151, v138, v139
    s_add_u32 m0, s44, 151072
    s_add_u32 s46, s65, 6144
    v_mfma_f32_16x16x32_bf16 v[116:119], a[176:179], a[96:99], v[116:119]
    buffer_load_dwordx4 v7, s[12:15], s46 offen offset:0 lds
    v_mfma_f32_16x16x32_bf16 v[120:123], a[176:179], a[100:103], v[120:123]
    ds_read_b64_tr_b16 a[16:17], v4 offset:6240
    s_waitcnt lgkmcnt(7)
    v_mfma_f32_16x16x32_bf16 v[56:59], v[140:143], v[220:223], v[56:59]
    ds_read_b64_tr_b16 a[18:19], v4 offset:7008
    v_mfma_f32_16x16x32_bf16 v[60:63], v[144:147], v[220:223], v[60:63]
    ds_read_b64_tr_b16 a[20:21], v5 offset:6272
    v_mfma_f32_16x16x32_bf16 v[64:67], v[148:151], v[220:223], v[64:67]
    ds_read_b64_tr_b16 a[22:23], v5 offset:7040
    v_mfma_f32_16x16x32_bf16 v[124:127], a[176:179], a[104:107], v[124:127]
    ds_read_b64 v[216:217], v3 offset:10560
    v_mfma_f32_16x16x32_bf16 v[128:131], a[180:183], a[108:111], 0
    ds_read_b64 v[218:219], v3 offset:11088
    v_mfma_f32_16x16x32_bf16 v[132:135], a[180:183], a[112:115], 0
    buffer_load_dwordx4 v7, s[12:15], s46 offen offset:1024 lds
    v_mfma_f32_16x16x32_bf16 v[136:139], a[180:183], a[116:119], 0
    ds_read_b64_tr_b16 a[24:25], v4 offset:12416
    ds_read_b64_tr_b16 a[26:27], v4 offset:13184
    v_mfma_f32_16x16x32_bf16 v[128:131], a[184:187], a[120:123], v[128:131]
    v_cvt_pk_bf16_f32 v140, v116, v117
    v_cvt_pk_bf16_f32 v141, v118, v119
    v_mfma_f32_16x16x32_bf16 v[132:135], a[184:187], a[124:127], v[132:135]
    v_cvt_pk_bf16_f32 v144, v120, v121
    v_cvt_pk_bf16_f32 v145, v122, v123
    v_mfma_f32_16x16x32_bf16 v[136:139], a[184:187], a[128:131], v[136:139]
    v_cvt_pk_bf16_f32 v148, v124, v125
    v_cvt_pk_bf16_f32 v149, v126, v127
    v_mfma_f32_16x16x32_bf16 v[128:131], a[188:191], a[132:135], v[128:131]
    ds_read_b64_tr_b16 a[28:29], v4 offset:12448
    v_mfma_f32_16x16x32_bf16 v[132:135], a[188:191], a[136:139], v[132:135]
    buffer_load_dwordx4 v7, s[12:15], s46 offen offset:2048 lds
    v_mfma_f32_16x16x32_bf16 v[136:139], a[188:191], a[140:143], v[136:139]
    ds_read_b64_tr_b16 a[30:31], v4 offset:13216
    v_mfma_f32_16x16x32_bf16 v[116:119], a[180:183], a[72:75], 0
    ds_read_b64_tr_b16 a[32:33], v5 offset:12480
    v_mfma_f32_16x16x32_bf16 v[120:123], a[180:183], a[76:79], 0
    ds_read_b64_tr_b16 a[34:35], v5 offset:13248
    v_mfma_f32_16x16x32_bf16 v[124:127], a[180:183], a[80:83], 0
    ds_read_b64_tr_b16 a[36:37], v4 offset:18624
    v_mfma_f32_16x16x32_bf16 v[116:119], a[184:187], a[84:87], v[116:119]
    v_cvt_pk_bf16_f32 v142, v128, v129
    v_cvt_pk_bf16_f32 v143, v130, v131
    v_mfma_f32_16x16x32_bf16 v[120:123], a[184:187], a[88:91], v[120:123]
    v_cvt_pk_bf16_f32 v146, v132, v133
    v_cvt_pk_bf16_f32 v147, v134, v135
    v_mfma_f32_16x16x32_bf16 v[124:127], a[184:187], a[92:95], v[124:127]
    v_cvt_pk_bf16_f32 v150, v136, v137
    v_cvt_pk_bf16_f32 v151, v138, v139
    v_mfma_f32_16x16x32_bf16 v[116:119], a[188:191], a[96:99], v[116:119]
    ds_read_b64_tr_b16 a[38:39], v4 offset:19392
    v_mfma_f32_16x16x32_bf16 v[120:123], a[188:191], a[100:103], v[120:123]
    ds_read_b64_tr_b16 a[40:41], v4 offset:18656
    s_waitcnt lgkmcnt(7)
    v_mfma_f32_16x16x32_bf16 v[68:71], v[140:143], v[216:219], v[68:71]
    ds_read_b64_tr_b16 a[42:43], v4 offset:19424
    v_mfma_f32_16x16x32_bf16 v[72:75], v[144:147], v[216:219], v[72:75]
    ds_read_b64_tr_b16 a[44:45], v5 offset:18688
    v_mfma_f32_16x16x32_bf16 v[76:79], v[148:151], v[216:219], v[76:79]
    ds_read_b64_tr_b16 a[46:47], v5 offset:19456
    v_mfma_f32_16x16x32_bf16 v[124:127], a[188:191], a[104:107], v[124:127]
    ds_read_b64 v[220:221], v3 offset:15312
    v_mfma_f32_16x16x32_bf16 v[128:131], a[192:195], a[108:111], 0
    ds_read_b64 v[222:223], v3 offset:15840
    v_mfma_f32_16x16x32_bf16 v[132:135], a[192:195], a[112:115], 0
    ds_read_b64_tr_b16 a[48:49], v4 offset:24832
    v_mfma_f32_16x16x32_bf16 v[136:139], a[192:195], a[116:119], 0
    ds_read_b64_tr_b16 a[50:51], v4 offset:25600
    v_mfma_f32_16x16x32_bf16 v[128:131], a[196:199], a[120:123], v[128:131]
    v_cvt_pk_bf16_f32 v140, v116, v117
    v_cvt_pk_bf16_f32 v141, v118, v119
    v_mfma_f32_16x16x32_bf16 v[132:135], a[196:199], a[124:127], v[132:135]
    v_cvt_pk_bf16_f32 v144, v120, v121
    v_cvt_pk_bf16_f32 v145, v122, v123
    v_mfma_f32_16x16x32_bf16 v[136:139], a[196:199], a[128:131], v[136:139]
    v_cvt_pk_bf16_f32 v148, v124, v125
    v_cvt_pk_bf16_f32 v149, v126, v127
    v_mfma_f32_16x16x32_bf16 v[128:131], a[200:203], a[132:135], v[128:131]
    ds_read_b64_tr_b16 a[52:53], v4 offset:24864
    v_mfma_f32_16x16x32_bf16 v[132:135], a[200:203], a[136:139], v[132:135]
    ds_read_b64_tr_b16 a[54:55], v4 offset:25632
    v_mfma_f32_16x16x32_bf16 v[136:139], a[200:203], a[140:143], v[136:139]
    ds_read_b64_tr_b16 a[56:57], v5 offset:24896
    v_mfma_f32_16x16x32_bf16 v[116:119], a[192:195], a[72:75], 0
    ds_read_b64_tr_b16 a[58:59], v5 offset:25664
    v_mfma_f32_16x16x32_bf16 v[120:123], a[192:195], a[76:79], 0
    v_mfma_f32_16x16x32_bf16 v[124:127], a[192:195], a[80:83], 0
    ds_read_b64_tr_b16 a[60:61], v4 offset:31040
    v_mfma_f32_16x16x32_bf16 v[116:119], a[196:199], a[84:87], v[116:119]
    v_cvt_pk_bf16_f32 v142, v128, v129
    v_cvt_pk_bf16_f32 v143, v130, v131
    v_mfma_f32_16x16x32_bf16 v[120:123], a[196:199], a[88:91], v[120:123]
    v_cvt_pk_bf16_f32 v146, v132, v133
    v_cvt_pk_bf16_f32 v147, v134, v135
    v_mfma_f32_16x16x32_bf16 v[124:127], a[196:199], a[92:95], v[124:127]
    v_cvt_pk_bf16_f32 v150, v136, v137
    v_cvt_pk_bf16_f32 v151, v138, v139
    v_mfma_f32_16x16x32_bf16 v[116:119], a[200:203], a[96:99], v[116:119]
    ds_read_b64_tr_b16 a[62:63], v4 offset:31808
    v_mfma_f32_16x16x32_bf16 v[120:123], a[200:203], a[100:103], v[120:123]
    ds_read_b64_tr_b16 a[64:65], v4 offset:31072
    s_waitcnt lgkmcnt(7)
    v_mfma_f32_16x16x32_bf16 v[80:83], v[140:143], v[220:223], v[80:83]
    ds_read_b64_tr_b16 a[66:67], v4 offset:31840
    v_mfma_f32_16x16x32_bf16 v[84:87], v[144:147], v[220:223], v[84:87]
    ds_read_b64_tr_b16 a[68:69], v5 offset:31104
    v_mfma_f32_16x16x32_bf16 v[88:91], v[148:151], v[220:223], v[88:91]
    v_mfma_f32_16x16x32_bf16 v[124:127], a[200:203], a[104:107], v[124:127]
    ds_read_b64 v[216:217], v3 offset:20064
    v_mfma_f32_16x16x32_bf16 v[128:131], a[204:207], a[108:111], 0
    ds_read_b64 v[218:219], v3 offset:20592
    v_mfma_f32_16x16x32_bf16 v[132:135], a[204:207], a[112:115], 0
    ds_read_b64_tr_b16 a[70:71], v5 offset:31872
    v_mfma_f32_16x16x32_bf16 v[136:139], a[204:207], a[116:119], 0
    v_add_u32 v4, 37248, v4
    v_mfma_f32_16x16x32_bf16 v[128:131], a[208:211], a[120:123], v[128:131]
    v_cvt_pk_bf16_f32 v140, v116, v117
    v_cvt_pk_bf16_f32 v141, v118, v119
    v_add_u32 v5, 37248, v5
    v_mfma_f32_16x16x32_bf16 v[132:135], a[208:211], a[124:127], v[132:135]
    v_cvt_pk_bf16_f32 v144, v120, v121
    v_cvt_pk_bf16_f32 v145, v122, v123
    v_mfma_f32_16x16x32_bf16 v[136:139], a[208:211], a[128:131], v[136:139]
    v_cvt_pk_bf16_f32 v148, v124, v125
    v_cvt_pk_bf16_f32 v149, v126, v127
    v_mfma_f32_16x16x32_bf16 v[128:131], a[212:215], a[132:135], v[128:131]
    v_mfma_f32_16x16x32_bf16 v[132:135], a[212:215], a[136:139], v[132:135]
    v_mfma_f32_16x16x32_bf16 v[136:139], a[212:215], a[140:143], v[136:139]
    s_waitcnt vmcnt(0)
    s_waitcnt lgkmcnt(0)
    s_barrier
    v_mfma_f32_16x16x32_bf16 v[116:119], a[156:159], a[0:3], 0
    ds_read_b64_tr_b16 a[72:73], v4 offset:0
    v_mfma_f32_16x16x32_bf16 v[120:123], a[156:159], a[4:7], 0
    s_add_u32 m0, s44, 88992
    s_bfe_u32 s46, s25, 0x40000
    s_mul_i32 s46, s46, 18432
    v_mfma_f32_16x16x32_bf16 v[124:127], a[156:159], a[8:11], 0
    buffer_load_dwordx4 v7, s[12:15], s46 offen offset:0 lds
    ds_read_b64_tr_b16 a[74:75], v4 offset:768
    v_mfma_f32_16x16x32_bf16 v[116:119], a[160:163], a[12:15], v[116:119]
    v_cvt_pk_bf16_f32 v142, v128, v129
    v_cvt_pk_bf16_f32 v143, v130, v131
    v_mfma_f32_16x16x32_bf16 v[120:123], a[160:163], a[16:19], v[120:123]
    v_cvt_pk_bf16_f32 v146, v132, v133
    v_cvt_pk_bf16_f32 v147, v134, v135
    v_mfma_f32_16x16x32_bf16 v[124:127], a[160:163], a[20:23], v[124:127]
    v_cvt_pk_bf16_f32 v150, v136, v137
    v_cvt_pk_bf16_f32 v151, v138, v139
    v_mfma_f32_16x16x32_bf16 v[116:119], a[164:167], a[24:27], v[116:119]
    ds_read_b64_tr_b16 a[76:77], v4 offset:32
    v_mfma_f32_16x16x32_bf16 v[120:123], a[164:167], a[28:31], v[120:123]
    buffer_load_dwordx4 v7, s[12:15], s46 offen offset:1024 lds
    v_mfma_f32_16x16x32_bf16 v[92:95], v[140:143], v[216:219], v[92:95]
    ds_read_b64_tr_b16 a[78:79], v4 offset:800
    v_mfma_f32_16x16x32_bf16 v[96:99], v[144:147], v[216:219], v[96:99]
    ds_read_b64_tr_b16 a[80:81], v5 offset:64
    v_mfma_f32_16x16x32_bf16 v[100:103], v[148:151], v[216:219], v[100:103]
    ds_read_b64_tr_b16 a[82:83], v5 offset:832
    ds_read_b64_tr_b16 a[84:85], v4 offset:6208
    v_mfma_f32_16x16x32_bf16 v[124:127], a[164:167], a[32:35], v[124:127]
    ds_read_b64 v[220:221], v3 offset:2112
    v_mfma_f32_16x16x32_bf16 v[128:131], a[156:159], a[36:39], 0
    ds_read_b64 v[222:223], v3 offset:2640
    v_mfma_f32_16x16x32_bf16 v[132:135], a[156:159], a[40:43], 0
    buffer_load_dwordx4 v7, s[12:15], s46 offen offset:2048 lds
    v_mfma_f32_16x16x32_bf16 v[136:139], a[156:159], a[44:47], 0
    ds_read_b64_tr_b16 a[86:87], v4 offset:6976
    ds_read_b64_tr_b16 a[88:89], v4 offset:6240
    v_mfma_f32_16x16x32_bf16 v[128:131], a[160:163], a[48:51], v[128:131]
    v_cvt_pk_bf16_f32 v140, v116, v117
    v_cvt_pk_bf16_f32 v141, v118, v119
    ds_read_b64_tr_b16 a[90:91], v4 offset:7008
    v_mfma_f32_16x16x32_bf16 v[132:135], a[160:163], a[52:55], v[132:135]
    v_cvt_pk_bf16_f32 v144, v120, v121
    v_cvt_pk_bf16_f32 v145, v122, v123
    v_mfma_f32_16x16x32_bf16 v[136:139], a[160:163], a[56:59], v[136:139]
    v_cvt_pk_bf16_f32 v148, v124, v125
    v_cvt_pk_bf16_f32 v149, v126, v127
    s_add_u32 m0, s44, 101408
    s_add_u32 s64, s46, 12288
    s_mov_b32 s46, 2130706432
    s_cmp_eq_u32 s30, 0
    s_cselect_b32 s46, s64, s46
    v_mfma_f32_16x16x32_bf16 v[128:131], a[164:167], a[60:63], v[128:131]
    buffer_load_dwordx4 v7, s[12:15], s46 offen offset:0 lds
    v_mfma_f32_16x16x32_bf16 v[132:135], a[164:167], a[64:67], v[132:135]
    ds_read_b64_tr_b16 a[92:93], v5 offset:6272
    v_mfma_f32_16x16x32_bf16 v[136:139], a[164:167], a[68:71], v[136:139]
    ds_read_b64_tr_b16 a[94:95], v5 offset:7040
    v_mfma_f32_16x16x32_bf16 v[116:119], a[168:171], a[0:3], 0
    ds_read_b64_tr_b16 a[96:97], v4 offset:12416
    v_mfma_f32_16x16x32_bf16 v[120:123], a[168:171], a[4:7], 0
    buffer_load_dwordx4 v7, s[12:15], s46 offen offset:1024 lds
    v_mfma_f32_16x16x32_bf16 v[124:127], a[168:171], a[8:11], 0
    ds_read_b64_tr_b16 a[98:99], v4 offset:13184
    ds_read_b64_tr_b16 a[100:101], v4 offset:12448
    v_mfma_f32_16x16x32_bf16 v[116:119], a[172:175], a[12:15], v[116:119]
    v_cvt_pk_bf16_f32 v142, v128, v129
    v_cvt_pk_bf16_f32 v143, v130, v131
    v_mfma_f32_16x16x32_bf16 v[120:123], a[172:175], a[16:19], v[120:123]
    v_cvt_pk_bf16_f32 v146, v132, v133
    v_cvt_pk_bf16_f32 v147, v134, v135
    v_mfma_f32_16x16x32_bf16 v[124:127], a[172:175], a[20:23], v[124:127]
    v_cvt_pk_bf16_f32 v150, v136, v137
    v_cvt_pk_bf16_f32 v151, v138, v139
    v_mfma_f32_16x16x32_bf16 v[116:119], a[176:179], a[24:27], v[116:119]
    buffer_load_dwordx4 v7, s[12:15], s46 offen offset:2048 lds
    v_mfma_f32_16x16x32_bf16 v[120:123], a[176:179], a[28:31], v[120:123]
    ds_read_b64_tr_b16 a[102:103], v4 offset:13216
    s_waitcnt lgkmcnt(7)
    v_mfma_f32_16x16x32_bf16 v[44:47], v[140:143], v[220:223], v[44:47]
    ds_read_b64_tr_b16 a[104:105], v5 offset:12480
    v_mfma_f32_16x16x32_bf16 v[48:51], v[144:147], v[220:223], v[48:51]
    ds_read_b64_tr_b16 a[106:107], v5 offset:13248
    v_mfma_f32_16x16x32_bf16 v[52:55], v[148:151], v[220:223], v[52:55]
    ds_read_b64_tr_b16 a[108:109], v4 offset:18624
    v_mfma_f32_16x16x32_bf16 v[124:127], a[176:179], a[32:35], v[124:127]
    ds_read_b64 v[216:217], v3 offset:6864
    v_mfma_f32_16x16x32_bf16 v[128:131], a[168:171], a[36:39], 0
    ds_read_b64 v[218:219], v3 offset:7392
    v_mfma_f32_16x16x32_bf16 v[132:135], a[168:171], a[40:43], 0
    ds_read_b64_tr_b16 a[110:111], v4 offset:19392
    v_mfma_f32_16x16x32_bf16 v[136:139], a[168:171], a[44:47], 0
    ds_read_b64_tr_b16 a[112:113], v4 offset:18656
    ds_read_b64_tr_b16 a[114:115], v4 offset:19424
    v_mfma_f32_16x16x32_bf16 v[128:131], a[172:175], a[48:51], v[128:131]
    v_cvt_pk_bf16_f32 v140, v116, v117
    v_cvt_pk_bf16_f32 v141, v118, v119
    v_mfma_f32_16x16x32_bf16 v[132:135], a[172:175], a[52:55], v[132:135]
    v_cvt_pk_bf16_f32 v144, v120, v121
    v_cvt_pk_bf16_f32 v145, v122, v123
    v_mfma_f32_16x16x32_bf16 v[136:139], a[172:175], a[56:59], v[136:139]
    v_cvt_pk_bf16_f32 v148, v124, v125
    v_cvt_pk_bf16_f32 v149, v126, v127
    v_mfma_f32_16x16x32_bf16 v[128:131], a[176:179], a[60:63], v[128:131]
    ds_read_b64_tr_b16 a[116:117], v5 offset:18688
    v_mfma_f32_16x16x32_bf16 v[132:135], a[176:179], a[64:67], v[132:135]
    ds_read_b64_tr_b16 a[118:119], v5 offset:19456
    v_mfma_f32_16x16x32_bf16 v[136:139], a[176:179], a[68:71], v[136:139]
    ds_read_b64_tr_b16 a[120:121], v4 offset:24832
    v_mfma_f32_16x16x32_bf16 v[116:119], a[180:183], a[0:3], 0
    ds_read_b64_tr_b16 a[122:123], v4 offset:25600
    v_mfma_f32_16x16x32_bf16 v[120:123], a[180:183], a[4:7], 0
    ds_read_b64_tr_b16 a[124:125], v4 offset:24864
    v_mfma_f32_16x16x32_bf16 v[124:127], a[180:183], a[8:11], 0
    ds_read_b64_tr_b16 a[126:127], v4 offset:25632
    v_mfma_f32_16x16x32_bf16 v[116:119], a[184:187], a[12:15], v[116:119]
    v_cvt_pk_bf16_f32 v142, v128, v129
    v_cvt_pk_bf16_f32 v143, v130, v131
    v_mfma_f32_16x16x32_bf16 v[120:123], a[184:187], a[16:19], v[120:123]
    v_cvt_pk_bf16_f32 v146, v132, v133
    v_cvt_pk_bf16_f32 v147, v134, v135
    v_mfma_f32_16x16x32_bf16 v[124:127], a[184:187], a[20:23], v[124:127]
    v_cvt_pk_bf16_f32 v150, v136, v137
    v_cvt_pk_bf16_f32 v151, v138, v139
    v_mfma_f32_16x16x32_bf16 v[116:119], a[188:191], a[24:27], v[116:119]
    ds_read_b64_tr_b16 a[128:129], v5 offset:24896
    v_mfma_f32_16x16x32_bf16 v[120:123], a[188:191], a[28:31], v[120:123]
    ds_read_b64_tr_b16 a[130:131], v5 offset:25664
    s_waitcnt lgkmcnt(7)
    v_mfma_f32_16x16x32_bf16 v[56:59], v[140:143], v[216:219], v[56:59]
    ds_read_b64_tr_b16 a[132:133], v4 offset:31040
    v_mfma_f32_16x16x32_bf16 v[60:63], v[144:147], v[216:219], v[60:63]
    ds_read_b64_tr_b16 a[134:135], v4 offset:31808
    v_mfma_f32_16x16x32_bf16 v[64:67], v[148:151], v[216:219], v[64:67]
    v_mfma_f32_16x16x32_bf16 v[124:127], a[188:191], a[32:35], v[124:127]
    ds_read_b64 v[220:221], v3 offset:11616
    v_mfma_f32_16x16x32_bf16 v[128:131], a[180:183], a[36:39], 0
    ds_read_b64 v[222:223], v3 offset:12144
    v_mfma_f32_16x16x32_bf16 v[132:135], a[180:183], a[40:43], 0
    ds_read_b64_tr_b16 a[136:137], v4 offset:31072
    v_mfma_f32_16x16x32_bf16 v[136:139], a[180:183], a[44:47], 0
    ds_read_b64_tr_b16 a[138:139], v4 offset:31840
    ds_read_b64_tr_b16 a[140:141], v5 offset:31104
    v_mfma_f32_16x16x32_bf16 v[128:131], a[184:187], a[48:51], v[128:131]
    v_cvt_pk_bf16_f32 v140, v116, v117
    v_cvt_pk_bf16_f32 v141, v118, v119
    v_mfma_f32_16x16x32_bf16 v[132:135], a[184:187], a[52:55], v[132:135]
    v_cvt_pk_bf16_f32 v144, v120, v121
    v_cvt_pk_bf16_f32 v145, v122, v123
    v_mfma_f32_16x16x32_bf16 v[136:139], a[184:187], a[56:59], v[136:139]
    v_cvt_pk_bf16_f32 v148, v124, v125
    v_cvt_pk_bf16_f32 v149, v126, v127
    v_mfma_f32_16x16x32_bf16 v[128:131], a[188:191], a[60:63], v[128:131]
    ds_read_b64_tr_b16 a[142:143], v5 offset:31872
    v_mfma_f32_16x16x32_bf16 v[132:135], a[188:191], a[64:67], v[132:135]
    v_add_u32 v4, -37248, v4
    v_add_u32 v5, -37248, v5
    v_mfma_f32_16x16x32_bf16 v[136:139], a[188:191], a[68:71], v[136:139]
    v_mfma_f32_16x16x32_bf16 v[116:119], a[192:195], a[0:3], 0
    s_waitcnt vmcnt(0)
    s_barrier
    v_mfma_f32_16x16x32_bf16 v[120:123], a[192:195], a[4:7], 0
    ds_read_b64_tr_b16 v[180:181], v4 offset:0
    v_mfma_f32_16x16x32_bf16 v[124:127], a[192:195], a[8:11], 0
    ds_read_b64_tr_b16 v[182:183], v4 offset:768
    v_mfma_f32_16x16x32_bf16 v[116:119], a[196:199], a[12:15], v[116:119]
    v_cvt_pk_bf16_f32 v142, v128, v129
    v_cvt_pk_bf16_f32 v143, v130, v131
    ds_read_b64_tr_b16 v[184:185], v4 offset:32
    v_mfma_f32_16x16x32_bf16 v[120:123], a[196:199], a[16:19], v[120:123]
    v_cvt_pk_bf16_f32 v146, v132, v133
    v_cvt_pk_bf16_f32 v147, v134, v135
    v_mfma_f32_16x16x32_bf16 v[124:127], a[196:199], a[20:23], v[124:127]
    v_cvt_pk_bf16_f32 v150, v136, v137
    v_cvt_pk_bf16_f32 v151, v138, v139
    v_mfma_f32_16x16x32_bf16 v[116:119], a[200:203], a[24:27], v[116:119]
    ds_read_b64_tr_b16 v[186:187], v4 offset:800
    v_mfma_f32_16x16x32_bf16 v[120:123], a[200:203], a[28:31], v[120:123]
    ds_read_b64_tr_b16 v[188:189], v5 offset:64
    s_waitcnt lgkmcnt(7)
    v_mfma_f32_16x16x32_bf16 v[68:71], v[140:143], v[220:223], v[68:71]
    ds_read_b64_tr_b16 v[190:191], v5 offset:832
    v_mfma_f32_16x16x32_bf16 v[72:75], v[144:147], v[220:223], v[72:75]
    ds_read_b64_tr_b16 v[192:193], v4 offset:6208
    v_mfma_f32_16x16x32_bf16 v[76:79], v[148:151], v[220:223], v[76:79]
    ds_read_b64_tr_b16 v[194:195], v4 offset:6976
    ds_read_b64_tr_b16 v[196:197], v4 offset:6240
    v_mfma_f32_16x16x32_bf16 v[124:127], a[200:203], a[32:35], v[124:127]
    ds_read_b64 v[216:217], v3 offset:16368
    v_mfma_f32_16x16x32_bf16 v[128:131], a[192:195], a[36:39], 0
    ds_read_b64 v[218:219], v3 offset:16896
    v_mfma_f32_16x16x32_bf16 v[132:135], a[192:195], a[40:43], 0
    ds_read_b64_tr_b16 v[198:199], v4 offset:7008
    v_mfma_f32_16x16x32_bf16 v[136:139], a[192:195], a[44:47], 0
    ds_read_b64_tr_b16 v[200:201], v5 offset:6272
    ds_read_b64_tr_b16 v[202:203], v5 offset:7040
    v_mfma_f32_16x16x32_bf16 v[128:131], a[196:199], a[48:51], v[128:131]
    v_cvt_pk_bf16_f32 v140, v116, v117
    v_cvt_pk_bf16_f32 v141, v118, v119
    ds_read_b64_tr_b16 v[204:205], v4 offset:12416
    v_mfma_f32_16x16x32_bf16 v[132:135], a[196:199], a[52:55], v[132:135]
    v_cvt_pk_bf16_f32 v144, v120, v121
    v_cvt_pk_bf16_f32 v145, v122, v123
    v_mfma_f32_16x16x32_bf16 v[136:139], a[196:199], a[56:59], v[136:139]
    v_cvt_pk_bf16_f32 v148, v124, v125
    v_cvt_pk_bf16_f32 v149, v126, v127
    v_mfma_f32_16x16x32_bf16 v[128:131], a[200:203], a[60:63], v[128:131]
    ds_read_b64_tr_b16 v[206:207], v4 offset:13184
    v_mfma_f32_16x16x32_bf16 v[132:135], a[200:203], a[64:67], v[132:135]
    ds_read_b64_tr_b16 v[208:209], v4 offset:12448
    v_mfma_f32_16x16x32_bf16 v[136:139], a[200:203], a[68:71], v[136:139]
    ds_read_b64_tr_b16 v[210:211], v4 offset:13216
    v_mfma_f32_16x16x32_bf16 v[116:119], a[204:207], a[0:3], 0
    ds_read_b64_tr_b16 v[212:213], v5 offset:12480
    v_mfma_f32_16x16x32_bf16 v[120:123], a[204:207], a[4:7], 0
    ds_read_b64_tr_b16 v[214:215], v5 offset:13248
    v_mfma_f32_16x16x32_bf16 v[124:127], a[204:207], a[8:11], 0
    s_mul_i32 s47, s30, 8064
    s_lshl_b32 s48, s29, 3
    v_mfma_f32_16x16x32_bf16 v[116:119], a[208:211], a[12:15], v[116:119]
    v_cvt_pk_bf16_f32 v142, v128, v129
    v_cvt_pk_bf16_f32 v143, v130, v131
    v_bfe_u32 v38, v6, 4, 4
    v_mfma_f32_16x16x32_bf16 v[120:123], a[208:211], a[16:19], v[120:123]
    v_cvt_pk_bf16_f32 v146, v132, v133
    v_cvt_pk_bf16_f32 v147, v134, v135
    v_mfma_f32_16x16x32_bf16 v[124:127], a[208:211], a[20:23], v[124:127]
    v_cvt_pk_bf16_f32 v150, v136, v137
    v_cvt_pk_bf16_f32 v151, v138, v139
    v_mfma_f32_16x16x32_bf16 v[116:119], a[212:215], a[24:27], v[116:119]
    s_add_u32 s47, s47, 0
    v_lshrrev_b32 v39, 8, v6
    v_mfma_f32_16x16x32_bf16 v[120:123], a[212:215], a[28:31], v[120:123]
    v_mul_u32_u24 v17, 72, v38
    v_mul_u32_u24 v16, s2, v38
    s_waitcnt lgkmcnt(7)
    v_mfma_f32_16x16x32_bf16 v[80:83], v[140:143], v[216:219], v[80:83]
    s_lshl2_add_u32 s49, s48, s47
    v_mfma_f32_16x16x32_bf16 v[84:87], v[144:147], v[216:219], v[84:87]
    v_mfma_f32_16x16x32_bf16 v[88:91], v[148:151], v[216:219], v[88:91]
    v_lshl_add_u32 v17, v39, 3, v17
    v_mfma_f32_16x16x32_bf16 v[124:127], a[212:215], a[32:35], v[124:127]
    ds_read_b64 v[220:221], v3 offset:21120
    v_mfma_f32_16x16x32_bf16 v[128:131], a[204:207], a[36:39], 0
    ds_read_b64 v[222:223], v3 offset:21648
    v_mfma_f32_16x16x32_bf16 v[132:135], a[204:207], a[40:43], 0
    v_and_b32 v38, 1, v39
    v_lshrrev_b32 v39, 1, v39
    v_mfma_f32_16x16x32_bf16 v[136:139], a[204:207], a[44:47], 0
    v_add_u32 v17, s49, v17
    v_lshl_add_u32 v38, v38, 1, v39
    v_mfma_f32_16x16x32_bf16 v[128:131], a[208:211], a[48:51], v[128:131]
    v_cvt_pk_bf16_f32 v140, v116, v117
    v_cvt_pk_bf16_f32 v141, v118, v119
    v_mfma_f32_16x16x32_bf16 v[132:135], a[208:211], a[52:55], v[132:135]
    v_cvt_pk_bf16_f32 v144, v120, v121
    v_cvt_pk_bf16_f32 v145, v122, v123
    v_mfma_f32_16x16x32_bf16 v[136:139], a[208:211], a[56:59], v[136:139]
    v_cvt_pk_bf16_f32 v148, v124, v125
    v_cvt_pk_bf16_f32 v149, v126, v127
    v_mfma_f32_16x16x32_bf16 v[128:131], a[212:215], a[60:63], v[128:131]
    v_lshrrev_b32 v39, 7, v6
    v_add_u32 v38, s48, v38
    v_mfma_f32_16x16x32_bf16 v[132:135], a[212:215], a[64:67], v[132:135]
    v_add_u32 v39, s48, v39
    v_lshl_add_u32 v16, v38, 4, v16
    v_mfma_f32_16x16x32_bf16 v[136:139], a[212:215], a[68:71], v[136:139]
    v_bfe_u32 v38, v6, 1, 6
    v_mfma_f32_16x16x32_bf16 v[116:119], a[240:243], a[0:3], 0
    v_mul_u32_u24 v18, 72, v39
    s_branch L_S1_s1
L_S1_t1:
    s_setpc_b64 s[78:79]
L_S1_s1:
    v_mfma_f32_16x16x32_bf16 v[120:123], a[240:243], a[4:7], 0
    v_mul_u32_u24 v19, s2, v39
    v_mfma_f32_16x16x32_bf16 v[124:127], a[240:243], a[8:11], 0
    v_add3_u32 v18, v18, s47, v38
    v_mfma_f32_16x16x32_bf16 v[116:119], a[244:247], a[12:15], v[116:119]
    v_cvt_pk_bf16_f32 v142, v128, v129
    v_cvt_pk_bf16_f32 v143, v130, v131
    v_mfma_f32_16x16x32_bf16 v[120:123], a[244:247], a[16:19], v[120:123]
    v_cvt_pk_bf16_f32 v146, v132, v133
    v_cvt_pk_bf16_f32 v147, v134, v135
    v_mfma_f32_16x16x32_bf16 v[124:127], a[244:247], a[20:23], v[124:127]
    v_cvt_pk_bf16_f32 v150, v136, v137
    v_cvt_pk_bf16_f32 v151, v138, v139
    v_mfma_f32_16x16x32_bf16 v[116:119], a[248:251], a[24:27], v[116:119]
    v_add3_u32 v19, v19, 64, v38
    s_mov_b32 s46, s31
    v_mfma_f32_16x16x32_bf16 v[120:123], a[248:251], a[28:31], v[120:123]
    v_or3_b32 v228, v228, v229, v230
    v_or_b32 v228, v228, v231
    s_waitcnt lgkmcnt(0)
    v_mfma_f32_16x16x32_bf16 v[92:95], v[140:143], v[220:223], v[92:95]
    s_nop 0
    v_mfma_f32_16x16x32_bf16 v[96:99], v[144:147], v[220:223], v[96:99]
    v_readfirstlane_b32 s54, v228
    v_mfma_f32_16x16x32_bf16 v[100:103], v[148:151], v[220:223], v[100:103]
    v_lshrrev_b32 v12, 8, v6
    v_mfma_f32_16x16x32_bf16 v[124:127], a[248:251], a[32:35], v[124:127]
    ds_read_b32 v216, v9 offset:2112
    v_mfma_f32_16x16x32_bf16 v[128:131], a[240:243], a[36:39], 0
    ds_read_b32 v217, v10 offset:2112
    v_cmp_eq_u32 s[60:61], 0, v12
    v_mfma_f32_16x16x32_bf16 v[132:135], a[240:243], a[40:43], 0
    ds_read_b32 v218, v9 offset:2640
    v_cmp_eq_u32 s[62:63], 1, v12
    v_mfma_f32_16x16x32_bf16 v[136:139], a[240:243], a[44:47], 0
    ds_read_b32 v219, v10 offset:2640
    v_cmp_eq_u32 s[64:65], 2, v12
    v_mfma_f32_16x16x32_bf16 v[128:131], a[244:247], a[48:51], v[128:131]
    v_cvt_pk_bf16_f32 v140, v116, v117
    v_cvt_pk_bf16_f32 v141, v118, v119
    v_cndmask_b32 v172, 0, v167, s[60:61]
    v_mfma_f32_16x16x32_bf16 v[132:135], a[244:247], a[52:55], v[132:135]
    v_cvt_pk_bf16_f32 v144, v120, v121
    v_cvt_pk_bf16_f32 v145, v122, v123
    v_mfma_f32_16x16x32_bf16 v[136:139], a[244:247], a[56:59], v[136:139]
    v_cvt_pk_bf16_f32 v148, v124, v125
    v_cvt_pk_bf16_f32 v149, v126, v127
    v_mfma_f32_16x16x32_bf16 v[128:131], a[248:251], a[60:63], v[128:131]
    v_cndmask_b32 v173, 0, v167, s[62:63]
    v_cndmask_b32 v174, 0, v167, s[64:65]
    v_mfma_f32_16x16x32_bf16 v[132:135], a[248:251], a[64:67], v[132:135]
    v_mfma_f32_16x16x32_bf16 v[136:139], a[248:251], a[68:71], v[136:139]
    v_mfma_f32_16x16x32_bf16 v[116:119], a[228:231], a[72:75], 0
    s_mul_i32 s47, s30, 6656
    v_mfma_f32_16x16x32_bf16 v[120:123], a[228:231], a[76:79], 0
    v_lshrrev_b32 v26, 4, v6
    v_mfma_f32_16x16x32_bf16 v[124:127], a[228:231], a[80:83], 0
    v_mfma_f32_16x16x32_bf16 v[116:119], a[232:235], a[84:87], v[116:119]
    v_cvt_pk_bf16_f32 v142, v128, v129
    v_cvt_pk_bf16_f32 v143, v130, v131
    v_mfma_f32_16x16x32_bf16 v[120:123], a[232:235], a[88:91], v[120:123]
    v_cvt_pk_bf16_f32 v146, v132, v133
    v_cvt_pk_bf16_f32 v147, v134, v135
    v_mfma_f32_16x16x32_bf16 v[124:127], a[232:235], a[92:95], v[124:127]
    v_cvt_pk_bf16_f32 v150, v136, v137
    v_cvt_pk_bf16_f32 v151, v138, v139
    v_mfma_f32_16x16x32_bf16 v[116:119], a[236:239], a[96:99], v[116:119]
    s_add_u32 s47, s47, 16128
    v_mul_u32_u24 v27, 43, v26
    v_mfma_f32_16x16x32_bf16 v[120:123], a[236:239], a[100:103], v[120:123]
    v_add_u32 v28, 128, v26
    s_waitcnt lgkmcnt(0)
    v_mfma_f32_16x16x32_bf16 v[104:107], v[216:219], v[140:143], v[104:107]
    s_lshl_b32 s48, s29, 3
    v_mfma_f32_16x16x32_bf16 v[108:111], v[216:219], v[144:147], v[108:111]
    v_mfma_f32_16x16x32_bf16 v[112:115], v[216:219], v[148:151], v[112:115]
    v_lshrrev_b32 v27, 9, v27
    v_mfma_f32_16x16x32_bf16 v[124:127], a[236:239], a[104:107], v[124:127]
    ds_read_b32 v220, v9 offset:3168
    v_mul_u32_u24 v29, 2731, v28
    v_mfma_f32_16x16x32_bf16 v[128:131], a[228:231], a[108:111], 0
    ds_read_b32 v221, v10 offset:3168
    v_mfma_f32_16x16x32_bf16 v[132:135], a[228:231], a[112:115], 0
    ds_read_b32 v222, v9 offset:3696
    v_mad_i32_i24 v26, v27, -12, v26
    v_mfma_f32_16x16x32_bf16 v[136:139], a[228:231], a[116:119], 0
    ds_read_b32 v223, v10 offset:3696
    v_mfma_f32_16x16x32_bf16 v[128:131], a[232:235], a[120:123], v[128:131]
    v_cvt_pk_bf16_f32 v140, v116, v117
    v_cvt_pk_bf16_f32 v141, v118, v119
    v_mfma_f32_16x16x32_bf16 v[132:135], a[232:235], a[124:127], v[132:135]
    v_cvt_pk_bf16_f32 v144, v120, v121
    v_cvt_pk_bf16_f32 v145, v122, v123
    v_mfma_f32_16x16x32_bf16 v[136:139], a[232:235], a[128:131], v[136:139]
    v_cvt_pk_bf16_f32 v148, v124, v125
    v_cvt_pk_bf16_f32 v149, v126, v127
    v_mfma_f32_16x16x32_bf16 v[128:131], a[236:239], a[132:135], v[128:131]
    v_lshrrev_b32 v29, 16, v29
    v_add_u32 v27, s48, v27
    v_mfma_f32_16x16x32_bf16 v[132:135], a[236:239], a[136:139], v[132:135]
    v_mul_u32_u24 v30, 24, v29
    v_mfma_f32_16x16x32_bf16 v[136:139], a[236:239], a[140:143], v[136:139]
    v_mul_u32_u24 v22, 208, v27
    v_mfma_f32_16x16x32_bf16 v[116:119], a[168:171], a[72:75], 0
    v_sub_u32 v28, v28, v30
    v_mfma_f32_16x16x32_bf16 v[120:123], a[168:171], a[76:79], 0
    v_mfma_f32_16x16x32_bf16 v[124:127], a[168:171], a[80:83], 0
    v_add_u32 v29, s48, v29
    v_mfma_f32_16x16x32_bf16 v[116:119], a[172:175], a[84:87], v[116:119]
    v_cvt_pk_bf16_f32 v142, v128, v129
    v_cvt_pk_bf16_f32 v143, v130, v131
    v_mfma_f32_16x16x32_bf16 v[120:123], a[172:175], a[88:91], v[120:123]
    v_cvt_pk_bf16_f32 v146, v132, v133
    v_cvt_pk_bf16_f32 v147, v134, v135
    v_mfma_f32_16x16x32_bf16 v[124:127], a[172:175], a[92:95], v[124:127]
    v_cvt_pk_bf16_f32 v150, v136, v137
    v_cvt_pk_bf16_f32 v151, v138, v139
    v_mfma_f32_16x16x32_bf16 v[116:119], a[176:179], a[96:99], v[116:119]
    v_mul_u32_u24 v24, s2, v27
    v_lshlrev_b32 v26, 4, v26
    v_mfma_f32_16x16x32_bf16 v[120:123], a[176:179], a[100:103], v[120:123]
    v_mul_u32_u24 v23, 208, v29
    s_waitcnt lgkmcnt(0)
    v_mfma_f32_16x16x32_bf16 v[104:107], v[220:223], v[140:143], v[104:107]
    v_mfma_f32_16x16x32_bf16 v[108:111], v[220:223], v[144:147], v[108:111]
    v_mul_u32_u24 v25, s2, v29
    v_mfma_f32_16x16x32_bf16 v[112:115], v[220:223], v[148:151], v[112:115]
    v_mfma_f32_16x16x32_bf16 v[124:127], a[176:179], a[104:107], v[124:127]
    ds_read_b64 v[216:217], v3 offset:3168
    v_mfma_f32_16x16x32_bf16 v[128:131], a[168:171], a[108:111], 0
    ds_read_b64 v[218:219], v3 offset:3696
    v_mfma_f32_16x16x32_bf16 v[132:135], a[168:171], a[112:115], 0
    v_lshlrev_b32 v28, 3, v28
    v_add3_u32 v22, v22, s47, v26
    v_mfma_f32_16x16x32_bf16 v[136:139], a[168:171], a[116:119], 0
    v_add_u32 v24, v24, v26
    v_mfma_f32_16x16x32_bf16 v[128:131], a[172:175], a[120:123], v[128:131]
    v_cvt_pk_bf16_f32 v140, v116, v117
    v_cvt_pk_bf16_f32 v141, v118, v119
    v_mfma_f32_16x16x32_bf16 v[132:135], a[172:175], a[124:127], v[132:135]
    v_cvt_pk_bf16_f32 v144, v120, v121
    v_cvt_pk_bf16_f32 v145, v122, v123
    v_add3_u32 v23, v23, s47, v28
    v_mfma_f32_16x16x32_bf16 v[136:139], a[172:175], a[128:131], v[136:139]
    v_cvt_pk_bf16_f32 v148, v124, v125
    v_cvt_pk_bf16_f32 v149, v126, v127
    v_mfma_f32_16x16x32_bf16 v[128:131], a[176:179], a[132:135], v[128:131]
    v_cvt_pk_bf16_f32 v154, v104, v105
    v_cvt_pk_bf16_f32 v155, v106, v107
    v_mfma_f32_16x16x32_bf16 v[132:135], a[176:179], a[136:139], v[132:135]
    v_cvt_pk_bf16_f32 v158, v108, v109
    v_cvt_pk_bf16_f32 v159, v110, v111
    v_mfma_f32_16x16x32_bf16 v[136:139], a[176:179], a[140:143], v[136:139]
    v_cvt_pk_bf16_f32 v162, v112, v113
    v_cvt_pk_bf16_f32 v163, v114, v115
    v_mfma_f32_16x16x32_bf16 v[116:119], a[168:171], v[180:183], 0
    ds_read_b64 v[224:225], v3 offset:4224
    v_add_u32 v25, v25, v28
    v_mfma_f32_16x16x32_bf16 v[120:123], a[168:171], v[184:187], 0
    v_mov_b32 v226, v172
    v_mov_b32 v227, 0
    v_bfe_u32 v26, v6, 4, 4
    v_mfma_f32_16x16x32_bf16 v[124:127], a[168:171], v[188:191], 0
    v_lshrrev_b32 v27, 8, v6
    v_mul_u32_u24 v26, 208, v26
    v_mfma_f32_16x16x32_bf16 v[116:119], a[172:175], v[192:195], v[116:119]
    v_cvt_pk_bf16_f32 v142, v128, v129
    v_cvt_pk_bf16_f32 v143, v130, v131
    v_mfma_f32_16x16x32_bf16 v[120:123], a[172:175], v[196:199], v[120:123]
    v_cvt_pk_bf16_f32 v146, v132, v133
    v_cvt_pk_bf16_f32 v147, v134, v135
    v_mfma_f32_16x16x32_bf16 v[124:127], a[172:175], v[200:203], v[124:127]
    v_cvt_pk_bf16_f32 v150, v136, v137
    v_cvt_pk_bf16_f32 v151, v138, v139
    v_mfma_f32_16x16x32_bf16 v[116:119], a[176:179], v[204:207], v[116:119]
    s_lshl4_add_u32 s49, s48, s47
    v_lshl_add_u32 v26, v27, 3, v26
    v_mfma_f32_16x16x32_bf16 v[120:123], a[176:179], v[208:211], v[120:123]
    s_lshl2_add_u32 s48, s48, s47
    s_waitcnt lgkmcnt(1)
    v_mfma_f32_16x16x32_bf16 v[44:47], v[140:143], v[216:219], v[44:47]
    v_add_u32 v20, s49, v26
    v_mfma_f32_16x16x32_bf16 v[48:51], v[144:147], v[216:219], v[48:51]
    v_mfma_f32_16x16x32_bf16 v[52:55], v[148:151], v[216:219], v[52:55]
    v_add_u32 v21, s48, v26
    v_mfma_f32_16x16x32_bf16 v[124:127], a[176:179], v[212:215], v[124:127]
    v_mfma_f32_16x16x32_bf16 v[128:131], a[180:183], a[72:75], 0
    v_mfma_f32_16x16x32_bf16 v[132:135], a[180:183], a[76:79], 0
    v_mfma_f32_16x16x32_bf16 v[136:139], a[180:183], a[80:83], 0
    v_mfma_f32_16x16x32_bf16 v[128:131], a[184:187], a[84:87], v[128:131]
    v_cvt_pk_bf16_f32 v152, v116, v117
    v_cvt_pk_bf16_f32 v153, v118, v119
    v_mfma_f32_16x16x32_bf16 v[132:135], a[184:187], a[88:91], v[132:135]
    v_cvt_pk_bf16_f32 v156, v120, v121
    v_cvt_pk_bf16_f32 v157, v122, v123
    v_mfma_f32_16x16x32_bf16 v[136:139], a[184:187], a[92:95], v[136:139]
    v_cvt_pk_bf16_f32 v160, v124, v125
    v_cvt_pk_bf16_f32 v161, v126, v127
    v_mfma_f32_16x16x32_bf16 v[128:131], a[188:191], a[96:99], v[128:131]
    v_mfma_f32_16x16x32_bf16 v[132:135], a[188:191], a[100:103], v[132:135]
    s_waitcnt lgkmcnt(0)
    v_mfma_f32_16x16x32_bf16 v[44:47], v[152:155], v[224:227], v[44:47]
    v_mfma_f32_16x16x32_bf16 v[48:51], v[156:159], v[224:227], v[48:51]
    v_mfma_f32_16x16x32_bf16 v[52:55], v[160:163], v[224:227], v[52:55]
    v_mfma_f32_16x16x32_bf16 v[136:139], a[188:191], a[104:107], v[136:139]
    ds_read_b64 v[220:221], v3 offset:7920
    v_mfma_f32_16x16x32_bf16 v[116:119], a[180:183], a[108:111], 0
    ds_read_b64 v[222:223], v3 offset:8448
    v_mfma_f32_16x16x32_bf16 v[120:123], a[180:183], a[112:115], 0
    v_mfma_f32_16x16x32_bf16 v[124:127], a[180:183], a[116:119], 0
    v_mfma_f32_16x16x32_bf16 v[116:119], a[184:187], a[120:123], v[116:119]
    v_cvt_pk_bf16_f32 v140, v128, v129
    v_cvt_pk_bf16_f32 v141, v130, v131
    v_mfma_f32_16x16x32_bf16 v[120:123], a[184:187], a[124:127], v[120:123]
    v_cvt_pk_bf16_f32 v144, v132, v133
    v_cvt_pk_bf16_f32 v145, v134, v135
    v_mfma_f32_16x16x32_bf16 v[124:127], a[184:187], a[128:131], v[124:127]
    v_cvt_pk_bf16_f32 v148, v136, v137
    v_cvt_pk_bf16_f32 v149, v138, v139
    v_mfma_f32_16x16x32_bf16 v[116:119], a[188:191], a[132:135], v[116:119]
    v_cvt_pk_bf16_f32 v32, v44, v45
    v_cvt_pk_bf16_f32 v33, v46, v47
    v_mfma_f32_16x16x32_bf16 v[120:123], a[188:191], a[136:139], v[120:123]
    v_cvt_pk_bf16_f32 v34, v48, v49
    v_cvt_pk_bf16_f32 v35, v50, v51
    v_mfma_f32_16x16x32_bf16 v[124:127], a[188:191], a[140:143], v[124:127]
    v_cvt_pk_bf16_f32 v36, v52, v53
    v_cvt_pk_bf16_f32 v37, v54, v55
    v_mfma_f32_16x16x32_bf16 v[128:131], a[180:183], v[180:183], 0
    ds_read_b64 v[224:225], v3 offset:8976
    v_mfma_f32_16x16x32_bf16 v[132:135], a[180:183], v[184:187], 0
    v_mov_b32 v227, v172
    v_mov_b32 v226, 0
    v_mfma_f32_16x16x32_bf16 v[136:139], a[180:183], v[188:191], 0
    v_permlane16_swap_b32 v32, v34
    v_permlane16_swap_b32 v33, v35
    v_mfma_f32_16x16x32_bf16 v[128:131], a[184:187], v[192:195], v[128:131]
    v_cvt_pk_bf16_f32 v142, v116, v117
    v_cvt_pk_bf16_f32 v143, v118, v119
    v_mfma_f32_16x16x32_bf16 v[132:135], a[184:187], v[196:199], v[132:135]
    v_cvt_pk_bf16_f32 v146, v120, v121
    v_cvt_pk_bf16_f32 v147, v122, v123
    v_mfma_f32_16x16x32_bf16 v[136:139], a[184:187], v[200:203], v[136:139]
    v_cvt_pk_bf16_f32 v150, v124, v125
    v_cvt_pk_bf16_f32 v151, v126, v127
    v_mfma_f32_16x16x32_bf16 v[128:131], a[188:191], v[204:207], v[128:131]
    ds_write_b64 v17, v[36:37] offset:0
    v_mfma_f32_16x16x32_bf16 v[132:135], a[188:191], v[208:211], v[132:135]
    buffer_store_dwordx4 v[32:35], v16, s[16:19], s31 offen sc1
    s_add_u32 s31, s31, s55
    s_waitcnt lgkmcnt(2)
    v_mfma_f32_16x16x32_bf16 v[56:59], v[140:143], v[220:223], v[56:59]
    v_mfma_f32_16x16x32_bf16 v[60:63], v[144:147], v[220:223], v[60:63]
    v_mfma_f32_16x16x32_bf16 v[64:67], v[148:151], v[220:223], v[64:67]
    v_mfma_f32_16x16x32_bf16 v[136:139], a[188:191], v[212:215], v[136:139]
    v_mfma_f32_16x16x32_bf16 v[116:119], a[192:195], a[72:75], 0
    v_mfma_f32_16x16x32_bf16 v[120:123], a[192:195], a[76:79], 0
    v_mfma_f32_16x16x32_bf16 v[124:127], a[192:195], a[80:83], 0
    v_mfma_f32_16x16x32_bf16 v[116:119], a[196:199], a[84:87], v[116:119]
    v_cvt_pk_bf16_f32 v152, v128, v129
    v_cvt_pk_bf16_f32 v153, v130, v131
    v_mfma_f32_16x16x32_bf16 v[120:123], a[196:199], a[88:91], v[120:123]
    v_cvt_pk_bf16_f32 v156, v132, v133
    v_cvt_pk_bf16_f32 v157, v134, v135
    v_mfma_f32_16x16x32_bf16 v[124:127], a[196:199], a[92:95], v[124:127]
    v_cvt_pk_bf16_f32 v160, v136, v137
    v_cvt_pk_bf16_f32 v161, v138, v139
    v_mfma_f32_16x16x32_bf16 v[116:119], a[200:203], a[96:99], v[116:119]
    v_mfma_f32_16x16x32_bf16 v[120:123], a[200:203], a[100:103], v[120:123]
    s_waitcnt lgkmcnt(1)
    v_mfma_f32_16x16x32_bf16 v[56:59], v[152:155], v[224:227], v[56:59]
    v_mfma_f32_16x16x32_bf16 v[60:63], v[156:159], v[224:227], v[60:63]
    v_mfma_f32_16x16x32_bf16 v[64:67], v[160:163], v[224:227], v[64:67]
    v_mfma_f32_16x16x32_bf16 v[124:127], a[200:203], a[104:107], v[124:127]
    ds_read_b64 v[216:217], v3 offset:12672
    v_mfma_f32_16x16x32_bf16 v[128:131], a[192:195], a[108:111], 0
    ds_read_b64 v[218:219], v3 offset:13200
    v_mfma_f32_16x16x32_bf16 v[132:135], a[192:195], a[112:115], 0
    v_mfma_f32_16x16x32_bf16 v[136:139], a[192:195], a[116:119], 0
    v_mfma_f32_16x16x32_bf16 v[128:131], a[196:199], a[120:123], v[128:131]
    v_cvt_pk_bf16_f32 v140, v116, v117
    v_cvt_pk_bf16_f32 v141, v118, v119
    v_mfma_f32_16x16x32_bf16 v[132:135], a[196:199], a[124:127], v[132:135]
    v_cvt_pk_bf16_f32 v144, v120, v121
    v_cvt_pk_bf16_f32 v145, v122, v123
    v_mfma_f32_16x16x32_bf16 v[136:139], a[196:199], a[128:131], v[136:139]
    v_cvt_pk_bf16_f32 v148, v124, v125
    v_cvt_pk_bf16_f32 v149, v126, v127
    v_mfma_f32_16x16x32_bf16 v[128:131], a[200:203], a[132:135], v[128:131]
    v_cvt_pk_bf16_f32 v32, v56, v57
    v_cvt_pk_bf16_f32 v33, v58, v59
    v_mfma_f32_16x16x32_bf16 v[132:135], a[200:203], a[136:139], v[132:135]
    v_cvt_pk_bf16_f32 v34, v60, v61
    v_cvt_pk_bf16_f32 v35, v62, v63
    v_mfma_f32_16x16x32_bf16 v[136:139], a[200:203], a[140:143], v[136:139]
    v_cvt_pk_bf16_f32 v36, v64, v65
    v_cvt_pk_bf16_f32 v37, v66, v67
    v_mfma_f32_16x16x32_bf16 v[116:119], a[192:195], v[180:183], 0
    ds_read_b64 v[224:225], v3 offset:13728
    v_mfma_f32_16x16x32_bf16 v[120:123], a[192:195], v[184:187], 0
    v_mov_b32 v226, v173
    v_mov_b32 v227, 0
    v_mfma_f32_16x16x32_bf16 v[124:127], a[192:195], v[188:191], 0
    v_permlane16_swap_b32 v32, v34
    v_permlane16_swap_b32 v33, v35
    v_mfma_f32_16x16x32_bf16 v[116:119], a[196:199], v[192:195], v[116:119]
    v_cvt_pk_bf16_f32 v142, v128, v129
    v_cvt_pk_bf16_f32 v143, v130, v131
    v_mfma_f32_16x16x32_bf16 v[120:123], a[196:199], v[196:199], v[120:123]
    v_cvt_pk_bf16_f32 v146, v132, v133
    v_cvt_pk_bf16_f32 v147, v134, v135
    v_mfma_f32_16x16x32_bf16 v[124:127], a[196:199], v[200:203], v[124:127]
    v_cvt_pk_bf16_f32 v150, v136, v137
    v_cvt_pk_bf16_f32 v151, v138, v139
    v_mfma_f32_16x16x32_bf16 v[116:119], a[200:203], v[204:207], v[116:119]
    ds_write_b64 v17, v[36:37] offset:1152
    v_mfma_f32_16x16x32_bf16 v[120:123], a[200:203], v[208:211], v[120:123]
    buffer_store_dwordx4 v[32:35], v16, s[16:19], s31 offen sc1
    s_add_u32 s31, s31, s55
    s_waitcnt lgkmcnt(2)
    v_mfma_f32_16x16x32_bf16 v[68:71], v[140:143], v[216:219], v[68:71]
    v_mfma_f32_16x16x32_bf16 v[72:75], v[144:147], v[216:219], v[72:75]
    v_mfma_f32_16x16x32_bf16 v[76:79], v[148:151], v[216:219], v[76:79]
    v_mfma_f32_16x16x32_bf16 v[124:127], a[200:203], v[212:215], v[124:127]
    v_mfma_f32_16x16x32_bf16 v[128:131], a[204:207], a[72:75], 0
    v_mfma_f32_16x16x32_bf16 v[132:135], a[204:207], a[76:79], 0
    v_mfma_f32_16x16x32_bf16 v[136:139], a[204:207], a[80:83], 0
    v_mfma_f32_16x16x32_bf16 v[128:131], a[208:211], a[84:87], v[128:131]
    v_cvt_pk_bf16_f32 v152, v116, v117
    v_cvt_pk_bf16_f32 v153, v118, v119
    v_mfma_f32_16x16x32_bf16 v[132:135], a[208:211], a[88:91], v[132:135]
    v_cvt_pk_bf16_f32 v156, v120, v121
    v_cvt_pk_bf16_f32 v157, v122, v123
    v_mfma_f32_16x16x32_bf16 v[136:139], a[208:211], a[92:95], v[136:139]
    v_cvt_pk_bf16_f32 v160, v124, v125
    v_cvt_pk_bf16_f32 v161, v126, v127
    v_mfma_f32_16x16x32_bf16 v[128:131], a[212:215], a[96:99], v[128:131]
    v_mfma_f32_16x16x32_bf16 v[132:135], a[212:215], a[100:103], v[132:135]
    s_waitcnt lgkmcnt(1)
    v_mfma_f32_16x16x32_bf16 v[68:71], v[152:155], v[224:227], v[68:71]
    v_mfma_f32_16x16x32_bf16 v[72:75], v[156:159], v[224:227], v[72:75]
    v_mfma_f32_16x16x32_bf16 v[76:79], v[160:163], v[224:227], v[76:79]
    v_mfma_f32_16x16x32_bf16 v[136:139], a[212:215], a[104:107], v[136:139]
    ds_read_b64 v[220:221], v3 offset:17424
    v_mfma_f32_16x16x32_bf16 v[116:119], a[204:207], a[108:111], 0
    ds_read_b64 v[222:223], v3 offset:17952
    v_mfma_f32_16x16x32_bf16 v[120:123], a[204:207], a[112:115], 0
    v_mfma_f32_16x16x32_bf16 v[124:127], a[204:207], a[116:119], 0
    v_mfma_f32_16x16x32_bf16 v[116:119], a[208:211], a[120:123], v[116:119]
    v_cvt_pk_bf16_f32 v140, v128, v129
    v_cvt_pk_bf16_f32 v141, v130, v131
    v_mfma_f32_16x16x32_bf16 v[120:123], a[208:211], a[124:127], v[120:123]
    v_cvt_pk_bf16_f32 v144, v132, v133
    v_cvt_pk_bf16_f32 v145, v134, v135
    v_mfma_f32_16x16x32_bf16 v[124:127], a[208:211], a[128:131], v[124:127]
    v_cvt_pk_bf16_f32 v148, v136, v137
    v_cvt_pk_bf16_f32 v149, v138, v139
    v_mfma_f32_16x16x32_bf16 v[116:119], a[212:215], a[132:135], v[116:119]
    v_cvt_pk_bf16_f32 v32, v68, v69
    v_cvt_pk_bf16_f32 v33, v70, v71
    v_mfma_f32_16x16x32_bf16 v[120:123], a[212:215], a[136:139], v[120:123]
    v_cvt_pk_bf16_f32 v34, v72, v73
    v_cvt_pk_bf16_f32 v35, v74, v75
    v_mfma_f32_16x16x32_bf16 v[124:127], a[212:215], a[140:143], v[124:127]
    v_cvt_pk_bf16_f32 v36, v76, v77
    v_cvt_pk_bf16_f32 v37, v78, v79
    v_mfma_f32_16x16x32_bf16 v[128:131], a[204:207], v[180:183], 0
    ds_read_b64 v[224:225], v3 offset:18480
    v_mfma_f32_16x16x32_bf16 v[132:135], a[204:207], v[184:187], 0
    v_mov_b32 v227, v173
    v_mov_b32 v226, 0
    v_mfma_f32_16x16x32_bf16 v[136:139], a[204:207], v[188:191], 0
    v_permlane16_swap_b32 v32, v34
    v_permlane16_swap_b32 v33, v35
    v_mfma_f32_16x16x32_bf16 v[128:131], a[208:211], v[192:195], v[128:131]
    v_cvt_pk_bf16_f32 v142, v116, v117
    v_cvt_pk_bf16_f32 v143, v118, v119
    v_mfma_f32_16x16x32_bf16 v[132:135], a[208:211], v[196:199], v[132:135]
    v_cvt_pk_bf16_f32 v146, v120, v121
    v_cvt_pk_bf16_f32 v147, v122, v123
    v_mfma_f32_16x16x32_bf16 v[136:139], a[208:211], v[200:203], v[136:139]
    v_cvt_pk_bf16_f32 v150, v124, v125
    v_cvt_pk_bf16_f32 v151, v126, v127
    v_mfma_f32_16x16x32_bf16 v[128:131], a[212:215], v[204:207], v[128:131]
    ds_write_b64 v17, v[36:37] offset:2304
    v_mfma_f32_16x16x32_bf16 v[132:135], a[212:215], v[208:211], v[132:135]
    buffer_store_dwordx4 v[32:35], v16, s[16:19], s31 offen sc1
    s_add_u32 s31, s31, s55
    s_waitcnt lgkmcnt(2)
    v_mfma_f32_16x16x32_bf16 v[80:83], v[140:143], v[220:223], v[80:83]
    v_mfma_f32_16x16x32_bf16 v[84:87], v[144:147], v[220:223], v[84:87]
    v_mfma_f32_16x16x32_bf16 v[88:91], v[148:151], v[220:223], v[88:91]
    v_mfma_f32_16x16x32_bf16 v[136:139], a[212:215], v[212:215], v[136:139]
    v_mfma_f32_16x16x32_bf16 v[116:119], a[216:219], a[72:75], 0
    s_waitcnt lgkmcnt(0)
    s_barrier
    v_mfma_f32_16x16x32_bf16 v[120:123], a[216:219], a[76:79], 0
    ds_read_b64 v[38:39], v18 offset:0
    v_mfma_f32_16x16x32_bf16 v[124:127], a[216:219], a[80:83], 0
    ds_read_b64 v[40:41], v18 offset:1152
    v_mfma_f32_16x16x32_bf16 v[116:119], a[220:223], a[84:87], v[116:119]
    v_cvt_pk_bf16_f32 v152, v128, v129
    v_cvt_pk_bf16_f32 v153, v130, v131
    v_mfma_f32_16x16x32_bf16 v[120:123], a[220:223], a[88:91], v[120:123]
    v_cvt_pk_bf16_f32 v156, v132, v133
    v_cvt_pk_bf16_f32 v157, v134, v135
    v_mfma_f32_16x16x32_bf16 v[124:127], a[220:223], a[92:95], v[124:127]
    v_cvt_pk_bf16_f32 v160, v136, v137
    v_cvt_pk_bf16_f32 v161, v138, v139
    v_mfma_f32_16x16x32_bf16 v[116:119], a[224:227], a[96:99], v[116:119]
    ds_read_b64 v[42:43], v18 offset:2304
    v_mfma_f32_16x16x32_bf16 v[120:123], a[224:227], a[100:103], v[120:123]
    v_mfma_f32_16x16x32_bf16 v[80:83], v[152:155], v[224:227], v[80:83]
    v_mfma_f32_16x16x32_bf16 v[84:87], v[156:159], v[224:227], v[84:87]
    v_mfma_f32_16x16x32_bf16 v[88:91], v[160:163], v[224:227], v[88:91]
    v_mfma_f32_16x16x32_bf16 v[124:127], a[224:227], a[104:107], v[124:127]
    ds_read_b64 v[216:217], v3 offset:22176
    v_mfma_f32_16x16x32_bf16 v[128:131], a[216:219], a[108:111], 0
    ds_read_b64 v[218:219], v3 offset:22704
    v_mfma_f32_16x16x32_bf16 v[132:135], a[216:219], a[112:115], 0
    s_waitcnt lgkmcnt(4)
    buffer_store_dwordx2 v[38:39], v19, s[16:19], s46 offen sc1
    s_add_u32 s46, s46, s55
    v_mfma_f32_16x16x32_bf16 v[136:139], a[216:219], a[116:119], 0
    v_mfma_f32_16x16x32_bf16 v[128:131], a[220:223], a[120:123], v[128:131]
    v_cvt_pk_bf16_f32 v140, v116, v117
    v_cvt_pk_bf16_f32 v141, v118, v119
    v_mfma_f32_16x16x32_bf16 v[132:135], a[220:223], a[124:127], v[132:135]
    v_cvt_pk_bf16_f32 v144, v120, v121
    v_cvt_pk_bf16_f32 v145, v122, v123
    v_mfma_f32_16x16x32_bf16 v[136:139], a[220:223], a[128:131], v[136:139]
    v_cvt_pk_bf16_f32 v148, v124, v125
    v_cvt_pk_bf16_f32 v149, v126, v127
    v_mfma_f32_16x16x32_bf16 v[128:131], a[224:227], a[132:135], v[128:131]
    s_waitcnt lgkmcnt(3)
    buffer_store_dwordx2 v[40:41], v19, s[16:19], s46 offen sc1
    s_add_u32 s46, s46, s55
    v_mfma_f32_16x16x32_bf16 v[132:135], a[224:227], a[136:139], v[132:135]
    v_cvt_pk_bf16_f32 v32, v80, v81
    v_cvt_pk_bf16_f32 v33, v82, v83
    v_mfma_f32_16x16x32_bf16 v[136:139], a[224:227], a[140:143], v[136:139]
    v_cvt_pk_bf16_f32 v34, v84, v85
    v_cvt_pk_bf16_f32 v35, v86, v87
    v_mfma_f32_16x16x32_bf16 v[116:119], a[216:219], v[180:183], 0
    ds_read_b64 v[224:225], v3 offset:23232
    v_mfma_f32_16x16x32_bf16 v[120:123], a[216:219], v[184:187], 0
    v_mov_b32 v226, v174
    v_mov_b32 v227, 0
    v_mfma_f32_16x16x32_bf16 v[124:127], a[216:219], v[188:191], 0
    s_waitcnt lgkmcnt(3)
    buffer_store_dwordx2 v[42:43], v19, s[16:19], s46 offen sc1
    s_add_u32 s46, s46, s55
    v_mfma_f32_16x16x32_bf16 v[116:119], a[220:223], v[192:195], v[116:119]
    v_cvt_pk_bf16_f32 v142, v128, v129
    v_cvt_pk_bf16_f32 v143, v130, v131
    v_mfma_f32_16x16x32_bf16 v[120:123], a[220:223], v[196:199], v[120:123]
    v_cvt_pk_bf16_f32 v146, v132, v133
    v_cvt_pk_bf16_f32 v147, v134, v135
    v_mfma_f32_16x16x32_bf16 v[124:127], a[220:223], v[200:203], v[124:127]
    v_cvt_pk_bf16_f32 v150, v136, v137
    v_cvt_pk_bf16_f32 v151, v138, v139
    v_mfma_f32_16x16x32_bf16 v[116:119], a[224:227], v[204:207], v[116:119]
    v_cvt_pk_bf16_f32 v36, v88, v89
    v_cvt_pk_bf16_f32 v37, v90, v91
    v_mfma_f32_16x16x32_bf16 v[120:123], a[224:227], v[208:211], v[120:123]
    v_permlane16_swap_b32 v32, v34
    v_permlane16_swap_b32 v33, v35
    s_waitcnt lgkmcnt(1)
    v_mfma_f32_16x16x32_bf16 v[92:95], v[140:143], v[216:219], v[92:95]
    ds_write_b64 v17, v[36:37] offset:3456
    v_mfma_f32_16x16x32_bf16 v[96:99], v[144:147], v[216:219], v[96:99]
    buffer_store_dwordx4 v[32:35], v16, s[16:19], s31 offen sc1
    s_add_u32 s31, s31, s55
    v_mfma_f32_16x16x32_bf16 v[100:103], v[148:151], v[216:219], v[100:103]
    v_mfma_f32_16x16x32_bf16 v[124:127], a[224:227], v[212:215], v[124:127]
    v_cvt_pk_bf16_f32 v152, v116, v117
    v_cvt_pk_bf16_f32 v153, v118, v119
    v_cvt_pk_bf16_f32 v156, v120, v121
    v_cvt_pk_bf16_f32 v157, v122, v123
    s_nop 3
    v_cvt_pk_bf16_f32 v160, v124, v125
    v_cvt_pk_bf16_f32 v161, v126, v127
    s_waitcnt lgkmcnt(1)
    v_mfma_f32_16x16x32_bf16 v[92:95], v[152:155], v[224:227], v[92:95]
    v_mfma_f32_16x16x32_bf16 v[96:99], v[156:159], v[224:227], v[96:99]
    v_mfma_f32_16x16x32_bf16 v[100:103], v[160:163], v[224:227], v[100:103]
    s_cmp_lg_u32 s54, 0
    s_nop 4
    v_cvt_pk_bf16_f32 v32, v92, v93
    v_cvt_pk_bf16_f32 v33, v94, v95
    v_cvt_pk_bf16_f32 v34, v96, v97
    v_cvt_pk_bf16_f32 v35, v98, v99
    ds_write_b64 v20, v[32:33] offset:0
    v_cvt_pk_bf16_f32 v36, v100, v101
    v_cvt_pk_bf16_f32 v37, v102, v103
    ds_write_b64 v20, v[34:35] offset:32
    ds_write_b64 v21, v[36:37] offset:64
    s_waitcnt lgkmcnt(0)
    s_barrier
    ds_read_b64 v[38:39], v18 offset:3456
    ds_read_b128 v[26:29], v22 offset:0
    ds_read_b64 v[30:31], v23 offset:0
    s_waitcnt lgkmcnt(2)
    buffer_store_dwordx2 v[38:39], v19, s[16:19], s46 offen sc1
    s_waitcnt lgkmcnt(1)
    buffer_store_dwordx4 v[26:29], v24, s[16:19], s31 offen sc1
    s_waitcnt lgkmcnt(0)
    buffer_store_dwordx2 v[30:31], v25, s[16:19], s31 offen sc1
    s_cbranch_scc0 L_end
L_gS:
    s_waitcnt vmcnt(0)
    s_barrier
    s_branch L_gW
.p2align 12
L_P:
    v_and_b32 v34, 28, v32
    s_add_u32 m0, s33, 7808
    s_min_i32 s39, s20, s21
    s_add_u32 s20, s20, s55
    buffer_load_dwordx4 v8, s[4:7], s39 offen lds
    v_mov_b32 v35, 0
    v_add_u32 v34, 163488, v34
    s_cmp_eq_u32 s56, 0
    ds_write_b32 v34, v35
    s_mov_b32 s57, 0x4000002
    s_cselect_b32 s57, 0x40002, s57
    s_cselect_b32 s35, 4.0, 0
    s_cselect_b32 s32, 0, 4.0
    s_cselect_b64 vcc, -1, 0
    s_cselect_b32 s47, 1, 0
    s_mul_i32 s48, s56, 244
    s_movk_i32 s49, 244
    v_mad_u32_u24 v56, v39, s56, v40
    v_mad_u32_u24 v59, v39, s47, v41
    v_cndmask_b32 v104, v40, v41, vcc
    v_add_u32 v56, 1, v56
    v_mul_u32_u24 v59, s49, v59
    v_cndmask_b32 v105, v41, v40, vcc
    v_add_u32 v57, s47, v56
    v_add_u32 v104, v104, v39
    s_add_u32 m0, s33, 11712
    s_min_i32 s39, s20, s21
    s_add_u32 s20, s20, s55
    buffer_load_dwordx4 v8, s[4:7], s39 offen lds
    v_add_u32 v58, s47, v57
    v_lshl_or_b32 v24, v105, 8, v104
    v_bfe_u32 v60, v56, 2, 2
    v_bfe_u32 v61, v57, 2, 2
    v_bfe_u32 v62, v58, 2, 2
    v_mad_u32_u24 v56, v56, 12, v60
    v_mad_u32_u24 v57, v57, 12, v61
    v_mad_u32_u24 v58, v58, 12, v62
    v_cvt_f32_u32 v104, v104
    v_cvt_f32_u32 v105, v105
    v_add3_u32 v56, v56, v59, s70
    s_add_u32 s70, s70, s48
    v_add3_u32 v57, v57, v59, s70
    s_add_u32 m0, s33, 15616
    s_min_i32 s39, s20, s21
    s_add_u32 s20, s20, s55
    buffer_load_dwordx4 v8, s[4:7], s39 offen lds
    s_add_u32 s70, s70, s48
    v_add3_u32 v58, v58, v59, s70
    s_add_u32 s70, s70, s48
    v_mov_b32 v59, 0x3d00000
    s_mov_b32 s47, 0x10001
    v_add_f32 v104, s68, v104
    v_add_f32 v105, s69, v105
    v_mad_u32_u24 v80, v56, s47, v59
    v_add_u32 v81, 1952, v56
    v_mad_u32_u24 v82, v57, s47, v59
    v_add_u32 v83, 1952, v57
    v_mad_u32_u24 v84, v58, s47, v59
    v_add_u32 v85, 1952, v58
    s_add_u32 m0, s33, 19520
    s_min_i32 s39, s20, s21
    s_add_u32 s20, s20, s55
    buffer_load_dwordx4 v8, s[4:7], s39 offen lds
    s_waitcnt vmcnt(10)
    v_lshrrev_b32 v23, 16, v167
    v_and_b32 v25, 0xffff, v167
    v_lshl_add_u32 v23, v40, 4, v23
    v_add_f32 v106, 1.0, v105
    v_lshl_or_b32 v24, v24, 16, v23
    v_add_u32 v23, 103008, v23
    v_add_f32 v107, 2.0, v105
    s_mov_b32 exec_hi, 0xffff
    ds_write_b64 v23, v[80:81] offset:0
    ds_write_b64 v23, v[82:83] offset:256
    ds_write_b64 v23, v[84:85] offset:512
    s_mov_b32 exec_hi, -1
    s_lshl_b32 s42, s56, 4
    s_add_u32 s44, s44, 107616
    s_mul_i32 s45, s30, 3104
    s_lshl_b32 s47, s29, 10
    s_add_u32 m0, s33, 23424
    s_min_i32 s39, s20, s21
    s_add_u32 s20, s20, s55
    buffer_load_dwordx4 v8, s[4:7], s39 offen lds
    s_add_u32 s45, s45, s47
    s_add_u32 s45, s45, 120032
    s_mul_i32 s48, s30, 3072
    s_add_u32 s47, s47, s48
    s_add_u32 s47, s47, 12288
    v_add_u32 v26, s47, v6
    s_mul_i32 s47, s30, 2304
    s_add_u32 s47, s47, 103008
    v_lshl_add_u32 v172, v165, 4, s47
    v_add_u32 v173, 16, v164
    v_mov_b32 v174, 0xf400f40
    s_lshl_b32 s48, s29, 7
    s_lshl_b32 s49, s29, 5
    s_add_u32 s47, s48, 107616
    v_add_u32_sdwa v4, s47, v16 dst_sel:DWORD dst_unused:UNUSED_PAD src0_sel:DWORD src1_sel:WORD_0
    s_add_u32 s47, s49, 107616
    v_add_u32_sdwa v5, s47, v16 dst_sel:DWORD dst_unused:UNUSED_PAD src0_sel:DWORD src1_sel:WORD_0
    v_mov_b32 v14, 163488
    s_lshl_b32 s38, s28, 12
    s_add_u32 s38, s38, 144864
    s_lshl_b32 s47, s30, 2
    s_cselect_b32 s31, s27, s26
    s_lshr_b32 s36, s22, s47
    s_and_b32 s36, s36, 15
    s_mov_b32 s52, 0x435f435f
    s_mov_b32 s46, 0
    s_waitcnt lgkmcnt(0)
    s_barrier
    v_cvt_pk_bf16_f32 v180, v104, v105
    v_cvt_pk_bf16_f32 v181, v104, v106
    v_cvt_pk_bf16_f32 v182, v104, v107
    v_pk_max_i16 v180, v180, 0
    v_pk_max_i16 v181, v181, 0
    v_pk_max_i16 v182, v182, 0
    v_mov_b32 v204, 0
    s_cmp_lt_u32 s72, 8
    s_cbranch_scc1 L_Pv
    s_add_u32 m0, s33, 27328
    s_min_i32 s47, s20, s21
    s_add_u32 s20, s20, s55
    buffer_load_dwordx4 v8, s[4:7], s47 offen lds
    s_waitcnt vmcnt(9)
L_Pv2:
    v_lshlrev_b32 v56, 16, v232
    v_lshlrev_b32 v58, 16, v233
    v_lshlrev_b32 v60, 16, v234
    v_and_b32 v57, 0xffff0000, v232
    v_and_b32 v59, 0xffff0000, v233
    v_and_b32 v61, 0xffff0000, v234
    v_add_f32 v56, v56, v104
    v_add_f32 v58, v58, v104
    v_add_f32 v60, v60, v104
    v_add_f32 v57, v57, v105
    v_add_f32 v59, v59, v106
    v_add_f32 v61, v61, v107
    v_cvt_pk_bf16_f32 v56, v56, v57
    v_cvt_pk_bf16_f32 v58, v58, v59
    v_cvt_pk_bf16_f32 v60, v60, v61
    v_pk_max_i16 v56, v56, 0
    v_pk_max_i16 v58, v58, 0
    v_pk_max_i16 v60, v60, 0
    v_cmp_ne_u32 s[58:59], v56, v180
    v_cmp_ne_u32 s[60:61], v58, v181
    v_cmp_ne_u32 s[62:63], v60, v182
    s_cmp_le_u32 s75, 4
    s_cbranch_scc0 L_Ps
    v_addc_co_u32 v205, vcc, 0, v204, s[58:59]
    v_addc_co_u32 v206, vcc, 0, v205, s[60:61]
    v_addc_co_u32 v213, vcc, 0, v206, s[62:63]
    s_branch L_Pk
L_Pv:
    s_waitcnt vmcnt(8)
    s_cmp_le_u32 s72, 7
    s_cbranch_scc1 L_l1
    s_add_u32 m0, s33, 27328
    s_min_i32 s47, s20, s21
    s_add_u32 s20, s20, s55
    buffer_load_dwordx4 v8, s[4:7], s47 offen lds
L_l1:
    s_branch L_Pv2
L_Ps:
    v_lshlrev_b32 v56, 16, v236
    v_add_f32 v108, s35, v104
    s_cmp_le_u32 s72, 8
    s_cbranch_scc1 L_l2
    s_add_u32 m0, s33, 31232
    s_min_i32 s47, s20, s21
    s_add_u32 s20, s20, s55
    buffer_load_dwordx4 v8, s[4:7], s47 offen lds
L_l2:
    v_addc_co_u32 v205, vcc, 0, v204, s[58:59]
    v_lshlrev_b32 v58, 16, v237
    v_add_f32 v109, s32, v105
    v_lshlrev_b32 v60, 16, v238
    v_addc_co_u32 v206, vcc, 0, v205, s[60:61]
    v_add_f32 v110, s32, v106
    v_and_b32 v57, 0xffff0000, v236
    v_add_f32 v111, s32, v107
    v_addc_co_u32 v207, vcc, 0, v206, s[62:63]
    v_and_b32 v59, 0xffff0000, v237
    v_cvt_pk_bf16_f32 v183, v108, v109
    v_and_b32 v61, 0xffff0000, v238
    v_cvt_pk_bf16_f32 v184, v108, v110
    v_add_f32 v56, v56, v108
    v_cvt_pk_bf16_f32 v185, v108, v111
    v_add_f32 v58, v58, v108
    v_pk_max_i16 v183, v183, 0
    v_add_f32 v60, v60, v108
    v_pk_max_i16 v184, v184, 0
    v_add_f32 v57, v57, v109
    v_pk_max_i16 v185, v185, 0
    v_add_f32 v59, v59, v110
    s_cmp_le_u32 s72, 9
    s_cbranch_scc1 L_l3
    s_add_u32 m0, s33, 35136
    s_min_i32 s47, s20, s21
    s_add_u32 s20, s20, s55
    buffer_load_dwordx4 v8, s[4:7], s47 offen lds
L_l3:
    v_add_f32 v61, v61, v111
    v_cvt_pk_bf16_f32 v56, v56, v57
    v_cvt_pk_bf16_f32 v58, v58, v59
    v_cvt_pk_bf16_f32 v60, v60, v61
    v_pk_max_i16 v56, v56, 0
    v_pk_max_i16 v58, v58, 0
    v_pk_max_i16 v60, v60, 0
    v_cmp_ne_u32 s[64:65], v56, v183
    v_cmp_ne_u32 s[66:67], v58, v184
    v_cmp_ne_u32 s[76:77], v60, v185
    v_lshlrev_b32 v56, 16, v240
    v_add_f32 v112, s35, v108
    v_addc_co_u32 v208, vcc, 0, v207, s[64:65]
    v_lshlrev_b32 v58, 16, v241
    v_add_f32 v113, s32, v109
    v_lshlrev_b32 v60, 16, v242
    v_addc_co_u32 v209, vcc, 0, v208, s[66:67]
    v_add_f32 v114, s32, v110
    v_and_b32 v57, 0xffff0000, v240
    v_add_f32 v115, s32, v111
    v_addc_co_u32 v210, vcc, 0, v209, s[76:77]
    v_and_b32 v59, 0xffff0000, v241
    s_cmp_le_u32 s72, 10
    s_cbranch_scc1 L_l4
    s_add_u32 m0, s33, 39040
    s_min_i32 s47, s20, s21
    s_add_u32 s20, s20, s55
    buffer_load_dwordx4 v8, s[4:7], s47 offen lds
L_l4:
    v_cvt_pk_bf16_f32 v186, v112, v113
    v_and_b32 v61, 0xffff0000, v242
    v_cvt_pk_bf16_f32 v187, v112, v114
    v_add_f32 v56, v56, v112
    v_cvt_pk_bf16_f32 v188, v112, v115
    v_add_f32 v58, v58, v112
    v_pk_max_i16 v186, v186, 0
    v_add_f32 v60, v60, v112
    v_pk_max_i16 v187, v187, 0
    v_add_f32 v57, v57, v113
    v_pk_max_i16 v188, v188, 0
    v_add_f32 v59, v59, v114
    v_add_f32 v61, v61, v115
    v_cvt_pk_bf16_f32 v56, v56, v57
    v_cvt_pk_bf16_f32 v58, v58, v59
    v_cvt_pk_bf16_f32 v60, v60, v61
    v_pk_max_i16 v56, v56, 0
    v_pk_max_i16 v58, v58, 0
    v_pk_max_i16 v60, v60, 0
    v_cmp_ne_u32 s[78:79], v56, v186
    v_cmp_ne_u32 s[0:1], v58, v187
    v_cmp_ne_u32 s[50:51], v60, v188
    v_addc_co_u32 v211, vcc, 0, v210, s[78:79]
    v_addc_co_u32 v212, vcc, 0, v211, s[0:1]
    v_addc_co_u32 v213, vcc, 0, v212, s[50:51]
L_Pk:
    v_mov_b32 v67, v213
    v_add_u32 v192, 0x0, v24
    v_add_u32 v193, 0x1000100, v24
    v_add_u32_dpp v67, v67, v67 row_shr:1 row_mask:0xf bank_mask:0xf bound_ctrl:0
    v_add_u32 v194, 0x2000200, v24
    v_add_u32 v195, s57, v192
    v_add_u32_dpp v67, v67, v67 row_shr:2 row_mask:0xf bank_mask:0xf bound_ctrl:0
    v_add_u32 v196, s57, v193
    v_add_u32 v197, s57, v194
    v_add_u32_dpp v67, v67, v67 row_shr:4 row_mask:0xf bank_mask:0xf bound_ctrl:0
    v_add_u32 v198, s57, v195
    v_add_u32 v199, s57, v196
    v_add_u32_dpp v67, v67, v67 row_shr:8 row_mask:0xf bank_mask:0xf bound_ctrl:0
    v_add_u32 v200, s57, v197
    s_add_u32 s49, s38, 2048
    v_add_u32_dpp v67, v67, v67 row_bcast:15 row_mask:0xa bank_mask:0xf
    v_mov_b32 v69, 163504
    v_lshrrev_b32 v82, 4, v6
    v_add_u32_dpp v67, v67, v67 row_bcast:31 row_mask:0xc bank_mask:0xf
    s_mov_b32 s39, 0
    v_readlane_b32 s37, v67, 63
    v_sub_u32 v67, v67, v213
    v_lshl_add_u32 v68, v67, 3, s49
    s_sub_u32 s32, s37, 1
    v_mov_b32 v78, s37
    s_cmpk_ge_u32 s32, 128
    s_cbranch_scc1 L_Pz
    v_lshl_add_u32 v204, v204, 3, v68
    v_lshl_add_u32 v205, v205, 3, v68
    v_lshl_add_u32 v206, v206, 3, v68
    v_lshl_add_u32 v207, v207, 3, v68
    v_lshl_add_u32 v208, v208, 3, v68
    v_lshl_add_u32 v209, v209, 3, v68
    v_lshl_add_u32 v210, v210, 3, v68
    v_lshl_add_u32 v211, v211, 3, v68
    v_lshl_add_u32 v212, v212, 3, v68
    s_cmp_le_u32 s72, 8
    s_mov_b64 exec, 1
    ds_add_rtn_u32 v78, v69, v78
    s_mov_b64 exec, s[58:59]
    s_cbranch_execz L_Pb0
    ds_write2_b32 v204, v232, v192 offset1:1
L_Pb0:
    s_mov_b64 exec, s[60:61]
    s_cbranch_execz L_Pb1
    ds_write2_b32 v205, v233, v193 offset1:1
L_Pb1:
    s_mov_b64 exec, s[62:63]
    s_cbranch_execz L_Pb2
    ds_write2_b32 v206, v234, v194 offset1:1
L_Pb2:
    s_cbranch_scc1 L_Pq
    s_mov_b64 exec, s[64:65]
    s_cbranch_execz L_Pb3
    ds_write2_b32 v207, v236, v195 offset1:1
L_Pb3:
    s_mov_b64 exec, s[66:67]
    s_cbranch_execz L_Pb4
    ds_write2_b32 v208, v237, v196 offset1:1
L_Pb4:
    s_mov_b64 exec, s[76:77]
    s_cbranch_execz L_Pb5
    ds_write2_b32 v209, v238, v197 offset1:1
L_Pb5:
    s_mov_b64 exec, s[78:79]
    s_cbranch_execz L_Pb6
    ds_write2_b32 v210, v240, v198 offset1:1
L_Pb6:
    s_mov_b64 exec, s[0:1]
    s_cbranch_execz L_Pb7
    ds_write2_b32 v211, v241, v199 offset1:1
L_Pb7:
    s_mov_b64 exec, s[50:51]
    s_cbranch_execz L_Pb8
    ds_write2_b32 v212, v242, v200 offset1:1
L_Pb8:
L_Pq:
    s_mov_b64 exec, -1
    v_min_u32 v85, s32, v82
    v_cmp_ge_u32 s[64:65], s32, v82
    v_lshl_add_u32 v83, v85, 3, s38
    ds_read_b64 v[80:81], v83 offset:2048
    v_add_u32 v82, 64, v82
    s_add_u32 s39, s39, 64
    s_mov_b32 s49, 103008
    s_mov_b32 s50, 0
    s_lshr_b32 s35, s24, 4
    v_min_u32 v10, s32, v25
    v_lshlrev_b32 v10, 2, v10
    s_cmp_eq_u32 s28, 1
    s_cbranch_scc0 L_Pa_n0
    s_call_b64 s[78:79], L_Pa_t0
L_Pa_n0:
    s_cmp_eq_u32 s28, 2
    s_cbranch_scc0 L_Pa_n1
    s_call_b64 s[78:79], L_Pa_t1
L_Pa_n1:
    s_cmp_le_u32 s72, 11
    s_cbranch_scc1 L_l5
    s_add_u32 m0, s33, 42944
    s_min_i32 s47, s20, s21
    s_add_u32 s20, s20, s55
    buffer_load_dwordx4 v8, s[4:7], s47 offen lds
L_l5:
    s_cmp_le_u32 s72, 12
    s_cbranch_scc1 L_l6
    s_add_u32 m0, s33, 46848
    s_min_i32 s47, s20, s21
    s_add_u32 s20, s20, s55
    buffer_load_dwordx4 v8, s[4:7], s47 offen lds
L_l6:
    s_cmp_le_u32 s72, 13
    s_cbranch_scc1 L_l7
    s_add_u32 m0, s33, 50752
    s_min_i32 s47, s20, s21
    s_add_u32 s20, s20, s55
    buffer_load_dwordx4 v8, s[4:7], s47 offen lds
L_l7:
    s_waitcnt lgkmcnt(0)
    v_readfirstlane_b32 s53, v78
    v_cvt_f32_ubyte2 v86, v81
    v_cvt_f32_ubyte3 v87, v81
    v_add_u32_sdwa v84, s49, v81 dst_sel:DWORD dst_unused:UNUSED_PAD src0_sel:DWORD src1_sel:WORD_0
    v_add_f32 v86, s68, v86
    v_add_f32 v87, s69, v87
    v_mov_b32 v81, s50
    v_lshlrev_b32 v61, 16, v80
    v_and_b32 v62, 0xffff0000, v80
    s_cmp_le_u32 s72, 14
    s_cbranch_scc1 L_l8
    s_add_u32 m0, s33, 54656
    s_min_i32 s47, s20, s21
    s_add_u32 s20, s20, s55
    buffer_load_dwordx4 v8, s[4:7], s47 offen lds
L_l8:
    v_add_f32 v61, v61, v86
    v_add_f32 v62, v62, v87
    v_cvt_pk_bf16_f32 v60, v61, v62
    v_pk_max_i16 v60, v60, 0
    v_pk_min_i16 v60, v60, s52
    v_alignbit_b32 v60, v60, v60, s42
    v_lshlrev_b32 v61, 16, v60
    v_and_b32 v62, 0xffff0000, v60
    v_fract_f32 v63, v61
    v_fract_f32 v64, v62
    s_cmp_le_u32 s72, 15
    s_cbranch_scc1 L_l9
    s_add_u32 m0, s33, 58560
    s_min_i32 s47, s20, s21
    s_add_u32 s20, s20, s55
    buffer_load_dwordx4 v8, s[4:7], s47 offen lds
L_l9:
    v_cvt_u32_f32 v65, v61
    v_cvt_u32_f32 v66, v62
    v_cmp_neq_f32 s[58:59], 0, v64
    v_cmp_neq_f32 s[60:61], 0, v63
    v_sub_f32 v67, 1.0, v63
    v_sub_f32 v68, 1.0, v64
    v_subrev_u32 v65, s71, v65
    v_subrev_u32 v66, s43, v66
    v_cvt_pk_bf16_f32 v61, v67, v68
    v_addc_co_u32 v74, vcc, 0, v66, s[58:59]
    s_add_u32 m0, s44, 0
    s_nop 0
    buffer_load_dwordx4 v7, s[12:15], s46 offen offset:0 lds
    v_addc_co_u32 v73, vcc, 0, v65, s[60:61]
    v_lshlrev_b32 v67, 16, v61
    v_and_b32 v68, 0xffff0000, v61
    v_mul_u32_u24 v75, 976, v65
    v_mul_f32 v69, v67, v68
    v_mul_f32 v70, v67, v64
    v_mul_f32 v71, v63, v68
    v_mul_f32 v72, v63, v64
    v_max_u32 v73, v73, v65
    v_max_u32 v61, v66, v74
    buffer_load_dwordx4 v7, s[12:15], s46 offen offset:1024 lds
    v_mad_u32_u24 v67, v66, 48, v75
    v_mad_u32_u24 v68, v74, 48, v75
    v_and_b32 v66, 12, v66
    v_and_b32 v74, 12, v74
    s_andn2_b64 s[62:63], s[60:61], s[58:59]
    v_add_lshl_u32 v67, v67, v66, 2
    v_add_lshl_u32 v68, v68, v74, 2
    v_cndmask_b32 v70, v71, v70, s[58:59]
    v_cndmask_b32 v62, 0, v174, s[62:63]
    s_and_b64 s[62:63], s[60:61], s[58:59]
    v_cndmask_b32 v71, 0, v71, s[58:59]
    s_and_b64 s[66:67], s[62:63], s[64:65]
    v_cmp_le_u32 s[60:61], s72, v73
    v_mbcnt_lo_u32_b32 v81, s66, v81
    v_cmp_lt_u32 s[58:59], 19, v61
    s_bcnt1_i32_b64 s48, s[66:67]
    v_lshl_or_b32 v58, v68, 16, v67
    v_mbcnt_hi_u32_b32 v81, s67, v81
    v_cvt_pk_bf16_f32 v57, v69, v70
    s_add_u32 s50, s50, s48
    v_cvt_pk_bf16_f32 v59, v71, v72
    v_sub_u32 v85, v85, v81
    v_and_b32 v62, 0xffff0000, v62
    v_sub_u32 v81, s32, v81
    v_cndmask_b32 v61, 0, v174, s[62:63]
    v_cndmask_b32 v85, v85, v81, s[66:67]
    v_add_u32 v56, v58, v62
    v_lshl_add_u32 v83, v85, 4, s38
    v_add_u32 v58, v58, v61
    v_add_u32 v85, s53, v85
    ds_bpermute_b32 v28, v10, v56
    v_bfe_u32 v81, v85, 1, 2
    ds_bpermute_b32 v29, v10, v57
    v_mad_u32_u24 v85, v85, 12, s35
    v_add_u32 v85, v85, v81
    s_mov_b64 exec, s[64:65]
    ds_write_b128 v83, v[56:59]
    ds_write_b16 v84, v85
    s_mov_b64 exec, -1
    s_or_b64 s[58:59], s[58:59], s[60:61]
    s_cbranch_scc1 L_Pfail
    s_add_u32 s47, s53, s37
    s_cmp_gt_u32 s47, s25
    s_cbranch_scc1 L_Pfail
    s_cmp_lt_u32 s39, s37
    s_cbranch_scc1 L_Pr2
    s_lshr_b32 s47, s32, 4
    s_cmp_lt_u32 s36, 4
    s_addc_u32 s47, s47, s50
    s_mov_b32 s39, 0
    s_cmp_lg_u32 s47, 0
    s_cbranch_scc1 L_Pgl
    s_waitcnt lgkmcnt(2)
    v_add_u32 v9, s39, v165
    v_xor_b32_sdwa v0, v28, v164 dst_sel:DWORD dst_unused:UNUSED_PAD src0_sel:WORD_0 src1_sel:DWORD
    buffer_load_dwordx4 v7, s[12:15], s46 offen offset:2048 lds
    v_min_u32 v9, s32, v9
    v_xor_b32_sdwa v2, v28, v164 dst_sel:DWORD dst_unused:UNUSED_PAD src0_sel:WORD_1 src1_sel:DWORD
    v_add_u32 v9, s53, v9
    v_xor_b32_sdwa v1, v28, v173 dst_sel:DWORD dst_unused:UNUSED_PAD src0_sel:WORD_0 src1_sel:DWORD
    s_add_u32 s39, s39, 16
    s_add_u32 m0, s45, 0
    s_nop 0
    buffer_load_dwordx4 v26, s[12:15], s46 offen offset:0 lds
    v_xor_b32_sdwa v3, v28, v173 dst_sel:DWORD dst_unused:UNUSED_PAD src0_sel:WORD_1 src1_sel:DWORD
    v_bfe_u32 v10, v9, 1, 2
    v_perm_b32 v32, v29, v29, v168
    v_mad_u32_u24 v9, v9, 12, v10
    v_perm_b32 v33, v29, v29, v169
    buffer_load_dwordx4 v26, s[12:15], s46 offen offset:1024 lds
    s_add_u32 s46, s46, 18432
    v_xor_b32_sdwa v9, v166, v9 dst_sel:DWORD dst_unused:UNUSED_PAD src0_sel:WORD_0 src1_sel:DWORD
    v_perm_b32 v34, v29, v29, v170
    v_lshl_add_u32 v9, v9, 4, s24
    v_perm_b32 v35, v29, v29, v171
    s_waitcnt vmcnt(5) lgkmcnt(0)
    s_barrier
    ds_read_b64_tr_b16 v[180:181], v0 offset:0
    ds_read_b64_tr_b16 v[182:183], v2 offset:0
    ds_read_b64_tr_b16 v[184:185], v1 offset:0
    ds_read_b64_tr_b16 v[186:187], v3 offset:0
    ds_read_b64_tr_b16 v[188:189], v0 offset:64
    ds_read_b64_tr_b16 v[190:191], v2 offset:64
    ds_read_b64_tr_b16 v[192:193], v1 offset:64
    ds_read_b64_tr_b16 v[194:195], v3 offset:64
    ds_read_b64_tr_b16 v[196:197], v0 offset:128
    ds_read_b64_tr_b16 v[198:199], v2 offset:128
    ds_read_b64_tr_b16 v[200:201], v1 offset:128
    ds_read_b64_tr_b16 v[202:203], v3 offset:128
    ds_read_b128 v[136:139], v172 offset:0
    ds_read_b128 v[144:147], v14
    s_waitcnt lgkmcnt(12)
    v_mfma_f32_16x16x32_bf16 v[56:59], v[180:183], v[32:35], 0
    s_waitcnt lgkmcnt(10)
    v_mfma_f32_16x16x32_bf16 v[60:63], v[184:187], v[32:35], 0
    s_waitcnt lgkmcnt(8)
    v_mfma_f32_16x16x32_bf16 v[64:67], v[188:191], v[32:35], 0
    s_waitcnt lgkmcnt(6)
    v_mfma_f32_16x16x32_bf16 v[68:71], v[192:195], v[32:35], 0
    s_waitcnt lgkmcnt(1)
    v_xor_b32 v136, v136, v166
    v_xor_b32 v137, v137, v166
    v_xor_b32 v138, v138, v166
    v_xor_b32 v139, v139, v166
    v_mfma_f32_16x16x32_bf16 v[72:75], v[196:199], v[32:35], 0
    v_lshlrev_b32_sdwa v116, 4, v136 dst_sel:DWORD dst_unused:UNUSED_PAD src0_sel:DWORD src1_sel:WORD_0
    v_lshlrev_b32_sdwa v117, 4, v138 dst_sel:DWORD dst_unused:UNUSED_PAD src0_sel:DWORD src1_sel:WORD_0
    v_lshlrev_b32_sdwa v118, 4, v136 dst_sel:DWORD dst_unused:UNUSED_PAD src0_sel:DWORD src1_sel:WORD_1
    v_mfma_f32_16x16x32_bf16 v[76:79], v[200:203], v[32:35], 0
    v_lshlrev_b32_sdwa v119, 4, v138 dst_sel:DWORD dst_unused:UNUSED_PAD src0_sel:DWORD src1_sel:WORD_1
    v_lshlrev_b32_sdwa v120, 4, v137 dst_sel:DWORD dst_unused:UNUSED_PAD src0_sel:DWORD src1_sel:WORD_0
    v_lshlrev_b32_sdwa v121, 4, v139 dst_sel:DWORD dst_unused:UNUSED_PAD src0_sel:DWORD src1_sel:WORD_0
    v_cvt_pk_bf16_f32 v80, v56, v57
    v_cvt_pk_bf16_f32 v81, v58, v59
    v_cvt_pk_bf16_f32 v82, v60, v61
    v_cvt_pk_bf16_f32 v83, v62, v63
    v_cvt_pk_bf16_f32 v84, v64, v65
    v_cvt_pk_bf16_f32 v85, v66, v67
    v_cvt_pk_bf16_f32 v86, v68, v69
    v_cvt_pk_bf16_f32 v87, v70, v71
    v_permlane32_swap_b32 v80, v82
    v_permlane32_swap_b32 v81, v83
    ds_write_b128 v9, v[80:83] offset:0
    v_cvt_pk_bf16_f32 v88, v72, v73
    v_cvt_pk_bf16_f32 v89, v74, v75
    v_cvt_pk_bf16_f32 v90, v76, v77
    v_cvt_pk_bf16_f32 v91, v78, v79
    v_permlane32_swap_b32 v84, v86
    v_permlane32_swap_b32 v85, v87
    ds_write_b128 v9, v[84:87] offset:64
    v_permlane32_swap_b32 v88, v90
    v_permlane32_swap_b32 v89, v91
    ds_write_b128 v9, v[88:91] offset:128
    s_waitcnt lgkmcnt(3)
    v_or3_b32 v144, v144, v145, v146
    v_or_b32 v144, v144, v147
    s_nop 0
    v_readfirstlane_b32 s54, v144
L_Pa:
    s_cmp_ge_u32 s36, 4
    s_waitcnt vmcnt(0) lgkmcnt(0)
    s_barrier
    s_cbranch_scc0 L_Pd
    ds_read_b128 v[180:183], v116 offset:0
    ds_read_b64_tr_b16 a[0:1], v4 offset:0
    ds_read_b64_tr_b16 a[2:3], v4 offset:768
    ds_read_b64_tr_b16 a[4:5], v4 offset:32
    ds_read_b64_tr_b16 a[6:7], v4 offset:800
    ds_read_b64_tr_b16 a[8:9], v5 offset:64
    ds_read_b64_tr_b16 a[10:11], v5 offset:832
    ds_read_b128 v[192:195], v117 offset:0
    ds_read_b128 v[204:207], v118 offset:0
    ds_read_b64_tr_b16 a[12:13], v4 offset:6208
    ds_read_b64_tr_b16 a[14:15], v4 offset:6976
    s_waitcnt lgkmcnt(7)
    v_mfma_f32_16x16x32_bf16 v[44:47], a[0:3], v[180:183], 0
    s_add_u32 m0, s44, 18624
    ds_read_b128 v[184:187], v116 offset:64
    s_waitcnt lgkmcnt(7)
    v_mfma_f32_16x16x32_bf16 v[48:51], a[4:7], v[180:183], 0
    buffer_load_dwordx4 v7, s[12:15], s46 offen offset:0 lds
    s_waitcnt lgkmcnt(5)
    v_mfma_f32_16x16x32_bf16 v[52:55], a[8:11], v[180:183], 0
    ds_read_b64_tr_b16 a[16:17], v4 offset:6240
    s_waitcnt lgkmcnt(5)
    v_mfma_f32_16x16x32_bf16 v[56:59], a[0:3], v[192:195], 0
    ds_read_b64_tr_b16 a[18:19], v4 offset:7008
    v_mfma_f32_16x16x32_bf16 v[60:63], a[4:7], v[192:195], 0
    ds_read_b64_tr_b16 a[20:21], v5 offset:6272
    ds_read_b64_tr_b16 a[22:23], v5 offset:7040
    v_mfma_f32_16x16x32_bf16 v[64:67], a[8:11], v[192:195], 0
    buffer_load_dwordx4 v7, s[12:15], s46 offen offset:1024 lds
    s_waitcnt lgkmcnt(7)
    v_mfma_f32_16x16x32_bf16 v[68:71], a[0:3], v[204:207], 0
    ds_read_b128 v[196:199], v117 offset:64
    v_mfma_f32_16x16x32_bf16 v[72:75], a[4:7], v[204:207], 0
    ds_read_b128 v[208:211], v118 offset:64
    ds_read_b128 v[188:191], v116 offset:128
    v_mfma_f32_16x16x32_bf16 v[76:79], a[8:11], v[204:207], 0
    ds_read_b64_tr_b16 a[24:25], v4 offset:12416
    ds_read_b64_tr_b16 a[26:27], v4 offset:13184
    s_waitcnt lgkmcnt(5)
    v_mfma_f32_16x16x32_bf16 v[52:55], a[20:23], v[184:187], v[52:55]
    buffer_load_dwordx4 v7, s[12:15], s46 offen offset:2048 lds
    v_mfma_f32_16x16x32_bf16 v[48:51], a[16:19], v[184:187], v[48:51]
    ds_read_b64_tr_b16 a[28:29], v4 offset:12448
    v_mfma_f32_16x16x32_bf16 v[44:47], a[12:15], v[184:187], v[44:47]
    s_add_u32 m0, s45, 18624
    ds_read_b64_tr_b16 a[30:31], v4 offset:13216
    ds_read_b128 v[136:139], v172 offset:256
    s_waitcnt lgkmcnt(7)
    v_mfma_f32_16x16x32_bf16 v[64:67], a[20:23], v[196:199], v[64:67]
    buffer_load_dwordx4 v26, s[12:15], s46 offen offset:0 lds
    ds_read_b64_tr_b16 a[32:33], v5 offset:12480
    v_mfma_f32_16x16x32_bf16 v[60:63], a[16:19], v[196:199], v[60:63]
    ds_read_b64_tr_b16 a[34:35], v5 offset:13248
    ds_read_b128 v[200:203], v117 offset:128
    ds_read_b128 v[212:215], v118 offset:128
    v_mfma_f32_16x16x32_bf16 v[56:59], a[12:15], v[196:199], v[56:59]
    ds_read_b128 v[216:219], v119 offset:0
    s_waitcnt lgkmcnt(7)
    v_mfma_f32_16x16x32_bf16 v[76:79], a[20:23], v[208:211], v[76:79]
    ds_read_b128 v[220:223], v119 offset:64
    v_mfma_f32_16x16x32_bf16 v[72:75], a[16:19], v[208:211], v[72:75]
    buffer_load_dwordx4 v26, s[12:15], s46 offen offset:1024 lds
    s_add_u32 s46, s46, 18432
    v_mfma_f32_16x16x32_bf16 v[68:71], a[12:15], v[208:211], v[68:71]
    ds_read_b128 v[224:227], v119 offset:128
    v_mfma_f32_16x16x32_bf16 v[44:47], a[24:27], v[188:191], v[44:47]
    s_add_u32 m0, s44, 37248
    s_waitcnt lgkmcnt(7)
    v_xor_b32 v136, v136, v166
    v_xor_b32 v137, v137, v166
    v_mfma_f32_16x16x32_bf16 v[48:51], a[28:31], v[188:191], v[48:51]
    buffer_load_dwordx4 v7, s[12:15], s46 offen offset:0 lds
    s_waitcnt lgkmcnt(5)
    v_mfma_f32_16x16x32_bf16 v[52:55], a[32:35], v[188:191], v[52:55]
    ds_read_b128 v[228:231], v120 offset:0
    v_xor_b32 v138, v138, v166
    v_xor_b32 v139, v139, v166
    s_waitcnt lgkmcnt(5)
    v_mfma_f32_16x16x32_bf16 v[56:59], a[24:27], v[200:203], v[56:59]
    ds_read_b128 v[232:235], v120 offset:64
    v_lshlrev_b32_sdwa v122, 4, v136 dst_sel:DWORD dst_unused:UNUSED_PAD src0_sel:DWORD src1_sel:WORD_0
    v_lshlrev_b32_sdwa v123, 4, v138 dst_sel:DWORD dst_unused:UNUSED_PAD src0_sel:DWORD src1_sel:WORD_0
    v_mfma_f32_16x16x32_bf16 v[60:63], a[28:31], v[200:203], v[60:63]
    ds_read_b128 v[236:239], v120 offset:128
    v_lshlrev_b32_sdwa v124, 4, v136 dst_sel:DWORD dst_unused:UNUSED_PAD src0_sel:DWORD src1_sel:WORD_1
    v_lshlrev_b32_sdwa v125, 4, v138 dst_sel:DWORD dst_unused:UNUSED_PAD src0_sel:DWORD src1_sel:WORD_1
    v_mfma_f32_16x16x32_bf16 v[64:67], a[32:35], v[200:203], v[64:67]
    buffer_load_dwordx4 v7, s[12:15], s46 offen offset:1024 lds
    s_waitcnt lgkmcnt(6)
    v_mfma_f32_16x16x32_bf16 v[68:71], a[24:27], v[212:215], v[68:71]
    ds_read_b128 v[240:243], v121 offset:0
    v_lshlrev_b32_sdwa v126, 4, v137 dst_sel:DWORD dst_unused:UNUSED_PAD src0_sel:DWORD src1_sel:WORD_0
    v_lshlrev_b32_sdwa v127, 4, v139 dst_sel:DWORD dst_unused:UNUSED_PAD src0_sel:DWORD src1_sel:WORD_0
    v_mfma_f32_16x16x32_bf16 v[72:75], a[28:31], v[212:215], v[72:75]
    ds_read_b128 v[244:247], v121 offset:64
    v_mfma_f32_16x16x32_bf16 v[76:79], a[32:35], v[212:215], v[76:79]
    s_waitcnt lgkmcnt(7)
    v_mfma_f32_16x16x32_bf16 v[80:83], a[0:3], v[216:219], 0
    ds_read_b128 v[248:251], v121 offset:128
    v_mfma_f32_16x16x32_bf16 v[84:87], a[4:7], v[216:219], 0
    buffer_load_dwordx4 v7, s[12:15], s46 offen offset:2048 lds
    v_mfma_f32_16x16x32_bf16 v[88:91], a[8:11], v[216:219], 0
    ds_read_b128 v[180:183], v122 offset:0
    s_waitcnt lgkmcnt(7)
    v_mfma_f32_16x16x32_bf16 v[88:91], a[20:23], v[220:223], v[88:91]
    v_mfma_f32_16x16x32_bf16 v[84:87], a[16:19], v[220:223], v[84:87]
    ds_read_b128 v[184:187], v122 offset:64
    s_waitcnt vmcnt(3)
    s_barrier
    s_branch L_Pa_s0
L_Pa_t0:
    s_setpc_b64 s[78:79]
L_Pa_s0:
    v_mfma_f32_16x16x32_bf16 v[80:83], a[12:15], v[220:223], v[80:83]
    s_add_u32 m0, s45, 37248
    ds_read_b64_tr_b16 a[36:37], v4 offset:18624
    v_mfma_f32_16x16x32_bf16 v[80:83], a[24:27], v[224:227], v[80:83]
    buffer_load_dwordx4 v26, s[12:15], s46 offen offset:0 lds
    v_mfma_f32_16x16x32_bf16 v[84:87], a[28:31], v[224:227], v[84:87]
    ds_read_b128 v[188:191], v122 offset:128
    ds_read_b64_tr_b16 a[38:39], v4 offset:19392
    v_mfma_f32_16x16x32_bf16 v[88:91], a[32:35], v[224:227], v[88:91]
    ds_read_b64_tr_b16 a[40:41], v4 offset:18656
    s_waitcnt lgkmcnt(7)
    v_mfma_f32_16x16x32_bf16 v[92:95], a[0:3], v[228:231], 0
    ds_read_b64_tr_b16 a[42:43], v4 offset:19424
    ds_read_b64_tr_b16 a[44:45], v5 offset:18688
    v_mfma_f32_16x16x32_bf16 v[96:99], a[4:7], v[228:231], 0
    buffer_load_dwordx4 v26, s[12:15], s46 offen offset:1024 lds
    s_add_u32 s46, s46, 18432
    v_mfma_f32_16x16x32_bf16 v[100:103], a[8:11], v[228:231], 0
    ds_read_b128 v[192:195], v123 offset:0
    ds_read_b64_tr_b16 a[46:47], v5 offset:19456
    v_mfma_f32_16x16x32_bf16 v[100:103], a[20:23], v[232:235], v[100:103]
    ds_read_b64_tr_b16 a[48:49], v4 offset:24832
    ds_read_b64_tr_b16 a[50:51], v4 offset:25600
    v_mfma_f32_16x16x32_bf16 v[96:99], a[16:19], v[232:235], v[96:99]
    ds_read_b128 v[196:199], v123 offset:64
    v_mfma_f32_16x16x32_bf16 v[92:95], a[12:15], v[232:235], v[92:95]
    ds_read_b64_tr_b16 a[52:53], v4 offset:24864
    v_mfma_f32_16x16x32_bf16 v[92:95], a[24:27], v[236:239], v[92:95]
    ds_read_b64_tr_b16 a[54:55], v4 offset:25632
    ds_read_b64_tr_b16 a[56:57], v5 offset:24896
    v_mfma_f32_16x16x32_bf16 v[96:99], a[28:31], v[236:239], v[96:99]
    ds_read_b128 v[200:203], v123 offset:128
    s_add_u32 m0, s44, 0
    v_mfma_f32_16x16x32_bf16 v[100:103], a[32:35], v[236:239], v[100:103]
    buffer_load_dwordx4 v7, s[12:15], s46 offen offset:0 lds
    ds_read_b64_tr_b16 a[58:59], v5 offset:25664
    v_mfma_f32_16x16x32_bf16 v[104:107], a[0:3], v[240:243], 0
    ds_read_b64_tr_b16 a[60:61], v4 offset:31040
    ds_read_b64_tr_b16 a[62:63], v4 offset:31808
    v_mfma_f32_16x16x32_bf16 v[108:111], a[4:7], v[240:243], 0
    ds_read_b128 v[204:207], v124 offset:0
    ds_read_b64_tr_b16 a[64:65], v4 offset:31072
    v_mfma_f32_16x16x32_bf16 v[112:115], a[8:11], v[240:243], 0
    buffer_load_dwordx4 v7, s[12:15], s46 offen offset:1024 lds
    v_mfma_f32_16x16x32_bf16 v[112:115], a[20:23], v[244:247], v[112:115]
    ds_read_b64_tr_b16 a[66:67], v4 offset:31840
    ds_read_b64_tr_b16 a[68:69], v5 offset:31104
    ds_read_b64_tr_b16 a[70:71], v5 offset:31872
    v_mfma_f32_16x16x32_bf16 v[108:111], a[16:19], v[244:247], v[108:111]
    ds_read_b128 v[208:211], v124 offset:64
    v_mfma_f32_16x16x32_bf16 v[104:107], a[12:15], v[244:247], v[104:107]
    s_waitcnt lgkmcnt(7)
    v_mfma_f32_16x16x32_bf16 v[104:107], a[24:27], v[248:251], v[104:107]
    buffer_load_dwordx4 v7, s[12:15], s46 offen offset:2048 lds
    v_mfma_f32_16x16x32_bf16 v[108:111], a[28:31], v[248:251], v[108:111]
    ds_read_b128 v[212:215], v124 offset:128
    v_mfma_f32_16x16x32_bf16 v[112:115], a[32:35], v[248:251], v[112:115]
    s_waitcnt vmcnt(3)
    s_waitcnt lgkmcnt(2)
    s_barrier
    v_mfma_f32_16x16x32_bf16 v[44:47], a[36:39], v[180:183], v[44:47]
    v_mfma_f32_16x16x32_bf16 v[48:51], a[40:43], v[180:183], v[48:51]
    ds_read_b128 v[216:219], v125 offset:0
    s_add_u32 m0, s45, 0
    v_mfma_f32_16x16x32_bf16 v[52:55], a[44:47], v[180:183], v[52:55]
    buffer_load_dwordx4 v26, s[12:15], s46 offen offset:0 lds
    v_mfma_f32_16x16x32_bf16 v[52:55], a[56:59], v[184:187], v[52:55]
    ds_read_b128 v[136:139], v172 offset:512
    ds_read_b64_tr_b16 a[72:73], v4 offset:37248
    v_mfma_f32_16x16x32_bf16 v[48:51], a[52:55], v[184:187], v[48:51]
    ds_read_b128 v[220:223], v125 offset:64
    v_mfma_f32_16x16x32_bf16 v[44:47], a[48:51], v[184:187], v[44:47]
    buffer_load_dwordx4 v26, s[12:15], s46 offen offset:1024 lds
    s_add_u32 s46, s46, 18432
    v_mfma_f32_16x16x32_bf16 v[44:47], a[60:63], v[188:191], v[44:47]
    ds_read_b64_tr_b16 a[74:75], v4 offset:38016
    v_mfma_f32_16x16x32_bf16 v[48:51], a[64:67], v[188:191], v[48:51]
    ds_read_b128 v[224:227], v125 offset:128
    v_mfma_f32_16x16x32_bf16 v[52:55], a[68:71], v[188:191], v[52:55]
    ds_read_b64_tr_b16 a[76:77], v4 offset:37280
    v_mfma_f32_16x16x32_bf16 v[56:59], a[36:39], v[192:195], v[56:59]
    ds_read_b64_tr_b16 a[78:79], v4 offset:38048
    v_mfma_f32_16x16x32_bf16 v[60:63], a[40:43], v[192:195], v[60:63]
    ds_read_b128 v[228:231], v126 offset:0
    v_mfma_f32_16x16x32_bf16 v[64:67], a[44:47], v[192:195], v[64:67]
    s_add_u32 m0, s44, 18624
    v_mfma_f32_16x16x32_bf16 v[64:67], a[56:59], v[196:199], v[64:67]
    buffer_load_dwordx4 v7, s[12:15], s46 offen offset:0 lds
    v_mfma_f32_16x16x32_bf16 v[60:63], a[52:55], v[196:199], v[60:63]
    ds_read_b128 v[232:235], v126 offset:64
    ds_read_b64_tr_b16 a[80:81], v5 offset:37312
    v_mfma_f32_16x16x32_bf16 v[56:59], a[48:51], v[196:199], v[56:59]
    s_waitcnt lgkmcnt(7)
    v_xor_b32 v136, v136, v166
    v_xor_b32 v137, v137, v166
    v_mfma_f32_16x16x32_bf16 v[56:59], a[60:63], v[200:203], v[56:59]
    v_xor_b32 v138, v138, v166
    v_xor_b32 v139, v139, v166
    v_mfma_f32_16x16x32_bf16 v[60:63], a[64:67], v[200:203], v[60:63]
    ds_read_b128 v[236:239], v126 offset:128
    v_mfma_f32_16x16x32_bf16 v[64:67], a[68:71], v[200:203], v[64:67]
    ds_read_b64_tr_b16 a[82:83], v5 offset:38080
    ds_read_b64_tr_b16 a[84:85], v4 offset:43456
    v_mfma_f32_16x16x32_bf16 v[68:71], a[36:39], v[204:207], v[68:71]
    buffer_load_dwordx4 v7, s[12:15], s46 offen offset:1024 lds
    v_mfma_f32_16x16x32_bf16 v[72:75], a[40:43], v[204:207], v[72:75]
    ds_read_b128 v[240:243], v127 offset:0
    v_mfma_f32_16x16x32_bf16 v[76:79], a[44:47], v[204:207], v[76:79]
    v_lshlrev_b32_sdwa v128, 4, v136 dst_sel:DWORD dst_unused:UNUSED_PAD src0_sel:DWORD src1_sel:WORD_0
    v_lshlrev_b32_sdwa v129, 4, v138 dst_sel:DWORD dst_unused:UNUSED_PAD src0_sel:DWORD src1_sel:WORD_0
    v_mfma_f32_16x16x32_bf16 v[76:79], a[56:59], v[208:211], v[76:79]
    v_lshlrev_b32_sdwa v130, 4, v136 dst_sel:DWORD dst_unused:UNUSED_PAD src0_sel:DWORD src1_sel:WORD_1
    v_lshlrev_b32_sdwa v131, 4, v138 dst_sel:DWORD dst_unused:UNUSED_PAD src0_sel:DWORD src1_sel:WORD_1
    v_mfma_f32_16x16x32_bf16 v[72:75], a[52:55], v[208:211], v[72:75]
    ds_read_b128 v[244:247], v127 offset:64
    v_mfma_f32_16x16x32_bf16 v[68:71], a[48:51], v[208:211], v[68:71]
    ds_read_b64_tr_b16 a[86:87], v4 offset:44224
    v_mfma_f32_16x16x32_bf16 v[68:71], a[60:63], v[212:215], v[68:71]
    buffer_load_dwordx4 v7, s[12:15], s46 offen offset:2048 lds
    v_mfma_f32_16x16x32_bf16 v[72:75], a[64:67], v[212:215], v[72:75]
    ds_read_b128 v[248:251], v127 offset:128
    v_lshlrev_b32_sdwa v132, 4, v137 dst_sel:DWORD dst_unused:UNUSED_PAD src0_sel:DWORD src1_sel:WORD_0
    v_lshlrev_b32_sdwa v133, 4, v139 dst_sel:DWORD dst_unused:UNUSED_PAD src0_sel:DWORD src1_sel:WORD_0
    v_mfma_f32_16x16x32_bf16 v[76:79], a[68:71], v[212:215], v[76:79]
    ds_read_b64_tr_b16 a[88:89], v4 offset:43488
    v_mfma_f32_16x16x32_bf16 v[80:83], a[36:39], v[216:219], v[80:83]
    ds_read_b64_tr_b16 a[90:91], v4 offset:44256
    v_mfma_f32_16x16x32_bf16 v[84:87], a[40:43], v[216:219], v[84:87]
    ds_read_b128 v[180:183], v128 offset:0
    v_mfma_f32_16x16x32_bf16 v[88:91], a[44:47], v[216:219], v[88:91]
    s_add_u32 m0, s45, 18624
    v_mfma_f32_16x16x32_bf16 v[88:91], a[56:59], v[220:223], v[88:91]
    buffer_load_dwordx4 v26, s[12:15], s46 offen offset:0 lds
    v_mfma_f32_16x16x32_bf16 v[84:87], a[52:55], v[220:223], v[84:87]
    ds_read_b128 v[184:187], v128 offset:64
    v_mfma_f32_16x16x32_bf16 v[80:83], a[48:51], v[220:223], v[80:83]
    ds_read_b64_tr_b16 a[92:93], v5 offset:43520
    s_waitcnt lgkmcnt(7)
    v_mfma_f32_16x16x32_bf16 v[80:83], a[60:63], v[224:227], v[80:83]
    ds_read_b64_tr_b16 a[94:95], v5 offset:44288
    v_mfma_f32_16x16x32_bf16 v[84:87], a[64:67], v[224:227], v[84:87]
    ds_read_b128 v[188:191], v128 offset:128
    v_mfma_f32_16x16x32_bf16 v[88:91], a[68:71], v[224:227], v[88:91]
    ds_read_b64_tr_b16 a[96:97], v4 offset:49664
    v_mfma_f32_16x16x32_bf16 v[92:95], a[36:39], v[228:231], v[92:95]
    buffer_load_dwordx4 v26, s[12:15], s46 offen offset:1024 lds
    s_add_u32 s46, s46, 18432
    v_mfma_f32_16x16x32_bf16 v[96:99], a[40:43], v[228:231], v[96:99]
    ds_read_b128 v[192:195], v129 offset:0
    v_mfma_f32_16x16x32_bf16 v[100:103], a[44:47], v[228:231], v[100:103]
    ds_read_b64_tr_b16 a[98:99], v4 offset:50432
    v_mfma_f32_16x16x32_bf16 v[100:103], a[56:59], v[232:235], v[100:103]
    ds_read_b64_tr_b16 a[100:101], v4 offset:49696
    v_mfma_f32_16x16x32_bf16 v[96:99], a[52:55], v[232:235], v[96:99]
    ds_read_b128 v[196:199], v129 offset:64
    v_mfma_f32_16x16x32_bf16 v[92:95], a[48:51], v[232:235], v[92:95]
    v_mfma_f32_16x16x32_bf16 v[92:95], a[60:63], v[236:239], v[92:95]
    ds_read_b64_tr_b16 a[102:103], v4 offset:50464
    v_mfma_f32_16x16x32_bf16 v[96:99], a[64:67], v[236:239], v[96:99]
    ds_read_b128 v[200:203], v129 offset:128
    v_mfma_f32_16x16x32_bf16 v[100:103], a[68:71], v[236:239], v[100:103]
    ds_read_b64_tr_b16 a[104:105], v5 offset:49728
    v_mfma_f32_16x16x32_bf16 v[104:107], a[36:39], v[240:243], v[104:107]
    v_mfma_f32_16x16x32_bf16 v[108:111], a[40:43], v[240:243], v[108:111]
    ds_read_b128 v[204:207], v130 offset:0
    v_mfma_f32_16x16x32_bf16 v[112:115], a[44:47], v[240:243], v[112:115]
    ds_read_b64_tr_b16 a[106:107], v5 offset:50496
    v_mfma_f32_16x16x32_bf16 v[112:115], a[56:59], v[244:247], v[112:115]
    v_mfma_f32_16x16x32_bf16 v[108:111], a[52:55], v[244:247], v[108:111]
    ds_read_b128 v[208:211], v130 offset:64
    v_mfma_f32_16x16x32_bf16 v[104:107], a[48:51], v[244:247], v[104:107]
    s_waitcnt lgkmcnt(7)
    v_mfma_f32_16x16x32_bf16 v[104:107], a[60:63], v[248:251], v[104:107]
    v_mfma_f32_16x16x32_bf16 v[108:111], a[64:67], v[248:251], v[108:111]
    ds_read_b128 v[212:215], v130 offset:128
    v_mfma_f32_16x16x32_bf16 v[112:115], a[68:71], v[248:251], v[112:115]
    s_waitcnt vmcnt(5)
    s_waitcnt lgkmcnt(2)
    s_barrier
    v_mfma_f32_16x16x32_bf16 v[44:47], a[72:75], v[180:183], v[44:47]
    v_mfma_f32_16x16x32_bf16 v[48:51], a[76:79], v[180:183], v[48:51]
    ds_read_b128 v[216:219], v131 offset:0
    v_mfma_f32_16x16x32_bf16 v[52:55], a[80:83], v[180:183], v[52:55]
    ds_read_b64_tr_b16 a[108:109], v4 offset:0
    v_mfma_f32_16x16x32_bf16 v[52:55], a[92:95], v[184:187], v[52:55]
    ds_read_b128 v[136:139], v172 offset:768
    v_mfma_f32_16x16x32_bf16 v[48:51], a[88:91], v[184:187], v[48:51]
    ds_read_b128 v[220:223], v131 offset:64
    s_add_u32 m0, s44, 37248
    v_mfma_f32_16x16x32_bf16 v[44:47], a[84:87], v[184:187], v[44:47]
    buffer_load_dwordx4 v7, s[12:15], s46 offen offset:0 lds
    v_mfma_f32_16x16x32_bf16 v[44:47], a[96:99], v[188:191], v[44:47]
    ds_read_b64_tr_b16 a[110:111], v4 offset:768
    v_mfma_f32_16x16x32_bf16 v[48:51], a[100:103], v[188:191], v[48:51]
    ds_read_b128 v[224:227], v131 offset:128
    v_mfma_f32_16x16x32_bf16 v[52:55], a[104:107], v[188:191], v[52:55]
    ds_read_b64_tr_b16 a[112:113], v4 offset:32
    v_mfma_f32_16x16x32_bf16 v[56:59], a[72:75], v[192:195], v[56:59]
    ds_read_b64_tr_b16 a[114:115], v4 offset:800
    v_mfma_f32_16x16x32_bf16 v[60:63], a[76:79], v[192:195], v[60:63]
    ds_read_b128 v[228:231], v132 offset:0
    v_mfma_f32_16x16x32_bf16 v[64:67], a[80:83], v[192:195], v[64:67]
    s_waitcnt lgkmcnt(6)
    v_xor_b32 v136, v136, v166
    v_xor_b32 v137, v137, v166
    v_mfma_f32_16x16x32_bf16 v[64:67], a[92:95], v[196:199], v[64:67]
    buffer_load_dwordx4 v7, s[12:15], s46 offen offset:1024 lds
    v_mfma_f32_16x16x32_bf16 v[60:63], a[88:91], v[196:199], v[60:63]
    ds_read_b128 v[232:235], v132 offset:64
    v_mfma_f32_16x16x32_bf16 v[56:59], a[84:87], v[196:199], v[56:59]
    v_xor_b32 v138, v138, v166
    v_xor_b32 v139, v139, v166
    v_mfma_f32_16x16x32_bf16 v[56:59], a[96:99], v[200:203], v[56:59]
    ds_read_b64_tr_b16 a[116:117], v5 offset:64
    v_mfma_f32_16x16x32_bf16 v[60:63], a[100:103], v[200:203], v[60:63]
    ds_read_b128 v[236:239], v132 offset:128
    v_mfma_f32_16x16x32_bf16 v[64:67], a[104:107], v[200:203], v[64:67]
    ds_read_b64_tr_b16 a[118:119], v5 offset:832
    ds_read_b64_tr_b16 a[120:121], v4 offset:6208
    v_mfma_f32_16x16x32_bf16 v[68:71], a[72:75], v[204:207], v[68:71]
    v_lshlrev_b32_sdwa v116, 4, v136 dst_sel:DWORD dst_unused:UNUSED_PAD src0_sel:DWORD src1_sel:WORD_0
    v_lshlrev_b32_sdwa v117, 4, v138 dst_sel:DWORD dst_unused:UNUSED_PAD src0_sel:DWORD src1_sel:WORD_0
    v_mfma_f32_16x16x32_bf16 v[72:75], a[76:79], v[204:207], v[72:75]
    ds_read_b128 v[240:243], v133 offset:0
    v_mfma_f32_16x16x32_bf16 v[76:79], a[80:83], v[204:207], v[76:79]
    buffer_load_dwordx4 v7, s[12:15], s46 offen offset:2048 lds
    v_mfma_f32_16x16x32_bf16 v[76:79], a[92:95], v[208:211], v[76:79]
    v_lshlrev_b32_sdwa v118, 4, v136 dst_sel:DWORD dst_unused:UNUSED_PAD src0_sel:DWORD src1_sel:WORD_1
    v_lshlrev_b32_sdwa v119, 4, v138 dst_sel:DWORD dst_unused:UNUSED_PAD src0_sel:DWORD src1_sel:WORD_1
    v_mfma_f32_16x16x32_bf16 v[72:75], a[88:91], v[208:211], v[72:75]
    ds_read_b128 v[244:247], v133 offset:64
    v_mfma_f32_16x16x32_bf16 v[68:71], a[84:87], v[208:211], v[68:71]
    ds_read_b64_tr_b16 a[122:123], v4 offset:6976
    v_mfma_f32_16x16x32_bf16 v[68:71], a[96:99], v[212:215], v[68:71]
    v_lshlrev_b32_sdwa v120, 4, v137 dst_sel:DWORD dst_unused:UNUSED_PAD src0_sel:DWORD src1_sel:WORD_0
    v_lshlrev_b32_sdwa v121, 4, v139 dst_sel:DWORD dst_unused:UNUSED_PAD src0_sel:DWORD src1_sel:WORD_0
    v_mfma_f32_16x16x32_bf16 v[72:75], a[100:103], v[212:215], v[72:75]
    ds_read_b128 v[248:251], v133 offset:128
    v_mfma_f32_16x16x32_bf16 v[76:79], a[104:107], v[212:215], v[76:79]
    ds_read_b64_tr_b16 a[124:125], v4 offset:6240
    v_mfma_f32_16x16x32_bf16 v[80:83], a[72:75], v[216:219], v[80:83]
    ds_read_b64_tr_b16 a[126:127], v4 offset:7008
    v_mfma_f32_16x16x32_bf16 v[84:87], a[76:79], v[216:219], v[84:87]
    ds_read_b128 v[180:183], v116 offset:0
    s_add_u32 m0, s45, 37248
    v_mfma_f32_16x16x32_bf16 v[88:91], a[80:83], v[216:219], v[88:91]
    buffer_load_dwordx4 v26, s[12:15], s46 offen offset:0 lds
    s_waitcnt lgkmcnt(7)
    v_mfma_f32_16x16x32_bf16 v[88:91], a[92:95], v[220:223], v[88:91]
    ds_read_b64_tr_b16 a[128:129], v5 offset:6272
    v_mfma_f32_16x16x32_bf16 v[84:87], a[88:91], v[220:223], v[84:87]
    ds_read_b128 v[184:187], v116 offset:64
    v_mfma_f32_16x16x32_bf16 v[80:83], a[84:87], v[220:223], v[80:83]
    ds_read_b64_tr_b16 a[130:131], v5 offset:7040
    v_mfma_f32_16x16x32_bf16 v[80:83], a[96:99], v[224:227], v[80:83]
    v_mfma_f32_16x16x32_bf16 v[84:87], a[100:103], v[224:227], v[84:87]
    ds_read_b128 v[188:191], v116 offset:128
    v_mfma_f32_16x16x32_bf16 v[88:91], a[104:107], v[224:227], v[88:91]
    ds_read_b64_tr_b16 a[132:133], v4 offset:12416
    v_mfma_f32_16x16x32_bf16 v[92:95], a[72:75], v[228:231], v[92:95]
    buffer_load_dwordx4 v26, s[12:15], s46 offen offset:1024 lds
    s_add_u32 s46, s46, 18432
    v_mfma_f32_16x16x32_bf16 v[96:99], a[76:79], v[228:231], v[96:99]
    ds_read_b128 v[192:195], v117 offset:0
    v_mfma_f32_16x16x32_bf16 v[100:103], a[80:83], v[228:231], v[100:103]
    ds_read_b64_tr_b16 a[134:135], v4 offset:13184
    v_mfma_f32_16x16x32_bf16 v[100:103], a[92:95], v[232:235], v[100:103]
    ds_read_b64_tr_b16 a[136:137], v4 offset:12448
    v_mfma_f32_16x16x32_bf16 v[96:99], a[88:91], v[232:235], v[96:99]
    ds_read_b128 v[196:199], v117 offset:64
    v_mfma_f32_16x16x32_bf16 v[92:95], a[84:87], v[232:235], v[92:95]
    v_mfma_f32_16x16x32_bf16 v[92:95], a[96:99], v[236:239], v[92:95]
    ds_read_b64_tr_b16 a[138:139], v4 offset:13216
    v_mfma_f32_16x16x32_bf16 v[96:99], a[100:103], v[236:239], v[96:99]
    ds_read_b128 v[200:203], v117 offset:128
    v_mfma_f32_16x16x32_bf16 v[100:103], a[104:107], v[236:239], v[100:103]
    ds_read_b64_tr_b16 a[140:141], v5 offset:12480
    s_waitcnt lgkmcnt(7)
    v_mfma_f32_16x16x32_bf16 v[104:107], a[72:75], v[240:243], v[104:107]
    v_mfma_f32_16x16x32_bf16 v[108:111], a[76:79], v[240:243], v[108:111]
    ds_read_b128 v[204:207], v118 offset:0
    v_mfma_f32_16x16x32_bf16 v[112:115], a[80:83], v[240:243], v[112:115]
    ds_read_b64_tr_b16 a[142:143], v5 offset:13248
    v_mfma_f32_16x16x32_bf16 v[112:115], a[92:95], v[244:247], v[112:115]
    v_mfma_f32_16x16x32_bf16 v[108:111], a[88:91], v[244:247], v[108:111]
    ds_read_b128 v[208:211], v118 offset:64
    v_mfma_f32_16x16x32_bf16 v[104:107], a[84:87], v[244:247], v[104:107]
    v_mfma_f32_16x16x32_bf16 v[104:107], a[96:99], v[248:251], v[104:107]
    v_mfma_f32_16x16x32_bf16 v[108:111], a[100:103], v[248:251], v[108:111]
    ds_read_b128 v[212:215], v118 offset:128
    v_mfma_f32_16x16x32_bf16 v[112:115], a[104:107], v[248:251], v[112:115]
    s_waitcnt vmcnt(5)
    s_waitcnt lgkmcnt(2)
    s_barrier
    v_mfma_f32_16x16x32_bf16 v[44:47], a[108:111], v[180:183], v[44:47]
    v_mfma_f32_16x16x32_bf16 v[48:51], a[112:115], v[180:183], v[48:51]
    ds_read_b128 v[216:219], v119 offset:0
    v_mfma_f32_16x16x32_bf16 v[52:55], a[116:119], v[180:183], v[52:55]
    ds_read_b64_tr_b16 a[0:1], v4 offset:18624
    v_mfma_f32_16x16x32_bf16 v[52:55], a[128:131], v[184:187], v[52:55]
    ds_read_b128 v[136:139], v172 offset:1024
    v_mfma_f32_16x16x32_bf16 v[48:51], a[124:127], v[184:187], v[48:51]
    ds_read_b128 v[220:223], v119 offset:64
    s_add_u32 m0, s44, 0
    v_mfma_f32_16x16x32_bf16 v[44:47], a[120:123], v[184:187], v[44:47]
    buffer_load_dwordx4 v7, s[12:15], s46 offen offset:0 lds
    v_mfma_f32_16x16x32_bf16 v[44:47], a[132:135], v[188:191], v[44:47]
    ds_read_b64_tr_b16 a[2:3], v4 offset:19392
    v_mfma_f32_16x16x32_bf16 v[48:51], a[136:139], v[188:191], v[48:51]
    ds_read_b128 v[224:227], v119 offset:128
    v_mfma_f32_16x16x32_bf16 v[52:55], a[140:143], v[188:191], v[52:55]
    ds_read_b64_tr_b16 a[4:5], v4 offset:18656
    v_mfma_f32_16x16x32_bf16 v[56:59], a[108:111], v[192:195], v[56:59]
    ds_read_b64_tr_b16 a[6:7], v4 offset:19424
    v_mfma_f32_16x16x32_bf16 v[60:63], a[112:115], v[192:195], v[60:63]
    ds_read_b128 v[228:231], v120 offset:0
    v_mfma_f32_16x16x32_bf16 v[64:67], a[116:119], v[192:195], v[64:67]
    s_waitcnt lgkmcnt(6)
    v_xor_b32 v136, v136, v166
    v_xor_b32 v137, v137, v166
    v_mfma_f32_16x16x32_bf16 v[64:67], a[128:131], v[196:199], v[64:67]
    buffer_load_dwordx4 v7, s[12:15], s46 offen offset:1024 lds
    v_mfma_f32_16x16x32_bf16 v[60:63], a[124:127], v[196:199], v[60:63]
    ds_read_b128 v[232:235], v120 offset:64
    v_mfma_f32_16x16x32_bf16 v[56:59], a[120:123], v[196:199], v[56:59]
    v_xor_b32 v138, v138, v166
    v_xor_b32 v139, v139, v166
    v_mfma_f32_16x16x32_bf16 v[56:59], a[132:135], v[200:203], v[56:59]
    ds_read_b64_tr_b16 a[8:9], v5 offset:18688
    v_mfma_f32_16x16x32_bf16 v[60:63], a[136:139], v[200:203], v[60:63]
    ds_read_b128 v[236:239], v120 offset:128
    v_mfma_f32_16x16x32_bf16 v[64:67], a[140:143], v[200:203], v[64:67]
    ds_read_b64_tr_b16 a[10:11], v5 offset:19456
    ds_read_b64_tr_b16 a[12:13], v4 offset:24832
    v_mfma_f32_16x16x32_bf16 v[68:71], a[108:111], v[204:207], v[68:71]
    v_lshlrev_b32_sdwa v122, 4, v136 dst_sel:DWORD dst_unused:UNUSED_PAD src0_sel:DWORD src1_sel:WORD_0
    v_lshlrev_b32_sdwa v123, 4, v138 dst_sel:DWORD dst_unused:UNUSED_PAD src0_sel:DWORD src1_sel:WORD_0
    v_mfma_f32_16x16x32_bf16 v[72:75], a[112:115], v[204:207], v[72:75]
    ds_read_b128 v[240:243], v121 offset:0
    v_mfma_f32_16x16x32_bf16 v[76:79], a[116:119], v[204:207], v[76:79]
    buffer_load_dwordx4 v7, s[12:15], s46 offen offset:2048 lds
    v_mfma_f32_16x16x32_bf16 v[76:79], a[128:131], v[208:211], v[76:79]
    v_lshlrev_b32_sdwa v124, 4, v136 dst_sel:DWORD dst_unused:UNUSED_PAD src0_sel:DWORD src1_sel:WORD_1
    v_lshlrev_b32_sdwa v125, 4, v138 dst_sel:DWORD dst_unused:UNUSED_PAD src0_sel:DWORD src1_sel:WORD_1
    v_mfma_f32_16x16x32_bf16 v[72:75], a[124:127], v[208:211], v[72:75]
    ds_read_b128 v[244:247], v121 offset:64
    v_mfma_f32_16x16x32_bf16 v[68:71], a[120:123], v[208:211], v[68:71]
    ds_read_b64_tr_b16 a[14:15], v4 offset:25600
    v_mfma_f32_16x16x32_bf16 v[68:71], a[132:135], v[212:215], v[68:71]
    v_lshlrev_b32_sdwa v126, 4, v137 dst_sel:DWORD dst_unused:UNUSED_PAD src0_sel:DWORD src1_sel:WORD_0
    v_lshlrev_b32_sdwa v127, 4, v139 dst_sel:DWORD dst_unused:UNUSED_PAD src0_sel:DWORD src1_sel:WORD_0
    v_mfma_f32_16x16x32_bf16 v[72:75], a[136:139], v[212:215], v[72:75]
    ds_read_b128 v[248:251], v121 offset:128
    v_mfma_f32_16x16x32_bf16 v[76:79], a[140:143], v[212:215], v[76:79]
    ds_read_b64_tr_b16 a[16:17], v4 offset:24864
    v_mfma_f32_16x16x32_bf16 v[80:83], a[108:111], v[216:219], v[80:83]
    ds_read_b64_tr_b16 a[18:19], v4 offset:25632
    v_mfma_f32_16x16x32_bf16 v[84:87], a[112:115], v[216:219], v[84:87]
    ds_read_b128 v[180:183], v122 offset:0
    s_add_u32 m0, s45, 0
    v_mfma_f32_16x16x32_bf16 v[88:91], a[116:119], v[216:219], v[88:91]
    buffer_load_dwordx4 v26, s[12:15], s46 offen offset:0 lds
    s_waitcnt lgkmcnt(7)
    v_mfma_f32_16x16x32_bf16 v[88:91], a[128:131], v[220:223], v[88:91]
    ds_read_b64_tr_b16 a[20:21], v5 offset:24896
    s_mul_i32 s47, s30, 6656
    v_mfma_f32_16x16x32_bf16 v[84:87], a[124:127], v[220:223], v[84:87]
    ds_read_b128 v[184:187], v122 offset:64
    v_mfma_f32_16x16x32_bf16 v[80:83], a[120:123], v[220:223], v[80:83]
    ds_read_b64_tr_b16 a[22:23], v5 offset:25664
    v_mfma_f32_16x16x32_bf16 v[80:83], a[132:135], v[224:227], v[80:83]
    v_lshrrev_b32 v38, 4, v6
    s_add_u32 s47, s47, 123744
    v_mfma_f32_16x16x32_bf16 v[84:87], a[136:139], v[224:227], v[84:87]
    ds_read_b128 v[188:191], v122 offset:128
    v_mfma_f32_16x16x32_bf16 v[88:91], a[140:143], v[224:227], v[88:91]
    ds_read_b64_tr_b16 a[24:25], v4 offset:31040
    v_mul_u32_u24 v39, 43, v38
    v_mfma_f32_16x16x32_bf16 v[92:95], a[108:111], v[228:231], v[92:95]
    buffer_load_dwordx4 v26, s[12:15], s46 offen offset:1024 lds
    s_add_u32 s46, s46, 18432
    v_mfma_f32_16x16x32_bf16 v[96:99], a[112:115], v[228:231], v[96:99]
    ds_read_b128 v[192:195], v123 offset:0
    v_add_u32 v40, 128, v38
    v_mfma_f32_16x16x32_bf16 v[100:103], a[116:119], v[228:231], v[100:103]
    ds_read_b64_tr_b16 a[26:27], v4 offset:31808
    v_mfma_f32_16x16x32_bf16 v[100:103], a[128:131], v[232:235], v[100:103]
    ds_read_b64_tr_b16 a[28:29], v4 offset:31072
    v_mfma_f32_16x16x32_bf16 v[96:99], a[124:127], v[232:235], v[96:99]
    ds_read_b128 v[196:199], v123 offset:64
    v_mfma_f32_16x16x32_bf16 v[92:95], a[120:123], v[232:235], v[92:95]
    s_lshl_b32 s48, s29, 3
    v_lshrrev_b32 v39, 9, v39
    v_mfma_f32_16x16x32_bf16 v[92:95], a[132:135], v[236:239], v[92:95]
    ds_read_b64_tr_b16 a[30:31], v4 offset:31840
    v_mfma_f32_16x16x32_bf16 v[96:99], a[136:139], v[236:239], v[96:99]
    ds_read_b128 v[200:203], v123 offset:128
    v_mfma_f32_16x16x32_bf16 v[100:103], a[140:143], v[236:239], v[100:103]
    ds_read_b64_tr_b16 a[32:33], v5 offset:31104
    s_waitcnt lgkmcnt(7)
    v_mfma_f32_16x16x32_bf16 v[104:107], a[108:111], v[240:243], v[104:107]
    v_mul_u32_u24 v41, 2731, v40
    v_mfma_f32_16x16x32_bf16 v[108:111], a[112:115], v[240:243], v[108:111]
    ds_read_b128 v[204:207], v124 offset:0
    v_mfma_f32_16x16x32_bf16 v[112:115], a[116:119], v[240:243], v[112:115]
    ds_read_b64_tr_b16 a[34:35], v5 offset:31872
    v_mfma_f32_16x16x32_bf16 v[112:115], a[128:131], v[244:247], v[112:115]
    v_mad_i32_i24 v38, v39, -12, v38
    v_lshrrev_b32 v41, 16, v41
    v_mfma_f32_16x16x32_bf16 v[108:111], a[124:127], v[244:247], v[108:111]
    ds_read_b128 v[208:211], v124 offset:64
    v_mfma_f32_16x16x32_bf16 v[104:107], a[120:123], v[244:247], v[104:107]
    v_add_u32 v39, s48, v39
    v_mfma_f32_16x16x32_bf16 v[104:107], a[132:135], v[248:251], v[104:107]
    v_mfma_f32_16x16x32_bf16 v[108:111], a[136:139], v[248:251], v[108:111]
    ds_read_b128 v[212:215], v124 offset:128
    v_mfma_f32_16x16x32_bf16 v[112:115], a[140:143], v[248:251], v[112:115]
    s_waitcnt vmcnt(5)
    s_waitcnt lgkmcnt(2)
    s_barrier
    v_mul_u32_u24 v42, 24, v41
    v_mfma_f32_16x16x32_bf16 v[44:47], a[0:3], v[180:183], v[44:47]
    v_mul_u32_u24 v22, 208, v39
    v_mfma_f32_16x16x32_bf16 v[48:51], a[4:7], v[180:183], v[48:51]
    ds_read_b128 v[216:219], v125 offset:0
    v_mfma_f32_16x16x32_bf16 v[52:55], a[8:11], v[180:183], v[52:55]
    ds_read_b64_tr_b16 a[36:37], v4 offset:37248
    v_sub_u32 v40, v40, v42
    v_mfma_f32_16x16x32_bf16 v[52:55], a[20:23], v[184:187], v[52:55]
    ds_read_b128 v[136:139], v172 offset:1280
    v_mfma_f32_16x16x32_bf16 v[48:51], a[16:19], v[184:187], v[48:51]
    ds_read_b128 v[220:223], v125 offset:64
    s_add_u32 m0, s44, 18624
    v_mfma_f32_16x16x32_bf16 v[44:47], a[12:15], v[184:187], v[44:47]
    buffer_load_dwordx4 v7, s[12:15], s46 offen offset:0 lds
    v_mfma_f32_16x16x32_bf16 v[44:47], a[24:27], v[188:191], v[44:47]
    ds_read_b64_tr_b16 a[38:39], v4 offset:38016
    v_add_u32 v41, s48, v41
    v_mfma_f32_16x16x32_bf16 v[48:51], a[28:31], v[188:191], v[48:51]
    ds_read_b128 v[224:227], v125 offset:128
    v_mul_u32_u24 v24, s2, v39
    v_mfma_f32_16x16x32_bf16 v[52:55], a[32:35], v[188:191], v[52:55]
    ds_read_b64_tr_b16 a[40:41], v4 offset:37280
    v_lshlrev_b32 v38, 4, v38
    v_mfma_f32_16x16x32_bf16 v[56:59], a[0:3], v[192:195], v[56:59]
    ds_read_b64_tr_b16 a[42:43], v4 offset:38048
    v_mfma_f32_16x16x32_bf16 v[60:63], a[4:7], v[192:195], v[60:63]
    ds_read_b128 v[228:231], v126 offset:0
    v_mfma_f32_16x16x32_bf16 v[64:67], a[8:11], v[192:195], v[64:67]
    s_waitcnt lgkmcnt(6)
    v_xor_b32 v136, v136, v166
    v_xor_b32 v137, v137, v166
    v_mfma_f32_16x16x32_bf16 v[64:67], a[20:23], v[196:199], v[64:67]
    buffer_load_dwordx4 v7, s[12:15], s46 offen offset:1024 lds
    v_mfma_f32_16x16x32_bf16 v[60:63], a[16:19], v[196:199], v[60:63]
    ds_read_b128 v[232:235], v126 offset:64
    v_mul_u32_u24 v23, 208, v41
    v_mfma_f32_16x16x32_bf16 v[56:59], a[12:15], v[196:199], v[56:59]
    v_xor_b32 v138, v138, v166
    v_xor_b32 v139, v139, v166
    v_mfma_f32_16x16x32_bf16 v[56:59], a[24:27], v[200:203], v[56:59]
    ds_read_b64_tr_b16 a[44:45], v5 offset:37312
    v_mul_u32_u24 v25, s2, v41
    v_mfma_f32_16x16x32_bf16 v[60:63], a[28:31], v[200:203], v[60:63]
    ds_read_b128 v[236:239], v126 offset:128
    v_lshlrev_b32 v40, 3, v40
    v_mfma_f32_16x16x32_bf16 v[64:67], a[32:35], v[200:203], v[64:67]
    ds_read_b64_tr_b16 a[46:47], v5 offset:38080
    ds_read_b64_tr_b16 a[48:49], v4 offset:43456
    v_mfma_f32_16x16x32_bf16 v[68:71], a[0:3], v[204:207], v[68:71]
    v_lshlrev_b32_sdwa v128, 4, v136 dst_sel:DWORD dst_unused:UNUSED_PAD src0_sel:DWORD src1_sel:WORD_0
    v_lshlrev_b32_sdwa v129, 4, v138 dst_sel:DWORD dst_unused:UNUSED_PAD src0_sel:DWORD src1_sel:WORD_0
    v_mfma_f32_16x16x32_bf16 v[72:75], a[4:7], v[204:207], v[72:75]
    ds_read_b128 v[240:243], v127 offset:0
    v_add3_u32 v22, v22, s47, v38
    v_mfma_f32_16x16x32_bf16 v[76:79], a[8:11], v[204:207], v[76:79]
    buffer_load_dwordx4 v7, s[12:15], s46 offen offset:2048 lds
    v_mfma_f32_16x16x32_bf16 v[76:79], a[20:23], v[208:211], v[76:79]
    v_lshlrev_b32_sdwa v130, 4, v136 dst_sel:DWORD dst_unused:UNUSED_PAD src0_sel:DWORD src1_sel:WORD_1
    v_lshlrev_b32_sdwa v131, 4, v138 dst_sel:DWORD dst_unused:UNUSED_PAD src0_sel:DWORD src1_sel:WORD_1
    v_mfma_f32_16x16x32_bf16 v[72:75], a[16:19], v[208:211], v[72:75]
    ds_read_b128 v[244:247], v127 offset:64
    v_add_u32 v24, v24, v38
    v_mfma_f32_16x16x32_bf16 v[68:71], a[12:15], v[208:211], v[68:71]
    ds_read_b64_tr_b16 a[50:51], v4 offset:44224
    v_add3_u32 v23, v23, s47, v40
    v_mfma_f32_16x16x32_bf16 v[68:71], a[24:27], v[212:215], v[68:71]
    v_lshlrev_b32_sdwa v132, 4, v137 dst_sel:DWORD dst_unused:UNUSED_PAD src0_sel:DWORD src1_sel:WORD_0
    v_lshlrev_b32_sdwa v133, 4, v139 dst_sel:DWORD dst_unused:UNUSED_PAD src0_sel:DWORD src1_sel:WORD_0
    v_mfma_f32_16x16x32_bf16 v[72:75], a[28:31], v[212:215], v[72:75]
    ds_read_b128 v[248:251], v127 offset:128
    v_add_u32 v25, v25, v40
    v_mfma_f32_16x16x32_bf16 v[76:79], a[32:35], v[212:215], v[76:79]
    ds_read_b64_tr_b16 a[52:53], v4 offset:43488
    v_bfe_u32 v38, v6, 4, 2
    v_mfma_f32_16x16x32_bf16 v[80:83], a[0:3], v[216:219], v[80:83]
    ds_read_b64_tr_b16 a[54:55], v4 offset:44256
    v_mfma_f32_16x16x32_bf16 v[84:87], a[4:7], v[216:219], v[84:87]
    ds_read_b128 v[180:183], v128 offset:0
    s_add_u32 m0, s45, 18624
    v_mfma_f32_16x16x32_bf16 v[88:91], a[8:11], v[216:219], v[88:91]
    buffer_load_dwordx4 v26, s[12:15], s46 offen offset:0 lds
    s_waitcnt lgkmcnt(7)
    v_mfma_f32_16x16x32_bf16 v[88:91], a[20:23], v[220:223], v[88:91]
    ds_read_b64_tr_b16 a[56:57], v5 offset:43520
    v_bfe_u32 v39, v6, 6, 2
    v_mfma_f32_16x16x32_bf16 v[84:87], a[16:19], v[220:223], v[84:87]
    ds_read_b128 v[184:187], v128 offset:64
    v_mfma_f32_16x16x32_bf16 v[80:83], a[12:15], v[220:223], v[80:83]
    ds_read_b64_tr_b16 a[58:59], v5 offset:44288
    v_mfma_f32_16x16x32_bf16 v[80:83], a[24:27], v[224:227], v[80:83]
    v_lshl_add_u32 v38, v38, 2, v39
    v_lshrrev_b32 v39, 8, v6
    v_mfma_f32_16x16x32_bf16 v[84:87], a[28:31], v[224:227], v[84:87]
    ds_read_b128 v[188:191], v128 offset:128
    v_mul_u32_u24 v38, 208, v38
    v_mfma_f32_16x16x32_bf16 v[88:91], a[32:35], v[224:227], v[88:91]
    ds_read_b64_tr_b16 a[60:61], v4 offset:49664
    v_mfma_f32_16x16x32_bf16 v[92:95], a[0:3], v[228:231], v[92:95]
    buffer_load_dwordx4 v26, s[12:15], s46 offen offset:1024 lds
    s_add_u32 s46, s46, 18432
    v_mfma_f32_16x16x32_bf16 v[96:99], a[4:7], v[228:231], v[96:99]
    ds_read_b128 v[192:195], v129 offset:0
    s_lshl4_add_u32 s49, s48, s47
    v_mfma_f32_16x16x32_bf16 v[100:103], a[8:11], v[228:231], v[100:103]
    ds_read_b64_tr_b16 a[62:63], v4 offset:50432
    v_mfma_f32_16x16x32_bf16 v[100:103], a[20:23], v[232:235], v[100:103]
    ds_read_b64_tr_b16 a[64:65], v4 offset:49696
    v_mfma_f32_16x16x32_bf16 v[96:99], a[16:19], v[232:235], v[96:99]
    ds_read_b128 v[196:199], v129 offset:64
    v_mfma_f32_16x16x32_bf16 v[92:95], a[12:15], v[232:235], v[92:95]
    v_lshl_add_u32 v38, v39, 3, v38
    s_lshl2_add_u32 s48, s48, s47
    v_mfma_f32_16x16x32_bf16 v[92:95], a[24:27], v[236:239], v[92:95]
    ds_read_b64_tr_b16 a[66:67], v4 offset:50464
    v_mfma_f32_16x16x32_bf16 v[96:99], a[28:31], v[236:239], v[96:99]
    ds_read_b128 v[200:203], v129 offset:128
    v_mfma_f32_16x16x32_bf16 v[100:103], a[32:35], v[236:239], v[100:103]
    ds_read_b64_tr_b16 a[68:69], v5 offset:49728
    s_waitcnt lgkmcnt(7)
    v_mfma_f32_16x16x32_bf16 v[104:107], a[0:3], v[240:243], v[104:107]
    v_add_u32 v20, s49, v38
    v_add_u32 v21, s48, v38
    s_branch L_Pa_s1
L_Pa_t1:
    s_setpc_b64 s[78:79]
L_Pa_s1:
    v_mfma_f32_16x16x32_bf16 v[108:111], a[4:7], v[240:243], v[108:111]
    ds_read_b128 v[204:207], v130 offset:0
    v_mfma_f32_16x16x32_bf16 v[112:115], a[8:11], v[240:243], v[112:115]
    ds_read_b64_tr_b16 a[70:71], v5 offset:50496
    v_mfma_f32_16x16x32_bf16 v[112:115], a[20:23], v[244:247], v[112:115]
    v_mfma_f32_16x16x32_bf16 v[108:111], a[16:19], v[244:247], v[108:111]
    ds_read_b128 v[208:211], v130 offset:64
    v_mfma_f32_16x16x32_bf16 v[104:107], a[12:15], v[244:247], v[104:107]
    v_mfma_f32_16x16x32_bf16 v[104:107], a[24:27], v[248:251], v[104:107]
    v_mfma_f32_16x16x32_bf16 v[108:111], a[28:31], v[248:251], v[108:111]
    ds_read_b128 v[212:215], v130 offset:128
    v_mfma_f32_16x16x32_bf16 v[112:115], a[32:35], v[248:251], v[112:115]
    s_waitcnt vmcnt(5)
    s_waitcnt lgkmcnt(2)
    s_barrier
    v_mfma_f32_16x16x32_bf16 v[44:47], a[36:39], v[180:183], v[44:47]
    ds_read_b64_tr_b16 a[72:73], v4 offset:0
    v_mfma_f32_16x16x32_bf16 v[48:51], a[40:43], v[180:183], v[48:51]
    ds_read_b128 v[216:219], v131 offset:0
    s_add_u32 m0, s44, 37248
    v_mfma_f32_16x16x32_bf16 v[52:55], a[44:47], v[180:183], v[52:55]
    buffer_load_dwordx4 v7, s[12:15], s46 offen offset:0 lds
    v_mfma_f32_16x16x32_bf16 v[52:55], a[56:59], v[184:187], v[52:55]
    ds_read_b128 v[136:139], v172 offset:1536
    ds_read_b64_tr_b16 a[74:75], v4 offset:768
    v_mfma_f32_16x16x32_bf16 v[48:51], a[52:55], v[184:187], v[48:51]
    ds_read_b128 v[220:223], v131 offset:64
    ds_read_b64_tr_b16 a[76:77], v4 offset:32
    v_mfma_f32_16x16x32_bf16 v[44:47], a[48:51], v[184:187], v[44:47]
    ds_read_b64_tr_b16 a[78:79], v4 offset:800
    v_mfma_f32_16x16x32_bf16 v[44:47], a[60:63], v[188:191], v[44:47]
    ds_read_b64_tr_b16 a[80:81], v5 offset:64
    ds_read_b64_tr_b16 a[82:83], v5 offset:832
    v_mfma_f32_16x16x32_bf16 v[48:51], a[64:67], v[188:191], v[48:51]
    ds_read_b128 v[224:227], v131 offset:128
    v_mfma_f32_16x16x32_bf16 v[52:55], a[68:71], v[188:191], v[52:55]
    buffer_load_dwordx4 v7, s[12:15], s46 offen offset:1024 lds
    v_mfma_f32_16x16x32_bf16 v[56:59], a[36:39], v[192:195], v[56:59]
    ds_read_b64_tr_b16 a[84:85], v4 offset:6208
    ds_read_b64_tr_b16 a[86:87], v4 offset:6976
    v_mfma_f32_16x16x32_bf16 v[60:63], a[40:43], v[192:195], v[60:63]
    ds_read_b128 v[228:231], v132 offset:0
    ds_read_b64_tr_b16 a[88:89], v4 offset:6240
    v_mfma_f32_16x16x32_bf16 v[64:67], a[44:47], v[192:195], v[64:67]
    s_waitcnt lgkmcnt(7)
    v_xor_b32 v136, v136, v166
    v_xor_b32 v137, v137, v166
    v_mfma_f32_16x16x32_bf16 v[64:67], a[56:59], v[196:199], v[64:67]
    buffer_load_dwordx4 v7, s[12:15], s46 offen offset:2048 lds
    v_mfma_f32_16x16x32_bf16 v[60:63], a[52:55], v[196:199], v[60:63]
    ds_read_b128 v[232:235], v132 offset:64
    ds_read_b64_tr_b16 a[90:91], v4 offset:7008
    v_mfma_f32_16x16x32_bf16 v[56:59], a[48:51], v[196:199], v[56:59]
    v_xor_b32 v138, v138, v166
    v_xor_b32 v139, v139, v166
    ds_read_b64_tr_b16 a[92:93], v5 offset:6272
    v_mfma_f32_16x16x32_bf16 v[56:59], a[60:63], v[200:203], v[56:59]
    ds_read_b64_tr_b16 a[94:95], v5 offset:7040
    ds_read_b64_tr_b16 a[96:97], v4 offset:12416
    v_mfma_f32_16x16x32_bf16 v[60:63], a[64:67], v[200:203], v[60:63]
    ds_read_b128 v[236:239], v132 offset:128
    s_add_u32 m0, s45, 37248
    v_mfma_f32_16x16x32_bf16 v[64:67], a[68:71], v[200:203], v[64:67]
    buffer_load_dwordx4 v26, s[12:15], s46 offen offset:0 lds
    ds_read_b64_tr_b16 a[98:99], v4 offset:13184
    v_mfma_f32_16x16x32_bf16 v[68:71], a[36:39], v[204:207], v[68:71]
    v_lshlrev_b32_sdwa v116, 4, v136 dst_sel:DWORD dst_unused:UNUSED_PAD src0_sel:DWORD src1_sel:WORD_0
    v_lshlrev_b32_sdwa v117, 4, v138 dst_sel:DWORD dst_unused:UNUSED_PAD src0_sel:DWORD src1_sel:WORD_0
    v_mfma_f32_16x16x32_bf16 v[72:75], a[40:43], v[204:207], v[72:75]
    ds_read_b128 v[240:243], v133 offset:0
    ds_read_b64_tr_b16 a[100:101], v4 offset:12448
    v_mfma_f32_16x16x32_bf16 v[76:79], a[44:47], v[204:207], v[76:79]
    ds_read_b64_tr_b16 a[102:103], v4 offset:13216
    ds_read_b64_tr_b16 a[104:105], v5 offset:12480
    v_mfma_f32_16x16x32_bf16 v[76:79], a[56:59], v[208:211], v[76:79]
    v_lshlrev_b32_sdwa v118, 4, v136 dst_sel:DWORD dst_unused:UNUSED_PAD src0_sel:DWORD src1_sel:WORD_1
    v_lshlrev_b32_sdwa v119, 4, v138 dst_sel:DWORD dst_unused:UNUSED_PAD src0_sel:DWORD src1_sel:WORD_1
    ds_read_b64_tr_b16 a[106:107], v5 offset:13248
    v_mfma_f32_16x16x32_bf16 v[72:75], a[52:55], v[208:211], v[72:75]
    ds_read_b128 v[244:247], v133 offset:64
    v_mfma_f32_16x16x32_bf16 v[68:71], a[48:51], v[208:211], v[68:71]
    buffer_load_dwordx4 v26, s[12:15], s46 offen offset:1024 lds
    s_add_u32 s46, s46, 18432
    v_mfma_f32_16x16x32_bf16 v[68:71], a[60:63], v[212:215], v[68:71]
    v_lshlrev_b32_sdwa v120, 4, v137 dst_sel:DWORD dst_unused:UNUSED_PAD src0_sel:DWORD src1_sel:WORD_0
    v_lshlrev_b32_sdwa v121, 4, v139 dst_sel:DWORD dst_unused:UNUSED_PAD src0_sel:DWORD src1_sel:WORD_0
    v_mfma_f32_16x16x32_bf16 v[72:75], a[64:67], v[212:215], v[72:75]
    ds_read_b128 v[248:251], v133 offset:128
    v_mfma_f32_16x16x32_bf16 v[76:79], a[68:71], v[212:215], v[76:79]
    s_waitcnt vmcnt(5)
    s_waitcnt lgkmcnt(2)
    s_barrier
    v_mfma_f32_16x16x32_bf16 v[80:83], a[36:39], v[216:219], v[80:83]
    ds_read_b128 v[136:139], v172 offset:1792
    v_mfma_f32_16x16x32_bf16 v[84:87], a[40:43], v[216:219], v[84:87]
    ds_read_b128 v[180:183], v116 offset:0
    v_mfma_f32_16x16x32_bf16 v[88:91], a[44:47], v[216:219], v[88:91]
    ds_read_b64_tr_b16 a[108:109], v4 offset:18624
    v_mfma_f32_16x16x32_bf16 v[88:91], a[56:59], v[220:223], v[88:91]
    ds_read_b64_tr_b16 a[110:111], v4 offset:19392
    v_mfma_f32_16x16x32_bf16 v[84:87], a[52:55], v[220:223], v[84:87]
    ds_read_b128 v[184:187], v116 offset:64
    s_lshl_b32 s55, s55, 1
    v_mfma_f32_16x16x32_bf16 v[80:83], a[48:51], v[220:223], v[80:83]
    ds_read_b64_tr_b16 a[112:113], v4 offset:18656
    v_mfma_f32_16x16x32_bf16 v[80:83], a[60:63], v[224:227], v[80:83]
    ds_read_b64_tr_b16 a[114:115], v4 offset:19424
    v_mfma_f32_16x16x32_bf16 v[84:87], a[64:67], v[224:227], v[84:87]
    ds_read_b128 v[188:191], v116 offset:128
    s_mul_i32 s47, s30, 8064
    v_mfma_f32_16x16x32_bf16 v[88:91], a[68:71], v[224:227], v[88:91]
    s_waitcnt lgkmcnt(7)
    v_xor_b32 v136, v136, v166
    v_xor_b32 v137, v137, v166
    v_mfma_f32_16x16x32_bf16 v[92:95], a[36:39], v[228:231], v[92:95]
    ds_read_b64_tr_b16 a[116:117], v5 offset:18688
    ds_read_b64_tr_b16 a[118:119], v5 offset:19456
    v_mfma_f32_16x16x32_bf16 v[96:99], a[40:43], v[228:231], v[96:99]
    ds_read_b128 v[192:195], v117 offset:0
    ds_read_b64_tr_b16 a[120:121], v4 offset:24832
    v_mfma_f32_16x16x32_bf16 v[100:103], a[44:47], v[228:231], v[100:103]
    v_xor_b32 v138, v138, v166
    v_xor_b32 v139, v139, v166
    v_mfma_f32_16x16x32_bf16 v[100:103], a[56:59], v[232:235], v[100:103]
    v_lshlrev_b32_sdwa v122, 4, v136 dst_sel:DWORD dst_unused:UNUSED_PAD src0_sel:DWORD src1_sel:WORD_0
    v_lshlrev_b32_sdwa v123, 4, v138 dst_sel:DWORD dst_unused:UNUSED_PAD src0_sel:DWORD src1_sel:WORD_0
    v_mfma_f32_16x16x32_bf16 v[96:99], a[52:55], v[232:235], v[96:99]
    ds_read_b128 v[196:199], v117 offset:64
    s_lshl_b32 s48, s29, 3
    v_mfma_f32_16x16x32_bf16 v[92:95], a[48:51], v[232:235], v[92:95]
    v_lshlrev_b32_sdwa v124, 4, v136 dst_sel:DWORD dst_unused:UNUSED_PAD src0_sel:DWORD src1_sel:WORD_1
    v_lshlrev_b32_sdwa v125, 4, v138 dst_sel:DWORD dst_unused:UNUSED_PAD src0_sel:DWORD src1_sel:WORD_1
    v_mfma_f32_16x16x32_bf16 v[92:95], a[60:63], v[236:239], v[92:95]
    ds_read_b64_tr_b16 a[122:123], v4 offset:25600
    v_bfe_u32 v38, v6, 4, 2
    v_mfma_f32_16x16x32_bf16 v[96:99], a[64:67], v[236:239], v[96:99]
    ds_read_b128 v[200:203], v117 offset:128
    v_lshlrev_b32_sdwa v126, 4, v137 dst_sel:DWORD dst_unused:UNUSED_PAD src0_sel:DWORD src1_sel:WORD_0
    v_lshlrev_b32_sdwa v127, 4, v139 dst_sel:DWORD dst_unused:UNUSED_PAD src0_sel:DWORD src1_sel:WORD_0
    v_mfma_f32_16x16x32_bf16 v[100:103], a[68:71], v[236:239], v[100:103]
    ds_read_b64_tr_b16 a[124:125], v4 offset:24864
    v_bfe_u32 v39, v6, 6, 2
    v_mfma_f32_16x16x32_bf16 v[104:107], a[36:39], v[240:243], v[104:107]
    ds_read_b64_tr_b16 a[126:127], v4 offset:25632
    v_lshl_add_u32 v38, v38, 2, v39
    v_mfma_f32_16x16x32_bf16 v[108:111], a[40:43], v[240:243], v[108:111]
    ds_read_b128 v[204:207], v122 offset:0
    v_mfma_f32_16x16x32_bf16 v[112:115], a[44:47], v[240:243], v[112:115]
    ds_read_b64_tr_b16 a[128:129], v5 offset:24896
    ds_read_b128 v[136:139], v172 offset:2048
    v_mfma_f32_16x16x32_bf16 v[112:115], a[56:59], v[244:247], v[112:115]
    ds_read_b64_tr_b16 a[130:131], v5 offset:25664
    s_add_u32 s47, s47, 107616
    v_mfma_f32_16x16x32_bf16 v[108:111], a[52:55], v[244:247], v[108:111]
    ds_read_b128 v[208:211], v122 offset:64
    v_mfma_f32_16x16x32_bf16 v[104:107], a[48:51], v[244:247], v[104:107]
    ds_read_b64_tr_b16 a[132:133], v4 offset:31040
    v_lshrrev_b32 v39, 8, v6
    v_mfma_f32_16x16x32_bf16 v[104:107], a[60:63], v[248:251], v[104:107]
    ds_read_b64_tr_b16 a[134:135], v4 offset:31808
    v_mfma_f32_16x16x32_bf16 v[108:111], a[64:67], v[248:251], v[108:111]
    ds_read_b128 v[212:215], v122 offset:128
    v_mfma_f32_16x16x32_bf16 v[112:115], a[68:71], v[248:251], v[112:115]
    ds_read_b64_tr_b16 a[136:137], v4 offset:31072
    v_mul_u32_u24 v17, 72, v38
    s_waitcnt lgkmcnt(7)
    v_mfma_f32_16x16x32_bf16 v[44:47], a[72:75], v[180:183], v[44:47]
    ds_read_b64_tr_b16 a[138:139], v4 offset:31840
    v_mfma_f32_16x16x32_bf16 v[48:51], a[76:79], v[180:183], v[48:51]
    ds_read_b128 v[216:219], v123 offset:0
    v_mfma_f32_16x16x32_bf16 v[52:55], a[80:83], v[180:183], v[52:55]
    ds_read_b64_tr_b16 a[140:141], v5 offset:31104
    v_mul_u32_u24 v16, s2, v38
    v_mfma_f32_16x16x32_bf16 v[52:55], a[92:95], v[184:187], v[52:55]
    ds_read_b64_tr_b16 a[142:143], v5 offset:31872
    v_mfma_f32_16x16x32_bf16 v[48:51], a[88:91], v[184:187], v[48:51]
    ds_read_b128 v[220:223], v123 offset:64
    v_mfma_f32_16x16x32_bf16 v[44:47], a[84:87], v[184:187], v[44:47]
    s_waitcnt lgkmcnt(7)
    v_xor_b32 v136, v136, v166
    v_xor_b32 v137, v137, v166
    v_mfma_f32_16x16x32_bf16 v[44:47], a[96:99], v[188:191], v[44:47]
    v_xor_b32 v138, v138, v166
    v_xor_b32 v139, v139, v166
    v_mfma_f32_16x16x32_bf16 v[48:51], a[100:103], v[188:191], v[48:51]
    ds_read_b128 v[224:227], v123 offset:128
    v_mfma_f32_16x16x32_bf16 v[52:55], a[104:107], v[188:191], v[52:55]
    s_waitcnt vmcnt(0)
    s_waitcnt lgkmcnt(2)
    s_barrier
    s_lshl2_add_u32 s49, s48, s47
    v_lshl_add_u32 v17, v39, 3, v17
    v_mfma_f32_16x16x32_bf16 v[56:59], a[72:75], v[192:195], v[56:59]
    v_lshlrev_b32_sdwa v128, 4, v136 dst_sel:DWORD dst_unused:UNUSED_PAD src0_sel:DWORD src1_sel:WORD_0
    v_lshlrev_b32_sdwa v129, 4, v138 dst_sel:DWORD dst_unused:UNUSED_PAD src0_sel:DWORD src1_sel:WORD_0
    v_mfma_f32_16x16x32_bf16 v[60:63], a[76:79], v[192:195], v[60:63]
    ds_read_b128 v[228:231], v118 offset:0
    v_and_b32 v38, 1, v39
    v_mfma_f32_16x16x32_bf16 v[64:67], a[80:83], v[192:195], v[64:67]
    v_lshlrev_b32_sdwa v130, 4, v136 dst_sel:DWORD dst_unused:UNUSED_PAD src0_sel:DWORD src1_sel:WORD_1
    v_lshlrev_b32_sdwa v131, 4, v138 dst_sel:DWORD dst_unused:UNUSED_PAD src0_sel:DWORD src1_sel:WORD_1
    v_mfma_f32_16x16x32_bf16 v[64:67], a[92:95], v[196:199], v[64:67]
    ds_read_b64_tr_b16 a[0:1], v4 offset:37248
    v_mfma_f32_16x16x32_bf16 v[60:63], a[88:91], v[196:199], v[60:63]
    ds_read_b128 v[232:235], v118 offset:64
    v_lshrrev_b32 v39, 1, v39
    v_mfma_f32_16x16x32_bf16 v[56:59], a[84:87], v[196:199], v[56:59]
    ds_read_b64_tr_b16 a[2:3], v4 offset:38016
    ds_read_b64_tr_b16 a[4:5], v4 offset:37280
    v_mfma_f32_16x16x32_bf16 v[56:59], a[96:99], v[200:203], v[56:59]
    v_lshlrev_b32_sdwa v132, 4, v137 dst_sel:DWORD dst_unused:UNUSED_PAD src0_sel:DWORD src1_sel:WORD_0
    v_lshlrev_b32_sdwa v133, 4, v139 dst_sel:DWORD dst_unused:UNUSED_PAD src0_sel:DWORD src1_sel:WORD_0
    v_mfma_f32_16x16x32_bf16 v[60:63], a[100:103], v[200:203], v[60:63]
    ds_read_b128 v[236:239], v118 offset:128
    v_add_u32 v17, s49, v17
    v_mfma_f32_16x16x32_bf16 v[64:67], a[104:107], v[200:203], v[64:67]
    ds_read_b64_tr_b16 a[6:7], v4 offset:38048
    v_mfma_f32_16x16x32_bf16 v[44:47], a[108:111], v[204:207], v[44:47]
    ds_read_b64_tr_b16 a[8:9], v5 offset:37312
    v_lshl_add_u32 v38, v38, 1, v39
    v_mfma_f32_16x16x32_bf16 v[48:51], a[112:115], v[204:207], v[48:51]
    ds_read_b128 v[240:243], v128 offset:0
    v_mfma_f32_16x16x32_bf16 v[52:55], a[116:119], v[204:207], v[52:55]
    ds_read_b64_tr_b16 a[10:11], v5 offset:38080
    v_mfma_f32_16x16x32_bf16 v[52:55], a[128:131], v[208:211], v[52:55]
    ds_read_b64_tr_b16 a[12:13], v4 offset:43456
    v_lshrrev_b32 v39, 7, v6
    v_mfma_f32_16x16x32_bf16 v[48:51], a[124:127], v[208:211], v[48:51]
    ds_read_b128 v[244:247], v128 offset:64
    v_mfma_f32_16x16x32_bf16 v[44:47], a[120:123], v[208:211], v[44:47]
    ds_read_b64_tr_b16 a[14:15], v4 offset:44224
    v_mfma_f32_16x16x32_bf16 v[44:47], a[132:135], v[212:215], v[44:47]
    ds_read_b64_tr_b16 a[16:17], v4 offset:43488
    v_add_u32 v38, s48, v38
    v_mfma_f32_16x16x32_bf16 v[48:51], a[136:139], v[212:215], v[48:51]
    ds_read_b128 v[248:251], v128 offset:128
    v_mfma_f32_16x16x32_bf16 v[52:55], a[140:143], v[212:215], v[52:55]
    ds_read_b64_tr_b16 a[18:19], v4 offset:44256
    v_mfma_f32_16x16x32_bf16 v[56:59], a[108:111], v[216:219], v[56:59]
    ds_read_b64_tr_b16 a[20:21], v5 offset:43520
    v_add_u32 v39, s48, v39
    v_mfma_f32_16x16x32_bf16 v[60:63], a[112:115], v[216:219], v[60:63]
    ds_read_b128 v[180:183], v129 offset:0
    v_mfma_f32_16x16x32_bf16 v[64:67], a[116:119], v[216:219], v[64:67]
    ds_read_b64_tr_b16 a[22:23], v5 offset:44288
    s_waitcnt lgkmcnt(7)
    v_mfma_f32_16x16x32_bf16 v[64:67], a[128:131], v[220:223], v[64:67]
    ds_read_b64_tr_b16 a[24:25], v4 offset:49664
    v_lshl_add_u32 v16, v38, 4, v16
    v_mfma_f32_16x16x32_bf16 v[60:63], a[124:127], v[220:223], v[60:63]
    ds_read_b128 v[184:187], v129 offset:64
    v_mfma_f32_16x16x32_bf16 v[56:59], a[120:123], v[220:223], v[56:59]
    ds_read_b64_tr_b16 a[26:27], v4 offset:50432
    v_bfe_u32 v38, v6, 1, 6
    v_mfma_f32_16x16x32_bf16 v[56:59], a[132:135], v[224:227], v[56:59]
    ds_read_b64_tr_b16 a[28:29], v4 offset:49696
    v_mfma_f32_16x16x32_bf16 v[60:63], a[136:139], v[224:227], v[60:63]
    ds_read_b128 v[188:191], v129 offset:128
    v_mfma_f32_16x16x32_bf16 v[64:67], a[140:143], v[224:227], v[64:67]
    ds_read_b64_tr_b16 a[30:31], v4 offset:50464
    v_mfma_f32_16x16x32_bf16 v[68:71], a[72:75], v[228:231], v[68:71]
    ds_read_b64_tr_b16 a[32:33], v5 offset:49728
    v_mfma_f32_16x16x32_bf16 v[72:75], a[76:79], v[228:231], v[72:75]
    ds_read_b128 v[192:195], v124 offset:0
    v_mfma_f32_16x16x32_bf16 v[76:79], a[80:83], v[228:231], v[76:79]
    ds_read_b64_tr_b16 a[34:35], v5 offset:50496
    v_mfma_f32_16x16x32_bf16 v[76:79], a[92:95], v[232:235], v[76:79]
    v_mul_u32_u24 v18, 72, v39
    v_mul_u32_u24 v19, s2, v39
    v_mfma_f32_16x16x32_bf16 v[72:75], a[88:91], v[232:235], v[72:75]
    ds_read_b128 v[196:199], v124 offset:64
    v_mfma_f32_16x16x32_bf16 v[68:71], a[84:87], v[232:235], v[68:71]
    v_add3_u32 v18, v18, s47, v38
    v_mfma_f32_16x16x32_bf16 v[68:71], a[96:99], v[236:239], v[68:71]
    v_mfma_f32_16x16x32_bf16 v[72:75], a[100:103], v[236:239], v[72:75]
    ds_read_b128 v[200:203], v124 offset:128
    v_mfma_f32_16x16x32_bf16 v[76:79], a[104:107], v[236:239], v[76:79]
    v_add3_u32 v19, v19, 64, v38
    v_mfma_f32_16x16x32_bf16 v[44:47], a[0:3], v[240:243], v[44:47]
    v_mfma_f32_16x16x32_bf16 v[48:51], a[4:7], v[240:243], v[48:51]
    ds_read_b128 v[204:207], v130 offset:0
    v_mfma_f32_16x16x32_bf16 v[52:55], a[8:11], v[240:243], v[52:55]
    s_mov_b32 s46, s31
    s_waitcnt lgkmcnt(7)
    v_mfma_f32_16x16x32_bf16 v[52:55], a[20:23], v[244:247], v[52:55]
    v_mfma_f32_16x16x32_bf16 v[48:51], a[16:19], v[244:247], v[48:51]
    ds_read_b128 v[208:211], v130 offset:64
    v_mfma_f32_16x16x32_bf16 v[44:47], a[12:15], v[244:247], v[44:47]
    v_mfma_f32_16x16x32_bf16 v[44:47], a[24:27], v[248:251], v[44:47]
    s_waitcnt lgkmcnt(7)
    v_mfma_f32_16x16x32_bf16 v[48:51], a[28:31], v[248:251], v[48:51]
    ds_read_b128 v[212:215], v130 offset:128
    s_waitcnt lgkmcnt(5)
    v_mfma_f32_16x16x32_bf16 v[52:55], a[32:35], v[248:251], v[52:55]
    v_mfma_f32_16x16x32_bf16 v[56:59], a[0:3], v[180:183], v[56:59]
    v_mfma_f32_16x16x32_bf16 v[60:63], a[4:7], v[180:183], v[60:63]
    ds_read_b128 v[216:219], v119 offset:0
    v_mfma_f32_16x16x32_bf16 v[64:67], a[8:11], v[180:183], v[64:67]
    v_mfma_f32_16x16x32_bf16 v[64:67], a[20:23], v[184:187], v[64:67]
    v_mfma_f32_16x16x32_bf16 v[60:63], a[16:19], v[184:187], v[60:63]
    ds_read_b128 v[220:223], v119 offset:64
    v_mfma_f32_16x16x32_bf16 v[56:59], a[12:15], v[184:187], v[56:59]
    v_cvt_pk_bf16_f32 v32, v44, v45
    v_cvt_pk_bf16_f32 v33, v46, v47
    v_mfma_f32_16x16x32_bf16 v[56:59], a[24:27], v[188:191], v[56:59]
    v_cvt_pk_bf16_f32 v34, v48, v49
    v_cvt_pk_bf16_f32 v35, v50, v51
    v_mfma_f32_16x16x32_bf16 v[60:63], a[28:31], v[188:191], v[60:63]
    ds_read_b128 v[224:227], v119 offset:128
    v_mfma_f32_16x16x32_bf16 v[64:67], a[32:35], v[188:191], v[64:67]
    v_cvt_pk_bf16_f32 v36, v52, v53
    v_cvt_pk_bf16_f32 v37, v54, v55
    v_mfma_f32_16x16x32_bf16 v[68:71], a[108:111], v[192:195], v[68:71]
    v_permlane16_swap_b32 v32, v34
    v_permlane16_swap_b32 v33, v35
    v_mfma_f32_16x16x32_bf16 v[72:75], a[112:115], v[192:195], v[72:75]
    ds_read_b128 v[228:231], v125 offset:0
    v_mfma_f32_16x16x32_bf16 v[76:79], a[116:119], v[192:195], v[76:79]
    ds_write_b64 v17, v[36:37] offset:0
    s_waitcnt lgkmcnt(7)
    v_mfma_f32_16x16x32_bf16 v[76:79], a[128:131], v[196:199], v[76:79]
    buffer_store_dwordx4 v[32:35], v16, s[16:19], s31 offen sc1
    s_add_u32 s31, s31, s55
    v_mfma_f32_16x16x32_bf16 v[72:75], a[124:127], v[196:199], v[72:75]
    ds_read_b128 v[232:235], v125 offset:64
    v_mfma_f32_16x16x32_bf16 v[68:71], a[120:123], v[196:199], v[68:71]
    v_mfma_f32_16x16x32_bf16 v[68:71], a[132:135], v[200:203], v[68:71]
    v_mfma_f32_16x16x32_bf16 v[72:75], a[136:139], v[200:203], v[72:75]
    ds_read_b128 v[236:239], v125 offset:128
    v_mfma_f32_16x16x32_bf16 v[76:79], a[140:143], v[200:203], v[76:79]
    v_mfma_f32_16x16x32_bf16 v[68:71], a[0:3], v[204:207], v[68:71]
    v_mfma_f32_16x16x32_bf16 v[72:75], a[4:7], v[204:207], v[72:75]
    ds_read_b128 v[240:243], v131 offset:0
    v_mfma_f32_16x16x32_bf16 v[76:79], a[8:11], v[204:207], v[76:79]
    s_waitcnt lgkmcnt(7)
    v_mfma_f32_16x16x32_bf16 v[76:79], a[20:23], v[208:211], v[76:79]
    v_mfma_f32_16x16x32_bf16 v[72:75], a[16:19], v[208:211], v[72:75]
    ds_read_b128 v[244:247], v131 offset:64
    v_mfma_f32_16x16x32_bf16 v[68:71], a[12:15], v[208:211], v[68:71]
    v_cvt_pk_bf16_f32 v32, v56, v57
    v_cvt_pk_bf16_f32 v33, v58, v59
    v_mfma_f32_16x16x32_bf16 v[68:71], a[24:27], v[212:215], v[68:71]
    v_cvt_pk_bf16_f32 v34, v60, v61
    v_cvt_pk_bf16_f32 v35, v62, v63
    v_mfma_f32_16x16x32_bf16 v[72:75], a[28:31], v[212:215], v[72:75]
    ds_read_b128 v[248:251], v131 offset:128
    v_mfma_f32_16x16x32_bf16 v[76:79], a[32:35], v[212:215], v[76:79]
    v_cvt_pk_bf16_f32 v36, v64, v65
    v_cvt_pk_bf16_f32 v37, v66, v67
    v_mfma_f32_16x16x32_bf16 v[80:83], a[72:75], v[216:219], v[80:83]
    v_permlane16_swap_b32 v32, v34
    v_permlane16_swap_b32 v33, v35
    v_mfma_f32_16x16x32_bf16 v[84:87], a[76:79], v[216:219], v[84:87]
    ds_read_b128 v[180:183], v120 offset:0
    v_mfma_f32_16x16x32_bf16 v[88:91], a[80:83], v[216:219], v[88:91]
    ds_write_b64 v17, v[36:37] offset:1152
    s_waitcnt lgkmcnt(7)
    v_mfma_f32_16x16x32_bf16 v[88:91], a[92:95], v[220:223], v[88:91]
    buffer_store_dwordx4 v[32:35], v16, s[16:19], s31 offen sc1
    s_add_u32 s31, s31, s55
    v_mfma_f32_16x16x32_bf16 v[84:87], a[88:91], v[220:223], v[84:87]
    ds_read_b128 v[184:187], v120 offset:64
    v_mfma_f32_16x16x32_bf16 v[80:83], a[84:87], v[220:223], v[80:83]
    v_mfma_f32_16x16x32_bf16 v[80:83], a[96:99], v[224:227], v[80:83]
    v_mfma_f32_16x16x32_bf16 v[84:87], a[100:103], v[224:227], v[84:87]
    ds_read_b128 v[188:191], v120 offset:128
    v_mfma_f32_16x16x32_bf16 v[88:91], a[104:107], v[224:227], v[88:91]
    v_mfma_f32_16x16x32_bf16 v[80:83], a[108:111], v[228:231], v[80:83]
    v_mfma_f32_16x16x32_bf16 v[84:87], a[112:115], v[228:231], v[84:87]
    ds_read_b128 v[192:195], v126 offset:0
    v_mfma_f32_16x16x32_bf16 v[88:91], a[116:119], v[228:231], v[88:91]
    s_waitcnt lgkmcnt(7)
    v_mfma_f32_16x16x32_bf16 v[88:91], a[128:131], v[232:235], v[88:91]
    v_mfma_f32_16x16x32_bf16 v[84:87], a[124:127], v[232:235], v[84:87]
    ds_read_b128 v[196:199], v126 offset:64
    v_mfma_f32_16x16x32_bf16 v[80:83], a[120:123], v[232:235], v[80:83]
    v_cvt_pk_bf16_f32 v32, v68, v69
    v_cvt_pk_bf16_f32 v33, v70, v71
    v_mfma_f32_16x16x32_bf16 v[80:83], a[132:135], v[236:239], v[80:83]
    v_cvt_pk_bf16_f32 v34, v72, v73
    v_cvt_pk_bf16_f32 v35, v74, v75
    v_mfma_f32_16x16x32_bf16 v[84:87], a[136:139], v[236:239], v[84:87]
    ds_read_b128 v[200:203], v126 offset:128
    v_mfma_f32_16x16x32_bf16 v[88:91], a[140:143], v[236:239], v[88:91]
    v_cvt_pk_bf16_f32 v36, v76, v77
    v_cvt_pk_bf16_f32 v37, v78, v79
    v_mfma_f32_16x16x32_bf16 v[80:83], a[0:3], v[240:243], v[80:83]
    v_permlane16_swap_b32 v32, v34
    v_permlane16_swap_b32 v33, v35
    v_mfma_f32_16x16x32_bf16 v[84:87], a[4:7], v[240:243], v[84:87]
    ds_read_b128 v[204:207], v132 offset:0
    v_mfma_f32_16x16x32_bf16 v[88:91], a[8:11], v[240:243], v[88:91]
    ds_write_b64 v17, v[36:37] offset:2304
    s_waitcnt lgkmcnt(7)
    v_mfma_f32_16x16x32_bf16 v[88:91], a[20:23], v[244:247], v[88:91]
    buffer_store_dwordx4 v[32:35], v16, s[16:19], s31 offen sc1
    s_add_u32 s31, s31, s55
    v_mfma_f32_16x16x32_bf16 v[84:87], a[16:19], v[244:247], v[84:87]
    ds_read_b128 v[208:211], v132 offset:64
    v_mfma_f32_16x16x32_bf16 v[80:83], a[12:15], v[244:247], v[80:83]
    v_mfma_f32_16x16x32_bf16 v[80:83], a[24:27], v[248:251], v[80:83]
    v_mfma_f32_16x16x32_bf16 v[84:87], a[28:31], v[248:251], v[84:87]
    ds_read_b128 v[212:215], v132 offset:128
    s_waitcnt lgkmcnt(2)
    s_barrier
    v_mfma_f32_16x16x32_bf16 v[88:91], a[32:35], v[248:251], v[88:91]
    ds_read_b64 v[38:39], v18 offset:0
    v_mfma_f32_16x16x32_bf16 v[92:95], a[72:75], v[180:183], v[92:95]
    ds_read_b64 v[40:41], v18 offset:1152
    v_mfma_f32_16x16x32_bf16 v[96:99], a[76:79], v[180:183], v[96:99]
    ds_read_b128 v[216:219], v121 offset:0
    v_mfma_f32_16x16x32_bf16 v[100:103], a[80:83], v[180:183], v[100:103]
    ds_read_b64 v[42:43], v18 offset:2304
    v_mfma_f32_16x16x32_bf16 v[100:103], a[92:95], v[184:187], v[100:103]
    v_mfma_f32_16x16x32_bf16 v[96:99], a[88:91], v[184:187], v[96:99]
    ds_read_b128 v[220:223], v121 offset:64
    v_mfma_f32_16x16x32_bf16 v[92:95], a[84:87], v[184:187], v[92:95]
    v_cvt_pk_bf16_f32 v32, v80, v81
    v_cvt_pk_bf16_f32 v33, v82, v83
    v_mfma_f32_16x16x32_bf16 v[92:95], a[96:99], v[188:191], v[92:95]
    v_cvt_pk_bf16_f32 v34, v84, v85
    v_cvt_pk_bf16_f32 v35, v86, v87
    v_mfma_f32_16x16x32_bf16 v[96:99], a[100:103], v[188:191], v[96:99]
    ds_read_b128 v[224:227], v121 offset:128
    v_mfma_f32_16x16x32_bf16 v[100:103], a[104:107], v[188:191], v[100:103]
    s_waitcnt lgkmcnt(5)
    buffer_store_dwordx2 v[38:39], v19, s[16:19], s46 offen sc1
    s_add_u32 s46, s46, s55
    v_mfma_f32_16x16x32_bf16 v[92:95], a[108:111], v[192:195], v[92:95]
    v_cvt_pk_bf16_f32 v36, v88, v89
    v_cvt_pk_bf16_f32 v37, v90, v91
    v_mfma_f32_16x16x32_bf16 v[96:99], a[112:115], v[192:195], v[96:99]
    ds_read_b128 v[228:231], v127 offset:0
    v_mfma_f32_16x16x32_bf16 v[100:103], a[116:119], v[192:195], v[100:103]
    v_permlane16_swap_b32 v32, v34
    v_permlane16_swap_b32 v33, v35
    v_mfma_f32_16x16x32_bf16 v[100:103], a[128:131], v[196:199], v[100:103]
    s_waitcnt lgkmcnt(5)
    buffer_store_dwordx2 v[40:41], v19, s[16:19], s46 offen sc1
    s_add_u32 s46, s46, s55
    v_mfma_f32_16x16x32_bf16 v[96:99], a[124:127], v[196:199], v[96:99]
    ds_read_b128 v[232:235], v127 offset:64
    v_mfma_f32_16x16x32_bf16 v[92:95], a[120:123], v[196:199], v[92:95]
    ds_write_b64 v17, v[36:37] offset:3456
    v_mfma_f32_16x16x32_bf16 v[92:95], a[132:135], v[200:203], v[92:95]
    buffer_store_dwordx4 v[32:35], v16, s[16:19], s31 offen sc1
    s_add_u32 s31, s31, s55
    v_mfma_f32_16x16x32_bf16 v[96:99], a[136:139], v[200:203], v[96:99]
    ds_read_b128 v[236:239], v127 offset:128
    v_mfma_f32_16x16x32_bf16 v[100:103], a[140:143], v[200:203], v[100:103]
    s_waitcnt lgkmcnt(6)
    buffer_store_dwordx2 v[42:43], v19, s[16:19], s46 offen sc1
    s_add_u32 s46, s46, s55
    v_mfma_f32_16x16x32_bf16 v[92:95], a[0:3], v[204:207], v[92:95]
    v_mfma_f32_16x16x32_bf16 v[96:99], a[4:7], v[204:207], v[96:99]
    ds_read_b128 v[240:243], v133 offset:0
    v_mfma_f32_16x16x32_bf16 v[100:103], a[8:11], v[204:207], v[100:103]
    v_mfma_f32_16x16x32_bf16 v[100:103], a[20:23], v[208:211], v[100:103]
    v_mfma_f32_16x16x32_bf16 v[96:99], a[16:19], v[208:211], v[96:99]
    ds_read_b128 v[244:247], v133 offset:64
    v_mfma_f32_16x16x32_bf16 v[92:95], a[12:15], v[208:211], v[92:95]
    v_mfma_f32_16x16x32_bf16 v[92:95], a[24:27], v[212:215], v[92:95]
    v_mfma_f32_16x16x32_bf16 v[96:99], a[28:31], v[212:215], v[96:99]
    ds_read_b128 v[248:251], v133 offset:128
    v_mfma_f32_16x16x32_bf16 v[100:103], a[32:35], v[212:215], v[100:103]
    s_cmp_eq_u32 s36, 5
    s_cbranch_scc1 L_Pe6
    v_mfma_f32_16x16x32_bf16 v[104:107], a[72:75], v[216:219], v[104:107]
    v_mfma_f32_16x16x32_bf16 v[108:111], a[76:79], v[216:219], v[108:111]
    v_mfma_f32_16x16x32_bf16 v[112:115], a[80:83], v[216:219], v[112:115]
    s_waitcnt lgkmcnt(7)
    v_mfma_f32_16x16x32_bf16 v[112:115], a[92:95], v[220:223], v[112:115]
    v_mfma_f32_16x16x32_bf16 v[108:111], a[88:91], v[220:223], v[108:111]
    v_cvt_pk_bf16_f32 v32, v92, v93
    v_cvt_pk_bf16_f32 v33, v94, v95
    v_mfma_f32_16x16x32_bf16 v[104:107], a[84:87], v[220:223], v[104:107]
    v_cvt_pk_bf16_f32 v34, v96, v97
    v_cvt_pk_bf16_f32 v35, v98, v99
    v_mfma_f32_16x16x32_bf16 v[104:107], a[96:99], v[224:227], v[104:107]
    v_cvt_pk_bf16_f32 v36, v100, v101
    v_cvt_pk_bf16_f32 v37, v102, v103
    v_mfma_f32_16x16x32_bf16 v[108:111], a[100:103], v[224:227], v[108:111]
    v_permlane16_swap_b32 v32, v34
    v_permlane16_swap_b32 v33, v35
    v_mfma_f32_16x16x32_bf16 v[112:115], a[104:107], v[224:227], v[112:115]
    ds_write_b64 v17, v[36:37] offset:4608
    s_waitcnt lgkmcnt(7)
    v_mfma_f32_16x16x32_bf16 v[104:107], a[108:111], v[228:231], v[104:107]
    buffer_store_dwordx4 v[32:35], v16, s[16:19], s31 offen sc1
    s_add_u32 s31, s31, s55
    v_mfma_f32_16x16x32_bf16 v[108:111], a[112:115], v[228:231], v[108:111]
    v_mfma_f32_16x16x32_bf16 v[112:115], a[116:119], v[228:231], v[112:115]
    s_waitcnt lgkmcnt(6)
    v_mfma_f32_16x16x32_bf16 v[112:115], a[128:131], v[232:235], v[112:115]
    v_mfma_f32_16x16x32_bf16 v[108:111], a[124:127], v[232:235], v[108:111]
    s_waitcnt lgkmcnt(0)
    s_barrier
    v_mfma_f32_16x16x32_bf16 v[104:107], a[120:123], v[232:235], v[104:107]
    ds_read_b64 v[38:39], v18 offset:3456
    v_mfma_f32_16x16x32_bf16 v[104:107], a[132:135], v[236:239], v[104:107]
    ds_read_b64 v[40:41], v18 offset:4608
    v_mfma_f32_16x16x32_bf16 v[108:111], a[136:139], v[236:239], v[108:111]
    v_mfma_f32_16x16x32_bf16 v[112:115], a[140:143], v[236:239], v[112:115]
    v_mfma_f32_16x16x32_bf16 v[104:107], a[0:3], v[240:243], v[104:107]
    v_mfma_f32_16x16x32_bf16 v[108:111], a[4:7], v[240:243], v[108:111]
    s_waitcnt lgkmcnt(1)
    buffer_store_dwordx2 v[38:39], v19, s[16:19], s46 offen sc1
    s_add_u32 s46, s46, s55
    v_mfma_f32_16x16x32_bf16 v[112:115], a[8:11], v[240:243], v[112:115]
    v_mfma_f32_16x16x32_bf16 v[112:115], a[20:23], v[244:247], v[112:115]
    v_mfma_f32_16x16x32_bf16 v[108:111], a[16:19], v[244:247], v[108:111]
    s_waitcnt lgkmcnt(0)
    buffer_store_dwordx2 v[40:41], v19, s[16:19], s46 offen sc1
    s_add_u32 s46, s46, s55
    v_mfma_f32_16x16x32_bf16 v[104:107], a[12:15], v[244:247], v[104:107]
    v_mfma_f32_16x16x32_bf16 v[104:107], a[24:27], v[248:251], v[104:107]
    v_mfma_f32_16x16x32_bf16 v[108:111], a[28:31], v[248:251], v[108:111]
    v_mfma_f32_16x16x32_bf16 v[112:115], a[32:35], v[248:251], v[112:115]
    s_cmp_lg_u32 s54, 0
    s_nop 4
    v_cvt_pk_bf16_f32 v32, v104, v105
    v_cvt_pk_bf16_f32 v33, v106, v107
    v_cvt_pk_bf16_f32 v34, v108, v109
    v_cvt_pk_bf16_f32 v35, v110, v111
    ds_write_b64 v20, v[32:33] offset:0
    v_cvt_pk_bf16_f32 v36, v112, v113
    v_cvt_pk_bf16_f32 v37, v114, v115
    ds_write_b64 v20, v[34:35] offset:32
    ds_write_b64 v21, v[36:37] offset:64
    s_waitcnt lgkmcnt(0)
    s_barrier
    ds_read_b128 v[26:29], v22 offset:0
    ds_read_b64 v[30:31], v23 offset:0
    s_waitcnt lgkmcnt(1)
    buffer_store_dwordx4 v[26:29], v24, s[16:19], s31 offen sc1
    s_waitcnt lgkmcnt(0)
    buffer_store_dwordx2 v[30:31], v25, s[16:19], s31 offen sc1
    s_cbranch_scc1 L_gS
    s_endpgm
L_Pe6:
    s_cmp_lg_u32 s54, 0
    s_nop 1
    v_cvt_pk_bf16_f32 v32, v92, v93
    v_cvt_pk_bf16_f32 v33, v94, v95
    v_cvt_pk_bf16_f32 v34, v96, v97
    v_cvt_pk_bf16_f32 v35, v98, v99
    ds_write_b64 v20, v[32:33] offset:0
    v_cvt_pk_bf16_f32 v36, v100, v101
    v_cvt_pk_bf16_f32 v37, v102, v103
    ds_write_b64 v20, v[34:35] offset:32
    ds_write_b64 v21, v[36:37] offset:64
    s_waitcnt lgkmcnt(0)
    s_barrier
    ds_read_b64 v[38:39], v18 offset:3456
    ds_read_b128 v[26:29], v22 offset:0
    ds_read_b64 v[30:31], v23 offset:0
    s_waitcnt lgkmcnt(2)
    buffer_store_dwordx2 v[38:39], v19, s[16:19], s46 offen sc1
    s_waitcnt lgkmcnt(1)
    buffer_store_dwordx4 v[26:29], v24, s[16:19], s31 offen sc1
    s_waitcnt lgkmcnt(0)
    buffer_store_dwordx2 v[30:31], v25, s[16:19], s31 offen sc1
    s_cbranch_scc1 L_gS
    s_endpgm
L_Pz:
    s_cmp_le_u32 s72, 11
    s_cbranch_scc1 L_l10
    s_add_u32 m0, s33, 42944
    s_min_i32 s47, s20, s21
    s_add_u32 s20, s20, s55
    buffer_load_dwordx4 v8, s[4:7], s47 offen lds
L_l10:
    s_cmp_le_u32 s72, 12
    s_cbranch_scc1 L_l11
    s_add_u32 m0, s33, 46848
    s_min_i32 s47, s20, s21
    s_add_u32 s20, s20, s55
    buffer_load_dwordx4 v8, s[4:7], s47 offen lds
L_l11:
    s_cmp_le_u32 s72, 13
    s_cbranch_scc1 L_l12
    s_add_u32 m0, s33, 50752
    s_min_i32 s47, s20, s21
    s_add_u32 s20, s20, s55
    buffer_load_dwordx4 v8, s[4:7], s47 offen lds
L_l12:
    s_cmp_le_u32 s72, 14
    s_cbranch_scc1 L_l13
    s_add_u32 m0, s33, 54656
    s_min_i32 s47, s20, s21
    s_add_u32 s20, s20, s55
    buffer_load_dwordx4 v8, s[4:7], s47 offen lds
L_l13:
    s_cmp_le_u32 s72, 15
    s_cbranch_scc1 L_l14
    s_add_u32 m0, s33, 58560
    s_min_i32 s47, s20, s21
    s_add_u32 s20, s20, s55
    buffer_load_dwordx4 v8, s[4:7], s47 offen lds
L_l14:
    s_add_u32 m0, s44, 0
    s_nop 0
    buffer_load_dwordx4 v7, s[12:15], s46 offen offset:0 lds
    buffer_load_dwordx4 v7, s[12:15], s46 offen offset:1024 lds
    s_cmp_eq_u32 s37, 0
    s_cbranch_scc1 L_Pn
L_Pfail:
    v_mov_b32 v12, 0xff
    ds_write_b32 v14, v12
L_Pn:
    buffer_load_dwordx4 v7, s[12:15], s46 offen offset:2048 lds
    s_add_u32 m0, s45, 0
    s_nop 0
    buffer_load_dwordx4 v26, s[12:15], s46 offen offset:0 lds
    buffer_load_dwordx4 v26, s[12:15], s46 offen offset:1024 lds
    s_add_u32 s46, s46, 18432
    s_waitcnt vmcnt(5) lgkmcnt(0)
    s_barrier
    s_cmp_ge_u32 s36, 4
    s_cbranch_scc1 L_l15
    s_add_u32 m0, s44, 18624
    s_nop 0
    buffer_load_dwordx4 v7, s[12:15], s46 offen offset:0 lds
    buffer_load_dwordx4 v7, s[12:15], s46 offen offset:1024 lds
    buffer_load_dwordx4 v7, s[12:15], s46 offen offset:2048 lds
    s_add_u32 m0, s45, 18624
    s_nop 0
    buffer_load_dwordx4 v26, s[12:15], s46 offen offset:0 lds
    buffer_load_dwordx4 v26, s[12:15], s46 offen offset:1024 lds
    s_add_u32 s46, s46, 18432
L_l15:
L_Pn2:
    ds_read_b128 v[136:139], v172 offset:0
    ds_read_b128 v[144:147], v14
    s_waitcnt lgkmcnt(0)
    v_xor_b32 v136, v136, v166
    v_xor_b32 v137, v137, v166
    v_xor_b32 v138, v138, v166
    v_xor_b32 v139, v139, v166
    v_lshlrev_b32_sdwa v116, 4, v136 dst_sel:DWORD dst_unused:UNUSED_PAD src0_sel:DWORD src1_sel:WORD_0
    v_lshlrev_b32_sdwa v117, 4, v138 dst_sel:DWORD dst_unused:UNUSED_PAD src0_sel:DWORD src1_sel:WORD_0
    v_lshlrev_b32_sdwa v118, 4, v136 dst_sel:DWORD dst_unused:UNUSED_PAD src0_sel:DWORD src1_sel:WORD_1
    v_lshlrev_b32_sdwa v119, 4, v138 dst_sel:DWORD dst_unused:UNUSED_PAD src0_sel:DWORD src1_sel:WORD_1
    v_lshlrev_b32_sdwa v120, 4, v137 dst_sel:DWORD dst_unused:UNUSED_PAD src0_sel:DWORD src1_sel:WORD_0
    v_lshlrev_b32_sdwa v121, 4, v139 dst_sel:DWORD dst_unused:UNUSED_PAD src0_sel:DWORD src1_sel:WORD_0
    v_or3_b32 v144, v144, v145, v146
    v_or_b32 v144, v144, v147
    s_nop 0
    v_readfirstlane_b32 s54, v144
    s_branch L_Pa
L_Pr2:
    v_min_u32 v85, s32, v82
    v_cmp_ge_u32 s[64:65], s32, v82
    v_lshl_add_u32 v83, v85, 3, s38
    ds_read_b64 v[80:81], v83 offset:2048
    v_add_u32 v82, 64, v82
    s_add_u32 s39, s39, 64
    s_waitcnt lgkmcnt(0)
    v_readfirstlane_b32 s53, v78
    v_cvt_f32_ubyte2 v86, v81
    v_cvt_f32_ubyte3 v87, v81
    v_add_u32_sdwa v84, s49, v81 dst_sel:DWORD dst_unused:UNUSED_PAD src0_sel:DWORD src1_sel:WORD_0
    v_add_f32 v86, s68, v86
    v_add_f32 v87, s69, v87
    v_mov_b32 v81, s50
    v_lshlrev_b32 v61, 16, v80
    v_and_b32 v62, 0xffff0000, v80
    v_add_f32 v61, v61, v86
    v_add_f32 v62, v62, v87
    v_cvt_pk_bf16_f32 v60, v61, v62
    v_pk_max_i16 v60, v60, 0
    v_pk_min_i16 v60, v60, s52
    v_alignbit_b32 v60, v60, v60, s42
    v_lshlrev_b32 v61, 16, v60
    v_and_b32 v62, 0xffff0000, v60
    v_fract_f32 v63, v61
    v_fract_f32 v64, v62
    v_cvt_u32_f32 v65, v61
    v_cvt_u32_f32 v66, v62
    v_cmp_neq_f32 s[58:59], 0, v64
    v_cmp_neq_f32 s[60:61], 0, v63
    v_sub_f32 v67, 1.0, v63
    v_sub_f32 v68, 1.0, v64
    v_subrev_u32 v65, s71, v65
    v_subrev_u32 v66, s43, v66
    v_cvt_pk_bf16_f32 v61, v67, v68
    v_addc_co_u32 v74, vcc, 0, v66, s[58:59]
    v_addc_co_u32 v73, vcc, 0, v65, s[60:61]
    v_lshlrev_b32 v67, 16, v61
    v_and_b32 v68, 0xffff0000, v61
    v_mul_u32_u24 v75, 976, v65
    v_mul_f32 v69, v67, v68
    v_mul_f32 v70, v67, v64
    v_mul_f32 v71, v63, v68
    v_mul_f32 v72, v63, v64
    v_max_u32 v73, v73, v65
    v_max_u32 v61, v66, v74
    v_mad_u32_u24 v67, v66, 48, v75
    v_mad_u32_u24 v68, v74, 48, v75
    v_and_b32 v66, 12, v66
    v_and_b32 v74, 12, v74
    s_andn2_b64 s[62:63], s[60:61], s[58:59]
    v_add_lshl_u32 v67, v67, v66, 2
    v_add_lshl_u32 v68, v68, v74, 2
    v_cndmask_b32 v70, v71, v70, s[58:59]
    v_cndmask_b32 v62, 0, v174, s[62:63]
    s_and_b64 s[62:63], s[60:61], s[58:59]
    v_cndmask_b32 v71, 0, v71, s[58:59]
    s_and_b64 s[66:67], s[62:63], s[64:65]
    v_cmp_le_u32 s[60:61], s72, v73
    v_mbcnt_lo_u32_b32 v81, s66, v81
    v_cmp_lt_u32 s[58:59], 19, v61
    s_bcnt1_i32_b64 s48, s[66:67]
    v_lshl_or_b32 v58, v68, 16, v67
    v_mbcnt_hi_u32_b32 v81, s67, v81
    v_cvt_pk_bf16_f32 v57, v69, v70
    s_add_u32 s50, s50, s48
    v_cvt_pk_bf16_f32 v59, v71, v72
    v_sub_u32 v85, v85, v81
    v_and_b32 v62, 0xffff0000, v62
    v_sub_u32 v81, s32, v81
    v_cndmask_b32 v61, 0, v174, s[62:63]
    v_cndmask_b32 v85, v85, v81, s[66:67]
    v_add_u32 v56, v58, v62
    v_lshl_add_u32 v83, v85, 4, s38
    v_add_u32 v58, v58, v61
    v_add_u32 v85, s53, v85
    v_bfe_u32 v81, v85, 1, 2
    v_mad_u32_u24 v85, v85, 12, s35
    v_add_u32 v85, v85, v81
    s_mov_b64 exec, s[64:65]
    ds_write_b128 v83, v[56:59]
    ds_write_b16 v84, v85
    s_mov_b64 exec, -1
    s_or_b64 s[58:59], s[58:59], s[60:61]
    s_cbranch_scc1 L_Pfail
    s_cmp_lt_u32 s39, s37
    s_cbranch_scc1 L_Pr2
L_Pgl:
    s_mov_b32 s39, 0
    v_add_u32 v12, s39, v25
    v_min_u32 v12, s32, v12
    v_lshl_add_u32 v12, v12, 4, s38
    ds_read_b128 v[28:31], v12
    buffer_load_dwordx4 v7, s[12:15], s46 offen offset:2048 lds
    s_add_u32 m0, s45, 0
    s_nop 0
    buffer_load_dwordx4 v26, s[12:15], s46 offen offset:0 lds
    buffer_load_dwordx4 v26, s[12:15], s46 offen offset:1024 lds
    s_add_u32 s46, s46, 18432
    s_cmp_eq_u32 s50, 0
    s_cselect_b32 s47, 15, 0
    s_sub_u32 s50, s37, s50
    s_add_u32 s50, s50, s47
    s_waitcnt lgkmcnt(0)
    v_xor_b32_sdwa v0, v28, v164 dst_sel:DWORD dst_unused:UNUSED_PAD src0_sel:WORD_0 src1_sel:DWORD
    v_xor_b32_sdwa v2, v28, v164 dst_sel:DWORD dst_unused:UNUSED_PAD src0_sel:WORD_1 src1_sel:DWORD
    v_xor_b32_sdwa v1, v28, v173 dst_sel:DWORD dst_unused:UNUSED_PAD src0_sel:WORD_0 src1_sel:DWORD
    v_xor_b32_sdwa v3, v28, v173 dst_sel:DWORD dst_unused:UNUSED_PAD src0_sel:WORD_1 src1_sel:DWORD
    v_perm_b32 v32, v29, v29, v168
    v_perm_b32 v33, v29, v29, v169
    v_perm_b32 v34, v29, v29, v170
    v_perm_b32 v35, v29, v29, v171
    s_waitcnt vmcnt(5)
    s_barrier
    ds_read_b64_tr_b16 v[180:181], v0 offset:0
    ds_read_b64_tr_b16 v[182:183], v2 offset:0
    ds_read_b64_tr_b16 v[184:185], v1 offset:0
    ds_read_b64_tr_b16 v[186:187], v3 offset:0
    ds_read_b64_tr_b16 v[188:189], v0 offset:64
    ds_read_b64_tr_b16 v[190:191], v2 offset:64
    ds_read_b64_tr_b16 v[192:193], v1 offset:64
    ds_read_b64_tr_b16 v[194:195], v3 offset:64
    ds_read_b64_tr_b16 v[196:197], v0 offset:128
    ds_read_b64_tr_b16 v[198:199], v2 offset:128
    ds_read_b64_tr_b16 v[200:201], v1 offset:128
    ds_read_b64_tr_b16 v[202:203], v3 offset:128
    s_cmp_ge_u32 s36, 4
    s_cbranch_scc1 L_l16
    s_add_u32 m0, s44, 18624
    s_nop 0
    buffer_load_dwordx4 v7, s[12:15], s46 offen offset:0 lds
    buffer_load_dwordx4 v7, s[12:15], s46 offen offset:1024 lds
    buffer_load_dwordx4 v7, s[12:15], s46 offen offset:2048 lds
    s_add_u32 m0, s45, 18624
    s_nop 0
    buffer_load_dwordx4 v26, s[12:15], s46 offen offset:0 lds
    buffer_load_dwordx4 v26, s[12:15], s46 offen offset:1024 lds
    s_add_u32 s46, s46, 18432
L_l16:
    s_and_b32 s50, s50, -16
    s_cbranch_scc0 L_Pg4
L_Pl2:
    v_add_u32 v9, s39, v165
    v_min_u32 v9, s32, v9
    v_add_u32 v9, s53, v9
    s_add_u32 s39, s39, 16
    v_bfe_u32 v10, v9, 1, 2
    v_add_u32 v12, s39, v25
    v_mad_u32_u24 v9, v9, 12, v10
    v_min_u32 v12, s32, v12
    v_xor_b32_sdwa v9, v166, v9 dst_sel:DWORD dst_unused:UNUSED_PAD src0_sel:WORD_0 src1_sel:DWORD
    v_lshl_add_u32 v12, v12, 4, s38
    v_lshl_add_u32 v9, v9, 4, s24
    ds_read_b128 v[28:31], v12
    s_waitcnt lgkmcnt(11)
    v_mfma_f32_16x16x32_bf16 v[56:59], v[180:183], v[32:35], 0
    s_waitcnt lgkmcnt(9)
    v_mfma_f32_16x16x32_bf16 v[60:63], v[184:187], v[32:35], 0
    s_waitcnt lgkmcnt(7)
    v_mfma_f32_16x16x32_bf16 v[64:67], v[188:191], v[32:35], 0
    s_waitcnt lgkmcnt(5)
    v_mfma_f32_16x16x32_bf16 v[68:71], v[192:195], v[32:35], 0
    s_waitcnt lgkmcnt(3)
    v_mfma_f32_16x16x32_bf16 v[72:75], v[196:199], v[32:35], 0
    s_waitcnt lgkmcnt(0)
    v_xor_b32_sdwa v0, v28, v164 dst_sel:DWORD dst_unused:UNUSED_PAD src0_sel:WORD_0 src1_sel:DWORD
    v_xor_b32_sdwa v2, v28, v164 dst_sel:DWORD dst_unused:UNUSED_PAD src0_sel:WORD_1 src1_sel:DWORD
    v_xor_b32_sdwa v1, v28, v173 dst_sel:DWORD dst_unused:UNUSED_PAD src0_sel:WORD_0 src1_sel:DWORD
    v_xor_b32_sdwa v3, v28, v173 dst_sel:DWORD dst_unused:UNUSED_PAD src0_sel:WORD_1 src1_sel:DWORD
    v_mfma_f32_16x16x32_bf16 v[76:79], v[200:203], v[32:35], 0
    ds_read_b64_tr_b16 v[180:181], v0 offset:0
    ds_read_b64_tr_b16 v[182:183], v2 offset:0
    ds_read_b64_tr_b16 v[184:185], v1 offset:0
    ds_read_b64_tr_b16 v[186:187], v3 offset:0
    ds_read_b64_tr_b16 v[188:189], v0 offset:64
    ds_read_b64_tr_b16 v[190:191], v2 offset:64
    v_perm_b32 v32, v29, v29, v168
    v_perm_b32 v33, v29, v29, v169
    v_perm_b32 v34, v29, v29, v170
    v_perm_b32 v35, v29, v29, v171
    ds_read_b64_tr_b16 v[192:193], v1 offset:64
    v_cvt_pk_bf16_f32 v80, v56, v57
    ds_read_b64_tr_b16 v[194:195], v3 offset:64
    v_cvt_pk_bf16_f32 v81, v58, v59
    ds_read_b64_tr_b16 v[196:197], v0 offset:128
    v_cvt_pk_bf16_f32 v82, v60, v61
    ds_read_b64_tr_b16 v[198:199], v2 offset:128
    v_cvt_pk_bf16_f32 v83, v62, v63
    ds_read_b64_tr_b16 v[200:201], v1 offset:128
    v_cvt_pk_bf16_f32 v84, v64, v65
    ds_read_b64_tr_b16 v[202:203], v3 offset:128
    v_cvt_pk_bf16_f32 v85, v66, v67
    v_cvt_pk_bf16_f32 v86, v68, v69
    v_cvt_pk_bf16_f32 v87, v70, v71
    v_permlane32_swap_b32 v80, v82
    v_permlane32_swap_b32 v81, v83
    ds_write_b128 v9, v[80:83] offset:0
    v_cvt_pk_bf16_f32 v88, v72, v73
    v_cvt_pk_bf16_f32 v89, v74, v75
    v_cvt_pk_bf16_f32 v90, v76, v77
    v_cvt_pk_bf16_f32 v91, v78, v79
    v_permlane32_swap_b32 v84, v86
    v_permlane32_swap_b32 v85, v87
    ds_write_b128 v9, v[84:87] offset:64
    v_permlane32_swap_b32 v88, v90
    v_permlane32_swap_b32 v89, v91
    ds_write_b128 v9, v[88:91] offset:128
    s_cmp_lt_u32 s39, s50
    s_cbranch_scc1 L_Pl2
    s_cmp_ge_u32 s39, s37
    s_cbranch_scc1 L_Pn2
L_Pg4:
    v_xor_b32_sdwa v40, v30, v164 dst_sel:DWORD dst_unused:UNUSED_PAD src0_sel:WORD_0 src1_sel:DWORD
    v_xor_b32_sdwa v42, v30, v164 dst_sel:DWORD dst_unused:UNUSED_PAD src0_sel:WORD_1 src1_sel:DWORD
    v_xor_b32_sdwa v41, v30, v173 dst_sel:DWORD dst_unused:UNUSED_PAD src0_sel:WORD_0 src1_sel:DWORD
    v_xor_b32_sdwa v43, v30, v173 dst_sel:DWORD dst_unused:UNUSED_PAD src0_sel:WORD_1 src1_sel:DWORD
    v_perm_b32 v36, v31, v31, v168
    v_perm_b32 v37, v31, v31, v169
    v_perm_b32 v38, v31, v31, v170
    v_perm_b32 v39, v31, v31, v171
    ds_read_b64_tr_b16 v[204:205], v40 offset:0
    ds_read_b64_tr_b16 v[206:207], v42 offset:0
    ds_read_b64_tr_b16 v[208:209], v41 offset:0
    ds_read_b64_tr_b16 v[210:211], v43 offset:0
    ds_read_b64_tr_b16 v[212:213], v40 offset:64
    ds_read_b64_tr_b16 v[214:215], v42 offset:64
    ds_read_b64_tr_b16 v[216:217], v41 offset:64
    ds_read_b64_tr_b16 v[218:219], v43 offset:64
    ds_read_b64_tr_b16 v[220:221], v40 offset:128
    ds_read_b64_tr_b16 v[222:223], v42 offset:128
    ds_read_b64_tr_b16 v[224:225], v41 offset:128
    ds_read_b64_tr_b16 v[226:227], v43 offset:128
L_Pl4:
    v_add_u32 v9, s39, v165
    v_min_u32 v9, s32, v9
    v_add_u32 v9, s53, v9
    s_add_u32 s39, s39, 16
    v_bfe_u32 v10, v9, 1, 2
    v_add_u32 v12, s39, v25
    v_mad_u32_u24 v9, v9, 12, v10
    v_min_u32 v12, s32, v12
    v_xor_b32_sdwa v9, v166, v9 dst_sel:DWORD dst_unused:UNUSED_PAD src0_sel:WORD_0 src1_sel:DWORD
    v_lshl_add_u32 v12, v12, 4, s38
    v_lshl_add_u32 v9, v9, 4, s24
    ds_read_b128 v[28:31], v12
    s_waitcnt lgkmcnt(15)
    v_mfma_f32_16x16x32_bf16 v[56:59], v[180:183], v[32:35], 0
    v_mfma_f32_16x16x32_bf16 v[60:63], v[184:187], v[32:35], 0
    v_mfma_f32_16x16x32_bf16 v[64:67], v[188:191], v[32:35], 0
    v_mfma_f32_16x16x32_bf16 v[68:71], v[192:195], v[32:35], 0
    v_mfma_f32_16x16x32_bf16 v[72:75], v[196:199], v[32:35], 0
    s_waitcnt lgkmcnt(13)
    v_mfma_f32_16x16x32_bf16 v[76:79], v[200:203], v[32:35], 0
    s_waitcnt lgkmcnt(11)
    v_mfma_f32_16x16x32_bf16 v[56:59], v[204:207], v[36:39], v[56:59]
    s_waitcnt lgkmcnt(9)
    v_mfma_f32_16x16x32_bf16 v[60:63], v[208:211], v[36:39], v[60:63]
    s_waitcnt lgkmcnt(7)
    v_mfma_f32_16x16x32_bf16 v[64:67], v[212:215], v[36:39], v[64:67]
    s_waitcnt lgkmcnt(5)
    v_mfma_f32_16x16x32_bf16 v[68:71], v[216:219], v[36:39], v[68:71]
    s_waitcnt lgkmcnt(3)
    v_mfma_f32_16x16x32_bf16 v[72:75], v[220:223], v[36:39], v[72:75]
    s_waitcnt lgkmcnt(0)
    v_xor_b32_sdwa v0, v28, v164 dst_sel:DWORD dst_unused:UNUSED_PAD src0_sel:WORD_0 src1_sel:DWORD
    v_xor_b32_sdwa v2, v28, v164 dst_sel:DWORD dst_unused:UNUSED_PAD src0_sel:WORD_1 src1_sel:DWORD
    v_xor_b32_sdwa v1, v28, v173 dst_sel:DWORD dst_unused:UNUSED_PAD src0_sel:WORD_0 src1_sel:DWORD
    v_xor_b32_sdwa v3, v28, v173 dst_sel:DWORD dst_unused:UNUSED_PAD src0_sel:WORD_1 src1_sel:DWORD
    v_mfma_f32_16x16x32_bf16 v[76:79], v[224:227], v[36:39], v[76:79]
    v_xor_b32_sdwa v40, v30, v164 dst_sel:DWORD dst_unused:UNUSED_PAD src0_sel:WORD_0 src1_sel:DWORD
    v_xor_b32_sdwa v42, v30, v164 dst_sel:DWORD dst_unused:UNUSED_PAD src0_sel:WORD_1 src1_sel:DWORD
    v_xor_b32_sdwa v41, v30, v173 dst_sel:DWORD dst_unused:UNUSED_PAD src0_sel:WORD_0 src1_sel:DWORD
    v_xor_b32_sdwa v43, v30, v173 dst_sel:DWORD dst_unused:UNUSED_PAD src0_sel:WORD_1 src1_sel:DWORD
    ds_read_b64_tr_b16 v[180:181], v0 offset:0
    ds_read_b64_tr_b16 v[182:183], v2 offset:0
    ds_read_b64_tr_b16 v[184:185], v1 offset:0
    ds_read_b64_tr_b16 v[186:187], v3 offset:0
    ds_read_b64_tr_b16 v[188:189], v0 offset:64
    ds_read_b64_tr_b16 v[190:191], v2 offset:64
    v_perm_b32 v32, v29, v29, v168
    v_perm_b32 v33, v29, v29, v169
    v_perm_b32 v34, v29, v29, v170
    v_perm_b32 v35, v29, v29, v171
    ds_read_b64_tr_b16 v[192:193], v1 offset:64
    v_cvt_pk_bf16_f32 v80, v56, v57
    ds_read_b64_tr_b16 v[194:195], v3 offset:64
    v_cvt_pk_bf16_f32 v81, v58, v59
    ds_read_b64_tr_b16 v[196:197], v0 offset:128
    v_cvt_pk_bf16_f32 v82, v60, v61
    ds_read_b64_tr_b16 v[198:199], v2 offset:128
    v_cvt_pk_bf16_f32 v83, v62, v63
    ds_read_b64_tr_b16 v[200:201], v1 offset:128
    v_cvt_pk_bf16_f32 v84, v64, v65
    ds_read_b64_tr_b16 v[202:203], v3 offset:128
    v_cvt_pk_bf16_f32 v85, v66, v67
    ds_read_b64_tr_b16 v[204:205], v40 offset:0
    v_cvt_pk_bf16_f32 v86, v68, v69
    ds_read_b64_tr_b16 v[206:207], v42 offset:0
    v_cvt_pk_bf16_f32 v87, v70, v71
    ds_read_b64_tr_b16 v[208:209], v41 offset:0
    v_permlane32_swap_b32 v80, v82
    ds_read_b64_tr_b16 v[210:211], v43 offset:0
    v_permlane32_swap_b32 v81, v83
    ds_read_b64_tr_b16 v[212:213], v40 offset:64
    ds_write_b128 v9, v[80:83] offset:0
    ds_read_b64_tr_b16 v[214:215], v42 offset:64
    v_cvt_pk_bf16_f32 v88, v72, v73
    ds_read_b64_tr_b16 v[216:217], v41 offset:64
    v_cvt_pk_bf16_f32 v89, v74, v75
    ds_read_b64_tr_b16 v[218:219], v43 offset:64
    v_cvt_pk_bf16_f32 v90, v76, v77
    ds_read_b64_tr_b16 v[220:221], v40 offset:128
    v_cvt_pk_bf16_f32 v91, v78, v79
    ds_read_b64_tr_b16 v[222:223], v42 offset:128
    v_permlane32_swap_b32 v84, v86
    ds_read_b64_tr_b16 v[224:225], v41 offset:128
    v_permlane32_swap_b32 v85, v87
    ds_read_b64_tr_b16 v[226:227], v43 offset:128
    ds_write_b128 v9, v[84:87] offset:64
    v_perm_b32 v36, v31, v31, v168
    v_permlane32_swap_b32 v88, v90
    v_perm_b32 v37, v31, v31, v169
    v_permlane32_swap_b32 v89, v91
    v_perm_b32 v38, v31, v31, v170
    ds_write_b128 v9, v[88:91] offset:128
    v_perm_b32 v39, v31, v31, v171
    s_cmp_lt_u32 s39, s37
    s_cbranch_scc1 L_Pl4
    s_branch L_Pn2
L_Pd:
    s_cmp_eq_u32 s36, 3
    s_cbranch_scc1 L_Pj3
    ds_read_b128 v[180:183], v116 offset:0
    ds_read_b64_tr_b16 a[0:1], v4 offset:0
    ds_read_b64_tr_b16 a[2:3], v4 offset:768
    ds_read_b64_tr_b16 a[4:5], v4 offset:32
    ds_read_b64_tr_b16 a[6:7], v4 offset:800
    ds_read_b64_tr_b16 a[8:9], v5 offset:64
    ds_read_b64_tr_b16 a[10:11], v5 offset:832
    ds_read_b128 v[192:195], v117 offset:0
    ds_read_b64_tr_b16 a[12:13], v4 offset:6208
    ds_read_b64_tr_b16 a[14:15], v4 offset:6976
    ds_read_b128 v[136:139], v172 offset:256
    ds_read_b128 v[184:187], v116 offset:64
    ds_read_b64_tr_b16 a[16:17], v4 offset:6240
    s_add_u32 m0, s44, 37248
    s_nop 0
    buffer_load_dwordx4 v7, s[12:15], s46 offen offset:0 lds
    ds_read_b64_tr_b16 a[18:19], v4 offset:7008
    ds_read_b64_tr_b16 a[20:21], v5 offset:6272
    ds_read_b64_tr_b16 a[22:23], v5 offset:7040
    ds_read_b128 v[196:199], v117 offset:64
    buffer_load_dwordx4 v7, s[12:15], s46 offen offset:1024 lds
    ds_read_b128 v[188:191], v116 offset:128
    ds_read_b64_tr_b16 a[24:25], v4 offset:12416
    ds_read_b64_tr_b16 a[26:27], v4 offset:13184
    ds_read_b64_tr_b16 a[28:29], v4 offset:12448
    buffer_load_dwordx4 v7, s[12:15], s46 offen offset:2048 lds
    ds_read_b64_tr_b16 a[30:31], v4 offset:13216
    ds_read_b64_tr_b16 a[32:33], v5 offset:12480
    ds_read_b64_tr_b16 a[34:35], v5 offset:13248
    ds_read_b128 v[200:203], v117 offset:128
    s_add_u32 m0, s45, 37248
    s_nop 0
    buffer_load_dwordx4 v26, s[12:15], s46 offen offset:0 lds
    s_waitcnt lgkmcnt(7)
    v_xor_b32 v136, v136, v166
    v_xor_b32 v138, v138, v166
    v_lshlrev_b32_sdwa v122, 4, v136 dst_sel:DWORD dst_unused:UNUSED_PAD src0_sel:DWORD src1_sel:WORD_0
    v_lshlrev_b32_sdwa v123, 4, v138 dst_sel:DWORD dst_unused:UNUSED_PAD src0_sel:DWORD src1_sel:WORD_0
    buffer_load_dwordx4 v26, s[12:15], s46 offen offset:1024 lds
    s_add_u32 s46, s46, 18432
    v_mfma_f32_16x16x32_bf16 v[44:47], a[0:3], v[180:183], 0
    s_waitcnt lgkmcnt(1)
    s_barrier
    v_mfma_f32_16x16x32_bf16 v[48:51], a[4:7], v[180:183], 0
    ds_read_b128 v[204:207], v122 offset:0
    s_add_u32 m0, s44, 0
    ds_read_b128 v[136:139], v172 offset:512
    v_mfma_f32_16x16x32_bf16 v[52:55], a[8:11], v[180:183], 0
    buffer_load_dwordx4 v7, s[12:15], s46 offen offset:0 lds
    ds_read_b64_tr_b16 a[36:37], v4 offset:18624
    v_mfma_f32_16x16x32_bf16 v[56:59], a[0:3], v[192:195], 0
    ds_read_b64_tr_b16 a[38:39], v4 offset:19392
    ds_read_b64_tr_b16 a[40:41], v4 offset:18656
    v_mfma_f32_16x16x32_bf16 v[60:63], a[4:7], v[192:195], 0
    ds_read_b128 v[208:211], v122 offset:64
    ds_read_b64_tr_b16 a[42:43], v4 offset:19424
    v_mfma_f32_16x16x32_bf16 v[64:67], a[8:11], v[192:195], 0
    buffer_load_dwordx4 v7, s[12:15], s46 offen offset:1024 lds
    v_mfma_f32_16x16x32_bf16 v[52:55], a[20:23], v[184:187], v[52:55]
    ds_read_b64_tr_b16 a[44:45], v5 offset:18688
    ds_read_b64_tr_b16 a[46:47], v5 offset:19456
    v_mfma_f32_16x16x32_bf16 v[48:51], a[16:19], v[184:187], v[48:51]
    ds_read_b128 v[212:215], v122 offset:128
    ds_read_b64_tr_b16 a[48:49], v4 offset:24832
    v_mfma_f32_16x16x32_bf16 v[44:47], a[12:15], v[184:187], v[44:47]
    buffer_load_dwordx4 v7, s[12:15], s46 offen offset:2048 lds
    ds_read_b64_tr_b16 a[50:51], v4 offset:25600
    v_mfma_f32_16x16x32_bf16 v[64:67], a[20:23], v[196:199], v[64:67]
    ds_read_b64_tr_b16 a[52:53], v4 offset:24864
    ds_read_b64_tr_b16 a[54:55], v4 offset:25632
    v_mfma_f32_16x16x32_bf16 v[60:63], a[16:19], v[196:199], v[60:63]
    ds_read_b128 v[216:219], v123 offset:0
    s_add_u32 m0, s45, 0
    v_mfma_f32_16x16x32_bf16 v[56:59], a[12:15], v[196:199], v[56:59]
    buffer_load_dwordx4 v26, s[12:15], s46 offen offset:0 lds
    ds_read_b64_tr_b16 a[56:57], v5 offset:24896
    ds_read_b64_tr_b16 a[58:59], v5 offset:25664
    v_mfma_f32_16x16x32_bf16 v[44:47], a[24:27], v[188:191], v[44:47]
    ds_read_b64_tr_b16 a[60:61], v4 offset:31040
    ds_read_b64_tr_b16 a[62:63], v4 offset:31808
    v_mfma_f32_16x16x32_bf16 v[48:51], a[28:31], v[188:191], v[48:51]
    ds_read_b128 v[220:223], v123 offset:64
    ds_read_b64_tr_b16 a[64:65], v4 offset:31072
    v_mfma_f32_16x16x32_bf16 v[52:55], a[32:35], v[188:191], v[52:55]
    buffer_load_dwordx4 v26, s[12:15], s46 offen offset:1024 lds
    s_add_u32 s46, s46, 18432
    s_waitcnt lgkmcnt(7)
    v_mfma_f32_16x16x32_bf16 v[56:59], a[24:27], v[200:203], v[56:59]
    ds_read_b64_tr_b16 a[66:67], v4 offset:31840
    ds_read_b64_tr_b16 a[68:69], v5 offset:31104
    ds_read_b64_tr_b16 a[70:71], v5 offset:31872
    v_mfma_f32_16x16x32_bf16 v[60:63], a[28:31], v[200:203], v[60:63]
    ds_read_b128 v[224:227], v123 offset:128
    v_xor_b32 v136, v136, v166
    v_xor_b32 v138, v138, v166
    v_lshlrev_b32_sdwa v128, 4, v136 dst_sel:DWORD dst_unused:UNUSED_PAD src0_sel:DWORD src1_sel:WORD_0
    v_lshlrev_b32_sdwa v129, 4, v138 dst_sel:DWORD dst_unused:UNUSED_PAD src0_sel:DWORD src1_sel:WORD_0
    v_mfma_f32_16x16x32_bf16 v[64:67], a[32:35], v[200:203], v[64:67]
    s_waitcnt vmcnt(5)
    s_waitcnt lgkmcnt(1)
    s_barrier
    v_mfma_f32_16x16x32_bf16 v[44:47], a[36:39], v[204:207], v[44:47]
    ds_read_b64_tr_b16 a[72:73], v4 offset:37248
    ds_read_b64_tr_b16 a[74:75], v4 offset:38016
    v_mfma_f32_16x16x32_bf16 v[48:51], a[40:43], v[204:207], v[48:51]
    ds_read_b128 v[228:231], v128 offset:0
    s_add_u32 m0, s44, 18624
    ds_read_b128 v[136:139], v172 offset:768
    v_mfma_f32_16x16x32_bf16 v[52:55], a[44:47], v[204:207], v[52:55]
    buffer_load_dwordx4 v7, s[12:15], s46 offen offset:0 lds
    v_mfma_f32_16x16x32_bf16 v[52:55], a[56:59], v[208:211], v[52:55]
    ds_read_b64_tr_b16 a[76:77], v4 offset:37280
    ds_read_b64_tr_b16 a[78:79], v4 offset:38048
    v_mfma_f32_16x16x32_bf16 v[48:51], a[52:55], v[208:211], v[48:51]
    ds_read_b128 v[232:235], v128 offset:64
    ds_read_b64_tr_b16 a[80:81], v5 offset:37312
    v_mfma_f32_16x16x32_bf16 v[44:47], a[48:51], v[208:211], v[44:47]
    buffer_load_dwordx4 v7, s[12:15], s46 offen offset:1024 lds
    v_mfma_f32_16x16x32_bf16 v[44:47], a[60:63], v[212:215], v[44:47]
    ds_read_b64_tr_b16 a[82:83], v5 offset:38080
    ds_read_b64_tr_b16 a[84:85], v4 offset:43456
    v_mfma_f32_16x16x32_bf16 v[48:51], a[64:67], v[212:215], v[48:51]
    ds_read_b128 v[236:239], v128 offset:128
    ds_read_b64_tr_b16 a[86:87], v4 offset:44224
    v_mfma_f32_16x16x32_bf16 v[52:55], a[68:71], v[212:215], v[52:55]
    buffer_load_dwordx4 v7, s[12:15], s46 offen offset:2048 lds
    ds_read_b64_tr_b16 a[88:89], v4 offset:43488
    v_mfma_f32_16x16x32_bf16 v[56:59], a[36:39], v[216:219], v[56:59]
    ds_read_b64_tr_b16 a[90:91], v4 offset:44256
    ds_read_b64_tr_b16 a[92:93], v5 offset:43520
    v_mfma_f32_16x16x32_bf16 v[60:63], a[40:43], v[216:219], v[60:63]
    ds_read_b128 v[240:243], v129 offset:0
    s_add_u32 m0, s45, 18624
    v_mfma_f32_16x16x32_bf16 v[64:67], a[44:47], v[216:219], v[64:67]
    buffer_load_dwordx4 v26, s[12:15], s46 offen offset:0 lds
    ds_read_b64_tr_b16 a[94:95], v5 offset:44288
    v_mfma_f32_16x16x32_bf16 v[64:67], a[56:59], v[220:223], v[64:67]
    ds_read_b64_tr_b16 a[96:97], v4 offset:49664
    ds_read_b64_tr_b16 a[98:99], v4 offset:50432
    v_mfma_f32_16x16x32_bf16 v[60:63], a[52:55], v[220:223], v[60:63]
    ds_read_b128 v[244:247], v129 offset:64
    ds_read_b64_tr_b16 a[100:101], v4 offset:49696
    v_mfma_f32_16x16x32_bf16 v[56:59], a[48:51], v[220:223], v[56:59]
    buffer_load_dwordx4 v26, s[12:15], s46 offen offset:1024 lds
    s_add_u32 s46, s46, 18432
    s_waitcnt lgkmcnt(7)
    v_mfma_f32_16x16x32_bf16 v[56:59], a[60:63], v[224:227], v[56:59]
    ds_read_b64_tr_b16 a[102:103], v4 offset:50464
    ds_read_b64_tr_b16 a[104:105], v5 offset:49728
    ds_read_b64_tr_b16 a[106:107], v5 offset:50496
    v_mfma_f32_16x16x32_bf16 v[60:63], a[64:67], v[224:227], v[60:63]
    ds_read_b128 v[248:251], v129 offset:128
    v_xor_b32 v136, v136, v166
    v_xor_b32 v138, v138, v166
    v_lshlrev_b32_sdwa v116, 4, v136 dst_sel:DWORD dst_unused:UNUSED_PAD src0_sel:DWORD src1_sel:WORD_0
    v_lshlrev_b32_sdwa v117, 4, v138 dst_sel:DWORD dst_unused:UNUSED_PAD src0_sel:DWORD src1_sel:WORD_0
    v_mfma_f32_16x16x32_bf16 v[64:67], a[68:71], v[224:227], v[64:67]
    s_waitcnt vmcnt(5)
    s_waitcnt lgkmcnt(1)
    s_barrier
    v_mfma_f32_16x16x32_bf16 v[44:47], a[72:75], v[228:231], v[44:47]
    ds_read_b64_tr_b16 a[108:109], v4 offset:0
    ds_read_b64_tr_b16 a[110:111], v4 offset:768
    v_mfma_f32_16x16x32_bf16 v[48:51], a[76:79], v[228:231], v[48:51]
    ds_read_b128 v[180:183], v116 offset:0
    s_add_u32 m0, s44, 37248
    ds_read_b128 v[136:139], v172 offset:1024
    v_mfma_f32_16x16x32_bf16 v[52:55], a[80:83], v[228:231], v[52:55]
    buffer_load_dwordx4 v7, s[12:15], s46 offen offset:0 lds
    v_mfma_f32_16x16x32_bf16 v[52:55], a[92:95], v[232:235], v[52:55]
    ds_read_b64_tr_b16 a[112:113], v4 offset:32
    ds_read_b64_tr_b16 a[114:115], v4 offset:800
    v_mfma_f32_16x16x32_bf16 v[48:51], a[88:91], v[232:235], v[48:51]
    ds_read_b128 v[184:187], v116 offset:64
    ds_read_b64_tr_b16 a[116:117], v5 offset:64
    v_mfma_f32_16x16x32_bf16 v[44:47], a[84:87], v[232:235], v[44:47]
    buffer_load_dwordx4 v7, s[12:15], s46 offen offset:1024 lds
    v_mfma_f32_16x16x32_bf16 v[44:47], a[96:99], v[236:239], v[44:47]
    ds_read_b64_tr_b16 a[118:119], v5 offset:832
    ds_read_b64_tr_b16 a[120:121], v4 offset:6208
    v_mfma_f32_16x16x32_bf16 v[48:51], a[100:103], v[236:239], v[48:51]
    ds_read_b128 v[188:191], v116 offset:128
    ds_read_b64_tr_b16 a[122:123], v4 offset:6976
    v_mfma_f32_16x16x32_bf16 v[52:55], a[104:107], v[236:239], v[52:55]
    buffer_load_dwordx4 v7, s[12:15], s46 offen offset:2048 lds
    ds_read_b64_tr_b16 a[124:125], v4 offset:6240
    v_mfma_f32_16x16x32_bf16 v[56:59], a[72:75], v[240:243], v[56:59]
    ds_read_b64_tr_b16 a[126:127], v4 offset:7008
    ds_read_b64_tr_b16 a[128:129], v5 offset:6272
    v_mfma_f32_16x16x32_bf16 v[60:63], a[76:79], v[240:243], v[60:63]
    ds_read_b128 v[192:195], v117 offset:0
    s_add_u32 m0, s45, 37248
    v_mfma_f32_16x16x32_bf16 v[64:67], a[80:83], v[240:243], v[64:67]
    buffer_load_dwordx4 v26, s[12:15], s46 offen offset:0 lds
    ds_read_b64_tr_b16 a[130:131], v5 offset:7040
    v_mfma_f32_16x16x32_bf16 v[64:67], a[92:95], v[244:247], v[64:67]
    ds_read_b64_tr_b16 a[132:133], v4 offset:12416
    ds_read_b64_tr_b16 a[134:135], v4 offset:13184
    v_mfma_f32_16x16x32_bf16 v[60:63], a[88:91], v[244:247], v[60:63]
    ds_read_b128 v[196:199], v117 offset:64
    ds_read_b64_tr_b16 a[136:137], v4 offset:12448
    v_mfma_f32_16x16x32_bf16 v[56:59], a[84:87], v[244:247], v[56:59]
    buffer_load_dwordx4 v26, s[12:15], s46 offen offset:1024 lds
    s_add_u32 s46, s46, 18432
    s_waitcnt lgkmcnt(7)
    v_mfma_f32_16x16x32_bf16 v[56:59], a[96:99], v[248:251], v[56:59]
    ds_read_b64_tr_b16 a[138:139], v4 offset:13216
    ds_read_b64_tr_b16 a[140:141], v5 offset:12480
    ds_read_b64_tr_b16 a[142:143], v5 offset:13248
    v_mfma_f32_16x16x32_bf16 v[60:63], a[100:103], v[248:251], v[60:63]
    ds_read_b128 v[200:203], v117 offset:128
    v_xor_b32 v136, v136, v166
    v_xor_b32 v138, v138, v166
    v_lshlrev_b32_sdwa v122, 4, v136 dst_sel:DWORD dst_unused:UNUSED_PAD src0_sel:DWORD src1_sel:WORD_0
    v_lshlrev_b32_sdwa v123, 4, v138 dst_sel:DWORD dst_unused:UNUSED_PAD src0_sel:DWORD src1_sel:WORD_0
    v_mfma_f32_16x16x32_bf16 v[64:67], a[104:107], v[248:251], v[64:67]
    s_waitcnt vmcnt(5)
    s_waitcnt lgkmcnt(1)
    s_barrier
    v_mfma_f32_16x16x32_bf16 v[44:47], a[108:111], v[180:183], v[44:47]
    ds_read_b64_tr_b16 a[0:1], v4 offset:18624
    ds_read_b64_tr_b16 a[2:3], v4 offset:19392
    v_mfma_f32_16x16x32_bf16 v[48:51], a[112:115], v[180:183], v[48:51]
    ds_read_b128 v[204:207], v122 offset:0
    s_add_u32 m0, s44, 0
    ds_read_b128 v[136:139], v172 offset:1280
    v_mfma_f32_16x16x32_bf16 v[52:55], a[116:119], v[180:183], v[52:55]
    buffer_load_dwordx4 v7, s[12:15], s46 offen offset:0 lds
    v_mfma_f32_16x16x32_bf16 v[52:55], a[128:131], v[184:187], v[52:55]
    ds_read_b64_tr_b16 a[4:5], v4 offset:18656
    ds_read_b64_tr_b16 a[6:7], v4 offset:19424
    v_mfma_f32_16x16x32_bf16 v[48:51], a[124:127], v[184:187], v[48:51]
    ds_read_b128 v[208:211], v122 offset:64
    ds_read_b64_tr_b16 a[8:9], v5 offset:18688
    v_mfma_f32_16x16x32_bf16 v[44:47], a[120:123], v[184:187], v[44:47]
    buffer_load_dwordx4 v7, s[12:15], s46 offen offset:1024 lds
    v_mfma_f32_16x16x32_bf16 v[44:47], a[132:135], v[188:191], v[44:47]
    ds_read_b64_tr_b16 a[10:11], v5 offset:19456
    ds_read_b64_tr_b16 a[12:13], v4 offset:24832
    v_mfma_f32_16x16x32_bf16 v[48:51], a[136:139], v[188:191], v[48:51]
    ds_read_b128 v[212:215], v122 offset:128
    ds_read_b64_tr_b16 a[14:15], v4 offset:25600
    v_mfma_f32_16x16x32_bf16 v[52:55], a[140:143], v[188:191], v[52:55]
    buffer_load_dwordx4 v7, s[12:15], s46 offen offset:2048 lds
    ds_read_b64_tr_b16 a[16:17], v4 offset:24864
    v_mfma_f32_16x16x32_bf16 v[56:59], a[108:111], v[192:195], v[56:59]
    ds_read_b64_tr_b16 a[18:19], v4 offset:25632
    ds_read_b64_tr_b16 a[20:21], v5 offset:24896
    v_mfma_f32_16x16x32_bf16 v[60:63], a[112:115], v[192:195], v[60:63]
    ds_read_b128 v[216:219], v123 offset:0
    s_add_u32 m0, s45, 0
    v_mfma_f32_16x16x32_bf16 v[64:67], a[116:119], v[192:195], v[64:67]
    buffer_load_dwordx4 v26, s[12:15], s46 offen offset:0 lds
    ds_read_b64_tr_b16 a[22:23], v5 offset:25664
    v_mfma_f32_16x16x32_bf16 v[64:67], a[128:131], v[196:199], v[64:67]
    ds_read_b64_tr_b16 a[24:25], v4 offset:31040
    ds_read_b64_tr_b16 a[26:27], v4 offset:31808
    v_mfma_f32_16x16x32_bf16 v[60:63], a[124:127], v[196:199], v[60:63]
    ds_read_b128 v[220:223], v123 offset:64
    ds_read_b64_tr_b16 a[28:29], v4 offset:31072
    v_mfma_f32_16x16x32_bf16 v[56:59], a[120:123], v[196:199], v[56:59]
    buffer_load_dwordx4 v26, s[12:15], s46 offen offset:1024 lds
    s_add_u32 s46, s46, 18432
    s_waitcnt lgkmcnt(7)
    v_mfma_f32_16x16x32_bf16 v[56:59], a[132:135], v[200:203], v[56:59]
    ds_read_b64_tr_b16 a[30:31], v4 offset:31840
    ds_read_b64_tr_b16 a[32:33], v5 offset:31104
    ds_read_b64_tr_b16 a[34:35], v5 offset:31872
    v_mfma_f32_16x16x32_bf16 v[60:63], a[136:139], v[200:203], v[60:63]
    ds_read_b128 v[224:227], v123 offset:128
    v_xor_b32 v136, v136, v166
    v_xor_b32 v138, v138, v166
    v_lshlrev_b32_sdwa v128, 4, v136 dst_sel:DWORD dst_unused:UNUSED_PAD src0_sel:DWORD src1_sel:WORD_0
    v_lshlrev_b32_sdwa v129, 4, v138 dst_sel:DWORD dst_unused:UNUSED_PAD src0_sel:DWORD src1_sel:WORD_0
    v_mfma_f32_16x16x32_bf16 v[64:67], a[140:143], v[200:203], v[64:67]
    s_waitcnt vmcnt(5)
    s_waitcnt lgkmcnt(1)
    s_barrier
    v_mfma_f32_16x16x32_bf16 v[44:47], a[0:3], v[204:207], v[44:47]
    ds_read_b64_tr_b16 a[36:37], v4 offset:37248
    ds_read_b64_tr_b16 a[38:39], v4 offset:38016
    v_mfma_f32_16x16x32_bf16 v[48:51], a[4:7], v[204:207], v[48:51]
    ds_read_b128 v[228:231], v128 offset:0
    s_add_u32 m0, s44, 18624
    ds_read_b128 v[136:139], v172 offset:1536
    v_mfma_f32_16x16x32_bf16 v[52:55], a[8:11], v[204:207], v[52:55]
    buffer_load_dwordx4 v7, s[12:15], s46 offen offset:0 lds
    v_mfma_f32_16x16x32_bf16 v[52:55], a[20:23], v[208:211], v[52:55]
    ds_read_b64_tr_b16 a[40:41], v4 offset:37280
    ds_read_b64_tr_b16 a[42:43], v4 offset:38048
    v_mfma_f32_16x16x32_bf16 v[48:51], a[16:19], v[208:211], v[48:51]
    ds_read_b128 v[232:235], v128 offset:64
    ds_read_b64_tr_b16 a[44:45], v5 offset:37312
    v_mfma_f32_16x16x32_bf16 v[44:47], a[12:15], v[208:211], v[44:47]
    buffer_load_dwordx4 v7, s[12:15], s46 offen offset:1024 lds
    v_mfma_f32_16x16x32_bf16 v[44:47], a[24:27], v[212:215], v[44:47]
    ds_read_b64_tr_b16 a[46:47], v5 offset:38080
    ds_read_b64_tr_b16 a[48:49], v4 offset:43456
    v_mfma_f32_16x16x32_bf16 v[48:51], a[28:31], v[212:215], v[48:51]
    ds_read_b128 v[236:239], v128 offset:128
    ds_read_b64_tr_b16 a[50:51], v4 offset:44224
    v_mfma_f32_16x16x32_bf16 v[52:55], a[32:35], v[212:215], v[52:55]
    buffer_load_dwordx4 v7, s[12:15], s46 offen offset:2048 lds
    ds_read_b64_tr_b16 a[52:53], v4 offset:43488
    v_mfma_f32_16x16x32_bf16 v[56:59], a[0:3], v[216:219], v[56:59]
    ds_read_b64_tr_b16 a[54:55], v4 offset:44256
    ds_read_b64_tr_b16 a[56:57], v5 offset:43520
    v_mfma_f32_16x16x32_bf16 v[60:63], a[4:7], v[216:219], v[60:63]
    ds_read_b128 v[240:243], v129 offset:0
    s_add_u32 m0, s45, 18624
    v_mfma_f32_16x16x32_bf16 v[64:67], a[8:11], v[216:219], v[64:67]
    buffer_load_dwordx4 v26, s[12:15], s46 offen offset:0 lds
    ds_read_b64_tr_b16 a[58:59], v5 offset:44288
    v_mfma_f32_16x16x32_bf16 v[64:67], a[20:23], v[220:223], v[64:67]
    ds_read_b64_tr_b16 a[60:61], v4 offset:49664
    ds_read_b64_tr_b16 a[62:63], v4 offset:50432
    v_mfma_f32_16x16x32_bf16 v[60:63], a[16:19], v[220:223], v[60:63]
    ds_read_b128 v[244:247], v129 offset:64
    ds_read_b64_tr_b16 a[64:65], v4 offset:49696
    v_mfma_f32_16x16x32_bf16 v[56:59], a[12:15], v[220:223], v[56:59]
    buffer_load_dwordx4 v26, s[12:15], s46 offen offset:1024 lds
    s_add_u32 s46, s46, 18432
    s_waitcnt lgkmcnt(7)
    v_mfma_f32_16x16x32_bf16 v[56:59], a[24:27], v[224:227], v[56:59]
    ds_read_b64_tr_b16 a[66:67], v4 offset:50464
    ds_read_b64_tr_b16 a[68:69], v5 offset:49728
    ds_read_b64_tr_b16 a[70:71], v5 offset:50496
    v_mfma_f32_16x16x32_bf16 v[60:63], a[28:31], v[224:227], v[60:63]
    ds_read_b128 v[248:251], v129 offset:128
    v_xor_b32 v136, v136, v166
    v_xor_b32 v138, v138, v166
    v_lshlrev_b32_sdwa v116, 4, v136 dst_sel:DWORD dst_unused:UNUSED_PAD src0_sel:DWORD src1_sel:WORD_0
    v_lshlrev_b32_sdwa v117, 4, v138 dst_sel:DWORD dst_unused:UNUSED_PAD src0_sel:DWORD src1_sel:WORD_0
    v_mfma_f32_16x16x32_bf16 v[64:67], a[32:35], v[224:227], v[64:67]
    s_waitcnt vmcnt(5)
    s_waitcnt lgkmcnt(1)
    s_barrier
    v_mfma_f32_16x16x32_bf16 v[44:47], a[36:39], v[228:231], v[44:47]
    ds_read_b64_tr_b16 a[72:73], v4 offset:0
    ds_read_b64_tr_b16 a[74:75], v4 offset:768
    v_mfma_f32_16x16x32_bf16 v[48:51], a[40:43], v[228:231], v[48:51]
    ds_read_b128 v[180:183], v116 offset:0
    s_add_u32 m0, s44, 37248
    ds_read_b128 v[136:139], v172 offset:1792
    v_mfma_f32_16x16x32_bf16 v[52:55], a[44:47], v[228:231], v[52:55]
    buffer_load_dwordx4 v7, s[12:15], s46 offen offset:0 lds
    v_mfma_f32_16x16x32_bf16 v[52:55], a[56:59], v[232:235], v[52:55]
    ds_read_b64_tr_b16 a[76:77], v4 offset:32
    ds_read_b64_tr_b16 a[78:79], v4 offset:800
    v_mfma_f32_16x16x32_bf16 v[48:51], a[52:55], v[232:235], v[48:51]
    ds_read_b128 v[184:187], v116 offset:64
    ds_read_b64_tr_b16 a[80:81], v5 offset:64
    v_mfma_f32_16x16x32_bf16 v[44:47], a[48:51], v[232:235], v[44:47]
    buffer_load_dwordx4 v7, s[12:15], s46 offen offset:1024 lds
    v_mfma_f32_16x16x32_bf16 v[44:47], a[60:63], v[236:239], v[44:47]
    ds_read_b64_tr_b16 a[82:83], v5 offset:832
    ds_read_b64_tr_b16 a[84:85], v4 offset:6208
    v_mfma_f32_16x16x32_bf16 v[48:51], a[64:67], v[236:239], v[48:51]
    ds_read_b128 v[188:191], v116 offset:128
    ds_read_b64_tr_b16 a[86:87], v4 offset:6976
    v_mfma_f32_16x16x32_bf16 v[52:55], a[68:71], v[236:239], v[52:55]
    buffer_load_dwordx4 v7, s[12:15], s46 offen offset:2048 lds
    ds_read_b64_tr_b16 a[88:89], v4 offset:6240
    v_mfma_f32_16x16x32_bf16 v[56:59], a[36:39], v[240:243], v[56:59]
    ds_read_b64_tr_b16 a[90:91], v4 offset:7008
    ds_read_b64_tr_b16 a[92:93], v5 offset:6272
    v_mfma_f32_16x16x32_bf16 v[60:63], a[40:43], v[240:243], v[60:63]
    ds_read_b128 v[192:195], v117 offset:0
    s_add_u32 m0, s45, 37248
    v_mfma_f32_16x16x32_bf16 v[64:67], a[44:47], v[240:243], v[64:67]
    buffer_load_dwordx4 v26, s[12:15], s46 offen offset:0 lds
    ds_read_b64_tr_b16 a[94:95], v5 offset:7040
    v_mfma_f32_16x16x32_bf16 v[64:67], a[56:59], v[244:247], v[64:67]
    ds_read_b64_tr_b16 a[96:97], v4 offset:12416
    ds_read_b64_tr_b16 a[98:99], v4 offset:13184
    v_mfma_f32_16x16x32_bf16 v[60:63], a[52:55], v[244:247], v[60:63]
    ds_read_b128 v[196:199], v117 offset:64
    ds_read_b64_tr_b16 a[100:101], v4 offset:12448
    v_mfma_f32_16x16x32_bf16 v[56:59], a[48:51], v[244:247], v[56:59]
    buffer_load_dwordx4 v26, s[12:15], s46 offen offset:1024 lds
    s_add_u32 s46, s46, 18432
    s_waitcnt lgkmcnt(7)
    v_mfma_f32_16x16x32_bf16 v[56:59], a[60:63], v[248:251], v[56:59]
    ds_read_b64_tr_b16 a[102:103], v4 offset:13216
    ds_read_b64_tr_b16 a[104:105], v5 offset:12480
    ds_read_b64_tr_b16 a[106:107], v5 offset:13248
    v_mfma_f32_16x16x32_bf16 v[60:63], a[64:67], v[248:251], v[60:63]
    ds_read_b128 v[200:203], v117 offset:128
    v_xor_b32 v136, v136, v166
    v_xor_b32 v138, v138, v166
    v_lshlrev_b32_sdwa v122, 4, v136 dst_sel:DWORD dst_unused:UNUSED_PAD src0_sel:DWORD src1_sel:WORD_0
    v_lshlrev_b32_sdwa v123, 4, v138 dst_sel:DWORD dst_unused:UNUSED_PAD src0_sel:DWORD src1_sel:WORD_0
    v_mfma_f32_16x16x32_bf16 v[64:67], a[68:71], v[248:251], v[64:67]
    s_waitcnt vmcnt(5)
    s_waitcnt lgkmcnt(1)
    s_barrier
    v_mfma_f32_16x16x32_bf16 v[44:47], a[72:75], v[180:183], v[44:47]
    ds_read_b64_tr_b16 a[108:109], v4 offset:18624
    v_mfma_f32_16x16x32_bf16 v[48:51], a[76:79], v[180:183], v[48:51]
    ds_read_b128 v[204:207], v122 offset:0
    ds_read_b128 v[136:139], v172 offset:2048
    v_mfma_f32_16x16x32_bf16 v[52:55], a[80:83], v[180:183], v[52:55]
    ds_read_b64_tr_b16 a[110:111], v4 offset:19392
    v_mfma_f32_16x16x32_bf16 v[52:55], a[92:95], v[184:187], v[52:55]
    ds_read_b64_tr_b16 a[112:113], v4 offset:18656
    ds_read_b64_tr_b16 a[114:115], v4 offset:19424
    v_mfma_f32_16x16x32_bf16 v[48:51], a[88:91], v[184:187], v[48:51]
    ds_read_b128 v[208:211], v122 offset:64
    v_mfma_f32_16x16x32_bf16 v[44:47], a[84:87], v[184:187], v[44:47]
    ds_read_b64_tr_b16 a[116:117], v5 offset:18688
    v_mfma_f32_16x16x32_bf16 v[44:47], a[96:99], v[188:191], v[44:47]
    ds_read_b64_tr_b16 a[118:119], v5 offset:19456
    ds_read_b64_tr_b16 a[120:121], v4 offset:24832
    v_mfma_f32_16x16x32_bf16 v[48:51], a[100:103], v[188:191], v[48:51]
    ds_read_b128 v[212:215], v122 offset:128
    v_mfma_f32_16x16x32_bf16 v[52:55], a[104:107], v[188:191], v[52:55]
    ds_read_b64_tr_b16 a[122:123], v4 offset:25600
    ds_read_b64_tr_b16 a[124:125], v4 offset:24864
    v_mfma_f32_16x16x32_bf16 v[56:59], a[72:75], v[192:195], v[56:59]
    ds_read_b64_tr_b16 a[126:127], v4 offset:25632
    ds_read_b64_tr_b16 a[128:129], v5 offset:24896
    v_mfma_f32_16x16x32_bf16 v[60:63], a[76:79], v[192:195], v[60:63]
    ds_read_b128 v[216:219], v123 offset:0
    s_waitcnt lgkmcnt(7)
    v_xor_b32 v136, v136, v166
    v_xor_b32 v138, v138, v166
    v_mfma_f32_16x16x32_bf16 v[64:67], a[80:83], v[192:195], v[64:67]
    ds_read_b64_tr_b16 a[130:131], v5 offset:25664
    v_mfma_f32_16x16x32_bf16 v[64:67], a[92:95], v[196:199], v[64:67]
    ds_read_b64_tr_b16 a[132:133], v4 offset:31040
    ds_read_b64_tr_b16 a[134:135], v4 offset:31808
    v_mfma_f32_16x16x32_bf16 v[60:63], a[88:91], v[196:199], v[60:63]
    ds_read_b128 v[220:223], v123 offset:64
    v_mfma_f32_16x16x32_bf16 v[56:59], a[84:87], v[196:199], v[56:59]
    ds_read_b64_tr_b16 a[136:137], v4 offset:31072
    v_lshlrev_b32_sdwa v128, 4, v136 dst_sel:DWORD dst_unused:UNUSED_PAD src0_sel:DWORD src1_sel:WORD_0
    v_lshlrev_b32_sdwa v129, 4, v138 dst_sel:DWORD dst_unused:UNUSED_PAD src0_sel:DWORD src1_sel:WORD_0
    v_mfma_f32_16x16x32_bf16 v[56:59], a[96:99], v[200:203], v[56:59]
    ds_read_b64_tr_b16 a[138:139], v4 offset:31840
    ds_read_b64_tr_b16 a[140:141], v5 offset:31104
    ds_read_b64_tr_b16 a[142:143], v5 offset:31872
    v_mfma_f32_16x16x32_bf16 v[60:63], a[100:103], v[200:203], v[60:63]
    ds_read_b128 v[224:227], v123 offset:128
    v_mfma_f32_16x16x32_bf16 v[64:67], a[104:107], v[200:203], v[64:67]
    s_waitcnt vmcnt(0)
    s_waitcnt lgkmcnt(1)
    s_barrier
    v_mfma_f32_16x16x32_bf16 v[44:47], a[108:111], v[204:207], v[44:47]
    ds_read_b64_tr_b16 a[0:1], v4 offset:37248
    s_lshl_b32 s55, s55, 1
    v_mfma_f32_16x16x32_bf16 v[48:51], a[112:115], v[204:207], v[48:51]
    ds_read_b128 v[228:231], v128 offset:0
    s_mul_i32 s47, s30, 6656
    v_mfma_f32_16x16x32_bf16 v[52:55], a[116:119], v[204:207], v[52:55]
    ds_read_b64_tr_b16 a[2:3], v4 offset:38016
    v_lshrrev_b32 v38, 4, v6
    s_add_u32 s47, s47, 107616
    v_mfma_f32_16x16x32_bf16 v[52:55], a[128:131], v[208:211], v[52:55]
    ds_read_b64_tr_b16 a[4:5], v4 offset:37280
    ds_read_b64_tr_b16 a[6:7], v4 offset:38048
    v_mfma_f32_16x16x32_bf16 v[48:51], a[124:127], v[208:211], v[48:51]
    ds_read_b128 v[232:235], v128 offset:64
    v_mul_u32_u24 v39, 43, v38
    v_mfma_f32_16x16x32_bf16 v[44:47], a[120:123], v[208:211], v[44:47]
    ds_read_b64_tr_b16 a[8:9], v5 offset:37312
    v_add_u32 v40, 128, v38
    s_lshl_b32 s48, s29, 3
    v_mfma_f32_16x16x32_bf16 v[44:47], a[132:135], v[212:215], v[44:47]
    ds_read_b64_tr_b16 a[10:11], v5 offset:38080
    ds_read_b64_tr_b16 a[12:13], v4 offset:43456
    v_lshrrev_b32 v39, 9, v39
    v_mfma_f32_16x16x32_bf16 v[48:51], a[136:139], v[212:215], v[48:51]
    ds_read_b128 v[236:239], v128 offset:128
    v_mul_u32_u24 v41, 2731, v40
    v_mad_i32_i24 v38, v39, -12, v38
    v_mfma_f32_16x16x32_bf16 v[52:55], a[140:143], v[212:215], v[52:55]
    ds_read_b64_tr_b16 a[14:15], v4 offset:44224
    ds_read_b64_tr_b16 a[16:17], v4 offset:43488
    v_lshrrev_b32 v41, 16, v41
    v_mfma_f32_16x16x32_bf16 v[56:59], a[108:111], v[216:219], v[56:59]
    ds_read_b64_tr_b16 a[18:19], v4 offset:44256
    ds_read_b64_tr_b16 a[20:21], v5 offset:43520
    v_mfma_f32_16x16x32_bf16 v[60:63], a[112:115], v[216:219], v[60:63]
    ds_read_b128 v[240:243], v129 offset:0
    v_add_u32 v39, s48, v39
    v_mul_u32_u24 v42, 24, v41
    v_mfma_f32_16x16x32_bf16 v[64:67], a[116:119], v[216:219], v[64:67]
    ds_read_b64_tr_b16 a[22:23], v5 offset:44288
    v_mul_u32_u24 v18, 208, v39
    v_sub_u32 v40, v40, v42
    v_mfma_f32_16x16x32_bf16 v[64:67], a[128:131], v[220:223], v[64:67]
    ds_read_b64_tr_b16 a[24:25], v4 offset:49664
    ds_read_b64_tr_b16 a[26:27], v4 offset:50432
    v_mfma_f32_16x16x32_bf16 v[60:63], a[124:127], v[220:223], v[60:63]
    ds_read_b128 v[244:247], v129 offset:64
    v_add_u32 v41, s48, v41
    v_mul_u32_u24 v20, s2, v39
    v_mfma_f32_16x16x32_bf16 v[56:59], a[120:123], v[220:223], v[56:59]
    ds_read_b64_tr_b16 a[28:29], v4 offset:49696
    v_lshlrev_b32 v38, 4, v38
    v_mul_u32_u24 v19, 208, v41
    s_waitcnt lgkmcnt(7)
    v_mfma_f32_16x16x32_bf16 v[56:59], a[132:135], v[224:227], v[56:59]
    ds_read_b64_tr_b16 a[30:31], v4 offset:50464
    ds_read_b64_tr_b16 a[32:33], v5 offset:49728
    ds_read_b64_tr_b16 a[34:35], v5 offset:50496
    v_mfma_f32_16x16x32_bf16 v[60:63], a[136:139], v[224:227], v[60:63]
    ds_read_b128 v[248:251], v129 offset:128
    v_mul_u32_u24 v21, s2, v41
    v_lshlrev_b32 v40, 3, v40
    v_mfma_f32_16x16x32_bf16 v[64:67], a[140:143], v[224:227], v[64:67]
    v_add3_u32 v18, v18, s47, v38
    v_add_u32 v20, v20, v38
    v_mfma_f32_16x16x32_bf16 v[44:47], a[0:3], v[228:231], v[44:47]
    v_add3_u32 v19, v19, s47, v40
    v_add_u32 v21, v21, v40
    v_mfma_f32_16x16x32_bf16 v[48:51], a[4:7], v[228:231], v[48:51]
    v_bfe_u32 v38, v6, 4, 2
    v_mfma_f32_16x16x32_bf16 v[52:55], a[8:11], v[228:231], v[52:55]
    v_bfe_u32 v39, v6, 6, 2
    v_lshl_add_u32 v38, v38, 2, v39
    s_waitcnt lgkmcnt(7)
    v_mfma_f32_16x16x32_bf16 v[52:55], a[20:23], v[232:235], v[52:55]
    v_lshrrev_b32 v39, 8, v6
    v_mfma_f32_16x16x32_bf16 v[48:51], a[16:19], v[232:235], v[48:51]
    v_mul_u32_u24 v38, 208, v38
    v_mfma_f32_16x16x32_bf16 v[44:47], a[12:15], v[232:235], v[44:47]
    s_lshl4_add_u32 s49, s48, s47
    v_lshl_add_u32 v38, v39, 3, v38
    s_waitcnt lgkmcnt(6)
    v_mfma_f32_16x16x32_bf16 v[44:47], a[24:27], v[236:239], v[44:47]
    s_lshl2_add_u32 s48, s48, s47
    s_waitcnt lgkmcnt(3)
    v_mfma_f32_16x16x32_bf16 v[48:51], a[28:31], v[236:239], v[48:51]
    v_add_u32 v16, s49, v38
    s_waitcnt lgkmcnt(1)
    v_mfma_f32_16x16x32_bf16 v[52:55], a[32:35], v[236:239], v[52:55]
    v_add_u32 v17, s48, v38
    s_cmp_eq_u32 s36, 1
    s_cbranch_scc1 L_Pe2
    v_mfma_f32_16x16x32_bf16 v[56:59], a[0:3], v[240:243], v[56:59]
    v_mfma_f32_16x16x32_bf16 v[60:63], a[4:7], v[240:243], v[60:63]
    v_mfma_f32_16x16x32_bf16 v[64:67], a[8:11], v[240:243], v[64:67]
    v_mfma_f32_16x16x32_bf16 v[64:67], a[20:23], v[244:247], v[64:67]
    v_cvt_pk_bf16_f32 v32, v44, v45
    v_cvt_pk_bf16_f32 v33, v46, v47
    v_mfma_f32_16x16x32_bf16 v[60:63], a[16:19], v[244:247], v[60:63]
    v_cvt_pk_bf16_f32 v34, v48, v49
    v_cvt_pk_bf16_f32 v35, v50, v51
    v_mfma_f32_16x16x32_bf16 v[56:59], a[12:15], v[244:247], v[56:59]
    v_cvt_pk_bf16_f32 v36, v52, v53
    v_cvt_pk_bf16_f32 v37, v54, v55
    s_waitcnt lgkmcnt(0)
    v_mfma_f32_16x16x32_bf16 v[56:59], a[24:27], v[248:251], v[56:59]
    ds_write_b64 v16, v[32:33] offset:0
    v_mfma_f32_16x16x32_bf16 v[60:63], a[28:31], v[248:251], v[60:63]
    ds_write_b64 v16, v[34:35] offset:32
    v_mfma_f32_16x16x32_bf16 v[64:67], a[32:35], v[248:251], v[64:67]
    ds_write_b64 v17, v[36:37] offset:64
    s_waitcnt lgkmcnt(0)
    s_barrier
    ds_read_b128 v[38:41], v18 offset:0
    ds_read_b64 v[42:43], v19 offset:0
    v_cvt_pk_bf16_f32 v32, v56, v57
    v_cvt_pk_bf16_f32 v33, v58, v59
    v_cvt_pk_bf16_f32 v34, v60, v61
    v_cvt_pk_bf16_f32 v35, v62, v63
    ds_write_b64 v16, v[32:33] offset:3328
    s_waitcnt lgkmcnt(2)
    buffer_store_dwordx4 v[38:41], v20, s[16:19], s31 offen sc1
    s_waitcnt lgkmcnt(1)
    buffer_store_dwordx2 v[42:43], v21, s[16:19], s31 offen sc1
    s_add_u32 s31, s31, s55
    s_cmp_lg_u32 s54, 0
    v_cvt_pk_bf16_f32 v36, v64, v65
    v_cvt_pk_bf16_f32 v37, v66, v67
    ds_write_b64 v16, v[34:35] offset:3360
    ds_write_b64 v17, v[36:37] offset:3392
    s_waitcnt lgkmcnt(0)
    s_barrier
    ds_read_b128 v[24:27], v18 offset:3328
    ds_read_b64 v[28:29], v19 offset:3328
    s_waitcnt lgkmcnt(1)
    buffer_store_dwordx4 v[24:27], v20, s[16:19], s31 offen sc1
    s_waitcnt lgkmcnt(0)
    buffer_store_dwordx2 v[28:29], v21, s[16:19], s31 offen sc1
    s_barrier
    s_cbranch_scc1 L_gS
    s_endpgm
L_Pe2:
    s_cmp_lg_u32 s54, 0
    v_cvt_pk_bf16_f32 v32, v44, v45
    v_cvt_pk_bf16_f32 v33, v46, v47
    v_cvt_pk_bf16_f32 v34, v48, v49
    v_cvt_pk_bf16_f32 v35, v50, v51
    ds_write_b64 v16, v[32:33] offset:0
    v_cvt_pk_bf16_f32 v36, v52, v53
    v_cvt_pk_bf16_f32 v37, v54, v55
    ds_write_b64 v16, v[34:35] offset:32
    ds_write_b64 v17, v[36:37] offset:64
    s_waitcnt lgkmcnt(0)
    s_barrier
    ds_read_b128 v[38:41], v18 offset:0
    ds_read_b64 v[42:43], v19 offset:0
    s_waitcnt lgkmcnt(1)
    buffer_store_dwordx4 v[38:41], v20, s[16:19], s31 offen sc1
    s_waitcnt lgkmcnt(0)
    buffer_store_dwordx2 v[42:43], v21, s[16:19], s31 offen sc1
    s_barrier
    s_barrier
    s_cbranch_scc1 L_gS
    s_endpgm
L_Pj3:
    ds_read_b128 v[180:183], v116 offset:0
    ds_read_b64_tr_b16 a[0:1], v4 offset:0
    ds_read_b64_tr_b16 a[2:3], v4 offset:768
    ds_read_b64_tr_b16 a[4:5], v4 offset:32
    ds_read_b64_tr_b16 a[6:7], v4 offset:800
    ds_read_b64_tr_b16 a[8:9], v5 offset:64
    ds_read_b64_tr_b16 a[10:11], v5 offset:832
    ds_read_b128 v[192:195], v117 offset:0
    ds_read_b128 v[204:207], v118 offset:0
    ds_read_b64_tr_b16 a[12:13], v4 offset:6208
    ds_read_b64_tr_b16 a[14:15], v4 offset:6976
    ds_read_b128 v[136:139], v172 offset:256
    ds_read_b128 v[184:187], v116 offset:64
    ds_read_b64_tr_b16 a[16:17], v4 offset:6240
    s_add_u32 m0, s44, 37248
    s_nop 0
    buffer_load_dwordx4 v7, s[12:15], s46 offen offset:0 lds
    ds_read_b64_tr_b16 a[18:19], v4 offset:7008
    ds_read_b64_tr_b16 a[20:21], v5 offset:6272
    ds_read_b64_tr_b16 a[22:23], v5 offset:7040
    ds_read_b128 v[196:199], v117 offset:64
    buffer_load_dwordx4 v7, s[12:15], s46 offen offset:1024 lds
    ds_read_b128 v[208:211], v118 offset:64
    ds_read_b128 v[188:191], v116 offset:128
    ds_read_b64_tr_b16 a[24:25], v4 offset:12416
    ds_read_b64_tr_b16 a[26:27], v4 offset:13184
    buffer_load_dwordx4 v7, s[12:15], s46 offen offset:2048 lds
    ds_read_b64_tr_b16 a[28:29], v4 offset:12448
    ds_read_b64_tr_b16 a[30:31], v4 offset:13216
    ds_read_b64_tr_b16 a[32:33], v5 offset:12480
    ds_read_b64_tr_b16 a[34:35], v5 offset:13248
    s_add_u32 m0, s45, 37248
    s_nop 0
    buffer_load_dwordx4 v26, s[12:15], s46 offen offset:0 lds
    ds_read_b128 v[200:203], v117 offset:128
    ds_read_b128 v[212:215], v118 offset:128
    s_waitcnt lgkmcnt(7)
    v_xor_b32 v136, v136, v166
    v_xor_b32 v138, v138, v166
    buffer_load_dwordx4 v26, s[12:15], s46 offen offset:1024 lds
    v_lshlrev_b32_sdwa v122, 4, v136 dst_sel:DWORD dst_unused:UNUSED_PAD src0_sel:DWORD src1_sel:WORD_0
    v_lshlrev_b32_sdwa v123, 4, v138 dst_sel:DWORD dst_unused:UNUSED_PAD src0_sel:DWORD src1_sel:WORD_0
    v_lshlrev_b32_sdwa v124, 4, v136 dst_sel:DWORD dst_unused:UNUSED_PAD src0_sel:DWORD src1_sel:WORD_1
    s_add_u32 s46, s46, 18432
    v_mfma_f32_16x16x32_bf16 v[44:47], a[0:3], v[180:183], 0
    s_waitcnt lgkmcnt(2)
    s_barrier
    v_mfma_f32_16x16x32_bf16 v[48:51], a[4:7], v[180:183], 0
    ds_read_b128 v[216:219], v122 offset:0
    ds_read_b128 v[136:139], v172 offset:512
    v_mfma_f32_16x16x32_bf16 v[52:55], a[8:11], v[180:183], 0
    s_add_u32 m0, s44, 0
    ds_read_b64_tr_b16 a[36:37], v4 offset:18624
    v_mfma_f32_16x16x32_bf16 v[56:59], a[0:3], v[192:195], 0
    buffer_load_dwordx4 v7, s[12:15], s46 offen offset:0 lds
    v_mfma_f32_16x16x32_bf16 v[60:63], a[4:7], v[192:195], 0
    ds_read_b128 v[220:223], v122 offset:64
    v_mfma_f32_16x16x32_bf16 v[64:67], a[8:11], v[192:195], 0
    ds_read_b64_tr_b16 a[38:39], v4 offset:19392
    v_mfma_f32_16x16x32_bf16 v[68:71], a[0:3], v[204:207], 0
    ds_read_b64_tr_b16 a[40:41], v4 offset:18656
    ds_read_b64_tr_b16 a[42:43], v4 offset:19424
    v_mfma_f32_16x16x32_bf16 v[72:75], a[4:7], v[204:207], 0
    ds_read_b128 v[224:227], v122 offset:128
    v_mfma_f32_16x16x32_bf16 v[76:79], a[8:11], v[204:207], 0
    buffer_load_dwordx4 v7, s[12:15], s46 offen offset:1024 lds
    v_mfma_f32_16x16x32_bf16 v[52:55], a[20:23], v[184:187], v[52:55]
    ds_read_b64_tr_b16 a[44:45], v5 offset:18688
    ds_read_b64_tr_b16 a[46:47], v5 offset:19456
    v_mfma_f32_16x16x32_bf16 v[48:51], a[16:19], v[184:187], v[48:51]
    ds_read_b128 v[228:231], v123 offset:0
    v_mfma_f32_16x16x32_bf16 v[44:47], a[12:15], v[184:187], v[44:47]
    ds_read_b64_tr_b16 a[48:49], v4 offset:24832
    s_waitcnt lgkmcnt(7)
    v_xor_b32 v136, v136, v166
    v_xor_b32 v138, v138, v166
    v_mfma_f32_16x16x32_bf16 v[64:67], a[20:23], v[196:199], v[64:67]
    ds_read_b64_tr_b16 a[50:51], v4 offset:25600
    ds_read_b64_tr_b16 a[52:53], v4 offset:24864
    v_mfma_f32_16x16x32_bf16 v[60:63], a[16:19], v[196:199], v[60:63]
    ds_read_b128 v[232:235], v123 offset:64
    v_mfma_f32_16x16x32_bf16 v[56:59], a[12:15], v[196:199], v[56:59]
    buffer_load_dwordx4 v7, s[12:15], s46 offen offset:2048 lds
    v_mfma_f32_16x16x32_bf16 v[76:79], a[20:23], v[208:211], v[76:79]
    ds_read_b64_tr_b16 a[54:55], v4 offset:25632
    ds_read_b64_tr_b16 a[56:57], v5 offset:24896
    v_mfma_f32_16x16x32_bf16 v[72:75], a[16:19], v[208:211], v[72:75]
    ds_read_b128 v[236:239], v123 offset:128
    s_add_u32 m0, s45, 0
    v_mfma_f32_16x16x32_bf16 v[68:71], a[12:15], v[208:211], v[68:71]
    buffer_load_dwordx4 v26, s[12:15], s46 offen offset:0 lds
    v_mfma_f32_16x16x32_bf16 v[44:47], a[24:27], v[188:191], v[44:47]
    ds_read_b64_tr_b16 a[58:59], v5 offset:25664
    ds_read_b64_tr_b16 a[60:61], v4 offset:31040
    v_mfma_f32_16x16x32_bf16 v[48:51], a[28:31], v[188:191], v[48:51]
    ds_read_b128 v[240:243], v124 offset:0
    v_lshlrev_b32_sdwa v128, 4, v136 dst_sel:DWORD dst_unused:UNUSED_PAD src0_sel:DWORD src1_sel:WORD_0
    v_lshlrev_b32_sdwa v129, 4, v138 dst_sel:DWORD dst_unused:UNUSED_PAD src0_sel:DWORD src1_sel:WORD_0
    v_mfma_f32_16x16x32_bf16 v[52:55], a[32:35], v[188:191], v[52:55]
    ds_read_b64_tr_b16 a[62:63], v4 offset:31808
    v_mfma_f32_16x16x32_bf16 v[56:59], a[24:27], v[200:203], v[56:59]
    ds_read_b64_tr_b16 a[64:65], v4 offset:31072
    ds_read_b64_tr_b16 a[66:67], v4 offset:31840
    v_mfma_f32_16x16x32_bf16 v[60:63], a[28:31], v[200:203], v[60:63]
    ds_read_b128 v[244:247], v124 offset:64
    v_mfma_f32_16x16x32_bf16 v[64:67], a[32:35], v[200:203], v[64:67]
    buffer_load_dwordx4 v26, s[12:15], s46 offen offset:1024 lds
    s_add_u32 s46, s46, 18432
    v_mfma_f32_16x16x32_bf16 v[68:71], a[24:27], v[212:215], v[68:71]
    ds_read_b64_tr_b16 a[68:69], v5 offset:31104
    ds_read_b64_tr_b16 a[70:71], v5 offset:31872
    v_mfma_f32_16x16x32_bf16 v[72:75], a[28:31], v[212:215], v[72:75]
    ds_read_b128 v[248:251], v124 offset:128
    v_lshlrev_b32_sdwa v130, 4, v136 dst_sel:DWORD dst_unused:UNUSED_PAD src0_sel:DWORD src1_sel:WORD_1
    v_mfma_f32_16x16x32_bf16 v[76:79], a[32:35], v[212:215], v[76:79]
    s_waitcnt vmcnt(5)
    s_waitcnt lgkmcnt(1)
    s_barrier
    v_mfma_f32_16x16x32_bf16 v[44:47], a[36:39], v[216:219], v[44:47]
    ds_read_b64_tr_b16 a[72:73], v4 offset:37248
    v_mfma_f32_16x16x32_bf16 v[48:51], a[40:43], v[216:219], v[48:51]
    ds_read_b128 v[180:183], v128 offset:0
    s_add_u32 m0, s44, 18624
    ds_read_b128 v[136:139], v172 offset:768
    v_mfma_f32_16x16x32_bf16 v[52:55], a[44:47], v[216:219], v[52:55]
    buffer_load_dwordx4 v7, s[12:15], s46 offen offset:0 lds
    v_mfma_f32_16x16x32_bf16 v[52:55], a[56:59], v[220:223], v[52:55]
    ds_read_b64_tr_b16 a[74:75], v4 offset:38016
    v_mfma_f32_16x16x32_bf16 v[48:51], a[52:55], v[220:223], v[48:51]
    ds_read_b128 v[184:187], v128 offset:64
    v_mfma_f32_16x16x32_bf16 v[44:47], a[48:51], v[220:223], v[44:47]
    ds_read_b64_tr_b16 a[76:77], v4 offset:37280
    v_mfma_f32_16x16x32_bf16 v[44:47], a[60:63], v[224:227], v[44:47]
    ds_read_b64_tr_b16 a[78:79], v4 offset:38048
    ds_read_b64_tr_b16 a[80:81], v5 offset:37312
    v_mfma_f32_16x16x32_bf16 v[48:51], a[64:67], v[224:227], v[48:51]
    ds_read_b128 v[188:191], v128 offset:128
    v_mfma_f32_16x16x32_bf16 v[52:55], a[68:71], v[224:227], v[52:55]
    buffer_load_dwordx4 v7, s[12:15], s46 offen offset:1024 lds
    v_mfma_f32_16x16x32_bf16 v[56:59], a[36:39], v[228:231], v[56:59]
    ds_read_b64_tr_b16 a[82:83], v5 offset:38080
    v_mfma_f32_16x16x32_bf16 v[60:63], a[40:43], v[228:231], v[60:63]
    ds_read_b128 v[192:195], v129 offset:0
    v_mfma_f32_16x16x32_bf16 v[64:67], a[44:47], v[228:231], v[64:67]
    ds_read_b64_tr_b16 a[84:85], v4 offset:43456
    ds_read_b64_tr_b16 a[86:87], v4 offset:44224
    v_mfma_f32_16x16x32_bf16 v[64:67], a[56:59], v[232:235], v[64:67]
    buffer_load_dwordx4 v7, s[12:15], s46 offen offset:2048 lds
    v_mfma_f32_16x16x32_bf16 v[60:63], a[52:55], v[232:235], v[60:63]
    ds_read_b128 v[196:199], v129 offset:64
    ds_read_b64_tr_b16 a[88:89], v4 offset:43488
    v_mfma_f32_16x16x32_bf16 v[56:59], a[48:51], v[232:235], v[56:59]
    ds_read_b64_tr_b16 a[90:91], v4 offset:44256
    s_waitcnt lgkmcnt(7)
    v_xor_b32 v136, v136, v166
    v_xor_b32 v138, v138, v166
    v_mfma_f32_16x16x32_bf16 v[56:59], a[60:63], v[236:239], v[56:59]
    ds_read_b64_tr_b16 a[92:93], v5 offset:43520
    v_mfma_f32_16x16x32_bf16 v[60:63], a[64:67], v[236:239], v[60:63]
    ds_read_b128 v[200:203], v129 offset:128
    s_add_u32 m0, s45, 18624
    v_mfma_f32_16x16x32_bf16 v[64:67], a[68:71], v[236:239], v[64:67]
    buffer_load_dwordx4 v26, s[12:15], s46 offen offset:0 lds
    v_mfma_f32_16x16x32_bf16 v[68:71], a[36:39], v[240:243], v[68:71]
    ds_read_b64_tr_b16 a[94:95], v5 offset:44288
    ds_read_b64_tr_b16 a[96:97], v4 offset:49664
    v_mfma_f32_16x16x32_bf16 v[72:75], a[40:43], v[240:243], v[72:75]
    ds_read_b128 v[204:207], v130 offset:0
    v_lshlrev_b32_sdwa v116, 4, v136 dst_sel:DWORD dst_unused:UNUSED_PAD src0_sel:DWORD src1_sel:WORD_0
    v_lshlrev_b32_sdwa v117, 4, v138 dst_sel:DWORD dst_unused:UNUSED_PAD src0_sel:DWORD src1_sel:WORD_0
    v_mfma_f32_16x16x32_bf16 v[76:79], a[44:47], v[240:243], v[76:79]
    ds_read_b64_tr_b16 a[98:99], v4 offset:50432
    v_mfma_f32_16x16x32_bf16 v[76:79], a[56:59], v[244:247], v[76:79]
    ds_read_b64_tr_b16 a[100:101], v4 offset:49696
    ds_read_b64_tr_b16 a[102:103], v4 offset:50464
    v_mfma_f32_16x16x32_bf16 v[72:75], a[52:55], v[244:247], v[72:75]
    ds_read_b128 v[208:211], v130 offset:64
    v_mfma_f32_16x16x32_bf16 v[68:71], a[48:51], v[244:247], v[68:71]
    buffer_load_dwordx4 v26, s[12:15], s46 offen offset:1024 lds
    s_add_u32 s46, s46, 18432
    v_mfma_f32_16x16x32_bf16 v[68:71], a[60:63], v[248:251], v[68:71]
    ds_read_b64_tr_b16 a[104:105], v5 offset:49728
    ds_read_b64_tr_b16 a[106:107], v5 offset:50496
    v_mfma_f32_16x16x32_bf16 v[72:75], a[64:67], v[248:251], v[72:75]
    ds_read_b128 v[212:215], v130 offset:128
    v_lshlrev_b32_sdwa v118, 4, v136 dst_sel:DWORD dst_unused:UNUSED_PAD src0_sel:DWORD src1_sel:WORD_1
    v_mfma_f32_16x16x32_bf16 v[76:79], a[68:71], v[248:251], v[76:79]
    s_waitcnt vmcnt(5)
    s_waitcnt lgkmcnt(1)
    s_barrier
    v_mfma_f32_16x16x32_bf16 v[44:47], a[72:75], v[180:183], v[44:47]
    ds_read_b64_tr_b16 a[108:109], v4 offset:0
    v_mfma_f32_16x16x32_bf16 v[48:51], a[76:79], v[180:183], v[48:51]
    ds_read_b128 v[216:219], v116 offset:0
    s_add_u32 m0, s44, 37248
    ds_read_b128 v[136:139], v172 offset:1024
    v_mfma_f32_16x16x32_bf16 v[52:55], a[80:83], v[180:183], v[52:55]
    buffer_load_dwordx4 v7, s[12:15], s46 offen offset:0 lds
    v_mfma_f32_16x16x32_bf16 v[52:55], a[92:95], v[184:187], v[52:55]
    ds_read_b64_tr_b16 a[110:111], v4 offset:768
    v_mfma_f32_16x16x32_bf16 v[48:51], a[88:91], v[184:187], v[48:51]
    ds_read_b128 v[220:223], v116 offset:64
    v_mfma_f32_16x16x32_bf16 v[44:47], a[84:87], v[184:187], v[44:47]
    ds_read_b64_tr_b16 a[112:113], v4 offset:32
    v_mfma_f32_16x16x32_bf16 v[44:47], a[96:99], v[188:191], v[44:47]
    ds_read_b64_tr_b16 a[114:115], v4 offset:800
    ds_read_b64_tr_b16 a[116:117], v5 offset:64
    v_mfma_f32_16x16x32_bf16 v[48:51], a[100:103], v[188:191], v[48:51]
    ds_read_b128 v[224:227], v116 offset:128
    v_mfma_f32_16x16x32_bf16 v[52:55], a[104:107], v[188:191], v[52:55]
    buffer_load_dwordx4 v7, s[12:15], s46 offen offset:1024 lds
    v_mfma_f32_16x16x32_bf16 v[56:59], a[72:75], v[192:195], v[56:59]
    ds_read_b64_tr_b16 a[118:119], v5 offset:832
    v_mfma_f32_16x16x32_bf16 v[60:63], a[76:79], v[192:195], v[60:63]
    ds_read_b128 v[228:231], v117 offset:0
    v_mfma_f32_16x16x32_bf16 v[64:67], a[80:83], v[192:195], v[64:67]
    ds_read_b64_tr_b16 a[120:121], v4 offset:6208
    ds_read_b64_tr_b16 a[122:123], v4 offset:6976
    v_mfma_f32_16x16x32_bf16 v[64:67], a[92:95], v[196:199], v[64:67]
    buffer_load_dwordx4 v7, s[12:15], s46 offen offset:2048 lds
    v_mfma_f32_16x16x32_bf16 v[60:63], a[88:91], v[196:199], v[60:63]
    ds_read_b128 v[232:235], v117 offset:64
    ds_read_b64_tr_b16 a[124:125], v4 offset:6240
    v_mfma_f32_16x16x32_bf16 v[56:59], a[84:87], v[196:199], v[56:59]
    ds_read_b64_tr_b16 a[126:127], v4 offset:7008
    s_waitcnt lgkmcnt(7)
    v_xor_b32 v136, v136, v166
    v_xor_b32 v138, v138, v166
    v_mfma_f32_16x16x32_bf16 v[56:59], a[96:99], v[200:203], v[56:59]
    ds_read_b64_tr_b16 a[128:129], v5 offset:6272
    v_mfma_f32_16x16x32_bf16 v[60:63], a[100:103], v[200:203], v[60:63]
    ds_read_b128 v[236:239], v117 offset:128
    s_add_u32 m0, s45, 37248
    v_mfma_f32_16x16x32_bf16 v[64:67], a[104:107], v[200:203], v[64:67]
    buffer_load_dwordx4 v26, s[12:15], s46 offen offset:0 lds
    v_mfma_f32_16x16x32_bf16 v[68:71], a[72:75], v[204:207], v[68:71]
    ds_read_b64_tr_b16 a[130:131], v5 offset:7040
    ds_read_b64_tr_b16 a[132:133], v4 offset:12416
    v_mfma_f32_16x16x32_bf16 v[72:75], a[76:79], v[204:207], v[72:75]
    ds_read_b128 v[240:243], v118 offset:0
    v_lshlrev_b32_sdwa v122, 4, v136 dst_sel:DWORD dst_unused:UNUSED_PAD src0_sel:DWORD src1_sel:WORD_0
    v_lshlrev_b32_sdwa v123, 4, v138 dst_sel:DWORD dst_unused:UNUSED_PAD src0_sel:DWORD src1_sel:WORD_0
    v_mfma_f32_16x16x32_bf16 v[76:79], a[80:83], v[204:207], v[76:79]
    ds_read_b64_tr_b16 a[134:135], v4 offset:13184
    v_mfma_f32_16x16x32_bf16 v[76:79], a[92:95], v[208:211], v[76:79]
    ds_read_b64_tr_b16 a[136:137], v4 offset:12448
    ds_read_b64_tr_b16 a[138:139], v4 offset:13216
    v_mfma_f32_16x16x32_bf16 v[72:75], a[88:91], v[208:211], v[72:75]
    ds_read_b128 v[244:247], v118 offset:64
    v_mfma_f32_16x16x32_bf16 v[68:71], a[84:87], v[208:211], v[68:71]
    buffer_load_dwordx4 v26, s[12:15], s46 offen offset:1024 lds
    s_add_u32 s46, s46, 18432
    v_mfma_f32_16x16x32_bf16 v[68:71], a[96:99], v[212:215], v[68:71]
    ds_read_b64_tr_b16 a[140:141], v5 offset:12480
    ds_read_b64_tr_b16 a[142:143], v5 offset:13248
    v_mfma_f32_16x16x32_bf16 v[72:75], a[100:103], v[212:215], v[72:75]
    ds_read_b128 v[248:251], v118 offset:128
    v_lshlrev_b32_sdwa v124, 4, v136 dst_sel:DWORD dst_unused:UNUSED_PAD src0_sel:DWORD src1_sel:WORD_1
    v_mfma_f32_16x16x32_bf16 v[76:79], a[104:107], v[212:215], v[76:79]
    s_waitcnt vmcnt(5)
    s_waitcnt lgkmcnt(1)
    s_barrier
    v_mfma_f32_16x16x32_bf16 v[44:47], a[108:111], v[216:219], v[44:47]
    ds_read_b64_tr_b16 a[0:1], v4 offset:18624
    v_mfma_f32_16x16x32_bf16 v[48:51], a[112:115], v[216:219], v[48:51]
    ds_read_b128 v[180:183], v122 offset:0
    s_add_u32 m0, s44, 0
    ds_read_b128 v[136:139], v172 offset:1280
    v_mfma_f32_16x16x32_bf16 v[52:55], a[116:119], v[216:219], v[52:55]
    buffer_load_dwordx4 v7, s[12:15], s46 offen offset:0 lds
    v_mfma_f32_16x16x32_bf16 v[52:55], a[128:131], v[220:223], v[52:55]
    ds_read_b64_tr_b16 a[2:3], v4 offset:19392
    v_mfma_f32_16x16x32_bf16 v[48:51], a[124:127], v[220:223], v[48:51]
    ds_read_b128 v[184:187], v122 offset:64
    v_mfma_f32_16x16x32_bf16 v[44:47], a[120:123], v[220:223], v[44:47]
    ds_read_b64_tr_b16 a[4:5], v4 offset:18656
    v_mfma_f32_16x16x32_bf16 v[44:47], a[132:135], v[224:227], v[44:47]
    ds_read_b64_tr_b16 a[6:7], v4 offset:19424
    ds_read_b64_tr_b16 a[8:9], v5 offset:18688
    v_mfma_f32_16x16x32_bf16 v[48:51], a[136:139], v[224:227], v[48:51]
    ds_read_b128 v[188:191], v122 offset:128
    v_mfma_f32_16x16x32_bf16 v[52:55], a[140:143], v[224:227], v[52:55]
    buffer_load_dwordx4 v7, s[12:15], s46 offen offset:1024 lds
    v_mfma_f32_16x16x32_bf16 v[56:59], a[108:111], v[228:231], v[56:59]
    ds_read_b64_tr_b16 a[10:11], v5 offset:19456
    v_mfma_f32_16x16x32_bf16 v[60:63], a[112:115], v[228:231], v[60:63]
    ds_read_b128 v[192:195], v123 offset:0
    v_mfma_f32_16x16x32_bf16 v[64:67], a[116:119], v[228:231], v[64:67]
    ds_read_b64_tr_b16 a[12:13], v4 offset:24832
    ds_read_b64_tr_b16 a[14:15], v4 offset:25600
    v_mfma_f32_16x16x32_bf16 v[64:67], a[128:131], v[232:235], v[64:67]
    buffer_load_dwordx4 v7, s[12:15], s46 offen offset:2048 lds
    v_mfma_f32_16x16x32_bf16 v[60:63], a[124:127], v[232:235], v[60:63]
    ds_read_b128 v[196:199], v123 offset:64
    ds_read_b64_tr_b16 a[16:17], v4 offset:24864
    v_mfma_f32_16x16x32_bf16 v[56:59], a[120:123], v[232:235], v[56:59]
    ds_read_b64_tr_b16 a[18:19], v4 offset:25632
    s_waitcnt lgkmcnt(7)
    v_xor_b32 v136, v136, v166
    v_xor_b32 v138, v138, v166
    v_mfma_f32_16x16x32_bf16 v[56:59], a[132:135], v[236:239], v[56:59]
    ds_read_b64_tr_b16 a[20:21], v5 offset:24896
    v_mfma_f32_16x16x32_bf16 v[60:63], a[136:139], v[236:239], v[60:63]
    ds_read_b128 v[200:203], v123 offset:128
    s_add_u32 m0, s45, 0
    v_mfma_f32_16x16x32_bf16 v[64:67], a[140:143], v[236:239], v[64:67]
    buffer_load_dwordx4 v26, s[12:15], s46 offen offset:0 lds
    v_mfma_f32_16x16x32_bf16 v[68:71], a[108:111], v[240:243], v[68:71]
    ds_read_b64_tr_b16 a[22:23], v5 offset:25664
    ds_read_b64_tr_b16 a[24:25], v4 offset:31040
    v_mfma_f32_16x16x32_bf16 v[72:75], a[112:115], v[240:243], v[72:75]
    ds_read_b128 v[204:207], v124 offset:0
    v_lshlrev_b32_sdwa v128, 4, v136 dst_sel:DWORD dst_unused:UNUSED_PAD src0_sel:DWORD src1_sel:WORD_0
    v_lshlrev_b32_sdwa v129, 4, v138 dst_sel:DWORD dst_unused:UNUSED_PAD src0_sel:DWORD src1_sel:WORD_0
    v_mfma_f32_16x16x32_bf16 v[76:79], a[116:119], v[240:243], v[76:79]
    ds_read_b64_tr_b16 a[26:27], v4 offset:31808
    v_mfma_f32_16x16x32_bf16 v[76:79], a[128:131], v[244:247], v[76:79]
    ds_read_b64_tr_b16 a[28:29], v4 offset:31072
    ds_read_b64_tr_b16 a[30:31], v4 offset:31840
    v_mfma_f32_16x16x32_bf16 v[72:75], a[124:127], v[244:247], v[72:75]
    ds_read_b128 v[208:211], v124 offset:64
    v_mfma_f32_16x16x32_bf16 v[68:71], a[120:123], v[244:247], v[68:71]
    buffer_load_dwordx4 v26, s[12:15], s46 offen offset:1024 lds
    s_add_u32 s46, s46, 18432
    v_mfma_f32_16x16x32_bf16 v[68:71], a[132:135], v[248:251], v[68:71]
    ds_read_b64_tr_b16 a[32:33], v5 offset:31104
    ds_read_b64_tr_b16 a[34:35], v5 offset:31872
    v_mfma_f32_16x16x32_bf16 v[72:75], a[136:139], v[248:251], v[72:75]
    ds_read_b128 v[212:215], v124 offset:128
    v_lshlrev_b32_sdwa v130, 4, v136 dst_sel:DWORD dst_unused:UNUSED_PAD src0_sel:DWORD src1_sel:WORD_1
    v_mfma_f32_16x16x32_bf16 v[76:79], a[140:143], v[248:251], v[76:79]
    s_waitcnt vmcnt(5)
    s_waitcnt lgkmcnt(1)
    s_barrier
    v_mfma_f32_16x16x32_bf16 v[44:47], a[0:3], v[180:183], v[44:47]
    ds_read_b64_tr_b16 a[36:37], v4 offset:37248
    v_mfma_f32_16x16x32_bf16 v[48:51], a[4:7], v[180:183], v[48:51]
    ds_read_b128 v[216:219], v128 offset:0
    s_add_u32 m0, s44, 18624
    ds_read_b128 v[136:139], v172 offset:1536
    v_mfma_f32_16x16x32_bf16 v[52:55], a[8:11], v[180:183], v[52:55]
    buffer_load_dwordx4 v7, s[12:15], s46 offen offset:0 lds
    v_mfma_f32_16x16x32_bf16 v[52:55], a[20:23], v[184:187], v[52:55]
    ds_read_b64_tr_b16 a[38:39], v4 offset:38016
    v_mfma_f32_16x16x32_bf16 v[48:51], a[16:19], v[184:187], v[48:51]
    ds_read_b128 v[220:223], v128 offset:64
    v_mfma_f32_16x16x32_bf16 v[44:47], a[12:15], v[184:187], v[44:47]
    ds_read_b64_tr_b16 a[40:41], v4 offset:37280
    v_mfma_f32_16x16x32_bf16 v[44:47], a[24:27], v[188:191], v[44:47]
    ds_read_b64_tr_b16 a[42:43], v4 offset:38048
    ds_read_b64_tr_b16 a[44:45], v5 offset:37312
    v_mfma_f32_16x16x32_bf16 v[48:51], a[28:31], v[188:191], v[48:51]
    ds_read_b128 v[224:227], v128 offset:128
    v_mfma_f32_16x16x32_bf16 v[52:55], a[32:35], v[188:191], v[52:55]
    buffer_load_dwordx4 v7, s[12:15], s46 offen offset:1024 lds
    v_mfma_f32_16x16x32_bf16 v[56:59], a[0:3], v[192:195], v[56:59]
    ds_read_b64_tr_b16 a[46:47], v5 offset:38080
    v_mfma_f32_16x16x32_bf16 v[60:63], a[4:7], v[192:195], v[60:63]
    ds_read_b128 v[228:231], v129 offset:0
    v_mfma_f32_16x16x32_bf16 v[64:67], a[8:11], v[192:195], v[64:67]
    ds_read_b64_tr_b16 a[48:49], v4 offset:43456
    ds_read_b64_tr_b16 a[50:51], v4 offset:44224
    v_mfma_f32_16x16x32_bf16 v[64:67], a[20:23], v[196:199], v[64:67]
    buffer_load_dwordx4 v7, s[12:15], s46 offen offset:2048 lds
    v_mfma_f32_16x16x32_bf16 v[60:63], a[16:19], v[196:199], v[60:63]
    ds_read_b128 v[232:235], v129 offset:64
    ds_read_b64_tr_b16 a[52:53], v4 offset:43488
    v_mfma_f32_16x16x32_bf16 v[56:59], a[12:15], v[196:199], v[56:59]
    ds_read_b64_tr_b16 a[54:55], v4 offset:44256
    s_waitcnt lgkmcnt(7)
    v_xor_b32 v136, v136, v166
    v_xor_b32 v138, v138, v166
    v_mfma_f32_16x16x32_bf16 v[56:59], a[24:27], v[200:203], v[56:59]
    ds_read_b64_tr_b16 a[56:57], v5 offset:43520
    v_mfma_f32_16x16x32_bf16 v[60:63], a[28:31], v[200:203], v[60:63]
    ds_read_b128 v[236:239], v129 offset:128
    s_add_u32 m0, s45, 18624
    v_mfma_f32_16x16x32_bf16 v[64:67], a[32:35], v[200:203], v[64:67]
    buffer_load_dwordx4 v26, s[12:15], s46 offen offset:0 lds
    v_mfma_f32_16x16x32_bf16 v[68:71], a[0:3], v[204:207], v[68:71]
    ds_read_b64_tr_b16 a[58:59], v5 offset:44288
    ds_read_b64_tr_b16 a[60:61], v4 offset:49664
    v_mfma_f32_16x16x32_bf16 v[72:75], a[4:7], v[204:207], v[72:75]
    ds_read_b128 v[240:243], v130 offset:0
    v_lshlrev_b32_sdwa v116, 4, v136 dst_sel:DWORD dst_unused:UNUSED_PAD src0_sel:DWORD src1_sel:WORD_0
    v_lshlrev_b32_sdwa v117, 4, v138 dst_sel:DWORD dst_unused:UNUSED_PAD src0_sel:DWORD src1_sel:WORD_0
    v_mfma_f32_16x16x32_bf16 v[76:79], a[8:11], v[204:207], v[76:79]
    ds_read_b64_tr_b16 a[62:63], v4 offset:50432
    v_mfma_f32_16x16x32_bf16 v[76:79], a[20:23], v[208:211], v[76:79]
    ds_read_b64_tr_b16 a[64:65], v4 offset:49696
    ds_read_b64_tr_b16 a[66:67], v4 offset:50464
    v_mfma_f32_16x16x32_bf16 v[72:75], a[16:19], v[208:211], v[72:75]
    ds_read_b128 v[244:247], v130 offset:64
    v_mfma_f32_16x16x32_bf16 v[68:71], a[12:15], v[208:211], v[68:71]
    buffer_load_dwordx4 v26, s[12:15], s46 offen offset:1024 lds
    s_add_u32 s46, s46, 18432
    v_mfma_f32_16x16x32_bf16 v[68:71], a[24:27], v[212:215], v[68:71]
    ds_read_b64_tr_b16 a[68:69], v5 offset:49728
    ds_read_b64_tr_b16 a[70:71], v5 offset:50496
    v_mfma_f32_16x16x32_bf16 v[72:75], a[28:31], v[212:215], v[72:75]
    ds_read_b128 v[248:251], v130 offset:128
    v_lshlrev_b32_sdwa v118, 4, v136 dst_sel:DWORD dst_unused:UNUSED_PAD src0_sel:DWORD src1_sel:WORD_1
    v_mfma_f32_16x16x32_bf16 v[76:79], a[32:35], v[212:215], v[76:79]
    s_waitcnt vmcnt(5)
    s_waitcnt lgkmcnt(1)
    s_barrier
    v_mfma_f32_16x16x32_bf16 v[44:47], a[36:39], v[216:219], v[44:47]
    ds_read_b64_tr_b16 a[72:73], v4 offset:0
    v_mfma_f32_16x16x32_bf16 v[48:51], a[40:43], v[216:219], v[48:51]
    ds_read_b128 v[180:183], v116 offset:0
    s_add_u32 m0, s44, 37248
    ds_read_b128 v[136:139], v172 offset:1792
    v_mfma_f32_16x16x32_bf16 v[52:55], a[44:47], v[216:219], v[52:55]
    buffer_load_dwordx4 v7, s[12:15], s46 offen offset:0 lds
    v_mfma_f32_16x16x32_bf16 v[52:55], a[56:59], v[220:223], v[52:55]
    ds_read_b64_tr_b16 a[74:75], v4 offset:768
    v_mfma_f32_16x16x32_bf16 v[48:51], a[52:55], v[220:223], v[48:51]
    ds_read_b128 v[184:187], v116 offset:64
    v_mfma_f32_16x16x32_bf16 v[44:47], a[48:51], v[220:223], v[44:47]
    ds_read_b64_tr_b16 a[76:77], v4 offset:32
    v_mfma_f32_16x16x32_bf16 v[44:47], a[60:63], v[224:227], v[44:47]
    ds_read_b64_tr_b16 a[78:79], v4 offset:800
    ds_read_b64_tr_b16 a[80:81], v5 offset:64
    v_mfma_f32_16x16x32_bf16 v[48:51], a[64:67], v[224:227], v[48:51]
    ds_read_b128 v[188:191], v116 offset:128
    v_mfma_f32_16x16x32_bf16 v[52:55], a[68:71], v[224:227], v[52:55]
    buffer_load_dwordx4 v7, s[12:15], s46 offen offset:1024 lds
    v_mfma_f32_16x16x32_bf16 v[56:59], a[36:39], v[228:231], v[56:59]
    ds_read_b64_tr_b16 a[82:83], v5 offset:832
    v_mfma_f32_16x16x32_bf16 v[60:63], a[40:43], v[228:231], v[60:63]
    ds_read_b128 v[192:195], v117 offset:0
    v_mfma_f32_16x16x32_bf16 v[64:67], a[44:47], v[228:231], v[64:67]
    ds_read_b64_tr_b16 a[84:85], v4 offset:6208
    ds_read_b64_tr_b16 a[86:87], v4 offset:6976
    v_mfma_f32_16x16x32_bf16 v[64:67], a[56:59], v[232:235], v[64:67]
    buffer_load_dwordx4 v7, s[12:15], s46 offen offset:2048 lds
    v_mfma_f32_16x16x32_bf16 v[60:63], a[52:55], v[232:235], v[60:63]
    ds_read_b128 v[196:199], v117 offset:64
    ds_read_b64_tr_b16 a[88:89], v4 offset:6240
    v_mfma_f32_16x16x32_bf16 v[56:59], a[48:51], v[232:235], v[56:59]
    ds_read_b64_tr_b16 a[90:91], v4 offset:7008
    s_waitcnt lgkmcnt(7)
    v_xor_b32 v136, v136, v166
    v_xor_b32 v138, v138, v166
    v_mfma_f32_16x16x32_bf16 v[56:59], a[60:63], v[236:239], v[56:59]
    ds_read_b64_tr_b16 a[92:93], v5 offset:6272
    v_mfma_f32_16x16x32_bf16 v[60:63], a[64:67], v[236:239], v[60:63]
    ds_read_b128 v[200:203], v117 offset:128
    s_add_u32 m0, s45, 37248
    v_mfma_f32_16x16x32_bf16 v[64:67], a[68:71], v[236:239], v[64:67]
    buffer_load_dwordx4 v26, s[12:15], s46 offen offset:0 lds
    v_mfma_f32_16x16x32_bf16 v[68:71], a[36:39], v[240:243], v[68:71]
    ds_read_b64_tr_b16 a[94:95], v5 offset:7040
    ds_read_b64_tr_b16 a[96:97], v4 offset:12416
    v_mfma_f32_16x16x32_bf16 v[72:75], a[40:43], v[240:243], v[72:75]
    ds_read_b128 v[204:207], v118 offset:0
    v_lshlrev_b32_sdwa v122, 4, v136 dst_sel:DWORD dst_unused:UNUSED_PAD src0_sel:DWORD src1_sel:WORD_0
    v_lshlrev_b32_sdwa v123, 4, v138 dst_sel:DWORD dst_unused:UNUSED_PAD src0_sel:DWORD src1_sel:WORD_0
    v_mfma_f32_16x16x32_bf16 v[76:79], a[44:47], v[240:243], v[76:79]
    ds_read_b64_tr_b16 a[98:99], v4 offset:13184
    v_mfma_f32_16x16x32_bf16 v[76:79], a[56:59], v[244:247], v[76:79]
    ds_read_b64_tr_b16 a[100:101], v4 offset:12448
    ds_read_b64_tr_b16 a[102:103], v4 offset:13216
    v_mfma_f32_16x16x32_bf16 v[72:75], a[52:55], v[244:247], v[72:75]
    ds_read_b128 v[208:211], v118 offset:64
    v_mfma_f32_16x16x32_bf16 v[68:71], a[48:51], v[244:247], v[68:71]
    buffer_load_dwordx4 v26, s[12:15], s46 offen offset:1024 lds
    s_add_u32 s46, s46, 18432
    v_mfma_f32_16x16x32_bf16 v[68:71], a[60:63], v[248:251], v[68:71]
    ds_read_b64_tr_b16 a[104:105], v5 offset:12480
    ds_read_b64_tr_b16 a[106:107], v5 offset:13248
    v_mfma_f32_16x16x32_bf16 v[72:75], a[64:67], v[248:251], v[72:75]
    ds_read_b128 v[212:215], v118 offset:128
    v_lshlrev_b32_sdwa v124, 4, v136 dst_sel:DWORD dst_unused:UNUSED_PAD src0_sel:DWORD src1_sel:WORD_1
    v_mfma_f32_16x16x32_bf16 v[76:79], a[68:71], v[248:251], v[76:79]
    s_waitcnt vmcnt(5)
    s_waitcnt lgkmcnt(1)
    s_barrier
    v_mfma_f32_16x16x32_bf16 v[44:47], a[72:75], v[180:183], v[44:47]
    ds_read_b64_tr_b16 a[108:109], v4 offset:18624
    v_mfma_f32_16x16x32_bf16 v[48:51], a[76:79], v[180:183], v[48:51]
    ds_read_b128 v[216:219], v122 offset:0
    ds_read_b128 v[136:139], v172 offset:2048
    v_mfma_f32_16x16x32_bf16 v[52:55], a[80:83], v[180:183], v[52:55]
    ds_read_b64_tr_b16 a[110:111], v4 offset:19392
    v_mfma_f32_16x16x32_bf16 v[52:55], a[92:95], v[184:187], v[52:55]
    ds_read_b64_tr_b16 a[112:113], v4 offset:18656
    v_mfma_f32_16x16x32_bf16 v[48:51], a[88:91], v[184:187], v[48:51]
    ds_read_b128 v[220:223], v122 offset:64
    v_mfma_f32_16x16x32_bf16 v[44:47], a[84:87], v[184:187], v[44:47]
    ds_read_b64_tr_b16 a[114:115], v4 offset:19424
    v_mfma_f32_16x16x32_bf16 v[44:47], a[96:99], v[188:191], v[44:47]
    ds_read_b64_tr_b16 a[116:117], v5 offset:18688
    v_mfma_f32_16x16x32_bf16 v[48:51], a[100:103], v[188:191], v[48:51]
    ds_read_b128 v[224:227], v122 offset:128
    v_mfma_f32_16x16x32_bf16 v[52:55], a[104:107], v[188:191], v[52:55]
    ds_read_b64_tr_b16 a[118:119], v5 offset:19456
    v_mfma_f32_16x16x32_bf16 v[56:59], a[72:75], v[192:195], v[56:59]
    ds_read_b64_tr_b16 a[120:121], v4 offset:24832
    v_mfma_f32_16x16x32_bf16 v[60:63], a[76:79], v[192:195], v[60:63]
    ds_read_b128 v[228:231], v123 offset:0
    v_mfma_f32_16x16x32_bf16 v[64:67], a[80:83], v[192:195], v[64:67]
    ds_read_b64_tr_b16 a[122:123], v4 offset:25600
    s_waitcnt lgkmcnt(7)
    v_xor_b32 v136, v136, v166
    v_xor_b32 v138, v138, v166
    v_mfma_f32_16x16x32_bf16 v[64:67], a[92:95], v[196:199], v[64:67]
    ds_read_b64_tr_b16 a[124:125], v4 offset:24864
    v_mfma_f32_16x16x32_bf16 v[60:63], a[88:91], v[196:199], v[60:63]
    ds_read_b128 v[232:235], v123 offset:64
    v_mfma_f32_16x16x32_bf16 v[56:59], a[84:87], v[196:199], v[56:59]
    ds_read_b64_tr_b16 a[126:127], v4 offset:25632
    v_mfma_f32_16x16x32_bf16 v[56:59], a[96:99], v[200:203], v[56:59]
    ds_read_b64_tr_b16 a[128:129], v5 offset:24896
    v_mfma_f32_16x16x32_bf16 v[60:63], a[100:103], v[200:203], v[60:63]
    ds_read_b128 v[236:239], v123 offset:128
    v_mfma_f32_16x16x32_bf16 v[64:67], a[104:107], v[200:203], v[64:67]
    ds_read_b64_tr_b16 a[130:131], v5 offset:25664
    v_lshlrev_b32_sdwa v128, 4, v136 dst_sel:DWORD dst_unused:UNUSED_PAD src0_sel:DWORD src1_sel:WORD_0
    v_lshlrev_b32_sdwa v129, 4, v138 dst_sel:DWORD dst_unused:UNUSED_PAD src0_sel:DWORD src1_sel:WORD_0
    v_mfma_f32_16x16x32_bf16 v[68:71], a[72:75], v[204:207], v[68:71]
    ds_read_b64_tr_b16 a[132:133], v4 offset:31040
    v_mfma_f32_16x16x32_bf16 v[72:75], a[76:79], v[204:207], v[72:75]
    ds_read_b128 v[240:243], v124 offset:0
    v_mfma_f32_16x16x32_bf16 v[76:79], a[80:83], v[204:207], v[76:79]
    ds_read_b64_tr_b16 a[134:135], v4 offset:31808
    v_mfma_f32_16x16x32_bf16 v[76:79], a[92:95], v[208:211], v[76:79]
    ds_read_b64_tr_b16 a[136:137], v4 offset:31072
    v_mfma_f32_16x16x32_bf16 v[72:75], a[88:91], v[208:211], v[72:75]
    ds_read_b128 v[244:247], v124 offset:64
    v_mfma_f32_16x16x32_bf16 v[68:71], a[84:87], v[208:211], v[68:71]
    ds_read_b64_tr_b16 a[138:139], v4 offset:31840
    v_lshlrev_b32_sdwa v130, 4, v136 dst_sel:DWORD dst_unused:UNUSED_PAD src0_sel:DWORD src1_sel:WORD_1
    v_mfma_f32_16x16x32_bf16 v[68:71], a[96:99], v[212:215], v[68:71]
    ds_read_b64_tr_b16 a[140:141], v5 offset:31104
    ds_read_b64_tr_b16 a[142:143], v5 offset:31872
    v_mfma_f32_16x16x32_bf16 v[72:75], a[100:103], v[212:215], v[72:75]
    ds_read_b128 v[248:251], v124 offset:128
    v_mfma_f32_16x16x32_bf16 v[76:79], a[104:107], v[212:215], v[76:79]
    s_waitcnt vmcnt(0)
    s_waitcnt lgkmcnt(1)
    s_barrier
    v_mfma_f32_16x16x32_bf16 v[44:47], a[108:111], v[216:219], v[44:47]
    ds_read_b64_tr_b16 a[0:1], v4 offset:37248
    s_lshl_b32 s55, s55, 1
    v_mfma_f32_16x16x32_bf16 v[48:51], a[112:115], v[216:219], v[48:51]
    ds_read_b128 v[180:183], v128 offset:0
    s_mul_i32 s47, s30, 6656
    v_mfma_f32_16x16x32_bf16 v[52:55], a[116:119], v[216:219], v[52:55]
    ds_read_b64_tr_b16 a[2:3], v4 offset:38016
    v_lshrrev_b32 v38, 4, v6
    v_mfma_f32_16x16x32_bf16 v[52:55], a[128:131], v[220:223], v[52:55]
    ds_read_b64_tr_b16 a[4:5], v4 offset:37280
    s_add_u32 s47, s47, 107616
    v_mfma_f32_16x16x32_bf16 v[48:51], a[124:127], v[220:223], v[48:51]
    ds_read_b128 v[184:187], v128 offset:64
    v_mul_u32_u24 v39, 43, v38
    v_mfma_f32_16x16x32_bf16 v[44:47], a[120:123], v[220:223], v[44:47]
    ds_read_b64_tr_b16 a[6:7], v4 offset:38048
    v_add_u32 v40, 128, v38
    v_mfma_f32_16x16x32_bf16 v[44:47], a[132:135], v[224:227], v[44:47]
    ds_read_b64_tr_b16 a[8:9], v5 offset:37312
    s_lshl_b32 s48, s29, 3
    v_mfma_f32_16x16x32_bf16 v[48:51], a[136:139], v[224:227], v[48:51]
    ds_read_b128 v[188:191], v128 offset:128
    v_lshrrev_b32 v39, 9, v39
    v_mfma_f32_16x16x32_bf16 v[52:55], a[140:143], v[224:227], v[52:55]
    ds_read_b64_tr_b16 a[10:11], v5 offset:38080
    v_mul_u32_u24 v41, 2731, v40
    v_mfma_f32_16x16x32_bf16 v[56:59], a[108:111], v[228:231], v[56:59]
    ds_read_b64_tr_b16 a[12:13], v4 offset:43456
    v_mad_i32_i24 v38, v39, -12, v38
    v_mfma_f32_16x16x32_bf16 v[60:63], a[112:115], v[228:231], v[60:63]
    ds_read_b128 v[192:195], v129 offset:0
    v_lshrrev_b32 v41, 16, v41
    v_mfma_f32_16x16x32_bf16 v[64:67], a[116:119], v[228:231], v[64:67]
    ds_read_b64_tr_b16 a[14:15], v4 offset:44224
    v_add_u32 v39, s48, v39
    v_mfma_f32_16x16x32_bf16 v[64:67], a[128:131], v[232:235], v[64:67]
    ds_read_b64_tr_b16 a[16:17], v4 offset:43488
    v_mul_u32_u24 v42, 24, v41
    v_mfma_f32_16x16x32_bf16 v[60:63], a[124:127], v[232:235], v[60:63]
    ds_read_b128 v[196:199], v129 offset:64
    v_mul_u32_u24 v18, 208, v39
    v_mfma_f32_16x16x32_bf16 v[56:59], a[120:123], v[232:235], v[56:59]
    ds_read_b64_tr_b16 a[18:19], v4 offset:44256
    v_sub_u32 v40, v40, v42
    v_mfma_f32_16x16x32_bf16 v[56:59], a[132:135], v[236:239], v[56:59]
    ds_read_b64_tr_b16 a[20:21], v5 offset:43520
    v_add_u32 v41, s48, v41
    v_mfma_f32_16x16x32_bf16 v[60:63], a[136:139], v[236:239], v[60:63]
    ds_read_b128 v[200:203], v129 offset:128
    v_mul_u32_u24 v20, s2, v39
    v_mfma_f32_16x16x32_bf16 v[64:67], a[140:143], v[236:239], v[64:67]
    ds_read_b64_tr_b16 a[22:23], v5 offset:44288
    v_lshlrev_b32 v38, 4, v38
    v_mfma_f32_16x16x32_bf16 v[68:71], a[108:111], v[240:243], v[68:71]
    ds_read_b64_tr_b16 a[24:25], v4 offset:49664
    v_mul_u32_u24 v19, 208, v41
    v_mfma_f32_16x16x32_bf16 v[72:75], a[112:115], v[240:243], v[72:75]
    ds_read_b128 v[204:207], v130 offset:0
    v_mul_u32_u24 v21, s2, v41
    v_mfma_f32_16x16x32_bf16 v[76:79], a[116:119], v[240:243], v[76:79]
    ds_read_b64_tr_b16 a[26:27], v4 offset:50432
    v_lshlrev_b32 v40, 3, v40
    v_mfma_f32_16x16x32_bf16 v[76:79], a[128:131], v[244:247], v[76:79]
    ds_read_b64_tr_b16 a[28:29], v4 offset:49696
    v_add3_u32 v18, v18, s47, v38
    v_mfma_f32_16x16x32_bf16 v[72:75], a[124:127], v[244:247], v[72:75]
    ds_read_b128 v[208:211], v130 offset:64
    v_add_u32 v20, v20, v38
    v_mfma_f32_16x16x32_bf16 v[68:71], a[120:123], v[244:247], v[68:71]
    ds_read_b64_tr_b16 a[30:31], v4 offset:50464
    v_add3_u32 v19, v19, s47, v40
    s_waitcnt lgkmcnt(7)
    v_mfma_f32_16x16x32_bf16 v[68:71], a[132:135], v[248:251], v[68:71]
    ds_read_b64_tr_b16 a[32:33], v5 offset:49728
    ds_read_b64_tr_b16 a[34:35], v5 offset:50496
    v_mfma_f32_16x16x32_bf16 v[72:75], a[136:139], v[248:251], v[72:75]
    ds_read_b128 v[212:215], v130 offset:128
    v_mfma_f32_16x16x32_bf16 v[76:79], a[140:143], v[248:251], v[76:79]
    v_add_u32 v21, v21, v40
    v_bfe_u32 v38, v6, 4, 2
    v_mfma_f32_16x16x32_bf16 v[44:47], a[0:3], v[180:183], v[44:47]
    v_bfe_u32 v39, v6, 6, 2
    v_lshl_add_u32 v38, v38, 2, v39
    v_mfma_f32_16x16x32_bf16 v[48:51], a[4:7], v[180:183], v[48:51]
    v_lshrrev_b32 v39, 8, v6
    v_mfma_f32_16x16x32_bf16 v[52:55], a[8:11], v[180:183], v[52:55]
    v_mul_u32_u24 v38, 208, v38
    s_waitcnt lgkmcnt(7)
    v_mfma_f32_16x16x32_bf16 v[52:55], a[20:23], v[184:187], v[52:55]
    s_lshl4_add_u32 s49, s48, s47
    v_mfma_f32_16x16x32_bf16 v[48:51], a[16:19], v[184:187], v[48:51]
    v_lshl_add_u32 v38, v39, 3, v38
    v_mfma_f32_16x16x32_bf16 v[44:47], a[12:15], v[184:187], v[44:47]
    s_lshl2_add_u32 s48, s48, s47
    s_waitcnt lgkmcnt(6)
    v_mfma_f32_16x16x32_bf16 v[44:47], a[24:27], v[188:191], v[44:47]
    v_add_u32 v16, s49, v38
    s_waitcnt lgkmcnt(3)
    v_mfma_f32_16x16x32_bf16 v[48:51], a[28:31], v[188:191], v[48:51]
    v_add_u32 v17, s48, v38
    s_waitcnt lgkmcnt(1)
    v_mfma_f32_16x16x32_bf16 v[52:55], a[32:35], v[188:191], v[52:55]
    v_mfma_f32_16x16x32_bf16 v[56:59], a[0:3], v[192:195], v[56:59]
    v_mfma_f32_16x16x32_bf16 v[60:63], a[4:7], v[192:195], v[60:63]
    v_mfma_f32_16x16x32_bf16 v[64:67], a[8:11], v[192:195], v[64:67]
    v_mfma_f32_16x16x32_bf16 v[64:67], a[20:23], v[196:199], v[64:67]
    v_cvt_pk_bf16_f32 v32, v44, v45
    v_cvt_pk_bf16_f32 v33, v46, v47
    v_mfma_f32_16x16x32_bf16 v[60:63], a[16:19], v[196:199], v[60:63]
    v_cvt_pk_bf16_f32 v34, v48, v49
    v_cvt_pk_bf16_f32 v35, v50, v51
    v_mfma_f32_16x16x32_bf16 v[56:59], a[12:15], v[196:199], v[56:59]
    v_cvt_pk_bf16_f32 v36, v52, v53
    v_cvt_pk_bf16_f32 v37, v54, v55
    v_mfma_f32_16x16x32_bf16 v[56:59], a[24:27], v[200:203], v[56:59]
    ds_write_b64 v16, v[32:33] offset:0
    v_mfma_f32_16x16x32_bf16 v[60:63], a[28:31], v[200:203], v[60:63]
    ds_write_b64 v16, v[34:35] offset:32
    v_mfma_f32_16x16x32_bf16 v[64:67], a[32:35], v[200:203], v[64:67]
    ds_write_b64 v17, v[36:37] offset:64
    v_mfma_f32_16x16x32_bf16 v[68:71], a[0:3], v[204:207], v[68:71]
    v_mfma_f32_16x16x32_bf16 v[72:75], a[4:7], v[204:207], v[72:75]
    s_waitcnt lgkmcnt(0)
    s_barrier
    ds_read_b128 v[38:41], v18 offset:0
    v_mfma_f32_16x16x32_bf16 v[76:79], a[8:11], v[204:207], v[76:79]
    ds_read_b64 v[42:43], v19 offset:0
    v_mfma_f32_16x16x32_bf16 v[76:79], a[20:23], v[208:211], v[76:79]
    v_cvt_pk_bf16_f32 v32, v56, v57
    v_cvt_pk_bf16_f32 v33, v58, v59
    v_mfma_f32_16x16x32_bf16 v[72:75], a[16:19], v[208:211], v[72:75]
    v_cvt_pk_bf16_f32 v34, v60, v61
    v_cvt_pk_bf16_f32 v35, v62, v63
    v_mfma_f32_16x16x32_bf16 v[68:71], a[12:15], v[208:211], v[68:71]
    v_cvt_pk_bf16_f32 v36, v64, v65
    v_cvt_pk_bf16_f32 v37, v66, v67
    v_mfma_f32_16x16x32_bf16 v[68:71], a[24:27], v[212:215], v[68:71]
    ds_write_b64 v16, v[32:33] offset:3328
    v_mfma_f32_16x16x32_bf16 v[72:75], a[28:31], v[212:215], v[72:75]
    ds_write_b64 v16, v[34:35] offset:3360
    v_mfma_f32_16x16x32_bf16 v[76:79], a[32:35], v[212:215], v[76:79]
    ds_write_b64 v17, v[36:37] offset:3392
    s_waitcnt lgkmcnt(4)
    buffer_store_dwordx4 v[38:41], v20, s[16:19], s31 offen sc1
    s_waitcnt lgkmcnt(3)
    buffer_store_dwordx2 v[42:43], v21, s[16:19], s31 offen sc1
    s_add_u32 s31, s31, s55
    s_waitcnt lgkmcnt(0)
    s_barrier
    ds_read_b128 v[24:27], v18 offset:3328
    ds_read_b64 v[28:29], v19 offset:3328
    v_cvt_pk_bf16_f32 v32, v68, v69
    v_cvt_pk_bf16_f32 v33, v70, v71
    v_cvt_pk_bf16_f32 v34, v72, v73
    v_cvt_pk_bf16_f32 v35, v74, v75
    ds_write_b64 v16, v[32:33] offset:0
    s_waitcnt lgkmcnt(2)
    buffer_store_dwordx4 v[24:27], v20, s[16:19], s31 offen sc1
    s_waitcnt lgkmcnt(1)
    buffer_store_dwordx2 v[28:29], v21, s[16:19], s31 offen sc1
    s_add_u32 s31, s31, s55
    s_cmp_lg_u32 s54, 0
    v_cvt_pk_bf16_f32 v36, v76, v77
    v_cvt_pk_bf16_f32 v37, v78, v79
    ds_write_b64 v16, v[34:35] offset:32
    ds_write_b64 v17, v[36:37] offset:64
    s_waitcnt lgkmcnt(0)
    s_barrier
    ds_read_b128 v[38:41], v18 offset:0
    ds_read_b64 v[42:43], v19 offset:0
    s_waitcnt lgkmcnt(1)
    buffer_store_dwordx4 v[38:41], v20, s[16:19], s31 offen sc1
    s_waitcnt lgkmcnt(0)
    buffer_store_dwordx2 v[42:43], v21, s[16:19], s31 offen sc1
    s_cbranch_scc1 L_gS
    s_endpgm
L_cold:
L_gW:
    s_waitcnt vmcnt(0) lgkmcnt(0)
    v_mbcnt_lo_u32_b32 v16, -1, 0
    v_mbcnt_hi_u32_b32 v16, -1, v16
    v_lshlrev_b32 v6, 4, v16
    v_lshrrev_b32 v17, 4, v16
    v_and_b32 v16, 15, v16
    v_and_b32 v4, 1, v17
    v_mul_u32_u24 v4, 3104, v4
    v_lshrrev_b32 v5, 1, v17
    v_lshlrev_b32 v5, 3, v5
    v_lshrrev_b32 v12, 2, v16
    v_add_u32 v5, v5, v12
    v_mul_u32_u24 v5, 192, v5
    v_and_b32 v12, 3, v16
    v_lshl_add_u32 v4, v12, 3, v4
    v_add_u32 v4, v4, v5
    s_mul_i32 s44, s28, 18624
    s_lshl_b32 s48, s29, 5
    s_add_u32 s48, s48, s44
    v_add_u32 v5, s48, v4
    s_lshl_b32 s48, s29, 7
    s_add_u32 s48, s48, s44
    v_add_u32 v4, s48, v4
    s_mov_b32 s46, 0
    s_call_b64 s[52:53], L_gD
    ds_read_b64_tr_b16 a[0:1], v4 offset:0
    ds_read_b64_tr_b16 a[2:3], v4 offset:768
    ds_read_b64_tr_b16 a[4:5], v4 offset:32
    ds_read_b64_tr_b16 a[6:7], v4 offset:800
    ds_read_b64_tr_b16 a[8:9], v5 offset:64
    ds_read_b64_tr_b16 a[10:11], v5 offset:832
    ds_read_b64_tr_b16 a[12:13], v4 offset:6208
    ds_read_b64_tr_b16 a[14:15], v4 offset:6976
    ds_read_b64_tr_b16 a[16:17], v4 offset:6240
    ds_read_b64_tr_b16 a[18:19], v4 offset:7008
    ds_read_b64_tr_b16 a[20:21], v5 offset:6272
    ds_read_b64_tr_b16 a[22:23], v5 offset:7040
    ds_read_b64_tr_b16 a[24:25], v4 offset:12416
    ds_read_b64_tr_b16 a[26:27], v4 offset:13184
    ds_read_b64_tr_b16 a[28:29], v4 offset:12448
    ds_read_b64_tr_b16 a[30:31], v4 offset:13216
    ds_read_b64_tr_b16 a[32:33], v5 offset:12480
    ds_read_b64_tr_b16 a[34:35], v5 offset:13248
    s_call_b64 s[52:53], L_gD
    ds_read_b64_tr_b16 a[36:37], v4 offset:0
    ds_read_b64_tr_b16 a[38:39], v4 offset:768
    ds_read_b64_tr_b16 a[40:41], v4 offset:32
    ds_read_b64_tr_b16 a[42:43], v4 offset:800
    ds_read_b64_tr_b16 a[44:45], v5 offset:64
    ds_read_b64_tr_b16 a[46:47], v5 offset:832
    ds_read_b64_tr_b16 a[48:49], v4 offset:6208
    ds_read_b64_tr_b16 a[50:51], v4 offset:6976
    ds_read_b64_tr_b16 a[52:53], v4 offset:6240
    ds_read_b64_tr_b16 a[54:55], v4 offset:7008
    ds_read_b64_tr_b16 a[56:57], v5 offset:6272
    ds_read_b64_tr_b16 a[58:59], v5 offset:7040
    ds_read_b64_tr_b16 a[60:61], v4 offset:12416
    ds_read_b64_tr_b16 a[62:63], v4 offset:13184
    ds_read_b64_tr_b16 a[64:65], v4 offset:12448
    ds_read_b64_tr_b16 a[66:67], v4 offset:13216
    ds_read_b64_tr_b16 a[68:69], v5 offset:12480
    ds_read_b64_tr_b16 a[70:71], v5 offset:13248
    s_call_b64 s[52:53], L_gD
    ds_read_b64_tr_b16 a[72:73], v4 offset:0
    ds_read_b64_tr_b16 a[74:75], v4 offset:768
    ds_read_b64_tr_b16 a[76:77], v4 offset:32
    ds_read_b64_tr_b16 a[78:79], v4 offset:800
    ds_read_b64_tr_b16 a[80:81], v5 offset:64
    ds_read_b64_tr_b16 a[82:83], v5 offset:832
    ds_read_b64_tr_b16 a[84:85], v4 offset:6208
    ds_read_b64_tr_b16 a[86:87], v4 offset:6976
    ds_read_b64_tr_b16 a[88:89], v4 offset:6240
    ds_read_b64_tr_b16 a[90:91], v4 offset:7008
    ds_read_b64_tr_b16 a[92:93], v5 offset:6272
    ds_read_b64_tr_b16 a[94:95], v5 offset:7040
    ds_read_b64_tr_b16 a[96:97], v4 offset:12416
    ds_read_b64_tr_b16 a[98:99], v4 offset:13184
    ds_read_b64_tr_b16 a[100:101], v4 offset:12448
    ds_read_b64_tr_b16 a[102:103], v4 offset:13216
    ds_read_b64_tr_b16 a[104:105], v5 offset:12480
    ds_read_b64_tr_b16 a[106:107], v5 offset:13248
    s_call_b64 s[52:53], L_gD
    ds_read_b64_tr_b16 a[108:109], v4 offset:0
    ds_read_b64_tr_b16 a[110:111], v4 offset:768
    ds_read_b64_tr_b16 a[112:113], v4 offset:32
    ds_read_b64_tr_b16 a[114:115], v4 offset:800
    ds_read_b64_tr_b16 a[116:117], v5 offset:64
    ds_read_b64_tr_b16 a[118:119], v5 offset:832
    ds_read_b64_tr_b16 a[120:121], v4 offset:6208
    ds_read_b64_tr_b16 a[122:123], v4 offset:6976
    ds_read_b64_tr_b16 a[124:125], v4 offset:6240
    ds_read_b64_tr_b16 a[126:127], v4 offset:7008
    ds_read_b64_tr_b16 a[128:129], v5 offset:6272
    ds_read_b64_tr_b16 a[130:131], v5 offset:7040
    ds_read_b64_tr_b16 a[132:133], v4 offset:12416
    ds_read_b64_tr_b16 a[134:135], v4 offset:13184
    ds_read_b64_tr_b16 a[136:137], v4 offset:12448
    ds_read_b64_tr_b16 a[138:139], v4 offset:13216
    ds_read_b64_tr_b16 a[140:141], v5 offset:12480
    ds_read_b64_tr_b16 a[142:143], v5 offset:13248
    s_call_b64 s[52:53], L_gD
    ds_read_b64_tr_b16 a[144:145], v4 offset:0
    ds_read_b64_tr_b16 a[146:147], v4 offset:768
    ds_read_b64_tr_b16 a[148:149], v4 offset:32
    ds_read_b64_tr_b16 a[150:151], v4 offset:800
    ds_read_b64_tr_b16 a[152:153], v5 offset:64
    ds_read_b64_tr_b16 a[154:155], v5 offset:832
    ds_read_b64_tr_b16 a[156:157], v4 offset:6208
    ds_read_b64_tr_b16 a[158:159], v4 offset:6976
    ds_read_b64_tr_b16 a[160:161], v4 offset:6240
    ds_read_b64_tr_b16 a[162:163], v4 offset:7008
    ds_read_b64_tr_b16 a[164:165], v5 offset:6272
    ds_read_b64_tr_b16 a[166:167], v5 offset:7040
    ds_read_b64_tr_b16 a[168:169], v4 offset:12416
    ds_read_b64_tr_b16 a[170:171], v4 offset:13184
    ds_read_b64_tr_b16 a[172:173], v4 offset:12448
    ds_read_b64_tr_b16 a[174:175], v4 offset:13216
    ds_read_b64_tr_b16 a[176:177], v5 offset:12480
    ds_read_b64_tr_b16 a[178:179], v5 offset:13248
    s_call_b64 s[52:53], L_gD
    ds_read_b64_tr_b16 a[180:181], v4 offset:0
    ds_read_b64_tr_b16 a[182:183], v4 offset:768
    ds_read_b64_tr_b16 a[184:185], v4 offset:32
    ds_read_b64_tr_b16 a[186:187], v4 offset:800
    ds_read_b64_tr_b16 a[188:189], v5 offset:64
    ds_read_b64_tr_b16 a[190:191], v5 offset:832
    ds_read_b64_tr_b16 a[192:193], v4 offset:6208
    ds_read_b64_tr_b16 a[194:195], v4 offset:6976
    ds_read_b64_tr_b16 a[196:197], v4 offset:6240
    ds_read_b64_tr_b16 a[198:199], v4 offset:7008
    ds_read_b64_tr_b16 a[200:201], v5 offset:6272
    ds_read_b64_tr_b16 a[202:203], v5 offset:7040
    ds_read_b64_tr_b16 a[204:205], v4 offset:12416
    ds_read_b64_tr_b16 a[206:207], v4 offset:13184
    ds_read_b64_tr_b16 a[208:209], v4 offset:12448
    ds_read_b64_tr_b16 a[210:211], v4 offset:13216
    ds_read_b64_tr_b16 a[212:213], v5 offset:12480
    ds_read_b64_tr_b16 a[214:215], v5 offset:13248
    s_call_b64 s[52:53], L_gD
    ds_read_b64_tr_b16 a[216:217], v4 offset:0
    ds_read_b64_tr_b16 a[218:219], v4 offset:768
    ds_read_b64_tr_b16 a[220:221], v4 offset:32
    ds_read_b64_tr_b16 a[222:223], v4 offset:800
    ds_read_b64_tr_b16 a[224:225], v5 offset:64
    ds_read_b64_tr_b16 a[226:227], v5 offset:832
    ds_read_b64_tr_b16 a[228:229], v4 offset:6208
    ds_read_b64_tr_b16 a[230:231], v4 offset:6976
    ds_read_b64_tr_b16 a[232:233], v4 offset:6240
    ds_read_b64_tr_b16 a[234:235], v4 offset:7008
    ds_read_b64_tr_b16 a[236:237], v5 offset:6272
    ds_read_b64_tr_b16 a[238:239], v5 offset:7040
    ds_read_b64_tr_b16 a[240:241], v4 offset:12416
    ds_read_b64_tr_b16 a[242:243], v4 offset:13184
    ds_read_b64_tr_b16 a[244:245], v4 offset:12448
    ds_read_b64_tr_b16 a[246:247], v4 offset:13216
    ds_read_b64_tr_b16 a[248:249], v5 offset:12480
    ds_read_b64_tr_b16 a[250:251], v5 offset:13248
    s_call_b64 s[52:53], L_gD
    ds_read_b64_tr_b16 a[252:253], v4 offset:0
    ds_read_b64_tr_b16 a[254:255], v4 offset:768
    ds_read_b64_tr_b16 v[188:189], v4 offset:32
    ds_read_b64_tr_b16 v[190:191], v4 offset:800
    ds_read_b64_tr_b16 v[192:193], v5 offset:64
    ds_read_b64_tr_b16 v[194:195], v5 offset:832
    ds_read_b64_tr_b16 v[196:197], v4 offset:6208
    ds_read_b64_tr_b16 v[198:199], v4 offset:6976
    ds_read_b64_tr_b16 v[200:201], v4 offset:6240
    ds_read_b64_tr_b16 v[202:203], v4 offset:7008
    ds_read_b64_tr_b16 v[204:205], v5 offset:6272
    ds_read_b64_tr_b16 v[206:207], v5 offset:7040
    ds_read_b64_tr_b16 v[208:209], v4 offset:12416
    ds_read_b64_tr_b16 v[210:211], v4 offset:13184
    ds_read_b64_tr_b16 v[212:213], v4 offset:12448
    ds_read_b64_tr_b16 v[214:215], v4 offset:13216
    ds_read_b64_tr_b16 v[216:217], v5 offset:12480
    ds_read_b64_tr_b16 v[218:219], v5 offset:13248
    s_call_b64 s[52:53], L_gD
    ds_read_b64_tr_b16 v[220:221], v4 offset:0
    ds_read_b64_tr_b16 v[222:223], v4 offset:768
    ds_read_b64_tr_b16 v[224:225], v4 offset:32
    ds_read_b64_tr_b16 v[226:227], v4 offset:800
    ds_read_b64_tr_b16 v[228:229], v5 offset:64
    ds_read_b64_tr_b16 v[230:231], v5 offset:832
    ds_read_b64_tr_b16 v[232:233], v4 offset:6208
    ds_read_b64_tr_b16 v[234:235], v4 offset:6976
    ds_read_b64_tr_b16 v[236:237], v4 offset:6240
    ds_read_b64_tr_b16 v[238:239], v4 offset:7008
    ds_read_b64_tr_b16 v[240:241], v5 offset:6272
    ds_read_b64_tr_b16 v[242:243], v5 offset:7040
    ds_read_b64_tr_b16 v[244:245], v4 offset:12416
    ds_read_b64_tr_b16 v[246:247], v4 offset:13184
    ds_read_b64_tr_b16 v[248:249], v4 offset:12448
    ds_read_b64_tr_b16 v[250:251], v4 offset:13216
    ds_read_b64_tr_b16 v[252:253], v5 offset:12480
    ds_read_b64_tr_b16 v[254:255], v5 offset:13248
    s_branch L_g0
L_gD:
    s_waitcnt lgkmcnt(0)
    s_add_u32 m0, s44, 0
    s_nop 0
    buffer_load_dwordx4 v6, s[12:15], s46 offen offset:0 lds
    buffer_load_dwordx4 v6, s[12:15], s46 offen offset:1024 lds
    buffer_load_dwordx4 v6, s[12:15], s46 offen offset:2048 lds
    s_add_u32 s46, s46, 3072
    s_add_u32 m0, s44, 3104
    s_nop 0
    buffer_load_dwordx4 v6, s[12:15], s46 offen offset:0 lds
    buffer_load_dwordx4 v6, s[12:15], s46 offen offset:1024 lds
    buffer_load_dwordx4 v6, s[12:15], s46 offen offset:2048 lds
    s_add_u32 s46, s46, 3072
    s_add_u32 m0, s44, 6208
    s_nop 0
    buffer_load_dwordx4 v6, s[12:15], s46 offen offset:0 lds
    buffer_load_dwordx4 v6, s[12:15], s46 offen offset:1024 lds
    buffer_load_dwordx4 v6, s[12:15], s46 offen offset:2048 lds
    s_add_u32 s46, s46, 3072
    s_add_u32 m0, s44, 9312
    s_nop 0
    buffer_load_dwordx4 v6, s[12:15], s46 offen offset:0 lds
    buffer_load_dwordx4 v6, s[12:15], s46 offen offset:1024 lds
    buffer_load_dwordx4 v6, s[12:15], s46 offen offset:2048 lds
    s_add_u32 s46, s46, 3072
    s_add_u32 m0, s44, 12416
    s_nop 0
    buffer_load_dwordx4 v6, s[12:15], s46 offen offset:0 lds
    buffer_load_dwordx4 v6, s[12:15], s46 offen offset:1024 lds
    buffer_load_dwordx4 v6, s[12:15], s46 offen offset:2048 lds
    s_add_u32 s46, s46, 3072
    s_add_u32 m0, s44, 15520
    s_nop 0
    buffer_load_dwordx4 v6, s[12:15], s46 offen offset:0 lds
    buffer_load_dwordx4 v6, s[12:15], s46 offen offset:1024 lds
    buffer_load_dwordx4 v6, s[12:15], s46 offen offset:2048 lds
    s_add_u32 s46, s46, 3072
    s_waitcnt vmcnt(0)
    s_setpc_b64 s[52:53]
L_gN:
    s_waitcnt vmcnt(0)
    s_barrier
    s_movk_i32 s54, 0x7f
L_g0:
    v_mbcnt_lo_u32_b32 v16, -1, 0
    v_mbcnt_hi_u32_b32 v16, -1, v16
    v_lshlrev_b32 v6, 4, v16
    v_lshrrev_b32 v17, 4, v16
    v_and_b32 v16, 15, v16
    s_bfe_u32 s56, s23, 0x10010
    s_and_b32 s59, s23, 0xff
    s_bfe_u32 s58, s23, 0x80008
    s_and_b32 s47, s22, 15
    s_bfe_u32 s57, s22, 0x40004
    s_bfe_u32 s64, s23, 0x10011
    s_cselect_b32 s48, 1, s47
    s_cselect_b32 s65, 2.0, 1.0
    s_cmp_eq_u32 s30, 0
    s_cselect_b32 s57, s47, s57
    s_cselect_b32 s47, 0, s48
    s_cselect_b32 s31, s26, s27
    s_add_u32 s58, s58, s47
    v_add_u32 v32, s59, v16
    v_mov_b32 v33, s58
    v_cvt_f32_u32 v32, v32
    v_cvt_f32_u32 v33, v33
    s_cmp_eq_u32 s56, 0
    s_cselect_b32 s60, 224, 1
    s_cselect_b32 s61, 1, 224
    s_cselect_b32 s62, s65, 0
    s_cselect_b32 s63, 0, s65
    s_cselect_b64 vcc, -1, 0
    s_lshl_b32 s60, s60, s64
    v_cndmask_b32 v19, v32, v33, vcc
    v_cndmask_b32 v20, v33, v32, vcc
    v_mul_u32_u24 v32, s61, v16
    v_mul_u32_u24 v21, 36, v32
    v_mul_u32_u24 v32, 192, v32
    v_and_b32 v18, 1, v17
    v_lshrrev_b32 v33, 1, v17
    v_lshl_add_u32 v18, v18, 1, v33
    v_lshlrev_b32 v22, 4, v18
    s_lshl_b32 s48, s29, 7
    v_add3_u32 v9, v32, s48, v22
    s_lshl_b32 s48, s29, 5
    s_add_u32 s48, s48, 64
    v_lshlrev_b32 v33, 3, v17
    v_add3_u32 v10, v32, s48, v33
    s_mul_i32 s32, s31, 3
    s_lshr_b32 s32, s32, 4
    s_mov_b32 s65, 0x435f435f
    s_bfm_b32 s47, s57, 0
    s_bitset1_b32 s47, 31
    s_and_b32 s54, s54, s47
L_gt:
    s_and_b32 s47, s54, 0xff
    s_cbranch_scc0 L_end
    s_bitcmp1_b32 s54, 0
    s_cbranch_scc0 L_gn
    buffer_load_dwordx4 v[24:27], v21, s[8:11], s32 offen offset:4
    buffer_load_dwordx4 v[28:31], v21, s[8:11], s32 offen offset:20
    buffer_load_dword v23, v21, s[8:11], s32 offen
    s_lshr_b32 s66, s54, 31
    s_mov_b32 s67, 0
    s_mov_b32 s64, 0
    s_waitcnt vmcnt(0) lgkmcnt(0)
    v_add_f32 v34, -1.0, v19
    v_add_f32 v35, -1.0, v20
    v_lshlrev_b32 v32, 16, v23
    v_and_b32 v33, 0xffff0000, v23
    v_add_f32 v32, v32, v34
    v_add_f32 v33, v33, v35
    v_cvt_pk_bf16_f32 v34, v34, v35
    v_cvt_pk_bf16_f32 v23, v32, v33
    v_cmp_ne_u32 vcc, v34, v23
    v_pk_max_i16 v23, v23, 0
    v_pk_min_i16 v23, v23, s65
    s_or_b64 s[66:67], s[66:67], vcc
    v_add_f32 v34, -1.0, v19
    v_add_f32 v35, 0.0, v20
    v_lshlrev_b32 v32, 16, v24
    v_and_b32 v33, 0xffff0000, v24
    v_add_f32 v32, v32, v34
    v_add_f32 v33, v33, v35
    v_cvt_pk_bf16_f32 v34, v34, v35
    v_cvt_pk_bf16_f32 v24, v32, v33
    v_cmp_ne_u32 vcc, v34, v24
    v_pk_max_i16 v24, v24, 0
    v_pk_min_i16 v24, v24, s65
    s_or_b64 s[66:67], s[66:67], vcc
    v_add_f32 v34, -1.0, v19
    v_add_f32 v35, 1.0, v20
    v_lshlrev_b32 v32, 16, v25
    v_and_b32 v33, 0xffff0000, v25
    v_add_f32 v32, v32, v34
    v_add_f32 v33, v33, v35
    v_cvt_pk_bf16_f32 v34, v34, v35
    v_cvt_pk_bf16_f32 v25, v32, v33
    v_cmp_ne_u32 vcc, v34, v25
    v_pk_max_i16 v25, v25, 0
    v_pk_min_i16 v25, v25, s65
    s_or_b64 s[66:67], s[66:67], vcc
    v_add_f32 v34, 0.0, v19
    v_add_f32 v35, -1.0, v20
    v_lshlrev_b32 v32, 16, v26
    v_and_b32 v33, 0xffff0000, v26
    v_add_f32 v32, v32, v34
    v_add_f32 v33, v33, v35
    v_cvt_pk_bf16_f32 v34, v34, v35
    v_cvt_pk_bf16_f32 v26, v32, v33
    v_cmp_ne_u32 vcc, v34, v26
    v_pk_max_i16 v26, v26, 0
    v_pk_min_i16 v26, v26, s65
    s_or_b64 s[66:67], s[66:67], vcc
    v_add_f32 v34, 0.0, v19
    v_add_f32 v35, 0.0, v20
    v_lshlrev_b32 v32, 16, v27
    v_and_b32 v33, 0xffff0000, v27
    v_add_f32 v32, v32, v34
    v_add_f32 v33, v33, v35
    v_cvt_pk_bf16_f32 v34, v34, v35
    v_cvt_pk_bf16_f32 v27, v32, v33
    v_cmp_ne_u32 vcc, v34, v27
    v_pk_max_i16 v27, v27, 0
    v_pk_min_i16 v27, v27, s65
    s_or_b64 s[66:67], s[66:67], vcc
    v_add_f32 v34, 0.0, v19
    v_add_f32 v35, 1.0, v20
    v_lshlrev_b32 v32, 16, v28
    v_and_b32 v33, 0xffff0000, v28
    v_add_f32 v32, v32, v34
    v_add_f32 v33, v33, v35
    v_cvt_pk_bf16_f32 v34, v34, v35
    v_cvt_pk_bf16_f32 v28, v32, v33
    v_cmp_ne_u32 vcc, v34, v28
    v_pk_max_i16 v28, v28, 0
    v_pk_min_i16 v28, v28, s65
    s_or_b64 s[66:67], s[66:67], vcc
    v_add_f32 v34, 1.0, v19
    v_add_f32 v35, -1.0, v20
    v_lshlrev_b32 v32, 16, v29
    v_and_b32 v33, 0xffff0000, v29
    v_add_f32 v32, v32, v34
    v_add_f32 v33, v33, v35
    v_cvt_pk_bf16_f32 v34, v34, v35
    v_cvt_pk_bf16_f32 v29, v32, v33
    v_cmp_ne_u32 vcc, v34, v29
    v_pk_max_i16 v29, v29, 0
    v_pk_min_i16 v29, v29, s65
    s_or_b64 s[66:67], s[66:67], vcc
    v_add_f32 v34, 1.0, v19
    v_add_f32 v35, 0.0, v20
    v_lshlrev_b32 v32, 16, v30
    v_and_b32 v33, 0xffff0000, v30
    v_add_f32 v32, v32, v34
    v_add_f32 v33, v33, v35
    v_cvt_pk_bf16_f32 v34, v34, v35
    v_cvt_pk_bf16_f32 v30, v32, v33
    v_cmp_ne_u32 vcc, v34, v30
    v_pk_max_i16 v30, v30, 0
    v_pk_min_i16 v30, v30, s65
    s_or_b64 s[66:67], s[66:67], vcc
    v_add_f32 v34, 1.0, v19
    v_add_f32 v35, 1.0, v20
    v_lshlrev_b32 v32, 16, v31
    v_and_b32 v33, 0xffff0000, v31
    v_add_f32 v32, v32, v34
    v_add_f32 v33, v33, v35
    v_cvt_pk_bf16_f32 v34, v34, v35
    v_cvt_pk_bf16_f32 v31, v32, v33
    v_cmp_ne_u32 vcc, v34, v31
    v_pk_max_i16 v31, v31, 0
    v_pk_min_i16 v31, v31, s65
    s_or_b64 s[66:67], s[66:67], vcc
    s_cbranch_scc0 L_gn
    s_movk_i32 s49, 224
    v_lshlrev_b32 v32, 16, v31
    v_and_b32 v33, 0xffff0000, v31
    v_fract_f32 v36, v32
    v_fract_f32 v37, v33
    v_cvt_u32_f32 v32, v32
    v_cvt_u32_f32 v33, v33
    v_mad_u32_u24 v40, v32, s49, v33
    v_mul_u32_u24 v40, 192, v40
    v_add_u32 v40, v40, v22
    v_or_b32 v36, v36, v37
    v_cmp_ne_u32 vcc, 0, v36
    buffer_load_dwordx4 v[176:179], v40, s[4:7], 0 offen offset:0
    buffer_load_dwordx4 v[180:183], v40, s[4:7], 0 offen offset:64
    buffer_load_dwordx4 v[184:187], v40, s[4:7], 0 offen offset:128
    s_cmp_lg_u64 vcc, 0
    s_addc_u32 s64, s64, s64
    v_lshlrev_b32 v32, 16, v30
    v_and_b32 v33, 0xffff0000, v30
    v_fract_f32 v36, v32
    v_fract_f32 v37, v33
    v_cvt_u32_f32 v32, v32
    v_cvt_u32_f32 v33, v33
    v_mad_u32_u24 v40, v32, s49, v33
    v_mul_u32_u24 v40, 192, v40
    v_add_u32 v40, v40, v22
    v_or_b32 v36, v36, v37
    v_cmp_ne_u32 vcc, 0, v36
    buffer_load_dwordx4 v[164:167], v40, s[4:7], 0 offen offset:0
    buffer_load_dwordx4 v[168:171], v40, s[4:7], 0 offen offset:64
    buffer_load_dwordx4 v[172:175], v40, s[4:7], 0 offen offset:128
    s_cmp_lg_u64 vcc, 0
    s_addc_u32 s64, s64, s64
    v_lshlrev_b32 v32, 16, v29
    v_and_b32 v33, 0xffff0000, v29
    v_fract_f32 v36, v32
    v_fract_f32 v37, v33
    v_cvt_u32_f32 v32, v32
    v_cvt_u32_f32 v33, v33
    v_mad_u32_u24 v40, v32, s49, v33
    v_mul_u32_u24 v40, 192, v40
    v_add_u32 v40, v40, v22
    v_or_b32 v36, v36, v37
    v_cmp_ne_u32 vcc, 0, v36
    buffer_load_dwordx4 v[152:155], v40, s[4:7], 0 offen offset:0
    buffer_load_dwordx4 v[156:159], v40, s[4:7], 0 offen offset:64
    buffer_load_dwordx4 v[160:163], v40, s[4:7], 0 offen offset:128
    s_cmp_lg_u64 vcc, 0
    s_addc_u32 s64, s64, s64
    v_lshlrev_b32 v32, 16, v28
    v_and_b32 v33, 0xffff0000, v28
    v_fract_f32 v36, v32
    v_fract_f32 v37, v33
    v_cvt_u32_f32 v32, v32
    v_cvt_u32_f32 v33, v33
    v_mad_u32_u24 v40, v32, s49, v33
    v_mul_u32_u24 v40, 192, v40
    v_add_u32 v40, v40, v22
    v_or_b32 v36, v36, v37
    v_cmp_ne_u32 vcc, 0, v36
    buffer_load_dwordx4 v[140:143], v40, s[4:7], 0 offen offset:0
    buffer_load_dwordx4 v[144:147], v40, s[4:7], 0 offen offset:64
    buffer_load_dwordx4 v[148:151], v40, s[4:7], 0 offen offset:128
    s_cmp_lg_u64 vcc, 0
    s_addc_u32 s64, s64, s64
    v_lshlrev_b32 v32, 16, v27
    v_and_b32 v33, 0xffff0000, v27
    v_fract_f32 v36, v32
    v_fract_f32 v37, v33
    v_cvt_u32_f32 v32, v32
    v_cvt_u32_f32 v33, v33
    v_mad_u32_u24 v40, v32, s49, v33
    v_mul_u32_u24 v40, 192, v40
    v_add_u32 v40, v40, v22
    v_or_b32 v36, v36, v37
    v_cmp_ne_u32 vcc, 0, v36
    buffer_load_dwordx4 v[128:131], v40, s[4:7], 0 offen offset:0
    buffer_load_dwordx4 v[132:135], v40, s[4:7], 0 offen offset:64
    buffer_load_dwordx4 v[136:139], v40, s[4:7], 0 offen offset:128
    s_cmp_lg_u64 vcc, 0
    s_addc_u32 s64, s64, s64
    v_lshlrev_b32 v32, 16, v26
    v_and_b32 v33, 0xffff0000, v26
    v_fract_f32 v36, v32
    v_fract_f32 v37, v33
    v_cvt_u32_f32 v32, v32
    v_cvt_u32_f32 v33, v33
    v_mad_u32_u24 v40, v32, s49, v33
    v_mul_u32_u24 v40, 192, v40
    v_add_u32 v40, v40, v22
    v_or_b32 v36, v36, v37
    v_cmp_ne_u32 vcc, 0, v36
    buffer_load_dwordx4 v[116:119], v40, s[4:7], 0 offen offset:0
    buffer_load_dwordx4 v[120:123], v40, s[4:7], 0 offen offset:64
    buffer_load_dwordx4 v[124:127], v40, s[4:7], 0 offen offset:128
    s_cmp_lg_u64 vcc, 0
    s_addc_u32 s64, s64, s64
    v_lshlrev_b32 v32, 16, v25
    v_and_b32 v33, 0xffff0000, v25
    v_fract_f32 v36, v32
    v_fract_f32 v37, v33
    v_cvt_u32_f32 v32, v32
    v_cvt_u32_f32 v33, v33
    v_mad_u32_u24 v40, v32, s49, v33
    v_mul_u32_u24 v40, 192, v40
    v_add_u32 v40, v40, v22
    v_or_b32 v36, v36, v37
    v_cmp_ne_u32 vcc, 0, v36
    buffer_load_dwordx4 v[104:107], v40, s[4:7], 0 offen offset:0
    buffer_load_dwordx4 v[108:111], v40, s[4:7], 0 offen offset:64
    buffer_load_dwordx4 v[112:115], v40, s[4:7], 0 offen offset:128
    s_cmp_lg_u64 vcc, 0
    s_addc_u32 s64, s64, s64
    v_lshlrev_b32 v32, 16, v24
    v_and_b32 v33, 0xffff0000, v24
    v_fract_f32 v36, v32
    v_fract_f32 v37, v33
    v_cvt_u32_f32 v32, v32
    v_cvt_u32_f32 v33, v33
    v_mad_u32_u24 v40, v32, s49, v33
    v_mul_u32_u24 v40, 192, v40
    v_add_u32 v40, v40, v22
    v_or_b32 v36, v36, v37
    v_cmp_ne_u32 vcc, 0, v36
    buffer_load_dwordx4 v[92:95], v40, s[4:7], 0 offen offset:0
    buffer_load_dwordx4 v[96:99], v40, s[4:7], 0 offen offset:64
    buffer_load_dwordx4 v[100:103], v40, s[4:7], 0 offen offset:128
    s_cmp_lg_u64 vcc, 0
    s_addc_u32 s64, s64, s64
    v_lshlrev_b32 v32, 16, v23
    v_and_b32 v33, 0xffff0000, v23
    v_fract_f32 v36, v32
    v_fract_f32 v37, v33
    v_cvt_u32_f32 v32, v32
    v_cvt_u32_f32 v33, v33
    v_mad_u32_u24 v40, v32, s49, v33
    v_mul_u32_u24 v40, 192, v40
    v_add_u32 v40, v40, v22
    v_or_b32 v36, v36, v37
    v_cmp_ne_u32 vcc, 0, v36
    buffer_load_dwordx4 v[80:83], v40, s[4:7], 0 offen offset:0
    buffer_load_dwordx4 v[84:87], v40, s[4:7], 0 offen offset:64
    buffer_load_dwordx4 v[88:91], v40, s[4:7], 0 offen offset:128
    s_cmp_lg_u64 vcc, 0
    s_addc_u32 s64, s64, s64
    s_bitcmp1_b32 s64, 0
    s_cbranch_scc0 L_gs0
    v_mov_b32 v43, v23
    s_call_b64 s[52:53], L_gI
    v_cvt_pk_bf16_f32 v80, v44, v45
    v_cvt_pk_bf16_f32 v81, v46, v47
    v_cvt_pk_bf16_f32 v82, v48, v49
    v_cvt_pk_bf16_f32 v83, v50, v51
    v_cvt_pk_bf16_f32 v84, v52, v53
    v_cvt_pk_bf16_f32 v85, v54, v55
    v_cvt_pk_bf16_f32 v86, v56, v57
    v_cvt_pk_bf16_f32 v87, v58, v59
    v_cvt_pk_bf16_f32 v88, v60, v61
    v_cvt_pk_bf16_f32 v89, v62, v63
    v_cvt_pk_bf16_f32 v90, v64, v65
    v_cvt_pk_bf16_f32 v91, v66, v67
L_gs0:
    s_bitcmp1_b32 s64, 1
    s_cbranch_scc0 L_gs1
    v_mov_b32 v43, v24
    s_call_b64 s[52:53], L_gI
    v_cvt_pk_bf16_f32 v92, v44, v45
    v_cvt_pk_bf16_f32 v93, v46, v47
    v_cvt_pk_bf16_f32 v94, v48, v49
    v_cvt_pk_bf16_f32 v95, v50, v51
    v_cvt_pk_bf16_f32 v96, v52, v53
    v_cvt_pk_bf16_f32 v97, v54, v55
    v_cvt_pk_bf16_f32 v98, v56, v57
    v_cvt_pk_bf16_f32 v99, v58, v59
    v_cvt_pk_bf16_f32 v100, v60, v61
    v_cvt_pk_bf16_f32 v101, v62, v63
    v_cvt_pk_bf16_f32 v102, v64, v65
    v_cvt_pk_bf16_f32 v103, v66, v67
L_gs1:
    s_bitcmp1_b32 s64, 2
    s_cbranch_scc0 L_gs2
    v_mov_b32 v43, v25
    s_call_b64 s[52:53], L_gI
    v_cvt_pk_bf16_f32 v104, v44, v45
    v_cvt_pk_bf16_f32 v105, v46, v47
    v_cvt_pk_bf16_f32 v106, v48, v49
    v_cvt_pk_bf16_f32 v107, v50, v51
    v_cvt_pk_bf16_f32 v108, v52, v53
    v_cvt_pk_bf16_f32 v109, v54, v55
    v_cvt_pk_bf16_f32 v110, v56, v57
    v_cvt_pk_bf16_f32 v111, v58, v59
    v_cvt_pk_bf16_f32 v112, v60, v61
    v_cvt_pk_bf16_f32 v113, v62, v63
    v_cvt_pk_bf16_f32 v114, v64, v65
    v_cvt_pk_bf16_f32 v115, v66, v67
L_gs2:
    s_bitcmp1_b32 s64, 3
    s_cbranch_scc0 L_gs3
    v_mov_b32 v43, v26
    s_call_b64 s[52:53], L_gI
    v_cvt_pk_bf16_f32 v116, v44, v45
    v_cvt_pk_bf16_f32 v117, v46, v47
    v_cvt_pk_bf16_f32 v118, v48, v49
    v_cvt_pk_bf16_f32 v119, v50, v51
    v_cvt_pk_bf16_f32 v120, v52, v53
    v_cvt_pk_bf16_f32 v121, v54, v55
    v_cvt_pk_bf16_f32 v122, v56, v57
    v_cvt_pk_bf16_f32 v123, v58, v59
    v_cvt_pk_bf16_f32 v124, v60, v61
    v_cvt_pk_bf16_f32 v125, v62, v63
    v_cvt_pk_bf16_f32 v126, v64, v65
    v_cvt_pk_bf16_f32 v127, v66, v67
L_gs3:
    s_bitcmp1_b32 s64, 4
    s_cbranch_scc0 L_gs4
    v_mov_b32 v43, v27
    s_call_b64 s[52:53], L_gI
    v_cvt_pk_bf16_f32 v128, v44, v45
    v_cvt_pk_bf16_f32 v129, v46, v47
    v_cvt_pk_bf16_f32 v130, v48, v49
    v_cvt_pk_bf16_f32 v131, v50, v51
    v_cvt_pk_bf16_f32 v132, v52, v53
    v_cvt_pk_bf16_f32 v133, v54, v55
    v_cvt_pk_bf16_f32 v134, v56, v57
    v_cvt_pk_bf16_f32 v135, v58, v59
    v_cvt_pk_bf16_f32 v136, v60, v61
    v_cvt_pk_bf16_f32 v137, v62, v63
    v_cvt_pk_bf16_f32 v138, v64, v65
    v_cvt_pk_bf16_f32 v139, v66, v67
L_gs4:
    s_bitcmp1_b32 s64, 5
    s_cbranch_scc0 L_gs5
    v_mov_b32 v43, v28
    s_call_b64 s[52:53], L_gI
    v_cvt_pk_bf16_f32 v140, v44, v45
    v_cvt_pk_bf16_f32 v141, v46, v47
    v_cvt_pk_bf16_f32 v142, v48, v49
    v_cvt_pk_bf16_f32 v143, v50, v51
    v_cvt_pk_bf16_f32 v144, v52, v53
    v_cvt_pk_bf16_f32 v145, v54, v55
    v_cvt_pk_bf16_f32 v146, v56, v57
    v_cvt_pk_bf16_f32 v147, v58, v59
    v_cvt_pk_bf16_f32 v148, v60, v61
    v_cvt_pk_bf16_f32 v149, v62, v63
    v_cvt_pk_bf16_f32 v150, v64, v65
    v_cvt_pk_bf16_f32 v151, v66, v67
L_gs5:
    s_bitcmp1_b32 s64, 6
    s_cbranch_scc0 L_gs6
    v_mov_b32 v43, v29
    s_call_b64 s[52:53], L_gI
    v_cvt_pk_bf16_f32 v152, v44, v45
    v_cvt_pk_bf16_f32 v153, v46, v47
    v_cvt_pk_bf16_f32 v154, v48, v49
    v_cvt_pk_bf16_f32 v155, v50, v51
    v_cvt_pk_bf16_f32 v156, v52, v53
    v_cvt_pk_bf16_f32 v157, v54, v55
    v_cvt_pk_bf16_f32 v158, v56, v57
    v_cvt_pk_bf16_f32 v159, v58, v59
    v_cvt_pk_bf16_f32 v160, v60, v61
    v_cvt_pk_bf16_f32 v161, v62, v63
    v_cvt_pk_bf16_f32 v162, v64, v65
    v_cvt_pk_bf16_f32 v163, v66, v67
L_gs6:
    s_bitcmp1_b32 s64, 7
    s_cbranch_scc0 L_gs7
    v_mov_b32 v43, v30
    s_call_b64 s[52:53], L_gI
    v_cvt_pk_bf16_f32 v164, v44, v45
    v_cvt_pk_bf16_f32 v165, v46, v47
    v_cvt_pk_bf16_f32 v166, v48, v49
    v_cvt_pk_bf16_f32 v167, v50, v51
    v_cvt_pk_bf16_f32 v168, v52, v53
    v_cvt_pk_bf16_f32 v169, v54, v55
    v_cvt_pk_bf16_f32 v170, v56, v57
    v_cvt_pk_bf16_f32 v171, v58, v59
    v_cvt_pk_bf16_f32 v172, v60, v61
    v_cvt_pk_bf16_f32 v173, v62, v63
    v_cvt_pk_bf16_f32 v174, v64, v65
    v_cvt_pk_bf16_f32 v175, v66, v67
L_gs7:
    s_bitcmp1_b32 s64, 8
    s_cbranch_scc0 L_gs8
    v_mov_b32 v43, v31
    s_call_b64 s[52:53], L_gI
    v_cvt_pk_bf16_f32 v176, v44, v45
    v_cvt_pk_bf16_f32 v177, v46, v47
    v_cvt_pk_bf16_f32 v178, v48, v49
    v_cvt_pk_bf16_f32 v179, v50, v51
    v_cvt_pk_bf16_f32 v180, v52, v53
    v_cvt_pk_bf16_f32 v181, v54, v55
    v_cvt_pk_bf16_f32 v182, v56, v57
    v_cvt_pk_bf16_f32 v183, v58, v59
    v_cvt_pk_bf16_f32 v184, v60, v61
    v_cvt_pk_bf16_f32 v185, v62, v63
    v_cvt_pk_bf16_f32 v186, v64, v65
    v_cvt_pk_bf16_f32 v187, v66, v67
L_gs8:
    s_waitcnt vmcnt(0)
    v_mfma_f32_16x16x32_bf16 v[44:47], a[0:3], v[80:83], 0
    v_mfma_f32_16x16x32_bf16 v[48:51], a[4:7], v[80:83], 0
    v_mfma_f32_16x16x32_bf16 v[52:55], a[8:11], v[80:83], 0
    v_mfma_f32_16x16x32_bf16 v[52:55], a[20:23], v[84:87], v[52:55]
    v_mfma_f32_16x16x32_bf16 v[48:51], a[16:19], v[84:87], v[48:51]
    v_mfma_f32_16x16x32_bf16 v[44:47], a[12:15], v[84:87], v[44:47]
    v_mfma_f32_16x16x32_bf16 v[44:47], a[24:27], v[88:91], v[44:47]
    v_mfma_f32_16x16x32_bf16 v[48:51], a[28:31], v[88:91], v[48:51]
    v_mfma_f32_16x16x32_bf16 v[52:55], a[32:35], v[88:91], v[52:55]
    v_mfma_f32_16x16x32_bf16 v[44:47], a[36:39], v[92:95], v[44:47]
    v_mfma_f32_16x16x32_bf16 v[48:51], a[40:43], v[92:95], v[48:51]
    v_mfma_f32_16x16x32_bf16 v[52:55], a[44:47], v[92:95], v[52:55]
    v_mfma_f32_16x16x32_bf16 v[52:55], a[56:59], v[96:99], v[52:55]
    v_mfma_f32_16x16x32_bf16 v[48:51], a[52:55], v[96:99], v[48:51]
    v_mfma_f32_16x16x32_bf16 v[44:47], a[48:51], v[96:99], v[44:47]
    v_mfma_f32_16x16x32_bf16 v[44:47], a[60:63], v[100:103], v[44:47]
    v_mfma_f32_16x16x32_bf16 v[48:51], a[64:67], v[100:103], v[48:51]
    v_mfma_f32_16x16x32_bf16 v[52:55], a[68:71], v[100:103], v[52:55]
    v_mfma_f32_16x16x32_bf16 v[44:47], a[72:75], v[104:107], v[44:47]
    v_mfma_f32_16x16x32_bf16 v[48:51], a[76:79], v[104:107], v[48:51]
    v_mfma_f32_16x16x32_bf16 v[52:55], a[80:83], v[104:107], v[52:55]
    v_mfma_f32_16x16x32_bf16 v[52:55], a[92:95], v[108:111], v[52:55]
    v_mfma_f32_16x16x32_bf16 v[48:51], a[88:91], v[108:111], v[48:51]
    v_mfma_f32_16x16x32_bf16 v[44:47], a[84:87], v[108:111], v[44:47]
    v_mfma_f32_16x16x32_bf16 v[44:47], a[96:99], v[112:115], v[44:47]
    v_mfma_f32_16x16x32_bf16 v[48:51], a[100:103], v[112:115], v[48:51]
    v_mfma_f32_16x16x32_bf16 v[52:55], a[104:107], v[112:115], v[52:55]
    v_mfma_f32_16x16x32_bf16 v[44:47], a[108:111], v[116:119], v[44:47]
    v_mfma_f32_16x16x32_bf16 v[48:51], a[112:115], v[116:119], v[48:51]
    v_mfma_f32_16x16x32_bf16 v[52:55], a[116:119], v[116:119], v[52:55]
    v_mfma_f32_16x16x32_bf16 v[52:55], a[128:131], v[120:123], v[52:55]
    v_mfma_f32_16x16x32_bf16 v[48:51], a[124:127], v[120:123], v[48:51]
    v_mfma_f32_16x16x32_bf16 v[44:47], a[120:123], v[120:123], v[44:47]
    v_mfma_f32_16x16x32_bf16 v[44:47], a[132:135], v[124:127], v[44:47]
    v_mfma_f32_16x16x32_bf16 v[48:51], a[136:139], v[124:127], v[48:51]
    v_mfma_f32_16x16x32_bf16 v[52:55], a[140:143], v[124:127], v[52:55]
    v_mfma_f32_16x16x32_bf16 v[44:47], a[144:147], v[128:131], v[44:47]
    v_mfma_f32_16x16x32_bf16 v[48:51], a[148:151], v[128:131], v[48:51]
    v_mfma_f32_16x16x32_bf16 v[52:55], a[152:155], v[128:131], v[52:55]
    v_mfma_f32_16x16x32_bf16 v[52:55], a[164:167], v[132:135], v[52:55]
    v_mfma_f32_16x16x32_bf16 v[48:51], a[160:163], v[132:135], v[48:51]
    v_mfma_f32_16x16x32_bf16 v[44:47], a[156:159], v[132:135], v[44:47]
    v_mfma_f32_16x16x32_bf16 v[44:47], a[168:171], v[136:139], v[44:47]
    v_mfma_f32_16x16x32_bf16 v[48:51], a[172:175], v[136:139], v[48:51]
    v_mfma_f32_16x16x32_bf16 v[52:55], a[176:179], v[136:139], v[52:55]
    v_mfma_f32_16x16x32_bf16 v[44:47], a[180:183], v[140:143], v[44:47]
    v_mfma_f32_16x16x32_bf16 v[48:51], a[184:187], v[140:143], v[48:51]
    v_mfma_f32_16x16x32_bf16 v[52:55], a[188:191], v[140:143], v[52:55]
    v_mfma_f32_16x16x32_bf16 v[52:55], a[200:203], v[144:147], v[52:55]
    v_mfma_f32_16x16x32_bf16 v[48:51], a[196:199], v[144:147], v[48:51]
    v_mfma_f32_16x16x32_bf16 v[44:47], a[192:195], v[144:147], v[44:47]
    v_mfma_f32_16x16x32_bf16 v[44:47], a[204:207], v[148:151], v[44:47]
    v_mfma_f32_16x16x32_bf16 v[48:51], a[208:211], v[148:151], v[48:51]
    v_mfma_f32_16x16x32_bf16 v[52:55], a[212:215], v[148:151], v[52:55]
    v_mfma_f32_16x16x32_bf16 v[44:47], a[216:219], v[152:155], v[44:47]
    v_mfma_f32_16x16x32_bf16 v[48:51], a[220:223], v[152:155], v[48:51]
    v_mfma_f32_16x16x32_bf16 v[52:55], a[224:227], v[152:155], v[52:55]
    v_mfma_f32_16x16x32_bf16 v[52:55], a[236:239], v[156:159], v[52:55]
    v_mfma_f32_16x16x32_bf16 v[48:51], a[232:235], v[156:159], v[48:51]
    v_mfma_f32_16x16x32_bf16 v[44:47], a[228:231], v[156:159], v[44:47]
    v_mfma_f32_16x16x32_bf16 v[44:47], a[240:243], v[160:163], v[44:47]
    v_mfma_f32_16x16x32_bf16 v[48:51], a[244:247], v[160:163], v[48:51]
    v_mfma_f32_16x16x32_bf16 v[52:55], a[248:251], v[160:163], v[52:55]
    v_mfma_f32_16x16x32_bf16 v[44:47], a[252:255], v[164:167], v[44:47]
    v_mfma_f32_16x16x32_bf16 v[48:51], v[188:191], v[164:167], v[48:51]
    v_mfma_f32_16x16x32_bf16 v[52:55], v[192:195], v[164:167], v[52:55]
    v_mfma_f32_16x16x32_bf16 v[52:55], v[204:207], v[168:171], v[52:55]
    v_mfma_f32_16x16x32_bf16 v[48:51], v[200:203], v[168:171], v[48:51]
    v_mfma_f32_16x16x32_bf16 v[44:47], v[196:199], v[168:171], v[44:47]
    v_mfma_f32_16x16x32_bf16 v[44:47], v[208:211], v[172:175], v[44:47]
    v_mfma_f32_16x16x32_bf16 v[48:51], v[212:215], v[172:175], v[48:51]
    v_mfma_f32_16x16x32_bf16 v[52:55], v[216:219], v[172:175], v[52:55]
    v_mfma_f32_16x16x32_bf16 v[44:47], v[220:223], v[176:179], v[44:47]
    v_mfma_f32_16x16x32_bf16 v[48:51], v[224:227], v[176:179], v[48:51]
    v_mfma_f32_16x16x32_bf16 v[52:55], v[228:231], v[176:179], v[52:55]
    v_mfma_f32_16x16x32_bf16 v[52:55], v[240:243], v[180:183], v[52:55]
    v_mfma_f32_16x16x32_bf16 v[48:51], v[236:239], v[180:183], v[48:51]
    v_mfma_f32_16x16x32_bf16 v[44:47], v[232:235], v[180:183], v[44:47]
    v_mfma_f32_16x16x32_bf16 v[44:47], v[244:247], v[184:187], v[44:47]
    v_mfma_f32_16x16x32_bf16 v[48:51], v[248:251], v[184:187], v[48:51]
    v_mfma_f32_16x16x32_bf16 v[52:55], v[252:255], v[184:187], v[52:55]
    s_nop 5
    v_cvt_pk_bf16_f32 v32, v44, v45
    v_cvt_pk_bf16_f32 v33, v46, v47
    v_cvt_pk_bf16_f32 v34, v48, v49
    v_cvt_pk_bf16_f32 v35, v50, v51
    v_cvt_pk_bf16_f32 v36, v52, v53
    v_cvt_pk_bf16_f32 v37, v54, v55
    v_permlane16_swap_b32 v32, v34
    v_permlane16_swap_b32 v33, v35
    buffer_store_dwordx4 v[32:35], v9, s[16:19], s31 offen sc1
    buffer_store_dwordx2 v[36:37], v10, s[16:19], s31 offen sc1
L_gn:
    s_ashr_i32 s54, s54, 1
    s_bitset0_b32 s54, 30
    s_mul_i32 s47, s60, 36
    s_add_u32 s32, s32, s47
    s_mul_i32 s47, s60, 192
    s_add_u32 s31, s31, s47
    v_add_f32 v19, s62, v19
    v_add_f32 v20, s63, v20
    s_branch L_gt
L_gI:
    v_lshlrev_b32 v32, 16, v43
    v_and_b32 v33, 0xffff0000, v43
    v_fract_f32 v36, v32
    v_fract_f32 v37, v33
    v_cvt_u32_f32 v32, v32
    v_cvt_u32_f32 v33, v33
    v_mad_u32_u24 v40, v32, s49, v33
    v_mul_u32_u24 v40, 192, v40
    v_add_u32 v40, v40, v22
    v_sub_f32 v38, 1.0, v36
    v_sub_f32 v39, 1.0, v37
    v_cvt_pk_bf16_f32 v32, v38, v39
    v_lshlrev_b32 v38, 16, v32
    v_and_b32 v39, 0xffff0000, v32
    v_mul_f32 v1, v38, v39
    v_mul_f32 v2, v38, v37
    v_mul_f32 v3, v36, v39
    v_mul_f32 v15, v36, v37
    v_cvt_pk_bf16_f32 v32, v1, v2
    v_cvt_pk_bf16_f32 v33, v3, v15
    v_lshlrev_b32 v1, 16, v32
    v_and_b32 v2, 0xffff0000, v32
    v_lshlrev_b32 v3, 16, v33
    v_and_b32 v15, 0xffff0000, v33
    v_cmp_neq_f32 vcc, 0, v37
    v_mov_b32 v32, 192
    v_mov_b32 v33, 43008
    v_cndmask_b32 v41, 0, v32, vcc
    v_cmp_neq_f32 vcc, 0, v36
    v_mov_b32 v44, 0
    v_mov_b32 v45, 0
    v_mov_b32 v46, 0
    v_mov_b32 v47, 0
    v_mov_b32 v48, 0
    v_mov_b32 v49, 0
    v_mov_b32 v50, 0
    v_mov_b32 v51, 0
    v_mov_b32 v52, 0
    v_mov_b32 v53, 0
    v_mov_b32 v54, 0
    v_mov_b32 v55, 0
    v_mov_b32 v56, 0
    v_mov_b32 v57, 0
    v_mov_b32 v58, 0
    v_mov_b32 v59, 0
    v_mov_b32 v60, 0
    v_mov_b32 v61, 0
    v_mov_b32 v62, 0
    v_mov_b32 v63, 0
    v_mov_b32 v64, 0
    v_mov_b32 v65, 0
    v_mov_b32 v66, 0
    v_mov_b32 v67, 0
    v_cndmask_b32 v42, 0, v33, vcc
    v_sub_u32 v42, v42, v41
    s_mov_b32 s47, 4
L_gl:
    buffer_load_dwordx4 v[68:71], v40, s[4:7], 0 offen offset:0
    buffer_load_dwordx4 v[72:75], v40, s[4:7], 0 offen offset:64
    buffer_load_dwordx4 v[76:79], v40, s[4:7], 0 offen offset:128
    v_add_u32 v40, v40, v41
    v_swap_b32 v41, v42
    s_waitcnt vmcnt(0)
    v_lshlrev_b32 v32, 16, v68
    v_and_b32 v33, 0xffff0000, v68
    v_fmac_f32 v44, v1, v32
    v_fmac_f32 v45, v1, v33
    v_lshlrev_b32 v32, 16, v69
    v_and_b32 v33, 0xffff0000, v69
    v_fmac_f32 v46, v1, v32
    v_fmac_f32 v47, v1, v33
    v_lshlrev_b32 v32, 16, v70
    v_and_b32 v33, 0xffff0000, v70
    v_fmac_f32 v48, v1, v32
    v_fmac_f32 v49, v1, v33
    v_lshlrev_b32 v32, 16, v71
    v_and_b32 v33, 0xffff0000, v71
    v_fmac_f32 v50, v1, v32
    v_fmac_f32 v51, v1, v33
    v_lshlrev_b32 v32, 16, v72
    v_and_b32 v33, 0xffff0000, v72
    v_fmac_f32 v52, v1, v32
    v_fmac_f32 v53, v1, v33
    v_lshlrev_b32 v32, 16, v73
    v_and_b32 v33, 0xffff0000, v73
    v_fmac_f32 v54, v1, v32
    v_fmac_f32 v55, v1, v33
    v_lshlrev_b32 v32, 16, v74
    v_and_b32 v33, 0xffff0000, v74
    v_fmac_f32 v56, v1, v32
    v_fmac_f32 v57, v1, v33
    v_lshlrev_b32 v32, 16, v75
    v_and_b32 v33, 0xffff0000, v75
    v_fmac_f32 v58, v1, v32
    v_fmac_f32 v59, v1, v33
    v_lshlrev_b32 v32, 16, v76
    v_and_b32 v33, 0xffff0000, v76
    v_fmac_f32 v60, v1, v32
    v_fmac_f32 v61, v1, v33
    v_lshlrev_b32 v32, 16, v77
    v_and_b32 v33, 0xffff0000, v77
    v_fmac_f32 v62, v1, v32
    v_fmac_f32 v63, v1, v33
    v_lshlrev_b32 v32, 16, v78
    v_and_b32 v33, 0xffff0000, v78
    v_fmac_f32 v64, v1, v32
    v_fmac_f32 v65, v1, v33
    v_lshlrev_b32 v32, 16, v79
    v_and_b32 v33, 0xffff0000, v79
    v_fmac_f32 v66, v1, v32
    v_fmac_f32 v67, v1, v33
    v_mov_b32 v1, v2
    v_mov_b32 v2, v3
    v_mov_b32 v3, v15
    s_sub_u32 s47, s47, 1
    s_cmp_lg_u32 s47, 0
    s_cbranch_scc1 L_gl
    s_setpc_b64 s[52:53]
.p2align 7
L_ctab:
    .long 0x0, 0x18000c0, 0x400000, 0x0
    .long 0x3100008, 0x49003d0, 0x3400300, 0x10
    .long 0x6200010, 0x7a006e0, 0x6400600, 0x20
    .long 0x9300018, 0xab009f0, 0x9400900, 0x30
    .long 0xc000c0, 0x2400180, 0x10000c0, 0x40
    .long 0x3d000c8, 0x5500490, 0x40003c0, 0x50
    .long 0x6e000d0, 0x86007a0, 0x70006c0, 0x60
    .long 0x9f000d8, 0xb700ab0, 0xa0009c0, 0x70
    .long 0x1800180, 0x3100240, 0x1c00180, 0x80
    .long 0x4900188, 0x6200550, 0x4c00480, 0x1f80
    .long 0x7a00190, 0x9300860, 0x7c00780, 0x1f90
    .long 0xab00198, 0xc000b70, 0xac00a80, 0x1fa0
    .long 0x2400240, 0x3d00310, 0x2800240, 0x1fb0
    .long 0x5500248, 0x6e00620, 0x5800540, 0x1fc0
    .long 0x8600250, 0x9f00930, 0x8800840, 0x1fd0
    .long 0xb700258, 0xcc00c00, 0xb800b40, 0x1fe0
    .long 0x200c20, 0x1a000e0, 0x480020, 0x1ff0
    .long 0x3300c28, 0x4b003f0, 0x3480320, 0x2000
    .long 0x6000c30, 0x78006c0, 0x6480620, 0x3f00
    .long 0x9100c38, 0xa9009d0, 0x9480920, 0x3f10
    .long 0xe00ce0, 0x26001a0, 0x10800e0, 0x3f20
    .long 0x3f00ce8, 0x57004b0, 0x40803e0, 0x3f30
    .long 0x6c00cf0, 0x8400780, 0x70806e0, 0x3f40
    .long 0x9d00cf8, 0xb500a90, 0xa0809e0, 0x3f50
    .long 0x1a00da0, 0x3300260, 0x1c801a0, 0x3f60
    .long 0x4b00da8, 0x6000570, 0x4c804a0, 0x3f70
    .long 0x7800db0, 0x9100840, 0x7c807a0, 0x3f80
    .long 0xa900db8, 0xc200b50, 0xac80aa0, 0x5e80
    .long 0x2600e60, 0x3f00330, 0x2880260, 0x5e90
    .long 0x5700e68, 0x6c00600, 0x5880560, 0x5ea0
    .long 0x8400e70, 0x9d00910, 0x8880860, 0x5eb0
    .long 0xb500e78, 0xce00c20, 0xb880b60, 0x5ec0
    .long 0x100600, 0x19000d0, 0x500010, 0x5ed0
    .long 0x3000608, 0x48003c0, 0x3500310, 0x5ee0
    .long 0x6300610, 0x7b006f0, 0x6500610, 0x5ef0
    .long 0x9200618, 0xaa009e0, 0x9500910, 0x5f00
    .long 0xd006c0, 0x2500190, 0x11000d0, 0x7e00
    .long 0x3c006c8, 0x5400480, 0x41003d0, 0x7e10
    .long 0x6f006d0, 0x87007b0, 0x71006d0, 0x7e20
    .long 0x9e006d8, 0xb600aa0, 0xa1009d0, 0x7e30
    .long 0x1900780, 0x3000250, 0x1d00190, 0x7e40
    .long 0x4800788, 0x6300540, 0x4d00490, 0x7e50
    .long 0x7b00790, 0x9200870, 0x7d00790, 0x7e60
    .long 0xaa00798, 0xc100b60, 0xad00a90, 0x7e70
    .long 0x2500840, 0x3c00300, 0x2900250, 0x7e80
    .long 0x5400848, 0x6f00630, 0x5900550, 0x9d80
    .long 0x8700850, 0x9e00920, 0x8900850, 0x9d90
    .long 0xb600858, 0xcd00c10, 0xb900b50, 0x9da0
    .long 0x301220, 0x1b000f0, 0x580030, 0x9db0
    .long 0x3201228, 0x4a003e0, 0x3580330, 0x9dc0
    .long 0x6101230, 0x79006d0, 0x6580630, 0x9dd0
    .long 0x9001238, 0xa8009c0, 0x9580930, 0x9de0
    .long 0xf012e0, 0x27001b0, 0x11800f0, 0x9df0
    .long 0x3e012e8, 0x56004a0, 0x41803f0, 0x9e00
    .long 0x6d012f0, 0x8500790, 0x71806f0, 0xbd00
    .long 0x9c012f8, 0xb400a80, 0xa1809f0, 0xbd10
    .long 0x1b013a0, 0x3200270, 0x1d801b0, 0xbd20
    .long 0x4a013a8, 0x6100560, 0x4d804b0, 0xbd30
    .long 0x79013b0, 0x9000850, 0x7d807b0, 0xbd40
    .long 0xa8013b8, 0xc300b40, 0xad80ab0, 0xbd50
    .long 0x2701460, 0x3e00320, 0x2980270, 0xbd60
    .long 0x5601468, 0x6d00610, 0x5980570, 0xbd70
    .long 0x8501470, 0x9c00900, 0x8980870, 0xbd80
    .long 0xb401478, 0xcf00c30, 0xb980b70, 0xbd80
    .long 0xc000000, 0x0, 0x1e401e0, 0x0
    .long 0xcc000c0, 0x20, 0x1e40208, 0x0
    .long 0x19800180, 0x40, 0x147001e4, 0x0
    .long 0x1a400240, 0x60, 0x149801e4, 0x0
    .long 0x27000310, 0x80, 0x1e401e4, 0x0
    .long 0x27c003d0, 0xa0, 0x1e401e4, 0x0
    .long 0x34800490, 0xc0, 0x1e401e4, 0x0
    .long 0x35400550, 0xe0, 0x1e401e4, 0x0
    .long 0x42000620, 0x100, 0x1e401e4, 0x0
    .long 0x42c006e0, 0x120, 0x1e401e4, 0x0
    .long 0x420007a0, 0x140, 0x1e401e4, 0x0
    .long 0x42c00860, 0x160, 0x1e401e4, 0x0
    .long 0x42000930, 0x5cd00180, 0x1e401e4, 0x0
    .long 0x42c009f0, 0x5cd001a0, 0x1e401e4, 0x0
    .long 0x42000ab0, 0x5cd001c0, 0x1e401e4, 0x3f80
    .long 0x42c00b70, 0x5cd001e8, 0x1e401e4, 0x3f800000
    .long 0xc200020, 0x5cd00008, 0x1e401e4, 0x0
    .long 0xce000e0, 0x5cd00028, 0x1e401e4, 0x0
    .long 0x19a001a0, 0x5cd00048, 0x1e401e4, 0x0
    .long 0x1a600260, 0x5cd00068, 0x1e401e4, 0x0
    .long 0x27200330, 0x5cd00088, 0x1e42700, 0x0
    .long 0x27e003f0, 0x5cd000a8, 0x1e42728, 0x0
    .long 0x34a004b0, 0x5cd000c8, 0x399001e4, 0x0
    .long 0x35600570, 0x5cd000e8, 0x39b801e4, 0x0
    .long 0x42200600, 0x12900108, 0x1e401e4, 0x0
    .long 0x42e006c0, 0x12900128, 0x1e401e4, 0x0
    .long 0x42200780, 0x12900148, 0x1e401e4, 0x0
    .long 0x42e00840, 0x12900168, 0x1e401e4, 0x0
    .long 0x42200910, 0x12900188, 0x1e401e4, 0x0
    .long 0x42e009d0, 0x129001a8, 0x1e401e4, 0x0
    .long 0x42200a90, 0x129001c8, 0x1e401e4, 0x3f80
    .long 0x42e00b50, 0x129001f0, 0x1e401e4, 0x3f800000
    .long 0xc100010, 0x12900010, 0x1e401e4, 0x0
    .long 0xcd000d0, 0x12900030, 0x1e401e4, 0x0
    .long 0x19900190, 0x12900050, 0x1e401e4, 0x0
    .long 0x1a500250, 0x12900070, 0x1e401e4, 0x0
    .long 0x27100300, 0x6f600090, 0x1e401e4, 0x0
    .long 0x27d003c0, 0x6f6000b0, 0x1e401e4, 0x0
    .long 0x34900480, 0x6f6000d0, 0x1e401e4, 0x0
    .long 0x35500540, 0x6f6000f0, 0x1e401e4, 0x0
    .long 0x42100630, 0x6f600110, 0x1e44c20, 0x0
    .long 0x42d006f0, 0x6f600130, 0x1e44c48, 0x0
    .long 0x421007b0, 0x6f600150, 0x1e401e4, 0x0
    .long 0x42d00870, 0x6f600170, 0x1e401e4, 0x0
    .long 0x42100920, 0x6f600190, 0x1e401e4, 0x0
    .long 0x42d009e0, 0x6f6001b0, 0x1e401e4, 0x0
    .long 0x42100aa0, 0x6f6001d0, 0x1e401e4, 0x3f80
    .long 0x42d00b60, 0x6f6001f8, 0x1e401e4, 0x3f800000
    .long 0xc300030, 0x25200018, 0x1e401e4, 0x0
    .long 0xcf000f0, 0x25200038, 0x1e401e4, 0x0
    .long 0x19b001b0, 0x25200058, 0x1e401e4, 0x0
    .long 0x1a700270, 0x25200078, 0x1e401e4, 0x0
    .long 0x27300320, 0x25200098, 0x1e401e4, 0x0
    .long 0x27f003e0, 0x252000b8, 0x1e401e4, 0x0
    .long 0x34b004a0, 0x252000d8, 0x1e401e4, 0x0
    .long 0x35700560, 0x252000f8, 0x1e401e4, 0x0
    .long 0x42300610, 0x25200118, 0x1e401e4, 0x0
    .long 0x42f006d0, 0x25200138, 0x1e401e4, 0x0
    .long 0x42300790, 0x25200158, 0x1e401e4, 0x0
    .long 0x42f00850, 0x25200178, 0x1e401e4, 0x0
    .long 0x42300900, 0x81f00198, 0x1e401e4, 0x0
    .long 0x42f009c0, 0x81f001b8, 0x1e401e4, 0x0
    .long 0x42300a80, 0x81f001d8, 0x1e401e4, 0x3f80
    .long 0x42f00b40, 0x81f00200, 0x1e401e4, 0x3f800000
    .long 0x0, 0x0, 0x0, 0x0
    .long 0x20, 0x4, 0x0, 0x3000000
    .long 0x8, 0x8, 0x0, 0x6000000
    .long 0x28, 0xc, 0x0, 0x0
    .long 0x0, 0x1, 0x0, 0x3000001
    .long 0x20, 0x5, 0x0, 0x6000001
    .long 0x8, 0x9, 0x0, 0x1
    .long 0x28, 0xd, 0x0, 0x3000001
    .long 0x0, 0x2, 0x0, 0x6000002
    .long 0x20, 0x6, 0x0, 0x2
    .long 0x8, 0xa, 0x0, 0x3000002
    .long 0x28, 0xe, 0x0, 0x6000002
    .long 0x0, 0x3, 0x0, 0x9000003
    .long 0x20, 0x7, 0x0, 0xc000003
    .long 0x8, 0xb, 0x0, 0xf000003
    .long 0x28, 0xf, 0x0, 0x9000003
    .long 0x0, 0x0, 0x20002, 0xc000004
    .long 0x20, 0x4, 0x20002, 0xf000004
    .long 0x8, 0x8, 0x20002, 0x9000004
    .long 0x28, 0xc, 0x20002, 0xc000004
    .long 0x0, 0x1, 0x20002, 0xf000005
    .long 0x20, 0x5, 0x20002, 0x9000005
    .long 0x8, 0x9, 0x20002, 0xc000005
    .long 0x28, 0xd, 0x20002, 0xf000005
    .long 0x0, 0x2, 0x20002, 0x80006
    .long 0x20, 0x6, 0x20002, 0x3080006
    .long 0x8, 0xa, 0x20002, 0x6080006
    .long 0x28, 0xe, 0x20002, 0x80006
    .long 0x0, 0x3, 0x20002, 0x3080007
    .long 0x20, 0x7, 0x20002, 0x6080007
    .long 0x8, 0xb, 0x20002, 0x80007
    .long 0x28, 0xf, 0x20002, 0x3080007
    .long 0x0, 0x0, 0x10001, 0x6080008
    .long 0x20, 0x4, 0x10001, 0x80008
    .long 0x8, 0x8, 0x10001, 0x3080008
    .long 0x28, 0xc, 0x10001, 0x6080008
    .long 0x0, 0x1, 0x10001, 0x9080009
    .long 0x20, 0x5, 0x10001, 0xc080009
    .long 0x8, 0x9, 0x10001, 0xf080009
    .long 0x28, 0xd, 0x10001, 0x9080009
    .long 0x0, 0x2, 0x10001, 0xc08000a
    .long 0x20, 0x6, 0x10001, 0xf08000a
    .long 0x8, 0xa, 0x10001, 0x908000a
    .long 0x28, 0xe, 0x10001, 0xc08000a
    .long 0x0, 0x3, 0x10001, 0xf08000b
    .long 0x20, 0x7, 0x10001, 0x908000b
    .long 0x8, 0xb, 0x10001, 0xc08000b
    .long 0x28, 0xf, 0x10001, 0xf08000b
    .long 0x0, 0x0, 0x30003, 0x10000c
    .long 0x20, 0x4, 0x30003, 0x310000c
    .long 0x8, 0x8, 0x30003, 0x610000c
    .long 0x28, 0xc, 0x30003, 0x10000c
    .long 0x0, 0x1, 0x30003, 0x310000d
    .long 0x20, 0x5, 0x30003, 0x610000d
    .long 0x8, 0x9, 0x30003, 0x10000d
    .long 0x28, 0xd, 0x30003, 0x310000d
    .long 0x0, 0x2, 0x30003, 0x610000e
    .long 0x20, 0x6, 0x30003, 0x10000e
    .long 0x8, 0xa, 0x30003, 0x310000e
    .long 0x28, 0xe, 0x30003, 0x610000e
    .long 0x0, 0x3, 0x30003, 0x910000f
    .long 0x20, 0x7, 0x30003, 0xc10000f
    .long 0x8, 0xb, 0x30003, 0xf10000f
    .long 0x28, 0xf, 0x30003, 0x910000f
    .long 0xc0c0100, 0xc0c0c0c, 0xc0c0302, 0xc0c0c0c
    .long 0xc0c0c0c, 0xc0c0c0c, 0xc0c0c0c, 0xc0c0c0c
    .long 0xc0c0c0c, 0xc0c0c0c, 0xc0c0c0c, 0xc0c0c0c
    .long 0xc0c0c0c, 0xc0c0c0c, 0xc0c0c0c, 0xc0c0c0c
    .long 0x1000c0c, 0xc0c0c0c, 0x3020c0c, 0xc0c0c0c
    .long 0xc0c0c0c, 0xc0c0c0c, 0xc0c0c0c, 0xc0c0c0c
    .long 0xc0c0c0c, 0xc0c0c0c, 0xc0c0c0c, 0xc0c0c0c
    .long 0xc0c0c0c, 0xc0c0c0c, 0xc0c0c0c, 0xc0c0c0c
    .long 0xc0c0c0c, 0xc0c0100, 0xc0c0c0c, 0xc0c0302
    .long 0xc0c0c0c, 0xc0c0c0c, 0xc0c0c0c, 0xc0c0c0c
    .long 0xc0c0c0c, 0xc0c0c0c, 0xc0c0c0c, 0xc0c0c0c
    .long 0xc0c0c0c, 0xc0c0c0c, 0xc0c0c0c, 0xc0c0c0c
    .long 0xc0c0c0c, 0x1000c0c, 0xc0c0c0c, 0x3020c0c
    .long 0xc0c0c0c, 0xc0c0c0c, 0xc0c0c0c, 0xc0c0c0c
    .long 0xc0c0c0c, 0xc0c0c0c, 0xc0c0c0c, 0xc0c0c0c
    .long 0xc0c0c0c, 0xc0c0c0c, 0xc0c0c0c, 0xc0c0c0c
    .long 0xc0c0c0c, 0xc0c0c0c, 0xc0c0c0c, 0xc0c0c0c
    .long 0xc0c0100, 0xc0c0c0c, 0xc0c0302, 0xc0c0c0c
    .long 0xc0c0c0c, 0xc0c0c0c, 0xc0c0c0c, 0xc0c0c0c
    .long 0xc0c0c0c, 0xc0c0c0c, 0xc0c0c0c, 0xc0c0c0c
    .long 0xc0c0c0c, 0xc0c0c0c, 0xc0c0c0c, 0xc0c0c0c
    .long 0x1000c0c, 0xc0c0c0c, 0x3020c0c, 0xc0c0c0c
    .long 0xc0c0c0c, 0xc0c0c0c, 0xc0c0c0c, 0xc0c0c0c
    .long 0xc0c0c0c, 0xc0c0c0c, 0xc0c0c0c, 0xc0c0c0c
    .long 0xc0c0c0c, 0xc0c0c0c, 0xc0c0c0c, 0xc0c0c0c
    .long 0xc0c0c0c, 0xc0c0100, 0xc0c0c0c, 0xc0c0302
    .long 0xc0c0c0c, 0xc0c0c0c, 0xc0c0c0c, 0xc0c0c0c
    .long 0xc0c0c0c, 0xc0c0c0c, 0xc0c0c0c, 0xc0c0c0c
    .long 0xc0c0c0c, 0xc0c0c0c, 0xc0c0c0c, 0xc0c0c0c
    .long 0xc0c0c0c, 0x1000c0c, 0xc0c0c0c, 0x3020c0c
    .long 0xc0c0c0c, 0xc0c0c0c, 0xc0c0c0c, 0xc0c0c0c
    .long 0xc0c0c0c, 0xc0c0c0c, 0xc0c0c0c, 0xc0c0c0c
    .long 0xc0c0c0c, 0xc0c0c0c, 0xc0c0c0c, 0xc0c0c0c
    .long 0xc0c0c0c, 0xc0c0c0c, 0xc0c0c0c, 0xc0c0c0c
    .long 0xc0c0100, 0xc0c0c0c, 0xc0c0302, 0xc0c0c0c
    .long 0xc0c0c0c, 0xc0c0c0c, 0xc0c0c0c, 0xc0c0c0c
    .long 0xc0c0c0c, 0xc0c0c0c, 0xc0c0c0c, 0xc0c0c0c
    .long 0xc0c0c0c, 0xc0c0c0c, 0xc0c0c0c, 0xc0c0c0c
    .long 0x1000c0c, 0xc0c0c0c, 0x3020c0c, 0xc0c0c0c
    .long 0xc0c0c0c, 0xc0c0c0c, 0xc0c0c0c, 0xc0c0c0c
    .long 0xc0c0c0c, 0xc0c0c0c, 0xc0c0c0c, 0xc0c0c0c
    .long 0xc0c0c0c, 0xc0c0c0c, 0xc0c0c0c, 0xc0c0c0c
    .long 0xc0c0c0c, 0xc0c0100, 0xc0c0c0c, 0xc0c0302
    .long 0xc0c0c0c, 0xc0c0c0c, 0xc0c0c0c, 0xc0c0c0c
    .long 0xc0c0c0c, 0xc0c0c0c, 0xc0c0c0c, 0xc0c0c0c
    .long 0xc0c0c0c, 0xc0c0c0c, 0xc0c0c0c, 0xc0c0c0c
    .long 0xc0c0c0c, 0x1000c0c, 0xc0c0c0c, 0x3020c0c
    .long 0xc0c0c0c, 0xc0c0c0c, 0xc0c0c0c, 0xc0c0c0c
    .long 0xc0c0c0c, 0xc0c0c0c, 0xc0c0c0c, 0xc0c0c0c
    .long 0xc0c0c0c, 0xc0c0c0c, 0xc0c0c0c, 0xc0c0c0c
    .long 0xc0c0c0c, 0xc0c0c0c, 0xc0c0c0c, 0xc0c0c0c
    .long 0xc0c0100, 0xc0c0c0c, 0xc0c0302, 0xc0c0c0c
    .long 0xc0c0c0c, 0xc0c0c0c, 0xc0c0c0c, 0xc0c0c0c
    .long 0xc0c0c0c, 0xc0c0c0c, 0xc0c0c0c, 0xc0c0c0c
    .long 0xc0c0c0c, 0xc0c0c0c, 0xc0c0c0c, 0xc0c0c0c
    .long 0x1000c0c, 0xc0c0c0c, 0x3020c0c, 0xc0c0c0c
    .long 0xc0c0c0c, 0xc0c0c0c, 0xc0c0c0c, 0xc0c0c0c
    .long 0xc0c0c0c, 0xc0c0c0c, 0xc0c0c0c, 0xc0c0c0c
    .long 0xc0c0c0c, 0xc0c0c0c, 0xc0c0c0c, 0xc0c0c0c
    .long 0xc0c0c0c, 0xc0c0100, 0xc0c0c0c, 0xc0c0302
    .long 0xc0c0c0c, 0xc0c0c0c, 0xc0c0c0c, 0xc0c0c0c
    .long 0xc0c0c0c, 0xc0c0c0c, 0xc0c0c0c, 0xc0c0c0c
    .long 0xc0c0c0c, 0xc0c0c0c, 0xc0c0c0c, 0xc0c0c0c
    .long 0xc0c0c0c, 0x1000c0c, 0xc0c0c0c, 0x3020c0c
.p2align 6
L_runtab:
    .long 0x15a800, 0x925800, 0x55, 0x2200, 0x87543021, 0x6, 0x165000, 0x199800, 0x3dff, 0x0, 0x0, 0x0, 0x0, 0x0, 0x42f00, 0xa
    .long 0x295800, 0x925800, 0x55, 0x4000, 0x87543021, 0x6, 0x2a0000, 0x2d4800, 0x3dff, 0x0, 0x0, 0x0, 0x0, 0x0, 0x7e000, 0xa
    .long 0x3d0800, 0x925800, 0x55, 0x5e00, 0x87543021, 0x6, 0x3db000, 0x40f800, 0x3e7f, 0x0, 0x0, 0x0, 0x0, 0x0, 0xb9100, 0xa
    .long 0x50b800, 0x925800, 0x55, 0x7c00, 0x87543021, 0x6, 0x516000, 0x54a800, 0x3e7f, 0x0, 0x0, 0x0, 0x0, 0x0, 0xf4200, 0xa
    .long 0x5dd800, 0x925800, 0x55, 0x9000, 0x87543021, 0x6, 0x5e8000, 0x61c800, 0x3eff, 0x0, 0x0, 0x0, 0x0, 0x0, 0x11b800, 0xa
    .long 0x6af800, 0x925800, 0x55, 0xa400, 0x87543021, 0x6, 0x6ba000, 0x6ee800, 0x3eff, 0x0, 0x0, 0x0, 0x0, 0x0, 0x142e00, 0xa
    .long 0x781800, 0x925800, 0x55, 0xb800, 0x87543021, 0x6, 0x78c000, 0x7c0800, 0x3eff, 0x0, 0x0, 0x0, 0x0, 0x0, 0x16a400, 0xa
    .long 0x853800, 0x925800, 0x55, 0xcc00, 0x87543021, 0x6, 0x85e000, 0x892800, 0x3eff, 0x0, 0x0, 0x0, 0x0, 0x0, 0x191a00, 0xa
    .long 0x1c3800, 0x925800, 0x55, 0x2c00, 0x87543021, 0x6, 0x1ce000, 0x202800, 0x3dff, 0x0, 0x0, 0x0, 0x0, 0x0, 0x56a00, 0xa
    .long 0x2fe800, 0x925800, 0x55, 0x4a00, 0x87543021, 0x6, 0x309000, 0x33d800, 0x3e7f, 0x0, 0x0, 0x0, 0x0, 0x0, 0x91b00, 0xa
    .long 0x439800, 0x925800, 0x55, 0x6800, 0x87543021, 0x6, 0x444000, 0x478800, 0x3e7f, 0x0, 0x0, 0x0, 0x0, 0x0, 0xccc00, 0xa
    .long 0x574800, 0x925800, 0x55, 0x8600, 0x87543021, 0x6, 0x57f000, 0x5b3800, 0x3eff, 0x0, 0x0, 0x0, 0x0, 0x0, 0x107d00, 0xa
    .long 0x646800, 0x925800, 0x55, 0x9a00, 0x87543021, 0x6, 0x651000, 0x685800, 0x3eff, 0x0, 0x0, 0x0, 0x0, 0x0, 0x12f300, 0xa
    .long 0x718800, 0x925800, 0x55, 0xae00, 0x87543021, 0x6, 0x723000, 0x757800, 0x3eff, 0x0, 0x0, 0x0, 0x0, 0x0, 0x156900, 0xa
    .long 0x7ea800, 0x925800, 0x55, 0xc200, 0x87543021, 0x6, 0x7f5000, 0x829800, 0x3eff, 0x0, 0x0, 0x0, 0x0, 0x0, 0x17df00, 0xa
    .long 0x8bc800, 0x925800, 0x55, 0xd600, 0x87543021, 0x6, 0x8c7000, 0x8fb800, 0x3eff, 0x0, 0x0, 0x0, 0x0, 0x0, 0x1a5500, 0xa
    .long 0x22c800, 0x925800, 0x55, 0x3600, 0x87543021, 0x6, 0x237000, 0x26b800, 0x3dff, 0x0, 0x0, 0x0, 0x0, 0x0, 0x6a500, 0xa
    .long 0x367800, 0x925800, 0x55, 0x5400, 0x87543021, 0x6, 0x372000, 0x3a6800, 0x3e7f, 0x0, 0x0, 0x0, 0x0, 0x0, 0xa5600, 0xa
    .long 0x4a2800, 0x925800, 0x55, 0x7200, 0x87543021, 0x6, 0x4ad000, 0x4e1800, 0x3e7f, 0x0, 0x0, 0x0, 0x0, 0x0, 0xe0700, 0xa
    .long 0x45c0, 0xa740, 0x55, 0x15e00, 0x85741063, 0x2, 0x4680, 0x4a40, 0x3e7f, 0x0, 0x0, 0x0, 0x0, 0x0, 0xd38, 0xa
    .long 0x5c40, 0xa740, 0x55, 0x17c00, 0x85741063, 0x2, 0x5d00, 0x60c0, 0x3e7f, 0x0, 0x0, 0x0, 0x0, 0x0, 0x1170, 0xa
    .long 0x72c0, 0xa740, 0x55, 0x19a00, 0x85741063, 0x2, 0x7380, 0x7740, 0x3eff, 0x0, 0x0, 0x0, 0x0, 0x0, 0x15a8, 0xa
    .long 0x8940, 0xa740, 0x55, 0x1b800, 0x85741063, 0x2, 0x8a00, 0x8dc0, 0x3eff, 0x0, 0x0, 0x0, 0x0, 0x0, 0x19e0, 0xa
    .long 0x9840, 0xa740, 0x55, 0x1cc00, 0x85741063, 0x2, 0x9900, 0x9cc0, 0x3eff, 0x0, 0x0, 0x0, 0x0, 0x0, 0x1cb0, 0xa
    .long 0x18c0, 0xa740, 0x55, 0x12200, 0x85741063, 0x2, 0x1980, 0x1d40, 0x3dff, 0x0, 0x0, 0x0, 0x0, 0x0, 0x4c8, 0xa
    .long 0x27c0, 0xa740, 0x55, 0x13600, 0x85741063, 0x2, 0x2880, 0x2c40, 0x3dff, 0x0, 0x0, 0x0, 0x0, 0x0, 0x798, 0xa
    .long 0x36c0, 0xa740, 0x55, 0x14a00, 0x85741063, 0x2, 0x3780, 0x3b40, 0x3e7f, 0x0, 0x0, 0x0, 0x0, 0x0, 0xa68, 0xa
    .long 0x4d40, 0xa740, 0x55, 0x16800, 0x85741063, 0x2, 0x4e00, 0x51c0, 0x3e7f, 0x0, 0x0, 0x0, 0x0, 0x0, 0xea0, 0xa
    .long 0x63c0, 0xa740, 0x55, 0x18600, 0x85741063, 0x2, 0x6480, 0x6840, 0x3eff, 0x0, 0x0, 0x0, 0x0, 0x0, 0x12d8, 0xa
    .long 0x7a40, 0xa740, 0x55, 0x1a400, 0x85741063, 0x2, 0x7b00, 0x7ec0, 0x3eff, 0x0, 0x0, 0x0, 0x0, 0x0, 0x1710, 0xa
    .long 0x90c0, 0xa740, 0x55, 0x1c200, 0x85741063, 0x2, 0x9180, 0x9540, 0x3eff, 0x0, 0x0, 0x0, 0x0, 0x0, 0x1b48, 0xa
    .long 0x9fc0, 0xa740, 0x55, 0x1d600, 0x85741063, 0x2, 0xa080, 0xa440, 0x3eff, 0x0, 0x0, 0x0, 0x0, 0x0, 0x1e18, 0xa
    .long 0x2040, 0xa740, 0x55, 0x12c00, 0x85741063, 0x2, 0x2100, 0x24c0, 0x3dff, 0x0, 0x0, 0x0, 0x0, 0x0, 0x630, 0xa
    .long 0x2f40, 0xa740, 0x55, 0x14000, 0x85741063, 0x2, 0x3000, 0x33c0, 0x3dff, 0x0, 0x0, 0x0, 0x0, 0x0, 0x900, 0xa
    .long 0x3e40, 0xa740, 0x55, 0x15400, 0x85741063, 0x2, 0x3f00, 0x42c0, 0x3e7f, 0x0, 0x0, 0x0, 0x0, 0x0, 0xbd0, 0xa
    .long 0x54c0, 0xa740, 0x55, 0x17200, 0x85741063, 0x2, 0x5580, 0x5940, 0x3e7f, 0x0, 0x0, 0x0, 0x0, 0x0, 0x1008, 0xa
    .long 0x6b40, 0xa740, 0x55, 0x19000, 0x85741063, 0x2, 0x6c00, 0x6fc0, 0x3eff, 0x0, 0x0, 0x0, 0x0, 0x0, 0x1440, 0xa
    .long 0x81c0, 0xa740, 0x55, 0x1ae00, 0x85741063, 0x2, 0x8280, 0x8640, 0x3eff, 0x0, 0x0, 0x0, 0x0, 0x0, 0x1878, 0xa
    .long 0xa80, 0xf00, 0x12, 0x1fe31000, 0x6ac0, 0x18a, 0xc00, 0xcc0, 0xbf800000, 0x41700000, 0xf4, 0xe, 0x7, 0x5b80, 0x240, 0x3
    .long 0xcc0, 0x1140, 0x12, 0x1fe31300, 0x6ac0, 0x18a, 0xe40, 0xf00, 0xbf800000, 0x41900000, 0xf4, 0x11, 0x7, 0x5b80, 0x2ac, 0x3
    .long 0xf00, 0x1440, 0x22, 0x1fe31600, 0x7a00, 0x175, 0x1080, 0x1140, 0xbf800000, 0x41a80000, 0xf4, 0x14, 0x8, 0x6ac0, 0x318, 0x4
    .long 0x1200, 0x1740, 0x22, 0x1fe31a00, 0x7a00, 0x175, 0x1380, 0x1440, 0xbf800000, 0x41c80000, 0xf4, 0x18, 0x8, 0x6ac0, 0x3a8, 0x4
    .long 0x1500, 0x1a40, 0x22, 0x1fe31e00, 0x7a00, 0x175, 0x1680, 0x1740, 0xbf800000, 0x41e80000, 0xf4, 0x1c, 0x8, 0x6ac0, 0x438, 0x4
    .long 0x4d40, 0x5700, 0x66, 0xe36810, 0xd580, 0xfb, 0xace00, 0xacec0, 0x41700000, 0x42ce0000, 0x0, 0x67, 0xe, 0xc640, 0x206a0, 0xc
    .long 0x5f40, 0x6900, 0x66, 0xe38010, 0xd580, 0xfb, 0xae000, 0xae0c0, 0x41700000, 0x42fe0000, 0x0, 0x7f, 0xe, 0xc640, 0x20a00, 0xc
    .long 0x7140, 0x7b00, 0x66, 0xe39810, 0xd580, 0xfb, 0xaf200, 0xaf2c0, 0x41700000, 0x43170000, 0x0, 0x97, 0xe, 0xc640, 0x20d60, 0xc
    .long 0x8340, 0x8d00, 0x66, 0xe3b010, 0xd580, 0xfb, 0xb0400, 0xb04c0, 0x41700000, 0x432f0000, 0x0, 0xaf, 0xe, 0xc640, 0x210c0, 0xc
    .long 0x9540, 0x9f00, 0x66, 0xe3c810, 0xd580, 0xfb, 0xb1600, 0xb16c0, 0x41700000, 0x43470000, 0x0, 0xc7, 0xe, 0xc640, 0x21420, 0xc
    .long 0x1680, 0x21c0, 0x66, 0xe32010, 0xf400, 0xd3, 0xa9800, 0xa98c0, 0x41700000, 0x41f80000, 0xf4, 0x1e, 0x10, 0xe4c0, 0x1fc80, 0xc
    .long 0x2940, 0x3300, 0x66, 0xe33810, 0xd580, 0xfb, 0xaaa00, 0xaaac0, 0x41700000, 0x425c0000, 0x0, 0x37, 0xe, 0xc640, 0x1ffe0, 0xc
    .long 0x3b40, 0x4500, 0x66, 0xe35010, 0xd580, 0xfb, 0xabc00, 0xabcc0, 0x41700000, 0x429e0000, 0x0, 0x4f, 0xe, 0xc640, 0x20340, 0xc
    .long 0x5640, 0x6000, 0x66, 0xe37410, 0xd580, 0xfb, 0xad700, 0xad7c0, 0x41700000, 0x42e60000, 0x0, 0x73, 0xe, 0xc640, 0x20850, 0xc
    .long 0x6840, 0x7200, 0x66, 0xe38c10, 0xd580, 0xfb, 0xae900, 0xae9c0, 0x41700000, 0x430b0000, 0x0, 0x8b, 0xe, 0xc640, 0x20bb0, 0xc
    .long 0x7a40, 0x8400, 0x66, 0xe3a410, 0xd580, 0xfb, 0xafb00, 0xafbc0, 0x41700000, 0x43230000, 0x0, 0xa3, 0xe, 0xc640, 0x20f10, 0xc
    .long 0x8c40, 0x9600, 0x66, 0xe3bc10, 0xd580, 0xfb, 0xb0d00, 0xb0dc0, 0x41700000, 0x433b0000, 0x0, 0xbb, 0xe, 0xc640, 0x21270, 0xc
    .long 0x9e40, 0xa740, 0x66, 0xe3d410, 0xd580, 0xfb, 0xb1f00, 0xb1fc0, 0x41700000, 0x43530000, 0x0, 0xd3, 0xe, 0xc640, 0x215d0, 0xc
    .long 0x2040, 0x2a00, 0x66, 0xe32c10, 0xd580, 0xfb, 0xaa100, 0xaa1c0, 0x41700000, 0x422c0000, 0x0, 0x2b, 0xe, 0xc640, 0x1fe30, 0xc
    .long 0x3240, 0x3c00, 0x66, 0xe34410, 0xd580, 0xfb, 0xab300, 0xab3c0, 0x41700000, 0x42860000, 0x0, 0x43, 0xe, 0xc640, 0x20190, 0xc
    .long 0x4440, 0x4e00, 0x66, 0xe35c10, 0xd580, 0xfb, 0xac500, 0xac5c0, 0x41700000, 0x42b60000, 0x0, 0x5b, 0xe, 0xc640, 0x204f0, 0xc
    .long 0xfffeb000, 0x2a000, 0x12, 0x1fe20000, 0x6ac0, 0x18a, 0x0, 0xa800, 0xbf800000, 0xbf800000, 0xf4, 0xfffffffe, 0x7, 0x5b80, 0x0, 0x3
    .long 0xa800, 0x49800, 0x12, 0x1fe20300, 0x6ac0, 0x18a, 0x1f800, 0x2a000, 0x40000000, 0xbf800000, 0xf4, 0x1, 0x7, 0x5b80, 0x5e80, 0x3
    .long 0x2a000, 0x69000, 0x12, 0x1fe20600, 0x6ac0, 0x18a, 0x3f000, 0x49800, 0x40a00000, 0xbf800000, 0xf4, 0x4, 0x7, 0x5b80, 0xbd00, 0x3
    .long 0x49800, 0x93000, 0x22, 0x1fe20900, 0x7a00, 0x175, 0x5e800, 0x69000, 0x41000000, 0xbf800000, 0xf4, 0x7, 0x8, 0x6ac0, 0x11b80, 0x4
    .long 0x73800, 0xbd000, 0x22, 0x1fe20d00, 0x7a00, 0x175, 0x88800, 0x93000, 0x41400000, 0xbf800000, 0xf4, 0xb, 0x8, 0x6ac0, 0x19980, 0x4
    .long 0x9d800, 0xe7000, 0x22, 0x1fe21100, 0x7a00, 0x175, 0xb2800, 0xbd000, 0x41800000, 0xbf800000, 0xf4, 0xf, 0x8, 0x6ac0, 0x21780, 0x4
    .long 0xc7800, 0x111000, 0x22, 0x1fe21500, 0x7a00, 0x175, 0xdc800, 0xe7000, 0x41a00000, 0xbf800000, 0xf4, 0x13, 0x8, 0x6ac0, 0x29580, 0x4
    .long 0xf1800, 0x13b000, 0x22, 0x1fe21900, 0x7a00, 0x175, 0x106800, 0x111000, 0x41c00000, 0xbf800000, 0xf4, 0x17, 0x8, 0x6ac0, 0x31380, 0x4
    .long 0x11b800, 0x16f800, 0x23, 0x1fe21d00, 0x8940, 0x161, 0x130800, 0x13b000, 0x41e00000, 0xbf800000, 0xf4, 0x1b, 0x9, 0x7a00, 0x39180, 0x5
    .long 0x5b3800, 0x63c000, 0x66, 0x1e28c20, 0xd580, 0xfb, 0x5bf800, 0x5ca000, 0x430b0000, 0x41f80000, 0x0, 0x8b, 0xe, 0xc640, 0x113e80, 0xc
    .long 0x7ab800, 0x834000, 0x66, 0xe2bc10, 0xd580, 0xfb, 0x7b6c00, 0x7c1400, 0x433b0000, 0x41700000, 0x0, 0xbb, 0xe, 0xc640, 0x172440, 0xc
    .long 0x8a7800, 0x925800, 0x66, 0x1e2d420, 0xd580, 0xfb, 0x8b3800, 0x8be000, 0x43530000, 0x41f80000, 0x0, 0xd3, 0xe, 0xc640, 0x1a1a80, 0xc
    .long 0x13b000, 0x1c3800, 0x55, 0x7e22080, 0xd580, 0xfb, 0x156000, 0x160800, 0x41f80000, 0x42fe0000, 0xf4, 0x1e, 0xe, 0xc640, 0x40200, 0xa
    .long 0x93000, 0xf1800, 0x33, 0xe21010, 0x9880, 0x14d, 0xa8c00, 0xb3400, 0x41700000, 0x41700000, 0xf4, 0xe, 0xa, 0x8940, 0x1fa40, 0x6
    .long 0x241800, 0x2ca000, 0x66, 0xe23810, 0xd580, 0xfb, 0x24cc00, 0x257400, 0x425c0000, 0x41700000, 0x0, 0x37, 0xe, 0xc640, 0x6e640, 0xc
    .long 0x33d800, 0x3c6000, 0x66, 0x1e25020, 0xd580, 0xfb, 0x349800, 0x354000, 0x429e0000, 0x41f80000, 0x0, 0x4f, 0xe, 0xc640, 0x9dc80, 0xc
    .long 0x4b7800, 0x540000, 0x66, 0xe27410, 0xd580, 0xfb, 0x4c2c00, 0x4cd400, 0x42e60000, 0x41700000, 0x0, 0x73, 0xe, 0xc640, 0xe4840, 0xc
    .long 0x631800, 0x6ba000, 0x66, 0xe29810, 0xd580, 0xfb, 0x63cc00, 0x647400, 0x43170000, 0x41700000, 0x0, 0x97, 0xe, 0xc640, 0x12b640, 0xc
    .long 0x72d800, 0x7b6000, 0x66, 0x1e2b020, 0xd580, 0xfb, 0x739800, 0x744000, 0x432f0000, 0x41f80000, 0x0, 0xaf, 0xe, 0xc640, 0x15ac80, 0xc
    .long 0x13b000, 0x1c3800, 0x55, 0x2e22030, 0xd580, 0xfb, 0x152400, 0x15cc00, 0x41f80000, 0x423c0000, 0xf4, 0x1e, 0xe, 0xc640, 0x3f6c0, 0xa
    .long 0x13b000, 0x1c3800, 0x55, 0x8e22090, 0xd580, 0xfb, 0x156c00, 0x161400, 0x41f80000, 0x430f0000, 0xf4, 0x1e, 0xe, 0xc640, 0x40440, 0xa
    .long 0xd2000, 0x15a800, 0x55, 0xe21610, 0xd580, 0xfb, 0xe7c00, 0xf2400, 0x41a80000, 0x41700000, 0xf4, 0x14, 0xe, 0xc640, 0x2b740, 0xa
    .long 0x241800, 0x2ca000, 0x66, 0x1e23820, 0xd580, 0xfb, 0x24d800, 0x258000, 0x425c0000, 0x41f80000, 0x0, 0x37, 0xe, 0xc640, 0x6e880, 0xc
    .long 0x3bb800, 0x444000, 0x66, 0xe25c10, 0xd580, 0xfb, 0x3c6c00, 0x3d1400, 0x42b60000, 0x41700000, 0x0, 0x5b, 0xe, 0xc640, 0xb5440, 0xc
    .long 0x4b7800, 0x540000, 0x66, 0x1e27420, 0xd580, 0xfb, 0x4c3800, 0x4ce000, 0x42e60000, 0x41f80000, 0x0, 0x73, 0xe, 0xc640, 0xe4a80, 0xc
    .long 0x631800, 0x6ba000, 0x66, 0x1e29820, 0xd580, 0xfb, 0x63d800, 0x648000, 0x43170000, 0x41f80000, 0x0, 0x97, 0xe, 0xc640, 0x12b880, 0xc
    .long 0x7ab800, 0x834000, 0x66, 0x1e2bc20, 0xd580, 0xfb, 0x7b7800, 0x7c2000, 0x433b0000, 0x41f80000, 0x0, 0xbb, 0xe, 0xc640, 0x172680, 0xc
    .long 0x13b000, 0x1c3800, 0x55, 0x3e22040, 0xd580, 0xfb, 0x153000, 0x15d800, 0x41f80000, 0x427c0000, 0xf4, 0x1e, 0xe, 0xc640, 0x3f900, 0xa
    .long 0x13b000, 0x1c3800, 0x55, 0x9e220a0, 0xd580, 0xfb, 0x157800, 0x162000, 0x41f80000, 0x431f0000, 0xf4, 0x1e, 0xe, 0xc640, 0x40680, 0xa
    .long 0x13b000, 0x1d8800, 0x66, 0xe22010, 0xf400, 0xd3, 0x150c00, 0x15b400, 0x41f80000, 0x41700000, 0xf4, 0x1e, 0x10, 0xe4c0, 0x3f240, 0xc
    .long 0x2bf800, 0x348000, 0x66, 0xe24410, 0xd580, 0xfb, 0x2cac00, 0x2d5400, 0x42860000, 0x41700000, 0x0, 0x43, 0xe, 0xc640, 0x86040, 0xc
    .long 0x439800, 0x4c2000, 0x66, 0xe26810, 0xd580, 0xfb, 0x444c00, 0x44f400, 0x42ce0000, 0x41700000, 0x0, 0x67, 0xe, 0xc640, 0xcce40, 0xc
    .long 0x535800, 0x5be000, 0x66, 0xe28010, 0xd580, 0xfb, 0x540c00, 0x54b400, 0x42fe0000, 0x41700000, 0x0, 0x7f, 0xe, 0xc640, 0xfc240, 0xc
    .long 0x6af800, 0x738000, 0x66, 0xe2a410, 0xd580, 0xfb, 0x6bac00, 0x6c5400, 0x43230000, 0x41700000, 0x0, 0xa3, 0xe, 0xc640, 0x143040, 0xc
    .long 0x829800, 0x8b2000, 0x66, 0xe2c810, 0xd580, 0xfb, 0x834c00, 0x83f400, 0x43470000, 0x41700000, 0x0, 0xc7, 0xe, 0xc640, 0x189e40, 0xc
    .long 0x13b000, 0x1c3800, 0x55, 0x4e22050, 0xd580, 0xfb, 0x153c00, 0x15e400, 0x41f80000, 0x429e0000, 0xf4, 0x1e, 0xe, 0xc640, 0x3fb40, 0xa
    .long 0x13b000, 0x1c3800, 0x55, 0xae220b0, 0xd580, 0xfb, 0x158400, 0x162c00, 0x41f80000, 0x432f0000, 0xf4, 0x1e, 0xe, 0xc640, 0x408c0, 0xa
    .long 0x13b000, 0x1d8800, 0x66, 0x1e22020, 0xf400, 0xd3, 0x151800, 0x15c000, 0x41f80000, 0x41f80000, 0xf4, 0x1e, 0x10, 0xe4c0, 0x3f480, 0xc
    .long 0x2bf800, 0x348000, 0x66, 0x1e24420, 0xd580, 0xfb, 0x2cb800, 0x2d6000, 0x42860000, 0x41f80000, 0x0, 0x43, 0xe, 0xc640, 0x86280, 0xc
    .long 0x3bb800, 0x444000, 0x66, 0x1e25c20, 0xd580, 0xfb, 0x3c7800, 0x3d2000, 0x42b60000, 0x41f80000, 0x0, 0x5b, 0xe, 0xc640, 0xb5680, 0xc
    .long 0x535800, 0x5be000, 0x66, 0x1e28020, 0xd580, 0xfb, 0x541800, 0x54c000, 0x42fe0000, 0x41f80000, 0x0, 0x7f, 0xe, 0xc640, 0xfc480, 0xc
    .long 0x6af800, 0x738000, 0x66, 0x1e2a420, 0xd580, 0xfb, 0x6bb800, 0x6c6000, 0x43230000, 0x41f80000, 0x0, 0xa3, 0xe, 0xc640, 0x143280, 0xc
    .long 0x829800, 0x8b2000, 0x66, 0x1e2c820, 0xd580, 0xfb, 0x835800, 0x840000, 0x43470000, 0x41f80000, 0x0, 0xc7, 0xe, 0xc640, 0x18a080, 0xc
    .long 0x13b000, 0x1c3800, 0x55, 0x5e22060, 0xd580, 0xfb, 0x154800, 0x15f000, 0x41f80000, 0x42be0000, 0xf4, 0x1e, 0xe, 0xc640, 0x3fd80, 0xa
    .long 0x13b000, 0x1c3800, 0x55, 0xbe220c0, 0xd580, 0xfb, 0x159000, 0x163800, 0x41f80000, 0x433f0000, 0xf4, 0x1e, 0xe, 0xc640, 0x40b00, 0xa
    .long 0x1c3800, 0x24c000, 0x66, 0xe22c10, 0xd580, 0xfb, 0x1cec00, 0x1d9400, 0x422c0000, 0x41700000, 0x0, 0x2b, 0xe, 0xc640, 0x56c40, 0xc
    .long 0x33d800, 0x3c6000, 0x66, 0xe25010, 0xd580, 0xfb, 0x348c00, 0x353400, 0x429e0000, 0x41700000, 0x0, 0x4f, 0xe, 0xc640, 0x9da40, 0xc
    .long 0x439800, 0x4c2000, 0x66, 0x1e26820, 0xd580, 0xfb, 0x445800, 0x450000, 0x42ce0000, 0x41f80000, 0x0, 0x67, 0xe, 0xc640, 0xcd080, 0xc
    .long 0x5b3800, 0x63c000, 0x66, 0xe28c10, 0xd580, 0xfb, 0x5bec00, 0x5c9400, 0x430b0000, 0x41700000, 0x0, 0x8b, 0xe, 0xc640, 0x113c40, 0xc
    .long 0x72d800, 0x7b6000, 0x66, 0xe2b010, 0xd580, 0xfb, 0x738c00, 0x743400, 0x432f0000, 0x41700000, 0x0, 0xaf, 0xe, 0xc640, 0x15aa40, 0xc
    .long 0x8a7800, 0x925800, 0x66, 0xe2d410, 0xd580, 0xfb, 0x8b2c00, 0x8bd400, 0x43530000, 0x41700000, 0x0, 0xd3, 0xe, 0xc640, 0x1a1840, 0xc
    .long 0x13b000, 0x1c3800, 0x55, 0x6e22070, 0xd580, 0xfb, 0x155400, 0x15fc00, 0x41f80000, 0x42de0000, 0xf4, 0x1e, 0xe, 0xc640, 0x3ffc0, 0xa
    .long 0x13b000, 0x1c3800, 0x55, 0xce220d0, 0xd580, 0xfb, 0x159c00, 0x164400, 0x41f80000, 0x434f0000, 0xf4, 0x1e, 0xe, 0xc640, 0x40d40, 0xa
    .long 0x1c3800, 0x24c000, 0x66, 0x1e22c20, 0xd580, 0xfb, 0x1cf800, 0x1da000, 0x422c0000, 0x41f80000, 0x0, 0x2b, 0xe, 0xc640, 0x56e80, 0xc
    .long 0x3fa800, 0x925800, 0x77, 0x6240, 0x3dff3e7f, 0x3dff3e7f, 0x408000, 0x451800, 0x0, 0x0, 0x0, 0x0, 0x0, 0x0, 0x0, 0x0
    .long 0x646800, 0x925800, 0x77, 0x9a60, 0x3e7f3eff, 0x3e7f3eff, 0x655800, 0x69f000, 0x0, 0x0, 0x0, 0x0, 0x0, 0x0, 0x0, 0x0
    .long 0x1ae800, 0x925800, 0x77, 0x2a80, 0x3e7f3dff, 0x3e7f3dff, 0x1bf000, 0x208800, 0x0, 0x0, 0x0, 0x0, 0x0, 0x0, 0x0, 0x0
    .long 0x3fa800, 0x925800, 0x77, 0x62a0, 0x3eff3e7f, 0x3eff3e7f, 0x40c800, 0x456000, 0x0, 0x0, 0x0, 0x0, 0x0, 0x0, 0x0, 0x0
    .long 0x6d9800, 0x925800, 0x77, 0xa880, 0x3e7f3eff, 0x3e7f3eff, 0x6ea000, 0x733800, 0x0, 0x0, 0x0, 0x0, 0x0, 0x0, 0x0, 0x0
    .long 0x241800, 0x925800, 0x77, 0x38b0, 0x3eff3dff, 0x3eff3dff, 0x254400, 0x29dc00, 0x0, 0x0, 0x0, 0x0, 0x0, 0x0, 0x0, 0x0
    .long 0x5b3800, 0x925800, 0x77, 0x8cb0, 0x3eff3eff, 0x3eff3eff, 0x5c6400, 0x60fc00, 0x0, 0x0, 0x0, 0x0, 0x0, 0x0, 0x0, 0x0
    .long 0x1ae800, 0x925800, 0x77, 0x2a30, 0x3dff3dff, 0x3dff3dff, 0x1bb400, 0x204c00, 0x0, 0x0, 0x0, 0x0, 0x0, 0x0, 0x0, 0x0
    .long 0x3fa800, 0x925800, 0x77, 0x6250, 0x3e7f3e7f, 0x3e7f3e7f, 0x408c00, 0x452400, 0x0, 0x0, 0x0, 0x0, 0x0, 0x0, 0x0, 0x0
    .long 0x6d9800, 0x925800, 0x77, 0xa830, 0x3dff3eff, 0x3dff3eff, 0x6e6400, 0x72fc00, 0x0, 0x0, 0x0, 0x0, 0x0, 0x0, 0x0, 0x0
    .long 0x1ae800, 0x925800, 0x77, 0x2a90, 0x3eff3dff, 0x3eff3dff, 0x1bfc00, 0x209400, 0x0, 0x0, 0x0, 0x0, 0x0, 0x0, 0x0, 0x0
    .long 0x48d800, 0x925800, 0x77, 0x7070, 0x3e7f3e7f, 0x3e7f3e7f, 0x49d400, 0x4e6c00, 0x0, 0x0, 0x0, 0x0, 0x0, 0x0, 0x0, 0x0
    .long 0x6d9800, 0x925800, 0x77, 0xa890, 0x3eff3eff, 0x3eff3eff, 0x6eac00, 0x734400, 0x0, 0x0, 0x0, 0x0, 0x0, 0x0, 0x0, 0x0
    .long 0x241800, 0x925800, 0x77, 0x38c0, 0x3eff3dff, 0x3eff3dff, 0x255000, 0x29e800, 0x0, 0x0, 0x0, 0x0, 0x0, 0x0, 0x0, 0x0
    .long 0x5b3800, 0x925800, 0x77, 0x8cc0, 0x3eff3eff, 0x3eff3eff, 0x5c7000, 0x610800, 0x0, 0x0, 0x0, 0x0, 0x0, 0x0, 0x0, 0x0
    .long 0x1ae800, 0x925800, 0x77, 0x2a40, 0x3dff3dff, 0x3dff3dff, 0x1bc000, 0x205800, 0x0, 0x0, 0x0, 0x0, 0x0, 0x0, 0x0, 0x0
    .long 0x3fa800, 0x925800, 0x77, 0x6260, 0x3e7f3e7f, 0x3e7f3e7f, 0x409800, 0x453000, 0x0, 0x0, 0x0, 0x0, 0x0, 0x0, 0x0, 0x0
    .long 0x6d9800, 0x925800, 0x77, 0xa840, 0x3dff3eff, 0x3dff3eff, 0x6e7000, 0x730800, 0x0, 0x0, 0x0, 0x0, 0x0, 0x0, 0x0, 0x0
    .long 0x1ae800, 0x925800, 0x77, 0x2aa0, 0x3eff3dff, 0x3eff3dff, 0x1c0800, 0x20a000, 0x0, 0x0, 0x0, 0x0, 0x0, 0x0, 0x0, 0x0
    .long 0x48d800, 0x925800, 0x77, 0x7080, 0x3e7f3e7f, 0x3e7f3e7f, 0x49e000, 0x4e7800, 0x0, 0x0, 0x0, 0x0, 0x0, 0x0, 0x0, 0x0
    .long 0x6d9800, 0x925800, 0x77, 0xa8a0, 0x3eff3eff, 0x3eff3eff, 0x6eb800, 0x735000, 0x0, 0x0, 0x0, 0x0, 0x0, 0x0, 0x0, 0x0
    .long 0x241800, 0x925800, 0x77, 0x38d0, 0x3eff3dff, 0x3eff3dff, 0x255c00, 0x29f400, 0x0, 0x0, 0x0, 0x0, 0x0, 0x0, 0x0, 0x0
    .long 0x5b3800, 0x925800, 0x77, 0x8cd0, 0x3eff3eff, 0x3eff3eff, 0x5c7c00, 0x611400, 0x0, 0x0, 0x0, 0x0, 0x0, 0x0, 0x0, 0x0
    .long 0x1ae800, 0x925800, 0x77, 0x2a50, 0x3e7f3dff, 0x3e7f3dff, 0x1bcc00, 0x206400, 0x0, 0x0, 0x0, 0x0, 0x0, 0x0, 0x0, 0x0
    .long 0x48d800, 0x925800, 0x77, 0x7030, 0x3dff3e7f, 0x3dff3e7f, 0x49a400, 0x4e3c00, 0x0, 0x0, 0x0, 0x0, 0x0, 0x0, 0x0, 0x0
    .long 0x6d9800, 0x925800, 0x77, 0xa850, 0x3e7f3eff, 0x3e7f3eff, 0x6e7c00, 0x731400, 0x0, 0x0, 0x0, 0x0, 0x0, 0x0, 0x0, 0x0
    .long 0x241800, 0x925800, 0x77, 0x3870, 0x3e7f3dff, 0x3e7f3dff, 0x251400, 0x29ac00, 0x0, 0x0, 0x0, 0x0, 0x0, 0x0, 0x0, 0x0
    .long 0x48d800, 0x925800, 0x77, 0x7090, 0x3eff3e7f, 0x3eff3e7f, 0x49ec00, 0x4e8400, 0x0, 0x0, 0x0, 0x0, 0x0, 0x0, 0x0, 0x0
    .long 0x76c800, 0x925800, 0x77, 0xb670, 0x3e7f3eff, 0x3e7f3eff, 0x77c400, 0x7c5c00, 0x0, 0x0, 0x0, 0x0, 0x0, 0x0, 0x0, 0x0
    .long 0x2d4800, 0x925800, 0x77, 0x46b0, 0x3eff3e7f, 0x3eff3e7f, 0x2e7400, 0x330c00, 0x0, 0x0, 0x0, 0x0, 0x0, 0x0, 0x0, 0x0
    .long 0x646800, 0x925800, 0x77, 0x9ab0, 0x3eff3eff, 0x3eff3eff, 0x659400, 0x6a2c00, 0x0, 0x0, 0x0, 0x0, 0x0, 0x0, 0x0, 0x0
    .long 0x1ae800, 0x925800, 0x77, 0x2a60, 0x3e7f3dff, 0x3e7f3dff, 0x1bd800, 0x207000, 0x0, 0x0, 0x0, 0x0, 0x0, 0x0, 0x0, 0x0
    .long 0x48d800, 0x925800, 0x77, 0x7040, 0x3dff3e7f, 0x3dff3e7f, 0x49b000, 0x4e4800, 0x0, 0x0, 0x0, 0x0, 0x0, 0x0, 0x0, 0x0
    .long 0x6d9800, 0x925800, 0x77, 0xa860, 0x3e7f3eff, 0x3e7f3eff, 0x6e8800, 0x732000, 0x0, 0x0, 0x0, 0x0, 0x0, 0x0, 0x0, 0x0
    .long 0x241800, 0x925800, 0x77, 0x3880, 0x3e7f3dff, 0x3e7f3dff, 0x252000, 0x29b800, 0x0, 0x0, 0x0, 0x0, 0x0, 0x0, 0x0, 0x0
    .long 0x48d800, 0x925800, 0x77, 0x70a0, 0x3eff3e7f, 0x3eff3e7f, 0x49f800, 0x4e9000, 0x0, 0x0, 0x0, 0x0, 0x0, 0x0, 0x0, 0x0
    .long 0x76c800, 0x925800, 0x77, 0xb680, 0x3e7f3eff, 0x3e7f3eff, 0x77d000, 0x7c6800, 0x0, 0x0, 0x0, 0x0, 0x0, 0x0, 0x0, 0x0
    .long 0x2d4800, 0x925800, 0x77, 0x46c0, 0x3eff3e7f, 0x3eff3e7f, 0x2e8000, 0x331800, 0x0, 0x0, 0x0, 0x0, 0x0, 0x0, 0x0, 0x0
    .long 0x646800, 0x925800, 0x77, 0x9ac0, 0x3eff3eff, 0x3eff3eff, 0x65a000, 0x6a3800, 0x0, 0x0, 0x0, 0x0, 0x0, 0x0, 0x0, 0x0
    .long 0x241800, 0x925800, 0x77, 0x3830, 0x3dff3dff, 0x3dff3dff, 0x24e400, 0x297c00, 0x0, 0x0, 0x0, 0x0, 0x0, 0x0, 0x0, 0x0
    .long 0x48d800, 0x925800, 0x77, 0x7050, 0x3e7f3e7f, 0x3e7f3e7f, 0x49bc00, 0x4e5400, 0x0, 0x0, 0x0, 0x0, 0x0, 0x0, 0x0, 0x0
    .long 0x76c800, 0x925800, 0x77, 0xb630, 0x3dff3eff, 0x3dff3eff, 0x779400, 0x7c2c00, 0x0, 0x0, 0x0, 0x0, 0x0, 0x0, 0x0, 0x0
    .long 0x241800, 0x925800, 0x77, 0x3890, 0x3eff3dff, 0x3eff3dff, 0x252c00, 0x29c400, 0x0, 0x0, 0x0, 0x0, 0x0, 0x0, 0x0, 0x0
    .long 0x520800, 0x925800, 0x77, 0x7e70, 0x3e7f3e7f, 0x3e7f3eff, 0x530400, 0x579c00, 0x0, 0x0, 0x0, 0x0, 0x0, 0x0, 0x0, 0x0
    .long 0x76c800, 0x925800, 0x77, 0xb690, 0x3eff3eff, 0x3eff3eff, 0x77dc00, 0x7c7400, 0x0, 0x0, 0x0, 0x0, 0x0, 0x0, 0x0, 0x0
    .long 0x2d4800, 0x925800, 0x77, 0x46d0, 0x3eff3e7f, 0x3eff3e7f, 0x2e8c00, 0x332400, 0x0, 0x0, 0x0, 0x0, 0x0, 0x0, 0x0, 0x0
    .long 0x646800, 0x925800, 0x77, 0x9ad0, 0x3eff3eff, 0x3eff3eff, 0x65ac00, 0x6a4400, 0x0, 0x0, 0x0, 0x0, 0x0, 0x0, 0x0, 0x0
    .long 0x241800, 0x925800, 0x77, 0x3840, 0x3dff3dff, 0x3dff3dff, 0x24f000, 0x298800, 0x0, 0x0, 0x0, 0x0, 0x0, 0x0, 0x0, 0x0
    .long 0x48d800, 0x925800, 0x77, 0x7060, 0x3e7f3e7f, 0x3e7f3e7f, 0x49c800, 0x4e6000, 0x0, 0x0, 0x0, 0x0, 0x0, 0x0, 0x0, 0x0
    .long 0x76c800, 0x925800, 0x77, 0xb640, 0x3dff3eff, 0x3dff3eff, 0x77a000, 0x7c3800, 0x0, 0x0, 0x0, 0x0, 0x0, 0x0, 0x0, 0x0
    .long 0x241800, 0x925800, 0x77, 0x38a0, 0x3eff3dff, 0x3eff3dff, 0x253800, 0x29d000, 0x0, 0x0, 0x0, 0x0, 0x0, 0x0, 0x0, 0x0
    .long 0x520800, 0x925800, 0x77, 0x7e80, 0x3e7f3e7f, 0x3e7f3eff, 0x531000, 0x57a800, 0x0, 0x0, 0x0, 0x0, 0x0, 0x0, 0x0, 0x0
    .long 0x76c800, 0x925800, 0x77, 0xb6a0, 0x3eff3eff, 0x3eff3eff, 0x77e800, 0x7c8000, 0x0, 0x0, 0x0, 0x0, 0x0, 0x0, 0x0, 0x0
    .long 0x367800, 0x925800, 0x77, 0x54b0, 0x3eff3e7f, 0x3eff3e7f, 0x37a400, 0x3c3c00, 0x0, 0x0, 0x0, 0x0, 0x0, 0x0, 0x0, 0x0
    .long 0x6d9800, 0x925800, 0x77, 0xa8b0, 0x3eff3eff, 0x3eff3eff, 0x6ec400, 0x735c00, 0x0, 0x0, 0x0, 0x0, 0x0, 0x0, 0x0, 0x0
    .long 0x241800, 0x925800, 0x77, 0x3850, 0x3e7f3dff, 0x3e7f3dff, 0x24fc00, 0x299400, 0x0, 0x0, 0x0, 0x0, 0x0, 0x0, 0x0, 0x0
    .long 0x520800, 0x925800, 0x77, 0x7e30, 0x3dff3e7f, 0x3dff3eff, 0x52d400, 0x576c00, 0x0, 0x0, 0x0, 0x0, 0x0, 0x0, 0x0, 0x0
    .long 0x76c800, 0x925800, 0x77, 0xb650, 0x3e7f3eff, 0x3e7f3eff, 0x77ac00, 0x7c4400, 0x0, 0x0, 0x0, 0x0, 0x0, 0x0, 0x0, 0x0
    .long 0x2d4800, 0x925800, 0x77, 0x4670, 0x3e7f3e7f, 0x3e7f3e7f, 0x2e4400, 0x32dc00, 0x0, 0x0, 0x0, 0x0, 0x0, 0x0, 0x0, 0x0
    .long 0x520800, 0x925800, 0x77, 0x7e90, 0x3eff3e7f, 0x3eff3eff, 0x531c00, 0x57b400, 0x0, 0x0, 0x0, 0x0, 0x0, 0x0, 0x0, 0x0
    .long 0x7ff800, 0x925800, 0x77, 0xc470, 0x3e7f3eff, 0x3e7f3eff, 0x80f400, 0x858c00, 0x0, 0x0, 0x0, 0x0, 0x0, 0x0, 0x0, 0x0
    .long 0x367800, 0x925800, 0x77, 0x54c0, 0x3eff3e7f, 0x3eff3e7f, 0x37b000, 0x3c4800, 0x0, 0x0, 0x0, 0x0, 0x0, 0x0, 0x0, 0x0
    .long 0x6d9800, 0x925800, 0x77, 0xa8c0, 0x3eff3eff, 0x3eff3eff, 0x6ed000, 0x736800, 0x0, 0x0, 0x0, 0x0, 0x0, 0x0, 0x0, 0x0
    .long 0x241800, 0x925800, 0x77, 0x3860, 0x3e7f3dff, 0x3e7f3dff, 0x250800, 0x29a000, 0x0, 0x0, 0x0, 0x0, 0x0, 0x0, 0x0, 0x0
    .long 0x520800, 0x925800, 0x77, 0x7e40, 0x3dff3e7f, 0x3dff3eff, 0x52e000, 0x577800, 0x0, 0x0, 0x0, 0x0, 0x0, 0x0, 0x0, 0x0
    .long 0x76c800, 0x925800, 0x77, 0xb660, 0x3e7f3eff, 0x3e7f3eff, 0x77b800, 0x7c5000, 0x0, 0x0, 0x0, 0x0, 0x0, 0x0, 0x0, 0x0
    .long 0x2d4800, 0x925800, 0x77, 0x4680, 0x3e7f3e7f, 0x3e7f3e7f, 0x2e5000, 0x32e800, 0x0, 0x0, 0x0, 0x0, 0x0, 0x0, 0x0, 0x0
    .long 0x520800, 0x925800, 0x77, 0x7ea0, 0x3eff3e7f, 0x3eff3eff, 0x532800, 0x57c000, 0x0, 0x0, 0x0, 0x0, 0x0, 0x0, 0x0, 0x0
    .long 0x7ff800, 0x925800, 0x77, 0xc480, 0x3e7f3eff, 0x3e7f3eff, 0x810000, 0x859800, 0x0, 0x0, 0x0, 0x0, 0x0, 0x0, 0x0, 0x0
    .long 0x367800, 0x925800, 0x77, 0x54d0, 0x3eff3e7f, 0x3eff3e7f, 0x37bc00, 0x3c5400, 0x0, 0x0, 0x0, 0x0, 0x0, 0x0, 0x0, 0x0
    .long 0x6d9800, 0x925800, 0x77, 0xa8d0, 0x3eff3eff, 0x3eff3eff, 0x6edc00, 0x737400, 0x0, 0x0, 0x0, 0x0, 0x0, 0x0, 0x0, 0x0
    .long 0x2d4800, 0x925800, 0x77, 0x4630, 0x3dff3e7f, 0x3dff3e7f, 0x2e1400, 0x32ac00, 0x0, 0x0, 0x0, 0x0, 0x0, 0x0, 0x0, 0x0
    .long 0x520800, 0x925800, 0x77, 0x7e50, 0x3e7f3e7f, 0x3e7f3eff, 0x52ec00, 0x578400, 0x0, 0x0, 0x0, 0x0, 0x0, 0x0, 0x0, 0x0
    .long 0x7ff800, 0x925800, 0x77, 0xc430, 0x3dff3eff, 0x3dff3eff, 0x80c400, 0x855c00, 0x0, 0x0, 0x0, 0x0, 0x0, 0x0, 0x0, 0x0
    .long 0x2d4800, 0x925800, 0x77, 0x4690, 0x3eff3e7f, 0x3eff3e7f, 0x2e5c00, 0x32f400, 0x0, 0x0, 0x0, 0x0, 0x0, 0x0, 0x0, 0x0
    .long 0x5b3800, 0x925800, 0x77, 0x8c70, 0x3e7f3eff, 0x3e7f3eff, 0x5c3400, 0x60cc00, 0x0, 0x0, 0x0, 0x0, 0x0, 0x0, 0x0, 0x0
    .long 0x7ff800, 0x925800, 0x77, 0xc490, 0x3eff3eff, 0x3eff3eff, 0x810c00, 0x85a400, 0x0, 0x0, 0x0, 0x0, 0x0, 0x0, 0x0, 0x0
    .long 0x3fa800, 0x925800, 0x77, 0x62b0, 0x3eff3e7f, 0x3eff3e7f, 0x40d400, 0x456c00, 0x0, 0x0, 0x0, 0x0, 0x0, 0x0, 0x0, 0x0
    .long 0x76c800, 0x925800, 0x77, 0xb6b0, 0x3eff3eff, 0x3eff3eff, 0x77f400, 0x7c8c00, 0x0, 0x0, 0x0, 0x0, 0x0, 0x0, 0x0, 0x0
    .long 0x2d4800, 0x925800, 0x77, 0x4640, 0x3dff3e7f, 0x3dff3e7f, 0x2e2000, 0x32b800, 0x0, 0x0, 0x0, 0x0, 0x0, 0x0, 0x0, 0x0
    .long 0x520800, 0x925800, 0x77, 0x7e60, 0x3e7f3e7f, 0x3e7f3eff, 0x52f800, 0x579000, 0x0, 0x0, 0x0, 0x0, 0x0, 0x0, 0x0, 0x0
    .long 0x7ff800, 0x925800, 0x77, 0xc440, 0x3dff3eff, 0x3dff3eff, 0x80d000, 0x856800, 0x0, 0x0, 0x0, 0x0, 0x0, 0x0, 0x0, 0x0
    .long 0x2d4800, 0x925800, 0x77, 0x46a0, 0x3eff3e7f, 0x3eff3e7f, 0x2e6800, 0x330000, 0x0, 0x0, 0x0, 0x0, 0x0, 0x0, 0x0, 0x0
    .long 0x5b3800, 0x925800, 0x77, 0x8c80, 0x3e7f3eff, 0x3e7f3eff, 0x5c4000, 0x60d800, 0x0, 0x0, 0x0, 0x0, 0x0, 0x0, 0x0, 0x0
    .long 0x7ff800, 0x925800, 0x77, 0xc4a0, 0x3eff3eff, 0x3eff3eff, 0x811800, 0x85b000, 0x0, 0x0, 0x0, 0x0, 0x0, 0x0, 0x0, 0x0
    .long 0x3fa800, 0x925800, 0x77, 0x62c0, 0x3eff3e7f, 0x3eff3e7f, 0x40e000, 0x457800, 0x0, 0x0, 0x0, 0x0, 0x0, 0x0, 0x0, 0x0
    .long 0x76c800, 0x925800, 0x77, 0xb6c0, 0x3eff3eff, 0x3eff3eff, 0x780000, 0x7c9800, 0x0, 0x0, 0x0, 0x0, 0x0, 0x0, 0x0, 0x0
    .long 0x2d4800, 0x925800, 0x77, 0x4650, 0x3e7f3e7f, 0x3e7f3e7f, 0x2e2c00, 0x32c400, 0x0, 0x0, 0x0, 0x0, 0x0, 0x0, 0x0, 0x0
    .long 0x5b3800, 0x925800, 0x77, 0x8c30, 0x3dff3eff, 0x3dff3eff, 0x5c0400, 0x609c00, 0x0, 0x0, 0x0, 0x0, 0x0, 0x0, 0x0, 0x0
    .long 0x7ff800, 0x925800, 0x77, 0xc450, 0x3e7f3eff, 0x3e7f3eff, 0x80dc00, 0x857400, 0x0, 0x0, 0x0, 0x0, 0x0, 0x0, 0x0, 0x0
    .long 0x367800, 0x925800, 0x77, 0x5470, 0x3e7f3e7f, 0x3e7f3e7f, 0x377400, 0x3c0c00, 0x0, 0x0, 0x0, 0x0, 0x0, 0x0, 0x0, 0x0
    .long 0x5b3800, 0x925800, 0x77, 0x8c90, 0x3eff3eff, 0x3eff3eff, 0x5c4c00, 0x60e400, 0x0, 0x0, 0x0, 0x0, 0x0, 0x0, 0x0, 0x0
    .long 0x892800, 0x925800, 0x77, 0xd270, 0x3e7f3eff, 0x3e7f3eff, 0x8a2400, 0x8ebc00, 0x0, 0x0, 0x0, 0x0, 0x0, 0x0, 0x0, 0x0
    .long 0x3fa800, 0x925800, 0x77, 0x62d0, 0x3eff3e7f, 0x3eff3e7f, 0x40ec00, 0x458400, 0x0, 0x0, 0x0, 0x0, 0x0, 0x0, 0x0, 0x0
    .long 0x76c800, 0x925800, 0x77, 0xb6d0, 0x3eff3eff, 0x3eff3eff, 0x780c00, 0x7ca400, 0x0, 0x0, 0x0, 0x0, 0x0, 0x0, 0x0, 0x0
    .long 0x2d4800, 0x925800, 0x77, 0x4660, 0x3e7f3e7f, 0x3e7f3e7f, 0x2e3800, 0x32d000, 0x0, 0x0, 0x0, 0x0, 0x0, 0x0, 0x0, 0x0
    .long 0x5b3800, 0x925800, 0x77, 0x8c40, 0x3dff3eff, 0x3dff3eff, 0x5c1000, 0x60a800, 0x0, 0x0, 0x0, 0x0, 0x0, 0x0, 0x0, 0x0
    .long 0x7ff800, 0x925800, 0x77, 0xc460, 0x3e7f3eff, 0x3e7f3eff, 0x80e800, 0x858000, 0x0, 0x0, 0x0, 0x0, 0x0, 0x0, 0x0, 0x0
    .long 0x367800, 0x925800, 0x77, 0x5480, 0x3e7f3e7f, 0x3e7f3e7f, 0x378000, 0x3c1800, 0x0, 0x0, 0x0, 0x0, 0x0, 0x0, 0x0, 0x0
    .long 0x5b3800, 0x925800, 0x77, 0x8ca0, 0x3eff3eff, 0x3eff3eff, 0x5c5800, 0x60f000, 0x0, 0x0, 0x0, 0x0, 0x0, 0x0, 0x0, 0x0
    .long 0x892800, 0x925800, 0x77, 0xd280, 0x3e7f3eff, 0x3e7f3eff, 0x8a3000, 0x8ec800, 0x0, 0x0, 0x0, 0x0, 0x0, 0x0, 0x0, 0x0
    .long 0x48d800, 0x925800, 0x77, 0x70b0, 0x3eff3e7f, 0x3eff3e7f, 0x4a0400, 0x4e9c00, 0x0, 0x0, 0x0, 0x0, 0x0, 0x0, 0x0, 0x0
    .long 0x7ff800, 0x925800, 0x77, 0xc4b0, 0x3eff3eff, 0x3eff3eff, 0x812400, 0x85bc00, 0x0, 0x0, 0x0, 0x0, 0x0, 0x0, 0x0, 0x0
    .long 0x367800, 0x925800, 0x77, 0x5430, 0x3dff3e7f, 0x3dff3e7f, 0x374400, 0x3bdc00, 0x0, 0x0, 0x0, 0x0, 0x0, 0x0, 0x0, 0x0
    .long 0x5b3800, 0x925800, 0x77, 0x8c50, 0x3e7f3eff, 0x3e7f3eff, 0x5c1c00, 0x60b400, 0x0, 0x0, 0x0, 0x0, 0x0, 0x0, 0x0, 0x0
    .long 0x892800, 0x925800, 0x77, 0xd230, 0x3dff3eff, 0x3dff3eff, 0x89f400, 0x8e8c00, 0x0, 0x0, 0x0, 0x0, 0x0, 0x0, 0x0, 0x0
    .long 0x367800, 0x925800, 0x77, 0x5490, 0x3eff3e7f, 0x3eff3e7f, 0x378c00, 0x3c2400, 0x0, 0x0, 0x0, 0x0, 0x0, 0x0, 0x0, 0x0
    .long 0x646800, 0x925800, 0x77, 0x9a70, 0x3e7f3eff, 0x3e7f3eff, 0x656400, 0x69fc00, 0x0, 0x0, 0x0, 0x0, 0x0, 0x0, 0x0, 0x0
    .long 0x892800, 0x925800, 0x77, 0xd290, 0x3eff3eff, 0x3eff3eff, 0x8a3c00, 0x8ed400, 0x0, 0x0, 0x0, 0x0, 0x0, 0x0, 0x0, 0x0
    .long 0x48d800, 0x925800, 0x77, 0x70c0, 0x3eff3e7f, 0x3eff3e7f, 0x4a1000, 0x4ea800, 0x0, 0x0, 0x0, 0x0, 0x0, 0x0, 0x0, 0x0
    .long 0x7ff800, 0x925800, 0x77, 0xc4c0, 0x3eff3eff, 0x3eff3eff, 0x813000, 0x85c800, 0x0, 0x0, 0x0, 0x0, 0x0, 0x0, 0x0, 0x0
    .long 0x367800, 0x925800, 0x77, 0x5440, 0x3dff3e7f, 0x3dff3e7f, 0x375000, 0x3be800, 0x0, 0x0, 0x0, 0x0, 0x0, 0x0, 0x0, 0x0
    .long 0x5b3800, 0x925800, 0x77, 0x8c60, 0x3e7f3eff, 0x3e7f3eff, 0x5c2800, 0x60c000, 0x0, 0x0, 0x0, 0x0, 0x0, 0x0, 0x0, 0x0
    .long 0x892800, 0x925800, 0x77, 0xd240, 0x3dff3eff, 0x3dff3eff, 0x8a0000, 0x8e9800, 0x0, 0x0, 0x0, 0x0, 0x0, 0x0, 0x0, 0x0
    .long 0x367800, 0x925800, 0x77, 0x54a0, 0x3eff3e7f, 0x3eff3e7f, 0x379800, 0x3c3000, 0x0, 0x0, 0x0, 0x0, 0x0, 0x0, 0x0, 0x0
    .long 0x646800, 0x925800, 0x77, 0x9a80, 0x3e7f3eff, 0x3e7f3eff, 0x657000, 0x6a0800, 0x0, 0x0, 0x0, 0x0, 0x0, 0x0, 0x0, 0x0
    .long 0x892800, 0x925800, 0x77, 0xd2a0, 0x3eff3eff, 0x3eff3eff, 0x8a4800, 0x8ee000, 0x0, 0x0, 0x0, 0x0, 0x0, 0x0, 0x0, 0x0
    .long 0x48d800, 0x925800, 0x77, 0x70d0, 0x3eff3e7f, 0x3eff3e7f, 0x4a1c00, 0x4eb400, 0x0, 0x0, 0x0, 0x0, 0x0, 0x0, 0x0, 0x0
    .long 0x7ff800, 0x925800, 0x77, 0xc4d0, 0x3eff3eff, 0x3eff3eff, 0x813c00, 0x85d400, 0x0, 0x0, 0x0, 0x0, 0x0, 0x0, 0x0, 0x0
    .long 0x367800, 0x925800, 0x77, 0x5450, 0x3e7f3e7f, 0x3e7f3e7f, 0x375c00, 0x3bf400, 0x0, 0x0, 0x0, 0x0, 0x0, 0x0, 0x0, 0x0
    .long 0x646800, 0x925800, 0x77, 0x9a30, 0x3dff3eff, 0x3dff3eff, 0x653400, 0x69cc00, 0x0, 0x0, 0x0, 0x0, 0x0, 0x0, 0x0, 0x0
    .long 0x892800, 0x925800, 0x77, 0xd250, 0x3e7f3eff, 0x3e7f3eff, 0x8a0c00, 0x8ea400, 0x0, 0x0, 0x0, 0x0, 0x0, 0x0, 0x0, 0x0
    .long 0x3fa800, 0x925800, 0x77, 0x6270, 0x3e7f3e7f, 0x3e7f3e7f, 0x40a400, 0x453c00, 0x0, 0x0, 0x0, 0x0, 0x0, 0x0, 0x0, 0x0
    .long 0x646800, 0x925800, 0x77, 0x9a90, 0x3eff3eff, 0x3eff3eff, 0x657c00, 0x6a1400, 0x0, 0x0, 0x0, 0x0, 0x0, 0x0, 0x0, 0x0
    .long 0x1ae800, 0x925800, 0x77, 0x2ab0, 0x3eff3dff, 0x3eff3dff, 0x1c1400, 0x20ac00, 0x0, 0x0, 0x0, 0x0, 0x0, 0x0, 0x0, 0x0
    .long 0x520800, 0x925800, 0x77, 0x7eb0, 0x3eff3e7f, 0x3eff3eff, 0x533400, 0x57cc00, 0x0, 0x0, 0x0, 0x0, 0x0, 0x0, 0x0, 0x0
    .long 0x892800, 0x925800, 0x77, 0xd2b0, 0x3eff3eff, 0x3eff3eff, 0x8a5400, 0x8eec00, 0x0, 0x0, 0x0, 0x0, 0x0, 0x0, 0x0, 0x0
    .long 0x367800, 0x925800, 0x77, 0x5460, 0x3e7f3e7f, 0x3e7f3e7f, 0x376800, 0x3c0000, 0x0, 0x0, 0x0, 0x0, 0x0, 0x0, 0x0, 0x0
    .long 0x646800, 0x925800, 0x77, 0x9a40, 0x3dff3eff, 0x3dff3eff, 0x654000, 0x69d800, 0x0, 0x0, 0x0, 0x0, 0x0, 0x0, 0x0, 0x0
    .long 0x892800, 0x925800, 0x77, 0xd260, 0x3e7f3eff, 0x3e7f3eff, 0x8a1800, 0x8eb000, 0x0, 0x0, 0x0, 0x0, 0x0, 0x0, 0x0, 0x0
    .long 0x3fa800, 0x925800, 0x77, 0x6280, 0x3e7f3e7f, 0x3e7f3e7f, 0x40b000, 0x454800, 0x0, 0x0, 0x0, 0x0, 0x0, 0x0, 0x0, 0x0
    .long 0x646800, 0x925800, 0x77, 0x9aa0, 0x3eff3eff, 0x3eff3eff, 0x658800, 0x6a2000, 0x0, 0x0, 0x0, 0x0, 0x0, 0x0, 0x0, 0x0
    .long 0x1ae800, 0x925800, 0x77, 0x2ac0, 0x3eff3dff, 0x3eff3dff, 0x1c2000, 0x20b800, 0x0, 0x0, 0x0, 0x0, 0x0, 0x0, 0x0, 0x0
    .long 0x520800, 0x925800, 0x77, 0x7ec0, 0x3eff3e7f, 0x3eff3eff, 0x534000, 0x57d800, 0x0, 0x0, 0x0, 0x0, 0x0, 0x0, 0x0, 0x0
    .long 0x892800, 0x925800, 0x77, 0xd2c0, 0x3eff3eff, 0x3eff3eff, 0x8a6000, 0x8ef800, 0x0, 0x0, 0x0, 0x0, 0x0, 0x0, 0x0, 0x0
    .long 0x3fa800, 0x925800, 0x77, 0x6230, 0x3dff3e7f, 0x3dff3e7f, 0x407400, 0x450c00, 0x0, 0x0, 0x0, 0x0, 0x0, 0x0, 0x0, 0x0
    .long 0x646800, 0x925800, 0x77, 0x9a50, 0x3e7f3eff, 0x3e7f3eff, 0x654c00, 0x69e400, 0x0, 0x0, 0x0, 0x0, 0x0, 0x0, 0x0, 0x0
    .long 0x1ae800, 0x925800, 0x77, 0x2a70, 0x3e7f3dff, 0x3e7f3dff, 0x1be400, 0x207c00, 0x0, 0x0, 0x0, 0x0, 0x0, 0x0, 0x0, 0x0
    .long 0x3fa800, 0x925800, 0x77, 0x6290, 0x3eff3e7f, 0x3eff3e7f, 0x40bc00, 0x455400, 0x0, 0x0, 0x0, 0x0, 0x0, 0x0, 0x0, 0x0
    .long 0x6d9800, 0x925800, 0x77, 0xa870, 0x3e7f3eff, 0x3e7f3eff, 0x6e9400, 0x732c00, 0x0, 0x0, 0x0, 0x0, 0x0, 0x0, 0x0, 0x0
    .long 0x1ae800, 0x925800, 0x77, 0x2ad0, 0x3eff3dff, 0x3eff3dff, 0x1c2c00, 0x20c400, 0x0, 0x0, 0x0, 0x0, 0x0, 0x0, 0x0, 0x0
    .long 0x520800, 0x925800, 0x77, 0x7ed0, 0x3eff3e7f, 0x3eff3eff, 0x534c00, 0x57e400, 0x0, 0x0, 0x0, 0x0, 0x0, 0x0, 0x0, 0x0
    .long 0x892800, 0x925800, 0x77, 0xd2d0, 0x3eff3eff, 0x3eff3eff, 0x8a6c00, 0x8f0400, 0x0, 0x0, 0x0, 0x0, 0x0, 0x0, 0x0, 0x0
.section .rodata,"a"
.p2align 6
.amdhsa_kernel standalone__deformable_dcnv1__vision_kernel
  .amdhsa_next_free_vgpr 512
  .amdhsa_next_free_sgpr 102
  .amdhsa_accum_offset 256
  .amdhsa_group_segment_fixed_size 0
  .amdhsa_kernarg_size 48
  .amdhsa_user_sgpr_count 2
  .amdhsa_user_sgpr_kernarg_segment_ptr 1
  .amdhsa_system_sgpr_workgroup_id_x 1
  .amdhsa_float_denorm_mode_32 3
.end_amdhsa_kernel
```

```asm
; @launch grid=(256,1,1) block=(256,1,1) lds=163840
.amdgcn_target "amdgcn-amd-amdhsa--gfx950"
.text
.globl standalone__deformable_dcnv1__vision_kernel
.p2align 12
.p2align 8
.type standalone__deformable_dcnv1__vision_kernel,@function
standalone__deformable_dcnv1__vision_kernel:
    s_cmp_ge_u32 s2, 256
    s_cbranch_scc1 L_end
    s_getpc_b64 s[40:41]
L_pc:
    v_and_b32 v32, 63, v0
    s_lshl_b32 s47, s2, 6
    v_lshlrev_b32 v13, 7, v32
    s_add_u32 s47, s47, L_runtab-L_pc
    s_add_u32 s54, s47, 32
    s_load_dwordx8 s[20:27], s[40:41], s47
    s_load_dwordx8 s[68:75], s[40:41], s54
    s_load_dwordx2 s[12:13], s[0:1], 16
    s_load_dwordx2 s[4:5], s[0:1], 0
    s_load_dwordx2 s[8:9], s[0:1], 8
    s_load_dwordx2 s[16:17], s[0:1], 24
    v_lshrrev_b32 v33, 6, v0
    v_lshlrev_b32 v6, 4, v32
    v_readfirstlane_b32 s28, v33
    v_add_u32 v12, L_ctab-L_pc, v6
    s_lshr_b32 s47, s2, 3
    global_load_dwordx4 v[16:19], v12, s[40:41]
    s_bfe_u32 s48, s2, 0x10007
    s_lshl1_add_u32 s49, s28, s48
    s_lshl_b32 s49, s49, 13
    s_and_b32 s48, s47, 15
    v_add_u32 v33, s49, v13
    v_min_u32 v33, L_cold-L_pc, v33
    s_lshl_b32 exec_lo, 0x10001, s48
    s_mov_b32 exec_hi, exec_lo
    global_load_dword v15, v33, s[40:41]
    s_mov_b64 exec, -1
    s_mov_b32 s6, 9633792
    s_mov_b32 s7, 0x00020000
    s_mov_b32 s10, 1806336
    s_mov_b32 s11, s7
    s_mov_b32 s14, 165888
    s_mov_b32 s15, s7
    s_mov_b32 s18, s6
    s_mov_b32 s19, s7
    s_and_b32 s29, s28, 1
    s_lshr_b32 s30, s28, 1
    s_lshl2_add_u32 s49, s47, s28
    s_mulk_i32 s49, 1280
    s_addk_i32 s49, 12288
    s_cmpk_lt_u32 s2, 38
    s_cselect_b32 s47, 40, 16
    s_cmpk_lt_u32 s2, 113
    s_cselect_b32 s47, s47, 0
    s_cmp_eq_u32 s28, 3
    s_cselect_b32 s47, s47, 0
    v_subrev_u32 v35, s47, v0
    s_lshl_b32 s33, s28, 6
    v_mul_u32_u24 v36, 5462, v35
    s_mul_i32 s44, s28, 3104
    v_lshrrev_b32 v36, 16, v36
    s_sub_u32 s33, s33, s47
    v_mad_i32_i24 v33, v36, -12, v35
    v_bfe_u32 v34, v36, 2, 2
    s_lshl_b32 s33, s33, 4
    v_xor_b32 v33, v33, v34
    s_mul_i32 s46, s28, 3072
    v_lshlrev_b32 v8, 4, v33
    s_movk_i32 s48, 223
    v_mov_b32 v35, 2130706432
    s_cmpk_lt_u32 s2, 113
    v_add_u32 v7, s46, v6
    s_cbranch_scc1 L_X
    v_cmp_gt_u32 vcc, 18, v36
    s_add_u32 s44, s44, 65536
    s_mul_i32 s45, s30, 93120
    s_sub_u32 s45, s44, s45
    s_cmp_eq_u32 s30, 0
    v_cndmask_b32 v8, v35, v8, vcc
    s_waitcnt lgkmcnt(0)
    s_cselect_b32 s31, s26, s27
    s_cselect_b32 s35, s24, s25
    s_mov_b64 exec, 0x3ff
    buffer_load_dword v13, v13, s[12:15], s49 offen
    s_mov_b64 exec, -1
    s_add_u32 m0, s44, 0
    s_mov_b32 s46, 0
    buffer_load_dwordx4 v7, s[12:15], s46 offen offset:0 lds
    buffer_load_dwordx4 v7, s[12:15], s46 offen offset:1024 lds
    buffer_load_dwordx4 v7, s[12:15], s46 offen offset:2048 lds
    s_and_b32 s47, s23, 0xff
    v_add3_u32 v34, v36, s47, -1
    v_min_u32 v34, s48, v34
    v_mul_u32_u24 v34, 192, v34
    v_add_u32 v8, v34, v8
    s_add_u32 m0, s44, 12416
    s_mov_b32 s46, 12288
    buffer_load_dwordx4 v7, s[12:15], s46 offen offset:0 lds
    buffer_load_dwordx4 v7, s[12:15], s46 offen offset:1024 lds
    buffer_load_dwordx4 v7, s[12:15], s46 offen offset:2048 lds
    s_add_u32 m0, s33, 0
    s_add_u32 s56, s20, 0
    buffer_load_dwordx4 v8, s[4:7], s56 offen lds
    s_add_u32 m0, s33, 28672
    s_add_u32 s63, s20, 301056
    buffer_load_dwordx4 v8, s[4:7], s63 offen lds
    s_add_u32 m0, s33, 4096
    s_add_u32 s57, s20, 43008
    buffer_load_dwordx4 v8, s[4:7], s57 offen lds
    s_add_u32 m0, s33, 32768
    s_add_u32 s64, s20, 344064
    buffer_load_dwordx4 v8, s[4:7], s64 offen lds
    s_add_u32 m0, s33, 8192
    s_add_u32 s58, s20, 86016
    buffer_load_dwordx4 v8, s[4:7], s58 offen lds
    s_add_u32 m0, s33, 36864
    s_add_u32 s65, s20, 387072
    buffer_load_dwordx4 v8, s[4:7], s65 offen lds
    s_branch L_N2
L_X:
    s_cmpk_ge_u32 s2, 38
    s_cselect_b32 s60, 1, 0
    s_cselect_b32 s43, 1, 5
    s_cselect_b32 s42, 0, -9
    s_sub_u32 s47, s2, 19
    s_movk_i32 s36, 192
    s_mov_b32 s38, 43008
    s_movk_i32 s39, 8064
    s_cmpk_lt_u32 s47, 40
    s_cselect_b32 s56, 1, 0
    s_cselect_b32 s55, s36, s38
    s_cselect_b32 s2, s38, s36
    s_cselect_b32 s37, 36, s39
    s_cselect_b32 s39, s39, 36
    s_lshl_b32 s47, s60, 10
    v_add_u32 v42, s47, v12
    global_load_dwordx4 v[164:167], v42, s[40:41] offset:1024
    global_load_dwordx4 v[168:171], v42, s[40:41] offset:2048
    v_mul_u32_u24 v40, 86, v32
    s_lshl2_add_u32 s47, s39, -36
    v_mul_u32_u24 v37, 12, v32
    s_mul_i32 s43, s43, s37
    v_lshrrev_b32 v40, 8, v40
    s_lshl_b32 s36, s39, 4
    s_mul_i32 s42, s42, s37
    v_lshrrev_b32 v41, 2, v40
    v_mad_u32_u24 v37, v40, s47, v37
    s_sub_u32 s43, s43, s36
    v_lshrrev_b32 v34, 3, v40
    v_and_b32 v33, 4, v41
    v_mad_i32_i24 v37, v41, s43, v37
    s_lshl_b32 s37, s37, 1
    v_lshl_or_b32 v38, v33, 4, v41
    v_mad_i32_i24 v37, v34, s42, v37
    s_lshl_b32 s37, s37, s60
    v_add_u32 v33, s28, v41
    v_mad_i32_i24 v39, v40, -3, v32
    v_and_b32 v33, 3, v33
    v_and_b32 v40, 3, v40
    v_mad_u32_u24 v37, v33, s39, v37
    v_lshl_add_u32 v40, v40, 2, v33
    s_cmp_eq_u32 s60, 0
    s_cbranch_scc0 L_Xz
    s_mul_i32 s47, s28, 11872
    v_mov_b32 v100, 0
    v_mov_b32 v101, 0
    v_mov_b32 v102, 0
    v_mov_b32 v103, 0
    v_add_u32 v104, s47, v6
    ds_write_b128 v104, v[100:103] offset:41472
    ds_write_b128 v104, v[100:103] offset:42496
    ds_write_b128 v104, v[100:103] offset:43520
    ds_write_b128 v104, v[100:103] offset:44544
    ds_write_b128 v104, v[100:103] offset:45568
L_Xz:
    s_waitcnt lgkmcnt(0)
    v_cmp_gt_u32 vcc, s75, v38
    v_add_u32 v38, 4, v38
    s_mov_b32 s32, s74
    v_cndmask_b32 v34, v35, v37, vcc
    buffer_load_dwordx3 v[232:234], v34, s[8:11], s32 offen
    v_cmp_gt_u32 vcc, s75, v38
    v_add_u32 v38, 4, v38
    s_add_u32 s32, s32, s37
    v_cndmask_b32 v34, v35, v37, vcc
    buffer_load_dwordx3 v[236:238], v34, s[8:11], s32 offen
    v_cmp_gt_u32 vcc, s75, v38
    v_add_u32 v38, 4, v38
    s_add_u32 s32, s32, s37
    v_cndmask_b32 v34, v35, v37, vcc
    buffer_load_dwordx3 v[240:242], v34, s[8:11], s32 offen
    s_bfe_i32 s43, s23, 0x90014
    s_mov_b64 exec, 0x3ff
    buffer_load_dword v13, v13, s[12:15], s49 offen
    s_mov_b64 exec, -1
    v_add_u32 v34, s43, v36
    s_cmp_eq_u32 s60, 0
    v_med3_i32 v34, v34, 0, s48
    v_mad_u32_u24 v8, v34, s2, v8
    s_cbranch_scc0 L_Xp
    s_add_u32 m0, s44, 88992
    s_bfe_u32 s46, s24, 0x40000
    s_mul_i32 s46, s46, 18432
    buffer_load_dwordx4 v7, s[12:15], s46 offen offset:0 lds
    s_branch L_S
L_Xp:
    s_add_u32 m0, s33, 0
    s_max_i32 s47, s20, 0
    s_add_u32 s20, s20, s55
    buffer_load_dwordx4 v8, s[4:7], s47 offen lds
    s_add_u32 m0, s33, 3904
    s_max_i32 s47, s20, 0
    s_add_u32 s20, s20, s55
    buffer_load_dwordx4 v8, s[4:7], s47 offen lds
    s_branch L_P
L_N2:
    s_add_u32 s59, s20, 129024
    s_add_u32 s60, s20, 172032
    s_add_u32 s61, s20, 215040
    s_add_u32 s62, s20, 258048
    s_add_u32 s66, s20, 430080
    s_add_u32 s67, s20, 473088
    s_add_u32 s68, s20, 516096
    s_add_u32 s69, s20, 559104
    s_add_u32 s70, s20, 602112
    s_add_u32 s71, s20, 645120
    s_min_i32 s71, s71, s21
    s_lshl_b32 s48, s29, 7
    s_lshl_b32 s49, s29, 5
    s_add_u32 s47, s48, 65536
    s_waitcnt vmcnt(14)
    v_add_u32_sdwa v4, s47, v16 dst_sel:DWORD dst_unused:UNUSED_PAD src0_sel:DWORD src1_sel:WORD_0
    s_add_u32 s47, s49, 65536
    v_add_u32_sdwa v5, s47, v16 dst_sel:DWORD dst_unused:UNUSED_PAD src0_sel:DWORD src1_sel:WORD_0
    s_mul_i32 s47, s30, 28672
    v_add_u32_sdwa v1, s47, v16 dst_sel:DWORD dst_unused:UNUSED_PAD src0_sel:DWORD src1_sel:WORD_1
    v_add_u32_sdwa v2, s47, v17 dst_sel:DWORD dst_unused:UNUSED_PAD src0_sel:DWORD src1_sel:WORD_0
    v_add_u32_sdwa v3, s47, v17 dst_sel:DWORD dst_unused:UNUSED_PAD src0_sel:DWORD src1_sel:WORD_1
    v_mov_b32 v14, v19
    s_mul_i32 s32, s31, 3
    s_lshr_b32 s32, s32, 4
    s_cmp_eq_u32 s28, 1
    s_cbranch_scc0 L_N2_n0
    s_call_b64 s[78:79], L_N2_t0
L_N2_n0:
    s_cmp_eq_u32 s28, 2
    s_cbranch_scc0 L_N2_n1
    s_call_b64 s[78:79], L_N2_t1
L_N2_n1:
    s_waitcnt vmcnt(6)
    s_barrier
    ds_read_b64_tr_b16 a[0:1], v4 offset:0
    ds_read_b64_tr_b16 a[2:3], v4 offset:768
    ds_read_b64_tr_b16 a[4:5], v4 offset:32
    ds_read_b64_tr_b16 a[6:7], v4 offset:800
    ds_read_b64_tr_b16 a[8:9], v5 offset:64
    ds_read_b64_tr_b16 a[10:11], v5 offset:832
    ds_read_b64_tr_b16 a[12:13], v4 offset:6208
    ds_read_b64_tr_b16 a[14:15], v4 offset:6976
    ds_read_b64_tr_b16 a[16:17], v4 offset:6240
    ds_read_b64_tr_b16 a[18:19], v4 offset:7008
    ds_read_b64_tr_b16 a[20:21], v5 offset:6272
    ds_read_b64_tr_b16 a[22:23], v5 offset:7040
    ds_read_b64_tr_b16 a[24:25], v4 offset:12416
    ds_read_b64_tr_b16 a[26:27], v4 offset:13184
    ds_read_b64_tr_b16 a[28:29], v4 offset:12448
    ds_read_b64_tr_b16 a[30:31], v4 offset:13216
    ds_read_b64_tr_b16 a[32:33], v5 offset:12480
    ds_read_b64_tr_b16 a[34:35], v5 offset:13248
    ds_read_b64_tr_b16 a[36:37], v4 offset:18624
    ds_read_b64_tr_b16 a[38:39], v4 offset:19392
    ds_read_b64_tr_b16 a[40:41], v4 offset:18656
    ds_read_b64_tr_b16 a[42:43], v4 offset:19424
    ds_read_b64_tr_b16 a[44:45], v5 offset:18688
    ds_read_b64_tr_b16 a[46:47], v5 offset:19456
    s_add_u32 m0, s44, 24832
    s_mov_b32 s46, 24576
    buffer_load_dwordx4 v7, s[12:15], s46 offen offset:0 lds
    buffer_load_dwordx4 v7, s[12:15], s46 offen offset:1024 lds
    buffer_load_dwordx4 v7, s[12:15], s46 offen offset:2048 lds
    s_add_u32 m0, s44, 37248
    s_mov_b32 s46, 36864
    buffer_load_dwordx4 v7, s[12:15], s46 offen offset:0 lds
    buffer_load_dwordx4 v7, s[12:15], s46 offen offset:1024 lds
    buffer_load_dwordx4 v7, s[12:15], s46 offen offset:2048 lds
    s_add_u32 m0, s44, 49664
    s_mov_b32 s46, 49152
    buffer_load_dwordx4 v7, s[12:15], s46 offen offset:0 lds
    buffer_load_dwordx4 v7, s[12:15], s46 offen offset:1024 lds
    buffer_load_dwordx4 v7, s[12:15], s46 offen offset:2048 lds
    s_waitcnt vmcnt(9)
    s_barrier
    ds_read_b128 v[80:83], v1 offset:0
    ds_read_b128 v[116:119], v1 offset:4096
    ds_read_b128 v[152:155], v1 offset:8192
    ds_read_b128 v[84:87], v1 offset:64
    ds_read_b128 v[120:123], v1 offset:4160
    ds_read_b128 v[156:159], v1 offset:8256
    s_waitcnt lgkmcnt(5)
    v_mfma_f32_16x16x32_bf16 v[44:47], a[0:3], v[80:83], 0
    ds_read_b128 v[88:91], v1 offset:128
    v_mfma_f32_16x16x32_bf16 v[48:51], a[4:7], v[80:83], 0
    s_add_u32 m0, s33, 12288
    v_mfma_f32_16x16x32_bf16 v[52:55], a[8:11], v[80:83], 0
    buffer_load_dwordx4 v8, s[4:7], s59 offen lds
    s_waitcnt lgkmcnt(5)
    v_mfma_f32_16x16x32_bf16 v[64:67], a[8:11], v[116:119], 0
    ds_read_b128 v[124:127], v1 offset:4224
    v_mfma_f32_16x16x32_bf16 v[60:63], a[4:7], v[116:119], 0
    ds_read_b128 v[160:163], v1 offset:8320
    v_mfma_f32_16x16x32_bf16 v[56:59], a[0:3], v[116:119], 0
    s_add_u32 m0, s33, 40960
    ds_read_b128 v[92:95], v2 offset:0
    ds_read_b128 v[128:131], v2 offset:4096
    ds_read_b128 v[164:167], v2 offset:8192
    s_waitcnt lgkmcnt(7)
    v_mfma_f32_16x16x32_bf16 v[68:71], a[0:3], v[152:155], 0
    buffer_load_dwordx4 v8, s[4:7], s66 offen lds
    s_waitcnt vmcnt(8)
    s_barrier
    v_mfma_f32_16x16x32_bf16 v[72:75], a[4:7], v[152:155], 0
    ds_read_b128 v[96:99], v2 offset:64
    v_mfma_f32_16x16x32_bf16 v[76:79], a[8:11], v[152:155], 0
    ds_read_b64_tr_b16 a[48:49], v4 offset:24832
    v_mfma_f32_16x16x32_bf16 v[44:47], a[12:15], v[84:87], v[44:47]
    s_add_u32 m0, s44, 62080
    s_mov_b32 s46, 61440
    v_mfma_f32_16x16x32_bf16 v[48:51], a[16:19], v[84:87], v[48:51]
    buffer_load_dwordx4 v7, s[12:15], s46 offen offset:0 lds
    v_mfma_f32_16x16x32_bf16 v[52:55], a[20:23], v[84:87], v[52:55]
    ds_read_b64_tr_b16 a[50:51], v4 offset:25600
    v_mfma_f32_16x16x32_bf16 v[64:67], a[20:23], v[120:123], v[64:67]
    ds_read_b64_tr_b16 a[52:53], v4 offset:24864
    v_mfma_f32_16x16x32_bf16 v[60:63], a[16:19], v[120:123], v[60:63]
    ds_read_b64_tr_b16 a[54:55], v4 offset:25632
    v_mfma_f32_16x16x32_bf16 v[56:59], a[12:15], v[120:123], v[56:59]
    ds_read_b64_tr_b16 a[56:57], v5 offset:24896
    s_waitcnt lgkmcnt(7)
    v_mfma_f32_16x16x32_bf16 v[68:71], a[12:15], v[156:159], v[68:71]
    buffer_load_dwordx4 v7, s[12:15], s46 offen offset:1024 lds
    v_mfma_f32_16x16x32_bf16 v[72:75], a[16:19], v[156:159], v[72:75]
    ds_read_b64_tr_b16 a[58:59], v5 offset:25664
    v_mfma_f32_16x16x32_bf16 v[76:79], a[20:23], v[156:159], v[76:79]
    ds_read_b128 v[132:135], v2 offset:4160
    v_mfma_f32_16x16x32_bf16 v[44:47], a[24:27], v[88:91], v[44:47]
    ds_read_b128 v[168:171], v2 offset:8256
    v_mfma_f32_16x16x32_bf16 v[48:51], a[28:31], v[88:91], v[48:51]
    buffer_load_dwordx4 v7, s[12:15], s46 offen offset:2048 lds
    v_mfma_f32_16x16x32_bf16 v[52:55], a[32:35], v[88:91], v[52:55]
    ds_read_b128 v[100:103], v2 offset:128
    v_mfma_f32_16x16x32_bf16 v[64:67], a[32:35], v[124:127], v[64:67]
    ds_read_b64_tr_b16 a[60:61], v4 offset:31040
    ds_read_b64_tr_b16 a[62:63], v4 offset:31808
    v_mfma_f32_16x16x32_bf16 v[60:63], a[28:31], v[124:127], v[60:63]
    s_add_u32 m0, s44, 74496
    s_mov_b32 s46, 73728
    v_mfma_f32_16x16x32_bf16 v[56:59], a[24:27], v[124:127], v[56:59]
    buffer_load_dwordx4 v7, s[12:15], s46 offen offset:0 lds
    v_mfma_f32_16x16x32_bf16 v[68:71], a[24:27], v[160:163], v[68:71]
    ds_read_b64_tr_b16 a[64:65], v4 offset:31072
    v_mfma_f32_16x16x32_bf16 v[72:75], a[28:31], v[160:163], v[72:75]
    ds_read_b64_tr_b16 a[66:67], v4 offset:31840
    v_mfma_f32_16x16x32_bf16 v[76:79], a[32:35], v[160:163], v[76:79]
    ds_read_b64_tr_b16 a[68:69], v5 offset:31104
    s_waitcnt vmcnt(6)
    s_barrier
    v_mfma_f32_16x16x32_bf16 v[44:47], a[36:39], v[92:95], v[44:47]
    ds_read_b64_tr_b16 a[70:71], v5 offset:31872
    v_mfma_f32_16x16x32_bf16 v[48:51], a[40:43], v[92:95], v[48:51]
    ds_read_b128 v[136:139], v2 offset:4224
    v_mfma_f32_16x16x32_bf16 v[52:55], a[44:47], v[92:95], v[52:55]
    ds_read_b128 v[172:175], v2 offset:8320
    v_mfma_f32_16x16x32_bf16 v[64:67], a[44:47], v[128:131], v[64:67]
    buffer_load_dwordx4 v7, s[12:15], s46 offen offset:1024 lds
    v_mfma_f32_16x16x32_bf16 v[60:63], a[40:43], v[128:131], v[60:63]
    ds_read_b128 v[104:107], v3 offset:0
    v_mfma_f32_16x16x32_bf16 v[56:59], a[36:39], v[128:131], v[56:59]
    ds_read_b64_tr_b16 a[72:73], v4 offset:37248
    ds_read_b64_tr_b16 a[74:75], v4 offset:38016
    s_waitcnt lgkmcnt(7)
    v_mfma_f32_16x16x32_bf16 v[68:71], a[36:39], v[164:167], v[68:71]
    buffer_load_dwordx4 v7, s[12:15], s46 offen offset:2048 lds
    v_mfma_f32_16x16x32_bf16 v[72:75], a[40:43], v[164:167], v[72:75]
    ds_read_b64_tr_b16 a[76:77], v4 offset:37280
    v_mfma_f32_16x16x32_bf16 v[76:79], a[44:47], v[164:167], v[76:79]
    ds_read_b64_tr_b16 a[78:79], v4 offset:38048
    ds_read_b64_tr_b16 a[80:81], v5 offset:37312
    v_mfma_f32_16x16x32_bf16 v[44:47], a[48:51], v[96:99], v[44:47]
    s_add_u32 m0, s45, 86912
    s_mov_b32 s46, 86016
    ds_read_b64_tr_b16 a[82:83], v5 offset:38080
    v_mfma_f32_16x16x32_bf16 v[48:51], a[52:55], v[96:99], v[48:51]
    buffer_load_dwordx4 v7, s[12:15], s46 offen offset:0 lds
    v_mfma_f32_16x16x32_bf16 v[52:55], a[56:59], v[96:99], v[52:55]
    ds_read_b128 v[140:143], v3 offset:4096
    v_mfma_f32_16x16x32_bf16 v[64:67], a[56:59], v[132:135], v[64:67]
    ds_read_b128 v[176:179], v3 offset:8192
    v_mfma_f32_16x16x32_bf16 v[60:63], a[52:55], v[132:135], v[60:63]
    ds_read_b128 v[108:111], v3 offset:64
    v_mfma_f32_16x16x32_bf16 v[56:59], a[48:51], v[132:135], v[56:59]
    ds_read_b64_tr_b16 a[84:85], v4 offset:43456
    ds_read_b64_tr_b16 a[86:87], v4 offset:44224
    v_mfma_f32_16x16x32_bf16 v[68:71], a[48:51], v[168:171], v[68:71]
    buffer_load_dwordx4 v7, s[12:15], s46 offen offset:1024 lds
    v_mfma_f32_16x16x32_bf16 v[72:75], a[52:55], v[168:171], v[72:75]
    ds_read_b64_tr_b16 a[88:89], v4 offset:43488
    v_mfma_f32_16x16x32_bf16 v[76:79], a[56:59], v[168:171], v[76:79]
    ds_read_b64_tr_b16 a[90:91], v4 offset:44256
    v_mfma_f32_16x16x32_bf16 v[44:47], a[60:63], v[100:103], v[44:47]
    ds_read_b64_tr_b16 a[92:93], v5 offset:43520
    ds_read_b64_tr_b16 a[94:95], v5 offset:44288
    v_mfma_f32_16x16x32_bf16 v[48:51], a[64:67], v[100:103], v[48:51]
    buffer_load_dwordx4 v7, s[12:15], s46 offen offset:2048 lds
    s_waitcnt lgkmcnt(7)
    v_mfma_f32_16x16x32_bf16 v[52:55], a[68:71], v[100:103], v[52:55]
    ds_read_b128 v[144:147], v3 offset:4160
    v_mfma_f32_16x16x32_bf16 v[64:67], a[68:71], v[136:139], v[64:67]
    ds_read_b128 v[180:183], v3 offset:8256
    ds_read_b128 v[112:115], v3 offset:128
    v_mfma_f32_16x16x32_bf16 v[60:63], a[64:67], v[136:139], v[60:63]
    s_add_u32 m0, s44, 6208
    s_mov_b32 s46, 98304
    ds_read_b64_tr_b16 a[96:97], v4 offset:49664
    v_mfma_f32_16x16x32_bf16 v[56:59], a[60:63], v[136:139], v[56:59]
    buffer_load_dwordx4 v7, s[12:15], s46 offen offset:0 lds
    v_mfma_f32_16x16x32_bf16 v[68:71], a[60:63], v[172:175], v[68:71]
    ds_read_b64_tr_b16 a[98:99], v4 offset:50432
    v_mfma_f32_16x16x32_bf16 v[72:75], a[64:67], v[172:175], v[72:75]
    ds_read_b64_tr_b16 a[100:101], v4 offset:49696
    v_mfma_f32_16x16x32_bf16 v[76:79], a[68:71], v[172:175], v[76:79]
    ds_read_b64_tr_b16 a[102:103], v4 offset:50464
    s_waitcnt vmcnt(7)
    s_barrier
    v_mfma_f32_16x16x32_bf16 v[44:47], a[72:75], v[104:107], v[44:47]
    ds_read_b64_tr_b16 a[104:105], v5 offset:49728
    v_mfma_f32_16x16x32_bf16 v[48:51], a[76:79], v[104:107], v[48:51]
    ds_read_b64_tr_b16 a[106:107], v5 offset:50496
    v_mfma_f32_16x16x32_bf16 v[52:55], a[80:83], v[104:107], v[52:55]
    ds_read_b128 v[148:151], v3 offset:4224
    ds_read_b128 v[184:187], v3 offset:8320
    v_mfma_f32_16x16x32_bf16 v[64:67], a[80:83], v[140:143], v[64:67]
    buffer_load_dwordx4 v7, s[12:15], s46 offen offset:1024 lds
    v_mfma_f32_16x16x32_bf16 v[60:63], a[76:79], v[140:143], v[60:63]
    v_add_u32 v4, 55872, v4
    v_add_u32 v5, 55872, v5
    v_mfma_f32_16x16x32_bf16 v[56:59], a[72:75], v[140:143], v[56:59]
    ds_read_b64_tr_b16 a[108:109], v4 offset:0
    v_mfma_f32_16x16x32_bf16 v[68:71], a[72:75], v[176:179], v[68:71]
    buffer_load_dwordx4 v7, s[12:15], s46 offen offset:2048 lds
    v_mfma_f32_16x16x32_bf16 v[72:75], a[76:79], v[176:179], v[72:75]
    ds_read_b64_tr_b16 a[110:111], v4 offset:768
    v_mfma_f32_16x16x32_bf16 v[76:79], a[80:83], v[176:179], v[76:79]
    ds_read_b64_tr_b16 a[112:113], v4 offset:32
    s_waitcnt lgkmcnt(7)
    v_mfma_f32_16x16x32_bf16 v[44:47], a[84:87], v[108:111], v[44:47]
    s_add_u32 m0, s33, 16384
    ds_read_b64_tr_b16 a[114:115], v4 offset:800
    v_mfma_f32_16x16x32_bf16 v[48:51], a[88:91], v[108:111], v[48:51]
    buffer_load_dwordx4 v8, s[4:7], s60 offen lds
    v_mfma_f32_16x16x32_bf16 v[52:55], a[92:95], v[108:111], v[52:55]
    ds_read_b64_tr_b16 a[116:117], v5 offset:64
    v_mfma_f32_16x16x32_bf16 v[64:67], a[92:95], v[144:147], v[64:67]
    ds_read_b64_tr_b16 a[118:119], v5 offset:832
    v_mfma_f32_16x16x32_bf16 v[60:63], a[88:91], v[144:147], v[60:63]
    ds_read_b128 v[80:83], v1 offset:12288
    v_mfma_f32_16x16x32_bf16 v[56:59], a[84:87], v[144:147], v[56:59]
    s_add_u32 m0, s33, 45056
    ds_read_b64_tr_b16 a[120:121], v4 offset:6208
    v_mfma_f32_16x16x32_bf16 v[68:71], a[84:87], v[180:183], v[68:71]
    buffer_load_dwordx4 v8, s[4:7], s67 offen lds
    v_mfma_f32_16x16x32_bf16 v[72:75], a[88:91], v[180:183], v[72:75]
    ds_read_b64_tr_b16 a[122:123], v4 offset:6976
    v_mfma_f32_16x16x32_bf16 v[76:79], a[92:95], v[180:183], v[76:79]
    ds_read_b64_tr_b16 a[124:125], v4 offset:6240
    ds_read_b64_tr_b16 a[126:127], v4 offset:7008
    v_mfma_f32_16x16x32_bf16 v[44:47], a[96:99], v[112:115], v[44:47]
    s_add_u32 m0, s44, 18624
    s_mov_b32 s46, 110592
    v_mfma_f32_16x16x32_bf16 v[48:51], a[100:103], v[112:115], v[48:51]
    buffer_load_dwordx4 v7, s[12:15], s46 offen offset:0 lds
    s_waitcnt lgkmcnt(7)
    v_mfma_f32_16x16x32_bf16 v[52:55], a[104:107], v[112:115], v[52:55]
    ds_read_b64_tr_b16 a[128:129], v5 offset:6272
    v_mfma_f32_16x16x32_bf16 v[64:67], a[104:107], v[148:151], v[64:67]
    ds_read_b64_tr_b16 a[130:131], v5 offset:7040
    v_mfma_f32_16x16x32_bf16 v[60:63], a[100:103], v[148:151], v[60:63]
    ds_read_b128 v[84:87], v1 offset:12352
    ds_read_b64_tr_b16 a[132:133], v4 offset:12416
    v_mfma_f32_16x16x32_bf16 v[56:59], a[96:99], v[148:151], v[56:59]
    buffer_load_dwordx4 v7, s[12:15], s46 offen offset:1024 lds
    v_mfma_f32_16x16x32_bf16 v[68:71], a[96:99], v[184:187], v[68:71]
    ds_read_b64_tr_b16 a[134:135], v4 offset:13184
    v_mfma_f32_16x16x32_bf16 v[72:75], a[100:103], v[184:187], v[72:75]
    ds_read_b64_tr_b16 a[136:137], v4 offset:12448
    v_mfma_f32_16x16x32_bf16 v[76:79], a[104:107], v[184:187], v[76:79]
    ds_read_b64_tr_b16 a[138:139], v4 offset:13216
    s_waitcnt vmcnt(7)
    s_barrier
    v_mfma_f32_16x16x32_bf16 v[44:47], a[108:111], v[116:119], v[44:47]
    ds_read_b64_tr_b16 a[140:141], v5 offset:12480
    v_mfma_f32_16x16x32_bf16 v[48:51], a[112:115], v[116:119], v[48:51]
    ds_read_b64_tr_b16 a[142:143], v5 offset:13248
    s_waitcnt lgkmcnt(7)
    v_mfma_f32_16x16x32_bf16 v[52:55], a[116:119], v[116:119], v[52:55]
    ds_read_b128 v[88:91], v1 offset:12416
    s_branch L_N2_s0
L_N2_t0:
    s_setpc_b64 s[78:79]
L_N2_s0:
    v_mfma_f32_16x16x32_bf16 v[64:67], a[116:119], v[152:155], v[64:67]
    buffer_load_dwordx4 v7, s[12:15], s46 offen offset:2048 lds
    v_mfma_f32_16x16x32_bf16 v[60:63], a[112:115], v[152:155], v[60:63]
    ds_read_b64_tr_b16 a[144:145], v4 offset:18624
    ds_read_b64_tr_b16 a[146:147], v4 offset:19392
    v_mfma_f32_16x16x32_bf16 v[56:59], a[108:111], v[152:155], v[56:59]
    s_add_u32 m0, s44, 31040
    s_mov_b32 s46, 122880
    v_mfma_f32_16x16x32_bf16 v[68:71], a[108:111], v[80:83], v[68:71]
    buffer_load_dwordx4 v7, s[12:15], s46 offen offset:0 lds
    v_mfma_f32_16x16x32_bf16 v[72:75], a[112:115], v[80:83], v[72:75]
    ds_read_b64_tr_b16 a[148:149], v4 offset:18656
    v_mfma_f32_16x16x32_bf16 v[76:79], a[116:119], v[80:83], v[76:79]
    ds_read_b64_tr_b16 a[150:151], v4 offset:19424
    v_mfma_f32_16x16x32_bf16 v[44:47], a[120:123], v[120:123], v[44:47]
    ds_read_b64_tr_b16 a[152:153], v5 offset:18688
    v_mfma_f32_16x16x32_bf16 v[48:51], a[124:127], v[120:123], v[48:51]
    buffer_load_dwordx4 v7, s[12:15], s46 offen offset:1024 lds
    v_mfma_f32_16x16x32_bf16 v[52:55], a[128:131], v[120:123], v[52:55]
    ds_read_b64_tr_b16 a[154:155], v5 offset:19456
    v_mfma_f32_16x16x32_bf16 v[64:67], a[128:131], v[156:159], v[64:67]
    ds_read_b128 v[92:95], v2 offset:12288
    v_mfma_f32_16x16x32_bf16 v[60:63], a[124:127], v[156:159], v[60:63]
    ds_read_b64_tr_b16 a[156:157], v4 offset:24832
    v_mfma_f32_16x16x32_bf16 v[56:59], a[120:123], v[156:159], v[56:59]
    ds_read_b64_tr_b16 a[158:159], v4 offset:25600
    s_waitcnt lgkmcnt(7)
    v_mfma_f32_16x16x32_bf16 v[68:71], a[120:123], v[84:87], v[68:71]
    buffer_load_dwordx4 v7, s[12:15], s46 offen offset:2048 lds
    v_mfma_f32_16x16x32_bf16 v[72:75], a[124:127], v[84:87], v[72:75]
    ds_read_b64_tr_b16 a[160:161], v4 offset:24864
    v_mfma_f32_16x16x32_bf16 v[76:79], a[128:131], v[84:87], v[76:79]
    ds_read_b64_tr_b16 a[162:163], v4 offset:25632
    ds_read_b64_tr_b16 a[164:165], v5 offset:24896
    v_mfma_f32_16x16x32_bf16 v[44:47], a[132:135], v[124:127], v[44:47]
    s_add_u32 m0, s44, 43456
    s_mov_b32 s46, 135168
    v_mfma_f32_16x16x32_bf16 v[48:51], a[136:139], v[124:127], v[48:51]
    buffer_load_dwordx4 v7, s[12:15], s46 offen offset:0 lds
    v_mfma_f32_16x16x32_bf16 v[52:55], a[140:143], v[124:127], v[52:55]
    ds_read_b64_tr_b16 a[166:167], v5 offset:25664
    v_mfma_f32_16x16x32_bf16 v[64:67], a[140:143], v[160:163], v[64:67]
    ds_read_b128 v[96:99], v2 offset:12352
    v_mfma_f32_16x16x32_bf16 v[60:63], a[136:139], v[160:163], v[60:63]
    ds_read_b64_tr_b16 a[168:169], v4 offset:31040
    v_mfma_f32_16x16x32_bf16 v[56:59], a[132:135], v[160:163], v[56:59]
    buffer_load_dwordx4 v7, s[12:15], s46 offen offset:1024 lds
    v_mfma_f32_16x16x32_bf16 v[68:71], a[132:135], v[88:91], v[68:71]
    ds_read_b64_tr_b16 a[170:171], v4 offset:31808
    v_mfma_f32_16x16x32_bf16 v[72:75], a[136:139], v[88:91], v[72:75]
    ds_read_b64_tr_b16 a[172:173], v4 offset:31072
    v_mfma_f32_16x16x32_bf16 v[76:79], a[140:143], v[88:91], v[76:79]
    ds_read_b64_tr_b16 a[174:175], v4 offset:31840
    s_waitcnt vmcnt(10)
    s_barrier
    v_mfma_f32_16x16x32_bf16 v[44:47], a[144:147], v[128:131], v[44:47]
    ds_read_b64_tr_b16 a[176:177], v5 offset:31104
    s_waitcnt lgkmcnt(7)
    v_mfma_f32_16x16x32_bf16 v[48:51], a[148:151], v[128:131], v[48:51]
    ds_read_b64_tr_b16 a[178:179], v5 offset:31872
    v_mfma_f32_16x16x32_bf16 v[52:55], a[152:155], v[128:131], v[52:55]
    ds_read_b128 v[100:103], v2 offset:12416
    v_mfma_f32_16x16x32_bf16 v[64:67], a[152:155], v[164:167], v[64:67]
    buffer_load_dwordx4 v7, s[12:15], s46 offen offset:2048 lds
    v_mfma_f32_16x16x32_bf16 v[60:63], a[148:151], v[164:167], v[60:63]
    v_add_u32 v4, -55872, v4
    v_add_u32 v5, -55872, v5
    v_mfma_f32_16x16x32_bf16 v[56:59], a[144:147], v[164:167], v[56:59]
    ds_read_b64_tr_b16 a[180:181], v4 offset:0
    v_mfma_f32_16x16x32_bf16 v[68:71], a[144:147], v[92:95], v[68:71]
    ds_read_b64_tr_b16 a[182:183], v4 offset:768
    v_mfma_f32_16x16x32_bf16 v[72:75], a[148:151], v[92:95], v[72:75]
    ds_read_b64_tr_b16 a[184:185], v4 offset:32
    v_mfma_f32_16x16x32_bf16 v[76:79], a[152:155], v[92:95], v[76:79]
    s_add_u32 m0, s44, 55872
    s_mov_b32 s46, 147456
    v_mfma_f32_16x16x32_bf16 v[44:47], a[156:159], v[132:135], v[44:47]
    buffer_load_dwordx4 v7, s[12:15], s46 offen offset:0 lds
    v_mfma_f32_16x16x32_bf16 v[48:51], a[160:163], v[132:135], v[48:51]
    ds_read_b64_tr_b16 a[186:187], v4 offset:800
    s_waitcnt lgkmcnt(7)
    v_mfma_f32_16x16x32_bf16 v[52:55], a[164:167], v[132:135], v[52:55]
    ds_read_b64_tr_b16 a[188:189], v5 offset:64
    v_mfma_f32_16x16x32_bf16 v[64:67], a[164:167], v[168:171], v[64:67]
    ds_read_b64_tr_b16 a[190:191], v5 offset:832
    v_mfma_f32_16x16x32_bf16 v[60:63], a[160:163], v[168:171], v[60:63]
    ds_read_b128 v[104:107], v3 offset:12288
    v_mfma_f32_16x16x32_bf16 v[56:59], a[156:159], v[168:171], v[56:59]
    ds_read_b64_tr_b16 a[192:193], v4 offset:6208
    v_mfma_f32_16x16x32_bf16 v[68:71], a[156:159], v[96:99], v[68:71]
    ds_read_b64_tr_b16 a[194:195], v4 offset:6976
    v_mfma_f32_16x16x32_bf16 v[72:75], a[160:163], v[96:99], v[72:75]
    buffer_load_dwordx4 v7, s[12:15], s46 offen offset:1024 lds
    v_mfma_f32_16x16x32_bf16 v[76:79], a[164:167], v[96:99], v[76:79]
    ds_read_b64_tr_b16 a[196:197], v4 offset:6240
    v_mfma_f32_16x16x32_bf16 v[44:47], a[168:171], v[136:139], v[44:47]
    ds_read_b64_tr_b16 a[198:199], v4 offset:7008
    v_mfma_f32_16x16x32_bf16 v[48:51], a[172:175], v[136:139], v[48:51]
    ds_read_b64_tr_b16 a[200:201], v5 offset:6272
    s_waitcnt lgkmcnt(7)
    v_mfma_f32_16x16x32_bf16 v[52:55], a[176:179], v[136:139], v[52:55]
    ds_read_b64_tr_b16 a[202:203], v5 offset:7040
    v_mfma_f32_16x16x32_bf16 v[64:67], a[176:179], v[172:175], v[64:67]
    ds_read_b128 v[108:111], v3 offset:12352
    v_mfma_f32_16x16x32_bf16 v[60:63], a[172:175], v[172:175], v[60:63]
    buffer_load_dwordx4 v7, s[12:15], s46 offen offset:2048 lds
    v_mfma_f32_16x16x32_bf16 v[56:59], a[168:171], v[172:175], v[56:59]
    ds_read_b64_tr_b16 a[204:205], v4 offset:12416
    v_mfma_f32_16x16x32_bf16 v[68:71], a[168:171], v[100:103], v[68:71]
    ds_read_b64_tr_b16 a[206:207], v4 offset:13184
    v_mfma_f32_16x16x32_bf16 v[72:75], a[172:175], v[100:103], v[72:75]
    ds_read_b64_tr_b16 a[208:209], v4 offset:12448
    v_mfma_f32_16x16x32_bf16 v[76:79], a[176:179], v[100:103], v[76:79]
    ds_read_b64_tr_b16 a[210:211], v4 offset:13216
    s_waitcnt vmcnt(6)
    s_barrier
    v_mfma_f32_16x16x32_bf16 v[44:47], a[180:183], v[140:143], v[44:47]
    ds_read_b64_tr_b16 a[212:213], v5 offset:12480
    v_mfma_f32_16x16x32_bf16 v[48:51], a[184:187], v[140:143], v[48:51]
    ds_read_b64_tr_b16 a[214:215], v5 offset:13248
    s_waitcnt lgkmcnt(7)
    v_mfma_f32_16x16x32_bf16 v[52:55], a[188:191], v[140:143], v[52:55]
    ds_read_b128 v[112:115], v3 offset:12416
    s_add_u32 m0, s44, 68288
    s_mov_b32 s46, 159744
    v_mfma_f32_16x16x32_bf16 v[64:67], a[188:191], v[176:179], v[64:67]
    buffer_load_dwordx4 v7, s[12:15], s46 offen offset:0 lds
    v_mfma_f32_16x16x32_bf16 v[60:63], a[184:187], v[176:179], v[60:63]
    ds_read_b64_tr_b16 a[216:217], v4 offset:18624
    v_mfma_f32_16x16x32_bf16 v[56:59], a[180:183], v[176:179], v[56:59]
    ds_read_b64_tr_b16 a[218:219], v4 offset:19392
    v_mfma_f32_16x16x32_bf16 v[68:71], a[180:183], v[104:107], v[68:71]
    ds_read_b64_tr_b16 a[220:221], v4 offset:18656
    v_mfma_f32_16x16x32_bf16 v[72:75], a[184:187], v[104:107], v[72:75]
    buffer_load_dwordx4 v7, s[12:15], s46 offen offset:1024 lds
    v_mfma_f32_16x16x32_bf16 v[76:79], a[188:191], v[104:107], v[76:79]
    ds_read_b64_tr_b16 a[222:223], v4 offset:19424
    v_mfma_f32_16x16x32_bf16 v[44:47], a[192:195], v[144:147], v[44:47]
    ds_read_b64_tr_b16 a[224:225], v5 offset:18688
    v_mfma_f32_16x16x32_bf16 v[48:51], a[196:199], v[144:147], v[48:51]
    ds_read_b64_tr_b16 a[226:227], v5 offset:19456
    v_mfma_f32_16x16x32_bf16 v[52:55], a[200:203], v[144:147], v[52:55]
    ds_read_b128 v[116:119], v1 offset:16384
    v_mfma_f32_16x16x32_bf16 v[64:67], a[200:203], v[180:183], v[64:67]
    ds_read_b64_tr_b16 a[228:229], v4 offset:24832
    v_mfma_f32_16x16x32_bf16 v[60:63], a[196:199], v[180:183], v[60:63]
    buffer_load_dwordx4 v7, s[12:15], s46 offen offset:2048 lds
    v_mfma_f32_16x16x32_bf16 v[56:59], a[192:195], v[180:183], v[56:59]
    ds_read_b64_tr_b16 a[230:231], v4 offset:25600
    s_waitcnt lgkmcnt(7)
    v_mfma_f32_16x16x32_bf16 v[68:71], a[192:195], v[108:111], v[68:71]
    ds_read_b64_tr_b16 a[232:233], v4 offset:24864
    v_mfma_f32_16x16x32_bf16 v[72:75], a[196:199], v[108:111], v[72:75]
    ds_read_b64_tr_b16 a[234:235], v4 offset:25632
    v_mfma_f32_16x16x32_bf16 v[76:79], a[200:203], v[108:111], v[76:79]
    s_add_u32 m0, s33, 20480
    v_mfma_f32_16x16x32_bf16 v[44:47], a[204:207], v[148:151], v[44:47]
    buffer_load_dwordx4 v8, s[4:7], s61 offen lds
    v_mfma_f32_16x16x32_bf16 v[48:51], a[208:211], v[148:151], v[48:51]
    ds_read_b64_tr_b16 a[236:237], v5 offset:24896
    v_mfma_f32_16x16x32_bf16 v[52:55], a[212:215], v[148:151], v[52:55]
    ds_read_b64_tr_b16 a[238:239], v5 offset:25664
    v_mfma_f32_16x16x32_bf16 v[64:67], a[212:215], v[184:187], v[64:67]
    ds_read_b128 v[120:123], v1 offset:16448
    v_mfma_f32_16x16x32_bf16 v[60:63], a[208:211], v[184:187], v[60:63]
    s_add_u32 m0, s33, 49152
    ds_read_b64_tr_b16 a[240:241], v4 offset:31040
    v_mfma_f32_16x16x32_bf16 v[56:59], a[204:207], v[184:187], v[56:59]
    buffer_load_dwordx4 v8, s[4:7], s68 offen lds
    v_mfma_f32_16x16x32_bf16 v[68:71], a[204:207], v[112:115], v[68:71]
    ds_read_b64_tr_b16 a[242:243], v4 offset:31808
    v_mfma_f32_16x16x32_bf16 v[72:75], a[208:211], v[112:115], v[72:75]
    ds_read_b64_tr_b16 a[244:245], v4 offset:31072
    v_mfma_f32_16x16x32_bf16 v[76:79], a[212:215], v[112:115], v[76:79]
    ds_read_b64_tr_b16 a[246:247], v4 offset:31840
    s_waitcnt vmcnt(8)
    s_barrier
    v_mfma_f32_16x16x32_bf16 v[44:47], a[216:219], v[152:155], v[44:47]
    ds_read_b64_tr_b16 a[248:249], v5 offset:31104
    s_waitcnt lgkmcnt(7)
    v_mfma_f32_16x16x32_bf16 v[48:51], a[220:223], v[152:155], v[48:51]
    ds_read_b64_tr_b16 a[250:251], v5 offset:31872
    v_mfma_f32_16x16x32_bf16 v[52:55], a[224:227], v[152:155], v[52:55]
    ds_read_b128 v[124:127], v1 offset:16512
    s_add_u32 m0, s33, 24576
    v_mfma_f32_16x16x32_bf16 v[64:67], a[224:227], v[80:83], v[64:67]
    buffer_load_dwordx4 v8, s[4:7], s62 offen lds
    v_mfma_f32_16x16x32_bf16 v[60:63], a[220:223], v[80:83], v[60:63]
    ds_read_b64_tr_b16 a[252:253], v4 offset:37248
    v_mfma_f32_16x16x32_bf16 v[56:59], a[216:219], v[80:83], v[56:59]
    ds_read_b64_tr_b16 a[254:255], v4 offset:38016
    v_mfma_f32_16x16x32_bf16 v[68:71], a[216:219], v[116:119], v[68:71]
    ds_read_b64_tr_b16 v[188:189], v4 offset:37280
    v_mfma_f32_16x16x32_bf16 v[72:75], a[220:223], v[116:119], v[72:75]
    ds_read_b64_tr_b16 v[190:191], v4 offset:38048
    v_mfma_f32_16x16x32_bf16 v[76:79], a[224:227], v[116:119], v[76:79]
    s_add_u32 m0, s33, 53248
    v_mfma_f32_16x16x32_bf16 v[44:47], a[228:231], v[156:159], v[44:47]
    buffer_load_dwordx4 v8, s[4:7], s69 offen lds
    v_mfma_f32_16x16x32_bf16 v[48:51], a[232:235], v[156:159], v[48:51]
    ds_read_b64_tr_b16 v[192:193], v5 offset:37312
    s_waitcnt lgkmcnt(7)
    v_mfma_f32_16x16x32_bf16 v[52:55], a[236:239], v[156:159], v[52:55]
    ds_read_b64_tr_b16 v[194:195], v5 offset:38080
    v_mfma_f32_16x16x32_bf16 v[64:67], a[236:239], v[84:87], v[64:67]
    ds_read_b128 v[128:131], v2 offset:16384
    v_mfma_f32_16x16x32_bf16 v[60:63], a[232:235], v[84:87], v[60:63]
    ds_read_b64_tr_b16 v[196:197], v4 offset:43456
    v_mfma_f32_16x16x32_bf16 v[56:59], a[228:231], v[84:87], v[56:59]
    ds_read_b64_tr_b16 v[198:199], v4 offset:44224
    v_mfma_f32_16x16x32_bf16 v[68:71], a[228:231], v[120:123], v[68:71]
    s_add_u32 m0, s33, 57344
    ds_read_b64_tr_b16 v[200:201], v4 offset:43488
    v_mfma_f32_16x16x32_bf16 v[72:75], a[232:235], v[120:123], v[72:75]
    buffer_load_dwordx4 v8, s[4:7], s70 offen lds
    v_mfma_f32_16x16x32_bf16 v[76:79], a[236:239], v[120:123], v[76:79]
    ds_read_b64_tr_b16 v[202:203], v4 offset:44256
    v_mfma_f32_16x16x32_bf16 v[44:47], a[240:243], v[160:163], v[44:47]
    ds_read_b64_tr_b16 v[204:205], v5 offset:43520
    v_mfma_f32_16x16x32_bf16 v[48:51], a[244:247], v[160:163], v[48:51]
    ds_read_b64_tr_b16 v[206:207], v5 offset:44288
    s_waitcnt lgkmcnt(7)
    v_mfma_f32_16x16x32_bf16 v[52:55], a[248:251], v[160:163], v[52:55]
    ds_read_b128 v[132:135], v2 offset:16448
    v_mfma_f32_16x16x32_bf16 v[64:67], a[248:251], v[88:91], v[64:67]
    s_add_u32 m0, s33, 61440
    v_mfma_f32_16x16x32_bf16 v[60:63], a[244:247], v[88:91], v[60:63]
    buffer_load_dwordx4 v8, s[4:7], s71 offen lds
    v_mfma_f32_16x16x32_bf16 v[56:59], a[240:243], v[88:91], v[56:59]
    ds_read_b64_tr_b16 v[208:209], v4 offset:49664
    v_mfma_f32_16x16x32_bf16 v[68:71], a[240:243], v[124:127], v[68:71]
    ds_read_b64_tr_b16 v[210:211], v4 offset:50432
    v_mfma_f32_16x16x32_bf16 v[72:75], a[244:247], v[124:127], v[72:75]
    ds_read_b64_tr_b16 v[212:213], v4 offset:49696
    v_mfma_f32_16x16x32_bf16 v[76:79], a[248:251], v[124:127], v[76:79]
    ds_read_b64_tr_b16 v[214:215], v4 offset:50464
    s_waitcnt vmcnt(6)
    s_barrier
    v_mfma_f32_16x16x32_bf16 v[44:47], a[252:255], v[164:167], v[44:47]
    ds_read_b64_tr_b16 v[216:217], v5 offset:49728
    v_mfma_f32_16x16x32_bf16 v[48:51], v[188:191], v[164:167], v[48:51]
    ds_read_b64_tr_b16 v[218:219], v5 offset:50496
    v_mfma_f32_16x16x32_bf16 v[52:55], v[192:195], v[164:167], v[52:55]
    ds_read_b128 v[136:139], v2 offset:16512
    v_mfma_f32_16x16x32_bf16 v[64:67], v[192:195], v[92:95], v[64:67]
    v_add_u32 v4, 55872, v4
    v_add_u32 v5, 55872, v5
    v_mfma_f32_16x16x32_bf16 v[60:63], v[188:191], v[92:95], v[60:63]
    ds_read_b64_tr_b16 v[220:221], v4 offset:0
    v_mfma_f32_16x16x32_bf16 v[56:59], a[252:255], v[92:95], v[56:59]
    ds_read_b64_tr_b16 v[222:223], v4 offset:768
    buffer_load_dwordx4 v[16:19], v14, s[8:11], s32 offen offset:0
    s_waitcnt lgkmcnt(7)
    v_mfma_f32_16x16x32_bf16 v[68:71], a[252:255], v[128:131], v[68:71]
    ds_read_b64_tr_b16 v[224:225], v4 offset:32
    v_mfma_f32_16x16x32_bf16 v[72:75], v[188:191], v[128:131], v[72:75]
    ds_read_b64_tr_b16 v[226:227], v4 offset:800
    v_mfma_f32_16x16x32_bf16 v[76:79], v[192:195], v[128:131], v[76:79]
    ds_read_b64_tr_b16 v[228:229], v5 offset:64
    buffer_load_dwordx4 v[20:23], v14, s[8:11], s32 offen offset:144
    v_mfma_f32_16x16x32_bf16 v[44:47], v[196:199], v[168:171], v[44:47]
    ds_read_b64_tr_b16 v[230:231], v5 offset:832
    v_mfma_f32_16x16x32_bf16 v[48:51], v[200:203], v[168:171], v[48:51]
    ds_read_b128 v[140:143], v3 offset:16384
    v_mfma_f32_16x16x32_bf16 v[52:55], v[204:207], v[168:171], v[52:55]
    ds_read_b64_tr_b16 v[232:233], v4 offset:6208
    buffer_load_dwordx4 v[24:27], v14, s[8:11], s32 offen offset:288
    v_mfma_f32_16x16x32_bf16 v[64:67], v[204:207], v[96:99], v[64:67]
    ds_read_b64_tr_b16 v[234:235], v4 offset:6976
    v_mfma_f32_16x16x32_bf16 v[60:63], v[200:203], v[96:99], v[60:63]
    ds_read_b64_tr_b16 v[236:237], v4 offset:6240
    v_mfma_f32_16x16x32_bf16 v[56:59], v[196:199], v[96:99], v[56:59]
    ds_read_b64_tr_b16 v[238:239], v4 offset:7008
    buffer_load_dwordx4 v[28:31], v14, s[8:11], s32 offen offset:432
    v_mfma_f32_16x16x32_bf16 v[68:71], v[196:199], v[132:135], v[68:71]
    ds_read_b64_tr_b16 v[240:241], v5 offset:6272
    v_mfma_f32_16x16x32_bf16 v[72:75], v[200:203], v[132:135], v[72:75]
    ds_read_b64_tr_b16 v[242:243], v5 offset:7040
    v_mfma_f32_16x16x32_bf16 v[76:79], v[204:207], v[132:135], v[76:79]
    ds_read_b128 v[144:147], v3 offset:16448
    v_mfma_f32_16x16x32_bf16 v[44:47], v[208:211], v[172:175], v[44:47]
    ds_read_b64_tr_b16 v[244:245], v4 offset:12416
    s_waitcnt lgkmcnt(7)
    v_mfma_f32_16x16x32_bf16 v[48:51], v[212:215], v[172:175], v[48:51]
    ds_read_b64_tr_b16 v[246:247], v4 offset:13184
    v_mfma_f32_16x16x32_bf16 v[52:55], v[216:219], v[172:175], v[52:55]
    ds_read_b64_tr_b16 v[248:249], v4 offset:12448
    v_mfma_f32_16x16x32_bf16 v[64:67], v[216:219], v[100:103], v[64:67]
    ds_read_b64_tr_b16 v[250:251], v4 offset:13216
    v_mfma_f32_16x16x32_bf16 v[60:63], v[212:215], v[100:103], v[60:63]
    ds_read_b64_tr_b16 v[252:253], v5 offset:12480
    v_mfma_f32_16x16x32_bf16 v[56:59], v[208:211], v[100:103], v[56:59]
    ds_read_b64_tr_b16 v[254:255], v5 offset:13248
    ds_read_b128 v[148:151], v3 offset:16512
    v_mfma_f32_16x16x32_bf16 v[68:71], v[208:211], v[136:139], v[68:71]
    v_mfma_f32_16x16x32_bf16 v[72:75], v[212:215], v[136:139], v[72:75]
    v_mfma_f32_16x16x32_bf16 v[76:79], v[216:219], v[136:139], v[76:79]
    v_mfma_f32_16x16x32_bf16 v[44:47], v[220:223], v[176:179], v[44:47]
    s_mul_i32 s47, s30, 8064
    s_lshl_b32 s48, s29, 3
    v_mfma_f32_16x16x32_bf16 v[48:51], v[224:227], v[176:179], v[48:51]
    v_bfe_u32 v38, v6, 4, 2
    v_bfe_u32 v39, v6, 6, 2
    v_mfma_f32_16x16x32_bf16 v[52:55], v[228:231], v[176:179], v[52:55]
    v_lshl_add_u32 v38, v38, 2, v39
    s_add_u32 s47, s47, 65536
    s_waitcnt lgkmcnt(7)
    v_mfma_f32_16x16x32_bf16 v[52:55], v[240:243], v[180:183], v[52:55]
    v_lshrrev_b32 v39, 8, v6
    v_mul_u32_u24 v10, 72, v38
    v_mfma_f32_16x16x32_bf16 v[48:51], v[236:239], v[180:183], v[48:51]
    v_mul_u32_u24 v9, 192, v38
    s_lshl2_add_u32 s49, s48, s47
    v_mfma_f32_16x16x32_bf16 v[44:47], v[232:235], v[180:183], v[44:47]
    v_lshl_add_u32 v10, v39, 3, v10
    v_and_b32 v38, 1, v39
    s_waitcnt lgkmcnt(5)
    v_mfma_f32_16x16x32_bf16 v[44:47], v[244:247], v[184:187], v[44:47]
    v_lshrrev_b32 v39, 1, v39
    v_add_u32 v10, s49, v10
    s_waitcnt lgkmcnt(3)
    v_mfma_f32_16x16x32_bf16 v[48:51], v[248:251], v[184:187], v[48:51]
    v_lshl_add_u32 v38, v38, 1, v39
    v_lshrrev_b32 v39, 7, v6
    s_waitcnt lgkmcnt(1)
    v_mfma_f32_16x16x32_bf16 v[52:55], v[252:255], v[184:187], v[52:55]
    v_add_u32 v38, s48, v38
    v_add_u32 v39, s48, v39
    v_mfma_f32_16x16x32_bf16 v[56:59], v[220:223], v[104:107], v[56:59]
    v_lshl_add_u32 v9, v38, 4, v9
    v_bfe_u32 v38, v6, 1, 6
    v_mfma_f32_16x16x32_bf16 v[60:63], v[224:227], v[104:107], v[60:63]
    v_mul_u32_u24 v4, 72, v39
    v_mul_u32_u24 v5, 192, v39
    v_mfma_f32_16x16x32_bf16 v[64:67], v[228:231], v[104:107], v[64:67]
    v_add3_u32 v4, v4, s47, v38
    v_add3_u32 v5, v5, 64, v38
    v_mfma_f32_16x16x32_bf16 v[64:67], v[240:243], v[108:111], v[64:67]
    s_mov_b32 s46, s31
    v_mfma_f32_16x16x32_bf16 v[60:63], v[236:239], v[108:111], v[60:63]
    v_mfma_f32_16x16x32_bf16 v[56:59], v[232:235], v[108:111], v[56:59]
    v_mfma_f32_16x16x32_bf16 v[56:59], v[244:247], v[112:115], v[56:59]
    v_mfma_f32_16x16x32_bf16 v[60:63], v[248:251], v[112:115], v[60:63]
    v_cvt_pk_bf16_f32 v32, v44, v45
    v_cvt_pk_bf16_f32 v33, v46, v47
    v_mfma_f32_16x16x32_bf16 v[64:67], v[252:255], v[112:115], v[64:67]
    v_cvt_pk_bf16_f32 v34, v48, v49
    v_cvt_pk_bf16_f32 v35, v50, v51
    v_mfma_f32_16x16x32_bf16 v[68:71], v[220:223], v[140:143], v[68:71]
    v_cvt_pk_bf16_f32 v36, v52, v53
    v_cvt_pk_bf16_f32 v37, v54, v55
    v_mfma_f32_16x16x32_bf16 v[72:75], v[224:227], v[140:143], v[72:75]
    v_permlane16_swap_b32 v32, v34
    v_permlane16_swap_b32 v33, v35
    v_mfma_f32_16x16x32_bf16 v[76:79], v[228:231], v[140:143], v[76:79]
    ds_write_b64 v10, v[36:37] offset:0
    v_mfma_f32_16x16x32_bf16 v[76:79], v[240:243], v[144:147], v[76:79]
    buffer_store_dwordx4 v[32:35], v9, s[16:19], s31 offen sc1
    s_add_u32 s31, s31, 43008
    v_mfma_f32_16x16x32_bf16 v[72:75], v[236:239], v[144:147], v[72:75]
    v_mfma_f32_16x16x32_bf16 v[68:71], v[232:235], v[144:147], v[68:71]
    s_waitcnt lgkmcnt(1)
    v_mfma_f32_16x16x32_bf16 v[68:71], v[244:247], v[148:151], v[68:71]
    v_mfma_f32_16x16x32_bf16 v[72:75], v[248:251], v[148:151], v[72:75]
    v_mfma_f32_16x16x32_bf16 v[76:79], v[252:255], v[148:151], v[76:79]
    v_mfma_f32_16x16x32_bf16 v[44:47], a[0:3], v[80:83], 0
    v_mfma_f32_16x16x32_bf16 v[48:51], a[4:7], v[80:83], 0
    v_mfma_f32_16x16x32_bf16 v[52:55], a[8:11], v[80:83], 0
    v_mfma_f32_16x16x32_bf16 v[52:55], a[20:23], v[84:87], v[52:55]
    v_mfma_f32_16x16x32_bf16 v[48:51], a[16:19], v[84:87], v[48:51]
    v_mfma_f32_16x16x32_bf16 v[44:47], a[12:15], v[84:87], v[44:47]
    v_mfma_f32_16x16x32_bf16 v[44:47], a[24:27], v[88:91], v[44:47]
    v_mfma_f32_16x16x32_bf16 v[48:51], a[28:31], v[88:91], v[48:51]
    v_mfma_f32_16x16x32_bf16 v[52:55], a[32:35], v[88:91], v[52:55]
    v_mfma_f32_16x16x32_bf16 v[44:47], a[36:39], v[92:95], v[44:47]
    v_mfma_f32_16x16x32_bf16 v[48:51], a[40:43], v[92:95], v[48:51]
    v_mfma_f32_16x16x32_bf16 v[52:55], a[44:47], v[92:95], v[52:55]
    v_mfma_f32_16x16x32_bf16 v[52:55], a[56:59], v[96:99], v[52:55]
    v_mfma_f32_16x16x32_bf16 v[48:51], a[52:55], v[96:99], v[48:51]
    v_mfma_f32_16x16x32_bf16 v[44:47], a[48:51], v[96:99], v[44:47]
    v_cvt_pk_bf16_f32 v32, v56, v57
    v_cvt_pk_bf16_f32 v33, v58, v59
    v_mfma_f32_16x16x32_bf16 v[44:47], a[60:63], v[100:103], v[44:47]
    v_cvt_pk_bf16_f32 v34, v60, v61
    v_cvt_pk_bf16_f32 v35, v62, v63
    v_mfma_f32_16x16x32_bf16 v[48:51], a[64:67], v[100:103], v[48:51]
    v_cvt_pk_bf16_f32 v36, v64, v65
    v_cvt_pk_bf16_f32 v37, v66, v67
    v_mfma_f32_16x16x32_bf16 v[52:55], a[68:71], v[100:103], v[52:55]
    v_permlane16_swap_b32 v32, v34
    v_permlane16_swap_b32 v33, v35
    v_mfma_f32_16x16x32_bf16 v[44:47], a[72:75], v[104:107], v[44:47]
    ds_write_b64 v10, v[36:37] offset:1152
    v_mfma_f32_16x16x32_bf16 v[48:51], a[76:79], v[104:107], v[48:51]
    buffer_store_dwordx4 v[32:35], v9, s[16:19], s31 offen sc1
    s_add_u32 s31, s31, 43008
    v_mfma_f32_16x16x32_bf16 v[52:55], a[80:83], v[104:107], v[52:55]
    v_mfma_f32_16x16x32_bf16 v[52:55], a[92:95], v[108:111], v[52:55]
    v_mfma_f32_16x16x32_bf16 v[48:51], a[88:91], v[108:111], v[48:51]
    v_mfma_f32_16x16x32_bf16 v[44:47], a[84:87], v[108:111], v[44:47]
    v_mfma_f32_16x16x32_bf16 v[44:47], a[96:99], v[112:115], v[44:47]
    v_mfma_f32_16x16x32_bf16 v[48:51], a[100:103], v[112:115], v[48:51]
    v_mfma_f32_16x16x32_bf16 v[52:55], a[104:107], v[112:115], v[52:55]
    v_mfma_f32_16x16x32_bf16 v[44:47], a[108:111], v[116:119], v[44:47]
    v_mfma_f32_16x16x32_bf16 v[48:51], a[112:115], v[116:119], v[48:51]
    v_mfma_f32_16x16x32_bf16 v[52:55], a[116:119], v[116:119], v[52:55]
    v_mfma_f32_16x16x32_bf16 v[52:55], a[128:131], v[120:123], v[52:55]
    v_mfma_f32_16x16x32_bf16 v[48:51], a[124:127], v[120:123], v[48:51]
    v_mfma_f32_16x16x32_bf16 v[44:47], a[120:123], v[120:123], v[44:47]
    v_mfma_f32_16x16x32_bf16 v[44:47], a[132:135], v[124:127], v[44:47]
    v_mfma_f32_16x16x32_bf16 v[48:51], a[136:139], v[124:127], v[48:51]
    v_mfma_f32_16x16x32_bf16 v[52:55], a[140:143], v[124:127], v[52:55]
    v_mfma_f32_16x16x32_bf16 v[44:47], a[144:147], v[128:131], v[44:47]
    v_mfma_f32_16x16x32_bf16 v[48:51], a[148:151], v[128:131], v[48:51]
    v_mfma_f32_16x16x32_bf16 v[52:55], a[152:155], v[128:131], v[52:55]
    s_waitcnt vmcnt(10)
    s_waitcnt lgkmcnt(0)
    s_barrier
    v_mfma_f32_16x16x32_bf16 v[52:55], a[164:167], v[132:135], v[52:55]
    ds_read_b128 v[152:155], v1 offset:20480
    v_mfma_f32_16x16x32_bf16 v[48:51], a[160:163], v[132:135], v[48:51]
    ds_read_b128 v[156:159], v1 offset:20544
    v_mfma_f32_16x16x32_bf16 v[44:47], a[156:159], v[132:135], v[44:47]
    ds_read_b128 v[160:163], v1 offset:20608
    v_mfma_f32_16x16x32_bf16 v[44:47], a[168:171], v[136:139], v[44:47]
    ds_read_b128 v[164:167], v2 offset:20480
    v_mfma_f32_16x16x32_bf16 v[48:51], a[172:175], v[136:139], v[48:51]
    ds_read_b128 v[168:171], v2 offset:20544
    v_mfma_f32_16x16x32_bf16 v[52:55], a[176:179], v[136:139], v[52:55]
    ds_read_b128 v[172:175], v2 offset:20608
    v_mfma_f32_16x16x32_bf16 v[44:47], a[180:183], v[140:143], v[44:47]
    ds_read_b128 v[176:179], v3 offset:20480
    v_mfma_f32_16x16x32_bf16 v[48:51], a[184:187], v[140:143], v[48:51]
    ds_read_b128 v[180:183], v3 offset:20544
    v_mfma_f32_16x16x32_bf16 v[52:55], a[188:191], v[140:143], v[52:55]
    ds_read_b128 v[184:187], v3 offset:20608
    v_mfma_f32_16x16x32_bf16 v[52:55], a[200:203], v[144:147], v[52:55]
    ds_read_b64 v[38:39], v4 offset:0
    v_mfma_f32_16x16x32_bf16 v[48:51], a[196:199], v[144:147], v[48:51]
    ds_read_b64 v[40:41], v4 offset:1152
    v_mfma_f32_16x16x32_bf16 v[44:47], a[192:195], v[144:147], v[44:47]
    v_mfma_f32_16x16x32_bf16 v[44:47], a[204:207], v[148:151], v[44:47]
    v_mfma_f32_16x16x32_bf16 v[48:51], a[208:211], v[148:151], v[48:51]
    v_mfma_f32_16x16x32_bf16 v[52:55], a[212:215], v[148:151], v[52:55]
    s_waitcnt lgkmcnt(7)
    v_mfma_f32_16x16x32_bf16 v[44:47], a[216:219], v[152:155], v[44:47]
    v_mfma_f32_16x16x32_bf16 v[48:51], a[220:223], v[152:155], v[48:51]
    v_mfma_f32_16x16x32_bf16 v[52:55], a[224:227], v[152:155], v[52:55]
    v_mfma_f32_16x16x32_bf16 v[52:55], a[236:239], v[156:159], v[52:55]
    s_waitcnt lgkmcnt(1)
    buffer_store_dwordx2 v[38:39], v5, s[16:19], s46 offen sc1
    s_add_u32 s46, s46, 43008
    v_mfma_f32_16x16x32_bf16 v[48:51], a[232:235], v[156:159], v[48:51]
    v_mfma_f32_16x16x32_bf16 v[44:47], a[228:231], v[156:159], v[44:47]
    v_mfma_f32_16x16x32_bf16 v[44:47], a[240:243], v[160:163], v[44:47]
    v_mfma_f32_16x16x32_bf16 v[48:51], a[244:247], v[160:163], v[48:51]
    v_mfma_f32_16x16x32_bf16 v[52:55], a[248:251], v[160:163], v[52:55]
    v_mfma_f32_16x16x32_bf16 v[44:47], a[252:255], v[164:167], v[44:47]
    v_mfma_f32_16x16x32_bf16 v[48:51], v[188:191], v[164:167], v[48:51]
    s_waitcnt lgkmcnt(0)
    buffer_store_dwordx2 v[40:41], v5, s[16:19], s46 offen sc1
    s_add_u32 s46, s46, 43008
    v_mfma_f32_16x16x32_bf16 v[52:55], v[192:195], v[164:167], v[52:55]
    v_mfma_f32_16x16x32_bf16 v[52:55], v[204:207], v[168:171], v[52:55]
    v_cvt_pk_bf16_f32 v32, v68, v69
    v_cvt_pk_bf16_f32 v33, v70, v71
    v_mfma_f32_16x16x32_bf16 v[48:51], v[200:203], v[168:171], v[48:51]
    v_cvt_pk_bf16_f32 v34, v72, v73
    v_cvt_pk_bf16_f32 v35, v74, v75
    v_mfma_f32_16x16x32_bf16 v[44:47], v[196:199], v[168:171], v[44:47]
    v_cvt_pk_bf16_f32 v36, v76, v77
    v_cvt_pk_bf16_f32 v37, v78, v79
    v_mfma_f32_16x16x32_bf16 v[44:47], v[208:211], v[172:175], v[44:47]
    v_permlane16_swap_b32 v32, v34
    v_permlane16_swap_b32 v33, v35
    v_mfma_f32_16x16x32_bf16 v[48:51], v[212:215], v[172:175], v[48:51]
    ds_write_b64 v10, v[36:37] offset:2304
    v_mfma_f32_16x16x32_bf16 v[52:55], v[216:219], v[172:175], v[52:55]
    buffer_store_dwordx4 v[32:35], v9, s[16:19], s31 offen sc1
    s_add_u32 s31, s31, 43008
    v_mfma_f32_16x16x32_bf16 v[44:47], v[220:223], v[176:179], v[44:47]
    v_mfma_f32_16x16x32_bf16 v[48:51], v[224:227], v[176:179], v[48:51]
    v_mfma_f32_16x16x32_bf16 v[52:55], v[228:231], v[176:179], v[52:55]
    v_mfma_f32_16x16x32_bf16 v[52:55], v[240:243], v[180:183], v[52:55]
    v_mfma_f32_16x16x32_bf16 v[48:51], v[236:239], v[180:183], v[48:51]
    v_mfma_f32_16x16x32_bf16 v[44:47], v[232:235], v[180:183], v[44:47]
    v_mfma_f32_16x16x32_bf16 v[44:47], v[244:247], v[184:187], v[44:47]
    v_mfma_f32_16x16x32_bf16 v[48:51], v[248:251], v[184:187], v[48:51]
    v_mfma_f32_16x16x32_bf16 v[52:55], v[252:255], v[184:187], v[52:55]
    v_mfma_f32_16x16x32_bf16 v[56:59], a[0:3], v[116:119], 0
    v_mfma_f32_16x16x32_bf16 v[60:63], a[4:7], v[116:119], 0
    v_mfma_f32_16x16x32_bf16 v[64:67], a[8:11], v[116:119], 0
    v_mfma_f32_16x16x32_bf16 v[64:67], a[20:23], v[120:123], v[64:67]
    v_mfma_f32_16x16x32_bf16 v[60:63], a[16:19], v[120:123], v[60:63]
    v_mfma_f32_16x16x32_bf16 v[56:59], a[12:15], v[120:123], v[56:59]
    v_mfma_f32_16x16x32_bf16 v[56:59], a[24:27], v[124:127], v[56:59]
    v_mfma_f32_16x16x32_bf16 v[60:63], a[28:31], v[124:127], v[60:63]
    v_mfma_f32_16x16x32_bf16 v[64:67], a[32:35], v[124:127], v[64:67]
    v_mfma_f32_16x16x32_bf16 v[56:59], a[36:39], v[128:131], v[56:59]
    v_mfma_f32_16x16x32_bf16 v[60:63], a[40:43], v[128:131], v[60:63]
    v_mfma_f32_16x16x32_bf16 v[64:67], a[44:47], v[128:131], v[64:67]
    v_mfma_f32_16x16x32_bf16 v[64:67], a[56:59], v[132:135], v[64:67]
    v_cvt_pk_bf16_f32 v32, v44, v45
    v_cvt_pk_bf16_f32 v33, v46, v47
    v_mfma_f32_16x16x32_bf16 v[60:63], a[52:55], v[132:135], v[60:63]
    v_cvt_pk_bf16_f32 v34, v48, v49
    v_cvt_pk_bf16_f32 v35, v50, v51
    v_mfma_f32_16x16x32_bf16 v[56:59], a[48:51], v[132:135], v[56:59]
    v_cvt_pk_bf16_f32 v36, v52, v53
    v_cvt_pk_bf16_f32 v37, v54, v55
    v_mfma_f32_16x16x32_bf16 v[56:59], a[60:63], v[136:139], v[56:59]
    v_permlane16_swap_b32 v32, v34
    v_permlane16_swap_b32 v33, v35
    v_mfma_f32_16x16x32_bf16 v[60:63], a[64:67], v[136:139], v[60:63]
    ds_write_b64 v10, v[36:37] offset:3456
    v_mfma_f32_16x16x32_bf16 v[64:67], a[68:71], v[136:139], v[64:67]
    buffer_store_dwordx4 v[32:35], v9, s[16:19], s31 offen sc1
    s_add_u32 s31, s31, 43008
    v_mfma_f32_16x16x32_bf16 v[56:59], a[72:75], v[140:143], v[56:59]
    v_mfma_f32_16x16x32_bf16 v[60:63], a[76:79], v[140:143], v[60:63]
    v_mfma_f32_16x16x32_bf16 v[64:67], a[80:83], v[140:143], v[64:67]
    v_mfma_f32_16x16x32_bf16 v[64:67], a[92:95], v[144:147], v[64:67]
    v_mfma_f32_16x16x32_bf16 v[60:63], a[88:91], v[144:147], v[60:63]
    v_mfma_f32_16x16x32_bf16 v[56:59], a[84:87], v[144:147], v[56:59]
    v_mfma_f32_16x16x32_bf16 v[56:59], a[96:99], v[148:151], v[56:59]
    v_mfma_f32_16x16x32_bf16 v[60:63], a[100:103], v[148:151], v[60:63]
    v_mfma_f32_16x16x32_bf16 v[64:67], a[104:107], v[148:151], v[64:67]
    v_mfma_f32_16x16x32_bf16 v[56:59], a[108:111], v[152:155], v[56:59]
    v_mfma_f32_16x16x32_bf16 v[60:63], a[112:115], v[152:155], v[60:63]
    v_mfma_f32_16x16x32_bf16 v[64:67], a[116:119], v[152:155], v[64:67]
    v_mfma_f32_16x16x32_bf16 v[64:67], a[128:131], v[156:159], v[64:67]
    v_mfma_f32_16x16x32_bf16 v[60:63], a[124:127], v[156:159], v[60:63]
    v_mfma_f32_16x16x32_bf16 v[56:59], a[120:123], v[156:159], v[56:59]
    v_mfma_f32_16x16x32_bf16 v[56:59], a[132:135], v[160:163], v[56:59]
    s_branch L_N2_s1
L_N2_t1:
    s_setpc_b64 s[78:79]
L_N2_s1:
    v_mfma_f32_16x16x32_bf16 v[60:63], a[136:139], v[160:163], v[60:63]
    v_mfma_f32_16x16x32_bf16 v[64:67], a[140:143], v[160:163], v[64:67]
    v_mfma_f32_16x16x32_bf16 v[56:59], a[144:147], v[164:167], v[56:59]
    s_waitcnt vmcnt(10)
    s_waitcnt lgkmcnt(0)
    s_barrier
    v_mfma_f32_16x16x32_bf16 v[60:63], a[148:151], v[164:167], v[60:63]
    ds_read_b128 v[80:83], v1 offset:24576
    v_mfma_f32_16x16x32_bf16 v[64:67], a[152:155], v[164:167], v[64:67]
    ds_read_b128 v[84:87], v1 offset:24640
    v_mfma_f32_16x16x32_bf16 v[64:67], a[164:167], v[168:171], v[64:67]
    ds_read_b128 v[88:91], v1 offset:24704
    v_mfma_f32_16x16x32_bf16 v[60:63], a[160:163], v[168:171], v[60:63]
    ds_read_b128 v[92:95], v2 offset:24576
    v_mfma_f32_16x16x32_bf16 v[56:59], a[156:159], v[168:171], v[56:59]
    ds_read_b128 v[96:99], v2 offset:24640
    v_mfma_f32_16x16x32_bf16 v[56:59], a[168:171], v[172:175], v[56:59]
    ds_read_b128 v[100:103], v2 offset:24704
    v_mfma_f32_16x16x32_bf16 v[60:63], a[172:175], v[172:175], v[60:63]
    ds_read_b128 v[104:107], v3 offset:24576
    v_mfma_f32_16x16x32_bf16 v[64:67], a[176:179], v[172:175], v[64:67]
    ds_read_b128 v[108:111], v3 offset:24640
    v_mfma_f32_16x16x32_bf16 v[56:59], a[180:183], v[176:179], v[56:59]
    ds_read_b128 v[112:115], v3 offset:24704
    v_mfma_f32_16x16x32_bf16 v[60:63], a[184:187], v[176:179], v[60:63]
    ds_read_b64 v[38:39], v4 offset:2304
    v_mfma_f32_16x16x32_bf16 v[64:67], a[188:191], v[176:179], v[64:67]
    ds_read_b64 v[40:41], v4 offset:3456
    v_mfma_f32_16x16x32_bf16 v[64:67], a[200:203], v[180:183], v[64:67]
    v_mfma_f32_16x16x32_bf16 v[60:63], a[196:199], v[180:183], v[60:63]
    v_mfma_f32_16x16x32_bf16 v[56:59], a[192:195], v[180:183], v[56:59]
    v_mfma_f32_16x16x32_bf16 v[56:59], a[204:207], v[184:187], v[56:59]
    v_mfma_f32_16x16x32_bf16 v[60:63], a[208:211], v[184:187], v[60:63]
    v_mfma_f32_16x16x32_bf16 v[64:67], a[212:215], v[184:187], v[64:67]
    s_waitcnt lgkmcnt(7)
    v_mfma_f32_16x16x32_bf16 v[56:59], a[216:219], v[80:83], v[56:59]
    v_mfma_f32_16x16x32_bf16 v[60:63], a[220:223], v[80:83], v[60:63]
    s_waitcnt lgkmcnt(1)
    buffer_store_dwordx2 v[38:39], v5, s[16:19], s46 offen sc1
    s_add_u32 s46, s46, 43008
    v_mfma_f32_16x16x32_bf16 v[64:67], a[224:227], v[80:83], v[64:67]
    v_mfma_f32_16x16x32_bf16 v[64:67], a[236:239], v[84:87], v[64:67]
    v_mfma_f32_16x16x32_bf16 v[60:63], a[232:235], v[84:87], v[60:63]
    v_mfma_f32_16x16x32_bf16 v[56:59], a[228:231], v[84:87], v[56:59]
    v_mfma_f32_16x16x32_bf16 v[56:59], a[240:243], v[88:91], v[56:59]
    v_mfma_f32_16x16x32_bf16 v[60:63], a[244:247], v[88:91], v[60:63]
    v_mfma_f32_16x16x32_bf16 v[64:67], a[248:251], v[88:91], v[64:67]
    s_waitcnt lgkmcnt(0)
    buffer_store_dwordx2 v[40:41], v5, s[16:19], s46 offen sc1
    s_add_u32 s46, s46, 43008
    v_mfma_f32_16x16x32_bf16 v[56:59], a[252:255], v[92:95], v[56:59]
    v_mfma_f32_16x16x32_bf16 v[60:63], v[188:191], v[92:95], v[60:63]
    v_mfma_f32_16x16x32_bf16 v[64:67], v[192:195], v[92:95], v[64:67]
    v_mfma_f32_16x16x32_bf16 v[64:67], v[204:207], v[96:99], v[64:67]
    v_mfma_f32_16x16x32_bf16 v[60:63], v[200:203], v[96:99], v[60:63]
    v_mfma_f32_16x16x32_bf16 v[56:59], v[196:199], v[96:99], v[56:59]
    v_mfma_f32_16x16x32_bf16 v[56:59], v[208:211], v[100:103], v[56:59]
    v_mfma_f32_16x16x32_bf16 v[60:63], v[212:215], v[100:103], v[60:63]
    v_mfma_f32_16x16x32_bf16 v[64:67], v[216:219], v[100:103], v[64:67]
    v_mfma_f32_16x16x32_bf16 v[56:59], v[220:223], v[104:107], v[56:59]
    v_mfma_f32_16x16x32_bf16 v[60:63], v[224:227], v[104:107], v[60:63]
    v_mfma_f32_16x16x32_bf16 v[64:67], v[228:231], v[104:107], v[64:67]
    v_mfma_f32_16x16x32_bf16 v[64:67], v[240:243], v[108:111], v[64:67]
    v_mfma_f32_16x16x32_bf16 v[60:63], v[236:239], v[108:111], v[60:63]
    v_mfma_f32_16x16x32_bf16 v[56:59], v[232:235], v[108:111], v[56:59]
    v_mfma_f32_16x16x32_bf16 v[56:59], v[244:247], v[112:115], v[56:59]
    v_mfma_f32_16x16x32_bf16 v[60:63], v[248:251], v[112:115], v[60:63]
    v_mfma_f32_16x16x32_bf16 v[64:67], v[252:255], v[112:115], v[64:67]
    v_mfma_f32_16x16x32_bf16 v[68:71], a[0:3], v[152:155], 0
    v_mfma_f32_16x16x32_bf16 v[72:75], a[4:7], v[152:155], 0
    v_mfma_f32_16x16x32_bf16 v[76:79], a[8:11], v[152:155], 0
    v_mfma_f32_16x16x32_bf16 v[76:79], a[20:23], v[156:159], v[76:79]
    v_mfma_f32_16x16x32_bf16 v[72:75], a[16:19], v[156:159], v[72:75]
    v_mfma_f32_16x16x32_bf16 v[68:71], a[12:15], v[156:159], v[68:71]
    v_mfma_f32_16x16x32_bf16 v[68:71], a[24:27], v[160:163], v[68:71]
    v_cvt_pk_bf16_f32 v32, v56, v57
    v_cvt_pk_bf16_f32 v33, v58, v59
    v_mfma_f32_16x16x32_bf16 v[72:75], a[28:31], v[160:163], v[72:75]
    v_cvt_pk_bf16_f32 v34, v60, v61
    v_cvt_pk_bf16_f32 v35, v62, v63
    v_mfma_f32_16x16x32_bf16 v[76:79], a[32:35], v[160:163], v[76:79]
    v_cvt_pk_bf16_f32 v36, v64, v65
    v_cvt_pk_bf16_f32 v37, v66, v67
    v_mfma_f32_16x16x32_bf16 v[68:71], a[36:39], v[164:167], v[68:71]
    v_permlane16_swap_b32 v32, v34
    v_permlane16_swap_b32 v33, v35
    v_mfma_f32_16x16x32_bf16 v[72:75], a[40:43], v[164:167], v[72:75]
    ds_write_b64 v10, v[36:37] offset:4608
    v_mfma_f32_16x16x32_bf16 v[76:79], a[44:47], v[164:167], v[76:79]
    buffer_store_dwordx4 v[32:35], v9, s[16:19], s31 offen sc1
    s_add_u32 s31, s31, 43008
    v_mfma_f32_16x16x32_bf16 v[76:79], a[56:59], v[168:171], v[76:79]
    v_mfma_f32_16x16x32_bf16 v[72:75], a[52:55], v[168:171], v[72:75]
    v_mfma_f32_16x16x32_bf16 v[68:71], a[48:51], v[168:171], v[68:71]
    ds_read_b128 v[116:119], v1 offset:28672
    v_mfma_f32_16x16x32_bf16 v[68:71], a[60:63], v[172:175], v[68:71]
    ds_read_b128 v[120:123], v1 offset:28736
    v_mfma_f32_16x16x32_bf16 v[72:75], a[64:67], v[172:175], v[72:75]
    ds_read_b128 v[124:127], v1 offset:28800
    v_mfma_f32_16x16x32_bf16 v[76:79], a[68:71], v[172:175], v[76:79]
    ds_read_b128 v[128:131], v2 offset:28672
    v_mfma_f32_16x16x32_bf16 v[68:71], a[72:75], v[176:179], v[68:71]
    ds_read_b128 v[132:135], v2 offset:28736
    v_mfma_f32_16x16x32_bf16 v[72:75], a[76:79], v[176:179], v[72:75]
    ds_read_b128 v[136:139], v2 offset:28800
    v_mfma_f32_16x16x32_bf16 v[76:79], a[80:83], v[176:179], v[76:79]
    ds_read_b128 v[140:143], v3 offset:28672
    v_mfma_f32_16x16x32_bf16 v[76:79], a[92:95], v[180:183], v[76:79]
    ds_read_b128 v[144:147], v3 offset:28736
    v_mfma_f32_16x16x32_bf16 v[72:75], a[88:91], v[180:183], v[72:75]
    ds_read_b128 v[148:151], v3 offset:28800
    v_mfma_f32_16x16x32_bf16 v[68:71], a[84:87], v[180:183], v[68:71]
    v_mfma_f32_16x16x32_bf16 v[68:71], a[96:99], v[184:187], v[68:71]
    v_mfma_f32_16x16x32_bf16 v[72:75], a[100:103], v[184:187], v[72:75]
    v_mfma_f32_16x16x32_bf16 v[76:79], a[104:107], v[184:187], v[76:79]
    v_mfma_f32_16x16x32_bf16 v[68:71], a[108:111], v[80:83], v[68:71]
    v_mfma_f32_16x16x32_bf16 v[72:75], a[112:115], v[80:83], v[72:75]
    s_mov_b32 s47, 0x7fff7fff
    s_waitcnt vmcnt(12)
    v_and_b32 v15, s47, v16
    v_mfma_f32_16x16x32_bf16 v[76:79], a[116:119], v[80:83], v[76:79]
    v_and_b32 v0, s47, v17
    v_pk_max_u16 v12, v15, s35
    v_mfma_f32_16x16x32_bf16 v[76:79], a[128:131], v[84:87], v[76:79]
    v_pk_max_u16 v13, v0, s35
    v_and_b32 v15, s47, v18
    v_mfma_f32_16x16x32_bf16 v[72:75], a[124:127], v[84:87], v[72:75]
    v_and_b32 v0, s47, v19
    v_pk_max_u16 v12, v15, v12
    v_mfma_f32_16x16x32_bf16 v[68:71], a[120:123], v[84:87], v[68:71]
    v_pk_max_u16 v13, v0, v13
    s_waitcnt vmcnt(11)
    v_and_b32 v15, s47, v20
    v_mfma_f32_16x16x32_bf16 v[68:71], a[132:135], v[88:91], v[68:71]
    v_and_b32 v0, s47, v21
    v_pk_max_u16 v12, v15, v12
    v_mfma_f32_16x16x32_bf16 v[72:75], a[136:139], v[88:91], v[72:75]
    v_pk_max_u16 v13, v0, v13
    v_and_b32 v15, s47, v22
    v_mfma_f32_16x16x32_bf16 v[76:79], a[140:143], v[88:91], v[76:79]
    v_and_b32 v0, s47, v23
    v_pk_max_u16 v12, v15, v12
    v_mfma_f32_16x16x32_bf16 v[68:71], a[144:147], v[92:95], v[68:71]
    v_pk_max_u16 v13, v0, v13
    s_waitcnt vmcnt(10)
    v_and_b32 v15, s47, v24
    v_mfma_f32_16x16x32_bf16 v[72:75], a[148:151], v[92:95], v[72:75]
    v_and_b32 v0, s47, v25
    v_pk_max_u16 v12, v15, v12
    v_mfma_f32_16x16x32_bf16 v[76:79], a[152:155], v[92:95], v[76:79]
    v_pk_max_u16 v13, v0, v13
    v_and_b32 v15, s47, v26
    v_mfma_f32_16x16x32_bf16 v[76:79], a[164:167], v[96:99], v[76:79]
    v_and_b32 v0, s47, v27
    v_pk_max_u16 v12, v15, v12
    v_mfma_f32_16x16x32_bf16 v[72:75], a[160:163], v[96:99], v[72:75]
    v_pk_max_u16 v13, v0, v13
    s_waitcnt vmcnt(9)
    v_and_b32 v15, s47, v28
    v_mfma_f32_16x16x32_bf16 v[68:71], a[156:159], v[96:99], v[68:71]
    v_and_b32 v0, s47, v29
    v_pk_max_u16 v12, v15, v12
    v_mfma_f32_16x16x32_bf16 v[68:71], a[168:171], v[100:103], v[68:71]
    v_pk_max_u16 v13, v0, v13
    v_and_b32 v15, s47, v30
    v_mfma_f32_16x16x32_bf16 v[72:75], a[172:175], v[100:103], v[72:75]
    v_and_b32 v0, s47, v31
    v_pk_max_u16 v12, v15, v12
    v_mfma_f32_16x16x32_bf16 v[76:79], a[176:179], v[100:103], v[76:79]
    v_pk_max_u16 v13, v0, v13
    v_pk_max_u16 v12, v12, v13
    v_mfma_f32_16x16x32_bf16 v[68:71], a[180:183], v[104:107], v[68:71]
    v_cmp_ne_u32 vcc, s35, v12
    v_mfma_f32_16x16x32_bf16 v[72:75], a[184:187], v[104:107], v[72:75]
    v_mfma_f32_16x16x32_bf16 v[76:79], a[188:191], v[104:107], v[76:79]
    v_mfma_f32_16x16x32_bf16 v[76:79], a[200:203], v[108:111], v[76:79]
    v_mfma_f32_16x16x32_bf16 v[72:75], a[196:199], v[108:111], v[72:75]
    v_mfma_f32_16x16x32_bf16 v[68:71], a[192:195], v[108:111], v[68:71]
    v_mfma_f32_16x16x32_bf16 v[68:71], a[204:207], v[112:115], v[68:71]
    v_mfma_f32_16x16x32_bf16 v[72:75], a[208:211], v[112:115], v[72:75]
    v_mfma_f32_16x16x32_bf16 v[76:79], a[212:215], v[112:115], v[76:79]
    s_waitcnt lgkmcnt(7)
    v_mfma_f32_16x16x32_bf16 v[68:71], a[216:219], v[116:119], v[68:71]
    v_mfma_f32_16x16x32_bf16 v[72:75], a[220:223], v[116:119], v[72:75]
    v_mfma_f32_16x16x32_bf16 v[76:79], a[224:227], v[116:119], v[76:79]
    v_mfma_f32_16x16x32_bf16 v[76:79], a[236:239], v[120:123], v[76:79]
    v_mfma_f32_16x16x32_bf16 v[72:75], a[232:235], v[120:123], v[72:75]
    v_mfma_f32_16x16x32_bf16 v[68:71], a[228:231], v[120:123], v[68:71]
    s_waitcnt lgkmcnt(6)
    v_mfma_f32_16x16x32_bf16 v[68:71], a[240:243], v[124:127], v[68:71]
    v_mfma_f32_16x16x32_bf16 v[72:75], a[244:247], v[124:127], v[72:75]
    v_mfma_f32_16x16x32_bf16 v[76:79], a[248:251], v[124:127], v[76:79]
    s_waitcnt lgkmcnt(5)
    v_mfma_f32_16x16x32_bf16 v[68:71], a[252:255], v[128:131], v[68:71]
    v_mfma_f32_16x16x32_bf16 v[72:75], v[188:191], v[128:131], v[72:75]
    v_mfma_f32_16x16x32_bf16 v[76:79], v[192:195], v[128:131], v[76:79]
    s_waitcnt lgkmcnt(4)
    v_mfma_f32_16x16x32_bf16 v[76:79], v[204:207], v[132:135], v[76:79]
    v_mfma_f32_16x16x32_bf16 v[72:75], v[200:203], v[132:135], v[72:75]
    v_mfma_f32_16x16x32_bf16 v[68:71], v[196:199], v[132:135], v[68:71]
    s_waitcnt lgkmcnt(3)
    v_mfma_f32_16x16x32_bf16 v[68:71], v[208:211], v[136:139], v[68:71]
    v_mfma_f32_16x16x32_bf16 v[72:75], v[212:215], v[136:139], v[72:75]
    v_mfma_f32_16x16x32_bf16 v[76:79], v[216:219], v[136:139], v[76:79]
    s_waitcnt lgkmcnt(2)
    v_mfma_f32_16x16x32_bf16 v[68:71], v[220:223], v[140:143], v[68:71]
    v_mfma_f32_16x16x32_bf16 v[72:75], v[224:227], v[140:143], v[72:75]
    v_mfma_f32_16x16x32_bf16 v[76:79], v[228:231], v[140:143], v[76:79]
    s_waitcnt lgkmcnt(1)
    v_mfma_f32_16x16x32_bf16 v[76:79], v[240:243], v[144:147], v[76:79]
    v_mfma_f32_16x16x32_bf16 v[72:75], v[236:239], v[144:147], v[72:75]
    v_mfma_f32_16x16x32_bf16 v[68:71], v[232:235], v[144:147], v[68:71]
    s_waitcnt lgkmcnt(0)
    v_mfma_f32_16x16x32_bf16 v[68:71], v[244:247], v[148:151], v[68:71]
    v_mfma_f32_16x16x32_bf16 v[72:75], v[248:251], v[148:151], v[72:75]
    v_mfma_f32_16x16x32_bf16 v[76:79], v[252:255], v[148:151], v[76:79]
    v_mfma_f32_16x16x32_bf16 v[44:47], a[0:3], v[80:83], 0
    v_mfma_f32_16x16x32_bf16 v[48:51], a[4:7], v[80:83], 0
    v_mfma_f32_16x16x32_bf16 v[52:55], a[8:11], v[80:83], 0
    v_mfma_f32_16x16x32_bf16 v[52:55], a[20:23], v[84:87], v[52:55]
    v_mfma_f32_16x16x32_bf16 v[48:51], a[16:19], v[84:87], v[48:51]
    v_mfma_f32_16x16x32_bf16 v[44:47], a[12:15], v[84:87], v[44:47]
    v_mfma_f32_16x16x32_bf16 v[44:47], a[24:27], v[88:91], v[44:47]
    v_cvt_pk_bf16_f32 v32, v68, v69
    v_cvt_pk_bf16_f32 v33, v70, v71
    v_mfma_f32_16x16x32_bf16 v[48:51], a[28:31], v[88:91], v[48:51]
    v_cvt_pk_bf16_f32 v34, v72, v73
    v_cvt_pk_bf16_f32 v35, v74, v75
    v_mfma_f32_16x16x32_bf16 v[52:55], a[32:35], v[88:91], v[52:55]
    v_cvt_pk_bf16_f32 v36, v76, v77
    v_cvt_pk_bf16_f32 v37, v78, v79
    v_mfma_f32_16x16x32_bf16 v[44:47], a[36:39], v[92:95], v[44:47]
    v_permlane16_swap_b32 v32, v34
    v_permlane16_swap_b32 v33, v35
    v_mfma_f32_16x16x32_bf16 v[48:51], a[40:43], v[92:95], v[48:51]
    ds_write_b64 v10, v[36:37] offset:5760
    v_mfma_f32_16x16x32_bf16 v[52:55], a[44:47], v[92:95], v[52:55]
    buffer_store_dwordx4 v[32:35], v9, s[16:19], s31 offen sc1
    s_add_u32 s31, s31, 43008
    v_mfma_f32_16x16x32_bf16 v[52:55], a[56:59], v[96:99], v[52:55]
    v_mfma_f32_16x16x32_bf16 v[48:51], a[52:55], v[96:99], v[48:51]
    v_mfma_f32_16x16x32_bf16 v[44:47], a[48:51], v[96:99], v[44:47]
    ds_read_b128 v[152:155], v1 offset:32768
    v_mfma_f32_16x16x32_bf16 v[44:47], a[60:63], v[100:103], v[44:47]
    ds_read_b128 v[156:159], v1 offset:32832
    v_mfma_f32_16x16x32_bf16 v[48:51], a[64:67], v[100:103], v[48:51]
    ds_read_b128 v[160:163], v1 offset:32896
    v_mfma_f32_16x16x32_bf16 v[52:55], a[68:71], v[100:103], v[52:55]
    ds_read_b128 v[164:167], v2 offset:32768
    v_mfma_f32_16x16x32_bf16 v[44:47], a[72:75], v[104:107], v[44:47]
    ds_read_b128 v[168:171], v2 offset:32832
    v_mfma_f32_16x16x32_bf16 v[48:51], a[76:79], v[104:107], v[48:51]
    ds_read_b128 v[172:175], v2 offset:32896
    v_mfma_f32_16x16x32_bf16 v[52:55], a[80:83], v[104:107], v[52:55]
    ds_read_b128 v[176:179], v3 offset:32768
    v_mfma_f32_16x16x32_bf16 v[52:55], a[92:95], v[108:111], v[52:55]
    ds_read_b128 v[180:183], v3 offset:32832
    v_mfma_f32_16x16x32_bf16 v[48:51], a[88:91], v[108:111], v[48:51]
    ds_read_b128 v[184:187], v3 offset:32896
    v_mfma_f32_16x16x32_bf16 v[44:47], a[84:87], v[108:111], v[44:47]
    v_mfma_f32_16x16x32_bf16 v[44:47], a[96:99], v[112:115], v[44:47]
    s_mul_i32 s47, s30, 6656
    v_lshrrev_b32 v26, 4, v6
    v_mfma_f32_16x16x32_bf16 v[48:51], a[100:103], v[112:115], v[48:51]
    s_add_u32 s47, s47, 81664
    v_mul_u32_u24 v27, 43, v26
    v_mfma_f32_16x16x32_bf16 v[52:55], a[104:107], v[112:115], v[52:55]
    v_add_u32 v28, 128, v26
    s_lshl_b32 s48, s29, 3
    v_mfma_f32_16x16x32_bf16 v[44:47], a[108:111], v[116:119], v[44:47]
    v_lshrrev_b32 v27, 9, v27
    v_mul_u32_u24 v29, 2731, v28
    v_mfma_f32_16x16x32_bf16 v[48:51], a[112:115], v[116:119], v[48:51]
    v_mad_i32_i24 v26, v27, -12, v26
    v_lshrrev_b32 v29, 16, v29
    v_mfma_f32_16x16x32_bf16 v[52:55], a[116:119], v[116:119], v[52:55]
    v_add_u32 v27, s48, v27
    v_mul_u32_u24 v30, 24, v29
    v_mfma_f32_16x16x32_bf16 v[52:55], a[128:131], v[120:123], v[52:55]
    v_mul_u32_u24 v22, 208, v27
    v_sub_u32 v28, v28, v30
    v_mfma_f32_16x16x32_bf16 v[48:51], a[124:127], v[120:123], v[48:51]
    v_add_u32 v29, s48, v29
    v_mul_u32_u24 v24, 192, v27
    v_mfma_f32_16x16x32_bf16 v[44:47], a[120:123], v[120:123], v[44:47]
    v_lshlrev_b32 v26, 4, v26
    v_mul_u32_u24 v23, 208, v29
    v_mfma_f32_16x16x32_bf16 v[44:47], a[132:135], v[124:127], v[44:47]
    v_mul_u32_u24 v25, 192, v29
    v_lshlrev_b32 v28, 3, v28
    v_mfma_f32_16x16x32_bf16 v[48:51], a[136:139], v[124:127], v[48:51]
    s_waitcnt lgkmcnt(9)
    s_barrier
    v_add3_u32 v22, v22, s47, v26
    v_mfma_f32_16x16x32_bf16 v[52:55], a[140:143], v[124:127], v[52:55]
    ds_read_b64 v[38:39], v4 offset:4608
    v_mfma_f32_16x16x32_bf16 v[44:47], a[144:147], v[128:131], v[44:47]
    ds_read_b64 v[40:41], v4 offset:5760
    v_mfma_f32_16x16x32_bf16 v[48:51], a[148:151], v[128:131], v[48:51]
    v_add_u32 v24, v24, v26
    v_add3_u32 v23, v23, s47, v28
    v_mfma_f32_16x16x32_bf16 v[52:55], a[152:155], v[128:131], v[52:55]
    v_add_u32 v25, v25, v28
    v_bfe_u32 v26, v6, 4, 2
    v_mfma_f32_16x16x32_bf16 v[52:55], a[164:167], v[132:135], v[52:55]
    v_bfe_u32 v27, v6, 6, 2
    v_lshl_add_u32 v26, v26, 2, v27
    v_mfma_f32_16x16x32_bf16 v[48:51], a[160:163], v[132:135], v[48:51]
    v_lshrrev_b32 v27, 8, v6
    v_mul_u32_u24 v26, 208, v26
    v_mfma_f32_16x16x32_bf16 v[44:47], a[156:159], v[132:135], v[44:47]
    s_lshl4_add_u32 s49, s48, s47
    v_lshl_add_u32 v26, v27, 3, v26
    v_mfma_f32_16x16x32_bf16 v[44:47], a[168:171], v[136:139], v[44:47]
    s_lshl2_add_u32 s48, s48, s47
    v_add_u32 v20, s49, v26
    v_mfma_f32_16x16x32_bf16 v[48:51], a[172:175], v[136:139], v[48:51]
    v_add_u32 v21, s48, v26
    v_mfma_f32_16x16x32_bf16 v[52:55], a[176:179], v[136:139], v[52:55]
    s_waitcnt lgkmcnt(1)
    buffer_store_dwordx2 v[38:39], v5, s[16:19], s46 offen sc1
    s_add_u32 s46, s46, 43008
    v_mfma_f32_16x16x32_bf16 v[44:47], a[180:183], v[140:143], v[44:47]
    v_mfma_f32_16x16x32_bf16 v[48:51], a[184:187], v[140:143], v[48:51]
    v_mfma_f32_16x16x32_bf16 v[52:55], a[188:191], v[140:143], v[52:55]
    v_mfma_f32_16x16x32_bf16 v[52:55], a[200:203], v[144:147], v[52:55]
    v_mfma_f32_16x16x32_bf16 v[48:51], a[196:199], v[144:147], v[48:51]
    v_mfma_f32_16x16x32_bf16 v[44:47], a[192:195], v[144:147], v[44:47]
    v_mfma_f32_16x16x32_bf16 v[44:47], a[204:207], v[148:151], v[44:47]
    s_waitcnt lgkmcnt(0)
    buffer_store_dwordx2 v[40:41], v5, s[16:19], s46 offen sc1
    s_add_u32 s46, s46, 43008
    v_mfma_f32_16x16x32_bf16 v[48:51], a[208:211], v[148:151], v[48:51]
    v_mfma_f32_16x16x32_bf16 v[52:55], a[212:215], v[148:151], v[52:55]
    v_mfma_f32_16x16x32_bf16 v[44:47], a[216:219], v[152:155], v[44:47]
    v_mfma_f32_16x16x32_bf16 v[48:51], a[220:223], v[152:155], v[48:51]
    v_mfma_f32_16x16x32_bf16 v[52:55], a[224:227], v[152:155], v[52:55]
    v_mfma_f32_16x16x32_bf16 v[52:55], a[236:239], v[156:159], v[52:55]
    v_mfma_f32_16x16x32_bf16 v[48:51], a[232:235], v[156:159], v[48:51]
    v_mfma_f32_16x16x32_bf16 v[44:47], a[228:231], v[156:159], v[44:47]
    v_mfma_f32_16x16x32_bf16 v[44:47], a[240:243], v[160:163], v[44:47]
    v_mfma_f32_16x16x32_bf16 v[48:51], a[244:247], v[160:163], v[48:51]
    v_mfma_f32_16x16x32_bf16 v[52:55], a[248:251], v[160:163], v[52:55]
    v_mfma_f32_16x16x32_bf16 v[44:47], a[252:255], v[164:167], v[44:47]
    v_mfma_f32_16x16x32_bf16 v[44:47], v[196:199], v[168:171], v[44:47]
    v_mfma_f32_16x16x32_bf16 v[44:47], v[208:211], v[172:175], v[44:47]
    v_mfma_f32_16x16x32_bf16 v[44:47], v[220:223], v[176:179], v[44:47]
    v_mfma_f32_16x16x32_bf16 v[44:47], v[232:235], v[180:183], v[44:47]
    v_mfma_f32_16x16x32_bf16 v[44:47], v[244:247], v[184:187], v[44:47]
    v_mfma_f32_16x16x32_bf16 v[48:51], v[188:191], v[164:167], v[48:51]
    v_mfma_f32_16x16x32_bf16 v[48:51], v[200:203], v[168:171], v[48:51]
    v_mfma_f32_16x16x32_bf16 v[48:51], v[212:215], v[172:175], v[48:51]
    v_mfma_f32_16x16x32_bf16 v[48:51], v[224:227], v[176:179], v[48:51]
    v_mfma_f32_16x16x32_bf16 v[48:51], v[236:239], v[180:183], v[48:51]
    s_nop 2
    v_cvt_pk_bf16_f32 v32, v44, v45
    v_cvt_pk_bf16_f32 v33, v46, v47
    v_mfma_f32_16x16x32_bf16 v[48:51], v[248:251], v[184:187], v[48:51]
    ds_write_b64 v20, v[32:33] offset:0
    v_mfma_f32_16x16x32_bf16 v[52:55], v[192:195], v[164:167], v[52:55]
    v_mfma_f32_16x16x32_bf16 v[52:55], v[204:207], v[168:171], v[52:55]
    v_mfma_f32_16x16x32_bf16 v[52:55], v[216:219], v[172:175], v[52:55]
    v_mfma_f32_16x16x32_bf16 v[52:55], v[228:231], v[176:179], v[52:55]
    v_mfma_f32_16x16x32_bf16 v[52:55], v[240:243], v[180:183], v[52:55]
    s_nop 1
    v_cvt_pk_bf16_f32 v34, v48, v49
    v_cvt_pk_bf16_f32 v35, v50, v51
    v_mfma_f32_16x16x32_bf16 v[52:55], v[252:255], v[184:187], v[52:55]
    ds_write_b64 v20, v[34:35] offset:32
    s_nop 6
    v_cvt_pk_bf16_f32 v36, v52, v53
    v_cvt_pk_bf16_f32 v37, v54, v55
    ds_write_b64 v21, v[36:37] offset:64
    s_waitcnt lgkmcnt(0)
    s_barrier
    ds_read_b128 v[26:29], v22 offset:0
    ds_read_b64 v[30:31], v23 offset:0
    s_waitcnt lgkmcnt(1)
    buffer_store_dwordx4 v[26:29], v24, s[16:19], s31 offen sc1
    s_waitcnt lgkmcnt(0)
    buffer_store_dwordx2 v[30:31], v25, s[16:19], s31 offen sc1
    s_cbranch_vccnz L_gN
L_fin:
L_end:
    s_endpgm
.p2align 6
L_S:
    ds_write_b128 v104, v[100:103] offset:46592
    buffer_load_dwordx4 v7, s[12:15], s46 offen offset:1024 lds
    s_cmp_eq_u32 s56, 0
    s_mov_b32 s59, 0x01000c0c
    s_cselect_b32 s59, 0x03020c0c, s59
    s_cselect_b32 s49, 1.0, 0
    s_movk_i32 s36, 0x102
    s_cselect_b32 s36, 0x832, s36
    s_movk_i32 s37, 0x543
    ds_write_b128 v104, v[100:103] offset:47616
    s_cselect_b32 s37, 0x640, s37
    s_movk_i32 s38, 0x768
    s_cselect_b32 s38, 0x751, s38
    s_lshl_b32 s42, s56, 4
    v_mad_u32_u24 v180, v39, s56, v40
    v_add_u32 v181, 1, v40
    v_cmp_gt_u32 vcc, 14, v40
    ds_write_b128 v104, v[100:103] offset:48640
    v_add_u32 v180, -1, v180
    v_lshrrev_b32 v181, 4, v181
    v_mov_b32 v182, 0x41880000
    v_cvt_f32_i32 v20, v180
    buffer_load_dwordx4 v7, s[12:15], s46 offen offset:2048 lds
    v_lshl_add_u32 v181, v40, 2, v181
    v_mov_b32 v23, 0x416fffff
    v_lshlrev_b32 v180, 2, v39
    ds_write_b128 v104, v[100:103] offset:49664
    v_add_f32 v21, s49, v20
    v_cndmask_b32 v23, v182, v23, vcc
    s_mov_b32 s47, 41472
    v_bfe_u32 v24, s36, v180, 4
    v_bfe_u32 v25, s37, v180, 4
    v_bfe_u32 v26, s38, v180, 4
    s_add_u32 m0, s44, 101408
    s_add_u32 s64, s46, 12288
    s_bfe_u32 s65, s24, 0x40004
    s_mul_i32 s65, s65, 18432
    s_sub_u32 s46, s65, 6144
    s_cmp_eq_u32 s30, 0
    s_cselect_b32 s46, s64, s46
    buffer_load_dwordx4 v7, s[12:15], s46 offen offset:0 lds
    v_add_f32 v22, s49, v21
    ds_write_b128 v104, v[100:103] offset:50688
    s_waitcnt vmcnt(9)
    v_add_u32_sdwa v182, s47, v165 dst_sel:DWORD dst_unused:UNUSED_PAD src0_sel:DWORD src1_sel:WORD_1
    s_movk_i32 s48, 528
    v_lshl_add_u32 v181, v181, 3, v182
    s_mul_i32 s61, s30, 23760
    v_mad_u32_u24 v24, v24, s48, v181
    v_mad_u32_u24 v25, v25, s48, v181
    v_mad_u32_u24 v26, v26, s48, v181
    ds_write_b128 v104, v[100:103] offset:51712
    buffer_load_dwordx4 v7, s[12:15], s46 offen offset:1024 lds
    s_add_u32 s61, s61, s47
    s_mul_i32 s47, s30, 17280
    v_add_u32_sdwa v3, s61, v165 dst_sel:DWORD dst_unused:UNUSED_PAD src0_sel:DWORD src1_sel:WORD_0
    v_add_u32_sdwa v9, s61, v166 dst_sel:DWORD dst_unused:UNUSED_PAD src0_sel:DWORD src1_sel:WORD_0
    v_add_u32_sdwa v10, s61, v166 dst_sel:DWORD dst_unused:UNUSED_PAD src0_sel:DWORD src1_sel:WORD_1
    v_add_u32_sdwa v1, s47, v164 dst_sel:DWORD dst_unused:UNUSED_PAD src0_sel:DWORD src1_sel:WORD_0
    v_add_u32_sdwa v2, s47, v164 dst_sel:DWORD dst_unused:UNUSED_PAD src0_sel:DWORD src1_sel:WORD_1
    ds_write_b128 v104, v[100:103] offset:52352
    s_lshl_b32 s48, s29, 7
    s_lshl_b32 s49, s29, 5
    buffer_load_dwordx4 v7, s[12:15], s46 offen offset:2048 lds
    s_add_u32 s47, s48, 88992
    v_add_u32_sdwa v4, s47, v16 dst_sel:DWORD dst_unused:UNUSED_PAD src0_sel:DWORD src1_sel:WORD_0
    s_add_u32 s47, s49, 88992
    v_add_u32_sdwa v5, s47, v16 dst_sel:DWORD dst_unused:UNUSED_PAD src0_sel:DWORD src1_sel:WORD_0
    s_lshl2_add_u32 s47, s28, 163488
    v_mov_b32 v27, s47
    s_mov_b32 s54, 0
    s_cmp_eq_u32 s30, 0
    s_cselect_b32 s31, s26, s27
    s_branch L_S1
.p2align 12
L_S1:
    s_waitcnt lgkmcnt(0)
    s_barrier
    s_add_u32 m0, s44, 113824
    s_add_u32 s46, s65, 6144
    buffer_load_dwordx4 v7, s[12:15], s46 offen offset:0 lds
    buffer_load_dwordx4 v7, s[12:15], s46 offen offset:1024 lds
    buffer_load_dwordx4 v7, s[12:15], s46 offen offset:2048 lds
    s_waitcnt vmcnt(10)
    v_mov_b32 v235, v240
    s_mul_i32 s48, s55, 0
    s_add_u32 m0, s33, 0
    s_add_u32 s48, s48, s20
    buffer_load_dwordx4 v8, s[4:7], s48 offen lds
    v_perm_b32 v180, v232, v232, s59
    v_perm_b32 v184, v233, v233, s59
    v_perm_b32 v188, v234, v234, s59
    v_bfe_u32 v183, v232, s42, 15
    v_bfe_u32 v187, v233, s42, 15
    v_bfe_u32 v191, v234, s42, 15
    v_add_f32 v180, v180, v20
    v_add_f32 v184, v184, v21
    v_add_f32 v188, v188, v22
    v_cvt_pk_bf16_f32 v180, v180, v180
    v_cvt_pk_bf16_f32 v184, v184, v184
    s_mul_i32 s48, s55, 5
    s_add_u32 m0, s33, 17280
    s_add_u32 s48, s48, s20
    buffer_load_dwordx4 v8, s[4:7], s48 offen lds
    v_cvt_pk_bf16_f32 v188, v188, v188
    v_lshlrev_b32 v232, 16, v180
    v_lshlrev_b32 v233, 16, v184
    v_lshlrev_b32 v234, 16, v188
    v_med3_i32 v180, v232, 0, v23
    v_med3_i32 v184, v233, 0, v23
    v_med3_i32 v188, v234, 0, v23
    v_fract_f32 v181, v180
    v_fract_f32 v185, v184
    v_fract_f32 v189, v188
    v_cvt_u32_f32 v182, v180
    s_mul_i32 s48, s55, 1
    s_add_u32 m0, s33, 3456
    s_add_u32 s48, s48, s20
    buffer_load_dwordx4 v8, s[4:7], s48 offen lds
    v_cvt_u32_f32 v186, v184
    v_cvt_u32_f32 v190, v188
    v_sub_f32 v180, 1.0, v181
    v_sub_f32 v184, 1.0, v185
    v_sub_f32 v188, 1.0, v189
    v_max3_u32 v183, v183, v187, v191
    v_max3_i32 v232, v232, v233, v234
    v_cmp_lt_u32 vcc, s68, v183
    v_cmp_gt_i32 s[66:67], v232, v23
    v_lshl_add_u32 v182, v182, 1, v24
    v_lshl_add_u32 v186, v186, 1, v25
    s_mul_i32 s48, s55, 6
    s_add_u32 m0, s33, 20736
    s_add_u32 s48, s48, s20
    buffer_load_dwordx4 v8, s[4:7], s48 offen lds
    v_lshl_add_u32 v190, v190, 1, v26
    v_cvt_pk_bf16_f32 v180, v180, v181
    v_cvt_pk_bf16_f32 v184, v184, v185
    v_cvt_pk_bf16_f32 v188, v188, v189
    s_or_b64 vcc, vcc, s[66:67]
    s_cselect_b32 s47, 3, 0
    s_or_b32 s54, s54, s47
    v_perm_b32 v192, v236, v236, s59
    v_perm_b32 v196, v237, v237, s59
    v_perm_b32 v200, v238, v238, s59
    v_bfe_u32 v195, v236, s42, 15
    v_bfe_u32 v199, v237, s42, 15
    v_bfe_u32 v203, v238, s42, 15
    s_mul_i32 s48, s55, 2
    s_add_u32 m0, s33, 6912
    s_add_u32 s48, s48, s20
    buffer_load_dwordx4 v8, s[4:7], s48 offen lds
    v_add_f32 v192, v192, v20
    v_add_f32 v196, v196, v21
    v_add_f32 v200, v200, v22
    v_cvt_pk_bf16_f32 v192, v192, v192
    v_cvt_pk_bf16_f32 v196, v196, v196
    v_cvt_pk_bf16_f32 v200, v200, v200
    v_lshlrev_b32 v236, 16, v192
    v_lshlrev_b32 v237, 16, v196
    v_lshlrev_b32 v238, 16, v200
    v_med3_i32 v192, v236, 0, v23
    v_med3_i32 v196, v237, 0, v23
    s_mul_i32 s48, s55, 7
    s_add_u32 m0, s33, 24192
    s_add_u32 s48, s48, s20
    buffer_load_dwordx4 v8, s[4:7], s48 offen lds
    v_med3_i32 v200, v238, 0, v23
    v_fract_f32 v193, v192
    v_fract_f32 v197, v196
    v_fract_f32 v201, v200
    v_cvt_u32_f32 v194, v192
    v_cvt_u32_f32 v198, v196
    v_cvt_u32_f32 v202, v200
    v_sub_f32 v192, 1.0, v193
    v_sub_f32 v196, 1.0, v197
    v_sub_f32 v200, 1.0, v201
    v_max3_u32 v195, v195, v199, v203
    v_max3_i32 v236, v236, v237, v238
    v_cmp_lt_u32 vcc, s68, v195
    v_cmp_gt_i32 s[66:67], v236, v23
    v_lshl_add_u32 v194, v194, 1, v24
    v_lshl_add_u32 v198, v198, 1, v25
    v_lshl_add_u32 v202, v202, 1, v26
    v_cvt_pk_bf16_f32 v192, v192, v193
    v_cvt_pk_bf16_f32 v196, v196, v197
    v_cvt_pk_bf16_f32 v200, v200, v201
    s_or_b64 vcc, vcc, s[66:67]
    s_cselect_b32 s47, 12, 0
    s_or_b32 s54, s54, s47
    v_perm_b32 v204, v240, v240, s59
    v_perm_b32 v208, v241, v241, s59
    v_perm_b32 v212, v242, v242, s59
    v_bfe_u32 v207, v240, s42, 15
    v_bfe_u32 v211, v241, s42, 15
    v_bfe_u32 v215, v242, s42, 15
    v_add_f32 v204, v204, v20
    v_add_f32 v208, v208, v21
    v_add_f32 v212, v212, v22
    v_cvt_pk_bf16_f32 v204, v204, v204
    v_cvt_pk_bf16_f32 v208, v208, v208
    v_cvt_pk_bf16_f32 v212, v212, v212
    v_lshlrev_b32 v240, 16, v204
    v_lshlrev_b32 v241, 16, v208
    v_lshlrev_b32 v242, 16, v212
    v_med3_i32 v204, v240, 0, v23
    v_med3_i32 v208, v241, 0, v23
    v_med3_i32 v212, v242, 0, v23
    v_fract_f32 v205, v204
    v_fract_f32 v209, v208
    v_fract_f32 v213, v212
    v_cvt_u32_f32 v206, v204
    v_cvt_u32_f32 v210, v208
    v_cvt_u32_f32 v214, v212
    v_sub_f32 v204, 1.0, v205
    v_sub_f32 v208, 1.0, v209
    v_sub_f32 v212, 1.0, v213
    v_max3_u32 v207, v207, v211, v215
    v_max3_i32 v240, v240, v241, v242
    v_cmp_lt_u32 vcc, s68, v207
    v_cmp_gt_i32 s[66:67], v240, v23
    v_lshl_add_u32 v206, v206, 1, v24
    v_lshl_add_u32 v210, v210, 1, v25
    v_lshl_add_u32 v214, v214, 1, v26
    v_cvt_pk_bf16_f32 v204, v204, v205
    v_cvt_pk_bf16_f32 v208, v208, v209
    v_cvt_pk_bf16_f32 v212, v212, v213
    s_or_b64 vcc, vcc, s[66:67]
    s_cselect_b32 s47, 48, 0
    s_or_b32 s54, s54, s47
    s_mov_b32 exec_hi, 0xffff
    ds_write_b16 v182, v180 offset:0
    ds_write_b16_d16_hi v182, v180 offset:2
    ds_write_b16 v186, v184 offset:0
    ds_write_b16_d16_hi v186, v184 offset:2
    ds_write_b16 v190, v188 offset:0
    ds_write_b16_d16_hi v190, v188 offset:2
    s_mov_b64 exec, -1
    s_mov_b32 exec_hi, 0xffff
    ds_write_b16 v194, v192 offset:9504
    ds_write_b16_d16_hi v194, v192 offset:9506
    ds_write_b16 v198, v196 offset:9504
    ds_write_b16_d16_hi v198, v196 offset:9506
    ds_write_b16 v202, v200 offset:9504
    ds_write_b16_d16_hi v202, v200 offset:9506
    s_mov_b64 exec, -1
    s_mov_b64 exec, 0xffffff
    ds_write_b16 v206, v204 offset:19008
    ds_write_b16_d16_hi v206, v204 offset:19010
    ds_write_b16 v210, v208 offset:19008
    ds_write_b16_d16_hi v210, v208 offset:19010
    ds_write_b16 v214, v212 offset:19008
    ds_write_b16_d16_hi v214, v212 offset:19010
    s_mov_b64 exec, -1
    v_mov_b32 v12, s54
    ds_write_b32 v27, v12
    s_waitcnt vmcnt(6)
    s_barrier
    s_mul_i32 s48, s55, 3
    s_add_u32 m0, s33, 10368
    s_add_u32 s48, s48, s20
    buffer_load_dwordx4 v8, s[4:7], s48 offen lds
    ds_read_b64_tr_b16 a[0:1], v4 offset:0
    ds_read_b64_tr_b16 a[2:3], v4 offset:768
    ds_read_b64_tr_b16 a[4:5], v4 offset:32
    ds_read_b64_tr_b16 a[6:7], v4 offset:800
    ds_read_b64_tr_b16 a[8:9], v5 offset:64
    ds_read_b64_tr_b16 a[10:11], v5 offset:832
    ds_read_b64_tr_b16 a[12:13], v4 offset:6208
    ds_read_b64_tr_b16 a[14:15], v4 offset:6976
    ds_read_b64_tr_b16 a[16:17], v4 offset:6240
    ds_read_b64_tr_b16 a[18:19], v4 offset:7008
    s_mul_i32 s48, s55, 8
    s_add_u32 m0, s33, 27648
    s_add_u32 s48, s48, s20
    buffer_load_dwordx4 v8, s[4:7], s48 offen lds
    ds_read_b64_tr_b16 a[20:21], v5 offset:6272
    ds_read_b64_tr_b16 a[22:23], v5 offset:7040
    ds_read_b64_tr_b16 a[24:25], v4 offset:12416
    ds_read_b64_tr_b16 a[26:27], v4 offset:13184
    ds_read_b64_tr_b16 a[28:29], v4 offset:12448
    ds_read_b64_tr_b16 a[30:31], v4 offset:13216
    ds_read_b64_tr_b16 a[32:33], v5 offset:12480
    ds_read_b64_tr_b16 a[34:35], v5 offset:13248
    ds_read_b64_tr_b16 a[36:37], v4 offset:18624
    ds_read_b64_tr_b16 a[38:39], v4 offset:19392
    s_mul_i32 s48, s55, 4
    s_add_u32 m0, s33, 13824
    s_add_u32 s48, s48, s20
    buffer_load_dwordx4 v8, s[4:7], s48 offen lds
    ds_read_b64_tr_b16 a[40:41], v4 offset:18656
    ds_read_b64_tr_b16 a[42:43], v4 offset:19424
    ds_read_b64_tr_b16 a[44:45], v5 offset:18688
    ds_read_b64_tr_b16 a[46:47], v5 offset:19456
    ds_read_b64_tr_b16 a[48:49], v4 offset:24832
    ds_read_b64_tr_b16 a[50:51], v4 offset:25600
    ds_read_b64_tr_b16 a[52:53], v4 offset:24864
    ds_read_b64_tr_b16 a[54:55], v4 offset:25632
    ds_read_b64_tr_b16 a[56:57], v5 offset:24896
    ds_read_b64_tr_b16 a[58:59], v5 offset:25664
    s_mul_i32 s48, s55, 9
    s_add_u32 m0, s33, 31104
    s_add_u32 s48, s48, s20
    buffer_load_dwordx4 v8, s[4:7], s48 offen lds
    ds_read_b64_tr_b16 a[60:61], v4 offset:31040
    ds_read_b64_tr_b16 a[62:63], v4 offset:31808
    ds_read_b64_tr_b16 a[64:65], v4 offset:31072
    ds_read_b64_tr_b16 a[66:67], v4 offset:31840
    ds_read_b64_tr_b16 a[68:69], v5 offset:31104
    ds_read_b64_tr_b16 a[70:71], v5 offset:31872
    v_add_u32 v4, 37248, v4
    v_add_u32 v5, 37248, v5
    s_cmp_eq_u32 s28, 1
    s_cbranch_scc0 L_S1_n0
    s_call_b64 s[78:79], L_S1_t0
L_S1_n0:
    s_cmp_eq_u32 s28, 2
    s_cbranch_scc0 L_S1_n1
    s_call_b64 s[78:79], L_S1_t1
L_S1_n1:
    s_waitcnt vmcnt(6)
    s_waitcnt lgkmcnt(0)
    s_barrier
    ds_read_b128 a[144:147], v1 offset:0
    ds_read_b128 a[148:151], v1 offset:64
    ds_read_b128 a[152:155], v1 offset:128
    ds_read_b128 a[156:159], v1 offset:3456
    ds_read_b128 a[160:163], v1 offset:3520
    ds_read_b128 a[164:167], v1 offset:3584
    s_waitcnt lgkmcnt(5)
    v_mfma_f32_16x16x32_bf16 v[116:119], a[144:147], a[0:3], 0
    s_add_u32 m0, s44, 126240
    s_bfe_u32 s46, s24, 0x40008
    s_mul_i32 s46, s46, 18432
    v_mfma_f32_16x16x32_bf16 v[120:123], a[144:147], a[4:7], 0
    buffer_load_dwordx4 v7, s[12:15], s46 offen offset:0 lds
    v_mfma_f32_16x16x32_bf16 v[124:127], a[144:147], a[8:11], 0
    s_waitcnt lgkmcnt(4)
    v_mfma_f32_16x16x32_bf16 v[116:119], a[148:151], a[12:15], v[116:119]
    v_mfma_f32_16x16x32_bf16 v[120:123], a[148:151], a[16:19], v[120:123]
    v_mfma_f32_16x16x32_bf16 v[124:127], a[148:151], a[20:23], v[124:127]
    buffer_load_dwordx4 v7, s[12:15], s46 offen offset:1024 lds
    s_waitcnt lgkmcnt(3)
    v_mfma_f32_16x16x32_bf16 v[116:119], a[152:155], a[24:27], v[116:119]
    v_mfma_f32_16x16x32_bf16 v[120:123], a[152:155], a[28:31], v[120:123]
    v_mfma_f32_16x16x32_bf16 v[124:127], a[152:155], a[32:35], v[124:127]
    v_mfma_f32_16x16x32_bf16 v[128:131], a[144:147], a[36:39], 0
    buffer_load_dwordx4 v7, s[12:15], s46 offen offset:2048 lds
    v_mfma_f32_16x16x32_bf16 v[132:135], a[144:147], a[40:43], 0
    v_mfma_f32_16x16x32_bf16 v[136:139], a[144:147], a[44:47], 0
    ds_read_b64 v[216:217], v3 offset:0
    v_mfma_f32_16x16x32_bf16 v[128:131], a[148:151], a[48:51], v[128:131]
    v_cvt_pk_bf16_f32 v140, v116, v117
    v_cvt_pk_bf16_f32 v141, v118, v119
    v_mfma_f32_16x16x32_bf16 v[132:135], a[148:151], a[52:55], v[132:135]
    v_cvt_pk_bf16_f32 v144, v120, v121
    v_cvt_pk_bf16_f32 v145, v122, v123
    v_mfma_f32_16x16x32_bf16 v[136:139], a[148:151], a[56:59], v[136:139]
    v_cvt_pk_bf16_f32 v148, v124, v125
    v_cvt_pk_bf16_f32 v149, v126, v127
    s_add_u32 m0, s44, 138656
    s_add_u32 s64, s46, 12288
    s_bfe_u32 s65, s24, 0x4000c
    s_mul_i32 s65, s65, 18432
    v_mfma_f32_16x16x32_bf16 v[128:131], a[152:155], a[60:63], v[128:131]
    ds_read_b64 v[218:219], v3 offset:528
    s_sub_u32 s46, s65, 6144
    s_cmp_eq_u32 s30, 0
    s_cselect_b32 s46, s64, s46
    v_mfma_f32_16x16x32_bf16 v[132:135], a[152:155], a[64:67], v[132:135]
    buffer_load_dwordx4 v7, s[12:15], s46 offen offset:0 lds
    v_mfma_f32_16x16x32_bf16 v[136:139], a[152:155], a[68:71], v[136:139]
    buffer_load_dwordx4 v7, s[12:15], s46 offen offset:1024 lds
    s_waitcnt lgkmcnt(4)
    v_mfma_f32_16x16x32_bf16 v[116:119], a[156:159], a[0:3], 0
    v_mfma_f32_16x16x32_bf16 v[120:123], a[156:159], a[4:7], 0
    v_mfma_f32_16x16x32_bf16 v[124:127], a[156:159], a[8:11], 0
    buffer_load_dwordx4 v7, s[12:15], s46 offen offset:2048 lds
    s_waitcnt lgkmcnt(3)
    v_mfma_f32_16x16x32_bf16 v[116:119], a[160:163], a[12:15], v[116:119]
    v_cvt_pk_bf16_f32 v142, v128, v129
    v_cvt_pk_bf16_f32 v143, v130, v131
    v_mfma_f32_16x16x32_bf16 v[120:123], a[160:163], a[16:19], v[120:123]
    v_cvt_pk_bf16_f32 v146, v132, v133
    v_cvt_pk_bf16_f32 v147, v134, v135
    v_mfma_f32_16x16x32_bf16 v[124:127], a[160:163], a[20:23], v[124:127]
    v_cvt_pk_bf16_f32 v150, v136, v137
    v_cvt_pk_bf16_f32 v151, v138, v139
    s_add_u32 m0, s44, 151072
    s_add_u32 s46, s65, 6144
    s_waitcnt lgkmcnt(2)
    v_mfma_f32_16x16x32_bf16 v[116:119], a[164:167], a[24:27], v[116:119]
    buffer_load_dwordx4 v7, s[12:15], s46 offen offset:0 lds
    v_mfma_f32_16x16x32_bf16 v[120:123], a[164:167], a[28:31], v[120:123]
    s_waitcnt lgkmcnt(0)
    v_mfma_f32_16x16x32_bf16 v[44:47], v[140:143], v[216:219], 0
    s_waitcnt vmcnt(7)
    s_barrier
    v_mfma_f32_16x16x32_bf16 v[48:51], v[144:147], v[216:219], 0
    buffer_load_dwordx4 v7, s[12:15], s46 offen offset:1024 lds
    v_mfma_f32_16x16x32_bf16 v[52:55], v[148:151], v[216:219], 0
    ds_read_b128 a[168:171], v1 offset:6912
    v_mfma_f32_16x16x32_bf16 v[124:127], a[164:167], a[32:35], v[124:127]
    ds_read_b64 v[220:221], v3 offset:4752
    v_mfma_f32_16x16x32_bf16 v[128:131], a[156:159], a[36:39], 0
    ds_read_b64 v[222:223], v3 offset:5280
    v_mfma_f32_16x16x32_bf16 v[132:135], a[156:159], a[40:43], 0
    buffer_load_dwordx4 v7, s[12:15], s46 offen offset:2048 lds
    v_mfma_f32_16x16x32_bf16 v[136:139], a[156:159], a[44:47], 0
    ds_read_b128 a[172:175], v1 offset:6976
    v_mfma_f32_16x16x32_bf16 v[128:131], a[160:163], a[48:51], v[128:131]
    v_cvt_pk_bf16_f32 v140, v116, v117
    v_cvt_pk_bf16_f32 v141, v118, v119
    v_mfma_f32_16x16x32_bf16 v[132:135], a[160:163], a[52:55], v[132:135]
    v_cvt_pk_bf16_f32 v144, v120, v121
    v_cvt_pk_bf16_f32 v145, v122, v123
    v_mfma_f32_16x16x32_bf16 v[136:139], a[160:163], a[56:59], v[136:139]
    v_cvt_pk_bf16_f32 v148, v124, v125
    v_cvt_pk_bf16_f32 v149, v126, v127
    s_mul_i32 s48, s55, 10
    s_add_u32 m0, s33, 34560
    s_add_u32 s48, s48, s20
    v_mfma_f32_16x16x32_bf16 v[128:131], a[164:167], a[60:63], v[128:131]
    buffer_load_dwordx4 v8, s[4:7], s48 offen lds
    v_mfma_f32_16x16x32_bf16 v[132:135], a[164:167], a[64:67], v[132:135]
    s_mul_i32 s48, s55, 11
    s_add_u32 m0, s33, 38016
    s_add_u32 s48, s48, s20
    s_min_u32 s48, s48, s21
    v_mfma_f32_16x16x32_bf16 v[136:139], a[164:167], a[68:71], v[136:139]
    buffer_load_dwordx4 v8, s[4:7], s48 offen lds
    s_waitcnt lgkmcnt(3)
    v_mfma_f32_16x16x32_bf16 v[116:119], a[168:171], a[0:3], 0
    ds_read_b128 a[176:179], v1 offset:7040
    v_mfma_f32_16x16x32_bf16 v[120:123], a[168:171], a[4:7], 0
    ds_read_b128 a[180:183], v1 offset:10368
    v_mfma_f32_16x16x32_bf16 v[124:127], a[168:171], a[8:11], 0
    ds_read_b128 a[184:187], v1 offset:10432
    s_waitcnt lgkmcnt(3)
    v_mfma_f32_16x16x32_bf16 v[116:119], a[172:175], a[12:15], v[116:119]
    v_cvt_pk_bf16_f32 v142, v128, v129
    v_cvt_pk_bf16_f32 v143, v130, v131
    v_mfma_f32_16x16x32_bf16 v[120:123], a[172:175], a[16:19], v[120:123]
    v_cvt_pk_bf16_f32 v146, v132, v133
    v_cvt_pk_bf16_f32 v147, v134, v135
    v_mfma_f32_16x16x32_bf16 v[124:127], a[172:175], a[20:23], v[124:127]
    v_cvt_pk_bf16_f32 v150, v136, v137
    v_cvt_pk_bf16_f32 v151, v138, v139
    s_add_u32 m0, s44, 88992
    s_bfe_u32 s46, s24, 0x40010
    s_mul_i32 s46, s46, 18432
    s_waitcnt lgkmcnt(2)
    v_mfma_f32_16x16x32_bf16 v[116:119], a[176:179], a[24:27], v[116:119]
    buffer_load_dwordx4 v7, s[12:15], s46 offen offset:0 lds
    v_mfma_f32_16x16x32_bf16 v[120:123], a[176:179], a[28:31], v[120:123]
    ds_read_b128 a[188:191], v1 offset:10496
    v_mfma_f32_16x16x32_bf16 v[56:59], v[140:143], v[220:223], 0
    ds_read_b128 a[192:195], v1 offset:13824
    v_mfma_f32_16x16x32_bf16 v[60:63], v[144:147], v[220:223], 0
    buffer_load_dwordx4 v7, s[12:15], s46 offen offset:1024 lds
    v_mfma_f32_16x16x32_bf16 v[64:67], v[148:151], v[220:223], 0
    ds_read_b128 a[196:199], v1 offset:13888
    v_mfma_f32_16x16x32_bf16 v[124:127], a[176:179], a[32:35], v[124:127]
    ds_read_b64 v[216:217], v3 offset:9504
    v_mfma_f32_16x16x32_bf16 v[128:131], a[168:171], a[36:39], 0
    ds_read_b64 v[218:219], v3 offset:10032
    v_mfma_f32_16x16x32_bf16 v[132:135], a[168:171], a[40:43], 0
    ds_read_b128 a[200:203], v1 offset:13952
    v_mfma_f32_16x16x32_bf16 v[136:139], a[168:171], a[44:47], 0
    ds_read_b128 a[228:231], v2 offset:0
    v_mfma_f32_16x16x32_bf16 v[128:131], a[172:175], a[48:51], v[128:131]
    v_cvt_pk_bf16_f32 v140, v116, v117
    v_cvt_pk_bf16_f32 v141, v118, v119
    v_mfma_f32_16x16x32_bf16 v[132:135], a[172:175], a[52:55], v[132:135]
    v_cvt_pk_bf16_f32 v144, v120, v121
    v_cvt_pk_bf16_f32 v145, v122, v123
    v_mfma_f32_16x16x32_bf16 v[136:139], a[172:175], a[56:59], v[136:139]
    v_cvt_pk_bf16_f32 v148, v124, v125
    v_cvt_pk_bf16_f32 v149, v126, v127
    v_mfma_f32_16x16x32_bf16 v[128:131], a[176:179], a[60:63], v[128:131]
    buffer_load_dwordx4 v7, s[12:15], s46 offen offset:2048 lds
    v_mfma_f32_16x16x32_bf16 v[132:135], a[176:179], a[64:67], v[132:135]
    s_add_u32 m0, s44, 101408
    s_add_u32 s64, s46, 12288
    s_bfe_u32 s65, s24, 0x40014
    s_mul_i32 s65, s65, 18432
    v_mfma_f32_16x16x32_bf16 v[136:139], a[176:179], a[68:71], v[136:139]
    s_sub_u32 s46, s65, 6144
    s_cmp_eq_u32 s30, 0
    s_cselect_b32 s46, s64, s46
    s_waitcnt lgkmcnt(7)
    v_mfma_f32_16x16x32_bf16 v[116:119], a[180:183], a[0:3], 0
    buffer_load_dwordx4 v7, s[12:15], s46 offen offset:0 lds
    s_waitcnt vmcnt(6)
    s_barrier
    v_mfma_f32_16x16x32_bf16 v[120:123], a[180:183], a[4:7], 0
    ds_read_b128 a[232:235], v2 offset:64
    ds_read_b64_tr_b16 a[72:73], v4 offset:0
    v_mfma_f32_16x16x32_bf16 v[124:127], a[180:183], a[8:11], 0
    ds_read_b128 a[236:239], v2 offset:128
    ds_read_b64_tr_b16 a[74:75], v4 offset:768
    v_mfma_f32_16x16x32_bf16 v[116:119], a[184:187], a[12:15], v[116:119]
    v_cvt_pk_bf16_f32 v142, v128, v129
    v_cvt_pk_bf16_f32 v143, v130, v131
    v_mfma_f32_16x16x32_bf16 v[120:123], a[184:187], a[16:19], v[120:123]
    v_cvt_pk_bf16_f32 v146, v132, v133
    v_cvt_pk_bf16_f32 v147, v134, v135
    v_mfma_f32_16x16x32_bf16 v[124:127], a[184:187], a[20:23], v[124:127]
    v_cvt_pk_bf16_f32 v150, v136, v137
    v_cvt_pk_bf16_f32 v151, v138, v139
    s_waitcnt lgkmcnt(7)
    v_mfma_f32_16x16x32_bf16 v[116:119], a[188:191], a[24:27], v[116:119]
    buffer_load_dwordx4 v7, s[12:15], s46 offen offset:1024 lds
    v_mfma_f32_16x16x32_bf16 v[120:123], a[188:191], a[28:31], v[120:123]
    ds_read_b64_tr_b16 a[76:77], v4 offset:32
    s_waitcnt lgkmcnt(7)
    v_mfma_f32_16x16x32_bf16 v[68:71], v[140:143], v[216:219], 0
    ds_read_b64_tr_b16 a[78:79], v4 offset:800
    v_mfma_f32_16x16x32_bf16 v[72:75], v[144:147], v[216:219], 0
    ds_read_b64_tr_b16 a[80:81], v5 offset:64
    v_mfma_f32_16x16x32_bf16 v[76:79], v[148:151], v[216:219], 0
    ds_read_b64_tr_b16 a[82:83], v5 offset:832
    ds_read_b64_tr_b16 a[84:85], v4 offset:6208
    v_mfma_f32_16x16x32_bf16 v[124:127], a[188:191], a[32:35], v[124:127]
    ds_read_b64 v[220:221], v3 offset:14256
    v_mfma_f32_16x16x32_bf16 v[128:131], a[180:183], a[36:39], 0
    ds_read_b64 v[222:223], v3 offset:14784
    v_mfma_f32_16x16x32_bf16 v[132:135], a[180:183], a[40:43], 0
    buffer_load_dwordx4 v7, s[12:15], s46 offen offset:2048 lds
    v_mfma_f32_16x16x32_bf16 v[136:139], a[180:183], a[44:47], 0
    ds_read_b64_tr_b16 a[86:87], v4 offset:6976
    ds_read_b64_tr_b16 a[88:89], v4 offset:6240
    v_mfma_f32_16x16x32_bf16 v[128:131], a[184:187], a[48:51], v[128:131]
    v_cvt_pk_bf16_f32 v140, v116, v117
    v_cvt_pk_bf16_f32 v141, v118, v119
    ds_read_b64_tr_b16 a[90:91], v4 offset:7008
    v_mfma_f32_16x16x32_bf16 v[132:135], a[184:187], a[52:55], v[132:135]
    v_cvt_pk_bf16_f32 v144, v120, v121
    v_cvt_pk_bf16_f32 v145, v122, v123
    v_mfma_f32_16x16x32_bf16 v[136:139], a[184:187], a[56:59], v[136:139]
    v_cvt_pk_bf16_f32 v148, v124, v125
    v_cvt_pk_bf16_f32 v149, v126, v127
    s_add_u32 m0, s44, 113824
    s_add_u32 s46, s65, 6144
    v_mfma_f32_16x16x32_bf16 v[128:131], a[188:191], a[60:63], v[128:131]
    buffer_load_dwordx4 v7, s[12:15], s46 offen offset:0 lds
    v_mfma_f32_16x16x32_bf16 v[132:135], a[188:191], a[64:67], v[132:135]
    ds_read_b64_tr_b16 a[92:93], v5 offset:6272
    v_mfma_f32_16x16x32_bf16 v[136:139], a[188:191], a[68:71], v[136:139]
    ds_read_b64_tr_b16 a[94:95], v5 offset:7040
    v_mfma_f32_16x16x32_bf16 v[116:119], a[192:195], a[0:3], 0
    ds_read_b64_tr_b16 a[96:97], v4 offset:12416
    v_mfma_f32_16x16x32_bf16 v[120:123], a[192:195], a[4:7], 0
    ds_read_b64_tr_b16 a[98:99], v4 offset:13184
    v_mfma_f32_16x16x32_bf16 v[124:127], a[192:195], a[8:11], 0
    ds_read_b64_tr_b16 a[100:101], v4 offset:12448
    ds_read_b64_tr_b16 a[102:103], v4 offset:13216
    v_mfma_f32_16x16x32_bf16 v[116:119], a[196:199], a[12:15], v[116:119]
    v_cvt_pk_bf16_f32 v142, v128, v129
    v_cvt_pk_bf16_f32 v143, v130, v131
    v_mfma_f32_16x16x32_bf16 v[120:123], a[196:199], a[16:19], v[120:123]
    v_cvt_pk_bf16_f32 v146, v132, v133
    v_cvt_pk_bf16_f32 v147, v134, v135
    v_mfma_f32_16x16x32_bf16 v[124:127], a[196:199], a[20:23], v[124:127]
    v_cvt_pk_bf16_f32 v150, v136, v137
    v_cvt_pk_bf16_f32 v151, v138, v139
    s_waitcnt lgkmcnt(7)
    v_mfma_f32_16x16x32_bf16 v[116:119], a[200:203], a[24:27], v[116:119]
    buffer_load_dwordx4 v7, s[12:15], s46 offen offset:1024 lds
    v_mfma_f32_16x16x32_bf16 v[120:123], a[200:203], a[28:31], v[120:123]
    ds_read_b64_tr_b16 a[104:105], v5 offset:12480
    v_mfma_f32_16x16x32_bf16 v[80:83], v[140:143], v[220:223], 0
    ds_read_b64_tr_b16 a[106:107], v5 offset:13248
    v_mfma_f32_16x16x32_bf16 v[84:87], v[144:147], v[220:223], 0
    buffer_load_dwordx4 v7, s[12:15], s46 offen offset:2048 lds
    v_mfma_f32_16x16x32_bf16 v[88:91], v[148:151], v[220:223], 0
    ds_read_b64_tr_b16 a[108:109], v4 offset:18624
    ds_read_b64_tr_b16 a[110:111], v4 offset:19392
    v_mfma_f32_16x16x32_bf16 v[124:127], a[200:203], a[32:35], v[124:127]
    ds_read_b64 v[216:217], v3 offset:19008
    v_mfma_f32_16x16x32_bf16 v[128:131], a[192:195], a[36:39], 0
    ds_read_b64 v[218:219], v3 offset:19536
    v_mfma_f32_16x16x32_bf16 v[132:135], a[192:195], a[40:43], 0
    ds_read_b64_tr_b16 a[112:113], v4 offset:18656
    v_mfma_f32_16x16x32_bf16 v[136:139], a[192:195], a[44:47], 0
    ds_read_b64_tr_b16 a[114:115], v4 offset:19424
    ds_read_b64_tr_b16 a[116:117], v5 offset:18688
    v_mfma_f32_16x16x32_bf16 v[128:131], a[196:199], a[48:51], v[128:131]
    v_cvt_pk_bf16_f32 v140, v116, v117
    v_cvt_pk_bf16_f32 v141, v118, v119
    v_mfma_f32_16x16x32_bf16 v[132:135], a[196:199], a[52:55], v[132:135]
    v_cvt_pk_bf16_f32 v144, v120, v121
    v_cvt_pk_bf16_f32 v145, v122, v123
    v_mfma_f32_16x16x32_bf16 v[136:139], a[196:199], a[56:59], v[136:139]
    v_cvt_pk_bf16_f32 v148, v124, v125
    v_cvt_pk_bf16_f32 v149, v126, v127
    v_mfma_f32_16x16x32_bf16 v[128:131], a[200:203], a[60:63], v[128:131]
    ds_read_b64_tr_b16 a[118:119], v5 offset:19456
    v_mfma_f32_16x16x32_bf16 v[132:135], a[200:203], a[64:67], v[132:135]
    ds_read_b64_tr_b16 a[120:121], v4 offset:24832
    v_mfma_f32_16x16x32_bf16 v[136:139], a[200:203], a[68:71], v[136:139]
    ds_read_b64_tr_b16 a[122:123], v4 offset:25600
    v_mfma_f32_16x16x32_bf16 v[116:119], a[228:231], a[0:3], 0
    ds_read_b64_tr_b16 a[124:125], v4 offset:24864
    v_mfma_f32_16x16x32_bf16 v[120:123], a[228:231], a[4:7], 0
    ds_read_b64_tr_b16 a[126:127], v4 offset:25632
    v_mfma_f32_16x16x32_bf16 v[124:127], a[228:231], a[8:11], 0
    ds_read_b64_tr_b16 a[128:129], v5 offset:24896
    v_mfma_f32_16x16x32_bf16 v[116:119], a[232:235], a[12:15], v[116:119]
    v_cvt_pk_bf16_f32 v142, v128, v129
    v_cvt_pk_bf16_f32 v143, v130, v131
    v_mfma_f32_16x16x32_bf16 v[120:123], a[232:235], a[16:19], v[120:123]
    v_cvt_pk_bf16_f32 v146, v132, v133
    v_cvt_pk_bf16_f32 v147, v134, v135
    v_mfma_f32_16x16x32_bf16 v[124:127], a[232:235], a[20:23], v[124:127]
    v_cvt_pk_bf16_f32 v150, v136, v137
    v_cvt_pk_bf16_f32 v151, v138, v139
    v_mfma_f32_16x16x32_bf16 v[116:119], a[236:239], a[24:27], v[116:119]
    ds_read_b64_tr_b16 a[130:131], v5 offset:25664
    v_mfma_f32_16x16x32_bf16 v[120:123], a[236:239], a[28:31], v[120:123]
    ds_read_b64_tr_b16 a[132:133], v4 offset:31040
    s_waitcnt lgkmcnt(7)
    v_mfma_f32_16x16x32_bf16 v[92:95], v[140:143], v[216:219], 0
    ds_read_b64_tr_b16 a[134:135], v4 offset:31808
    v_mfma_f32_16x16x32_bf16 v[96:99], v[144:147], v[216:219], 0
    ds_read_b64_tr_b16 a[136:137], v4 offset:31072
    v_mfma_f32_16x16x32_bf16 v[100:103], v[148:151], v[216:219], 0
    ds_read_b64_tr_b16 a[138:139], v4 offset:31840
    ds_read_b64_tr_b16 a[140:141], v5 offset:31104
    v_mfma_f32_16x16x32_bf16 v[124:127], a[236:239], a[32:35], v[124:127]
    ds_read_b32 v220, v9 offset:0
    v_mfma_f32_16x16x32_bf16 v[128:131], a[228:231], a[36:39], 0
    ds_read_b32 v221, v10 offset:0
    ds_read_b64_tr_b16 a[142:143], v5 offset:31872
    v_mfma_f32_16x16x32_bf16 v[132:135], a[228:231], a[40:43], 0
    ds_read_b32 v222, v9 offset:528
    v_add_u32 v4, -37248, v4
    v_mfma_f32_16x16x32_bf16 v[136:139], a[228:231], a[44:47], 0
    ds_read_b32 v223, v10 offset:528
    v_mfma_f32_16x16x32_bf16 v[128:131], a[232:235], a[48:51], v[128:131]
    v_cvt_pk_bf16_f32 v140, v116, v117
    v_cvt_pk_bf16_f32 v141, v118, v119
    v_add_u32 v5, -37248, v5
    v_mfma_f32_16x16x32_bf16 v[132:135], a[232:235], a[52:55], v[132:135]
    v_cvt_pk_bf16_f32 v144, v120, v121
    v_cvt_pk_bf16_f32 v145, v122, v123
    v_mfma_f32_16x16x32_bf16 v[136:139], a[232:235], a[56:59], v[136:139]
    v_cvt_pk_bf16_f32 v148, v124, v125
    v_cvt_pk_bf16_f32 v149, v126, v127
    v_mfma_f32_16x16x32_bf16 v[128:131], a[236:239], a[60:63], v[128:131]
    v_mfma_f32_16x16x32_bf16 v[132:135], a[236:239], a[64:67], v[132:135]
    v_mfma_f32_16x16x32_bf16 v[136:139], a[236:239], a[68:71], v[136:139]
    s_waitcnt vmcnt(0)
    s_waitcnt lgkmcnt(0)
    s_barrier
    s_branch L_S1_s0
L_S1_t0:
    s_setpc_b64 s[78:79]
L_S1_s0:
    v_mfma_f32_16x16x32_bf16 v[116:119], a[144:147], a[72:75], 0
    v_mfma_f32_16x16x32_bf16 v[120:123], a[144:147], a[76:79], 0
    v_mfma_f32_16x16x32_bf16 v[124:127], a[144:147], a[80:83], 0
    v_mfma_f32_16x16x32_bf16 v[116:119], a[148:151], a[84:87], v[116:119]
    v_cvt_pk_bf16_f32 v142, v128, v129
    v_cvt_pk_bf16_f32 v143, v130, v131
    v_mfma_f32_16x16x32_bf16 v[120:123], a[148:151], a[88:91], v[120:123]
    v_cvt_pk_bf16_f32 v146, v132, v133
    v_cvt_pk_bf16_f32 v147, v134, v135
    v_mfma_f32_16x16x32_bf16 v[124:127], a[148:151], a[92:95], v[124:127]
    v_cvt_pk_bf16_f32 v150, v136, v137
    v_cvt_pk_bf16_f32 v151, v138, v139
    s_add_u32 m0, s44, 126240
    s_bfe_u32 s46, s24, 0x40018
    s_mul_i32 s46, s46, 18432
    v_mfma_f32_16x16x32_bf16 v[116:119], a[152:155], a[96:99], v[116:119]
    buffer_load_dwordx4 v7, s[12:15], s46 offen offset:0 lds
    v_mfma_f32_16x16x32_bf16 v[120:123], a[152:155], a[100:103], v[120:123]
    v_mfma_f32_16x16x32_bf16 v[104:107], v[220:223], v[140:143], 0
    v_mfma_f32_16x16x32_bf16 v[108:111], v[220:223], v[144:147], 0
    v_mfma_f32_16x16x32_bf16 v[112:115], v[220:223], v[148:151], 0
    buffer_load_dwordx4 v7, s[12:15], s46 offen offset:1024 lds
    v_mfma_f32_16x16x32_bf16 v[124:127], a[152:155], a[104:107], v[124:127]
    ds_read_b64 v[216:217], v3 offset:1056
    v_mfma_f32_16x16x32_bf16 v[128:131], a[156:159], a[108:111], 0
    ds_read_b64 v[218:219], v3 offset:1584
    v_mfma_f32_16x16x32_bf16 v[132:135], a[156:159], a[112:115], 0
    ds_read_b128 a[204:207], v1 offset:17280
    v_mfma_f32_16x16x32_bf16 v[136:139], a[156:159], a[116:119], 0
    ds_read_b128 a[208:211], v1 offset:17344
    v_mfma_f32_16x16x32_bf16 v[128:131], a[160:163], a[120:123], v[128:131]
    v_cvt_pk_bf16_f32 v140, v116, v117
    v_cvt_pk_bf16_f32 v141, v118, v119
    ds_read_b128 a[212:215], v1 offset:17408
    v_mfma_f32_16x16x32_bf16 v[132:135], a[160:163], a[124:127], v[132:135]
    v_cvt_pk_bf16_f32 v144, v120, v121
    v_cvt_pk_bf16_f32 v145, v122, v123
    v_mfma_f32_16x16x32_bf16 v[136:139], a[160:163], a[128:131], v[136:139]
    v_cvt_pk_bf16_f32 v148, v124, v125
    v_cvt_pk_bf16_f32 v149, v126, v127
    v_mfma_f32_16x16x32_bf16 v[128:131], a[164:167], a[132:135], v[128:131]
    buffer_load_dwordx4 v7, s[12:15], s46 offen offset:2048 lds
    v_mfma_f32_16x16x32_bf16 v[132:135], a[164:167], a[136:139], v[132:135]
    ds_read_b128 a[216:219], v1 offset:20736
    v_mfma_f32_16x16x32_bf16 v[136:139], a[164:167], a[140:143], v[136:139]
    ds_read_b128 a[220:223], v1 offset:20800
    v_mfma_f32_16x16x32_bf16 v[116:119], a[156:159], a[72:75], 0
    ds_read_b128 a[224:227], v1 offset:20864
    v_mfma_f32_16x16x32_bf16 v[120:123], a[156:159], a[76:79], 0
    ds_read_b128 a[240:243], v2 offset:3456
    v_mfma_f32_16x16x32_bf16 v[124:127], a[156:159], a[80:83], 0
    ds_read_b128 a[244:247], v2 offset:3520
    v_mfma_f32_16x16x32_bf16 v[116:119], a[160:163], a[84:87], v[116:119]
    v_cvt_pk_bf16_f32 v142, v128, v129
    v_cvt_pk_bf16_f32 v143, v130, v131
    v_mfma_f32_16x16x32_bf16 v[120:123], a[160:163], a[88:91], v[120:123]
    v_cvt_pk_bf16_f32 v146, v132, v133
    v_cvt_pk_bf16_f32 v147, v134, v135
    s_add_u32 m0, s44, 138656
    s_add_u32 s64, s46, 12288
    s_bfe_u32 s65, s24, 0x4001c
    s_mul_i32 s65, s65, 18432
    v_mfma_f32_16x16x32_bf16 v[124:127], a[160:163], a[92:95], v[124:127]
    v_cvt_pk_bf16_f32 v150, v136, v137
    v_cvt_pk_bf16_f32 v151, v138, v139
    s_sub_u32 s46, s65, 6144
    s_cmp_eq_u32 s30, 0
    s_cselect_b32 s46, s64, s46
    v_mfma_f32_16x16x32_bf16 v[116:119], a[164:167], a[96:99], v[116:119]
    buffer_load_dwordx4 v7, s[12:15], s46 offen offset:0 lds
    v_mfma_f32_16x16x32_bf16 v[120:123], a[164:167], a[100:103], v[120:123]
    ds_read_b128 a[248:251], v2 offset:3584
    s_waitcnt lgkmcnt(7)
    v_mfma_f32_16x16x32_bf16 v[44:47], v[140:143], v[216:219], v[44:47]
    ds_read_b128 a[228:231], v2 offset:6912
    v_mfma_f32_16x16x32_bf16 v[48:51], v[144:147], v[216:219], v[48:51]
    ds_read_b128 a[232:235], v2 offset:6976
    v_mfma_f32_16x16x32_bf16 v[52:55], v[148:151], v[216:219], v[52:55]
    ds_read_b128 a[236:239], v2 offset:7040
    v_mfma_f32_16x16x32_bf16 v[124:127], a[164:167], a[104:107], v[124:127]
    ds_read_b64 v[220:221], v3 offset:5808
    v_mfma_f32_16x16x32_bf16 v[128:131], a[168:171], a[108:111], 0
    ds_read_b64 v[222:223], v3 offset:6336
    v_mfma_f32_16x16x32_bf16 v[132:135], a[168:171], a[112:115], 0
    buffer_load_dwordx4 v7, s[12:15], s46 offen offset:1024 lds
    v_mfma_f32_16x16x32_bf16 v[136:139], a[168:171], a[116:119], 0
    v_mov_b32 v14, 163488
    ds_read_b128 v[228:231], v14
    v_mfma_f32_16x16x32_bf16 v[128:131], a[172:175], a[120:123], v[128:131]
    v_cvt_pk_bf16_f32 v140, v116, v117
    v_cvt_pk_bf16_f32 v141, v118, v119
    ds_read_b64_tr_b16 a[0:1], v4 offset:0
    v_mfma_f32_16x16x32_bf16 v[132:135], a[172:175], a[124:127], v[132:135]
    v_cvt_pk_bf16_f32 v144, v120, v121
    v_cvt_pk_bf16_f32 v145, v122, v123
    v_mfma_f32_16x16x32_bf16 v[136:139], a[172:175], a[128:131], v[136:139]
    v_cvt_pk_bf16_f32 v148, v124, v125
    v_cvt_pk_bf16_f32 v149, v126, v127
    v_mfma_f32_16x16x32_bf16 v[128:131], a[176:179], a[132:135], v[128:131]
    buffer_load_dwordx4 v7, s[12:15], s46 offen offset:2048 lds
    v_mfma_f32_16x16x32_bf16 v[132:135], a[176:179], a[136:139], v[132:135]
    ds_read_b64_tr_b16 a[2:3], v4 offset:768
    v_mfma_f32_16x16x32_bf16 v[136:139], a[176:179], a[140:143], v[136:139]
    ds_read_b64_tr_b16 a[4:5], v4 offset:32
    v_mfma_f32_16x16x32_bf16 v[116:119], a[168:171], a[72:75], 0
    ds_read_b64_tr_b16 a[6:7], v4 offset:800
    v_mfma_f32_16x16x32_bf16 v[120:123], a[168:171], a[76:79], 0
    ds_read_b64_tr_b16 a[8:9], v5 offset:64
    v_mfma_f32_16x16x32_bf16 v[124:127], a[168:171], a[80:83], 0
    ds_read_b64_tr_b16 a[10:11], v5 offset:832
    v_mfma_f32_16x16x32_bf16 v[116:119], a[172:175], a[84:87], v[116:119]
    v_cvt_pk_bf16_f32 v142, v128, v129
    v_cvt_pk_bf16_f32 v143, v130, v131
    v_mfma_f32_16x16x32_bf16 v[120:123], a[172:175], a[88:91], v[120:123]
    v_cvt_pk_bf16_f32 v146, v132, v133
    v_cvt_pk_bf16_f32 v147, v134, v135
    v_mfma_f32_16x16x32_bf16 v[124:127], a[172:175], a[92:95], v[124:127]
    v_cvt_pk_bf16_f32 v150, v136, v137
    v_cvt_pk_bf16_f32 v151, v138, v139
    s_add_u32 m0, s44, 151072
    s_add_u32 s46, s65, 6144
    v_mfma_f32_16x16x32_bf16 v[116:119], a[176:179], a[96:99], v[116:119]
    buffer_load_dwordx4 v7, s[12:15], s46 offen offset:0 lds
    v_mfma_f32_16x16x32_bf16 v[120:123], a[176:179], a[100:103], v[120:123]
    ds_read_b64_tr_b16 a[12:13], v4 offset:6208
    s_waitcnt lgkmcnt(7)
    v_mfma_f32_16x16x32_bf16 v[56:59], v[140:143], v[220:223], v[56:59]
    ds_read_b64_tr_b16 a[14:15], v4 offset:6976
    v_mfma_f32_16x16x32_bf16 v[60:63], v[144:147], v[220:223], v[60:63]
    ds_read_b64_tr_b16 a[16:17], v4 offset:6240
    v_mfma_f32_16x16x32_bf16 v[64:67], v[148:151], v[220:223], v[64:67]
    ds_read_b64_tr_b16 a[18:19], v4 offset:7008
    v_mfma_f32_16x16x32_bf16 v[124:127], a[176:179], a[104:107], v[124:127]
    ds_read_b64 v[216:217], v3 offset:10560
    v_mfma_f32_16x16x32_bf16 v[128:131], a[180:183], a[108:111], 0
    ds_read_b64 v[218:219], v3 offset:11088
    v_mfma_f32_16x16x32_bf16 v[132:135], a[180:183], a[112:115], 0
    buffer_load_dwordx4 v7, s[12:15], s46 offen offset:1024 lds
    v_mfma_f32_16x16x32_bf16 v[136:139], a[180:183], a[116:119], 0
    ds_read_b64_tr_b16 a[20:21], v5 offset:6272
    ds_read_b64_tr_b16 a[22:23], v5 offset:7040
    v_mfma_f32_16x16x32_bf16 v[128:131], a[184:187], a[120:123], v[128:131]
    v_cvt_pk_bf16_f32 v140, v116, v117
    v_cvt_pk_bf16_f32 v141, v118, v119
    ds_read_b64_tr_b16 a[24:25], v4 offset:12416
    v_mfma_f32_16x16x32_bf16 v[132:135], a[184:187], a[124:127], v[132:135]
    v_cvt_pk_bf16_f32 v144, v120, v121
    v_cvt_pk_bf16_f32 v145, v122, v123
    v_mfma_f32_16x16x32_bf16 v[136:139], a[184:187], a[128:131], v[136:139]
    v_cvt_pk_bf16_f32 v148, v124, v125
    v_cvt_pk_bf16_f32 v149, v126, v127
    v_mfma_f32_16x16x32_bf16 v[128:131], a[188:191], a[132:135], v[128:131]
    ds_read_b64_tr_b16 a[26:27], v4 offset:13184
    v_mfma_f32_16x16x32_bf16 v[132:135], a[188:191], a[136:139], v[132:135]
    buffer_load_dwordx4 v7, s[12:15], s46 offen offset:2048 lds
    v_mfma_f32_16x16x32_bf16 v[136:139], a[188:191], a[140:143], v[136:139]
    ds_read_b64_tr_b16 a[28:29], v4 offset:12448
    v_mfma_f32_16x16x32_bf16 v[116:119], a[180:183], a[72:75], 0
    ds_read_b64_tr_b16 a[30:31], v4 offset:13216
    v_mfma_f32_16x16x32_bf16 v[120:123], a[180:183], a[76:79], 0
    ds_read_b64_tr_b16 a[32:33], v5 offset:12480
    v_mfma_f32_16x16x32_bf16 v[124:127], a[180:183], a[80:83], 0
    ds_read_b64_tr_b16 a[34:35], v5 offset:13248
    v_mfma_f32_16x16x32_bf16 v[116:119], a[184:187], a[84:87], v[116:119]
    v_cvt_pk_bf16_f32 v142, v128, v129
    v_cvt_pk_bf16_f32 v143, v130, v131
    v_mfma_f32_16x16x32_bf16 v[120:123], a[184:187], a[88:91], v[120:123]
    v_cvt_pk_bf16_f32 v146, v132, v133
    v_cvt_pk_bf16_f32 v147, v134, v135
    v_mfma_f32_16x16x32_bf16 v[124:127], a[184:187], a[92:95], v[124:127]
    v_cvt_pk_bf16_f32 v150, v136, v137
    v_cvt_pk_bf16_f32 v151, v138, v139
    v_mfma_f32_16x16x32_bf16 v[116:119], a[188:191], a[96:99], v[116:119]
    ds_read_b64_tr_b16 a[36:37], v4 offset:18624
    v_mfma_f32_16x16x32_bf16 v[120:123], a[188:191], a[100:103], v[120:123]
    ds_read_b64_tr_b16 a[38:39], v4 offset:19392
    s_waitcnt lgkmcnt(7)
    v_mfma_f32_16x16x32_bf16 v[68:71], v[140:143], v[216:219], v[68:71]
    ds_read_b64_tr_b16 a[40:41], v4 offset:18656
    v_mfma_f32_16x16x32_bf16 v[72:75], v[144:147], v[216:219], v[72:75]
    ds_read_b64_tr_b16 a[42:43], v4 offset:19424
    v_mfma_f32_16x16x32_bf16 v[76:79], v[148:151], v[216:219], v[76:79]
    ds_read_b64_tr_b16 a[44:45], v5 offset:18688
    v_mfma_f32_16x16x32_bf16 v[124:127], a[188:191], a[104:107], v[124:127]
    ds_read_b64 v[220:221], v3 offset:15312
    v_mfma_f32_16x16x32_bf16 v[128:131], a[192:195], a[108:111], 0
    ds_read_b64 v[222:223], v3 offset:15840
    v_mfma_f32_16x16x32_bf16 v[132:135], a[192:195], a[112:115], 0
    ds_read_b64_tr_b16 a[46:47], v5 offset:19456
    v_mfma_f32_16x16x32_bf16 v[136:139], a[192:195], a[116:119], 0
    ds_read_b64_tr_b16 a[48:49], v4 offset:24832
    v_mfma_f32_16x16x32_bf16 v[128:131], a[196:199], a[120:123], v[128:131]
    v_cvt_pk_bf16_f32 v140, v116, v117
    v_cvt_pk_bf16_f32 v141, v118, v119
    v_mfma_f32_16x16x32_bf16 v[132:135], a[196:199], a[124:127], v[132:135]
    v_cvt_pk_bf16_f32 v144, v120, v121
    v_cvt_pk_bf16_f32 v145, v122, v123
    v_mfma_f32_16x16x32_bf16 v[136:139], a[196:199], a[128:131], v[136:139]
    v_cvt_pk_bf16_f32 v148, v124, v125
    v_cvt_pk_bf16_f32 v149, v126, v127
    v_mfma_f32_16x16x32_bf16 v[128:131], a[200:203], a[132:135], v[128:131]
    ds_read_b64_tr_b16 a[50:51], v4 offset:25600
    v_mfma_f32_16x16x32_bf16 v[132:135], a[200:203], a[136:139], v[132:135]
    ds_read_b64_tr_b16 a[52:53], v4 offset:24864
    v_mfma_f32_16x16x32_bf16 v[136:139], a[200:203], a[140:143], v[136:139]
    ds_read_b64_tr_b16 a[54:55], v4 offset:25632
    v_mfma_f32_16x16x32_bf16 v[116:119], a[192:195], a[72:75], 0
    ds_read_b64_tr_b16 a[56:57], v5 offset:24896
    v_mfma_f32_16x16x32_bf16 v[120:123], a[192:195], a[76:79], 0
    ds_read_b64_tr_b16 a[58:59], v5 offset:25664
    v_mfma_f32_16x16x32_bf16 v[124:127], a[192:195], a[80:83], 0
    v_mfma_f32_16x16x32_bf16 v[116:119], a[196:199], a[84:87], v[116:119]
    v_cvt_pk_bf16_f32 v142, v128, v129
    v_cvt_pk_bf16_f32 v143, v130, v131
    v_mfma_f32_16x16x32_bf16 v[120:123], a[196:199], a[88:91], v[120:123]
    v_cvt_pk_bf16_f32 v146, v132, v133
    v_cvt_pk_bf16_f32 v147, v134, v135
    v_mfma_f32_16x16x32_bf16 v[124:127], a[196:199], a[92:95], v[124:127]
    v_cvt_pk_bf16_f32 v150, v136, v137
    v_cvt_pk_bf16_f32 v151, v138, v139
    v_mfma_f32_16x16x32_bf16 v[116:119], a[200:203], a[96:99], v[116:119]
    ds_read_b64_tr_b16 a[60:61], v4 offset:31040
    v_mfma_f32_16x16x32_bf16 v[120:123], a[200:203], a[100:103], v[120:123]
    ds_read_b64_tr_b16 a[62:63], v4 offset:31808
    s_waitcnt lgkmcnt(7)
    v_mfma_f32_16x16x32_bf16 v[80:83], v[140:143], v[220:223], v[80:83]
    ds_read_b64_tr_b16 a[64:65], v4 offset:31072
    v_mfma_f32_16x16x32_bf16 v[84:87], v[144:147], v[220:223], v[84:87]
    ds_read_b64_tr_b16 a[66:67], v4 offset:31840
    v_mfma_f32_16x16x32_bf16 v[88:91], v[148:151], v[220:223], v[88:91]
    ds_read_b64_tr_b16 a[68:69], v5 offset:31104
    v_mfma_f32_16x16x32_bf16 v[124:127], a[200:203], a[104:107], v[124:127]
    ds_read_b64 v[216:217], v3 offset:20064
    v_mfma_f32_16x16x32_bf16 v[128:131], a[204:207], a[108:111], 0
    ds_read_b64 v[218:219], v3 offset:20592
    v_mfma_f32_16x16x32_bf16 v[132:135], a[204:207], a[112:115], 0
    ds_read_b64_tr_b16 a[70:71], v5 offset:31872
    v_mfma_f32_16x16x32_bf16 v[136:139], a[204:207], a[116:119], 0
    v_add_u32 v4, 37248, v4
    v_mfma_f32_16x16x32_bf16 v[128:131], a[208:211], a[120:123], v[128:131]
    v_cvt_pk_bf16_f32 v140, v116, v117
    v_cvt_pk_bf16_f32 v141, v118, v119
    v_add_u32 v5, 37248, v5
    v_mfma_f32_16x16x32_bf16 v[132:135], a[208:211], a[124:127], v[132:135]
    v_cvt_pk_bf16_f32 v144, v120, v121
    v_cvt_pk_bf16_f32 v145, v122, v123
    v_mfma_f32_16x16x32_bf16 v[136:139], a[208:211], a[128:131], v[136:139]
    v_cvt_pk_bf16_f32 v148, v124, v125
    v_cvt_pk_bf16_f32 v149, v126, v127
    v_mfma_f32_16x16x32_bf16 v[128:131], a[212:215], a[132:135], v[128:131]
    v_mfma_f32_16x16x32_bf16 v[132:135], a[212:215], a[136:139], v[132:135]
    v_mfma_f32_16x16x32_bf16 v[136:139], a[212:215], a[140:143], v[136:139]
    s_waitcnt vmcnt(0)
    s_waitcnt lgkmcnt(0)
    s_barrier
    v_mfma_f32_16x16x32_bf16 v[116:119], a[156:159], a[0:3], 0
    ds_read_b64_tr_b16 a[72:73], v4 offset:0
    v_mfma_f32_16x16x32_bf16 v[120:123], a[156:159], a[4:7], 0
    s_add_u32 m0, s44, 88992
    s_bfe_u32 s46, s25, 0x40000
    s_mul_i32 s46, s46, 18432
    v_mfma_f32_16x16x32_bf16 v[124:127], a[156:159], a[8:11], 0
    buffer_load_dwordx4 v7, s[12:15], s46 offen offset:0 lds
    ds_read_b64_tr_b16 a[74:75], v4 offset:768
    v_mfma_f32_16x16x32_bf16 v[116:119], a[160:163], a[12:15], v[116:119]
    v_cvt_pk_bf16_f32 v142, v128, v129
    v_cvt_pk_bf16_f32 v143, v130, v131
    v_mfma_f32_16x16x32_bf16 v[120:123], a[160:163], a[16:19], v[120:123]
    v_cvt_pk_bf16_f32 v146, v132, v133
    v_cvt_pk_bf16_f32 v147, v134, v135
    v_mfma_f32_16x16x32_bf16 v[124:127], a[160:163], a[20:23], v[124:127]
    v_cvt_pk_bf16_f32 v150, v136, v137
    v_cvt_pk_bf16_f32 v151, v138, v139
    v_mfma_f32_16x16x32_bf16 v[116:119], a[164:167], a[24:27], v[116:119]
    ds_read_b64_tr_b16 a[76:77], v4 offset:32
    v_mfma_f32_16x16x32_bf16 v[120:123], a[164:167], a[28:31], v[120:123]
    buffer_load_dwordx4 v7, s[12:15], s46 offen offset:1024 lds
    v_mfma_f32_16x16x32_bf16 v[92:95], v[140:143], v[216:219], v[92:95]
    ds_read_b64_tr_b16 a[78:79], v4 offset:800
    v_mfma_f32_16x16x32_bf16 v[96:99], v[144:147], v[216:219], v[96:99]
    ds_read_b64_tr_b16 a[80:81], v5 offset:64
    v_mfma_f32_16x16x32_bf16 v[100:103], v[148:151], v[216:219], v[100:103]
    ds_read_b64_tr_b16 a[82:83], v5 offset:832
    ds_read_b64_tr_b16 a[84:85], v4 offset:6208
    v_mfma_f32_16x16x32_bf16 v[124:127], a[164:167], a[32:35], v[124:127]
    ds_read_b64 v[220:221], v3 offset:2112
    v_mfma_f32_16x16x32_bf16 v[128:131], a[156:159], a[36:39], 0
    ds_read_b64 v[222:223], v3 offset:2640
    v_mfma_f32_16x16x32_bf16 v[132:135], a[156:159], a[40:43], 0
    buffer_load_dwordx4 v7, s[12:15], s46 offen offset:2048 lds
    v_mfma_f32_16x16x32_bf16 v[136:139], a[156:159], a[44:47], 0
    ds_read_b64_tr_b16 a[86:87], v4 offset:6976
    ds_read_b64_tr_b16 a[88:89], v4 offset:6240
    v_mfma_f32_16x16x32_bf16 v[128:131], a[160:163], a[48:51], v[128:131]
    v_cvt_pk_bf16_f32 v140, v116, v117
    v_cvt_pk_bf16_f32 v141, v118, v119
    ds_read_b64_tr_b16 a[90:91], v4 offset:7008
    v_mfma_f32_16x16x32_bf16 v[132:135], a[160:163], a[52:55], v[132:135]
    v_cvt_pk_bf16_f32 v144, v120, v121
    v_cvt_pk_bf16_f32 v145, v122, v123
    s_add_u32 m0, s44, 101408
    s_add_u32 s64, s46, 12288
    s_mov_b32 s46, 2130706432
    s_cmp_eq_u32 s30, 0
    v_mfma_f32_16x16x32_bf16 v[136:139], a[160:163], a[56:59], v[136:139]
    v_cvt_pk_bf16_f32 v148, v124, v125
    v_cvt_pk_bf16_f32 v149, v126, v127
    s_cselect_b32 s46, s64, s46
    v_mfma_f32_16x16x32_bf16 v[128:131], a[164:167], a[60:63], v[128:131]
    buffer_load_dwordx4 v7, s[12:15], s46 offen offset:0 lds
    v_mfma_f32_16x16x32_bf16 v[132:135], a[164:167], a[64:67], v[132:135]
    ds_read_b64_tr_b16 a[92:93], v5 offset:6272
    v_mfma_f32_16x16x32_bf16 v[136:139], a[164:167], a[68:71], v[136:139]
    ds_read_b64_tr_b16 a[94:95], v5 offset:7040
    v_mfma_f32_16x16x32_bf16 v[116:119], a[168:171], a[0:3], 0
    ds_read_b64_tr_b16 a[96:97], v4 offset:12416
    v_mfma_f32_16x16x32_bf16 v[120:123], a[168:171], a[4:7], 0
    buffer_load_dwordx4 v7, s[12:15], s46 offen offset:1024 lds
    v_mfma_f32_16x16x32_bf16 v[124:127], a[168:171], a[8:11], 0
    ds_read_b64_tr_b16 a[98:99], v4 offset:13184
    ds_read_b64_tr_b16 a[100:101], v4 offset:12448
    v_mfma_f32_16x16x32_bf16 v[116:119], a[172:175], a[12:15], v[116:119]
    v_cvt_pk_bf16_f32 v142, v128, v129
    v_cvt_pk_bf16_f32 v143, v130, v131
    v_mfma_f32_16x16x32_bf16 v[120:123], a[172:175], a[16:19], v[120:123]
    v_cvt_pk_bf16_f32 v146, v132, v133
    v_cvt_pk_bf16_f32 v147, v134, v135
    v_mfma_f32_16x16x32_bf16 v[124:127], a[172:175], a[20:23], v[124:127]
    v_cvt_pk_bf16_f32 v150, v136, v137
    v_cvt_pk_bf16_f32 v151, v138, v139
    v_mfma_f32_16x16x32_bf16 v[116:119], a[176:179], a[24:27], v[116:119]
    buffer_load_dwordx4 v7, s[12:15], s46 offen offset:2048 lds
    v_mfma_f32_16x16x32_bf16 v[120:123], a[176:179], a[28:31], v[120:123]
    ds_read_b64_tr_b16 a[102:103], v4 offset:13216
    s_waitcnt lgkmcnt(7)
    v_mfma_f32_16x16x32_bf16 v[44:47], v[140:143], v[220:223], v[44:47]
    ds_read_b64_tr_b16 a[104:105], v5 offset:12480
    v_mfma_f32_16x16x32_bf16 v[48:51], v[144:147], v[220:223], v[48:51]
    ds_read_b64_tr_b16 a[106:107], v5 offset:13248
    v_mfma_f32_16x16x32_bf16 v[52:55], v[148:151], v[220:223], v[52:55]
    ds_read_b64_tr_b16 a[108:109], v4 offset:18624
    v_mfma_f32_16x16x32_bf16 v[124:127], a[176:179], a[32:35], v[124:127]
    ds_read_b64 v[216:217], v3 offset:6864
    v_mfma_f32_16x16x32_bf16 v[128:131], a[168:171], a[36:39], 0
    ds_read_b64 v[218:219], v3 offset:7392
    v_mfma_f32_16x16x32_bf16 v[132:135], a[168:171], a[40:43], 0
    ds_read_b64_tr_b16 a[110:111], v4 offset:19392
    v_mfma_f32_16x16x32_bf16 v[136:139], a[168:171], a[44:47], 0
    ds_read_b64_tr_b16 a[112:113], v4 offset:18656
    ds_read_b64_tr_b16 a[114:115], v4 offset:19424
    v_mfma_f32_16x16x32_bf16 v[128:131], a[172:175], a[48:51], v[128:131]
    v_cvt_pk_bf16_f32 v140, v116, v117
    v_cvt_pk_bf16_f32 v141, v118, v119
    v_mfma_f32_16x16x32_bf16 v[132:135], a[172:175], a[52:55], v[132:135]
    v_cvt_pk_bf16_f32 v144, v120, v121
    v_cvt_pk_bf16_f32 v145, v122, v123
    v_mfma_f32_16x16x32_bf16 v[136:139], a[172:175], a[56:59], v[136:139]
    v_cvt_pk_bf16_f32 v148, v124, v125
    v_cvt_pk_bf16_f32 v149, v126, v127
    v_mfma_f32_16x16x32_bf16 v[128:131], a[176:179], a[60:63], v[128:131]
    ds_read_b64_tr_b16 a[116:117], v5 offset:18688
    v_mfma_f32_16x16x32_bf16 v[132:135], a[176:179], a[64:67], v[132:135]
    ds_read_b64_tr_b16 a[118:119], v5 offset:19456
    v_mfma_f32_16x16x32_bf16 v[136:139], a[176:179], a[68:71], v[136:139]
    ds_read_b64_tr_b16 a[120:121], v4 offset:24832
    v_mfma_f32_16x16x32_bf16 v[116:119], a[180:183], a[0:3], 0
    ds_read_b64_tr_b16 a[122:123], v4 offset:25600
    v_mfma_f32_16x16x32_bf16 v[120:123], a[180:183], a[4:7], 0
    ds_read_b64_tr_b16 a[124:125], v4 offset:24864
    v_mfma_f32_16x16x32_bf16 v[124:127], a[180:183], a[8:11], 0
    ds_read_b64_tr_b16 a[126:127], v4 offset:25632
    v_mfma_f32_16x16x32_bf16 v[116:119], a[184:187], a[12:15], v[116:119]
    v_cvt_pk_bf16_f32 v142, v128, v129
    v_cvt_pk_bf16_f32 v143, v130, v131
    v_mfma_f32_16x16x32_bf16 v[120:123], a[184:187], a[16:19], v[120:123]
    v_cvt_pk_bf16_f32 v146, v132, v133
    v_cvt_pk_bf16_f32 v147, v134, v135
    v_mfma_f32_16x16x32_bf16 v[124:127], a[184:187], a[20:23], v[124:127]
    v_cvt_pk_bf16_f32 v150, v136, v137
    v_cvt_pk_bf16_f32 v151, v138, v139
    v_mfma_f32_16x16x32_bf16 v[116:119], a[188:191], a[24:27], v[116:119]
    ds_read_b64_tr_b16 a[128:129], v5 offset:24896
    v_mfma_f32_16x16x32_bf16 v[120:123], a[188:191], a[28:31], v[120:123]
    ds_read_b64_tr_b16 a[130:131], v5 offset:25664
    s_waitcnt lgkmcnt(7)
    v_mfma_f32_16x16x32_bf16 v[56:59], v[140:143], v[216:219], v[56:59]
    ds_read_b64_tr_b16 a[132:133], v4 offset:31040
    v_mfma_f32_16x16x32_bf16 v[60:63], v[144:147], v[216:219], v[60:63]
    ds_read_b64_tr_b16 a[134:135], v4 offset:31808
    v_mfma_f32_16x16x32_bf16 v[64:67], v[148:151], v[216:219], v[64:67]
    v_mfma_f32_16x16x32_bf16 v[124:127], a[188:191], a[32:35], v[124:127]
    ds_read_b64 v[220:221], v3 offset:11616
    v_mfma_f32_16x16x32_bf16 v[128:131], a[180:183], a[36:39], 0
    ds_read_b64 v[222:223], v3 offset:12144
    v_mfma_f32_16x16x32_bf16 v[132:135], a[180:183], a[40:43], 0
    ds_read_b64_tr_b16 a[136:137], v4 offset:31072
    v_mfma_f32_16x16x32_bf16 v[136:139], a[180:183], a[44:47], 0
    ds_read_b64_tr_b16 a[138:139], v4 offset:31840
    ds_read_b64_tr_b16 a[140:141], v5 offset:31104
    v_mfma_f32_16x16x32_bf16 v[128:131], a[184:187], a[48:51], v[128:131]
    v_cvt_pk_bf16_f32 v140, v116, v117
    v_cvt_pk_bf16_f32 v141, v118, v119
    v_mfma_f32_16x16x32_bf16 v[132:135], a[184:187], a[52:55], v[132:135]
    v_cvt_pk_bf16_f32 v144, v120, v121
    v_cvt_pk_bf16_f32 v145, v122, v123
    v_mfma_f32_16x16x32_bf16 v[136:139], a[184:187], a[56:59], v[136:139]
    v_cvt_pk_bf16_f32 v148, v124, v125
    v_cvt_pk_bf16_f32 v149, v126, v127
    v_mfma_f32_16x16x32_bf16 v[128:131], a[188:191], a[60:63], v[128:131]
    ds_read_b64_tr_b16 a[142:143], v5 offset:31872
    v_mfma_f32_16x16x32_bf16 v[132:135], a[188:191], a[64:67], v[132:135]
    v_add_u32 v4, -37248, v4
    v_add_u32 v5, -37248, v5
    v_mfma_f32_16x16x32_bf16 v[136:139], a[188:191], a[68:71], v[136:139]
    v_mfma_f32_16x16x32_bf16 v[116:119], a[192:195], a[0:3], 0
    s_waitcnt vmcnt(0)
    s_barrier
    v_mfma_f32_16x16x32_bf16 v[120:123], a[192:195], a[4:7], 0
    ds_read_b64_tr_b16 v[180:181], v4 offset:0
    v_mfma_f32_16x16x32_bf16 v[124:127], a[192:195], a[8:11], 0
    ds_read_b64_tr_b16 v[182:183], v4 offset:768
    v_mfma_f32_16x16x32_bf16 v[116:119], a[196:199], a[12:15], v[116:119]
    v_cvt_pk_bf16_f32 v142, v128, v129
    v_cvt_pk_bf16_f32 v143, v130, v131
    ds_read_b64_tr_b16 v[184:185], v4 offset:32
    v_mfma_f32_16x16x32_bf16 v[120:123], a[196:199], a[16:19], v[120:123]
    v_cvt_pk_bf16_f32 v146, v132, v133
    v_cvt_pk_bf16_f32 v147, v134, v135
    v_mfma_f32_16x16x32_bf16 v[124:127], a[196:199], a[20:23], v[124:127]
    v_cvt_pk_bf16_f32 v150, v136, v137
    v_cvt_pk_bf16_f32 v151, v138, v139
    v_mfma_f32_16x16x32_bf16 v[116:119], a[200:203], a[24:27], v[116:119]
    ds_read_b64_tr_b16 v[186:187], v4 offset:800
    v_mfma_f32_16x16x32_bf16 v[120:123], a[200:203], a[28:31], v[120:123]
    ds_read_b64_tr_b16 v[188:189], v5 offset:64
    s_waitcnt lgkmcnt(7)
    v_mfma_f32_16x16x32_bf16 v[68:71], v[140:143], v[220:223], v[68:71]
    ds_read_b64_tr_b16 v[190:191], v5 offset:832
    v_mfma_f32_16x16x32_bf16 v[72:75], v[144:147], v[220:223], v[72:75]
    ds_read_b64_tr_b16 v[192:193], v4 offset:6208
    v_mfma_f32_16x16x32_bf16 v[76:79], v[148:151], v[220:223], v[76:79]
    ds_read_b64_tr_b16 v[194:195], v4 offset:6976
    ds_read_b64_tr_b16 v[196:197], v4 offset:6240
    v_mfma_f32_16x16x32_bf16 v[124:127], a[200:203], a[32:35], v[124:127]
    ds_read_b64 v[216:217], v3 offset:16368
    v_mfma_f32_16x16x32_bf16 v[128:131], a[192:195], a[36:39], 0
    ds_read_b64 v[218:219], v3 offset:16896
    v_mfma_f32_16x16x32_bf16 v[132:135], a[192:195], a[40:43], 0
    ds_read_b64_tr_b16 v[198:199], v4 offset:7008
    v_mfma_f32_16x16x32_bf16 v[136:139], a[192:195], a[44:47], 0
    ds_read_b64_tr_b16 v[200:201], v5 offset:6272
    ds_read_b64_tr_b16 v[202:203], v5 offset:7040
    v_mfma_f32_16x16x32_bf16 v[128:131], a[196:199], a[48:51], v[128:131]
    v_cvt_pk_bf16_f32 v140, v116, v117
    v_cvt_pk_bf16_f32 v141, v118, v119
    ds_read_b64_tr_b16 v[204:205], v4 offset:12416
    v_mfma_f32_16x16x32_bf16 v[132:135], a[196:199], a[52:55], v[132:135]
    v_cvt_pk_bf16_f32 v144, v120, v121
    v_cvt_pk_bf16_f32 v145, v122, v123
    v_mfma_f32_16x16x32_bf16 v[136:139], a[196:199], a[56:59], v[136:139]
    v_cvt_pk_bf16_f32 v148, v124, v125
    v_cvt_pk_bf16_f32 v149, v126, v127
    v_mfma_f32_16x16x32_bf16 v[128:131], a[200:203], a[60:63], v[128:131]
    ds_read_b64_tr_b16 v[206:207], v4 offset:13184
    v_mfma_f32_16x16x32_bf16 v[132:135], a[200:203], a[64:67], v[132:135]
    ds_read_b64_tr_b16 v[208:209], v4 offset:12448
    v_mfma_f32_16x16x32_bf16 v[136:139], a[200:203], a[68:71], v[136:139]
    ds_read_b64_tr_b16 v[210:211], v4 offset:13216
    v_mfma_f32_16x16x32_bf16 v[116:119], a[204:207], a[0:3], 0
    ds_read_b64_tr_b16 v[212:213], v5 offset:12480
    v_mfma_f32_16x16x32_bf16 v[120:123], a[204:207], a[4:7], 0
    ds_read_b64_tr_b16 v[214:215], v5 offset:13248
    v_mfma_f32_16x16x32_bf16 v[124:127], a[204:207], a[8:11], 0
    s_mul_i32 s47, s30, 8064
    s_lshl_b32 s48, s29, 3
    v_mfma_f32_16x16x32_bf16 v[116:119], a[208:211], a[12:15], v[116:119]
    v_cvt_pk_bf16_f32 v142, v128, v129
    v_cvt_pk_bf16_f32 v143, v130, v131
    v_bfe_u32 v38, v6, 4, 4
    v_mfma_f32_16x16x32_bf16 v[120:123], a[208:211], a[16:19], v[120:123]
    v_cvt_pk_bf16_f32 v146, v132, v133
    v_cvt_pk_bf16_f32 v147, v134, v135
    v_mfma_f32_16x16x32_bf16 v[124:127], a[208:211], a[20:23], v[124:127]
    v_cvt_pk_bf16_f32 v150, v136, v137
    v_cvt_pk_bf16_f32 v151, v138, v139
    v_mfma_f32_16x16x32_bf16 v[116:119], a[212:215], a[24:27], v[116:119]
    s_add_u32 s47, s47, 0
    v_lshrrev_b32 v39, 8, v6
    v_mfma_f32_16x16x32_bf16 v[120:123], a[212:215], a[28:31], v[120:123]
    v_mul_u32_u24 v17, 72, v38
    v_mul_u32_u24 v16, s2, v38
    s_waitcnt lgkmcnt(7)
    v_mfma_f32_16x16x32_bf16 v[80:83], v[140:143], v[216:219], v[80:83]
    s_lshl2_add_u32 s49, s48, s47
    v_mfma_f32_16x16x32_bf16 v[84:87], v[144:147], v[216:219], v[84:87]
    v_mfma_f32_16x16x32_bf16 v[88:91], v[148:151], v[216:219], v[88:91]
    v_lshl_add_u32 v17, v39, 3, v17
    v_mfma_f32_16x16x32_bf16 v[124:127], a[212:215], a[32:35], v[124:127]
    ds_read_b64 v[220:221], v3 offset:21120
    v_mfma_f32_16x16x32_bf16 v[128:131], a[204:207], a[36:39], 0
    ds_read_b64 v[222:223], v3 offset:21648
    v_mfma_f32_16x16x32_bf16 v[132:135], a[204:207], a[40:43], 0
    v_and_b32 v38, 1, v39
    v_lshrrev_b32 v39, 1, v39
    v_mfma_f32_16x16x32_bf16 v[136:139], a[204:207], a[44:47], 0
    v_add_u32 v17, s49, v17
    v_lshl_add_u32 v38, v38, 1, v39
    v_mfma_f32_16x16x32_bf16 v[128:131], a[208:211], a[48:51], v[128:131]
    v_cvt_pk_bf16_f32 v140, v116, v117
    v_cvt_pk_bf16_f32 v141, v118, v119
    v_mfma_f32_16x16x32_bf16 v[132:135], a[208:211], a[52:55], v[132:135]
    v_cvt_pk_bf16_f32 v144, v120, v121
    v_cvt_pk_bf16_f32 v145, v122, v123
    v_mfma_f32_16x16x32_bf16 v[136:139], a[208:211], a[56:59], v[136:139]
    v_cvt_pk_bf16_f32 v148, v124, v125
    v_cvt_pk_bf16_f32 v149, v126, v127
    v_mfma_f32_16x16x32_bf16 v[128:131], a[212:215], a[60:63], v[128:131]
    v_lshrrev_b32 v39, 7, v6
    v_add_u32 v38, s48, v38
    v_mfma_f32_16x16x32_bf16 v[132:135], a[212:215], a[64:67], v[132:135]
    v_add_u32 v39, s48, v39
    v_lshl_add_u32 v16, v38, 4, v16
    v_mfma_f32_16x16x32_bf16 v[136:139], a[212:215], a[68:71], v[136:139]
    v_bfe_u32 v38, v6, 1, 6
    v_mfma_f32_16x16x32_bf16 v[116:119], a[240:243], a[0:3], 0
    v_mul_u32_u24 v18, 72, v39
    s_branch L_S1_s1
L_S1_t1:
    s_setpc_b64 s[78:79]
L_S1_s1:
    v_mfma_f32_16x16x32_bf16 v[120:123], a[240:243], a[4:7], 0
    v_mul_u32_u24 v19, s2, v39
    v_mfma_f32_16x16x32_bf16 v[124:127], a[240:243], a[8:11], 0
    v_add3_u32 v18, v18, s47, v38
    v_mfma_f32_16x16x32_bf16 v[116:119], a[244:247], a[12:15], v[116:119]
    v_cvt_pk_bf16_f32 v142, v128, v129
    v_cvt_pk_bf16_f32 v143, v130, v131
    v_mfma_f32_16x16x32_bf16 v[120:123], a[244:247], a[16:19], v[120:123]
    v_cvt_pk_bf16_f32 v146, v132, v133
    v_cvt_pk_bf16_f32 v147, v134, v135
    v_mfma_f32_16x16x32_bf16 v[124:127], a[244:247], a[20:23], v[124:127]
    v_cvt_pk_bf16_f32 v150, v136, v137
    v_cvt_pk_bf16_f32 v151, v138, v139
    v_mfma_f32_16x16x32_bf16 v[116:119], a[248:251], a[24:27], v[116:119]
    v_add3_u32 v19, v19, 64, v38
    s_mov_b32 s46, s31
    v_mfma_f32_16x16x32_bf16 v[120:123], a[248:251], a[28:31], v[120:123]
    v_or3_b32 v228, v228, v229, v230
    v_or_b32 v228, v228, v231
    s_waitcnt lgkmcnt(0)
    v_mfma_f32_16x16x32_bf16 v[92:95], v[140:143], v[220:223], v[92:95]
    s_nop 0
    v_mfma_f32_16x16x32_bf16 v[96:99], v[144:147], v[220:223], v[96:99]
    v_readfirstlane_b32 s54, v228
    v_mfma_f32_16x16x32_bf16 v[100:103], v[148:151], v[220:223], v[100:103]
    v_lshrrev_b32 v12, 8, v6
    v_mfma_f32_16x16x32_bf16 v[124:127], a[248:251], a[32:35], v[124:127]
    ds_read_b32 v216, v9 offset:2112
    v_mfma_f32_16x16x32_bf16 v[128:131], a[240:243], a[36:39], 0
    ds_read_b32 v217, v10 offset:2112
    v_cmp_eq_u32 s[60:61], 0, v12
    v_mfma_f32_16x16x32_bf16 v[132:135], a[240:243], a[40:43], 0
    ds_read_b32 v218, v9 offset:2640
    v_cmp_eq_u32 s[62:63], 1, v12
    v_mfma_f32_16x16x32_bf16 v[136:139], a[240:243], a[44:47], 0
    ds_read_b32 v219, v10 offset:2640
    v_cmp_eq_u32 s[64:65], 2, v12
    v_mfma_f32_16x16x32_bf16 v[128:131], a[244:247], a[48:51], v[128:131]
    v_cvt_pk_bf16_f32 v140, v116, v117
    v_cvt_pk_bf16_f32 v141, v118, v119
    v_cndmask_b32 v172, 0, v167, s[60:61]
    v_mfma_f32_16x16x32_bf16 v[132:135], a[244:247], a[52:55], v[132:135]
    v_cvt_pk_bf16_f32 v144, v120, v121
    v_cvt_pk_bf16_f32 v145, v122, v123
    v_mfma_f32_16x16x32_bf16 v[136:139], a[244:247], a[56:59], v[136:139]
    v_cvt_pk_bf16_f32 v148, v124, v125
    v_cvt_pk_bf16_f32 v149, v126, v127
    v_mfma_f32_16x16x32_bf16 v[128:131], a[248:251], a[60:63], v[128:131]
    v_cndmask_b32 v173, 0, v167, s[62:63]
    v_cndmask_b32 v174, 0, v167, s[64:65]
    v_mfma_f32_16x16x32_bf16 v[132:135], a[248:251], a[64:67], v[132:135]
    v_mfma_f32_16x16x32_bf16 v[136:139], a[248:251], a[68:71], v[136:139]
    v_mfma_f32_16x16x32_bf16 v[116:119], a[228:231], a[72:75], 0
    s_mul_i32 s47, s30, 6656
    v_mfma_f32_16x16x32_bf16 v[120:123], a[228:231], a[76:79], 0
    v_lshrrev_b32 v26, 4, v6
    v_mfma_f32_16x16x32_bf16 v[124:127], a[228:231], a[80:83], 0
    v_mfma_f32_16x16x32_bf16 v[116:119], a[232:235], a[84:87], v[116:119]
    v_cvt_pk_bf16_f32 v142, v128, v129
    v_cvt_pk_bf16_f32 v143, v130, v131
    v_mfma_f32_16x16x32_bf16 v[120:123], a[232:235], a[88:91], v[120:123]
    v_cvt_pk_bf16_f32 v146, v132, v133
    v_cvt_pk_bf16_f32 v147, v134, v135
    v_mfma_f32_16x16x32_bf16 v[124:127], a[232:235], a[92:95], v[124:127]
    v_cvt_pk_bf16_f32 v150, v136, v137
    v_cvt_pk_bf16_f32 v151, v138, v139
    v_mfma_f32_16x16x32_bf16 v[116:119], a[236:239], a[96:99], v[116:119]
    s_add_u32 s47, s47, 16128
    v_mul_u32_u24 v27, 43, v26
    v_mfma_f32_16x16x32_bf16 v[120:123], a[236:239], a[100:103], v[120:123]
    v_add_u32 v28, 128, v26
    s_waitcnt lgkmcnt(0)
    v_mfma_f32_16x16x32_bf16 v[104:107], v[216:219], v[140:143], v[104:107]
    s_lshl_b32 s48, s29, 3
    v_mfma_f32_16x16x32_bf16 v[108:111], v[216:219], v[144:147], v[108:111]
    v_mfma_f32_16x16x32_bf16 v[112:115], v[216:219], v[148:151], v[112:115]
    v_lshrrev_b32 v27, 9, v27
    v_mfma_f32_16x16x32_bf16 v[124:127], a[236:239], a[104:107], v[124:127]
    ds_read_b32 v220, v9 offset:3168
    v_mul_u32_u24 v29, 2731, v28
    v_mfma_f32_16x16x32_bf16 v[128:131], a[228:231], a[108:111], 0
    ds_read_b32 v221, v10 offset:3168
    v_mfma_f32_16x16x32_bf16 v[132:135], a[228:231], a[112:115], 0
    ds_read_b32 v222, v9 offset:3696
    v_mad_i32_i24 v26, v27, -12, v26
    v_mfma_f32_16x16x32_bf16 v[136:139], a[228:231], a[116:119], 0
    ds_read_b32 v223, v10 offset:3696
    v_mfma_f32_16x16x32_bf16 v[128:131], a[232:235], a[120:123], v[128:131]
    v_cvt_pk_bf16_f32 v140, v116, v117
    v_cvt_pk_bf16_f32 v141, v118, v119
    v_mfma_f32_16x16x32_bf16 v[132:135], a[232:235], a[124:127], v[132:135]
    v_cvt_pk_bf16_f32 v144, v120, v121
    v_cvt_pk_bf16_f32 v145, v122, v123
    v_mfma_f32_16x16x32_bf16 v[136:139], a[232:235], a[128:131], v[136:139]
    v_cvt_pk_bf16_f32 v148, v124, v125
    v_cvt_pk_bf16_f32 v149, v126, v127
    v_mfma_f32_16x16x32_bf16 v[128:131], a[236:239], a[132:135], v[128:131]
    v_lshrrev_b32 v29, 16, v29
    v_add_u32 v27, s48, v27
    v_mfma_f32_16x16x32_bf16 v[132:135], a[236:239], a[136:139], v[132:135]
    v_mul_u32_u24 v30, 24, v29
    v_mfma_f32_16x16x32_bf16 v[136:139], a[236:239], a[140:143], v[136:139]
    v_mul_u32_u24 v22, 208, v27
    v_mfma_f32_16x16x32_bf16 v[116:119], a[168:171], a[72:75], 0
    v_sub_u32 v28, v28, v30
    v_mfma_f32_16x16x32_bf16 v[120:123], a[168:171], a[76:79], 0
    v_mfma_f32_16x16x32_bf16 v[124:127], a[168:171], a[80:83], 0
    v_add_u32 v29, s48, v29
    v_mfma_f32_16x16x32_bf16 v[116:119], a[172:175], a[84:87], v[116:119]
    v_cvt_pk_bf16_f32 v142, v128, v129
    v_cvt_pk_bf16_f32 v143, v130, v131
    v_mfma_f32_16x16x32_bf16 v[120:123], a[172:175], a[88:91], v[120:123]
    v_cvt_pk_bf16_f32 v146, v132, v133
    v_cvt_pk_bf16_f32 v147, v134, v135
    v_mfma_f32_16x16x32_bf16 v[124:127], a[172:175], a[92:95], v[124:127]
    v_cvt_pk_bf16_f32 v150, v136, v137
    v_cvt_pk_bf16_f32 v151, v138, v139
    v_mfma_f32_16x16x32_bf16 v[116:119], a[176:179], a[96:99], v[116:119]
    v_mul_u32_u24 v24, s2, v27
    v_lshlrev_b32 v26, 4, v26
    v_mfma_f32_16x16x32_bf16 v[120:123], a[176:179], a[100:103], v[120:123]
    v_mul_u32_u24 v23, 208, v29
    s_waitcnt lgkmcnt(0)
    v_mfma_f32_16x16x32_bf16 v[104:107], v[220:223], v[140:143], v[104:107]
    v_mfma_f32_16x16x32_bf16 v[108:111], v[220:223], v[144:147], v[108:111]
    v_mul_u32_u24 v25, s2, v29
    v_mfma_f32_16x16x32_bf16 v[112:115], v[220:223], v[148:151], v[112:115]
    v_mfma_f32_16x16x32_bf16 v[124:127], a[176:179], a[104:107], v[124:127]
    ds_read_b64 v[216:217], v3 offset:3168
    v_mfma_f32_16x16x32_bf16 v[128:131], a[168:171], a[108:111], 0
    ds_read_b64 v[218:219], v3 offset:3696
    v_mfma_f32_16x16x32_bf16 v[132:135], a[168:171], a[112:115], 0
    v_lshlrev_b32 v28, 3, v28
    v_add3_u32 v22, v22, s47, v26
    v_mfma_f32_16x16x32_bf16 v[136:139], a[168:171], a[116:119], 0
    v_add_u32 v24, v24, v26
    v_mfma_f32_16x16x32_bf16 v[128:131], a[172:175], a[120:123], v[128:131]
    v_cvt_pk_bf16_f32 v140, v116, v117
    v_cvt_pk_bf16_f32 v141, v118, v119
    v_mfma_f32_16x16x32_bf16 v[132:135], a[172:175], a[124:127], v[132:135]
    v_cvt_pk_bf16_f32 v144, v120, v121
    v_cvt_pk_bf16_f32 v145, v122, v123
    v_add3_u32 v23, v23, s47, v28
    v_mfma_f32_16x16x32_bf16 v[136:139], a[172:175], a[128:131], v[136:139]
    v_cvt_pk_bf16_f32 v148, v124, v125
    v_cvt_pk_bf16_f32 v149, v126, v127
    v_mfma_f32_16x16x32_bf16 v[128:131], a[176:179], a[132:135], v[128:131]
    v_cvt_pk_bf16_f32 v154, v104, v105
    v_cvt_pk_bf16_f32 v155, v106, v107
    v_mfma_f32_16x16x32_bf16 v[132:135], a[176:179], a[136:139], v[132:135]
    v_cvt_pk_bf16_f32 v158, v108, v109
    v_cvt_pk_bf16_f32 v159, v110, v111
    v_mfma_f32_16x16x32_bf16 v[136:139], a[176:179], a[140:143], v[136:139]
    v_cvt_pk_bf16_f32 v162, v112, v113
    v_cvt_pk_bf16_f32 v163, v114, v115
    v_mfma_f32_16x16x32_bf16 v[116:119], a[168:171], v[180:183], 0
    ds_read_b64 v[224:225], v3 offset:4224
    v_add_u32 v25, v25, v28
    v_mfma_f32_16x16x32_bf16 v[120:123], a[168:171], v[184:187], 0
    v_mov_b32 v226, v172
    v_mov_b32 v227, 0
    v_bfe_u32 v26, v6, 4, 4
    v_mfma_f32_16x16x32_bf16 v[124:127], a[168:171], v[188:191], 0
    v_lshrrev_b32 v27, 8, v6
    v_mul_u32_u24 v26, 208, v26
    v_mfma_f32_16x16x32_bf16 v[116:119], a[172:175], v[192:195], v[116:119]
    v_cvt_pk_bf16_f32 v142, v128, v129
    v_cvt_pk_bf16_f32 v143, v130, v131
    v_mfma_f32_16x16x32_bf16 v[120:123], a[172:175], v[196:199], v[120:123]
    v_cvt_pk_bf16_f32 v146, v132, v133
    v_cvt_pk_bf16_f32 v147, v134, v135
    v_mfma_f32_16x16x32_bf16 v[124:127], a[172:175], v[200:203], v[124:127]
    v_cvt_pk_bf16_f32 v150, v136, v137
    v_cvt_pk_bf16_f32 v151, v138, v139
    v_mfma_f32_16x16x32_bf16 v[116:119], a[176:179], v[204:207], v[116:119]
    s_lshl4_add_u32 s49, s48, s47
    v_lshl_add_u32 v26, v27, 3, v26
    v_mfma_f32_16x16x32_bf16 v[120:123], a[176:179], v[208:211], v[120:123]
    s_lshl2_add_u32 s48, s48, s47
    s_waitcnt lgkmcnt(1)
    v_mfma_f32_16x16x32_bf16 v[44:47], v[140:143], v[216:219], v[44:47]
    v_add_u32 v20, s49, v26
    v_mfma_f32_16x16x32_bf16 v[48:51], v[144:147], v[216:219], v[48:51]
    v_mfma_f32_16x16x32_bf16 v[52:55], v[148:151], v[216:219], v[52:55]
    v_add_u32 v21, s48, v26
    v_mfma_f32_16x16x32_bf16 v[124:127], a[176:179], v[212:215], v[124:127]
    v_mfma_f32_16x16x32_bf16 v[128:131], a[180:183], a[72:75], 0
    v_mfma_f32_16x16x32_bf16 v[132:135], a[180:183], a[76:79], 0
    v_mfma_f32_16x16x32_bf16 v[136:139], a[180:183], a[80:83], 0
    v_mfma_f32_16x16x32_bf16 v[128:131], a[184:187], a[84:87], v[128:131]
    v_cvt_pk_bf16_f32 v152, v116, v117
    v_cvt_pk_bf16_f32 v153, v118, v119
    v_mfma_f32_16x16x32_bf16 v[132:135], a[184:187], a[88:91], v[132:135]
    v_cvt_pk_bf16_f32 v156, v120, v121
    v_cvt_pk_bf16_f32 v157, v122, v123
    v_mfma_f32_16x16x32_bf16 v[136:139], a[184:187], a[92:95], v[136:139]
    v_cvt_pk_bf16_f32 v160, v124, v125
    v_cvt_pk_bf16_f32 v161, v126, v127
    v_mfma_f32_16x16x32_bf16 v[128:131], a[188:191], a[96:99], v[128:131]
    v_mfma_f32_16x16x32_bf16 v[132:135], a[188:191], a[100:103], v[132:135]
    s_waitcnt lgkmcnt(0)
    v_mfma_f32_16x16x32_bf16 v[44:47], v[152:155], v[224:227], v[44:47]
    v_mfma_f32_16x16x32_bf16 v[48:51], v[156:159], v[224:227], v[48:51]
    v_mfma_f32_16x16x32_bf16 v[52:55], v[160:163], v[224:227], v[52:55]
    v_mfma_f32_16x16x32_bf16 v[136:139], a[188:191], a[104:107], v[136:139]
    ds_read_b64 v[220:221], v3 offset:7920
    v_mfma_f32_16x16x32_bf16 v[116:119], a[180:183], a[108:111], 0
    ds_read_b64 v[222:223], v3 offset:8448
    v_mfma_f32_16x16x32_bf16 v[120:123], a[180:183], a[112:115], 0
    v_mfma_f32_16x16x32_bf16 v[124:127], a[180:183], a[116:119], 0
    v_mfma_f32_16x16x32_bf16 v[116:119], a[184:187], a[120:123], v[116:119]
    v_cvt_pk_bf16_f32 v140, v128, v129
    v_cvt_pk_bf16_f32 v141, v130, v131
    v_mfma_f32_16x16x32_bf16 v[120:123], a[184:187], a[124:127], v[120:123]
    v_cvt_pk_bf16_f32 v144, v132, v133
    v_cvt_pk_bf16_f32 v145, v134, v135
    v_mfma_f32_16x16x32_bf16 v[124:127], a[184:187], a[128:131], v[124:127]
    v_cvt_pk_bf16_f32 v148, v136, v137
    v_cvt_pk_bf16_f32 v149, v138, v139
    v_mfma_f32_16x16x32_bf16 v[116:119], a[188:191], a[132:135], v[116:119]
    v_cvt_pk_bf16_f32 v32, v44, v45
    v_cvt_pk_bf16_f32 v33, v46, v47
    v_mfma_f32_16x16x32_bf16 v[120:123], a[188:191], a[136:139], v[120:123]
    v_cvt_pk_bf16_f32 v34, v48, v49
    v_cvt_pk_bf16_f32 v35, v50, v51
    v_mfma_f32_16x16x32_bf16 v[124:127], a[188:191], a[140:143], v[124:127]
    v_cvt_pk_bf16_f32 v36, v52, v53
    v_cvt_pk_bf16_f32 v37, v54, v55
    v_mfma_f32_16x16x32_bf16 v[128:131], a[180:183], v[180:183], 0
    ds_read_b64 v[224:225], v3 offset:8976
    v_mfma_f32_16x16x32_bf16 v[132:135], a[180:183], v[184:187], 0
    v_mov_b32 v227, v172
    v_mov_b32 v226, 0
    v_mfma_f32_16x16x32_bf16 v[136:139], a[180:183], v[188:191], 0
    v_permlane16_swap_b32 v32, v34
    v_permlane16_swap_b32 v33, v35
    v_mfma_f32_16x16x32_bf16 v[128:131], a[184:187], v[192:195], v[128:131]
    v_cvt_pk_bf16_f32 v142, v116, v117
    v_cvt_pk_bf16_f32 v143, v118, v119
    v_mfma_f32_16x16x32_bf16 v[132:135], a[184:187], v[196:199], v[132:135]
    v_cvt_pk_bf16_f32 v146, v120, v121
    v_cvt_pk_bf16_f32 v147, v122, v123
    v_mfma_f32_16x16x32_bf16 v[136:139], a[184:187], v[200:203], v[136:139]
    v_cvt_pk_bf16_f32 v150, v124, v125
    v_cvt_pk_bf16_f32 v151, v126, v127
    v_mfma_f32_16x16x32_bf16 v[128:131], a[188:191], v[204:207], v[128:131]
    ds_write_b64 v17, v[36:37] offset:0
    v_mfma_f32_16x16x32_bf16 v[132:135], a[188:191], v[208:211], v[132:135]
    buffer_store_dwordx4 v[32:35], v16, s[16:19], s31 offen sc1
    s_add_u32 s31, s31, s55
    s_waitcnt lgkmcnt(2)
    v_mfma_f32_16x16x32_bf16 v[56:59], v[140:143], v[220:223], v[56:59]
    v_mfma_f32_16x16x32_bf16 v[60:63], v[144:147], v[220:223], v[60:63]
    v_mfma_f32_16x16x32_bf16 v[64:67], v[148:151], v[220:223], v[64:67]
    v_mfma_f32_16x16x32_bf16 v[136:139], a[188:191], v[212:215], v[136:139]
    v_mfma_f32_16x16x32_bf16 v[116:119], a[192:195], a[72:75], 0
    v_mfma_f32_16x16x32_bf16 v[120:123], a[192:195], a[76:79], 0
    v_mfma_f32_16x16x32_bf16 v[124:127], a[192:195], a[80:83], 0
    v_mfma_f32_16x16x32_bf16 v[116:119], a[196:199], a[84:87], v[116:119]
    v_cvt_pk_bf16_f32 v152, v128, v129
    v_cvt_pk_bf16_f32 v153, v130, v131
    v_mfma_f32_16x16x32_bf16 v[120:123], a[196:199], a[88:91], v[120:123]
    v_cvt_pk_bf16_f32 v156, v132, v133
    v_cvt_pk_bf16_f32 v157, v134, v135
    v_mfma_f32_16x16x32_bf16 v[124:127], a[196:199], a[92:95], v[124:127]
    v_cvt_pk_bf16_f32 v160, v136, v137
    v_cvt_pk_bf16_f32 v161, v138, v139
    v_mfma_f32_16x16x32_bf16 v[116:119], a[200:203], a[96:99], v[116:119]
    v_mfma_f32_16x16x32_bf16 v[120:123], a[200:203], a[100:103], v[120:123]
    s_waitcnt lgkmcnt(1)
    v_mfma_f32_16x16x32_bf16 v[56:59], v[152:155], v[224:227], v[56:59]
    v_mfma_f32_16x16x32_bf16 v[60:63], v[156:159], v[224:227], v[60:63]
    v_mfma_f32_16x16x32_bf16 v[64:67], v[160:163], v[224:227], v[64:67]
    v_mfma_f32_16x16x32_bf16 v[124:127], a[200:203], a[104:107], v[124:127]
    ds_read_b64 v[216:217], v3 offset:12672
    v_mfma_f32_16x16x32_bf16 v[128:131], a[192:195], a[108:111], 0
    ds_read_b64 v[218:219], v3 offset:13200
    v_mfma_f32_16x16x32_bf16 v[132:135], a[192:195], a[112:115], 0
    v_mfma_f32_16x16x32_bf16 v[136:139], a[192:195], a[116:119], 0
    v_mfma_f32_16x16x32_bf16 v[128:131], a[196:199], a[120:123], v[128:131]
    v_cvt_pk_bf16_f32 v140, v116, v117
    v_cvt_pk_bf16_f32 v141, v118, v119
    v_mfma_f32_16x16x32_bf16 v[132:135], a[196:199], a[124:127], v[132:135]
    v_cvt_pk_bf16_f32 v144, v120, v121
    v_cvt_pk_bf16_f32 v145, v122, v123
    v_mfma_f32_16x16x32_bf16 v[136:139], a[196:199], a[128:131], v[136:139]
    v_cvt_pk_bf16_f32 v148, v124, v125
    v_cvt_pk_bf16_f32 v149, v126, v127
    v_mfma_f32_16x16x32_bf16 v[128:131], a[200:203], a[132:135], v[128:131]
    v_cvt_pk_bf16_f32 v32, v56, v57
    v_cvt_pk_bf16_f32 v33, v58, v59
    v_mfma_f32_16x16x32_bf16 v[132:135], a[200:203], a[136:139], v[132:135]
    v_cvt_pk_bf16_f32 v34, v60, v61
    v_cvt_pk_bf16_f32 v35, v62, v63
    v_mfma_f32_16x16x32_bf16 v[136:139], a[200:203], a[140:143], v[136:139]
    v_cvt_pk_bf16_f32 v36, v64, v65
    v_cvt_pk_bf16_f32 v37, v66, v67
    v_mfma_f32_16x16x32_bf16 v[116:119], a[192:195], v[180:183], 0
    ds_read_b64 v[224:225], v3 offset:13728
    v_mfma_f32_16x16x32_bf16 v[120:123], a[192:195], v[184:187], 0
    v_mov_b32 v226, v173
    v_mov_b32 v227, 0
    v_mfma_f32_16x16x32_bf16 v[124:127], a[192:195], v[188:191], 0
    v_permlane16_swap_b32 v32, v34
    v_permlane16_swap_b32 v33, v35
    v_mfma_f32_16x16x32_bf16 v[116:119], a[196:199], v[192:195], v[116:119]
    v_cvt_pk_bf16_f32 v142, v128, v129
    v_cvt_pk_bf16_f32 v143, v130, v131
    v_mfma_f32_16x16x32_bf16 v[120:123], a[196:199], v[196:199], v[120:123]
    v_cvt_pk_bf16_f32 v146, v132, v133
    v_cvt_pk_bf16_f32 v147, v134, v135
    v_mfma_f32_16x16x32_bf16 v[124:127], a[196:199], v[200:203], v[124:127]
    v_cvt_pk_bf16_f32 v150, v136, v137
    v_cvt_pk_bf16_f32 v151, v138, v139
    v_mfma_f32_16x16x32_bf16 v[116:119], a[200:203], v[204:207], v[116:119]
    ds_write_b64 v17, v[36:37] offset:1152
    v_mfma_f32_16x16x32_bf16 v[120:123], a[200:203], v[208:211], v[120:123]
    buffer_store_dwordx4 v[32:35], v16, s[16:19], s31 offen sc1
    s_add_u32 s31, s31, s55
    s_waitcnt lgkmcnt(2)
    v_mfma_f32_16x16x32_bf16 v[68:71], v[140:143], v[216:219], v[68:71]
    v_mfma_f32_16x16x32_bf16 v[72:75], v[144:147], v[216:219], v[72:75]
    v_mfma_f32_16x16x32_bf16 v[76:79], v[148:151], v[216:219], v[76:79]
    v_mfma_f32_16x16x32_bf16 v[124:127], a[200:203], v[212:215], v[124:127]
    v_mfma_f32_16x16x32_bf16 v[128:131], a[204:207], a[72:75], 0
    v_mfma_f32_16x16x32_bf16 v[132:135], a[204:207], a[76:79], 0
    v_mfma_f32_16x16x32_bf16 v[136:139], a[204:207], a[80:83], 0
    v_mfma_f32_16x16x32_bf16 v[128:131], a[208:211], a[84:87], v[128:131]
    v_cvt_pk_bf16_f32 v152, v116, v117
    v_cvt_pk_bf16_f32 v153, v118, v119
    v_mfma_f32_16x16x32_bf16 v[132:135], a[208:211], a[88:91], v[132:135]
    v_cvt_pk_bf16_f32 v156, v120, v121
    v_cvt_pk_bf16_f32 v157, v122, v123
    v_mfma_f32_16x16x32_bf16 v[136:139], a[208:211], a[92:95], v[136:139]
    v_cvt_pk_bf16_f32 v160, v124, v125
    v_cvt_pk_bf16_f32 v161, v126, v127
    v_mfma_f32_16x16x32_bf16 v[128:131], a[212:215], a[96:99], v[128:131]
    v_mfma_f32_16x16x32_bf16 v[132:135], a[212:215], a[100:103], v[132:135]
    s_waitcnt lgkmcnt(1)
    v_mfma_f32_16x16x32_bf16 v[68:71], v[152:155], v[224:227], v[68:71]
    v_mfma_f32_16x16x32_bf16 v[72:75], v[156:159], v[224:227], v[72:75]
    v_mfma_f32_16x16x32_bf16 v[76:79], v[160:163], v[224:227], v[76:79]
    v_mfma_f32_16x16x32_bf16 v[136:139], a[212:215], a[104:107], v[136:139]
    ds_read_b64 v[220:221], v3 offset:17424
    v_mfma_f32_16x16x32_bf16 v[116:119], a[204:207], a[108:111], 0
    ds_read_b64 v[222:223], v3 offset:17952
    v_mfma_f32_16x16x32_bf16 v[120:123], a[204:207], a[112:115], 0
    v_mfma_f32_16x16x32_bf16 v[124:127], a[204:207], a[116:119], 0
    v_mfma_f32_16x16x32_bf16 v[116:119], a[208:211], a[120:123], v[116:119]
    v_cvt_pk_bf16_f32 v140, v128, v129
    v_cvt_pk_bf16_f32 v141, v130, v131
    v_mfma_f32_16x16x32_bf16 v[120:123], a[208:211], a[124:127], v[120:123]
    v_cvt_pk_bf16_f32 v144, v132, v133
    v_cvt_pk_bf16_f32 v145, v134, v135
    v_mfma_f32_16x16x32_bf16 v[124:127], a[208:211], a[128:131], v[124:127]
    v_cvt_pk_bf16_f32 v148, v136, v137
    v_cvt_pk_bf16_f32 v149, v138, v139
    v_mfma_f32_16x16x32_bf16 v[116:119], a[212:215], a[132:135], v[116:119]
    v_cvt_pk_bf16_f32 v32, v68, v69
    v_cvt_pk_bf16_f32 v33, v70, v71
    v_mfma_f32_16x16x32_bf16 v[120:123], a[212:215], a[136:139], v[120:123]
    v_cvt_pk_bf16_f32 v34, v72, v73
    v_cvt_pk_bf16_f32 v35, v74, v75
    v_mfma_f32_16x16x32_bf16 v[124:127], a[212:215], a[140:143], v[124:127]
    v_cvt_pk_bf16_f32 v36, v76, v77
    v_cvt_pk_bf16_f32 v37, v78, v79
    v_mfma_f32_16x16x32_bf16 v[128:131], a[204:207], v[180:183], 0
    ds_read_b64 v[224:225], v3 offset:18480
    v_mfma_f32_16x16x32_bf16 v[132:135], a[204:207], v[184:187], 0
    v_mov_b32 v227, v173
    v_mov_b32 v226, 0
    v_mfma_f32_16x16x32_bf16 v[136:139], a[204:207], v[188:191], 0
    v_permlane16_swap_b32 v32, v34
    v_permlane16_swap_b32 v33, v35
    v_mfma_f32_16x16x32_bf16 v[128:131], a[208:211], v[192:195], v[128:131]
    v_cvt_pk_bf16_f32 v142, v116, v117
    v_cvt_pk_bf16_f32 v143, v118, v119
    v_mfma_f32_16x16x32_bf16 v[132:135], a[208:211], v[196:199], v[132:135]
    v_cvt_pk_bf16_f32 v146, v120, v121
    v_cvt_pk_bf16_f32 v147, v122, v123
    v_mfma_f32_16x16x32_bf16 v[136:139], a[208:211], v[200:203], v[136:139]
    v_cvt_pk_bf16_f32 v150, v124, v125
    v_cvt_pk_bf16_f32 v151, v126, v127
    v_mfma_f32_16x16x32_bf16 v[128:131], a[212:215], v[204:207], v[128:131]
    ds_write_b64 v17, v[36:37] offset:2304
    v_mfma_f32_16x16x32_bf16 v[132:135], a[212:215], v[208:211], v[132:135]
    buffer_store_dwordx4 v[32:35], v16, s[16:19], s31 offen sc1
    s_add_u32 s31, s31, s55
    s_waitcnt lgkmcnt(2)
    v_mfma_f32_16x16x32_bf16 v[80:83], v[140:143], v[220:223], v[80:83]
    v_mfma_f32_16x16x32_bf16 v[84:87], v[144:147], v[220:223], v[84:87]
    v_mfma_f32_16x16x32_bf16 v[88:91], v[148:151], v[220:223], v[88:91]
    v_mfma_f32_16x16x32_bf16 v[136:139], a[212:215], v[212:215], v[136:139]
    v_mfma_f32_16x16x32_bf16 v[116:119], a[216:219], a[72:75], 0
    s_waitcnt lgkmcnt(0)
    s_barrier
    v_mfma_f32_16x16x32_bf16 v[120:123], a[216:219], a[76:79], 0
    ds_read_b64 v[38:39], v18 offset:0
    v_mfma_f32_16x16x32_bf16 v[124:127], a[216:219], a[80:83], 0
    ds_read_b64 v[40:41], v18 offset:1152
    v_mfma_f32_16x16x32_bf16 v[116:119], a[220:223], a[84:87], v[116:119]
    v_cvt_pk_bf16_f32 v152, v128, v129
    v_cvt_pk_bf16_f32 v153, v130, v131
    v_mfma_f32_16x16x32_bf16 v[120:123], a[220:223], a[88:91], v[120:123]
    v_cvt_pk_bf16_f32 v156, v132, v133
    v_cvt_pk_bf16_f32 v157, v134, v135
    v_mfma_f32_16x16x32_bf16 v[124:127], a[220:223], a[92:95], v[124:127]
    v_cvt_pk_bf16_f32 v160, v136, v137
    v_cvt_pk_bf16_f32 v161, v138, v139
    v_mfma_f32_16x16x32_bf16 v[116:119], a[224:227], a[96:99], v[116:119]
    ds_read_b64 v[42:43], v18 offset:2304
    v_mfma_f32_16x16x32_bf16 v[120:123], a[224:227], a[100:103], v[120:123]
    v_mfma_f32_16x16x32_bf16 v[80:83], v[152:155], v[224:227], v[80:83]
    v_mfma_f32_16x16x32_bf16 v[84:87], v[156:159], v[224:227], v[84:87]
    v_mfma_f32_16x16x32_bf16 v[88:91], v[160:163], v[224:227], v[88:91]
    v_mfma_f32_16x16x32_bf16 v[124:127], a[224:227], a[104:107], v[124:127]
    ds_read_b64 v[216:217], v3 offset:22176
    v_mfma_f32_16x16x32_bf16 v[128:131], a[216:219], a[108:111], 0
    ds_read_b64 v[218:219], v3 offset:22704
    v_mfma_f32_16x16x32_bf16 v[132:135], a[216:219], a[112:115], 0
    s_waitcnt lgkmcnt(4)
    buffer_store_dwordx2 v[38:39], v19, s[16:19], s46 offen sc1
    s_add_u32 s46, s46, s55
    v_mfma_f32_16x16x32_bf16 v[136:139], a[216:219], a[116:119], 0
    v_mfma_f32_16x16x32_bf16 v[128:131], a[220:223], a[120:123], v[128:131]
    v_cvt_pk_bf16_f32 v140, v116, v117
    v_cvt_pk_bf16_f32 v141, v118, v119
    v_mfma_f32_16x16x32_bf16 v[132:135], a[220:223], a[124:127], v[132:135]
    v_cvt_pk_bf16_f32 v144, v120, v121
    v_cvt_pk_bf16_f32 v145, v122, v123
    v_mfma_f32_16x16x32_bf16 v[136:139], a[220:223], a[128:131], v[136:139]
    v_cvt_pk_bf16_f32 v148, v124, v125
    v_cvt_pk_bf16_f32 v149, v126, v127
    v_mfma_f32_16x16x32_bf16 v[128:131], a[224:227], a[132:135], v[128:131]
    s_waitcnt lgkmcnt(3)
    buffer_store_dwordx2 v[40:41], v19, s[16:19], s46 offen sc1
    s_add_u32 s46, s46, s55
    v_mfma_f32_16x16x32_bf16 v[132:135], a[224:227], a[136:139], v[132:135]
    v_cvt_pk_bf16_f32 v32, v80, v81
    v_cvt_pk_bf16_f32 v33, v82, v83
    v_mfma_f32_16x16x32_bf16 v[136:139], a[224:227], a[140:143], v[136:139]
    v_cvt_pk_bf16_f32 v34, v84, v85
    v_cvt_pk_bf16_f32 v35, v86, v87
    v_mfma_f32_16x16x32_bf16 v[116:119], a[216:219], v[180:183], 0
    ds_read_b64 v[224:225], v3 offset:23232
    v_mfma_f32_16x16x32_bf16 v[120:123], a[216:219], v[184:187], 0
    v_mov_b32 v226, v174
    v_mov_b32 v227, 0
    v_mfma_f32_16x16x32_bf16 v[124:127], a[216:219], v[188:191], 0
    s_waitcnt lgkmcnt(3)
    buffer_store_dwordx2 v[42:43], v19, s[16:19], s46 offen sc1
    s_add_u32 s46, s46, s55
    v_mfma_f32_16x16x32_bf16 v[116:119], a[220:223], v[192:195], v[116:119]
    v_cvt_pk_bf16_f32 v142, v128, v129
    v_cvt_pk_bf16_f32 v143, v130, v131
    v_mfma_f32_16x16x32_bf16 v[120:123], a[220:223], v[196:199], v[120:123]
    v_cvt_pk_bf16_f32 v146, v132, v133
    v_cvt_pk_bf16_f32 v147, v134, v135
    v_mfma_f32_16x16x32_bf16 v[124:127], a[220:223], v[200:203], v[124:127]
    v_cvt_pk_bf16_f32 v150, v136, v137
    v_cvt_pk_bf16_f32 v151, v138, v139
    v_mfma_f32_16x16x32_bf16 v[116:119], a[224:227], v[204:207], v[116:119]
    v_cvt_pk_bf16_f32 v36, v88, v89
    v_cvt_pk_bf16_f32 v37, v90, v91
    v_mfma_f32_16x16x32_bf16 v[120:123], a[224:227], v[208:211], v[120:123]
    v_permlane16_swap_b32 v32, v34
    v_permlane16_swap_b32 v33, v35
    s_waitcnt lgkmcnt(1)
    v_mfma_f32_16x16x32_bf16 v[92:95], v[140:143], v[216:219], v[92:95]
    ds_write_b64 v17, v[36:37] offset:3456
    v_mfma_f32_16x16x32_bf16 v[96:99], v[144:147], v[216:219], v[96:99]
    buffer_store_dwordx4 v[32:35], v16, s[16:19], s31 offen sc1
    s_add_u32 s31, s31, s55
    v_mfma_f32_16x16x32_bf16 v[100:103], v[148:151], v[216:219], v[100:103]
    v_mfma_f32_16x16x32_bf16 v[124:127], a[224:227], v[212:215], v[124:127]
    v_cvt_pk_bf16_f32 v152, v116, v117
    v_cvt_pk_bf16_f32 v153, v118, v119
    v_cvt_pk_bf16_f32 v156, v120, v121
    v_cvt_pk_bf16_f32 v157, v122, v123
    s_nop 3
    v_cvt_pk_bf16_f32 v160, v124, v125
    v_cvt_pk_bf16_f32 v161, v126, v127
    s_waitcnt lgkmcnt(1)
    v_mfma_f32_16x16x32_bf16 v[92:95], v[152:155], v[224:227], v[92:95]
    v_mfma_f32_16x16x32_bf16 v[96:99], v[156:159], v[224:227], v[96:99]
    v_mfma_f32_16x16x32_bf16 v[100:103], v[160:163], v[224:227], v[100:103]
    s_cmp_lg_u32 s54, 0
    s_nop 4
    v_cvt_pk_bf16_f32 v32, v92, v93
    v_cvt_pk_bf16_f32 v33, v94, v95
    v_cvt_pk_bf16_f32 v34, v96, v97
    v_cvt_pk_bf16_f32 v35, v98, v99
    ds_write_b64 v20, v[32:33] offset:0
    v_cvt_pk_bf16_f32 v36, v100, v101
    v_cvt_pk_bf16_f32 v37, v102, v103
    ds_write_b64 v20, v[34:35] offset:32
    ds_write_b64 v21, v[36:37] offset:64
    s_waitcnt lgkmcnt(0)
    s_barrier
    ds_read_b64 v[38:39], v18 offset:3456
    ds_read_b128 v[26:29], v22 offset:0
    ds_read_b64 v[30:31], v23 offset:0
    s_waitcnt lgkmcnt(2)
    buffer_store_dwordx2 v[38:39], v19, s[16:19], s46 offen sc1
    s_waitcnt lgkmcnt(1)
    buffer_store_dwordx4 v[26:29], v24, s[16:19], s31 offen sc1
    s_waitcnt lgkmcnt(0)
    buffer_store_dwordx2 v[30:31], v25, s[16:19], s31 offen sc1
    s_cbranch_scc0 L_end
L_gS:
    s_waitcnt vmcnt(0)
    s_barrier
    s_branch L_gW
.p2align 12
L_P:
    v_and_b32 v34, 28, v32
    s_add_u32 m0, s33, 7808
    s_min_i32 s39, s20, s21
    s_add_u32 s20, s20, s55
    buffer_load_dwordx4 v8, s[4:7], s39 offen lds
    v_mov_b32 v35, 0
    v_add_u32 v34, 163488, v34
    s_cmp_eq_u32 s56, 0
    ds_write_b32 v34, v35
    s_mov_b32 s57, 0x4000002
    s_cselect_b32 s57, 0x40002, s57
    s_cselect_b32 s35, 4.0, 0
    s_cselect_b32 s32, 0, 4.0
    s_cselect_b64 vcc, -1, 0
    s_cselect_b32 s47, 1, 0
    s_mul_i32 s48, s56, 244
    s_movk_i32 s49, 244
    v_mad_u32_u24 v56, v39, s56, v40
    v_mad_u32_u24 v59, v39, s47, v41
    v_cndmask_b32 v104, v40, v41, vcc
    v_add_u32 v56, 1, v56
    v_mul_u32_u24 v59, s49, v59
    v_cndmask_b32 v105, v41, v40, vcc
    v_add_u32 v57, s47, v56
    v_add_u32 v104, v104, v39
    s_add_u32 m0, s33, 11712
    s_min_i32 s39, s20, s21
    s_add_u32 s20, s20, s55
    buffer_load_dwordx4 v8, s[4:7], s39 offen lds
    v_add_u32 v58, s47, v57
    v_lshl_or_b32 v24, v105, 8, v104
    v_bfe_u32 v60, v56, 2, 2
    v_bfe_u32 v61, v57, 2, 2
    v_bfe_u32 v62, v58, 2, 2
    v_mad_u32_u24 v56, v56, 12, v60
    v_mad_u32_u24 v57, v57, 12, v61
    v_mad_u32_u24 v58, v58, 12, v62
    v_cvt_f32_u32 v104, v104
    v_cvt_f32_u32 v105, v105
    v_add3_u32 v56, v56, v59, s70
    s_add_u32 s70, s70, s48
    v_add3_u32 v57, v57, v59, s70
    s_add_u32 m0, s33, 15616
    s_min_i32 s39, s20, s21
    s_add_u32 s20, s20, s55
    buffer_load_dwordx4 v8, s[4:7], s39 offen lds
    s_add_u32 s70, s70, s48
    v_add3_u32 v58, v58, v59, s70
    s_add_u32 s70, s70, s48
    v_mov_b32 v59, 0x3d00000
    s_mov_b32 s47, 0x10001
    v_add_f32 v104, s68, v104
    v_add_f32 v105, s69, v105
    v_mad_u32_u24 v80, v56, s47, v59
    v_add_u32 v81, 1952, v56
    v_mad_u32_u24 v82, v57, s47, v59
    v_add_u32 v83, 1952, v57
    v_mad_u32_u24 v84, v58, s47, v59
    v_add_u32 v85, 1952, v58
    s_add_u32 m0, s33, 19520
    s_min_i32 s39, s20, s21
    s_add_u32 s20, s20, s55
    buffer_load_dwordx4 v8, s[4:7], s39 offen lds
    s_waitcnt vmcnt(10)
    v_lshrrev_b32 v23, 16, v167
    v_and_b32 v25, 0xffff, v167
    v_lshl_add_u32 v23, v40, 4, v23
    v_add_f32 v106, 1.0, v105
    v_lshl_or_b32 v24, v24, 16, v23
    v_add_u32 v23, 103008, v23
    v_add_f32 v107, 2.0, v105
    s_mov_b32 exec_hi, 0xffff
    ds_write_b64 v23, v[80:81] offset:0
    ds_write_b64 v23, v[82:83] offset:256
    ds_write_b64 v23, v[84:85] offset:512
    s_mov_b32 exec_hi, -1
    s_lshl_b32 s42, s56, 4
    s_add_u32 s44, s44, 107616
    s_mul_i32 s45, s30, 3104
    s_lshl_b32 s47, s29, 10
    s_add_u32 m0, s33, 23424
    s_min_i32 s39, s20, s21
    s_add_u32 s20, s20, s55
    buffer_load_dwordx4 v8, s[4:7], s39 offen lds
    s_add_u32 s45, s45, s47
    s_add_u32 s45, s45, 120032
    s_mul_i32 s48, s30, 3072
    s_add_u32 s47, s47, s48
    s_add_u32 s47, s47, 12288
    v_add_u32 v26, s47, v6
    s_mul_i32 s47, s30, 2304
    s_add_u32 s47, s47, 103008
    v_lshl_add_u32 v172, v165, 4, s47
    v_add_u32 v173, 16, v164
    v_mov_b32 v174, 0xf400f40
    s_lshl_b32 s48, s29, 7
    s_lshl_b32 s49, s29, 5
    s_add_u32 s47, s48, 107616
    v_add_u32_sdwa v4, s47, v16 dst_sel:DWORD dst_unused:UNUSED_PAD src0_sel:DWORD src1_sel:WORD_0
    s_add_u32 s47, s49, 107616
    v_add_u32_sdwa v5, s47, v16 dst_sel:DWORD dst_unused:UNUSED_PAD src0_sel:DWORD src1_sel:WORD_0
    v_mov_b32 v14, 163488
    s_lshl_b32 s38, s28, 12
    s_add_u32 s38, s38, 144864
    s_lshl_b32 s47, s30, 2
    s_cselect_b32 s31, s27, s26
    s_lshr_b32 s36, s22, s47
    s_and_b32 s36, s36, 15
    s_mov_b32 s52, 0x435f435f
    s_mov_b32 s46, 0
    s_waitcnt lgkmcnt(0)
    s_barrier
    v_cvt_pk_bf16_f32 v180, v104, v105
    v_cvt_pk_bf16_f32 v181, v104, v106
    v_cvt_pk_bf16_f32 v182, v104, v107
    v_pk_max_i16 v180, v180, 0
    v_pk_max_i16 v181, v181, 0
    v_pk_max_i16 v182, v182, 0
    v_mov_b32 v204, 0
    s_cmp_lt_u32 s72, 8
    s_cbranch_scc1 L_Pv
    s_add_u32 m0, s33, 27328
    s_min_i32 s47, s20, s21
    s_add_u32 s20, s20, s55
    buffer_load_dwordx4 v8, s[4:7], s47 offen lds
    s_waitcnt vmcnt(9)
L_Pv2:
    v_lshlrev_b32 v56, 16, v232
    v_lshlrev_b32 v58, 16, v233
    v_lshlrev_b32 v60, 16, v234
    v_and_b32 v57, 0xffff0000, v232
    v_and_b32 v59, 0xffff0000, v233
    v_and_b32 v61, 0xffff0000, v234
    v_add_f32 v56, v56, v104
    v_add_f32 v58, v58, v104
    v_add_f32 v60, v60, v104
    v_add_f32 v57, v57, v105
    v_add_f32 v59, v59, v106
    v_add_f32 v61, v61, v107
    v_cvt_pk_bf16_f32 v56, v56, v57
    v_cvt_pk_bf16_f32 v58, v58, v59
    v_cvt_pk_bf16_f32 v60, v60, v61
    v_pk_max_i16 v56, v56, 0
    v_pk_max_i16 v58, v58, 0
    v_pk_max_i16 v60, v60, 0
    v_cmp_ne_u32 s[58:59], v56, v180
    v_cmp_ne_u32 s[60:61], v58, v181
    v_cmp_ne_u32 s[62:63], v60, v182
    s_cmp_le_u32 s75, 4
    s_cbranch_scc0 L_Ps
    v_addc_co_u32 v205, vcc, 0, v204, s[58:59]
    v_addc_co_u32 v206, vcc, 0, v205, s[60:61]
    v_addc_co_u32 v213, vcc, 0, v206, s[62:63]
    s_branch L_Pk
L_Pv:
    s_waitcnt vmcnt(8)
    s_cmp_le_u32 s72, 7
    s_cbranch_scc1 L_l1
    s_add_u32 m0, s33, 27328
    s_min_i32 s47, s20, s21
    s_add_u32 s20, s20, s55
    buffer_load_dwordx4 v8, s[4:7], s47 offen lds
L_l1:
    s_branch L_Pv2
L_Ps:
    v_lshlrev_b32 v56, 16, v236
    v_add_f32 v108, s35, v104
    s_cmp_le_u32 s72, 8
    s_cbranch_scc1 L_l2
    s_add_u32 m0, s33, 31232
    s_min_i32 s47, s20, s21
    s_add_u32 s20, s20, s55
    buffer_load_dwordx4 v8, s[4:7], s47 offen lds
L_l2:
    v_addc_co_u32 v205, vcc, 0, v204, s[58:59]
    v_lshlrev_b32 v58, 16, v237
    v_add_f32 v109, s32, v105
    v_lshlrev_b32 v60, 16, v238
    v_addc_co_u32 v206, vcc, 0, v205, s[60:61]
    v_add_f32 v110, s32, v106
    v_and_b32 v57, 0xffff0000, v236
    v_add_f32 v111, s32, v107
    v_addc_co_u32 v207, vcc, 0, v206, s[62:63]
    v_and_b32 v59, 0xffff0000, v237
    v_cvt_pk_bf16_f32 v183, v108, v109
    v_and_b32 v61, 0xffff0000, v238
    v_cvt_pk_bf16_f32 v184, v108, v110
    v_add_f32 v56, v56, v108
    v_cvt_pk_bf16_f32 v185, v108, v111
    v_add_f32 v58, v58, v108
    v_pk_max_i16 v183, v183, 0
    v_add_f32 v60, v60, v108
    v_pk_max_i16 v184, v184, 0
    v_add_f32 v57, v57, v109
    v_pk_max_i16 v185, v185, 0
    v_add_f32 v59, v59, v110
    s_cmp_le_u32 s72, 9
    s_cbranch_scc1 L_l3
    s_add_u32 m0, s33, 35136
    s_min_i32 s47, s20, s21
    s_add_u32 s20, s20, s55
    buffer_load_dwordx4 v8, s[4:7], s47 offen lds
L_l3:
    v_add_f32 v61, v61, v111
    v_cvt_pk_bf16_f32 v56, v56, v57
    v_cvt_pk_bf16_f32 v58, v58, v59
    v_cvt_pk_bf16_f32 v60, v60, v61
    v_pk_max_i16 v56, v56, 0
    v_pk_max_i16 v58, v58, 0
    v_pk_max_i16 v60, v60, 0
    v_cmp_ne_u32 s[64:65], v56, v183
    v_cmp_ne_u32 s[66:67], v58, v184
    v_cmp_ne_u32 s[76:77], v60, v185
    v_lshlrev_b32 v56, 16, v240
    v_add_f32 v112, s35, v108
    v_addc_co_u32 v208, vcc, 0, v207, s[64:65]
    v_lshlrev_b32 v58, 16, v241
    v_add_f32 v113, s32, v109
    v_lshlrev_b32 v60, 16, v242
    v_addc_co_u32 v209, vcc, 0, v208, s[66:67]
    v_add_f32 v114, s32, v110
    v_and_b32 v57, 0xffff0000, v240
    v_add_f32 v115, s32, v111
    v_addc_co_u32 v210, vcc, 0, v209, s[76:77]
    v_and_b32 v59, 0xffff0000, v241
    s_cmp_le_u32 s72, 10
    s_cbranch_scc1 L_l4
    s_add_u32 m0, s33, 39040
    s_min_i32 s47, s20, s21
    s_add_u32 s20, s20, s55
    buffer_load_dwordx4 v8, s[4:7], s47 offen lds
L_l4:
    v_cvt_pk_bf16_f32 v186, v112, v113
    v_and_b32 v61, 0xffff0000, v242
    v_cvt_pk_bf16_f32 v187, v112, v114
    v_add_f32 v56, v56, v112
    v_cvt_pk_bf16_f32 v188, v112, v115
    v_add_f32 v58, v58, v112
    v_pk_max_i16 v186, v186, 0
    v_add_f32 v60, v60, v112
    v_pk_max_i16 v187, v187, 0
    v_add_f32 v57, v57, v113
    v_pk_max_i16 v188, v188, 0
    v_add_f32 v59, v59, v114
    v_add_f32 v61, v61, v115
    v_cvt_pk_bf16_f32 v56, v56, v57
    v_cvt_pk_bf16_f32 v58, v58, v59
    v_cvt_pk_bf16_f32 v60, v60, v61
    v_pk_max_i16 v56, v56, 0
    v_pk_max_i16 v58, v58, 0
    v_pk_max_i16 v60, v60, 0
    v_cmp_ne_u32 s[78:79], v56, v186
    v_cmp_ne_u32 s[0:1], v58, v187
    v_cmp_ne_u32 s[50:51], v60, v188
    v_addc_co_u32 v211, vcc, 0, v210, s[78:79]
    v_addc_co_u32 v212, vcc, 0, v211, s[0:1]
    v_addc_co_u32 v213, vcc, 0, v212, s[50:51]
L_Pk:
    v_mov_b32 v67, v213
    v_add_u32 v192, 0x0, v24
    v_add_u32 v193, 0x1000100, v24
    v_add_u32_dpp v67, v67, v67 row_shr:1 row_mask:0xf bank_mask:0xf bound_ctrl:0
    v_add_u32 v194, 0x2000200, v24
    v_add_u32 v195, s57, v192
    v_add_u32_dpp v67, v67, v67 row_shr:2 row_mask:0xf bank_mask:0xf bound_ctrl:0
    v_add_u32 v196, s57, v193
    v_add_u32 v197, s57, v194
    v_add_u32_dpp v67, v67, v67 row_shr:4 row_mask:0xf bank_mask:0xf bound_ctrl:0
    v_add_u32 v198, s57, v195
    v_add_u32 v199, s57, v196
    v_add_u32_dpp v67, v67, v67 row_shr:8 row_mask:0xf bank_mask:0xf bound_ctrl:0
    v_add_u32 v200, s57, v197
    s_add_u32 s49, s38, 2048
    v_add_u32_dpp v67, v67, v67 row_bcast:15 row_mask:0xa bank_mask:0xf
    v_mov_b32 v69, 163504
    v_lshrrev_b32 v82, 4, v6
    v_add_u32_dpp v67, v67, v67 row_bcast:31 row_mask:0xc bank_mask:0xf
    s_mov_b32 s39, 0
    v_readlane_b32 s37, v67, 63
    v_sub_u32 v67, v67, v213
    v_lshl_add_u32 v68, v67, 3, s49
    s_sub_u32 s32, s37, 1
    v_mov_b32 v78, s37
    s_cmpk_ge_u32 s32, 128
    s_cbranch_scc1 L_Pz
    v_lshl_add_u32 v204, v204, 3, v68
    v_lshl_add_u32 v205, v205, 3, v68
    v_lshl_add_u32 v206, v206, 3, v68
    v_lshl_add_u32 v207, v207, 3, v68
    v_lshl_add_u32 v208, v208, 3, v68
    v_lshl_add_u32 v209, v209, 3, v68
    v_lshl_add_u32 v210, v210, 3, v68
    v_lshl_add_u32 v211, v211, 3, v68
    v_lshl_add_u32 v212, v212, 3, v68
    s_cmp_le_u32 s72, 8
    s_mov_b64 exec, 1
    ds_add_rtn_u32 v78, v69, v78
    s_mov_b64 exec, s[58:59]
    s_cbranch_execz L_Pb0
    ds_write2_b32 v204, v232, v192 offset1:1
L_Pb0:
    s_mov_b64 exec, s[60:61]
    s_cbranch_execz L_Pb1
    ds_write2_b32 v205, v233, v193 offset1:1
L_Pb1:
    s_mov_b64 exec, s[62:63]
    s_cbranch_execz L_Pb2
    ds_write2_b32 v206, v234, v194 offset1:1
L_Pb2:
    s_cbranch_scc1 L_Pq
    s_mov_b64 exec, s[64:65]
    s_cbranch_execz L_Pb3
    ds_write2_b32 v207, v236, v195 offset1:1
L_Pb3:
    s_mov_b64 exec, s[66:67]
    s_cbranch_execz L_Pb4
    ds_write2_b32 v208, v237, v196 offset1:1
L_Pb4:
    s_mov_b64 exec, s[76:77]
    s_cbranch_execz L_Pb5
    ds_write2_b32 v209, v238, v197 offset1:1
L_Pb5:
    s_mov_b64 exec, s[78:79]
    s_cbranch_execz L_Pb6
    ds_write2_b32 v210, v240, v198 offset1:1
L_Pb6:
    s_mov_b64 exec, s[0:1]
    s_cbranch_execz L_Pb7
    ds_write2_b32 v211, v241, v199 offset1:1
L_Pb7:
    s_mov_b64 exec, s[50:51]
    s_cbranch_execz L_Pb8
    ds_write2_b32 v212, v242, v200 offset1:1
L_Pb8:
L_Pq:
    s_mov_b64 exec, -1
    v_min_u32 v85, s32, v82
    v_cmp_ge_u32 s[64:65], s32, v82
    v_lshl_add_u32 v83, v85, 3, s38
    ds_read_b64 v[80:81], v83 offset:2048
    v_add_u32 v82, 64, v82
    s_add_u32 s39, s39, 64
    s_mov_b32 s49, 103008
    s_mov_b32 s50, 0
    s_lshr_b32 s35, s24, 4
    v_min_u32 v10, s32, v25
    v_lshlrev_b32 v10, 2, v10
    s_cmp_eq_u32 s28, 1
    s_cbranch_scc0 L_Pa_n0
    s_call_b64 s[78:79], L_Pa_t0
L_Pa_n0:
    s_cmp_eq_u32 s28, 2
    s_cbranch_scc0 L_Pa_n1
    s_call_b64 s[78:79], L_Pa_t1
L_Pa_n1:
    s_cmp_le_u32 s72, 11
    s_cbranch_scc1 L_l5
    s_add_u32 m0, s33, 42944
    s_min_i32 s47, s20, s21
    s_add_u32 s20, s20, s55
    buffer_load_dwordx4 v8, s[4:7], s47 offen lds
L_l5:
    s_cmp_le_u32 s72, 12
    s_cbranch_scc1 L_l6
    s_add_u32 m0, s33, 46848
    s_min_i32 s47, s20, s21
    s_add_u32 s20, s20, s55
    buffer_load_dwordx4 v8, s[4:7], s47 offen lds
L_l6:
    s_cmp_le_u32 s72, 13
    s_cbranch_scc1 L_l7
    s_add_u32 m0, s33, 50752
    s_min_i32 s47, s20, s21
    s_add_u32 s20, s20, s55
    buffer_load_dwordx4 v8, s[4:7], s47 offen lds
L_l7:
    s_waitcnt lgkmcnt(0)
    v_readfirstlane_b32 s53, v78
    v_cvt_f32_ubyte2 v86, v81
    v_cvt_f32_ubyte3 v87, v81
    v_add_u32_sdwa v84, s49, v81 dst_sel:DWORD dst_unused:UNUSED_PAD src0_sel:DWORD src1_sel:WORD_0
    v_add_f32 v86, s68, v86
    v_add_f32 v87, s69, v87
    v_mov_b32 v81, s50
    v_lshlrev_b32 v61, 16, v80
    v_and_b32 v62, 0xffff0000, v80
    s_cmp_le_u32 s72, 14
    s_cbranch_scc1 L_l8
    s_add_u32 m0, s33, 54656
    s_min_i32 s47, s20, s21
    s_add_u32 s20, s20, s55
    buffer_load_dwordx4 v8, s[4:7], s47 offen lds
L_l8:
    v_add_f32 v61, v61, v86
    v_add_f32 v62, v62, v87
    v_cvt_pk_bf16_f32 v60, v61, v62
    v_pk_max_i16 v60, v60, 0
    v_pk_min_i16 v60, v60, s52
    v_alignbit_b32 v60, v60, v60, s42
    v_lshlrev_b32 v61, 16, v60
    v_and_b32 v62, 0xffff0000, v60
    v_fract_f32 v63, v61
    v_fract_f32 v64, v62
    s_cmp_le_u32 s72, 15
    s_cbranch_scc1 L_l9
    s_add_u32 m0, s33, 58560
    s_min_i32 s47, s20, s21
    s_add_u32 s20, s20, s55
    buffer_load_dwordx4 v8, s[4:7], s47 offen lds
L_l9:
    v_cvt_u32_f32 v65, v61
    v_cvt_u32_f32 v66, v62
    v_cmp_neq_f32 s[58:59], 0, v64
    v_cmp_neq_f32 s[60:61], 0, v63
    v_sub_f32 v67, 1.0, v63
    v_sub_f32 v68, 1.0, v64
    v_subrev_u32 v65, s71, v65
    v_subrev_u32 v66, s43, v66
    v_cvt_pk_bf16_f32 v61, v67, v68
    v_addc_co_u32 v74, vcc, 0, v66, s[58:59]
    s_add_u32 m0, s44, 0
    s_nop 0
    buffer_load_dwordx4 v7, s[12:15], s46 offen offset:0 lds
    v_addc_co_u32 v73, vcc, 0, v65, s[60:61]
    v_lshlrev_b32 v67, 16, v61
    v_and_b32 v68, 0xffff0000, v61
    v_mul_u32_u24 v75, 976, v65
    v_mul_f32 v69, v67, v68
    v_mul_f32 v70, v67, v64
    v_mul_f32 v71, v63, v68
    v_mul_f32 v72, v63, v64
    v_max_u32 v73, v73, v65
    v_max_u32 v61, v66, v74
    buffer_load_dwordx4 v7, s[12:15], s46 offen offset:1024 lds
    v_mad_u32_u24 v67, v66, 48, v75
    v_mad_u32_u24 v68, v74, 48, v75
    v_and_b32 v66, 12, v66
    v_and_b32 v74, 12, v74
    s_andn2_b64 s[62:63], s[60:61], s[58:59]
    v_add_lshl_u32 v67, v67, v66, 2
    v_add_lshl_u32 v68, v68, v74, 2
    v_cndmask_b32 v70, v71, v70, s[58:59]
    v_cndmask_b32 v62, 0, v174, s[62:63]
    s_and_b64 s[62:63], s[60:61], s[58:59]
    v_cndmask_b32 v71, 0, v71, s[58:59]
    s_and_b64 s[66:67], s[62:63], s[64:65]
    v_cmp_le_u32 s[60:61], s72, v73
    v_mbcnt_lo_u32_b32 v81, s66, v81
    v_cmp_lt_u32 s[58:59], 19, v61
    s_bcnt1_i32_b64 s48, s[66:67]
    v_lshl_or_b32 v58, v68, 16, v67
    v_mbcnt_hi_u32_b32 v81, s67, v81
    v_cvt_pk_bf16_f32 v57, v69, v70
    s_add_u32 s50, s50, s48
    v_cvt_pk_bf16_f32 v59, v71, v72
    v_sub_u32 v85, v85, v81
    v_and_b32 v62, 0xffff0000, v62
    v_sub_u32 v81, s32, v81
    v_cndmask_b32 v61, 0, v174, s[62:63]
    v_cndmask_b32 v85, v85, v81, s[66:67]
    v_add_u32 v56, v58, v62
    v_lshl_add_u32 v83, v85, 4, s38
    v_add_u32 v58, v58, v61
    v_add_u32 v85, s53, v85
    ds_bpermute_b32 v28, v10, v56
    v_bfe_u32 v81, v85, 1, 2
    ds_bpermute_b32 v29, v10, v57
    v_mad_u32_u24 v85, v85, 12, s35
    v_add_u32 v85, v85, v81
    s_mov_b64 exec, s[64:65]
    ds_write_b128 v83, v[56:59]
    ds_write_b16 v84, v85
    s_mov_b64 exec, -1
    s_or_b64 s[58:59], s[58:59], s[60:61]
    s_cbranch_scc1 L_Pfail
    s_add_u32 s47, s53, s37
    s_cmp_gt_u32 s47, s25
    s_cbranch_scc1 L_Pfail
    s_cmp_lt_u32 s39, s37
    s_cbranch_scc1 L_Pr2
    s_lshr_b32 s47, s32, 4
    s_cmp_lt_u32 s36, 4
    s_addc_u32 s47, s47, s50
    s_mov_b32 s39, 0
    s_cmp_lg_u32 s47, 0
    s_cbranch_scc1 L_Pgl
    s_waitcnt lgkmcnt(2)
    v_add_u32 v9, s39, v165
    v_xor_b32_sdwa v0, v28, v164 dst_sel:DWORD dst_unused:UNUSED_PAD src0_sel:WORD_0 src1_sel:DWORD
    buffer_load_dwordx4 v7, s[12:15], s46 offen offset:2048 lds
    v_min_u32 v9, s32, v9
    v_xor_b32_sdwa v2, v28, v164 dst_sel:DWORD dst_unused:UNUSED_PAD src0_sel:WORD_1 src1_sel:DWORD
    v_add_u32 v9, s53, v9
    v_xor_b32_sdwa v1, v28, v173 dst_sel:DWORD dst_unused:UNUSED_PAD src0_sel:WORD_0 src1_sel:DWORD
    s_add_u32 s39, s39, 16
    s_add_u32 m0, s45, 0
    s_nop 0
    buffer_load_dwordx4 v26, s[12:15], s46 offen offset:0 lds
    v_xor_b32_sdwa v3, v28, v173 dst_sel:DWORD dst_unused:UNUSED_PAD src0_sel:WORD_1 src1_sel:DWORD
    v_bfe_u32 v10, v9, 1, 2
    v_perm_b32 v32, v29, v29, v168
    v_mad_u32_u24 v9, v9, 12, v10
    v_perm_b32 v33, v29, v29, v169
    buffer_load_dwordx4 v26, s[12:15], s46 offen offset:1024 lds
    s_add_u32 s46, s46, 18432
    v_xor_b32_sdwa v9, v166, v9 dst_sel:DWORD dst_unused:UNUSED_PAD src0_sel:WORD_0 src1_sel:DWORD
    v_perm_b32 v34, v29, v29, v170
    v_lshl_add_u32 v9, v9, 4, s24
    v_perm_b32 v35, v29, v29, v171
    s_waitcnt vmcnt(5) lgkmcnt(0)
    s_barrier
    ds_read_b64_tr_b16 v[180:181], v0 offset:0
    ds_read_b64_tr_b16 v[182:183], v2 offset:0
    ds_read_b64_tr_b16 v[184:185], v1 offset:0
    ds_read_b64_tr_b16 v[186:187], v3 offset:0
    ds_read_b64_tr_b16 v[188:189], v0 offset:64
    ds_read_b64_tr_b16 v[190:191], v2 offset:64
    ds_read_b64_tr_b16 v[192:193], v1 offset:64
    ds_read_b64_tr_b16 v[194:195], v3 offset:64
    ds_read_b64_tr_b16 v[196:197], v0 offset:128
    ds_read_b64_tr_b16 v[198:199], v2 offset:128
    ds_read_b64_tr_b16 v[200:201], v1 offset:128
    ds_read_b64_tr_b16 v[202:203], v3 offset:128
    ds_read_b128 v[136:139], v172 offset:0
    ds_read_b128 v[144:147], v14
    s_waitcnt lgkmcnt(12)
    v_mfma_f32_16x16x32_bf16 v[56:59], v[180:183], v[32:35], 0
    s_waitcnt lgkmcnt(10)
    v_mfma_f32_16x16x32_bf16 v[60:63], v[184:187], v[32:35], 0
    s_waitcnt lgkmcnt(8)
    v_mfma_f32_16x16x32_bf16 v[64:67], v[188:191], v[32:35], 0
    s_waitcnt lgkmcnt(6)
    v_mfma_f32_16x16x32_bf16 v[68:71], v[192:195], v[32:35], 0
    s_waitcnt lgkmcnt(1)
    v_xor_b32 v136, v136, v166
    v_xor_b32 v137, v137, v166
    v_xor_b32 v138, v138, v166
    v_xor_b32 v139, v139, v166
    v_mfma_f32_16x16x32_bf16 v[72:75], v[196:199], v[32:35], 0
    v_lshlrev_b32_sdwa v116, 4, v136 dst_sel:DWORD dst_unused:UNUSED_PAD src0_sel:DWORD src1_sel:WORD_0
    v_lshlrev_b32_sdwa v117, 4, v138 dst_sel:DWORD dst_unused:UNUSED_PAD src0_sel:DWORD src1_sel:WORD_0
    v_lshlrev_b32_sdwa v118, 4, v136 dst_sel:DWORD dst_unused:UNUSED_PAD src0_sel:DWORD src1_sel:WORD_1
    v_mfma_f32_16x16x32_bf16 v[76:79], v[200:203], v[32:35], 0
    v_lshlrev_b32_sdwa v119, 4, v138 dst_sel:DWORD dst_unused:UNUSED_PAD src0_sel:DWORD src1_sel:WORD_1
    v_lshlrev_b32_sdwa v120, 4, v137 dst_sel:DWORD dst_unused:UNUSED_PAD src0_sel:DWORD src1_sel:WORD_0
    v_lshlrev_b32_sdwa v121, 4, v139 dst_sel:DWORD dst_unused:UNUSED_PAD src0_sel:DWORD src1_sel:WORD_0
    v_cvt_pk_bf16_f32 v80, v56, v57
    v_cvt_pk_bf16_f32 v81, v58, v59
    v_cvt_pk_bf16_f32 v82, v60, v61
    v_cvt_pk_bf16_f32 v83, v62, v63
    v_cvt_pk_bf16_f32 v84, v64, v65
    v_cvt_pk_bf16_f32 v85, v66, v67
    v_cvt_pk_bf16_f32 v86, v68, v69
    v_cvt_pk_bf16_f32 v87, v70, v71
    v_permlane32_swap_b32 v80, v82
    v_permlane32_swap_b32 v81, v83
    ds_write_b128 v9, v[80:83] offset:0
    v_cvt_pk_bf16_f32 v88, v72, v73
    v_cvt_pk_bf16_f32 v89, v74, v75
    v_cvt_pk_bf16_f32 v90, v76, v77
    v_cvt_pk_bf16_f32 v91, v78, v79
    v_permlane32_swap_b32 v84, v86
    v_permlane32_swap_b32 v85, v87
    ds_write_b128 v9, v[84:87] offset:64
    v_permlane32_swap_b32 v88, v90
    v_permlane32_swap_b32 v89, v91
    ds_write_b128 v9, v[88:91] offset:128
    s_waitcnt lgkmcnt(3)
    v_or3_b32 v144, v144, v145, v146
    v_or_b32 v144, v144, v147
    s_nop 0
    v_readfirstlane_b32 s54, v144
L_Pa:
    s_cmp_ge_u32 s36, 4
    s_waitcnt vmcnt(0) lgkmcnt(0)
    s_barrier
    s_cbranch_scc0 L_Pd
    ds_read_b128 v[180:183], v116 offset:0
    ds_read_b64_tr_b16 a[0:1], v4 offset:0
    ds_read_b64_tr_b16 a[2:3], v4 offset:768
    ds_read_b64_tr_b16 a[4:5], v4 offset:32
    ds_read_b64_tr_b16 a[6:7], v4 offset:800
    ds_read_b64_tr_b16 a[8:9], v5 offset:64
    ds_read_b64_tr_b16 a[10:11], v5 offset:832
    ds_read_b128 v[192:195], v117 offset:0
    ds_read_b128 v[204:207], v118 offset:0
    ds_read_b64_tr_b16 a[12:13], v4 offset:6208
    ds_read_b64_tr_b16 a[14:15], v4 offset:6976
    s_waitcnt lgkmcnt(7)
    v_mfma_f32_16x16x32_bf16 v[44:47], a[0:3], v[180:183], 0
    s_add_u32 m0, s44, 18624
    ds_read_b128 v[184:187], v116 offset:64
    s_waitcnt lgkmcnt(7)
    v_mfma_f32_16x16x32_bf16 v[48:51], a[4:7], v[180:183], 0
    buffer_load_dwordx4 v7, s[12:15], s46 offen offset:0 lds
    s_waitcnt lgkmcnt(5)
    v_mfma_f32_16x16x32_bf16 v[52:55], a[8:11], v[180:183], 0
    ds_read_b64_tr_b16 a[16:17], v4 offset:6240
    s_waitcnt lgkmcnt(5)
    v_mfma_f32_16x16x32_bf16 v[56:59], a[0:3], v[192:195], 0
    ds_read_b64_tr_b16 a[18:19], v4 offset:7008
    v_mfma_f32_16x16x32_bf16 v[60:63], a[4:7], v[192:195], 0
    ds_read_b64_tr_b16 a[20:21], v5 offset:6272
    ds_read_b64_tr_b16 a[22:23], v5 offset:7040
    v_mfma_f32_16x16x32_bf16 v[64:67], a[8:11], v[192:195], 0
    buffer_load_dwordx4 v7, s[12:15], s46 offen offset:1024 lds
    s_waitcnt lgkmcnt(7)
    v_mfma_f32_16x16x32_bf16 v[68:71], a[0:3], v[204:207], 0
    ds_read_b128 v[196:199], v117 offset:64
    v_mfma_f32_16x16x32_bf16 v[72:75], a[4:7], v[204:207], 0
    ds_read_b128 v[208:211], v118 offset:64
    ds_read_b128 v[188:191], v116 offset:128
    v_mfma_f32_16x16x32_bf16 v[76:79], a[8:11], v[204:207], 0
    ds_read_b64_tr_b16 a[24:25], v4 offset:12416
    ds_read_b64_tr_b16 a[26:27], v4 offset:13184
    s_waitcnt lgkmcnt(5)
    v_mfma_f32_16x16x32_bf16 v[52:55], a[20:23], v[184:187], v[52:55]
    buffer_load_dwordx4 v7, s[12:15], s46 offen offset:2048 lds
    v_mfma_f32_16x16x32_bf16 v[48:51], a[16:19], v[184:187], v[48:51]
    ds_read_b64_tr_b16 a[28:29], v4 offset:12448
    v_mfma_f32_16x16x32_bf16 v[44:47], a[12:15], v[184:187], v[44:47]
    s_add_u32 m0, s45, 18624
    ds_read_b64_tr_b16 a[30:31], v4 offset:13216
    ds_read_b128 v[136:139], v172 offset:256
    s_waitcnt lgkmcnt(7)
    v_mfma_f32_16x16x32_bf16 v[64:67], a[20:23], v[196:199], v[64:67]
    buffer_load_dwordx4 v26, s[12:15], s46 offen offset:0 lds
    ds_read_b64_tr_b16 a[32:33], v5 offset:12480
    v_mfma_f32_16x16x32_bf16 v[60:63], a[16:19], v[196:199], v[60:63]
    ds_read_b64_tr_b16 a[34:35], v5 offset:13248
    ds_read_b128 v[200:203], v117 offset:128
    ds_read_b128 v[212:215], v118 offset:128
    v_mfma_f32_16x16x32_bf16 v[56:59], a[12:15], v[196:199], v[56:59]
    ds_read_b128 v[216:219], v119 offset:0
    s_waitcnt lgkmcnt(7)
    v_mfma_f32_16x16x32_bf16 v[76:79], a[20:23], v[208:211], v[76:79]
    ds_read_b128 v[220:223], v119 offset:64
    v_mfma_f32_16x16x32_bf16 v[72:75], a[16:19], v[208:211], v[72:75]
    buffer_load_dwordx4 v26, s[12:15], s46 offen offset:1024 lds
    s_add_u32 s46, s46, 18432
    v_mfma_f32_16x16x32_bf16 v[68:71], a[12:15], v[208:211], v[68:71]
    ds_read_b128 v[224:227], v119 offset:128
    v_mfma_f32_16x16x32_bf16 v[44:47], a[24:27], v[188:191], v[44:47]
    s_add_u32 m0, s44, 37248
    s_waitcnt lgkmcnt(7)
    v_xor_b32 v136, v136, v166
    v_xor_b32 v137, v137, v166
    v_mfma_f32_16x16x32_bf16 v[48:51], a[28:31], v[188:191], v[48:51]
    buffer_load_dwordx4 v7, s[12:15], s46 offen offset:0 lds
    s_waitcnt lgkmcnt(5)
    v_mfma_f32_16x16x32_bf16 v[52:55], a[32:35], v[188:191], v[52:55]
    ds_read_b128 v[228:231], v120 offset:0
    v_xor_b32 v138, v138, v166
    v_xor_b32 v139, v139, v166
    s_waitcnt lgkmcnt(5)
    v_mfma_f32_16x16x32_bf16 v[56:59], a[24:27], v[200:203], v[56:59]
    ds_read_b128 v[232:235], v120 offset:64
    v_lshlrev_b32_sdwa v122, 4, v136 dst_sel:DWORD dst_unused:UNUSED_PAD src0_sel:DWORD src1_sel:WORD_0
    v_lshlrev_b32_sdwa v123, 4, v138 dst_sel:DWORD dst_unused:UNUSED_PAD src0_sel:DWORD src1_sel:WORD_0
    v_mfma_f32_16x16x32_bf16 v[60:63], a[28:31], v[200:203], v[60:63]
    ds_read_b128 v[236:239], v120 offset:128
    v_lshlrev_b32_sdwa v124, 4, v136 dst_sel:DWORD dst_unused:UNUSED_PAD src0_sel:DWORD src1_sel:WORD_1
    v_lshlrev_b32_sdwa v125, 4, v138 dst_sel:DWORD dst_unused:UNUSED_PAD src0_sel:DWORD src1_sel:WORD_1
    v_mfma_f32_16x16x32_bf16 v[64:67], a[32:35], v[200:203], v[64:67]
    buffer_load_dwordx4 v7, s[12:15], s46 offen offset:1024 lds
    s_waitcnt lgkmcnt(6)
    v_mfma_f32_16x16x32_bf16 v[68:71], a[24:27], v[212:215], v[68:71]
    ds_read_b128 v[240:243], v121 offset:0
    v_lshlrev_b32_sdwa v126, 4, v137 dst_sel:DWORD dst_unused:UNUSED_PAD src0_sel:DWORD src1_sel:WORD_0
    v_lshlrev_b32_sdwa v127, 4, v139 dst_sel:DWORD dst_unused:UNUSED_PAD src0_sel:DWORD src1_sel:WORD_0
    v_mfma_f32_16x16x32_bf16 v[72:75], a[28:31], v[212:215], v[72:75]
    ds_read_b128 v[244:247], v121 offset:64
    v_mfma_f32_16x16x32_bf16 v[76:79], a[32:35], v[212:215], v[76:79]
    s_waitcnt lgkmcnt(7)
    v_mfma_f32_16x16x32_bf16 v[80:83], a[0:3], v[216:219], 0
    ds_read_b128 v[248:251], v121 offset:128
    v_mfma_f32_16x16x32_bf16 v[84:87], a[4:7], v[216:219], 0
    buffer_load_dwordx4 v7, s[12:15], s46 offen offset:2048 lds
    v_mfma_f32_16x16x32_bf16 v[88:91], a[8:11], v[216:219], 0
    ds_read_b128 v[180:183], v122 offset:0
    s_waitcnt lgkmcnt(7)
    v_mfma_f32_16x16x32_bf16 v[88:91], a[20:23], v[220:223], v[88:91]
    v_mfma_f32_16x16x32_bf16 v[84:87], a[16:19], v[220:223], v[84:87]
    ds_read_b128 v[184:187], v122 offset:64
    s_waitcnt vmcnt(3)
    s_barrier
    s_branch L_Pa_s0
L_Pa_t0:
    s_setpc_b64 s[78:79]
L_Pa_s0:
    v_mfma_f32_16x16x32_bf16 v[80:83], a[12:15], v[220:223], v[80:83]
    s_add_u32 m0, s45, 37248
    ds_read_b64_tr_b16 a[36:37], v4 offset:18624
    v_mfma_f32_16x16x32_bf16 v[80:83], a[24:27], v[224:227], v[80:83]
    buffer_load_dwordx4 v26, s[12:15], s46 offen offset:0 lds
    v_mfma_f32_16x16x32_bf16 v[84:87], a[28:31], v[224:227], v[84:87]
    ds_read_b128 v[188:191], v122 offset:128
    ds_read_b64_tr_b16 a[38:39], v4 offset:19392
    v_mfma_f32_16x16x32_bf16 v[88:91], a[32:35], v[224:227], v[88:91]
    ds_read_b64_tr_b16 a[40:41], v4 offset:18656
    s_waitcnt lgkmcnt(7)
    v_mfma_f32_16x16x32_bf16 v[92:95], a[0:3], v[228:231], 0
    ds_read_b64_tr_b16 a[42:43], v4 offset:19424
    ds_read_b64_tr_b16 a[44:45], v5 offset:18688
    v_mfma_f32_16x16x32_bf16 v[96:99], a[4:7], v[228:231], 0
    buffer_load_dwordx4 v26, s[12:15], s46 offen offset:1024 lds
    s_add_u32 s46, s46, 18432
    v_mfma_f32_16x16x32_bf16 v[100:103], a[8:11], v[228:231], 0
    ds_read_b128 v[192:195], v123 offset:0
    ds_read_b64_tr_b16 a[46:47], v5 offset:19456
    v_mfma_f32_16x16x32_bf16 v[100:103], a[20:23], v[232:235], v[100:103]
    ds_read_b64_tr_b16 a[48:49], v4 offset:24832
    ds_read_b64_tr_b16 a[50:51], v4 offset:25600
    v_mfma_f32_16x16x32_bf16 v[96:99], a[16:19], v[232:235], v[96:99]
    ds_read_b128 v[196:199], v123 offset:64
    v_mfma_f32_16x16x32_bf16 v[92:95], a[12:15], v[232:235], v[92:95]
    ds_read_b64_tr_b16 a[52:53], v4 offset:24864
    v_mfma_f32_16x16x32_bf16 v[92:95], a[24:27], v[236:239], v[92:95]
    ds_read_b64_tr_b16 a[54:55], v4 offset:25632
    ds_read_b64_tr_b16 a[56:57], v5 offset:24896
    v_mfma_f32_16x16x32_bf16 v[96:99], a[28:31], v[236:239], v[96:99]
    ds_read_b128 v[200:203], v123 offset:128
    s_add_u32 m0, s44, 0
    v_mfma_f32_16x16x32_bf16 v[100:103], a[32:35], v[236:239], v[100:103]
    buffer_load_dwordx4 v7, s[12:15], s46 offen offset:0 lds
    ds_read_b64_tr_b16 a[58:59], v5 offset:25664
    v_mfma_f32_16x16x32_bf16 v[104:107], a[0:3], v[240:243], 0
    ds_read_b64_tr_b16 a[60:61], v4 offset:31040
    ds_read_b64_tr_b16 a[62:63], v4 offset:31808
    v_mfma_f32_16x16x32_bf16 v[108:111], a[4:7], v[240:243], 0
    ds_read_b128 v[204:207], v124 offset:0
    ds_read_b64_tr_b16 a[64:65], v4 offset:31072
    v_mfma_f32_16x16x32_bf16 v[112:115], a[8:11], v[240:243], 0
    buffer_load_dwordx4 v7, s[12:15], s46 offen offset:1024 lds
    v_mfma_f32_16x16x32_bf16 v[112:115], a[20:23], v[244:247], v[112:115]
    ds_read_b64_tr_b16 a[66:67], v4 offset:31840
    ds_read_b64_tr_b16 a[68:69], v5 offset:31104
    ds_read_b64_tr_b16 a[70:71], v5 offset:31872
    v_mfma_f32_16x16x32_bf16 v[108:111], a[16:19], v[244:247], v[108:111]
    ds_read_b128 v[208:211], v124 offset:64
    v_mfma_f32_16x16x32_bf16 v[104:107], a[12:15], v[244:247], v[104:107]
    s_waitcnt lgkmcnt(7)
    v_mfma_f32_16x16x32_bf16 v[104:107], a[24:27], v[248:251], v[104:107]
    buffer_load_dwordx4 v7, s[12:15], s46 offen offset:2048 lds
    v_mfma_f32_16x16x32_bf16 v[108:111], a[28:31], v[248:251], v[108:111]
    ds_read_b128 v[212:215], v124 offset:128
    v_mfma_f32_16x16x32_bf16 v[112:115], a[32:35], v[248:251], v[112:115]
    s_waitcnt vmcnt(3)
    s_waitcnt lgkmcnt(2)
    s_barrier
    v_mfma_f32_16x16x32_bf16 v[44:47], a[36:39], v[180:183], v[44:47]
    v_mfma_f32_16x16x32_bf16 v[48:51], a[40:43], v[180:183], v[48:51]
    ds_read_b128 v[216:219], v125 offset:0
    s_add_u32 m0, s45, 0
    v_mfma_f32_16x16x32_bf16 v[52:55], a[44:47], v[180:183], v[52:55]
    buffer_load_dwordx4 v26, s[12:15], s46 offen offset:0 lds
    v_mfma_f32_16x16x32_bf16 v[52:55], a[56:59], v[184:187], v[52:55]
    ds_read_b128 v[136:139], v172 offset:512
    ds_read_b64_tr_b16 a[72:73], v4 offset:37248
    v_mfma_f32_16x16x32_bf16 v[48:51], a[52:55], v[184:187], v[48:51]
    ds_read_b128 v[220:223], v125 offset:64
    v_mfma_f32_16x16x32_bf16 v[44:47], a[48:51], v[184:187], v[44:47]
    buffer_load_dwordx4 v26, s[12:15], s46 offen offset:1024 lds
    s_add_u32 s46, s46, 18432
    v_mfma_f32_16x16x32_bf16 v[44:47], a[60:63], v[188:191], v[44:47]
    ds_read_b64_tr_b16 a[74:75], v4 offset:38016
    v_mfma_f32_16x16x32_bf16 v[48:51], a[64:67], v[188:191], v[48:51]
    ds_read_b128 v[224:227], v125 offset:128
    v_mfma_f32_16x16x32_bf16 v[52:55], a[68:71], v[188:191], v[52:55]
    ds_read_b64_tr_b16 a[76:77], v4 offset:37280
    v_mfma_f32_16x16x32_bf16 v[56:59], a[36:39], v[192:195], v[56:59]
    ds_read_b64_tr_b16 a[78:79], v4 offset:38048
    v_mfma_f32_16x16x32_bf16 v[60:63], a[40:43], v[192:195], v[60:63]
    ds_read_b128 v[228:231], v126 offset:0
    v_mfma_f32_16x16x32_bf16 v[64:67], a[44:47], v[192:195], v[64:67]
    s_add_u32 m0, s44, 18624
    v_mfma_f32_16x16x32_bf16 v[64:67], a[56:59], v[196:199], v[64:67]
    buffer_load_dwordx4 v7, s[12:15], s46 offen offset:0 lds
    v_mfma_f32_16x16x32_bf16 v[60:63], a[52:55], v[196:199], v[60:63]
    ds_read_b128 v[232:235], v126 offset:64
    ds_read_b64_tr_b16 a[80:81], v5 offset:37312
    v_mfma_f32_16x16x32_bf16 v[56:59], a[48:51], v[196:199], v[56:59]
    s_waitcnt lgkmcnt(7)
    v_xor_b32 v136, v136, v166
    v_xor_b32 v137, v137, v166
    v_mfma_f32_16x16x32_bf16 v[56:59], a[60:63], v[200:203], v[56:59]
    v_xor_b32 v138, v138, v166
    v_xor_b32 v139, v139, v166
    v_mfma_f32_16x16x32_bf16 v[60:63], a[64:67], v[200:203], v[60:63]
    ds_read_b128 v[236:239], v126 offset:128
    v_mfma_f32_16x16x32_bf16 v[64:67], a[68:71], v[200:203], v[64:67]
    ds_read_b64_tr_b16 a[82:83], v5 offset:38080
    ds_read_b64_tr_b16 a[84:85], v4 offset:43456
    v_mfma_f32_16x16x32_bf16 v[68:71], a[36:39], v[204:207], v[68:71]
    buffer_load_dwordx4 v7, s[12:15], s46 offen offset:1024 lds
    v_mfma_f32_16x16x32_bf16 v[72:75], a[40:43], v[204:207], v[72:75]
    ds_read_b128 v[240:243], v127 offset:0
    v_mfma_f32_16x16x32_bf16 v[76:79], a[44:47], v[204:207], v[76:79]
    v_lshlrev_b32_sdwa v128, 4, v136 dst_sel:DWORD dst_unused:UNUSED_PAD src0_sel:DWORD src1_sel:WORD_0
    v_lshlrev_b32_sdwa v129, 4, v138 dst_sel:DWORD dst_unused:UNUSED_PAD src0_sel:DWORD src1_sel:WORD_0
    v_mfma_f32_16x16x32_bf16 v[76:79], a[56:59], v[208:211], v[76:79]
    v_lshlrev_b32_sdwa v130, 4, v136 dst_sel:DWORD dst_unused:UNUSED_PAD src0_sel:DWORD src1_sel:WORD_1
    v_lshlrev_b32_sdwa v131, 4, v138 dst_sel:DWORD dst_unused:UNUSED_PAD src0_sel:DWORD src1_sel:WORD_1
    v_mfma_f32_16x16x32_bf16 v[72:75], a[52:55], v[208:211], v[72:75]
    ds_read_b128 v[244:247], v127 offset:64
    v_mfma_f32_16x16x32_bf16 v[68:71], a[48:51], v[208:211], v[68:71]
    ds_read_b64_tr_b16 a[86:87], v4 offset:44224
    v_mfma_f32_16x16x32_bf16 v[68:71], a[60:63], v[212:215], v[68:71]
    buffer_load_dwordx4 v7, s[12:15], s46 offen offset:2048 lds
    v_mfma_f32_16x16x32_bf16 v[72:75], a[64:67], v[212:215], v[72:75]
    ds_read_b128 v[248:251], v127 offset:128
    v_lshlrev_b32_sdwa v132, 4, v137 dst_sel:DWORD dst_unused:UNUSED_PAD src0_sel:DWORD src1_sel:WORD_0
    v_lshlrev_b32_sdwa v133, 4, v139 dst_sel:DWORD dst_unused:UNUSED_PAD src0_sel:DWORD src1_sel:WORD_0
    v_mfma_f32_16x16x32_bf16 v[76:79], a[68:71], v[212:215], v[76:79]
    ds_read_b64_tr_b16 a[88:89], v4 offset:43488
    v_mfma_f32_16x16x32_bf16 v[80:83], a[36:39], v[216:219], v[80:83]
    ds_read_b64_tr_b16 a[90:91], v4 offset:44256
    v_mfma_f32_16x16x32_bf16 v[84:87], a[40:43], v[216:219], v[84:87]
    ds_read_b128 v[180:183], v128 offset:0
    v_mfma_f32_16x16x32_bf16 v[88:91], a[44:47], v[216:219], v[88:91]
    s_add_u32 m0, s45, 18624
    v_mfma_f32_16x16x32_bf16 v[88:91], a[56:59], v[220:223], v[88:91]
    buffer_load_dwordx4 v26, s[12:15], s46 offen offset:0 lds
    v_mfma_f32_16x16x32_bf16 v[84:87], a[52:55], v[220:223], v[84:87]
    ds_read_b128 v[184:187], v128 offset:64
    v_mfma_f32_16x16x32_bf16 v[80:83], a[48:51], v[220:223], v[80:83]
    ds_read_b64_tr_b16 a[92:93], v5 offset:43520
    s_waitcnt lgkmcnt(7)
    v_mfma_f32_16x16x32_bf16 v[80:83], a[60:63], v[224:227], v[80:83]
    ds_read_b64_tr_b16 a[94:95], v5 offset:44288
    v_mfma_f32_16x16x32_bf16 v[84:87], a[64:67], v[224:227], v[84:87]
    ds_read_b128 v[188:191], v128 offset:128
    v_mfma_f32_16x16x32_bf16 v[88:91], a[68:71], v[224:227], v[88:91]
    ds_read_b64_tr_b16 a[96:97], v4 offset:49664
    v_mfma_f32_16x16x32_bf16 v[92:95], a[36:39], v[228:231], v[92:95]
    buffer_load_dwordx4 v26, s[12:15], s46 offen offset:1024 lds
    s_add_u32 s46, s46, 18432
    v_mfma_f32_16x16x32_bf16 v[96:99], a[40:43], v[228:231], v[96:99]
    ds_read_b128 v[192:195], v129 offset:0
    v_mfma_f32_16x16x32_bf16 v[100:103], a[44:47], v[228:231], v[100:103]
    ds_read_b64_tr_b16 a[98:99], v4 offset:50432
    v_mfma_f32_16x16x32_bf16 v[100:103], a[56:59], v[232:235], v[100:103]
    ds_read_b64_tr_b16 a[100:101], v4 offset:49696
    v_mfma_f32_16x16x32_bf16 v[96:99], a[52:55], v[232:235], v[96:99]
    ds_read_b128 v[196:199], v129 offset:64
    v_mfma_f32_16x16x32_bf16 v[92:95], a[48:51], v[232:235], v[92:95]
    v_mfma_f32_16x16x32_bf16 v[92:95], a[60:63], v[236:239], v[92:95]
    ds_read_b64_tr_b16 a[102:103], v4 offset:50464
    v_mfma_f32_16x16x32_bf16 v[96:99], a[64:67], v[236:239], v[96:99]
    ds_read_b128 v[200:203], v129 offset:128
    v_mfma_f32_16x16x32_bf16 v[100:103], a[68:71], v[236:239], v[100:103]
    ds_read_b64_tr_b16 a[104:105], v5 offset:49728
    v_mfma_f32_16x16x32_bf16 v[104:107], a[36:39], v[240:243], v[104:107]
    v_mfma_f32_16x16x32_bf16 v[108:111], a[40:43], v[240:243], v[108:111]
    ds_read_b128 v[204:207], v130 offset:0
    v_mfma_f32_16x16x32_bf16 v[112:115], a[44:47], v[240:243], v[112:115]
    ds_read_b64_tr_b16 a[106:107], v5 offset:50496
    v_mfma_f32_16x16x32_bf16 v[112:115], a[56:59], v[244:247], v[112:115]
    v_mfma_f32_16x16x32_bf16 v[108:111], a[52:55], v[244:247], v[108:111]
    ds_read_b128 v[208:211], v130 offset:64
    v_mfma_f32_16x16x32_bf16 v[104:107], a[48:51], v[244:247], v[104:107]
    s_waitcnt lgkmcnt(7)
    v_mfma_f32_16x16x32_bf16 v[104:107], a[60:63], v[248:251], v[104:107]
    v_mfma_f32_16x16x32_bf16 v[108:111], a[64:67], v[248:251], v[108:111]
    ds_read_b128 v[212:215], v130 offset:128
    v_mfma_f32_16x16x32_bf16 v[112:115], a[68:71], v[248:251], v[112:115]
    s_waitcnt vmcnt(5)
    s_waitcnt lgkmcnt(2)
    s_barrier
    v_mfma_f32_16x16x32_bf16 v[44:47], a[72:75], v[180:183], v[44:47]
    v_mfma_f32_16x16x32_bf16 v[48:51], a[76:79], v[180:183], v[48:51]
    ds_read_b128 v[216:219], v131 offset:0
    v_mfma_f32_16x16x32_bf16 v[52:55], a[80:83], v[180:183], v[52:55]
    ds_read_b64_tr_b16 a[108:109], v4 offset:0
    v_mfma_f32_16x16x32_bf16 v[52:55], a[92:95], v[184:187], v[52:55]
    ds_read_b128 v[136:139], v172 offset:768
    v_mfma_f32_16x16x32_bf16 v[48:51], a[88:91], v[184:187], v[48:51]
    ds_read_b128 v[220:223], v131 offset:64
    s_add_u32 m0, s44, 37248
    v_mfma_f32_16x16x32_bf16 v[44:47], a[84:87], v[184:187], v[44:47]
    buffer_load_dwordx4 v7, s[12:15], s46 offen offset:0 lds
    v_mfma_f32_16x16x32_bf16 v[44:47], a[96:99], v[188:191], v[44:47]
    ds_read_b64_tr_b16 a[110:111], v4 offset:768
    v_mfma_f32_16x16x32_bf16 v[48:51], a[100:103], v[188:191], v[48:51]
    ds_read_b128 v[224:227], v131 offset:128
    v_mfma_f32_16x16x32_bf16 v[52:55], a[104:107], v[188:191], v[52:55]
    ds_read_b64_tr_b16 a[112:113], v4 offset:32
    v_mfma_f32_16x16x32_bf16 v[56:59], a[72:75], v[192:195], v[56:59]
    ds_read_b64_tr_b16 a[114:115], v4 offset:800
    v_mfma_f32_16x16x32_bf16 v[60:63], a[76:79], v[192:195], v[60:63]
    ds_read_b128 v[228:231], v132 offset:0
    v_mfma_f32_16x16x32_bf16 v[64:67], a[80:83], v[192:195], v[64:67]
    s_waitcnt lgkmcnt(6)
    v_xor_b32 v136, v136, v166
    v_xor_b32 v137, v137, v166
    v_mfma_f32_16x16x32_bf16 v[64:67], a[92:95], v[196:199], v[64:67]
    buffer_load_dwordx4 v7, s[12:15], s46 offen offset:1024 lds
    v_mfma_f32_16x16x32_bf16 v[60:63], a[88:91], v[196:199], v[60:63]
    ds_read_b128 v[232:235], v132 offset:64
    v_mfma_f32_16x16x32_bf16 v[56:59], a[84:87], v[196:199], v[56:59]
    v_xor_b32 v138, v138, v166
    v_xor_b32 v139, v139, v166
    v_mfma_f32_16x16x32_bf16 v[56:59], a[96:99], v[200:203], v[56:59]
    ds_read_b64_tr_b16 a[116:117], v5 offset:64
    v_mfma_f32_16x16x32_bf16 v[60:63], a[100:103], v[200:203], v[60:63]
    ds_read_b128 v[236:239], v132 offset:128
    v_mfma_f32_16x16x32_bf16 v[64:67], a[104:107], v[200:203], v[64:67]
    ds_read_b64_tr_b16 a[118:119], v5 offset:832
    ds_read_b64_tr_b16 a[120:121], v4 offset:6208
    v_mfma_f32_16x16x32_bf16 v[68:71], a[72:75], v[204:207], v[68:71]
    v_lshlrev_b32_sdwa v116, 4, v136 dst_sel:DWORD dst_unused:UNUSED_PAD src0_sel:DWORD src1_sel:WORD_0
    v_lshlrev_b32_sdwa v117, 4, v138 dst_sel:DWORD dst_unused:UNUSED_PAD src0_sel:DWORD src1_sel:WORD_0
    v_mfma_f32_16x16x32_bf16 v[72:75], a[76:79], v[204:207], v[72:75]
    ds_read_b128 v[240:243], v133 offset:0
    v_mfma_f32_16x16x32_bf16 v[76:79], a[80:83], v[204:207], v[76:79]
    buffer_load_dwordx4 v7, s[12:15], s46 offen offset:2048 lds
    v_mfma_f32_16x16x32_bf16 v[76:79], a[92:95], v[208:211], v[76:79]
    v_lshlrev_b32_sdwa v118, 4, v136 dst_sel:DWORD dst_unused:UNUSED_PAD src0_sel:DWORD src1_sel:WORD_1
    v_lshlrev_b32_sdwa v119, 4, v138 dst_sel:DWORD dst_unused:UNUSED_PAD src0_sel:DWORD src1_sel:WORD_1
    v_mfma_f32_16x16x32_bf16 v[72:75], a[88:91], v[208:211], v[72:75]
    ds_read_b128 v[244:247], v133 offset:64
    v_mfma_f32_16x16x32_bf16 v[68:71], a[84:87], v[208:211], v[68:71]
    ds_read_b64_tr_b16 a[122:123], v4 offset:6976
    v_mfma_f32_16x16x32_bf16 v[68:71], a[96:99], v[212:215], v[68:71]
    v_lshlrev_b32_sdwa v120, 4, v137 dst_sel:DWORD dst_unused:UNUSED_PAD src0_sel:DWORD src1_sel:WORD_0
    v_lshlrev_b32_sdwa v121, 4, v139 dst_sel:DWORD dst_unused:UNUSED_PAD src0_sel:DWORD src1_sel:WORD_0
    v_mfma_f32_16x16x32_bf16 v[72:75], a[100:103], v[212:215], v[72:75]
    ds_read_b128 v[248:251], v133 offset:128
    v_mfma_f32_16x16x32_bf16 v[76:79], a[104:107], v[212:215], v[76:79]
    ds_read_b64_tr_b16 a[124:125], v4 offset:6240
    v_mfma_f32_16x16x32_bf16 v[80:83], a[72:75], v[216:219], v[80:83]
    ds_read_b64_tr_b16 a[126:127], v4 offset:7008
    v_mfma_f32_16x16x32_bf16 v[84:87], a[76:79], v[216:219], v[84:87]
    ds_read_b128 v[180:183], v116 offset:0
    s_add_u32 m0, s45, 37248
    v_mfma_f32_16x16x32_bf16 v[88:91], a[80:83], v[216:219], v[88:91]
    buffer_load_dwordx4 v26, s[12:15], s46 offen offset:0 lds
    s_waitcnt lgkmcnt(7)
    v_mfma_f32_16x16x32_bf16 v[88:91], a[92:95], v[220:223], v[88:91]
    ds_read_b64_tr_b16 a[128:129], v5 offset:6272
    v_mfma_f32_16x16x32_bf16 v[84:87], a[88:91], v[220:223], v[84:87]
    ds_read_b128 v[184:187], v116 offset:64
    v_mfma_f32_16x16x32_bf16 v[80:83], a[84:87], v[220:223], v[80:83]
    ds_read_b64_tr_b16 a[130:131], v5 offset:7040
    v_mfma_f32_16x16x32_bf16 v[80:83], a[96:99], v[224:227], v[80:83]
    v_mfma_f32_16x16x32_bf16 v[84:87], a[100:103], v[224:227], v[84:87]
    ds_read_b128 v[188:191], v116 offset:128
    v_mfma_f32_16x16x32_bf16 v[88:91], a[104:107], v[224:227], v[88:91]
    ds_read_b64_tr_b16 a[132:133], v4 offset:12416
    v_mfma_f32_16x16x32_bf16 v[92:95], a[72:75], v[228:231], v[92:95]
    buffer_load_dwordx4 v26, s[12:15], s46 offen offset:1024 lds
    s_add_u32 s46, s46, 18432
    v_mfma_f32_16x16x32_bf16 v[96:99], a[76:79], v[228:231], v[96:99]
    ds_read_b128 v[192:195], v117 offset:0
    v_mfma_f32_16x16x32_bf16 v[100:103], a[80:83], v[228:231], v[100:103]
    ds_read_b64_tr_b16 a[134:135], v4 offset:13184
    v_mfma_f32_16x16x32_bf16 v[100:103], a[92:95], v[232:235], v[100:103]
    ds_read_b64_tr_b16 a[136:137], v4 offset:12448
    v_mfma_f32_16x16x32_bf16 v[96:99], a[88:91], v[232:235], v[96:99]
    ds_read_b128 v[196:199], v117 offset:64
    v_mfma_f32_16x16x32_bf16 v[92:95], a[84:87], v[232:235], v[92:95]
    v_mfma_f32_16x16x32_bf16 v[92:95], a[96:99], v[236:239], v[92:95]
    ds_read_b64_tr_b16 a[138:139], v4 offset:13216
    v_mfma_f32_16x16x32_bf16 v[96:99], a[100:103], v[236:239], v[96:99]
    ds_read_b128 v[200:203], v117 offset:128
    v_mfma_f32_16x16x32_bf16 v[100:103], a[104:107], v[236:239], v[100:103]
    ds_read_b64_tr_b16 a[140:141], v5 offset:12480
    s_waitcnt lgkmcnt(7)
    v_mfma_f32_16x16x32_bf16 v[104:107], a[72:75], v[240:243], v[104:107]
    v_mfma_f32_16x16x32_bf16 v[108:111], a[76:79], v[240:243], v[108:111]
    ds_read_b128 v[204:207], v118 offset:0
    v_mfma_f32_16x16x32_bf16 v[112:115], a[80:83], v[240:243], v[112:115]
    ds_read_b64_tr_b16 a[142:143], v5 offset:13248
    v_mfma_f32_16x16x32_bf16 v[112:115], a[92:95], v[244:247], v[112:115]
    v_mfma_f32_16x16x32_bf16 v[108:111], a[88:91], v[244:247], v[108:111]
    ds_read_b128 v[208:211], v118 offset:64
    v_mfma_f32_16x16x32_bf16 v[104:107], a[84:87], v[244:247], v[104:107]
    v_mfma_f32_16x16x32_bf16 v[104:107], a[96:99], v[248:251], v[104:107]
    v_mfma_f32_16x16x32_bf16 v[108:111], a[100:103], v[248:251], v[108:111]
    ds_read_b128 v[212:215], v118 offset:128
    v_mfma_f32_16x16x32_bf16 v[112:115], a[104:107], v[248:251], v[112:115]
    s_waitcnt vmcnt(5)
    s_waitcnt lgkmcnt(2)
    s_barrier
    v_mfma_f32_16x16x32_bf16 v[44:47], a[108:111], v[180:183], v[44:47]
    v_mfma_f32_16x16x32_bf16 v[48:51], a[112:115], v[180:183], v[48:51]
    ds_read_b128 v[216:219], v119 offset:0
    v_mfma_f32_16x16x32_bf16 v[52:55], a[116:119], v[180:183], v[52:55]
    ds_read_b64_tr_b16 a[0:1], v4 offset:18624
    v_mfma_f32_16x16x32_bf16 v[52:55], a[128:131], v[184:187], v[52:55]
    ds_read_b128 v[136:139], v172 offset:1024
    v_mfma_f32_16x16x32_bf16 v[48:51], a[124:127], v[184:187], v[48:51]
    ds_read_b128 v[220:223], v119 offset:64
    s_add_u32 m0, s44, 0
    v_mfma_f32_16x16x32_bf16 v[44:47], a[120:123], v[184:187], v[44:47]
    buffer_load_dwordx4 v7, s[12:15], s46 offen offset:0 lds
    v_mfma_f32_16x16x32_bf16 v[44:47], a[132:135], v[188:191], v[44:47]
    ds_read_b64_tr_b16 a[2:3], v4 offset:19392
    v_mfma_f32_16x16x32_bf16 v[48:51], a[136:139], v[188:191], v[48:51]
    ds_read_b128 v[224:227], v119 offset:128
    v_mfma_f32_16x16x32_bf16 v[52:55], a[140:143], v[188:191], v[52:55]
    ds_read_b64_tr_b16 a[4:5], v4 offset:18656
    v_mfma_f32_16x16x32_bf16 v[56:59], a[108:111], v[192:195], v[56:59]
    ds_read_b64_tr_b16 a[6:7], v4 offset:19424
    v_mfma_f32_16x16x32_bf16 v[60:63], a[112:115], v[192:195], v[60:63]
    ds_read_b128 v[228:231], v120 offset:0
    v_mfma_f32_16x16x32_bf16 v[64:67], a[116:119], v[192:195], v[64:67]
    s_waitcnt lgkmcnt(6)
    v_xor_b32 v136, v136, v166
    v_xor_b32 v137, v137, v166
    v_mfma_f32_16x16x32_bf16 v[64:67], a[128:131], v[196:199], v[64:67]
    buffer_load_dwordx4 v7, s[12:15], s46 offen offset:1024 lds
    v_mfma_f32_16x16x32_bf16 v[60:63], a[124:127], v[196:199], v[60:63]
    ds_read_b128 v[232:235], v120 offset:64
    v_mfma_f32_16x16x32_bf16 v[56:59], a[120:123], v[196:199], v[56:59]
    v_xor_b32 v138, v138, v166
    v_xor_b32 v139, v139, v166
    v_mfma_f32_16x16x32_bf16 v[56:59], a[132:135], v[200:203], v[56:59]
    ds_read_b64_tr_b16 a[8:9], v5 offset:18688
    v_mfma_f32_16x16x32_bf16 v[60:63], a[136:139], v[200:203], v[60:63]
    ds_read_b128 v[236:239], v120 offset:128
    v_mfma_f32_16x16x32_bf16 v[64:67], a[140:143], v[200:203], v[64:67]
    ds_read_b64_tr_b16 a[10:11], v5 offset:19456
    ds_read_b64_tr_b16 a[12:13], v4 offset:24832
    v_mfma_f32_16x16x32_bf16 v[68:71], a[108:111], v[204:207], v[68:71]
    v_lshlrev_b32_sdwa v122, 4, v136 dst_sel:DWORD dst_unused:UNUSED_PAD src0_sel:DWORD src1_sel:WORD_0
    v_lshlrev_b32_sdwa v123, 4, v138 dst_sel:DWORD dst_unused:UNUSED_PAD src0_sel:DWORD src1_sel:WORD_0
    v_mfma_f32_16x16x32_bf16 v[72:75], a[112:115], v[204:207], v[72:75]
    ds_read_b128 v[240:243], v121 offset:0
    v_mfma_f32_16x16x32_bf16 v[76:79], a[116:119], v[204:207], v[76:79]
    buffer_load_dwordx4 v7, s[12:15], s46 offen offset:2048 lds
    v_mfma_f32_16x16x32_bf16 v[76:79], a[128:131], v[208:211], v[76:79]
    v_lshlrev_b32_sdwa v124, 4, v136 dst_sel:DWORD dst_unused:UNUSED_PAD src0_sel:DWORD src1_sel:WORD_1
    v_lshlrev_b32_sdwa v125, 4, v138 dst_sel:DWORD dst_unused:UNUSED_PAD src0_sel:DWORD src1_sel:WORD_1
    v_mfma_f32_16x16x32_bf16 v[72:75], a[124:127], v[208:211], v[72:75]
    ds_read_b128 v[244:247], v121 offset:64
    v_mfma_f32_16x16x32_bf16 v[68:71], a[120:123], v[208:211], v[68:71]
    ds_read_b64_tr_b16 a[14:15], v4 offset:25600
    v_mfma_f32_16x16x32_bf16 v[68:71], a[132:135], v[212:215], v[68:71]
    v_lshlrev_b32_sdwa v126, 4, v137 dst_sel:DWORD dst_unused:UNUSED_PAD src0_sel:DWORD src1_sel:WORD_0
    v_lshlrev_b32_sdwa v127, 4, v139 dst_sel:DWORD dst_unused:UNUSED_PAD src0_sel:DWORD src1_sel:WORD_0
    v_mfma_f32_16x16x32_bf16 v[72:75], a[136:139], v[212:215], v[72:75]
    ds_read_b128 v[248:251], v121 offset:128
    v_mfma_f32_16x16x32_bf16 v[76:79], a[140:143], v[212:215], v[76:79]
    ds_read_b64_tr_b16 a[16:17], v4 offset:24864
    v_mfma_f32_16x16x32_bf16 v[80:83], a[108:111], v[216:219], v[80:83]
    ds_read_b64_tr_b16 a[18:19], v4 offset:25632
    v_mfma_f32_16x16x32_bf16 v[84:87], a[112:115], v[216:219], v[84:87]
    ds_read_b128 v[180:183], v122 offset:0
    s_add_u32 m0, s45, 0
    v_mfma_f32_16x16x32_bf16 v[88:91], a[116:119], v[216:219], v[88:91]
    buffer_load_dwordx4 v26, s[12:15], s46 offen offset:0 lds
    s_waitcnt lgkmcnt(7)
    v_mfma_f32_16x16x32_bf16 v[88:91], a[128:131], v[220:223], v[88:91]
    ds_read_b64_tr_b16 a[20:21], v5 offset:24896
    s_mul_i32 s47, s30, 6656
    v_mfma_f32_16x16x32_bf16 v[84:87], a[124:127], v[220:223], v[84:87]
    ds_read_b128 v[184:187], v122 offset:64
    v_mfma_f32_16x16x32_bf16 v[80:83], a[120:123], v[220:223], v[80:83]
    ds_read_b64_tr_b16 a[22:23], v5 offset:25664
    v_mfma_f32_16x16x32_bf16 v[80:83], a[132:135], v[224:227], v[80:83]
    v_lshrrev_b32 v38, 4, v6
    s_add_u32 s47, s47, 123744
    v_mfma_f32_16x16x32_bf16 v[84:87], a[136:139], v[224:227], v[84:87]
    ds_read_b128 v[188:191], v122 offset:128
    v_mfma_f32_16x16x32_bf16 v[88:91], a[140:143], v[224:227], v[88:91]
    ds_read_b64_tr_b16 a[24:25], v4 offset:31040
    v_mul_u32_u24 v39, 43, v38
    v_mfma_f32_16x16x32_bf16 v[92:95], a[108:111], v[228:231], v[92:95]
    buffer_load_dwordx4 v26, s[12:15], s46 offen offset:1024 lds
    s_add_u32 s46, s46, 18432
    v_mfma_f32_16x16x32_bf16 v[96:99], a[112:115], v[228:231], v[96:99]
    ds_read_b128 v[192:195], v123 offset:0
    v_add_u32 v40, 128, v38
    v_mfma_f32_16x16x32_bf16 v[100:103], a[116:119], v[228:231], v[100:103]
    ds_read_b64_tr_b16 a[26:27], v4 offset:31808
    v_mfma_f32_16x16x32_bf16 v[100:103], a[128:131], v[232:235], v[100:103]
    ds_read_b64_tr_b16 a[28:29], v4 offset:31072
    v_mfma_f32_16x16x32_bf16 v[96:99], a[124:127], v[232:235], v[96:99]
    ds_read_b128 v[196:199], v123 offset:64
    v_mfma_f32_16x16x32_bf16 v[92:95], a[120:123], v[232:235], v[92:95]
    s_lshl_b32 s48, s29, 3
    v_lshrrev_b32 v39, 9, v39
    v_mfma_f32_16x16x32_bf16 v[92:95], a[132:135], v[236:239], v[92:95]
    ds_read_b64_tr_b16 a[30:31], v4 offset:31840
    v_mfma_f32_16x16x32_bf16 v[96:99], a[136:139], v[236:239], v[96:99]
    ds_read_b128 v[200:203], v123 offset:128
    v_mfma_f32_16x16x32_bf16 v[100:103], a[140:143], v[236:239], v[100:103]
    ds_read_b64_tr_b16 a[32:33], v5 offset:31104
    s_waitcnt lgkmcnt(7)
    v_mfma_f32_16x16x32_bf16 v[104:107], a[108:111], v[240:243], v[104:107]
    v_mul_u32_u24 v41, 2731, v40
    v_mfma_f32_16x16x32_bf16 v[108:111], a[112:115], v[240:243], v[108:111]
    ds_read_b128 v[204:207], v124 offset:0
    v_mfma_f32_16x16x32_bf16 v[112:115], a[116:119], v[240:243], v[112:115]
    ds_read_b64_tr_b16 a[34:35], v5 offset:31872
    v_mfma_f32_16x16x32_bf16 v[112:115], a[128:131], v[244:247], v[112:115]
    v_mad_i32_i24 v38, v39, -12, v38
    v_lshrrev_b32 v41, 16, v41
    v_mfma_f32_16x16x32_bf16 v[108:111], a[124:127], v[244:247], v[108:111]
    ds_read_b128 v[208:211], v124 offset:64
    v_mfma_f32_16x16x32_bf16 v[104:107], a[120:123], v[244:247], v[104:107]
    v_add_u32 v39, s48, v39
    v_mfma_f32_16x16x32_bf16 v[104:107], a[132:135], v[248:251], v[104:107]
    v_mfma_f32_16x16x32_bf16 v[108:111], a[136:139], v[248:251], v[108:111]
    ds_read_b128 v[212:215], v124 offset:128
    v_mfma_f32_16x16x32_bf16 v[112:115], a[140:143], v[248:251], v[112:115]
    s_waitcnt vmcnt(5)
    s_waitcnt lgkmcnt(2)
    s_barrier
    v_mul_u32_u24 v42, 24, v41
    v_mfma_f32_16x16x32_bf16 v[44:47], a[0:3], v[180:183], v[44:47]
    v_mul_u32_u24 v22, 208, v39
    v_mfma_f32_16x16x32_bf16 v[48:51], a[4:7], v[180:183], v[48:51]
    ds_read_b128 v[216:219], v125 offset:0
    v_mfma_f32_16x16x32_bf16 v[52:55], a[8:11], v[180:183], v[52:55]
    ds_read_b64_tr_b16 a[36:37], v4 offset:37248
    v_sub_u32 v40, v40, v42
    v_mfma_f32_16x16x32_bf16 v[52:55], a[20:23], v[184:187], v[52:55]
    ds_read_b128 v[136:139], v172 offset:1280
    v_mfma_f32_16x16x32_bf16 v[48:51], a[16:19], v[184:187], v[48:51]
    ds_read_b128 v[220:223], v125 offset:64
    s_add_u32 m0, s44, 18624
    v_mfma_f32_16x16x32_bf16 v[44:47], a[12:15], v[184:187], v[44:47]
    buffer_load_dwordx4 v7, s[12:15], s46 offen offset:0 lds
    v_mfma_f32_16x16x32_bf16 v[44:47], a[24:27], v[188:191], v[44:47]
    ds_read_b64_tr_b16 a[38:39], v4 offset:38016
    v_add_u32 v41, s48, v41
    v_mfma_f32_16x16x32_bf16 v[48:51], a[28:31], v[188:191], v[48:51]
    ds_read_b128 v[224:227], v125 offset:128
    v_mul_u32_u24 v24, s2, v39
    v_mfma_f32_16x16x32_bf16 v[52:55], a[32:35], v[188:191], v[52:55]
    ds_read_b64_tr_b16 a[40:41], v4 offset:37280
    v_lshlrev_b32 v38, 4, v38
    v_mfma_f32_16x16x32_bf16 v[56:59], a[0:3], v[192:195], v[56:59]
    ds_read_b64_tr_b16 a[42:43], v4 offset:38048
    v_mfma_f32_16x16x32_bf16 v[60:63], a[4:7], v[192:195], v[60:63]
    ds_read_b128 v[228:231], v126 offset:0
    v_mfma_f32_16x16x32_bf16 v[64:67], a[8:11], v[192:195], v[64:67]
    s_waitcnt lgkmcnt(6)
    v_xor_b32 v136, v136, v166
    v_xor_b32 v137, v137, v166
    v_mfma_f32_16x16x32_bf16 v[64:67], a[20:23], v[196:199], v[64:67]
    buffer_load_dwordx4 v7, s[12:15], s46 offen offset:1024 lds
    v_mfma_f32_16x16x32_bf16 v[60:63], a[16:19], v[196:199], v[60:63]
    ds_read_b128 v[232:235], v126 offset:64
    v_mul_u32_u24 v23, 208, v41
    v_mfma_f32_16x16x32_bf16 v[56:59], a[12:15], v[196:199], v[56:59]
    v_xor_b32 v138, v138, v166
    v_xor_b32 v139, v139, v166
    v_mfma_f32_16x16x32_bf16 v[56:59], a[24:27], v[200:203], v[56:59]
    ds_read_b64_tr_b16 a[44:45], v5 offset:37312
    v_mul_u32_u24 v25, s2, v41
    v_mfma_f32_16x16x32_bf16 v[60:63], a[28:31], v[200:203], v[60:63]
    ds_read_b128 v[236:239], v126 offset:128
    v_lshlrev_b32 v40, 3, v40
    v_mfma_f32_16x16x32_bf16 v[64:67], a[32:35], v[200:203], v[64:67]
    ds_read_b64_tr_b16 a[46:47], v5 offset:38080
    ds_read_b64_tr_b16 a[48:49], v4 offset:43456
    v_mfma_f32_16x16x32_bf16 v[68:71], a[0:3], v[204:207], v[68:71]
    v_lshlrev_b32_sdwa v128, 4, v136 dst_sel:DWORD dst_unused:UNUSED_PAD src0_sel:DWORD src1_sel:WORD_0
    v_lshlrev_b32_sdwa v129, 4, v138 dst_sel:DWORD dst_unused:UNUSED_PAD src0_sel:DWORD src1_sel:WORD_0
    v_mfma_f32_16x16x32_bf16 v[72:75], a[4:7], v[204:207], v[72:75]
    ds_read_b128 v[240:243], v127 offset:0
    v_add3_u32 v22, v22, s47, v38
    v_mfma_f32_16x16x32_bf16 v[76:79], a[8:11], v[204:207], v[76:79]
    buffer_load_dwordx4 v7, s[12:15], s46 offen offset:2048 lds
    v_mfma_f32_16x16x32_bf16 v[76:79], a[20:23], v[208:211], v[76:79]
    v_lshlrev_b32_sdwa v130, 4, v136 dst_sel:DWORD dst_unused:UNUSED_PAD src0_sel:DWORD src1_sel:WORD_1
    v_lshlrev_b32_sdwa v131, 4, v138 dst_sel:DWORD dst_unused:UNUSED_PAD src0_sel:DWORD src1_sel:WORD_1
    v_mfma_f32_16x16x32_bf16 v[72:75], a[16:19], v[208:211], v[72:75]
    ds_read_b128 v[244:247], v127 offset:64
    v_add_u32 v24, v24, v38
    v_mfma_f32_16x16x32_bf16 v[68:71], a[12:15], v[208:211], v[68:71]
    ds_read_b64_tr_b16 a[50:51], v4 offset:44224
    v_add3_u32 v23, v23, s47, v40
    v_mfma_f32_16x16x32_bf16 v[68:71], a[24:27], v[212:215], v[68:71]
    v_lshlrev_b32_sdwa v132, 4, v137 dst_sel:DWORD dst_unused:UNUSED_PAD src0_sel:DWORD src1_sel:WORD_0
    v_lshlrev_b32_sdwa v133, 4, v139 dst_sel:DWORD dst_unused:UNUSED_PAD src0_sel:DWORD src1_sel:WORD_0
    v_mfma_f32_16x16x32_bf16 v[72:75], a[28:31], v[212:215], v[72:75]
    ds_read_b128 v[248:251], v127 offset:128
    v_add_u32 v25, v25, v40
    v_mfma_f32_16x16x32_bf16 v[76:79], a[32:35], v[212:215], v[76:79]
    ds_read_b64_tr_b16 a[52:53], v4 offset:43488
    v_bfe_u32 v38, v6, 4, 2
    v_mfma_f32_16x16x32_bf16 v[80:83], a[0:3], v[216:219], v[80:83]
    ds_read_b64_tr_b16 a[54:55], v4 offset:44256
    v_mfma_f32_16x16x32_bf16 v[84:87], a[4:7], v[216:219], v[84:87]
    ds_read_b128 v[180:183], v128 offset:0
    s_add_u32 m0, s45, 18624
    v_mfma_f32_16x16x32_bf16 v[88:91], a[8:11], v[216:219], v[88:91]
    buffer_load_dwordx4 v26, s[12:15], s46 offen offset:0 lds
    s_waitcnt lgkmcnt(7)
    v_mfma_f32_16x16x32_bf16 v[88:91], a[20:23], v[220:223], v[88:91]
    ds_read_b64_tr_b16 a[56:57], v5 offset:43520
    v_bfe_u32 v39, v6, 6, 2
    v_mfma_f32_16x16x32_bf16 v[84:87], a[16:19], v[220:223], v[84:87]
    ds_read_b128 v[184:187], v128 offset:64
    v_mfma_f32_16x16x32_bf16 v[80:83], a[12:15], v[220:223], v[80:83]
    ds_read_b64_tr_b16 a[58:59], v5 offset:44288
    v_mfma_f32_16x16x32_bf16 v[80:83], a[24:27], v[224:227], v[80:83]
    v_lshl_add_u32 v38, v38, 2, v39
    v_lshrrev_b32 v39, 8, v6
    v_mfma_f32_16x16x32_bf16 v[84:87], a[28:31], v[224:227], v[84:87]
    ds_read_b128 v[188:191], v128 offset:128
    v_mul_u32_u24 v38, 208, v38
    v_mfma_f32_16x16x32_bf16 v[88:91], a[32:35], v[224:227], v[88:91]
    ds_read_b64_tr_b16 a[60:61], v4 offset:49664
    v_mfma_f32_16x16x32_bf16 v[92:95], a[0:3], v[228:231], v[92:95]
    buffer_load_dwordx4 v26, s[12:15], s46 offen offset:1024 lds
    s_add_u32 s46, s46, 18432
    v_mfma_f32_16x16x32_bf16 v[96:99], a[4:7], v[228:231], v[96:99]
    ds_read_b128 v[192:195], v129 offset:0
    s_lshl4_add_u32 s49, s48, s47
    v_mfma_f32_16x16x32_bf16 v[100:103], a[8:11], v[228:231], v[100:103]
    ds_read_b64_tr_b16 a[62:63], v4 offset:50432
    v_mfma_f32_16x16x32_bf16 v[100:103], a[20:23], v[232:235], v[100:103]
    ds_read_b64_tr_b16 a[64:65], v4 offset:49696
    v_mfma_f32_16x16x32_bf16 v[96:99], a[16:19], v[232:235], v[96:99]
    ds_read_b128 v[196:199], v129 offset:64
    v_mfma_f32_16x16x32_bf16 v[92:95], a[12:15], v[232:235], v[92:95]
    v_lshl_add_u32 v38, v39, 3, v38
    s_lshl2_add_u32 s48, s48, s47
    v_mfma_f32_16x16x32_bf16 v[92:95], a[24:27], v[236:239], v[92:95]
    ds_read_b64_tr_b16 a[66:67], v4 offset:50464
    v_mfma_f32_16x16x32_bf16 v[96:99], a[28:31], v[236:239], v[96:99]
    ds_read_b128 v[200:203], v129 offset:128
    v_mfma_f32_16x16x32_bf16 v[100:103], a[32:35], v[236:239], v[100:103]
    ds_read_b64_tr_b16 a[68:69], v5 offset:49728
    s_waitcnt lgkmcnt(7)
    v_mfma_f32_16x16x32_bf16 v[104:107], a[0:3], v[240:243], v[104:107]
    v_add_u32 v20, s49, v38
    v_add_u32 v21, s48, v38
    s_branch L_Pa_s1
L_Pa_t1:
    s_setpc_b64 s[78:79]
L_Pa_s1:
    v_mfma_f32_16x16x32_bf16 v[108:111], a[4:7], v[240:243], v[108:111]
    ds_read_b128 v[204:207], v130 offset:0
    v_mfma_f32_16x16x32_bf16 v[112:115], a[8:11], v[240:243], v[112:115]
    ds_read_b64_tr_b16 a[70:71], v5 offset:50496
    v_mfma_f32_16x16x32_bf16 v[112:115], a[20:23], v[244:247], v[112:115]
    v_mfma_f32_16x16x32_bf16 v[108:111], a[16:19], v[244:247], v[108:111]
    ds_read_b128 v[208:211], v130 offset:64
    v_mfma_f32_16x16x32_bf16 v[104:107], a[12:15], v[244:247], v[104:107]
    v_mfma_f32_16x16x32_bf16 v[104:107], a[24:27], v[248:251], v[104:107]
    v_mfma_f32_16x16x32_bf16 v[108:111], a[28:31], v[248:251], v[108:111]
    ds_read_b128 v[212:215], v130 offset:128
    v_mfma_f32_16x16x32_bf16 v[112:115], a[32:35], v[248:251], v[112:115]
    s_waitcnt vmcnt(5)
    s_waitcnt lgkmcnt(2)
    s_barrier
    v_mfma_f32_16x16x32_bf16 v[44:47], a[36:39], v[180:183], v[44:47]
    ds_read_b64_tr_b16 a[72:73], v4 offset:0
    v_mfma_f32_16x16x32_bf16 v[48:51], a[40:43], v[180:183], v[48:51]
    ds_read_b128 v[216:219], v131 offset:0
    s_add_u32 m0, s44, 37248
    v_mfma_f32_16x16x32_bf16 v[52:55], a[44:47], v[180:183], v[52:55]
    buffer_load_dwordx4 v7, s[12:15], s46 offen offset:0 lds
    v_mfma_f32_16x16x32_bf16 v[52:55], a[56:59], v[184:187], v[52:55]
    ds_read_b128 v[136:139], v172 offset:1536
    ds_read_b64_tr_b16 a[74:75], v4 offset:768
    v_mfma_f32_16x16x32_bf16 v[48:51], a[52:55], v[184:187], v[48:51]
    ds_read_b128 v[220:223], v131 offset:64
    ds_read_b64_tr_b16 a[76:77], v4 offset:32
    v_mfma_f32_16x16x32_bf16 v[44:47], a[48:51], v[184:187], v[44:47]
    ds_read_b64_tr_b16 a[78:79], v4 offset:800
    v_mfma_f32_16x16x32_bf16 v[44:47], a[60:63], v[188:191], v[44:47]
    ds_read_b64_tr_b16 a[80:81], v5 offset:64
    ds_read_b64_tr_b16 a[82:83], v5 offset:832
    v_mfma_f32_16x16x32_bf16 v[48:51], a[64:67], v[188:191], v[48:51]
    ds_read_b128 v[224:227], v131 offset:128
    v_mfma_f32_16x16x32_bf16 v[52:55], a[68:71], v[188:191], v[52:55]
    buffer_load_dwordx4 v7, s[12:15], s46 offen offset:1024 lds
    v_mfma_f32_16x16x32_bf16 v[56:59], a[36:39], v[192:195], v[56:59]
    ds_read_b64_tr_b16 a[84:85], v4 offset:6208
    ds_read_b64_tr_b16 a[86:87], v4 offset:6976
    v_mfma_f32_16x16x32_bf16 v[60:63], a[40:43], v[192:195], v[60:63]
    ds_read_b128 v[228:231], v132 offset:0
    ds_read_b64_tr_b16 a[88:89], v4 offset:6240
    v_mfma_f32_16x16x32_bf16 v[64:67], a[44:47], v[192:195], v[64:67]
    s_waitcnt lgkmcnt(7)
    v_xor_b32 v136, v136, v166
    v_xor_b32 v137, v137, v166
    v_mfma_f32_16x16x32_bf16 v[64:67], a[56:59], v[196:199], v[64:67]
    buffer_load_dwordx4 v7, s[12:15], s46 offen offset:2048 lds
    v_mfma_f32_16x16x32_bf16 v[60:63], a[52:55], v[196:199], v[60:63]
    ds_read_b128 v[232:235], v132 offset:64
    ds_read_b64_tr_b16 a[90:91], v4 offset:7008
    v_mfma_f32_16x16x32_bf16 v[56:59], a[48:51], v[196:199], v[56:59]
    v_xor_b32 v138, v138, v166
    v_xor_b32 v139, v139, v166
    ds_read_b64_tr_b16 a[92:93], v5 offset:6272
    v_mfma_f32_16x16x32_bf16 v[56:59], a[60:63], v[200:203], v[56:59]
    ds_read_b64_tr_b16 a[94:95], v5 offset:7040
    ds_read_b64_tr_b16 a[96:97], v4 offset:12416
    v_mfma_f32_16x16x32_bf16 v[60:63], a[64:67], v[200:203], v[60:63]
    ds_read_b128 v[236:239], v132 offset:128
    s_add_u32 m0, s45, 37248
    v_mfma_f32_16x16x32_bf16 v[64:67], a[68:71], v[200:203], v[64:67]
    buffer_load_dwordx4 v26, s[12:15], s46 offen offset:0 lds
    ds_read_b64_tr_b16 a[98:99], v4 offset:13184
    v_mfma_f32_16x16x32_bf16 v[68:71], a[36:39], v[204:207], v[68:71]
    v_lshlrev_b32_sdwa v116, 4, v136 dst_sel:DWORD dst_unused:UNUSED_PAD src0_sel:DWORD src1_sel:WORD_0
    v_lshlrev_b32_sdwa v117, 4, v138 dst_sel:DWORD dst_unused:UNUSED_PAD src0_sel:DWORD src1_sel:WORD_0
    v_mfma_f32_16x16x32_bf16 v[72:75], a[40:43], v[204:207], v[72:75]
    ds_read_b128 v[240:243], v133 offset:0
    ds_read_b64_tr_b16 a[100:101], v4 offset:12448
    v_mfma_f32_16x16x32_bf16 v[76:79], a[44:47], v[204:207], v[76:79]
    ds_read_b64_tr_b16 a[102:103], v4 offset:13216
    ds_read_b64_tr_b16 a[104:105], v5 offset:12480
    v_mfma_f32_16x16x32_bf16 v[76:79], a[56:59], v[208:211], v[76:79]
    v_lshlrev_b32_sdwa v118, 4, v136 dst_sel:DWORD dst_unused:UNUSED_PAD src0_sel:DWORD src1_sel:WORD_1
    v_lshlrev_b32_sdwa v119, 4, v138 dst_sel:DWORD dst_unused:UNUSED_PAD src0_sel:DWORD src1_sel:WORD_1
    ds_read_b64_tr_b16 a[106:107], v5 offset:13248
    v_mfma_f32_16x16x32_bf16 v[72:75], a[52:55], v[208:211], v[72:75]
    ds_read_b128 v[244:247], v133 offset:64
    v_mfma_f32_16x16x32_bf16 v[68:71], a[48:51], v[208:211], v[68:71]
    buffer_load_dwordx4 v26, s[12:15], s46 offen offset:1024 lds
    s_add_u32 s46, s46, 18432
    v_mfma_f32_16x16x32_bf16 v[68:71], a[60:63], v[212:215], v[68:71]
    v_lshlrev_b32_sdwa v120, 4, v137 dst_sel:DWORD dst_unused:UNUSED_PAD src0_sel:DWORD src1_sel:WORD_0
    v_lshlrev_b32_sdwa v121, 4, v139 dst_sel:DWORD dst_unused:UNUSED_PAD src0_sel:DWORD src1_sel:WORD_0
    v_mfma_f32_16x16x32_bf16 v[72:75], a[64:67], v[212:215], v[72:75]
    ds_read_b128 v[248:251], v133 offset:128
    v_mfma_f32_16x16x32_bf16 v[76:79], a[68:71], v[212:215], v[76:79]
    s_waitcnt vmcnt(5)
    s_waitcnt lgkmcnt(2)
    s_barrier
    v_mfma_f32_16x16x32_bf16 v[80:83], a[36:39], v[216:219], v[80:83]
    ds_read_b128 v[136:139], v172 offset:1792
    v_mfma_f32_16x16x32_bf16 v[84:87], a[40:43], v[216:219], v[84:87]
    ds_read_b128 v[180:183], v116 offset:0
    v_mfma_f32_16x16x32_bf16 v[88:91], a[44:47], v[216:219], v[88:91]
    ds_read_b64_tr_b16 a[108:109], v4 offset:18624
    v_mfma_f32_16x16x32_bf16 v[88:91], a[56:59], v[220:223], v[88:91]
    ds_read_b64_tr_b16 a[110:111], v4 offset:19392
    v_mfma_f32_16x16x32_bf16 v[84:87], a[52:55], v[220:223], v[84:87]
    ds_read_b128 v[184:187], v116 offset:64
    s_lshl_b32 s55, s55, 1
    v_mfma_f32_16x16x32_bf16 v[80:83], a[48:51], v[220:223], v[80:83]
    ds_read_b64_tr_b16 a[112:113], v4 offset:18656
    v_mfma_f32_16x16x32_bf16 v[80:83], a[60:63], v[224:227], v[80:83]
    ds_read_b64_tr_b16 a[114:115], v4 offset:19424
    v_mfma_f32_16x16x32_bf16 v[84:87], a[64:67], v[224:227], v[84:87]
    ds_read_b128 v[188:191], v116 offset:128
    s_mul_i32 s47, s30, 8064
    v_mfma_f32_16x16x32_bf16 v[88:91], a[68:71], v[224:227], v[88:91]
    s_waitcnt lgkmcnt(7)
    v_xor_b32 v136, v136, v166
    v_xor_b32 v137, v137, v166
    v_mfma_f32_16x16x32_bf16 v[92:95], a[36:39], v[228:231], v[92:95]
    ds_read_b64_tr_b16 a[116:117], v5 offset:18688
    ds_read_b64_tr_b16 a[118:119], v5 offset:19456
    v_mfma_f32_16x16x32_bf16 v[96:99], a[40:43], v[228:231], v[96:99]
    ds_read_b128 v[192:195], v117 offset:0
    ds_read_b64_tr_b16 a[120:121], v4 offset:24832
    v_mfma_f32_16x16x32_bf16 v[100:103], a[44:47], v[228:231], v[100:103]
    v_xor_b32 v138, v138, v166
    v_xor_b32 v139, v139, v166
    v_mfma_f32_16x16x32_bf16 v[100:103], a[56:59], v[232:235], v[100:103]
    v_lshlrev_b32_sdwa v122, 4, v136 dst_sel:DWORD dst_unused:UNUSED_PAD src0_sel:DWORD src1_sel:WORD_0
    v_lshlrev_b32_sdwa v123, 4, v138 dst_sel:DWORD dst_unused:UNUSED_PAD src0_sel:DWORD src1_sel:WORD_0
    v_mfma_f32_16x16x32_bf16 v[96:99], a[52:55], v[232:235], v[96:99]
    ds_read_b128 v[196:199], v117 offset:64
    s_lshl_b32 s48, s29, 3
    v_mfma_f32_16x16x32_bf16 v[92:95], a[48:51], v[232:235], v[92:95]
    v_lshlrev_b32_sdwa v124, 4, v136 dst_sel:DWORD dst_unused:UNUSED_PAD src0_sel:DWORD src1_sel:WORD_1
    v_lshlrev_b32_sdwa v125, 4, v138 dst_sel:DWORD dst_unused:UNUSED_PAD src0_sel:DWORD src1_sel:WORD_1
    v_mfma_f32_16x16x32_bf16 v[92:95], a[60:63], v[236:239], v[92:95]
    ds_read_b64_tr_b16 a[122:123], v4 offset:25600
    v_bfe_u32 v38, v6, 4, 2
    v_mfma_f32_16x16x32_bf16 v[96:99], a[64:67], v[236:239], v[96:99]
    ds_read_b128 v[200:203], v117 offset:128
    v_lshlrev_b32_sdwa v126, 4, v137 dst_sel:DWORD dst_unused:UNUSED_PAD src0_sel:DWORD src1_sel:WORD_0
    v_lshlrev_b32_sdwa v127, 4, v139 dst_sel:DWORD dst_unused:UNUSED_PAD src0_sel:DWORD src1_sel:WORD_0
    v_mfma_f32_16x16x32_bf16 v[100:103], a[68:71], v[236:239], v[100:103]
    ds_read_b64_tr_b16 a[124:125], v4 offset:24864
    v_bfe_u32 v39, v6, 6, 2
    v_mfma_f32_16x16x32_bf16 v[104:107], a[36:39], v[240:243], v[104:107]
    ds_read_b64_tr_b16 a[126:127], v4 offset:25632
    v_lshl_add_u32 v38, v38, 2, v39
    v_mfma_f32_16x16x32_bf16 v[108:111], a[40:43], v[240:243], v[108:111]
    ds_read_b128 v[204:207], v122 offset:0
    v_mfma_f32_16x16x32_bf16 v[112:115], a[44:47], v[240:243], v[112:115]
    ds_read_b64_tr_b16 a[128:129], v5 offset:24896
    ds_read_b128 v[136:139], v172 offset:2048
    v_mfma_f32_16x16x32_bf16 v[112:115], a[56:59], v[244:247], v[112:115]
    ds_read_b64_tr_b16 a[130:131], v5 offset:25664
    s_add_u32 s47, s47, 107616
    v_mfma_f32_16x16x32_bf16 v[108:111], a[52:55], v[244:247], v[108:111]
    ds_read_b128 v[208:211], v122 offset:64
    v_mfma_f32_16x16x32_bf16 v[104:107], a[48:51], v[244:247], v[104:107]
    ds_read_b64_tr_b16 a[132:133], v4 offset:31040
    v_lshrrev_b32 v39, 8, v6
    v_mfma_f32_16x16x32_bf16 v[104:107], a[60:63], v[248:251], v[104:107]
    ds_read_b64_tr_b16 a[134:135], v4 offset:31808
    v_mfma_f32_16x16x32_bf16 v[108:111], a[64:67], v[248:251], v[108:111]
    ds_read_b128 v[212:215], v122 offset:128
    v_mfma_f32_16x16x32_bf16 v[112:115], a[68:71], v[248:251], v[112:115]
    ds_read_b64_tr_b16 a[136:137], v4 offset:31072
    v_mul_u32_u24 v17, 72, v38
    s_waitcnt lgkmcnt(7)
    v_mfma_f32_16x16x32_bf16 v[44:47], a[72:75], v[180:183], v[44:47]
    ds_read_b64_tr_b16 a[138:139], v4 offset:31840
    v_mfma_f32_16x16x32_bf16 v[48:51], a[76:79], v[180:183], v[48:51]
    ds_read_b128 v[216:219], v123 offset:0
    v_mfma_f32_16x16x32_bf16 v[52:55], a[80:83], v[180:183], v[52:55]
    ds_read_b64_tr_b16 a[140:141], v5 offset:31104
    v_mul_u32_u24 v16, s2, v38
    v_mfma_f32_16x16x32_bf16 v[52:55], a[92:95], v[184:187], v[52:55]
    ds_read_b64_tr_b16 a[142:143], v5 offset:31872
    v_mfma_f32_16x16x32_bf16 v[48:51], a[88:91], v[184:187], v[48:51]
    ds_read_b128 v[220:223], v123 offset:64
    v_mfma_f32_16x16x32_bf16 v[44:47], a[84:87], v[184:187], v[44:47]
    s_waitcnt lgkmcnt(7)
    v_xor_b32 v136, v136, v166
    v_xor_b32 v137, v137, v166
    v_mfma_f32_16x16x32_bf16 v[44:47], a[96:99], v[188:191], v[44:47]
    v_xor_b32 v138, v138, v166
    v_xor_b32 v139, v139, v166
    v_mfma_f32_16x16x32_bf16 v[48:51], a[100:103], v[188:191], v[48:51]
    ds_read_b128 v[224:227], v123 offset:128
    v_mfma_f32_16x16x32_bf16 v[52:55], a[104:107], v[188:191], v[52:55]
    s_waitcnt vmcnt(0)
    s_waitcnt lgkmcnt(2)
    s_barrier
    s_lshl2_add_u32 s49, s48, s47
    v_lshl_add_u32 v17, v39, 3, v17
    v_mfma_f32_16x16x32_bf16 v[56:59], a[72:75], v[192:195], v[56:59]
    v_lshlrev_b32_sdwa v128, 4, v136 dst_sel:DWORD dst_unused:UNUSED_PAD src0_sel:DWORD src1_sel:WORD_0
    v_lshlrev_b32_sdwa v129, 4, v138 dst_sel:DWORD dst_unused:UNUSED_PAD src0_sel:DWORD src1_sel:WORD_0
    v_mfma_f32_16x16x32_bf16 v[60:63], a[76:79], v[192:195], v[60:63]
    ds_read_b128 v[228:231], v118 offset:0
    v_and_b32 v38, 1, v39
    v_mfma_f32_16x16x32_bf16 v[64:67], a[80:83], v[192:195], v[64:67]
    v_lshlrev_b32_sdwa v130, 4, v136 dst_sel:DWORD dst_unused:UNUSED_PAD src0_sel:DWORD src1_sel:WORD_1
    v_lshlrev_b32_sdwa v131, 4, v138 dst_sel:DWORD dst_unused:UNUSED_PAD src0_sel:DWORD src1_sel:WORD_1
    v_mfma_f32_16x16x32_bf16 v[64:67], a[92:95], v[196:199], v[64:67]
    ds_read_b64_tr_b16 a[0:1], v4 offset:37248
    v_mfma_f32_16x16x32_bf16 v[60:63], a[88:91], v[196:199], v[60:63]
    ds_read_b128 v[232:235], v118 offset:64
    v_lshrrev_b32 v39, 1, v39
    v_mfma_f32_16x16x32_bf16 v[56:59], a[84:87], v[196:199], v[56:59]
    ds_read_b64_tr_b16 a[2:3], v4 offset:38016
    ds_read_b64_tr_b16 a[4:5], v4 offset:37280
    v_mfma_f32_16x16x32_bf16 v[56:59], a[96:99], v[200:203], v[56:59]
    v_lshlrev_b32_sdwa v132, 4, v137 dst_sel:DWORD dst_unused:UNUSED_PAD src0_sel:DWORD src1_sel:WORD_0
    v_lshlrev_b32_sdwa v133, 4, v139 dst_sel:DWORD dst_unused:UNUSED_PAD src0_sel:DWORD src1_sel:WORD_0
    v_mfma_f32_16x16x32_bf16 v[60:63], a[100:103], v[200:203], v[60:63]
    ds_read_b128 v[236:239], v118 offset:128
    v_add_u32 v17, s49, v17
    v_mfma_f32_16x16x32_bf16 v[64:67], a[104:107], v[200:203], v[64:67]
    ds_read_b64_tr_b16 a[6:7], v4 offset:38048
    v_mfma_f32_16x16x32_bf16 v[44:47], a[108:111], v[204:207], v[44:47]
    ds_read_b64_tr_b16 a[8:9], v5 offset:37312
    v_lshl_add_u32 v38, v38, 1, v39
    v_mfma_f32_16x16x32_bf16 v[48:51], a[112:115], v[204:207], v[48:51]
    ds_read_b128 v[240:243], v128 offset:0
    v_mfma_f32_16x16x32_bf16 v[52:55], a[116:119], v[204:207], v[52:55]
    ds_read_b64_tr_b16 a[10:11], v5 offset:38080
    v_mfma_f32_16x16x32_bf16 v[52:55], a[128:131], v[208:211], v[52:55]
    ds_read_b64_tr_b16 a[12:13], v4 offset:43456
    v_lshrrev_b32 v39, 7, v6
    v_mfma_f32_16x16x32_bf16 v[48:51], a[124:127], v[208:211], v[48:51]
    ds_read_b128 v[244:247], v128 offset:64
    v_mfma_f32_16x16x32_bf16 v[44:47], a[120:123], v[208:211], v[44:47]
    ds_read_b64_tr_b16 a[14:15], v4 offset:44224
    v_mfma_f32_16x16x32_bf16 v[44:47], a[132:135], v[212:215], v[44:47]
    ds_read_b64_tr_b16 a[16:17], v4 offset:43488
    v_add_u32 v38, s48, v38
    v_mfma_f32_16x16x32_bf16 v[48:51], a[136:139], v[212:215], v[48:51]
    ds_read_b128 v[248:251], v128 offset:128
    v_mfma_f32_16x16x32_bf16 v[52:55], a[140:143], v[212:215], v[52:55]
    ds_read_b64_tr_b16 a[18:19], v4 offset:44256
    v_mfma_f32_16x16x32_bf16 v[56:59], a[108:111], v[216:219], v[56:59]
    ds_read_b64_tr_b16 a[20:21], v5 offset:43520
    v_add_u32 v39, s48, v39
    v_mfma_f32_16x16x32_bf16 v[60:63], a[112:115], v[216:219], v[60:63]
    ds_read_b128 v[180:183], v129 offset:0
    v_mfma_f32_16x16x32_bf16 v[64:67], a[116:119], v[216:219], v[64:67]
    ds_read_b64_tr_b16 a[22:23], v5 offset:44288
    s_waitcnt lgkmcnt(7)
    v_mfma_f32_16x16x32_bf16 v[64:67], a[128:131], v[220:223], v[64:67]
    ds_read_b64_tr_b16 a[24:25], v4 offset:49664
    v_lshl_add_u32 v16, v38, 4, v16
    v_mfma_f32_16x16x32_bf16 v[60:63], a[124:127], v[220:223], v[60:63]
    ds_read_b128 v[184:187], v129 offset:64
    v_mfma_f32_16x16x32_bf16 v[56:59], a[120:123], v[220:223], v[56:59]
    ds_read_b64_tr_b16 a[26:27], v4 offset:50432
    v_bfe_u32 v38, v6, 1, 6
    v_mfma_f32_16x16x32_bf16 v[56:59], a[132:135], v[224:227], v[56:59]
    ds_read_b64_tr_b16 a[28:29], v4 offset:49696
    v_mfma_f32_16x16x32_bf16 v[60:63], a[136:139], v[224:227], v[60:63]
    ds_read_b128 v[188:191], v129 offset:128
    v_mfma_f32_16x16x32_bf16 v[64:67], a[140:143], v[224:227], v[64:67]
    ds_read_b64_tr_b16 a[30:31], v4 offset:50464
    v_mfma_f32_16x16x32_bf16 v[68:71], a[72:75], v[228:231], v[68:71]
    ds_read_b64_tr_b16 a[32:33], v5 offset:49728
    v_mfma_f32_16x16x32_bf16 v[72:75], a[76:79], v[228:231], v[72:75]
    ds_read_b128 v[192:195], v124 offset:0
    v_mfma_f32_16x16x32_bf16 v[76:79], a[80:83], v[228:231], v[76:79]
    ds_read_b64_tr_b16 a[34:35], v5 offset:50496
    v_mfma_f32_16x16x32_bf16 v[76:79], a[92:95], v[232:235], v[76:79]
    v_mul_u32_u24 v18, 72, v39
    v_mul_u32_u24 v19, s2, v39
    v_mfma_f32_16x16x32_bf16 v[72:75], a[88:91], v[232:235], v[72:75]
    ds_read_b128 v[196:199], v124 offset:64
    v_mfma_f32_16x16x32_bf16 v[68:71], a[84:87], v[232:235], v[68:71]
    v_add3_u32 v18, v18, s47, v38
    v_mfma_f32_16x16x32_bf16 v[68:71], a[96:99], v[236:239], v[68:71]
    v_mfma_f32_16x16x32_bf16 v[72:75], a[100:103], v[236:239], v[72:75]
    ds_read_b128 v[200:203], v124 offset:128
    v_mfma_f32_16x16x32_bf16 v[76:79], a[104:107], v[236:239], v[76:79]
    v_add3_u32 v19, v19, 64, v38
    v_mfma_f32_16x16x32_bf16 v[44:47], a[0:3], v[240:243], v[44:47]
    v_mfma_f32_16x16x32_bf16 v[48:51], a[4:7], v[240:243], v[48:51]
    ds_read_b128 v[204:207], v130 offset:0
    v_mfma_f32_16x16x32_bf16 v[52:55], a[8:11], v[240:243], v[52:55]
    s_mov_b32 s46, s31
    s_waitcnt lgkmcnt(7)
    v_mfma_f32_16x16x32_bf16 v[52:55], a[20:23], v[244:247], v[52:55]
    v_mfma_f32_16x16x32_bf16 v[48:51], a[16:19], v[244:247], v[48:51]
    ds_read_b128 v[208:211], v130 offset:64
    v_mfma_f32_16x16x32_bf16 v[44:47], a[12:15], v[244:247], v[44:47]
    v_mfma_f32_16x16x32_bf16 v[44:47], a[24:27], v[248:251], v[44:47]
    s_waitcnt lgkmcnt(7)
    v_mfma_f32_16x16x32_bf16 v[48:51], a[28:31], v[248:251], v[48:51]
    ds_read_b128 v[212:215], v130 offset:128
    s_waitcnt lgkmcnt(5)
    v_mfma_f32_16x16x32_bf16 v[52:55], a[32:35], v[248:251], v[52:55]
    v_mfma_f32_16x16x32_bf16 v[56:59], a[0:3], v[180:183], v[56:59]
    v_mfma_f32_16x16x32_bf16 v[60:63], a[4:7], v[180:183], v[60:63]
    ds_read_b128 v[216:219], v119 offset:0
    v_mfma_f32_16x16x32_bf16 v[64:67], a[8:11], v[180:183], v[64:67]
    v_mfma_f32_16x16x32_bf16 v[64:67], a[20:23], v[184:187], v[64:67]
    v_mfma_f32_16x16x32_bf16 v[60:63], a[16:19], v[184:187], v[60:63]
    ds_read_b128 v[220:223], v119 offset:64
    v_mfma_f32_16x16x32_bf16 v[56:59], a[12:15], v[184:187], v[56:59]
    v_cvt_pk_bf16_f32 v32, v44, v45
    v_cvt_pk_bf16_f32 v33, v46, v47
    v_mfma_f32_16x16x32_bf16 v[56:59], a[24:27], v[188:191], v[56:59]
    v_cvt_pk_bf16_f32 v34, v48, v49
    v_cvt_pk_bf16_f32 v35, v50, v51
    v_mfma_f32_16x16x32_bf16 v[60:63], a[28:31], v[188:191], v[60:63]
    ds_read_b128 v[224:227], v119 offset:128
    v_mfma_f32_16x16x32_bf16 v[64:67], a[32:35], v[188:191], v[64:67]
    v_cvt_pk_bf16_f32 v36, v52, v53
    v_cvt_pk_bf16_f32 v37, v54, v55
    v_mfma_f32_16x16x32_bf16 v[68:71], a[108:111], v[192:195], v[68:71]
    v_permlane16_swap_b32 v32, v34
    v_permlane16_swap_b32 v33, v35
    v_mfma_f32_16x16x32_bf16 v[72:75], a[112:115], v[192:195], v[72:75]
    ds_read_b128 v[228:231], v125 offset:0
    v_mfma_f32_16x16x32_bf16 v[76:79], a[116:119], v[192:195], v[76:79]
    ds_write_b64 v17, v[36:37] offset:0
    s_waitcnt lgkmcnt(7)
    v_mfma_f32_16x16x32_bf16 v[76:79], a[128:131], v[196:199], v[76:79]
    buffer_store_dwordx4 v[32:35], v16, s[16:19], s31 offen sc1
    s_add_u32 s31, s31, s55
    v_mfma_f32_16x16x32_bf16 v[72:75], a[124:127], v[196:199], v[72:75]
    ds_read_b128 v[232:235], v125 offset:64
    v_mfma_f32_16x16x32_bf16 v[68:71], a[120:123], v[196:199], v[68:71]
    v_mfma_f32_16x16x32_bf16 v[68:71], a[132:135], v[200:203], v[68:71]
    v_mfma_f32_16x16x32_bf16 v[72:75], a[136:139], v[200:203], v[72:75]
    ds_read_b128 v[236:239], v125 offset:128
    v_mfma_f32_16x16x32_bf16 v[76:79], a[140:143], v[200:203], v[76:79]
    v_mfma_f32_16x16x32_bf16 v[68:71], a[0:3], v[204:207], v[68:71]
    v_mfma_f32_16x16x32_bf16 v[72:75], a[4:7], v[204:207], v[72:75]
    ds_read_b128 v[240:243], v131 offset:0
    v_mfma_f32_16x16x32_bf16 v[76:79], a[8:11], v[204:207], v[76:79]
    s_waitcnt lgkmcnt(7)
    v_mfma_f32_16x16x32_bf16 v[76:79], a[20:23], v[208:211], v[76:79]
    v_mfma_f32_16x16x32_bf16 v[72:75], a[16:19], v[208:211], v[72:75]
    ds_read_b128 v[244:247], v131 offset:64
    v_mfma_f32_16x16x32_bf16 v[68:71], a[12:15], v[208:211], v[68:71]
    v_cvt_pk_bf16_f32 v32, v56, v57
    v_cvt_pk_bf16_f32 v33, v58, v59
    v_mfma_f32_16x16x32_bf16 v[68:71], a[24:27], v[212:215], v[68:71]
    v_cvt_pk_bf16_f32 v34, v60, v61
    v_cvt_pk_bf16_f32 v35, v62, v63
    v_mfma_f32_16x16x32_bf16 v[72:75], a[28:31], v[212:215], v[72:75]
    ds_read_b128 v[248:251], v131 offset:128
    v_mfma_f32_16x16x32_bf16 v[76:79], a[32:35], v[212:215], v[76:79]
    v_cvt_pk_bf16_f32 v36, v64, v65
    v_cvt_pk_bf16_f32 v37, v66, v67
    v_mfma_f32_16x16x32_bf16 v[80:83], a[72:75], v[216:219], v[80:83]
    v_permlane16_swap_b32 v32, v34
    v_permlane16_swap_b32 v33, v35
    v_mfma_f32_16x16x32_bf16 v[84:87], a[76:79], v[216:219], v[84:87]
    ds_read_b128 v[180:183], v120 offset:0
    v_mfma_f32_16x16x32_bf16 v[88:91], a[80:83], v[216:219], v[88:91]
    ds_write_b64 v17, v[36:37] offset:1152
    s_waitcnt lgkmcnt(7)
    v_mfma_f32_16x16x32_bf16 v[88:91], a[92:95], v[220:223], v[88:91]
    buffer_store_dwordx4 v[32:35], v16, s[16:19], s31 offen sc1
    s_add_u32 s31, s31, s55
    v_mfma_f32_16x16x32_bf16 v[84:87], a[88:91], v[220:223], v[84:87]
    ds_read_b128 v[184:187], v120 offset:64
    v_mfma_f32_16x16x32_bf16 v[80:83], a[84:87], v[220:223], v[80:83]
    v_mfma_f32_16x16x32_bf16 v[80:83], a[96:99], v[224:227], v[80:83]
    v_mfma_f32_16x16x32_bf16 v[84:87], a[100:103], v[224:227], v[84:87]
    ds_read_b128 v[188:191], v120 offset:128
    v_mfma_f32_16x16x32_bf16 v[88:91], a[104:107], v[224:227], v[88:91]
    v_mfma_f32_16x16x32_bf16 v[80:83], a[108:111], v[228:231], v[80:83]
    v_mfma_f32_16x16x32_bf16 v[84:87], a[112:115], v[228:231], v[84:87]
    ds_read_b128 v[192:195], v126 offset:0
    v_mfma_f32_16x16x32_bf16 v[88:91], a[116:119], v[228:231], v[88:91]
    s_waitcnt lgkmcnt(7)
    v_mfma_f32_16x16x32_bf16 v[88:91], a[128:131], v[232:235], v[88:91]
    v_mfma_f32_16x16x32_bf16 v[84:87], a[124:127], v[232:235], v[84:87]
    ds_read_b128 v[196:199], v126 offset:64
    v_mfma_f32_16x16x32_bf16 v[80:83], a[120:123], v[232:235], v[80:83]
    v_cvt_pk_bf16_f32 v32, v68, v69
    v_cvt_pk_bf16_f32 v33, v70, v71
    v_mfma_f32_16x16x32_bf16 v[80:83], a[132:135], v[236:239], v[80:83]
    v_cvt_pk_bf16_f32 v34, v72, v73
    v_cvt_pk_bf16_f32 v35, v74, v75
    v_mfma_f32_16x16x32_bf16 v[84:87], a[136:139], v[236:239], v[84:87]
    ds_read_b128 v[200:203], v126 offset:128
    v_mfma_f32_16x16x32_bf16 v[88:91], a[140:143], v[236:239], v[88:91]
    v_cvt_pk_bf16_f32 v36, v76, v77
    v_cvt_pk_bf16_f32 v37, v78, v79
    v_mfma_f32_16x16x32_bf16 v[80:83], a[0:3], v[240:243], v[80:83]
    v_permlane16_swap_b32 v32, v34
    v_permlane16_swap_b32 v33, v35
    v_mfma_f32_16x16x32_bf16 v[84:87], a[4:7], v[240:243], v[84:87]
    ds_read_b128 v[204:207], v132 offset:0
    v_mfma_f32_16x16x32_bf16 v[88:91], a[8:11], v[240:243], v[88:91]
    ds_write_b64 v17, v[36:37] offset:2304
    s_waitcnt lgkmcnt(7)
    v_mfma_f32_16x16x32_bf16 v[88:91], a[20:23], v[244:247], v[88:91]
    buffer_store_dwordx4 v[32:35], v16, s[16:19], s31 offen sc1
    s_add_u32 s31, s31, s55
    v_mfma_f32_16x16x32_bf16 v[84:87], a[16:19], v[244:247], v[84:87]
    ds_read_b128 v[208:211], v132 offset:64
    v_mfma_f32_16x16x32_bf16 v[80:83], a[12:15], v[244:247], v[80:83]
    v_mfma_f32_16x16x32_bf16 v[80:83], a[24:27], v[248:251], v[80:83]
    v_mfma_f32_16x16x32_bf16 v[84:87], a[28:31], v[248:251], v[84:87]
    ds_read_b128 v[212:215], v132 offset:128
    s_waitcnt lgkmcnt(2)
    s_barrier
    v_mfma_f32_16x16x32_bf16 v[88:91], a[32:35], v[248:251], v[88:91]
    ds_read_b64 v[38:39], v18 offset:0
    v_mfma_f32_16x16x32_bf16 v[92:95], a[72:75], v[180:183], v[92:95]
    ds_read_b64 v[40:41], v18 offset:1152
    v_mfma_f32_16x16x32_bf16 v[96:99], a[76:79], v[180:183], v[96:99]
    ds_read_b128 v[216:219], v121 offset:0
    v_mfma_f32_16x16x32_bf16 v[100:103], a[80:83], v[180:183], v[100:103]
    ds_read_b64 v[42:43], v18 offset:2304
    v_mfma_f32_16x16x32_bf16 v[100:103], a[92:95], v[184:187], v[100:103]
    v_mfma_f32_16x16x32_bf16 v[96:99], a[88:91], v[184:187], v[96:99]
    ds_read_b128 v[220:223], v121 offset:64
    v_mfma_f32_16x16x32_bf16 v[92:95], a[84:87], v[184:187], v[92:95]
    v_cvt_pk_bf16_f32 v32, v80, v81
    v_cvt_pk_bf16_f32 v33, v82, v83
    v_mfma_f32_16x16x32_bf16 v[92:95], a[96:99], v[188:191], v[92:95]
    v_cvt_pk_bf16_f32 v34, v84, v85
    v_cvt_pk_bf16_f32 v35, v86, v87
    v_mfma_f32_16x16x32_bf16 v[96:99], a[100:103], v[188:191], v[96:99]
    ds_read_b128 v[224:227], v121 offset:128
    v_mfma_f32_16x16x32_bf16 v[100:103], a[104:107], v[188:191], v[100:103]
    s_waitcnt lgkmcnt(5)
    buffer_store_dwordx2 v[38:39], v19, s[16:19], s46 offen sc1
    s_add_u32 s46, s46, s55
    v_mfma_f32_16x16x32_bf16 v[92:95], a[108:111], v[192:195], v[92:95]
    v_cvt_pk_bf16_f32 v36, v88, v89
    v_cvt_pk_bf16_f32 v37, v90, v91
    v_mfma_f32_16x16x32_bf16 v[96:99], a[112:115], v[192:195], v[96:99]
    ds_read_b128 v[228:231], v127 offset:0
    v_mfma_f32_16x16x32_bf16 v[100:103], a[116:119], v[192:195], v[100:103]
    v_permlane16_swap_b32 v32, v34
    v_permlane16_swap_b32 v33, v35
    v_mfma_f32_16x16x32_bf16 v[100:103], a[128:131], v[196:199], v[100:103]
    s_waitcnt lgkmcnt(5)
    buffer_store_dwordx2 v[40:41], v19, s[16:19], s46 offen sc1
    s_add_u32 s46, s46, s55
    v_mfma_f32_16x16x32_bf16 v[96:99], a[124:127], v[196:199], v[96:99]
    ds_read_b128 v[232:235], v127 offset:64
    v_mfma_f32_16x16x32_bf16 v[92:95], a[120:123], v[196:199], v[92:95]
    ds_write_b64 v17, v[36:37] offset:3456
    v_mfma_f32_16x16x32_bf16 v[92:95], a[132:135], v[200:203], v[92:95]
    buffer_store_dwordx4 v[32:35], v16, s[16:19], s31 offen sc1
    s_add_u32 s31, s31, s55
    v_mfma_f32_16x16x32_bf16 v[96:99], a[136:139], v[200:203], v[96:99]
    ds_read_b128 v[236:239], v127 offset:128
    v_mfma_f32_16x16x32_bf16 v[100:103], a[140:143], v[200:203], v[100:103]
    s_waitcnt lgkmcnt(6)
    buffer_store_dwordx2 v[42:43], v19, s[16:19], s46 offen sc1
    s_add_u32 s46, s46, s55
    v_mfma_f32_16x16x32_bf16 v[92:95], a[0:3], v[204:207], v[92:95]
    v_mfma_f32_16x16x32_bf16 v[96:99], a[4:7], v[204:207], v[96:99]
    ds_read_b128 v[240:243], v133 offset:0
    v_mfma_f32_16x16x32_bf16 v[100:103], a[8:11], v[204:207], v[100:103]
    v_mfma_f32_16x16x32_bf16 v[100:103], a[20:23], v[208:211], v[100:103]
    v_mfma_f32_16x16x32_bf16 v[96:99], a[16:19], v[208:211], v[96:99]
    ds_read_b128 v[244:247], v133 offset:64
    v_mfma_f32_16x16x32_bf16 v[92:95], a[12:15], v[208:211], v[92:95]
    v_mfma_f32_16x16x32_bf16 v[92:95], a[24:27], v[212:215], v[92:95]
    v_mfma_f32_16x16x32_bf16 v[96:99], a[28:31], v[212:215], v[96:99]
    ds_read_b128 v[248:251], v133 offset:128
    v_mfma_f32_16x16x32_bf16 v[100:103], a[32:35], v[212:215], v[100:103]
    s_cmp_eq_u32 s36, 5
    s_cbranch_scc1 L_Pe6
    v_mfma_f32_16x16x32_bf16 v[104:107], a[72:75], v[216:219], v[104:107]
    v_mfma_f32_16x16x32_bf16 v[108:111], a[76:79], v[216:219], v[108:111]
    v_mfma_f32_16x16x32_bf16 v[112:115], a[80:83], v[216:219], v[112:115]
    s_waitcnt lgkmcnt(7)
    v_mfma_f32_16x16x32_bf16 v[112:115], a[92:95], v[220:223], v[112:115]
    v_mfma_f32_16x16x32_bf16 v[108:111], a[88:91], v[220:223], v[108:111]
    v_cvt_pk_bf16_f32 v32, v92, v93
    v_cvt_pk_bf16_f32 v33, v94, v95
    v_mfma_f32_16x16x32_bf16 v[104:107], a[84:87], v[220:223], v[104:107]
    v_cvt_pk_bf16_f32 v34, v96, v97
    v_cvt_pk_bf16_f32 v35, v98, v99
    v_mfma_f32_16x16x32_bf16 v[104:107], a[96:99], v[224:227], v[104:107]
    v_cvt_pk_bf16_f32 v36, v100, v101
    v_cvt_pk_bf16_f32 v37, v102, v103
    v_mfma_f32_16x16x32_bf16 v[108:111], a[100:103], v[224:227], v[108:111]
    v_permlane16_swap_b32 v32, v34
    v_permlane16_swap_b32 v33, v35
    v_mfma_f32_16x16x32_bf16 v[112:115], a[104:107], v[224:227], v[112:115]
    ds_write_b64 v17, v[36:37] offset:4608
    s_waitcnt lgkmcnt(7)
    v_mfma_f32_16x16x32_bf16 v[104:107], a[108:111], v[228:231], v[104:107]
    buffer_store_dwordx4 v[32:35], v16, s[16:19], s31 offen sc1
    s_add_u32 s31, s31, s55
    v_mfma_f32_16x16x32_bf16 v[108:111], a[112:115], v[228:231], v[108:111]
    v_mfma_f32_16x16x32_bf16 v[112:115], a[116:119], v[228:231], v[112:115]
    s_waitcnt lgkmcnt(6)
    v_mfma_f32_16x16x32_bf16 v[112:115], a[128:131], v[232:235], v[112:115]
    v_mfma_f32_16x16x32_bf16 v[108:111], a[124:127], v[232:235], v[108:111]
    s_waitcnt lgkmcnt(0)
    s_barrier
    v_mfma_f32_16x16x32_bf16 v[104:107], a[120:123], v[232:235], v[104:107]
    ds_read_b64 v[38:39], v18 offset:3456
    v_mfma_f32_16x16x32_bf16 v[104:107], a[132:135], v[236:239], v[104:107]
    ds_read_b64 v[40:41], v18 offset:4608
    v_mfma_f32_16x16x32_bf16 v[108:111], a[136:139], v[236:239], v[108:111]
    v_mfma_f32_16x16x32_bf16 v[112:115], a[140:143], v[236:239], v[112:115]
    v_mfma_f32_16x16x32_bf16 v[104:107], a[0:3], v[240:243], v[104:107]
    v_mfma_f32_16x16x32_bf16 v[108:111], a[4:7], v[240:243], v[108:111]
    s_waitcnt lgkmcnt(1)
    buffer_store_dwordx2 v[38:39], v19, s[16:19], s46 offen sc1
    s_add_u32 s46, s46, s55
    v_mfma_f32_16x16x32_bf16 v[112:115], a[8:11], v[240:243], v[112:115]
    v_mfma_f32_16x16x32_bf16 v[112:115], a[20:23], v[244:247], v[112:115]
    v_mfma_f32_16x16x32_bf16 v[108:111], a[16:19], v[244:247], v[108:111]
    s_waitcnt lgkmcnt(0)
    buffer_store_dwordx2 v[40:41], v19, s[16:19], s46 offen sc1
    s_add_u32 s46, s46, s55
    v_mfma_f32_16x16x32_bf16 v[104:107], a[12:15], v[244:247], v[104:107]
    v_mfma_f32_16x16x32_bf16 v[104:107], a[24:27], v[248:251], v[104:107]
    v_mfma_f32_16x16x32_bf16 v[108:111], a[28:31], v[248:251], v[108:111]
    v_mfma_f32_16x16x32_bf16 v[112:115], a[32:35], v[248:251], v[112:115]
    s_cmp_lg_u32 s54, 0
    s_nop 4
    v_cvt_pk_bf16_f32 v32, v104, v105
    v_cvt_pk_bf16_f32 v33, v106, v107
    v_cvt_pk_bf16_f32 v34, v108, v109
    v_cvt_pk_bf16_f32 v35, v110, v111
    ds_write_b64 v20, v[32:33] offset:0
    v_cvt_pk_bf16_f32 v36, v112, v113
    v_cvt_pk_bf16_f32 v37, v114, v115
    ds_write_b64 v20, v[34:35] offset:32
    ds_write_b64 v21, v[36:37] offset:64
    s_waitcnt lgkmcnt(0)
    s_barrier
    ds_read_b128 v[26:29], v22 offset:0
    ds_read_b64 v[30:31], v23 offset:0
    s_waitcnt lgkmcnt(1)
    buffer_store_dwordx4 v[26:29], v24, s[16:19], s31 offen sc1
    s_waitcnt lgkmcnt(0)
    buffer_store_dwordx2 v[30:31], v25, s[16:19], s31 offen sc1
    s_cbranch_scc1 L_gS
    s_endpgm
L_Pe6:
    s_cmp_lg_u32 s54, 0
    s_nop 1
    v_cvt_pk_bf16_f32 v32, v92, v93
    v_cvt_pk_bf16_f32 v33, v94, v95
    v_cvt_pk_bf16_f32 v34, v96, v97
    v_cvt_pk_bf16_f32 v35, v98, v99
    ds_write_b64 v20, v[32:33] offset:0
    v_cvt_pk_bf16_f32 v36, v100, v101
    v_cvt_pk_bf16_f32 v37, v102, v103
    ds_write_b64 v20, v[34:35] offset:32
    ds_write_b64 v21, v[36:37] offset:64
    s_waitcnt lgkmcnt(0)
    s_barrier
    ds_read_b64 v[38:39], v18 offset:3456
    ds_read_b128 v[26:29], v22 offset:0
    ds_read_b64 v[30:31], v23 offset:0
    s_waitcnt lgkmcnt(2)
    buffer_store_dwordx2 v[38:39], v19, s[16:19], s46 offen sc1
    s_waitcnt lgkmcnt(1)
    buffer_store_dwordx4 v[26:29], v24, s[16:19], s31 offen sc1
    s_waitcnt lgkmcnt(0)
    buffer_store_dwordx2 v[30:31], v25, s[16:19], s31 offen sc1
    s_cbranch_scc1 L_gS
    s_endpgm
L_Pz:
    s_cmp_le_u32 s72, 11
    s_cbranch_scc1 L_l10
    s_add_u32 m0, s33, 42944
    s_min_i32 s47, s20, s21
    s_add_u32 s20, s20, s55
    buffer_load_dwordx4 v8, s[4:7], s47 offen lds
L_l10:
    s_cmp_le_u32 s72, 12
    s_cbranch_scc1 L_l11
    s_add_u32 m0, s33, 46848
    s_min_i32 s47, s20, s21
    s_add_u32 s20, s20, s55
    buffer_load_dwordx4 v8, s[4:7], s47 offen lds
L_l11:
    s_cmp_le_u32 s72, 13
    s_cbranch_scc1 L_l12
    s_add_u32 m0, s33, 50752
    s_min_i32 s47, s20, s21
    s_add_u32 s20, s20, s55
    buffer_load_dwordx4 v8, s[4:7], s47 offen lds
L_l12:
    s_cmp_le_u32 s72, 14
    s_cbranch_scc1 L_l13
    s_add_u32 m0, s33, 54656
    s_min_i32 s47, s20, s21
    s_add_u32 s20, s20, s55
    buffer_load_dwordx4 v8, s[4:7], s47 offen lds
L_l13:
    s_cmp_le_u32 s72, 15
    s_cbranch_scc1 L_l14
    s_add_u32 m0, s33, 58560
    s_min_i32 s47, s20, s21
    s_add_u32 s20, s20, s55
    buffer_load_dwordx4 v8, s[4:7], s47 offen lds
L_l14:
    s_add_u32 m0, s44, 0
    s_nop 0
    buffer_load_dwordx4 v7, s[12:15], s46 offen offset:0 lds
    buffer_load_dwordx4 v7, s[12:15], s46 offen offset:1024 lds
    s_cmp_eq_u32 s37, 0
    s_cbranch_scc1 L_Pn
L_Pfail:
    v_mov_b32 v12, 0xff
    ds_write_b32 v14, v12
L_Pn:
    buffer_load_dwordx4 v7, s[12:15], s46 offen offset:2048 lds
    s_add_u32 m0, s45, 0
    s_nop 0
    buffer_load_dwordx4 v26, s[12:15], s46 offen offset:0 lds
    buffer_load_dwordx4 v26, s[12:15], s46 offen offset:1024 lds
    s_add_u32 s46, s46, 18432
    s_waitcnt vmcnt(5) lgkmcnt(0)
    s_barrier
    s_cmp_ge_u32 s36, 4
    s_cbranch_scc1 L_l15
    s_add_u32 m0, s44, 18624
    s_nop 0
    buffer_load_dwordx4 v7, s[12:15], s46 offen offset:0 lds
    buffer_load_dwordx4 v7, s[12:15], s46 offen offset:1024 lds
    buffer_load_dwordx4 v7, s[12:15], s46 offen offset:2048 lds
    s_add_u32 m0, s45, 18624
    s_nop 0
    buffer_load_dwordx4 v26, s[12:15], s46 offen offset:0 lds
    buffer_load_dwordx4 v26, s[12:15], s46 offen offset:1024 lds
    s_add_u32 s46, s46, 18432
L_l15:
L_Pn2:
    ds_read_b128 v[136:139], v172 offset:0
    ds_read_b128 v[144:147], v14
    s_waitcnt lgkmcnt(0)
    v_xor_b32 v136, v136, v166
    v_xor_b32 v137, v137, v166
    v_xor_b32 v138, v138, v166
    v_xor_b32 v139, v139, v166
    v_lshlrev_b32_sdwa v116, 4, v136 dst_sel:DWORD dst_unused:UNUSED_PAD src0_sel:DWORD src1_sel:WORD_0
    v_lshlrev_b32_sdwa v117, 4, v138 dst_sel:DWORD dst_unused:UNUSED_PAD src0_sel:DWORD src1_sel:WORD_0
    v_lshlrev_b32_sdwa v118, 4, v136 dst_sel:DWORD dst_unused:UNUSED_PAD src0_sel:DWORD src1_sel:WORD_1
    v_lshlrev_b32_sdwa v119, 4, v138 dst_sel:DWORD dst_unused:UNUSED_PAD src0_sel:DWORD src1_sel:WORD_1
    v_lshlrev_b32_sdwa v120, 4, v137 dst_sel:DWORD dst_unused:UNUSED_PAD src0_sel:DWORD src1_sel:WORD_0
    v_lshlrev_b32_sdwa v121, 4, v139 dst_sel:DWORD dst_unused:UNUSED_PAD src0_sel:DWORD src1_sel:WORD_0
    v_or3_b32 v144, v144, v145, v146
    v_or_b32 v144, v144, v147
    s_nop 0
    v_readfirstlane_b32 s54, v144
    s_branch L_Pa
L_Pr2:
    v_min_u32 v85, s32, v82
    v_cmp_ge_u32 s[64:65], s32, v82
    v_lshl_add_u32 v83, v85, 3, s38
    ds_read_b64 v[80:81], v83 offset:2048
    v_add_u32 v82, 64, v82
    s_add_u32 s39, s39, 64
    s_waitcnt lgkmcnt(0)
    v_readfirstlane_b32 s53, v78
    v_cvt_f32_ubyte2 v86, v81
    v_cvt_f32_ubyte3 v87, v81
    v_add_u32_sdwa v84, s49, v81 dst_sel:DWORD dst_unused:UNUSED_PAD src0_sel:DWORD src1_sel:WORD_0
    v_add_f32 v86, s68, v86
    v_add_f32 v87, s69, v87
    v_mov_b32 v81, s50
    v_lshlrev_b32 v61, 16, v80
    v_and_b32 v62, 0xffff0000, v80
    v_add_f32 v61, v61, v86
    v_add_f32 v62, v62, v87
    v_cvt_pk_bf16_f32 v60, v61, v62
    v_pk_max_i16 v60, v60, 0
    v_pk_min_i16 v60, v60, s52
    v_alignbit_b32 v60, v60, v60, s42
    v_lshlrev_b32 v61, 16, v60
    v_and_b32 v62, 0xffff0000, v60
    v_fract_f32 v63, v61
    v_fract_f32 v64, v62
    v_cvt_u32_f32 v65, v61
    v_cvt_u32_f32 v66, v62
    v_cmp_neq_f32 s[58:59], 0, v64
    v_cmp_neq_f32 s[60:61], 0, v63
    v_sub_f32 v67, 1.0, v63
    v_sub_f32 v68, 1.0, v64
    v_subrev_u32 v65, s71, v65
    v_subrev_u32 v66, s43, v66
    v_cvt_pk_bf16_f32 v61, v67, v68
    v_addc_co_u32 v74, vcc, 0, v66, s[58:59]
    v_addc_co_u32 v73, vcc, 0, v65, s[60:61]
    v_lshlrev_b32 v67, 16, v61
    v_and_b32 v68, 0xffff0000, v61
    v_mul_u32_u24 v75, 976, v65
    v_mul_f32 v69, v67, v68
    v_mul_f32 v70, v67, v64
    v_mul_f32 v71, v63, v68
    v_mul_f32 v72, v63, v64
    v_max_u32 v73, v73, v65
    v_max_u32 v61, v66, v74
    v_mad_u32_u24 v67, v66, 48, v75
    v_mad_u32_u24 v68, v74, 48, v75
    v_and_b32 v66, 12, v66
    v_and_b32 v74, 12, v74
    s_andn2_b64 s[62:63], s[60:61], s[58:59]
    v_add_lshl_u32 v67, v67, v66, 2
    v_add_lshl_u32 v68, v68, v74, 2
    v_cndmask_b32 v70, v71, v70, s[58:59]
    v_cndmask_b32 v62, 0, v174, s[62:63]
    s_and_b64 s[62:63], s[60:61], s[58:59]
    v_cndmask_b32 v71, 0, v71, s[58:59]
    s_and_b64 s[66:67], s[62:63], s[64:65]
    v_cmp_le_u32 s[60:61], s72, v73
    v_mbcnt_lo_u32_b32 v81, s66, v81
    v_cmp_lt_u32 s[58:59], 19, v61
    s_bcnt1_i32_b64 s48, s[66:67]
    v_lshl_or_b32 v58, v68, 16, v67
    v_mbcnt_hi_u32_b32 v81, s67, v81
    v_cvt_pk_bf16_f32 v57, v69, v70
    s_add_u32 s50, s50, s48
    v_cvt_pk_bf16_f32 v59, v71, v72
    v_sub_u32 v85, v85, v81
    v_and_b32 v62, 0xffff0000, v62
    v_sub_u32 v81, s32, v81
    v_cndmask_b32 v61, 0, v174, s[62:63]
    v_cndmask_b32 v85, v85, v81, s[66:67]
    v_add_u32 v56, v58, v62
    v_lshl_add_u32 v83, v85, 4, s38
    v_add_u32 v58, v58, v61
    v_add_u32 v85, s53, v85
    v_bfe_u32 v81, v85, 1, 2
    v_mad_u32_u24 v85, v85, 12, s35
    v_add_u32 v85, v85, v81
    s_mov_b64 exec, s[64:65]
    ds_write_b128 v83, v[56:59]
    ds_write_b16 v84, v85
    s_mov_b64 exec, -1
    s_or_b64 s[58:59], s[58:59], s[60:61]
    s_cbranch_scc1 L_Pfail
    s_cmp_lt_u32 s39, s37
    s_cbranch_scc1 L_Pr2
L_Pgl:
    s_mov_b32 s39, 0
    v_add_u32 v12, s39, v25
    v_min_u32 v12, s32, v12
    v_lshl_add_u32 v12, v12, 4, s38
    ds_read_b128 v[28:31], v12
    buffer_load_dwordx4 v7, s[12:15], s46 offen offset:2048 lds
    s_add_u32 m0, s45, 0
    s_nop 0
    buffer_load_dwordx4 v26, s[12:15], s46 offen offset:0 lds
    buffer_load_dwordx4 v26, s[12:15], s46 offen offset:1024 lds
    s_add_u32 s46, s46, 18432
    s_cmp_eq_u32 s50, 0
    s_cselect_b32 s47, 15, 0
    s_sub_u32 s50, s37, s50
    s_add_u32 s50, s50, s47
    s_waitcnt lgkmcnt(0)
    v_xor_b32_sdwa v0, v28, v164 dst_sel:DWORD dst_unused:UNUSED_PAD src0_sel:WORD_0 src1_sel:DWORD
    v_xor_b32_sdwa v2, v28, v164 dst_sel:DWORD dst_unused:UNUSED_PAD src0_sel:WORD_1 src1_sel:DWORD
    v_xor_b32_sdwa v1, v28, v173 dst_sel:DWORD dst_unused:UNUSED_PAD src0_sel:WORD_0 src1_sel:DWORD
    v_xor_b32_sdwa v3, v28, v173 dst_sel:DWORD dst_unused:UNUSED_PAD src0_sel:WORD_1 src1_sel:DWORD
    v_perm_b32 v32, v29, v29, v168
    v_perm_b32 v33, v29, v29, v169
    v_perm_b32 v34, v29, v29, v170
    v_perm_b32 v35, v29, v29, v171
    s_waitcnt vmcnt(5)
    s_barrier
    ds_read_b64_tr_b16 v[180:181], v0 offset:0
    ds_read_b64_tr_b16 v[182:183], v2 offset:0
    ds_read_b64_tr_b16 v[184:185], v1 offset:0
    ds_read_b64_tr_b16 v[186:187], v3 offset:0
    ds_read_b64_tr_b16 v[188:189], v0 offset:64
    ds_read_b64_tr_b16 v[190:191], v2 offset:64
    ds_read_b64_tr_b16 v[192:193], v1 offset:64
    ds_read_b64_tr_b16 v[194:195], v3 offset:64
    ds_read_b64_tr_b16 v[196:197], v0 offset:128
    ds_read_b64_tr_b16 v[198:199], v2 offset:128
    ds_read_b64_tr_b16 v[200:201], v1 offset:128
    ds_read_b64_tr_b16 v[202:203], v3 offset:128
    s_cmp_ge_u32 s36, 4
    s_cbranch_scc1 L_l16
    s_add_u32 m0, s44, 18624
    s_nop 0
    buffer_load_dwordx4 v7, s[12:15], s46 offen offset:0 lds
    buffer_load_dwordx4 v7, s[12:15], s46 offen offset:1024 lds
    buffer_load_dwordx4 v7, s[12:15], s46 offen offset:2048 lds
    s_add_u32 m0, s45, 18624
    s_nop 0
    buffer_load_dwordx4 v26, s[12:15], s46 offen offset:0 lds
    buffer_load_dwordx4 v26, s[12:15], s46 offen offset:1024 lds
    s_add_u32 s46, s46, 18432
L_l16:
    s_and_b32 s50, s50, -16
    s_cbranch_scc0 L_Pg4
L_Pl2:
    v_add_u32 v9, s39, v165
    v_min_u32 v9, s32, v9
    v_add_u32 v9, s53, v9
    s_add_u32 s39, s39, 16
    v_bfe_u32 v10, v9, 1, 2
    v_add_u32 v12, s39, v25
    v_mad_u32_u24 v9, v9, 12, v10
    v_min_u32 v12, s32, v12
    v_xor_b32_sdwa v9, v166, v9 dst_sel:DWORD dst_unused:UNUSED_PAD src0_sel:WORD_0 src1_sel:DWORD
    v_lshl_add_u32 v12, v12, 4, s38
    v_lshl_add_u32 v9, v9, 4, s24
    ds_read_b128 v[28:31], v12
    s_waitcnt lgkmcnt(11)
    v_mfma_f32_16x16x32_bf16 v[56:59], v[180:183], v[32:35], 0
    s_waitcnt lgkmcnt(9)
    v_mfma_f32_16x16x32_bf16 v[60:63], v[184:187], v[32:35], 0
    s_waitcnt lgkmcnt(7)
    v_mfma_f32_16x16x32_bf16 v[64:67], v[188:191], v[32:35], 0
    s_waitcnt lgkmcnt(5)
    v_mfma_f32_16x16x32_bf16 v[68:71], v[192:195], v[32:35], 0
    s_waitcnt lgkmcnt(3)
    v_mfma_f32_16x16x32_bf16 v[72:75], v[196:199], v[32:35], 0
    s_waitcnt lgkmcnt(0)
    v_xor_b32_sdwa v0, v28, v164 dst_sel:DWORD dst_unused:UNUSED_PAD src0_sel:WORD_0 src1_sel:DWORD
    v_xor_b32_sdwa v2, v28, v164 dst_sel:DWORD dst_unused:UNUSED_PAD src0_sel:WORD_1 src1_sel:DWORD
    v_xor_b32_sdwa v1, v28, v173 dst_sel:DWORD dst_unused:UNUSED_PAD src0_sel:WORD_0 src1_sel:DWORD
    v_xor_b32_sdwa v3, v28, v173 dst_sel:DWORD dst_unused:UNUSED_PAD src0_sel:WORD_1 src1_sel:DWORD
    v_mfma_f32_16x16x32_bf16 v[76:79], v[200:203], v[32:35], 0
    ds_read_b64_tr_b16 v[180:181], v0 offset:0
    ds_read_b64_tr_b16 v[182:183], v2 offset:0
    ds_read_b64_tr_b16 v[184:185], v1 offset:0
    ds_read_b64_tr_b16 v[186:187], v3 offset:0
    ds_read_b64_tr_b16 v[188:189], v0 offset:64
    ds_read_b64_tr_b16 v[190:191], v2 offset:64
    v_perm_b32 v32, v29, v29, v168
    v_perm_b32 v33, v29, v29, v169
    v_perm_b32 v34, v29, v29, v170
    v_perm_b32 v35, v29, v29, v171
    ds_read_b64_tr_b16 v[192:193], v1 offset:64
    v_cvt_pk_bf16_f32 v80, v56, v57
    ds_read_b64_tr_b16 v[194:195], v3 offset:64
    v_cvt_pk_bf16_f32 v81, v58, v59
    ds_read_b64_tr_b16 v[196:197], v0 offset:128
    v_cvt_pk_bf16_f32 v82, v60, v61
    ds_read_b64_tr_b16 v[198:199], v2 offset:128
    v_cvt_pk_bf16_f32 v83, v62, v63
    ds_read_b64_tr_b16 v[200:201], v1 offset:128
    v_cvt_pk_bf16_f32 v84, v64, v65
    ds_read_b64_tr_b16 v[202:203], v3 offset:128
    v_cvt_pk_bf16_f32 v85, v66, v67
    v_cvt_pk_bf16_f32 v86, v68, v69
    v_cvt_pk_bf16_f32 v87, v70, v71
    v_permlane32_swap_b32 v80, v82
    v_permlane32_swap_b32 v81, v83
    ds_write_b128 v9, v[80:83] offset:0
    v_cvt_pk_bf16_f32 v88, v72, v73
    v_cvt_pk_bf16_f32 v89, v74, v75
    v_cvt_pk_bf16_f32 v90, v76, v77
    v_cvt_pk_bf16_f32 v91, v78, v79
    v_permlane32_swap_b32 v84, v86
    v_permlane32_swap_b32 v85, v87
    ds_write_b128 v9, v[84:87] offset:64
    v_permlane32_swap_b32 v88, v90
    v_permlane32_swap_b32 v89, v91
    ds_write_b128 v9, v[88:91] offset:128
    s_cmp_lt_u32 s39, s50
    s_cbranch_scc1 L_Pl2
    s_cmp_ge_u32 s39, s37
    s_cbranch_scc1 L_Pn2
L_Pg4:
    v_xor_b32_sdwa v40, v30, v164 dst_sel:DWORD dst_unused:UNUSED_PAD src0_sel:WORD_0 src1_sel:DWORD
    v_xor_b32_sdwa v42, v30, v164 dst_sel:DWORD dst_unused:UNUSED_PAD src0_sel:WORD_1 src1_sel:DWORD
    v_xor_b32_sdwa v41, v30, v173 dst_sel:DWORD dst_unused:UNUSED_PAD src0_sel:WORD_0 src1_sel:DWORD
    v_xor_b32_sdwa v43, v30, v173 dst_sel:DWORD dst_unused:UNUSED_PAD src0_sel:WORD_1 src1_sel:DWORD
    v_perm_b32 v36, v31, v31, v168
    v_perm_b32 v37, v31, v31, v169
    v_perm_b32 v38, v31, v31, v170
    v_perm_b32 v39, v31, v31, v171
    ds_read_b64_tr_b16 v[204:205], v40 offset:0
    ds_read_b64_tr_b16 v[206:207], v42 offset:0
    ds_read_b64_tr_b16 v[208:209], v41 offset:0
    ds_read_b64_tr_b16 v[210:211], v43 offset:0
    ds_read_b64_tr_b16 v[212:213], v40 offset:64
    ds_read_b64_tr_b16 v[214:215], v42 offset:64
    ds_read_b64_tr_b16 v[216:217], v41 offset:64
    ds_read_b64_tr_b16 v[218:219], v43 offset:64
    ds_read_b64_tr_b16 v[220:221], v40 offset:128
    ds_read_b64_tr_b16 v[222:223], v42 offset:128
    ds_read_b64_tr_b16 v[224:225], v41 offset:128
    ds_read_b64_tr_b16 v[226:227], v43 offset:128
L_Pl4:
    v_add_u32 v9, s39, v165
    v_min_u32 v9, s32, v9
    v_add_u32 v9, s53, v9
    s_add_u32 s39, s39, 16
    v_bfe_u32 v10, v9, 1, 2
    v_add_u32 v12, s39, v25
    v_mad_u32_u24 v9, v9, 12, v10
    v_min_u32 v12, s32, v12
    v_xor_b32_sdwa v9, v166, v9 dst_sel:DWORD dst_unused:UNUSED_PAD src0_sel:WORD_0 src1_sel:DWORD
    v_lshl_add_u32 v12, v12, 4, s38
    v_lshl_add_u32 v9, v9, 4, s24
    ds_read_b128 v[28:31], v12
    s_waitcnt lgkmcnt(15)
    v_mfma_f32_16x16x32_bf16 v[56:59], v[180:183], v[32:35], 0
    v_mfma_f32_16x16x32_bf16 v[60:63], v[184:187], v[32:35], 0
    v_mfma_f32_16x16x32_bf16 v[64:67], v[188:191], v[32:35], 0
    v_mfma_f32_16x16x32_bf16 v[68:71], v[192:195], v[32:35], 0
    v_mfma_f32_16x16x32_bf16 v[72:75], v[196:199], v[32:35], 0
    s_waitcnt lgkmcnt(13)
    v_mfma_f32_16x16x32_bf16 v[76:79], v[200:203], v[32:35], 0
    s_waitcnt lgkmcnt(11)
    v_mfma_f32_16x16x32_bf16 v[56:59], v[204:207], v[36:39], v[56:59]
    s_waitcnt lgkmcnt(9)
    v_mfma_f32_16x16x32_bf16 v[60:63], v[208:211], v[36:39], v[60:63]
    s_waitcnt lgkmcnt(7)
    v_mfma_f32_16x16x32_bf16 v[64:67], v[212:215], v[36:39], v[64:67]
    s_waitcnt lgkmcnt(5)
    v_mfma_f32_16x16x32_bf16 v[68:71], v[216:219], v[36:39], v[68:71]
    s_waitcnt lgkmcnt(3)
    v_mfma_f32_16x16x32_bf16 v[72:75], v[220:223], v[36:39], v[72:75]
    s_waitcnt lgkmcnt(0)
    v_xor_b32_sdwa v0, v28, v164 dst_sel:DWORD dst_unused:UNUSED_PAD src0_sel:WORD_0 src1_sel:DWORD
    v_xor_b32_sdwa v2, v28, v164 dst_sel:DWORD dst_unused:UNUSED_PAD src0_sel:WORD_1 src1_sel:DWORD
    v_xor_b32_sdwa v1, v28, v173 dst_sel:DWORD dst_unused:UNUSED_PAD src0_sel:WORD_0 src1_sel:DWORD
    v_xor_b32_sdwa v3, v28, v173 dst_sel:DWORD dst_unused:UNUSED_PAD src0_sel:WORD_1 src1_sel:DWORD
    v_mfma_f32_16x16x32_bf16 v[76:79], v[224:227], v[36:39], v[76:79]
    v_xor_b32_sdwa v40, v30, v164 dst_sel:DWORD dst_unused:UNUSED_PAD src0_sel:WORD_0 src1_sel:DWORD
    v_xor_b32_sdwa v42, v30, v164 dst_sel:DWORD dst_unused:UNUSED_PAD src0_sel:WORD_1 src1_sel:DWORD
    v_xor_b32_sdwa v41, v30, v173 dst_sel:DWORD dst_unused:UNUSED_PAD src0_sel:WORD_0 src1_sel:DWORD
    v_xor_b32_sdwa v43, v30, v173 dst_sel:DWORD dst_unused:UNUSED_PAD src0_sel:WORD_1 src1_sel:DWORD
    ds_read_b64_tr_b16 v[180:181], v0 offset:0
    ds_read_b64_tr_b16 v[182:183], v2 offset:0
    ds_read_b64_tr_b16 v[184:185], v1 offset:0
    ds_read_b64_tr_b16 v[186:187], v3 offset:0
    ds_read_b64_tr_b16 v[188:189], v0 offset:64
    ds_read_b64_tr_b16 v[190:191], v2 offset:64
    v_perm_b32 v32, v29, v29, v168
    v_perm_b32 v33, v29, v29, v169
    v_perm_b32 v34, v29, v29, v170
    v_perm_b32 v35, v29, v29, v171
    ds_read_b64_tr_b16 v[192:193], v1 offset:64
    v_cvt_pk_bf16_f32 v80, v56, v57
    ds_read_b64_tr_b16 v[194:195], v3 offset:64
    v_cvt_pk_bf16_f32 v81, v58, v59
    ds_read_b64_tr_b16 v[196:197], v0 offset:128
    v_cvt_pk_bf16_f32 v82, v60, v61
    ds_read_b64_tr_b16 v[198:199], v2 offset:128
    v_cvt_pk_bf16_f32 v83, v62, v63
    ds_read_b64_tr_b16 v[200:201], v1 offset:128
    v_cvt_pk_bf16_f32 v84, v64, v65
    ds_read_b64_tr_b16 v[202:203], v3 offset:128
    v_cvt_pk_bf16_f32 v85, v66, v67
    ds_read_b64_tr_b16 v[204:205], v40 offset:0
    v_cvt_pk_bf16_f32 v86, v68, v69
    ds_read_b64_tr_b16 v[206:207], v42 offset:0
    v_cvt_pk_bf16_f32 v87, v70, v71
    ds_read_b64_tr_b16 v[208:209], v41 offset:0
    v_permlane32_swap_b32 v80, v82
    ds_read_b64_tr_b16 v[210:211], v43 offset:0
    v_permlane32_swap_b32 v81, v83
    ds_read_b64_tr_b16 v[212:213], v40 offset:64
    ds_write_b128 v9, v[80:83] offset:0
    ds_read_b64_tr_b16 v[214:215], v42 offset:64
    v_cvt_pk_bf16_f32 v88, v72, v73
    ds_read_b64_tr_b16 v[216:217], v41 offset:64
    v_cvt_pk_bf16_f32 v89, v74, v75
    ds_read_b64_tr_b16 v[218:219], v43 offset:64
    v_cvt_pk_bf16_f32 v90, v76, v77
    ds_read_b64_tr_b16 v[220:221], v40 offset:128
    v_cvt_pk_bf16_f32 v91, v78, v79
    ds_read_b64_tr_b16 v[222:223], v42 offset:128
    v_permlane32_swap_b32 v84, v86
    ds_read_b64_tr_b16 v[224:225], v41 offset:128
    v_permlane32_swap_b32 v85, v87
    ds_read_b64_tr_b16 v[226:227], v43 offset:128
    ds_write_b128 v9, v[84:87] offset:64
    v_perm_b32 v36, v31, v31, v168
    v_permlane32_swap_b32 v88, v90
    v_perm_b32 v37, v31, v31, v169
    v_permlane32_swap_b32 v89, v91
    v_perm_b32 v38, v31, v31, v170
    ds_write_b128 v9, v[88:91] offset:128
    v_perm_b32 v39, v31, v31, v171
    s_cmp_lt_u32 s39, s37
    s_cbranch_scc1 L_Pl4
    s_branch L_Pn2
L_Pd:
    s_cmp_eq_u32 s36, 3
    s_cbranch_scc1 L_Pj3
    ds_read_b128 v[180:183], v116 offset:0
    ds_read_b64_tr_b16 a[0:1], v4 offset:0
    ds_read_b64_tr_b16 a[2:3], v4 offset:768
    ds_read_b64_tr_b16 a[4:5], v4 offset:32
    ds_read_b64_tr_b16 a[6:7], v4 offset:800
    ds_read_b64_tr_b16 a[8:9], v5 offset:64
    ds_read_b64_tr_b16 a[10:11], v5 offset:832
    ds_read_b128 v[192:195], v117 offset:0
    ds_read_b64_tr_b16 a[12:13], v4 offset:6208
    ds_read_b64_tr_b16 a[14:15], v4 offset:6976
    ds_read_b128 v[136:139], v172 offset:256
    ds_read_b128 v[184:187], v116 offset:64
    ds_read_b64_tr_b16 a[16:17], v4 offset:6240
    s_add_u32 m0, s44, 37248
    s_nop 0
    buffer_load_dwordx4 v7, s[12:15], s46 offen offset:0 lds
    ds_read_b64_tr_b16 a[18:19], v4 offset:7008
    ds_read_b64_tr_b16 a[20:21], v5 offset:6272
    ds_read_b64_tr_b16 a[22:23], v5 offset:7040
    ds_read_b128 v[196:199], v117 offset:64
    buffer_load_dwordx4 v7, s[12:15], s46 offen offset:1024 lds
    ds_read_b128 v[188:191], v116 offset:128
    ds_read_b64_tr_b16 a[24:25], v4 offset:12416
    ds_read_b64_tr_b16 a[26:27], v4 offset:13184
    ds_read_b64_tr_b16 a[28:29], v4 offset:12448
    buffer_load_dwordx4 v7, s[12:15], s46 offen offset:2048 lds
    ds_read_b64_tr_b16 a[30:31], v4 offset:13216
    ds_read_b64_tr_b16 a[32:33], v5 offset:12480
    ds_read_b64_tr_b16 a[34:35], v5 offset:13248
    ds_read_b128 v[200:203], v117 offset:128
    s_add_u32 m0, s45, 37248
    s_nop 0
    buffer_load_dwordx4 v26, s[12:15], s46 offen offset:0 lds
    s_waitcnt lgkmcnt(7)
    v_xor_b32 v136, v136, v166
    v_xor_b32 v138, v138, v166
    v_lshlrev_b32_sdwa v122, 4, v136 dst_sel:DWORD dst_unused:UNUSED_PAD src0_sel:DWORD src1_sel:WORD_0
    v_lshlrev_b32_sdwa v123, 4, v138 dst_sel:DWORD dst_unused:UNUSED_PAD src0_sel:DWORD src1_sel:WORD_0
    buffer_load_dwordx4 v26, s[12:15], s46 offen offset:1024 lds
    s_add_u32 s46, s46, 18432
    v_mfma_f32_16x16x32_bf16 v[44:47], a[0:3], v[180:183], 0
    s_waitcnt lgkmcnt(1)
    s_barrier
    v_mfma_f32_16x16x32_bf16 v[48:51], a[4:7], v[180:183], 0
    ds_read_b128 v[204:207], v122 offset:0
    s_add_u32 m0, s44, 0
    ds_read_b128 v[136:139], v172 offset:512
    v_mfma_f32_16x16x32_bf16 v[52:55], a[8:11], v[180:183], 0
    buffer_load_dwordx4 v7, s[12:15], s46 offen offset:0 lds
    ds_read_b64_tr_b16 a[36:37], v4 offset:18624
    v_mfma_f32_16x16x32_bf16 v[56:59], a[0:3], v[192:195], 0
    ds_read_b64_tr_b16 a[38:39], v4 offset:19392
    ds_read_b64_tr_b16 a[40:41], v4 offset:18656
    v_mfma_f32_16x16x32_bf16 v[60:63], a[4:7], v[192:195], 0
    ds_read_b128 v[208:211], v122 offset:64
    ds_read_b64_tr_b16 a[42:43], v4 offset:19424
    v_mfma_f32_16x16x32_bf16 v[64:67], a[8:11], v[192:195], 0
    buffer_load_dwordx4 v7, s[12:15], s46 offen offset:1024 lds
    v_mfma_f32_16x16x32_bf16 v[52:55], a[20:23], v[184:187], v[52:55]
    ds_read_b64_tr_b16 a[44:45], v5 offset:18688
    ds_read_b64_tr_b16 a[46:47], v5 offset:19456
    v_mfma_f32_16x16x32_bf16 v[48:51], a[16:19], v[184:187], v[48:51]
    ds_read_b128 v[212:215], v122 offset:128
    ds_read_b64_tr_b16 a[48:49], v4 offset:24832
    v_mfma_f32_16x16x32_bf16 v[44:47], a[12:15], v[184:187], v[44:47]
    buffer_load_dwordx4 v7, s[12:15], s46 offen offset:2048 lds
    ds_read_b64_tr_b16 a[50:51], v4 offset:25600
    v_mfma_f32_16x16x32_bf16 v[64:67], a[20:23], v[196:199], v[64:67]
    ds_read_b64_tr_b16 a[52:53], v4 offset:24864
    ds_read_b64_tr_b16 a[54:55], v4 offset:25632
    v_mfma_f32_16x16x32_bf16 v[60:63], a[16:19], v[196:199], v[60:63]
    ds_read_b128 v[216:219], v123 offset:0
    s_add_u32 m0, s45, 0
    v_mfma_f32_16x16x32_bf16 v[56:59], a[12:15], v[196:199], v[56:59]
    buffer_load_dwordx4 v26, s[12:15], s46 offen offset:0 lds
    ds_read_b64_tr_b16 a[56:57], v5 offset:24896
    ds_read_b64_tr_b16 a[58:59], v5 offset:25664
    v_mfma_f32_16x16x32_bf16 v[44:47], a[24:27], v[188:191], v[44:47]
    ds_read_b64_tr_b16 a[60:61], v4 offset:31040
    ds_read_b64_tr_b16 a[62:63], v4 offset:31808
    v_mfma_f32_16x16x32_bf16 v[48:51], a[28:31], v[188:191], v[48:51]
    ds_read_b128 v[220:223], v123 offset:64
    ds_read_b64_tr_b16 a[64:65], v4 offset:31072
    v_mfma_f32_16x16x32_bf16 v[52:55], a[32:35], v[188:191], v[52:55]
    buffer_load_dwordx4 v26, s[12:15], s46 offen offset:1024 lds
    s_add_u32 s46, s46, 18432
    s_waitcnt lgkmcnt(7)
    v_mfma_f32_16x16x32_bf16 v[56:59], a[24:27], v[200:203], v[56:59]
    ds_read_b64_tr_b16 a[66:67], v4 offset:31840
    ds_read_b64_tr_b16 a[68:69], v5 offset:31104
    ds_read_b64_tr_b16 a[70:71], v5 offset:31872
    v_mfma_f32_16x16x32_bf16 v[60:63], a[28:31], v[200:203], v[60:63]
    ds_read_b128 v[224:227], v123 offset:128
    v_xor_b32 v136, v136, v166
    v_xor_b32 v138, v138, v166
    v_lshlrev_b32_sdwa v128, 4, v136 dst_sel:DWORD dst_unused:UNUSED_PAD src0_sel:DWORD src1_sel:WORD_0
    v_lshlrev_b32_sdwa v129, 4, v138 dst_sel:DWORD dst_unused:UNUSED_PAD src0_sel:DWORD src1_sel:WORD_0
    v_mfma_f32_16x16x32_bf16 v[64:67], a[32:35], v[200:203], v[64:67]
    s_waitcnt vmcnt(5)
    s_waitcnt lgkmcnt(1)
    s_barrier
    v_mfma_f32_16x16x32_bf16 v[44:47], a[36:39], v[204:207], v[44:47]
    ds_read_b64_tr_b16 a[72:73], v4 offset:37248
    ds_read_b64_tr_b16 a[74:75], v4 offset:38016
    v_mfma_f32_16x16x32_bf16 v[48:51], a[40:43], v[204:207], v[48:51]
    ds_read_b128 v[228:231], v128 offset:0
    s_add_u32 m0, s44, 18624
    ds_read_b128 v[136:139], v172 offset:768
    v_mfma_f32_16x16x32_bf16 v[52:55], a[44:47], v[204:207], v[52:55]
    buffer_load_dwordx4 v7, s[12:15], s46 offen offset:0 lds
    v_mfma_f32_16x16x32_bf16 v[52:55], a[56:59], v[208:211], v[52:55]
    ds_read_b64_tr_b16 a[76:77], v4 offset:37280
    ds_read_b64_tr_b16 a[78:79], v4 offset:38048
    v_mfma_f32_16x16x32_bf16 v[48:51], a[52:55], v[208:211], v[48:51]
    ds_read_b128 v[232:235], v128 offset:64
    ds_read_b64_tr_b16 a[80:81], v5 offset:37312
    v_mfma_f32_16x16x32_bf16 v[44:47], a[48:51], v[208:211], v[44:47]
    buffer_load_dwordx4 v7, s[12:15], s46 offen offset:1024 lds
    v_mfma_f32_16x16x32_bf16 v[44:47], a[60:63], v[212:215], v[44:47]
    ds_read_b64_tr_b16 a[82:83], v5 offset:38080
    ds_read_b64_tr_b16 a[84:85], v4 offset:43456
    v_mfma_f32_16x16x32_bf16 v[48:51], a[64:67], v[212:215], v[48:51]
    ds_read_b128 v[236:239], v128 offset:128
    ds_read_b64_tr_b16 a[86:87], v4 offset:44224
    v_mfma_f32_16x16x32_bf16 v[52:55], a[68:71], v[212:215], v[52:55]
    buffer_load_dwordx4 v7, s[12:15], s46 offen offset:2048 lds
    ds_read_b64_tr_b16 a[88:89], v4 offset:43488
    v_mfma_f32_16x16x32_bf16 v[56:59], a[36:39], v[216:219], v[56:59]
    ds_read_b64_tr_b16 a[90:91], v4 offset:44256
    ds_read_b64_tr_b16 a[92:93], v5 offset:43520
    v_mfma_f32_16x16x32_bf16 v[60:63], a[40:43], v[216:219], v[60:63]
    ds_read_b128 v[240:243], v129 offset:0
    s_add_u32 m0, s45, 18624
    v_mfma_f32_16x16x32_bf16 v[64:67], a[44:47], v[216:219], v[64:67]
    buffer_load_dwordx4 v26, s[12:15], s46 offen offset:0 lds
    ds_read_b64_tr_b16 a[94:95], v5 offset:44288
    v_mfma_f32_16x16x32_bf16 v[64:67], a[56:59], v[220:223], v[64:67]
    ds_read_b64_tr_b16 a[96:97], v4 offset:49664
    ds_read_b64_tr_b16 a[98:99], v4 offset:50432
    v_mfma_f32_16x16x32_bf16 v[60:63], a[52:55], v[220:223], v[60:63]
    ds_read_b128 v[244:247], v129 offset:64
    ds_read_b64_tr_b16 a[100:101], v4 offset:49696
    v_mfma_f32_16x16x32_bf16 v[56:59], a[48:51], v[220:223], v[56:59]
    buffer_load_dwordx4 v26, s[12:15], s46 offen offset:1024 lds
    s_add_u32 s46, s46, 18432
    s_waitcnt lgkmcnt(7)
    v_mfma_f32_16x16x32_bf16 v[56:59], a[60:63], v[224:227], v[56:59]
    ds_read_b64_tr_b16 a[102:103], v4 offset:50464
    ds_read_b64_tr_b16 a[104:105], v5 offset:49728
    ds_read_b64_tr_b16 a[106:107], v5 offset:50496
    v_mfma_f32_16x16x32_bf16 v[60:63], a[64:67], v[224:227], v[60:63]
    ds_read_b128 v[248:251], v129 offset:128
    v_xor_b32 v136, v136, v166
    v_xor_b32 v138, v138, v166
    v_lshlrev_b32_sdwa v116, 4, v136 dst_sel:DWORD dst_unused:UNUSED_PAD src0_sel:DWORD src1_sel:WORD_0
    v_lshlrev_b32_sdwa v117, 4, v138 dst_sel:DWORD dst_unused:UNUSED_PAD src0_sel:DWORD src1_sel:WORD_0
    v_mfma_f32_16x16x32_bf16 v[64:67], a[68:71], v[224:227], v[64:67]
    s_waitcnt vmcnt(5)
    s_waitcnt lgkmcnt(1)
    s_barrier
    v_mfma_f32_16x16x32_bf16 v[44:47], a[72:75], v[228:231], v[44:47]
    ds_read_b64_tr_b16 a[108:109], v4 offset:0
    ds_read_b64_tr_b16 a[110:111], v4 offset:768
    v_mfma_f32_16x16x32_bf16 v[48:51], a[76:79], v[228:231], v[48:51]
    ds_read_b128 v[180:183], v116 offset:0
    s_add_u32 m0, s44, 37248
    ds_read_b128 v[136:139], v172 offset:1024
    v_mfma_f32_16x16x32_bf16 v[52:55], a[80:83], v[228:231], v[52:55]
    buffer_load_dwordx4 v7, s[12:15], s46 offen offset:0 lds
    v_mfma_f32_16x16x32_bf16 v[52:55], a[92:95], v[232:235], v[52:55]
    ds_read_b64_tr_b16 a[112:113], v4 offset:32
    ds_read_b64_tr_b16 a[114:115], v4 offset:800
    v_mfma_f32_16x16x32_bf16 v[48:51], a[88:91], v[232:235], v[48:51]
    ds_read_b128 v[184:187], v116 offset:64
    ds_read_b64_tr_b16 a[116:117], v5 offset:64
    v_mfma_f32_16x16x32_bf16 v[44:47], a[84:87], v[232:235], v[44:47]
    buffer_load_dwordx4 v7, s[12:15], s46 offen offset:1024 lds
    v_mfma_f32_16x16x32_bf16 v[44:47], a[96:99], v[236:239], v[44:47]
    ds_read_b64_tr_b16 a[118:119], v5 offset:832
    ds_read_b64_tr_b16 a[120:121], v4 offset:6208
    v_mfma_f32_16x16x32_bf16 v[48:51], a[100:103], v[236:239], v[48:51]
    ds_read_b128 v[188:191], v116 offset:128
    ds_read_b64_tr_b16 a[122:123], v4 offset:6976
    v_mfma_f32_16x16x32_bf16 v[52:55], a[104:107], v[236:239], v[52:55]
    buffer_load_dwordx4 v7, s[12:15], s46 offen offset:2048 lds
    ds_read_b64_tr_b16 a[124:125], v4 offset:6240
    v_mfma_f32_16x16x32_bf16 v[56:59], a[72:75], v[240:243], v[56:59]
    ds_read_b64_tr_b16 a[126:127], v4 offset:7008
    ds_read_b64_tr_b16 a[128:129], v5 offset:6272
    v_mfma_f32_16x16x32_bf16 v[60:63], a[76:79], v[240:243], v[60:63]
    ds_read_b128 v[192:195], v117 offset:0
    s_add_u32 m0, s45, 37248
    v_mfma_f32_16x16x32_bf16 v[64:67], a[80:83], v[240:243], v[64:67]
    buffer_load_dwordx4 v26, s[12:15], s46 offen offset:0 lds
    ds_read_b64_tr_b16 a[130:131], v5 offset:7040
    v_mfma_f32_16x16x32_bf16 v[64:67], a[92:95], v[244:247], v[64:67]
    ds_read_b64_tr_b16 a[132:133], v4 offset:12416
    ds_read_b64_tr_b16 a[134:135], v4 offset:13184
    v_mfma_f32_16x16x32_bf16 v[60:63], a[88:91], v[244:247], v[60:63]
    ds_read_b128 v[196:199], v117 offset:64
    ds_read_b64_tr_b16 a[136:137], v4 offset:12448
    v_mfma_f32_16x16x32_bf16 v[56:59], a[84:87], v[244:247], v[56:59]
    buffer_load_dwordx4 v26, s[12:15], s46 offen offset:1024 lds
    s_add_u32 s46, s46, 18432
    s_waitcnt lgkmcnt(7)
    v_mfma_f32_16x16x32_bf16 v[56:59], a[96:99], v[248:251], v[56:59]
    ds_read_b64_tr_b16 a[138:139], v4 offset:13216
    ds_read_b64_tr_b16 a[140:141], v5 offset:12480
    ds_read_b64_tr_b16 a[142:143], v5 offset:13248
    v_mfma_f32_16x16x32_bf16 v[60:63], a[100:103], v[248:251], v[60:63]
    ds_read_b128 v[200:203], v117 offset:128
    v_xor_b32 v136, v136, v166
    v_xor_b32 v138, v138, v166
    v_lshlrev_b32_sdwa v122, 4, v136 dst_sel:DWORD dst_unused:UNUSED_PAD src0_sel:DWORD src1_sel:WORD_0
    v_lshlrev_b32_sdwa v123, 4, v138 dst_sel:DWORD dst_unused:UNUSED_PAD src0_sel:DWORD src1_sel:WORD_0
    v_mfma_f32_16x16x32_bf16 v[64:67], a[104:107], v[248:251], v[64:67]
    s_waitcnt vmcnt(5)
    s_waitcnt lgkmcnt(1)
    s_barrier
    v_mfma_f32_16x16x32_bf16 v[44:47], a[108:111], v[180:183], v[44:47]
    ds_read_b64_tr_b16 a[0:1], v4 offset:18624
    ds_read_b64_tr_b16 a[2:3], v4 offset:19392
    v_mfma_f32_16x16x32_bf16 v[48:51], a[112:115], v[180:183], v[48:51]
    ds_read_b128 v[204:207], v122 offset:0
    s_add_u32 m0, s44, 0
    ds_read_b128 v[136:139], v172 offset:1280
    v_mfma_f32_16x16x32_bf16 v[52:55], a[116:119], v[180:183], v[52:55]
    buffer_load_dwordx4 v7, s[12:15], s46 offen offset:0 lds
    v_mfma_f32_16x16x32_bf16 v[52:55], a[128:131], v[184:187], v[52:55]
    ds_read_b64_tr_b16 a[4:5], v4 offset:18656
    ds_read_b64_tr_b16 a[6:7], v4 offset:19424
    v_mfma_f32_16x16x32_bf16 v[48:51], a[124:127], v[184:187], v[48:51]
    ds_read_b128 v[208:211], v122 offset:64
    ds_read_b64_tr_b16 a[8:9], v5 offset:18688
    v_mfma_f32_16x16x32_bf16 v[44:47], a[120:123], v[184:187], v[44:47]
    buffer_load_dwordx4 v7, s[12:15], s46 offen offset:1024 lds
    v_mfma_f32_16x16x32_bf16 v[44:47], a[132:135], v[188:191], v[44:47]
    ds_read_b64_tr_b16 a[10:11], v5 offset:19456
    ds_read_b64_tr_b16 a[12:13], v4 offset:24832
    v_mfma_f32_16x16x32_bf16 v[48:51], a[136:139], v[188:191], v[48:51]
    ds_read_b128 v[212:215], v122 offset:128
    ds_read_b64_tr_b16 a[14:15], v4 offset:25600
    v_mfma_f32_16x16x32_bf16 v[52:55], a[140:143], v[188:191], v[52:55]
    buffer_load_dwordx4 v7, s[12:15], s46 offen offset:2048 lds
    ds_read_b64_tr_b16 a[16:17], v4 offset:24864
    v_mfma_f32_16x16x32_bf16 v[56:59], a[108:111], v[192:195], v[56:59]
    ds_read_b64_tr_b16 a[18:19], v4 offset:25632
    ds_read_b64_tr_b16 a[20:21], v5 offset:24896
    v_mfma_f32_16x16x32_bf16 v[60:63], a[112:115], v[192:195], v[60:63]
    ds_read_b128 v[216:219], v123 offset:0
    s_add_u32 m0, s45, 0
    v_mfma_f32_16x16x32_bf16 v[64:67], a[116:119], v[192:195], v[64:67]
    buffer_load_dwordx4 v26, s[12:15], s46 offen offset:0 lds
    ds_read_b64_tr_b16 a[22:23], v5 offset:25664
    v_mfma_f32_16x16x32_bf16 v[64:67], a[128:131], v[196:199], v[64:67]
    ds_read_b64_tr_b16 a[24:25], v4 offset:31040
    ds_read_b64_tr_b16 a[26:27], v4 offset:31808
    v_mfma_f32_16x16x32_bf16 v[60:63], a[124:127], v[196:199], v[60:63]
    ds_read_b128 v[220:223], v123 offset:64
    ds_read_b64_tr_b16 a[28:29], v4 offset:31072
    v_mfma_f32_16x16x32_bf16 v[56:59], a[120:123], v[196:199], v[56:59]
    buffer_load_dwordx4 v26, s[12:15], s46 offen offset:1024 lds
    s_add_u32 s46, s46, 18432
    s_waitcnt lgkmcnt(7)
    v_mfma_f32_16x16x32_bf16 v[56:59], a[132:135], v[200:203], v[56:59]
    ds_read_b64_tr_b16 a[30:31], v4 offset:31840
    ds_read_b64_tr_b16 a[32:33], v5 offset:31104
    ds_read_b64_tr_b16 a[34:35], v5 offset:31872
    v_mfma_f32_16x16x32_bf16 v[60:63], a[136:139], v[200:203], v[60:63]
    ds_read_b128 v[224:227], v123 offset:128
    v_xor_b32 v136, v136, v166
    v_xor_b32 v138, v138, v166
    v_lshlrev_b32_sdwa v128, 4, v136 dst_sel:DWORD dst_unused:UNUSED_PAD src0_sel:DWORD src1_sel:WORD_0
    v_lshlrev_b32_sdwa v129, 4, v138 dst_sel:DWORD dst_unused:UNUSED_PAD src0_sel:DWORD src1_sel:WORD_0
    v_mfma_f32_16x16x32_bf16 v[64:67], a[140:143], v[200:203], v[64:67]
    s_waitcnt vmcnt(5)
    s_waitcnt lgkmcnt(1)
    s_barrier
    v_mfma_f32_16x16x32_bf16 v[44:47], a[0:3], v[204:207], v[44:47]
    ds_read_b64_tr_b16 a[36:37], v4 offset:37248
    ds_read_b64_tr_b16 a[38:39], v4 offset:38016
    v_mfma_f32_16x16x32_bf16 v[48:51], a[4:7], v[204:207], v[48:51]
    ds_read_b128 v[228:231], v128 offset:0
    s_add_u32 m0, s44, 18624
    ds_read_b128 v[136:139], v172 offset:1536
    v_mfma_f32_16x16x32_bf16 v[52:55], a[8:11], v[204:207], v[52:55]
    buffer_load_dwordx4 v7, s[12:15], s46 offen offset:0 lds
    v_mfma_f32_16x16x32_bf16 v[52:55], a[20:23], v[208:211], v[52:55]
    ds_read_b64_tr_b16 a[40:41], v4 offset:37280
    ds_read_b64_tr_b16 a[42:43], v4 offset:38048
    v_mfma_f32_16x16x32_bf16 v[48:51], a[16:19], v[208:211], v[48:51]
    ds_read_b128 v[232:235], v128 offset:64
    ds_read_b64_tr_b16 a[44:45], v5 offset:37312
    v_mfma_f32_16x16x32_bf16 v[44:47], a[12:15], v[208:211], v[44:47]
    buffer_load_dwordx4 v7, s[12:15], s46 offen offset:1024 lds
    v_mfma_f32_16x16x32_bf16 v[44:47], a[24:27], v[212:215], v[44:47]
    ds_read_b64_tr_b16 a[46:47], v5 offset:38080
    ds_read_b64_tr_b16 a[48:49], v4 offset:43456
    v_mfma_f32_16x16x32_bf16 v[48:51], a[28:31], v[212:215], v[48:51]
    ds_read_b128 v[236:239], v128 offset:128
    ds_read_b64_tr_b16 a[50:51], v4 offset:44224
    v_mfma_f32_16x16x32_bf16 v[52:55], a[32:35], v[212:215], v[52:55]
    buffer_load_dwordx4 v7, s[12:15], s46 offen offset:2048 lds
    ds_read_b64_tr_b16 a[52:53], v4 offset:43488
    v_mfma_f32_16x16x32_bf16 v[56:59], a[0:3], v[216:219], v[56:59]
    ds_read_b64_tr_b16 a[54:55], v4 offset:44256
    ds_read_b64_tr_b16 a[56:57], v5 offset:43520
    v_mfma_f32_16x16x32_bf16 v[60:63], a[4:7], v[216:219], v[60:63]
    ds_read_b128 v[240:243], v129 offset:0
    s_add_u32 m0, s45, 18624
    v_mfma_f32_16x16x32_bf16 v[64:67], a[8:11], v[216:219], v[64:67]
    buffer_load_dwordx4 v26, s[12:15], s46 offen offset:0 lds
    ds_read_b64_tr_b16 a[58:59], v5 offset:44288
    v_mfma_f32_16x16x32_bf16 v[64:67], a[20:23], v[220:223], v[64:67]
    ds_read_b64_tr_b16 a[60:61], v4 offset:49664
    ds_read_b64_tr_b16 a[62:63], v4 offset:50432
    v_mfma_f32_16x16x32_bf16 v[60:63], a[16:19], v[220:223], v[60:63]
    ds_read_b128 v[244:247], v129 offset:64
    ds_read_b64_tr_b16 a[64:65], v4 offset:49696
    v_mfma_f32_16x16x32_bf16 v[56:59], a[12:15], v[220:223], v[56:59]
    buffer_load_dwordx4 v26, s[12:15], s46 offen offset:1024 lds
    s_add_u32 s46, s46, 18432
    s_waitcnt lgkmcnt(7)
    v_mfma_f32_16x16x32_bf16 v[56:59], a[24:27], v[224:227], v[56:59]
    ds_read_b64_tr_b16 a[66:67], v4 offset:50464
    ds_read_b64_tr_b16 a[68:69], v5 offset:49728
    ds_read_b64_tr_b16 a[70:71], v5 offset:50496
    v_mfma_f32_16x16x32_bf16 v[60:63], a[28:31], v[224:227], v[60:63]
    ds_read_b128 v[248:251], v129 offset:128
    v_xor_b32 v136, v136, v166
    v_xor_b32 v138, v138, v166
    v_lshlrev_b32_sdwa v116, 4, v136 dst_sel:DWORD dst_unused:UNUSED_PAD src0_sel:DWORD src1_sel:WORD_0
    v_lshlrev_b32_sdwa v117, 4, v138 dst_sel:DWORD dst_unused:UNUSED_PAD src0_sel:DWORD src1_sel:WORD_0
    v_mfma_f32_16x16x32_bf16 v[64:67], a[32:35], v[224:227], v[64:67]
    s_waitcnt vmcnt(5)
    s_waitcnt lgkmcnt(1)
    s_barrier
    v_mfma_f32_16x16x32_bf16 v[44:47], a[36:39], v[228:231], v[44:47]
    ds_read_b64_tr_b16 a[72:73], v4 offset:0
    ds_read_b64_tr_b16 a[74:75], v4 offset:768
    v_mfma_f32_16x16x32_bf16 v[48:51], a[40:43], v[228:231], v[48:51]
    ds_read_b128 v[180:183], v116 offset:0
    s_add_u32 m0, s44, 37248
    ds_read_b128 v[136:139], v172 offset:1792
    v_mfma_f32_16x16x32_bf16 v[52:55], a[44:47], v[228:231], v[52:55]
    buffer_load_dwordx4 v7, s[12:15], s46 offen offset:0 lds
    v_mfma_f32_16x16x32_bf16 v[52:55], a[56:59], v[232:235], v[52:55]
    ds_read_b64_tr_b16 a[76:77], v4 offset:32
    ds_read_b64_tr_b16 a[78:79], v4 offset:800
    v_mfma_f32_16x16x32_bf16 v[48:51], a[52:55], v[232:235], v[48:51]
    ds_read_b128 v[184:187], v116 offset:64
    ds_read_b64_tr_b16 a[80:81], v5 offset:64
    v_mfma_f32_16x16x32_bf16 v[44:47], a[48:51], v[232:235], v[44:47]
    buffer_load_dwordx4 v7, s[12:15], s46 offen offset:1024 lds
    v_mfma_f32_16x16x32_bf16 v[44:47], a[60:63], v[236:239], v[44:47]
    ds_read_b64_tr_b16 a[82:83], v5 offset:832
    ds_read_b64_tr_b16 a[84:85], v4 offset:6208
    v_mfma_f32_16x16x32_bf16 v[48:51], a[64:67], v[236:239], v[48:51]
    ds_read_b128 v[188:191], v116 offset:128
    ds_read_b64_tr_b16 a[86:87], v4 offset:6976
    v_mfma_f32_16x16x32_bf16 v[52:55], a[68:71], v[236:239], v[52:55]
    buffer_load_dwordx4 v7, s[12:15], s46 offen offset:2048 lds
    ds_read_b64_tr_b16 a[88:89], v4 offset:6240
    v_mfma_f32_16x16x32_bf16 v[56:59], a[36:39], v[240:243], v[56:59]
    ds_read_b64_tr_b16 a[90:91], v4 offset:7008
    ds_read_b64_tr_b16 a[92:93], v5 offset:6272
    v_mfma_f32_16x16x32_bf16 v[60:63], a[40:43], v[240:243], v[60:63]
    ds_read_b128 v[192:195], v117 offset:0
    s_add_u32 m0, s45, 37248
    v_mfma_f32_16x16x32_bf16 v[64:67], a[44:47], v[240:243], v[64:67]
    buffer_load_dwordx4 v26, s[12:15], s46 offen offset:0 lds
    ds_read_b64_tr_b16 a[94:95], v5 offset:7040
    v_mfma_f32_16x16x32_bf16 v[64:67], a[56:59], v[244:247], v[64:67]
    ds_read_b64_tr_b16 a[96:97], v4 offset:12416
    ds_read_b64_tr_b16 a[98:99], v4 offset:13184
    v_mfma_f32_16x16x32_bf16 v[60:63], a[52:55], v[244:247], v[60:63]
    ds_read_b128 v[196:199], v117 offset:64
    ds_read_b64_tr_b16 a[100:101], v4 offset:12448
    v_mfma_f32_16x16x32_bf16 v[56:59], a[48:51], v[244:247], v[56:59]
    buffer_load_dwordx4 v26, s[12:15], s46 offen offset:1024 lds
    s_add_u32 s46, s46, 18432
    s_waitcnt lgkmcnt(7)
    v_mfma_f32_16x16x32_bf16 v[56:59], a[60:63], v[248:251], v[56:59]
    ds_read_b64_tr_b16 a[102:103], v4 offset:13216
    ds_read_b64_tr_b16 a[104:105], v5 offset:12480
    ds_read_b64_tr_b16 a[106:107], v5 offset:13248
    v_mfma_f32_16x16x32_bf16 v[60:63], a[64:67], v[248:251], v[60:63]
    ds_read_b128 v[200:203], v117 offset:128
    v_xor_b32 v136, v136, v166
    v_xor_b32 v138, v138, v166
    v_lshlrev_b32_sdwa v122, 4, v136 dst_sel:DWORD dst_unused:UNUSED_PAD src0_sel:DWORD src1_sel:WORD_0
    v_lshlrev_b32_sdwa v123, 4, v138 dst_sel:DWORD dst_unused:UNUSED_PAD src0_sel:DWORD src1_sel:WORD_0
    v_mfma_f32_16x16x32_bf16 v[64:67], a[68:71], v[248:251], v[64:67]
    s_waitcnt vmcnt(5)
    s_waitcnt lgkmcnt(1)
    s_barrier
    v_mfma_f32_16x16x32_bf16 v[44:47], a[72:75], v[180:183], v[44:47]
    ds_read_b64_tr_b16 a[108:109], v4 offset:18624
    v_mfma_f32_16x16x32_bf16 v[48:51], a[76:79], v[180:183], v[48:51]
    ds_read_b128 v[204:207], v122 offset:0
    ds_read_b128 v[136:139], v172 offset:2048
    v_mfma_f32_16x16x32_bf16 v[52:55], a[80:83], v[180:183], v[52:55]
    ds_read_b64_tr_b16 a[110:111], v4 offset:19392
    v_mfma_f32_16x16x32_bf16 v[52:55], a[92:95], v[184:187], v[52:55]
    ds_read_b64_tr_b16 a[112:113], v4 offset:18656
    ds_read_b64_tr_b16 a[114:115], v4 offset:19424
    v_mfma_f32_16x16x32_bf16 v[48:51], a[88:91], v[184:187], v[48:51]
    ds_read_b128 v[208:211], v122 offset:64
    v_mfma_f32_16x16x32_bf16 v[44:47], a[84:87], v[184:187], v[44:47]
    ds_read_b64_tr_b16 a[116:117], v5 offset:18688
    v_mfma_f32_16x16x32_bf16 v[44:47], a[96:99], v[188:191], v[44:47]
    ds_read_b64_tr_b16 a[118:119], v5 offset:19456
    ds_read_b64_tr_b16 a[120:121], v4 offset:24832
    v_mfma_f32_16x16x32_bf16 v[48:51], a[100:103], v[188:191], v[48:51]
    ds_read_b128 v[212:215], v122 offset:128
    v_mfma_f32_16x16x32_bf16 v[52:55], a[104:107], v[188:191], v[52:55]
    ds_read_b64_tr_b16 a[122:123], v4 offset:25600
    ds_read_b64_tr_b16 a[124:125], v4 offset:24864
    v_mfma_f32_16x16x32_bf16 v[56:59], a[72:75], v[192:195], v[56:59]
    ds_read_b64_tr_b16 a[126:127], v4 offset:25632
    ds_read_b64_tr_b16 a[128:129], v5 offset:24896
    v_mfma_f32_16x16x32_bf16 v[60:63], a[76:79], v[192:195], v[60:63]
    ds_read_b128 v[216:219], v123 offset:0
    s_waitcnt lgkmcnt(7)
    v_xor_b32 v136, v136, v166
    v_xor_b32 v138, v138, v166
    v_mfma_f32_16x16x32_bf16 v[64:67], a[80:83], v[192:195], v[64:67]
    ds_read_b64_tr_b16 a[130:131], v5 offset:25664
    v_mfma_f32_16x16x32_bf16 v[64:67], a[92:95], v[196:199], v[64:67]
    ds_read_b64_tr_b16 a[132:133], v4 offset:31040
    ds_read_b64_tr_b16 a[134:135], v4 offset:31808
    v_mfma_f32_16x16x32_bf16 v[60:63], a[88:91], v[196:199], v[60:63]
    ds_read_b128 v[220:223], v123 offset:64
    v_mfma_f32_16x16x32_bf16 v[56:59], a[84:87], v[196:199], v[56:59]
    ds_read_b64_tr_b16 a[136:137], v4 offset:31072
    v_lshlrev_b32_sdwa v128, 4, v136 dst_sel:DWORD dst_unused:UNUSED_PAD src0_sel:DWORD src1_sel:WORD_0
    v_lshlrev_b32_sdwa v129, 4, v138 dst_sel:DWORD dst_unused:UNUSED_PAD src0_sel:DWORD src1_sel:WORD_0
    v_mfma_f32_16x16x32_bf16 v[56:59], a[96:99], v[200:203], v[56:59]
    ds_read_b64_tr_b16 a[138:139], v4 offset:31840
    ds_read_b64_tr_b16 a[140:141], v5 offset:31104
    ds_read_b64_tr_b16 a[142:143], v5 offset:31872
    v_mfma_f32_16x16x32_bf16 v[60:63], a[100:103], v[200:203], v[60:63]
    ds_read_b128 v[224:227], v123 offset:128
    v_mfma_f32_16x16x32_bf16 v[64:67], a[104:107], v[200:203], v[64:67]
    s_waitcnt vmcnt(0)
    s_waitcnt lgkmcnt(1)
    s_barrier
    v_mfma_f32_16x16x32_bf16 v[44:47], a[108:111], v[204:207], v[44:47]
    ds_read_b64_tr_b16 a[0:1], v4 offset:37248
    s_lshl_b32 s55, s55, 1
    v_mfma_f32_16x16x32_bf16 v[48:51], a[112:115], v[204:207], v[48:51]
    ds_read_b128 v[228:231], v128 offset:0
    s_mul_i32 s47, s30, 6656
    v_mfma_f32_16x16x32_bf16 v[52:55], a[116:119], v[204:207], v[52:55]
    ds_read_b64_tr_b16 a[2:3], v4 offset:38016
    v_lshrrev_b32 v38, 4, v6
    s_add_u32 s47, s47, 107616
    v_mfma_f32_16x16x32_bf16 v[52:55], a[128:131], v[208:211], v[52:55]
    ds_read_b64_tr_b16 a[4:5], v4 offset:37280
    ds_read_b64_tr_b16 a[6:7], v4 offset:38048
    v_mfma_f32_16x16x32_bf16 v[48:51], a[124:127], v[208:211], v[48:51]
    ds_read_b128 v[232:235], v128 offset:64
    v_mul_u32_u24 v39, 43, v38
    v_mfma_f32_16x16x32_bf16 v[44:47], a[120:123], v[208:211], v[44:47]
    ds_read_b64_tr_b16 a[8:9], v5 offset:37312
    v_add_u32 v40, 128, v38
    s_lshl_b32 s48, s29, 3
    v_mfma_f32_16x16x32_bf16 v[44:47], a[132:135], v[212:215], v[44:47]
    ds_read_b64_tr_b16 a[10:11], v5 offset:38080
    ds_read_b64_tr_b16 a[12:13], v4 offset:43456
    v_lshrrev_b32 v39, 9, v39
    v_mfma_f32_16x16x32_bf16 v[48:51], a[136:139], v[212:215], v[48:51]
    ds_read_b128 v[236:239], v128 offset:128
    v_mul_u32_u24 v41, 2731, v40
    v_mad_i32_i24 v38, v39, -12, v38
    v_mfma_f32_16x16x32_bf16 v[52:55], a[140:143], v[212:215], v[52:55]
    ds_read_b64_tr_b16 a[14:15], v4 offset:44224
    ds_read_b64_tr_b16 a[16:17], v4 offset:43488
    v_lshrrev_b32 v41, 16, v41
    v_mfma_f32_16x16x32_bf16 v[56:59], a[108:111], v[216:219], v[56:59]
    ds_read_b64_tr_b16 a[18:19], v4 offset:44256
    ds_read_b64_tr_b16 a[20:21], v5 offset:43520
    v_mfma_f32_16x16x32_bf16 v[60:63], a[112:115], v[216:219], v[60:63]
    ds_read_b128 v[240:243], v129 offset:0
    v_add_u32 v39, s48, v39
    v_mul_u32_u24 v42, 24, v41
    v_mfma_f32_16x16x32_bf16 v[64:67], a[116:119], v[216:219], v[64:67]
    ds_read_b64_tr_b16 a[22:23], v5 offset:44288
    v_mul_u32_u24 v18, 208, v39
    v_sub_u32 v40, v40, v42
    v_mfma_f32_16x16x32_bf16 v[64:67], a[128:131], v[220:223], v[64:67]
    ds_read_b64_tr_b16 a[24:25], v4 offset:49664
    ds_read_b64_tr_b16 a[26:27], v4 offset:50432
    v_mfma_f32_16x16x32_bf16 v[60:63], a[124:127], v[220:223], v[60:63]
    ds_read_b128 v[244:247], v129 offset:64
    v_add_u32 v41, s48, v41
    v_mul_u32_u24 v20, s2, v39
    v_mfma_f32_16x16x32_bf16 v[56:59], a[120:123], v[220:223], v[56:59]
    ds_read_b64_tr_b16 a[28:29], v4 offset:49696
    v_lshlrev_b32 v38, 4, v38
    v_mul_u32_u24 v19, 208, v41
    s_waitcnt lgkmcnt(7)
    v_mfma_f32_16x16x32_bf16 v[56:59], a[132:135], v[224:227], v[56:59]
    ds_read_b64_tr_b16 a[30:31], v4 offset:50464
    ds_read_b64_tr_b16 a[32:33], v5 offset:49728
    ds_read_b64_tr_b16 a[34:35], v5 offset:50496
    v_mfma_f32_16x16x32_bf16 v[60:63], a[136:139], v[224:227], v[60:63]
    ds_read_b128 v[248:251], v129 offset:128
    v_mul_u32_u24 v21, s2, v41
    v_lshlrev_b32 v40, 3, v40
    v_mfma_f32_16x16x32_bf16 v[64:67], a[140:143], v[224:227], v[64:67]
    v_add3_u32 v18, v18, s47, v38
    v_add_u32 v20, v20, v38
    v_mfma_f32_16x16x32_bf16 v[44:47], a[0:3], v[228:231], v[44:47]
    v_add3_u32 v19, v19, s47, v40
    v_add_u32 v21, v21, v40
    v_mfma_f32_16x16x32_bf16 v[48:51], a[4:7], v[228:231], v[48:51]
    v_bfe_u32 v38, v6, 4, 2
    v_mfma_f32_16x16x32_bf16 v[52:55], a[8:11], v[228:231], v[52:55]
    v_bfe_u32 v39, v6, 6, 2
    v_lshl_add_u32 v38, v38, 2, v39
    s_waitcnt lgkmcnt(7)
    v_mfma_f32_16x16x32_bf16 v[52:55], a[20:23], v[232:235], v[52:55]
    v_lshrrev_b32 v39, 8, v6
    v_mfma_f32_16x16x32_bf16 v[48:51], a[16:19], v[232:235], v[48:51]
    v_mul_u32_u24 v38, 208, v38
    v_mfma_f32_16x16x32_bf16 v[44:47], a[12:15], v[232:235], v[44:47]
    s_lshl4_add_u32 s49, s48, s47
    v_lshl_add_u32 v38, v39, 3, v38
    s_waitcnt lgkmcnt(6)
    v_mfma_f32_16x16x32_bf16 v[44:47], a[24:27], v[236:239], v[44:47]
    s_lshl2_add_u32 s48, s48, s47
    s_waitcnt lgkmcnt(3)
    v_mfma_f32_16x16x32_bf16 v[48:51], a[28:31], v[236:239], v[48:51]
    v_add_u32 v16, s49, v38
    s_waitcnt lgkmcnt(1)
    v_mfma_f32_16x16x32_bf16 v[52:55], a[32:35], v[236:239], v[52:55]
    v_add_u32 v17, s48, v38
    s_cmp_eq_u32 s36, 1
    s_cbranch_scc1 L_Pe2
    v_mfma_f32_16x16x32_bf16 v[56:59], a[0:3], v[240:243], v[56:59]
    v_mfma_f32_16x16x32_bf16 v[60:63], a[4:7], v[240:243], v[60:63]
    v_mfma_f32_16x16x32_bf16 v[64:67], a[8:11], v[240:243], v[64:67]
    v_mfma_f32_16x16x32_bf16 v[64:67], a[20:23], v[244:247], v[64:67]
    v_cvt_pk_bf16_f32 v32, v44, v45
    v_cvt_pk_bf16_f32 v33, v46, v47
    v_mfma_f32_16x16x32_bf16 v[60:63], a[16:19], v[244:247], v[60:63]
    v_cvt_pk_bf16_f32 v34, v48, v49
    v_cvt_pk_bf16_f32 v35, v50, v51
    v_mfma_f32_16x16x32_bf16 v[56:59], a[12:15], v[244:247], v[56:59]
    v_cvt_pk_bf16_f32 v36, v52, v53
    v_cvt_pk_bf16_f32 v37, v54, v55
    s_waitcnt lgkmcnt(0)
    v_mfma_f32_16x16x32_bf16 v[56:59], a[24:27], v[248:251], v[56:59]
    ds_write_b64 v16, v[32:33] offset:0
    v_mfma_f32_16x16x32_bf16 v[60:63], a[28:31], v[248:251], v[60:63]
    ds_write_b64 v16, v[34:35] offset:32
    v_mfma_f32_16x16x32_bf16 v[64:67], a[32:35], v[248:251], v[64:67]
    ds_write_b64 v17, v[36:37] offset:64
    s_waitcnt lgkmcnt(0)
    s_barrier
    ds_read_b128 v[38:41], v18 offset:0
    ds_read_b64 v[42:43], v19 offset:0
    v_cvt_pk_bf16_f32 v32, v56, v57
    v_cvt_pk_bf16_f32 v33, v58, v59
    v_cvt_pk_bf16_f32 v34, v60, v61
    v_cvt_pk_bf16_f32 v35, v62, v63
    ds_write_b64 v16, v[32:33] offset:3328
    s_waitcnt lgkmcnt(2)
    buffer_store_dwordx4 v[38:41], v20, s[16:19], s31 offen sc1
    s_waitcnt lgkmcnt(1)
    buffer_store_dwordx2 v[42:43], v21, s[16:19], s31 offen sc1
    s_add_u32 s31, s31, s55
    s_cmp_lg_u32 s54, 0
    v_cvt_pk_bf16_f32 v36, v64, v65
    v_cvt_pk_bf16_f32 v37, v66, v67
    ds_write_b64 v16, v[34:35] offset:3360
    ds_write_b64 v17, v[36:37] offset:3392
    s_waitcnt lgkmcnt(0)
    s_barrier
    ds_read_b128 v[24:27], v18 offset:3328
    ds_read_b64 v[28:29], v19 offset:3328
    s_waitcnt lgkmcnt(1)
    buffer_store_dwordx4 v[24:27], v20, s[16:19], s31 offen sc1
    s_waitcnt lgkmcnt(0)
    buffer_store_dwordx2 v[28:29], v21, s[16:19], s31 offen sc1
    s_barrier
    s_cbranch_scc1 L_gS
    s_endpgm
L_Pe2:
    s_cmp_lg_u32 s54, 0
    v_cvt_pk_bf16_f32 v32, v44, v45
    v_cvt_pk_bf16_f32 v33, v46, v47
    v_cvt_pk_bf16_f32 v34, v48, v49
    v_cvt_pk_bf16_f32 v35, v50, v51
    ds_write_b64 v16, v[32:33] offset:0
    v_cvt_pk_bf16_f32 v36, v52, v53
    v_cvt_pk_bf16_f32 v37, v54, v55
    ds_write_b64 v16, v[34:35] offset:32
    ds_write_b64 v17, v[36:37] offset:64
    s_waitcnt lgkmcnt(0)
    s_barrier
    ds_read_b128 v[38:41], v18 offset:0
    ds_read_b64 v[42:43], v19 offset:0
    s_waitcnt lgkmcnt(1)
    buffer_store_dwordx4 v[38:41], v20, s[16:19], s31 offen sc1
    s_waitcnt lgkmcnt(0)
    buffer_store_dwordx2 v[42:43], v21, s[16:19], s31 offen sc1
    s_barrier
    s_barrier
    s_cbranch_scc1 L_gS
    s_endpgm
L_Pj3:
    ds_read_b128 v[180:183], v116 offset:0
    ds_read_b64_tr_b16 a[0:1], v4 offset:0
    ds_read_b64_tr_b16 a[2:3], v4 offset:768
    ds_read_b64_tr_b16 a[4:5], v4 offset:32
    ds_read_b64_tr_b16 a[6:7], v4 offset:800
    ds_read_b64_tr_b16 a[8:9], v5 offset:64
    ds_read_b64_tr_b16 a[10:11], v5 offset:832
    ds_read_b128 v[192:195], v117 offset:0
    ds_read_b128 v[204:207], v118 offset:0
    ds_read_b64_tr_b16 a[12:13], v4 offset:6208
    ds_read_b64_tr_b16 a[14:15], v4 offset:6976
    ds_read_b128 v[136:139], v172 offset:256
    ds_read_b128 v[184:187], v116 offset:64
    ds_read_b64_tr_b16 a[16:17], v4 offset:6240
    s_add_u32 m0, s44, 37248
    s_nop 0
    buffer_load_dwordx4 v7, s[12:15], s46 offen offset:0 lds
    ds_read_b64_tr_b16 a[18:19], v4 offset:7008
    ds_read_b64_tr_b16 a[20:21], v5 offset:6272
    ds_read_b64_tr_b16 a[22:23], v5 offset:7040
    ds_read_b128 v[196:199], v117 offset:64
    buffer_load_dwordx4 v7, s[12:15], s46 offen offset:1024 lds
    ds_read_b128 v[208:211], v118 offset:64
    ds_read_b128 v[188:191], v116 offset:128
    ds_read_b64_tr_b16 a[24:25], v4 offset:12416
    ds_read_b64_tr_b16 a[26:27], v4 offset:13184
    buffer_load_dwordx4 v7, s[12:15], s46 offen offset:2048 lds
    ds_read_b64_tr_b16 a[28:29], v4 offset:12448
    ds_read_b64_tr_b16 a[30:31], v4 offset:13216
    ds_read_b64_tr_b16 a[32:33], v5 offset:12480
    ds_read_b64_tr_b16 a[34:35], v5 offset:13248
    s_add_u32 m0, s45, 37248
    s_nop 0
    buffer_load_dwordx4 v26, s[12:15], s46 offen offset:0 lds
    ds_read_b128 v[200:203], v117 offset:128
    ds_read_b128 v[212:215], v118 offset:128
    s_waitcnt lgkmcnt(7)
    v_xor_b32 v136, v136, v166
    v_xor_b32 v138, v138, v166
    buffer_load_dwordx4 v26, s[12:15], s46 offen offset:1024 lds
    v_lshlrev_b32_sdwa v122, 4, v136 dst_sel:DWORD dst_unused:UNUSED_PAD src0_sel:DWORD src1_sel:WORD_0
    v_lshlrev_b32_sdwa v123, 4, v138 dst_sel:DWORD dst_unused:UNUSED_PAD src0_sel:DWORD src1_sel:WORD_0
    v_lshlrev_b32_sdwa v124, 4, v136 dst_sel:DWORD dst_unused:UNUSED_PAD src0_sel:DWORD src1_sel:WORD_1
    s_add_u32 s46, s46, 18432
    v_mfma_f32_16x16x32_bf16 v[44:47], a[0:3], v[180:183], 0
    s_waitcnt lgkmcnt(2)
    s_barrier
    v_mfma_f32_16x16x32_bf16 v[48:51], a[4:7], v[180:183], 0
    ds_read_b128 v[216:219], v122 offset:0
    ds_read_b128 v[136:139], v172 offset:512
    v_mfma_f32_16x16x32_bf16 v[52:55], a[8:11], v[180:183], 0
    s_add_u32 m0, s44, 0
    ds_read_b64_tr_b16 a[36:37], v4 offset:18624
    v_mfma_f32_16x16x32_bf16 v[56:59], a[0:3], v[192:195], 0
    buffer_load_dwordx4 v7, s[12:15], s46 offen offset:0 lds
    v_mfma_f32_16x16x32_bf16 v[60:63], a[4:7], v[192:195], 0
    ds_read_b128 v[220:223], v122 offset:64
    v_mfma_f32_16x16x32_bf16 v[64:67], a[8:11], v[192:195], 0
    ds_read_b64_tr_b16 a[38:39], v4 offset:19392
    v_mfma_f32_16x16x32_bf16 v[68:71], a[0:3], v[204:207], 0
    ds_read_b64_tr_b16 a[40:41], v4 offset:18656
    ds_read_b64_tr_b16 a[42:43], v4 offset:19424
    v_mfma_f32_16x16x32_bf16 v[72:75], a[4:7], v[204:207], 0
    ds_read_b128 v[224:227], v122 offset:128
    v_mfma_f32_16x16x32_bf16 v[76:79], a[8:11], v[204:207], 0
    buffer_load_dwordx4 v7, s[12:15], s46 offen offset:1024 lds
    v_mfma_f32_16x16x32_bf16 v[52:55], a[20:23], v[184:187], v[52:55]
    ds_read_b64_tr_b16 a[44:45], v5 offset:18688
    ds_read_b64_tr_b16 a[46:47], v5 offset:19456
    v_mfma_f32_16x16x32_bf16 v[48:51], a[16:19], v[184:187], v[48:51]
    ds_read_b128 v[228:231], v123 offset:0
    v_mfma_f32_16x16x32_bf16 v[44:47], a[12:15], v[184:187], v[44:47]
    ds_read_b64_tr_b16 a[48:49], v4 offset:24832
    s_waitcnt lgkmcnt(7)
    v_xor_b32 v136, v136, v166
    v_xor_b32 v138, v138, v166
    v_mfma_f32_16x16x32_bf16 v[64:67], a[20:23], v[196:199], v[64:67]
    ds_read_b64_tr_b16 a[50:51], v4 offset:25600
    ds_read_b64_tr_b16 a[52:53], v4 offset:24864
    v_mfma_f32_16x16x32_bf16 v[60:63], a[16:19], v[196:199], v[60:63]
    ds_read_b128 v[232:235], v123 offset:64
    v_mfma_f32_16x16x32_bf16 v[56:59], a[12:15], v[196:199], v[56:59]
    buffer_load_dwordx4 v7, s[12:15], s46 offen offset:2048 lds
    v_mfma_f32_16x16x32_bf16 v[76:79], a[20:23], v[208:211], v[76:79]
    ds_read_b64_tr_b16 a[54:55], v4 offset:25632
    ds_read_b64_tr_b16 a[56:57], v5 offset:24896
    v_mfma_f32_16x16x32_bf16 v[72:75], a[16:19], v[208:211], v[72:75]
    ds_read_b128 v[236:239], v123 offset:128
    s_add_u32 m0, s45, 0
    v_mfma_f32_16x16x32_bf16 v[68:71], a[12:15], v[208:211], v[68:71]
    buffer_load_dwordx4 v26, s[12:15], s46 offen offset:0 lds
    v_mfma_f32_16x16x32_bf16 v[44:47], a[24:27], v[188:191], v[44:47]
    ds_read_b64_tr_b16 a[58:59], v5 offset:25664
    ds_read_b64_tr_b16 a[60:61], v4 offset:31040
    v_mfma_f32_16x16x32_bf16 v[48:51], a[28:31], v[188:191], v[48:51]
    ds_read_b128 v[240:243], v124 offset:0
    v_lshlrev_b32_sdwa v128, 4, v136 dst_sel:DWORD dst_unused:UNUSED_PAD src0_sel:DWORD src1_sel:WORD_0
    v_lshlrev_b32_sdwa v129, 4, v138 dst_sel:DWORD dst_unused:UNUSED_PAD src0_sel:DWORD src1_sel:WORD_0
    v_mfma_f32_16x16x32_bf16 v[52:55], a[32:35], v[188:191], v[52:55]
    ds_read_b64_tr_b16 a[62:63], v4 offset:31808
    v_mfma_f32_16x16x32_bf16 v[56:59], a[24:27], v[200:203], v[56:59]
    ds_read_b64_tr_b16 a[64:65], v4 offset:31072
    ds_read_b64_tr_b16 a[66:67], v4 offset:31840
    v_mfma_f32_16x16x32_bf16 v[60:63], a[28:31], v[200:203], v[60:63]
    ds_read_b128 v[244:247], v124 offset:64
    v_mfma_f32_16x16x32_bf16 v[64:67], a[32:35], v[200:203], v[64:67]
    buffer_load_dwordx4 v26, s[12:15], s46 offen offset:1024 lds
    s_add_u32 s46, s46, 18432
    v_mfma_f32_16x16x32_bf16 v[68:71], a[24:27], v[212:215], v[68:71]
    ds_read_b64_tr_b16 a[68:69], v5 offset:31104
    ds_read_b64_tr_b16 a[70:71], v5 offset:31872
    v_mfma_f32_16x16x32_bf16 v[72:75], a[28:31], v[212:215], v[72:75]
    ds_read_b128 v[248:251], v124 offset:128
    v_lshlrev_b32_sdwa v130, 4, v136 dst_sel:DWORD dst_unused:UNUSED_PAD src0_sel:DWORD src1_sel:WORD_1
    v_mfma_f32_16x16x32_bf16 v[76:79], a[32:35], v[212:215], v[76:79]
    s_waitcnt vmcnt(5)
    s_waitcnt lgkmcnt(1)
    s_barrier
    v_mfma_f32_16x16x32_bf16 v[44:47], a[36:39], v[216:219], v[44:47]
    ds_read_b64_tr_b16 a[72:73], v4 offset:37248
    v_mfma_f32_16x16x32_bf16 v[48:51], a[40:43], v[216:219], v[48:51]
    ds_read_b128 v[180:183], v128 offset:0
    s_add_u32 m0, s44, 18624
    ds_read_b128 v[136:139], v172 offset:768
    v_mfma_f32_16x16x32_bf16 v[52:55], a[44:47], v[216:219], v[52:55]
    buffer_load_dwordx4 v7, s[12:15], s46 offen offset:0 lds
    v_mfma_f32_16x16x32_bf16 v[52:55], a[56:59], v[220:223], v[52:55]
    ds_read_b64_tr_b16 a[74:75], v4 offset:38016
    v_mfma_f32_16x16x32_bf16 v[48:51], a[52:55], v[220:223], v[48:51]
    ds_read_b128 v[184:187], v128 offset:64
    v_mfma_f32_16x16x32_bf16 v[44:47], a[48:51], v[220:223], v[44:47]
    ds_read_b64_tr_b16 a[76:77], v4 offset:37280
    v_mfma_f32_16x16x32_bf16 v[44:47], a[60:63], v[224:227], v[44:47]
    ds_read_b64_tr_b16 a[78:79], v4 offset:38048
    ds_read_b64_tr_b16 a[80:81], v5 offset:37312
    v_mfma_f32_16x16x32_bf16 v[48:51], a[64:67], v[224:227], v[48:51]
    ds_read_b128 v[188:191], v128 offset:128
    v_mfma_f32_16x16x32_bf16 v[52:55], a[68:71], v[224:227], v[52:55]
    buffer_load_dwordx4 v7, s[12:15], s46 offen offset:1024 lds
    v_mfma_f32_16x16x32_bf16 v[56:59], a[36:39], v[228:231], v[56:59]
    ds_read_b64_tr_b16 a[82:83], v5 offset:38080
    v_mfma_f32_16x16x32_bf16 v[60:63], a[40:43], v[228:231], v[60:63]
    ds_read_b128 v[192:195], v129 offset:0
    v_mfma_f32_16x16x32_bf16 v[64:67], a[44:47], v[228:231], v[64:67]
    ds_read_b64_tr_b16 a[84:85], v4 offset:43456
    ds_read_b64_tr_b16 a[86:87], v4 offset:44224
    v_mfma_f32_16x16x32_bf16 v[64:67], a[56:59], v[232:235], v[64:67]
    buffer_load_dwordx4 v7, s[12:15], s46 offen offset:2048 lds
    v_mfma_f32_16x16x32_bf16 v[60:63], a[52:55], v[232:235], v[60:63]
    ds_read_b128 v[196:199], v129 offset:64
    ds_read_b64_tr_b16 a[88:89], v4 offset:43488
    v_mfma_f32_16x16x32_bf16 v[56:59], a[48:51], v[232:235], v[56:59]
    ds_read_b64_tr_b16 a[90:91], v4 offset:44256
    s_waitcnt lgkmcnt(7)
    v_xor_b32 v136, v136, v166
    v_xor_b32 v138, v138, v166
    v_mfma_f32_16x16x32_bf16 v[56:59], a[60:63], v[236:239], v[56:59]
    ds_read_b64_tr_b16 a[92:93], v5 offset:43520
    v_mfma_f32_16x16x32_bf16 v[60:63], a[64:67], v[236:239], v[60:63]
    ds_read_b128 v[200:203], v129 offset:128
    s_add_u32 m0, s45, 18624
    v_mfma_f32_16x16x32_bf16 v[64:67], a[68:71], v[236:239], v[64:67]
    buffer_load_dwordx4 v26, s[12:15], s46 offen offset:0 lds
    v_mfma_f32_16x16x32_bf16 v[68:71], a[36:39], v[240:243], v[68:71]
    ds_read_b64_tr_b16 a[94:95], v5 offset:44288
    ds_read_b64_tr_b16 a[96:97], v4 offset:49664
    v_mfma_f32_16x16x32_bf16 v[72:75], a[40:43], v[240:243], v[72:75]
    ds_read_b128 v[204:207], v130 offset:0
    v_lshlrev_b32_sdwa v116, 4, v136 dst_sel:DWORD dst_unused:UNUSED_PAD src0_sel:DWORD src1_sel:WORD_0
    v_lshlrev_b32_sdwa v117, 4, v138 dst_sel:DWORD dst_unused:UNUSED_PAD src0_sel:DWORD src1_sel:WORD_0
    v_mfma_f32_16x16x32_bf16 v[76:79], a[44:47], v[240:243], v[76:79]
    ds_read_b64_tr_b16 a[98:99], v4 offset:50432
    v_mfma_f32_16x16x32_bf16 v[76:79], a[56:59], v[244:247], v[76:79]
    ds_read_b64_tr_b16 a[100:101], v4 offset:49696
    ds_read_b64_tr_b16 a[102:103], v4 offset:50464
    v_mfma_f32_16x16x32_bf16 v[72:75], a[52:55], v[244:247], v[72:75]
    ds_read_b128 v[208:211], v130 offset:64
    v_mfma_f32_16x16x32_bf16 v[68:71], a[48:51], v[244:247], v[68:71]
    buffer_load_dwordx4 v26, s[12:15], s46 offen offset:1024 lds
    s_add_u32 s46, s46, 18432
    v_mfma_f32_16x16x32_bf16 v[68:71], a[60:63], v[248:251], v[68:71]
    ds_read_b64_tr_b16 a[104:105], v5 offset:49728
    ds_read_b64_tr_b16 a[106:107], v5 offset:50496
    v_mfma_f32_16x16x32_bf16 v[72:75], a[64:67], v[248:251], v[72:75]
    ds_read_b128 v[212:215], v130 offset:128
    v_lshlrev_b32_sdwa v118, 4, v136 dst_sel:DWORD dst_unused:UNUSED_PAD src0_sel:DWORD src1_sel:WORD_1
    v_mfma_f32_16x16x32_bf16 v[76:79], a[68:71], v[248:251], v[76:79]
    s_waitcnt vmcnt(5)
    s_waitcnt lgkmcnt(1)
    s_barrier
    v_mfma_f32_16x16x32_bf16 v[44:47], a[72:75], v[180:183], v[44:47]
    ds_read_b64_tr_b16 a[108:109], v4 offset:0
    v_mfma_f32_16x16x32_bf16 v[48:51], a[76:79], v[180:183], v[48:51]
    ds_read_b128 v[216:219], v116 offset:0
    s_add_u32 m0, s44, 37248
    ds_read_b128 v[136:139], v172 offset:1024
    v_mfma_f32_16x16x32_bf16 v[52:55], a[80:83], v[180:183], v[52:55]
    buffer_load_dwordx4 v7, s[12:15], s46 offen offset:0 lds
    v_mfma_f32_16x16x32_bf16 v[52:55], a[92:95], v[184:187], v[52:55]
    ds_read_b64_tr_b16 a[110:111], v4 offset:768
    v_mfma_f32_16x16x32_bf16 v[48:51], a[88:91], v[184:187], v[48:51]
    ds_read_b128 v[220:223], v116 offset:64
    v_mfma_f32_16x16x32_bf16 v[44:47], a[84:87], v[184:187], v[44:47]
    ds_read_b64_tr_b16 a[112:113], v4 offset:32
    v_mfma_f32_16x16x32_bf16 v[44:47], a[96:99], v[188:191], v[44:47]
    ds_read_b64_tr_b16 a[114:115], v4 offset:800
    ds_read_b64_tr_b16 a[116:117], v5 offset:64
    v_mfma_f32_16x16x32_bf16 v[48:51], a[100:103], v[188:191], v[48:51]
    ds_read_b128 v[224:227], v116 offset:128
    v_mfma_f32_16x16x32_bf16 v[52:55], a[104:107], v[188:191], v[52:55]
    buffer_load_dwordx4 v7, s[12:15], s46 offen offset:1024 lds
    v_mfma_f32_16x16x32_bf16 v[56:59], a[72:75], v[192:195], v[56:59]
    ds_read_b64_tr_b16 a[118:119], v5 offset:832
    v_mfma_f32_16x16x32_bf16 v[60:63], a[76:79], v[192:195], v[60:63]
    ds_read_b128 v[228:231], v117 offset:0
    v_mfma_f32_16x16x32_bf16 v[64:67], a[80:83], v[192:195], v[64:67]
    ds_read_b64_tr_b16 a[120:121], v4 offset:6208
    ds_read_b64_tr_b16 a[122:123], v4 offset:6976
    v_mfma_f32_16x16x32_bf16 v[64:67], a[92:95], v[196:199], v[64:67]
    buffer_load_dwordx4 v7, s[12:15], s46 offen offset:2048 lds
    v_mfma_f32_16x16x32_bf16 v[60:63], a[88:91], v[196:199], v[60:63]
    ds_read_b128 v[232:235], v117 offset:64
    ds_read_b64_tr_b16 a[124:125], v4 offset:6240
    v_mfma_f32_16x16x32_bf16 v[56:59], a[84:87], v[196:199], v[56:59]
    ds_read_b64_tr_b16 a[126:127], v4 offset:7008
    s_waitcnt lgkmcnt(7)
    v_xor_b32 v136, v136, v166
    v_xor_b32 v138, v138, v166
    v_mfma_f32_16x16x32_bf16 v[56:59], a[96:99], v[200:203], v[56:59]
    ds_read_b64_tr_b16 a[128:129], v5 offset:6272
    v_mfma_f32_16x16x32_bf16 v[60:63], a[100:103], v[200:203], v[60:63]
    ds_read_b128 v[236:239], v117 offset:128
    s_add_u32 m0, s45, 37248
    v_mfma_f32_16x16x32_bf16 v[64:67], a[104:107], v[200:203], v[64:67]
    buffer_load_dwordx4 v26, s[12:15], s46 offen offset:0 lds
    v_mfma_f32_16x16x32_bf16 v[68:71], a[72:75], v[204:207], v[68:71]
    ds_read_b64_tr_b16 a[130:131], v5 offset:7040
    ds_read_b64_tr_b16 a[132:133], v4 offset:12416
    v_mfma_f32_16x16x32_bf16 v[72:75], a[76:79], v[204:207], v[72:75]
    ds_read_b128 v[240:243], v118 offset:0
    v_lshlrev_b32_sdwa v122, 4, v136 dst_sel:DWORD dst_unused:UNUSED_PAD src0_sel:DWORD src1_sel:WORD_0
    v_lshlrev_b32_sdwa v123, 4, v138 dst_sel:DWORD dst_unused:UNUSED_PAD src0_sel:DWORD src1_sel:WORD_0
    v_mfma_f32_16x16x32_bf16 v[76:79], a[80:83], v[204:207], v[76:79]
    ds_read_b64_tr_b16 a[134:135], v4 offset:13184
    v_mfma_f32_16x16x32_bf16 v[76:79], a[92:95], v[208:211], v[76:79]
    ds_read_b64_tr_b16 a[136:137], v4 offset:12448
    ds_read_b64_tr_b16 a[138:139], v4 offset:13216
    v_mfma_f32_16x16x32_bf16 v[72:75], a[88:91], v[208:211], v[72:75]
    ds_read_b128 v[244:247], v118 offset:64
    v_mfma_f32_16x16x32_bf16 v[68:71], a[84:87], v[208:211], v[68:71]
    buffer_load_dwordx4 v26, s[12:15], s46 offen offset:1024 lds
    s_add_u32 s46, s46, 18432
    v_mfma_f32_16x16x32_bf16 v[68:71], a[96:99], v[212:215], v[68:71]
    ds_read_b64_tr_b16 a[140:141], v5 offset:12480
    ds_read_b64_tr_b16 a[142:143], v5 offset:13248
    v_mfma_f32_16x16x32_bf16 v[72:75], a[100:103], v[212:215], v[72:75]
    ds_read_b128 v[248:251], v118 offset:128
    v_lshlrev_b32_sdwa v124, 4, v136 dst_sel:DWORD dst_unused:UNUSED_PAD src0_sel:DWORD src1_sel:WORD_1
    v_mfma_f32_16x16x32_bf16 v[76:79], a[104:107], v[212:215], v[76:79]
    s_waitcnt vmcnt(5)
    s_waitcnt lgkmcnt(1)
    s_barrier
    v_mfma_f32_16x16x32_bf16 v[44:47], a[108:111], v[216:219], v[44:47]
    ds_read_b64_tr_b16 a[0:1], v4 offset:18624
    v_mfma_f32_16x16x32_bf16 v[48:51], a[112:115], v[216:219], v[48:51]
    ds_read_b128 v[180:183], v122 offset:0
    s_add_u32 m0, s44, 0
    ds_read_b128 v[136:139], v172 offset:1280
    v_mfma_f32_16x16x32_bf16 v[52:55], a[116:119], v[216:219], v[52:55]
    buffer_load_dwordx4 v7, s[12:15], s46 offen offset:0 lds
    v_mfma_f32_16x16x32_bf16 v[52:55], a[128:131], v[220:223], v[52:55]
    ds_read_b64_tr_b16 a[2:3], v4 offset:19392
    v_mfma_f32_16x16x32_bf16 v[48:51], a[124:127], v[220:223], v[48:51]
    ds_read_b128 v[184:187], v122 offset:64
    v_mfma_f32_16x16x32_bf16 v[44:47], a[120:123], v[220:223], v[44:47]
    ds_read_b64_tr_b16 a[4:5], v4 offset:18656
    v_mfma_f32_16x16x32_bf16 v[44:47], a[132:135], v[224:227], v[44:47]
    ds_read_b64_tr_b16 a[6:7], v4 offset:19424
    ds_read_b64_tr_b16 a[8:9], v5 offset:18688
    v_mfma_f32_16x16x32_bf16 v[48:51], a[136:139], v[224:227], v[48:51]
    ds_read_b128 v[188:191], v122 offset:128
    v_mfma_f32_16x16x32_bf16 v[52:55], a[140:143], v[224:227], v[52:55]
    buffer_load_dwordx4 v7, s[12:15], s46 offen offset:1024 lds
    v_mfma_f32_16x16x32_bf16 v[56:59], a[108:111], v[228:231], v[56:59]
    ds_read_b64_tr_b16 a[10:11], v5 offset:19456
    v_mfma_f32_16x16x32_bf16 v[60:63], a[112:115], v[228:231], v[60:63]
    ds_read_b128 v[192:195], v123 offset:0
    v_mfma_f32_16x16x32_bf16 v[64:67], a[116:119], v[228:231], v[64:67]
    ds_read_b64_tr_b16 a[12:13], v4 offset:24832
    ds_read_b64_tr_b16 a[14:15], v4 offset:25600
    v_mfma_f32_16x16x32_bf16 v[64:67], a[128:131], v[232:235], v[64:67]
    buffer_load_dwordx4 v7, s[12:15], s46 offen offset:2048 lds
    v_mfma_f32_16x16x32_bf16 v[60:63], a[124:127], v[232:235], v[60:63]
    ds_read_b128 v[196:199], v123 offset:64
    ds_read_b64_tr_b16 a[16:17], v4 offset:24864
    v_mfma_f32_16x16x32_bf16 v[56:59], a[120:123], v[232:235], v[56:59]
    ds_read_b64_tr_b16 a[18:19], v4 offset:25632
    s_waitcnt lgkmcnt(7)
    v_xor_b32 v136, v136, v166
    v_xor_b32 v138, v138, v166
    v_mfma_f32_16x16x32_bf16 v[56:59], a[132:135], v[236:239], v[56:59]
    ds_read_b64_tr_b16 a[20:21], v5 offset:24896
    v_mfma_f32_16x16x32_bf16 v[60:63], a[136:139], v[236:239], v[60:63]
    ds_read_b128 v[200:203], v123 offset:128
    s_add_u32 m0, s45, 0
    v_mfma_f32_16x16x32_bf16 v[64:67], a[140:143], v[236:239], v[64:67]
    buffer_load_dwordx4 v26, s[12:15], s46 offen offset:0 lds
    v_mfma_f32_16x16x32_bf16 v[68:71], a[108:111], v[240:243], v[68:71]
    ds_read_b64_tr_b16 a[22:23], v5 offset:25664
    ds_read_b64_tr_b16 a[24:25], v4 offset:31040
    v_mfma_f32_16x16x32_bf16 v[72:75], a[112:115], v[240:243], v[72:75]
    ds_read_b128 v[204:207], v124 offset:0
    v_lshlrev_b32_sdwa v128, 4, v136 dst_sel:DWORD dst_unused:UNUSED_PAD src0_sel:DWORD src1_sel:WORD_0
    v_lshlrev_b32_sdwa v129, 4, v138 dst_sel:DWORD dst_unused:UNUSED_PAD src0_sel:DWORD src1_sel:WORD_0
    v_mfma_f32_16x16x32_bf16 v[76:79], a[116:119], v[240:243], v[76:79]
    ds_read_b64_tr_b16 a[26:27], v4 offset:31808
    v_mfma_f32_16x16x32_bf16 v[76:79], a[128:131], v[244:247], v[76:79]
    ds_read_b64_tr_b16 a[28:29], v4 offset:31072
    ds_read_b64_tr_b16 a[30:31], v4 offset:31840
    v_mfma_f32_16x16x32_bf16 v[72:75], a[124:127], v[244:247], v[72:75]
    ds_read_b128 v[208:211], v124 offset:64
    v_mfma_f32_16x16x32_bf16 v[68:71], a[120:123], v[244:247], v[68:71]
    buffer_load_dwordx4 v26, s[12:15], s46 offen offset:1024 lds
    s_add_u32 s46, s46, 18432
    v_mfma_f32_16x16x32_bf16 v[68:71], a[132:135], v[248:251], v[68:71]
    ds_read_b64_tr_b16 a[32:33], v5 offset:31104
    ds_read_b64_tr_b16 a[34:35], v5 offset:31872
    v_mfma_f32_16x16x32_bf16 v[72:75], a[136:139], v[248:251], v[72:75]
    ds_read_b128 v[212:215], v124 offset:128
    v_lshlrev_b32_sdwa v130, 4, v136 dst_sel:DWORD dst_unused:UNUSED_PAD src0_sel:DWORD src1_sel:WORD_1
    v_mfma_f32_16x16x32_bf16 v[76:79], a[140:143], v[248:251], v[76:79]
    s_waitcnt vmcnt(5)
    s_waitcnt lgkmcnt(1)
    s_barrier
    v_mfma_f32_16x16x32_bf16 v[44:47], a[0:3], v[180:183], v[44:47]
    ds_read_b64_tr_b16 a[36:37], v4 offset:37248
    v_mfma_f32_16x16x32_bf16 v[48:51], a[4:7], v[180:183], v[48:51]
    ds_read_b128 v[216:219], v128 offset:0
    s_add_u32 m0, s44, 18624
    ds_read_b128 v[136:139], v172 offset:1536
    v_mfma_f32_16x16x32_bf16 v[52:55], a[8:11], v[180:183], v[52:55]
    buffer_load_dwordx4 v7, s[12:15], s46 offen offset:0 lds
    v_mfma_f32_16x16x32_bf16 v[52:55], a[20:23], v[184:187], v[52:55]
    ds_read_b64_tr_b16 a[38:39], v4 offset:38016
    v_mfma_f32_16x16x32_bf16 v[48:51], a[16:19], v[184:187], v[48:51]
    ds_read_b128 v[220:223], v128 offset:64
    v_mfma_f32_16x16x32_bf16 v[44:47], a[12:15], v[184:187], v[44:47]
    ds_read_b64_tr_b16 a[40:41], v4 offset:37280
    v_mfma_f32_16x16x32_bf16 v[44:47], a[24:27], v[188:191], v[44:47]
    ds_read_b64_tr_b16 a[42:43], v4 offset:38048
    ds_read_b64_tr_b16 a[44:45], v5 offset:37312
    v_mfma_f32_16x16x32_bf16 v[48:51], a[28:31], v[188:191], v[48:51]
    ds_read_b128 v[224:227], v128 offset:128
    v_mfma_f32_16x16x32_bf16 v[52:55], a[32:35], v[188:191], v[52:55]
    buffer_load_dwordx4 v7, s[12:15], s46 offen offset:1024 lds
    v_mfma_f32_16x16x32_bf16 v[56:59], a[0:3], v[192:195], v[56:59]
    ds_read_b64_tr_b16 a[46:47], v5 offset:38080
    v_mfma_f32_16x16x32_bf16 v[60:63], a[4:7], v[192:195], v[60:63]
    ds_read_b128 v[228:231], v129 offset:0
    v_mfma_f32_16x16x32_bf16 v[64:67], a[8:11], v[192:195], v[64:67]
    ds_read_b64_tr_b16 a[48:49], v4 offset:43456
    ds_read_b64_tr_b16 a[50:51], v4 offset:44224
    v_mfma_f32_16x16x32_bf16 v[64:67], a[20:23], v[196:199], v[64:67]
    buffer_load_dwordx4 v7, s[12:15], s46 offen offset:2048 lds
    v_mfma_f32_16x16x32_bf16 v[60:63], a[16:19], v[196:199], v[60:63]
    ds_read_b128 v[232:235], v129 offset:64
    ds_read_b64_tr_b16 a[52:53], v4 offset:43488
    v_mfma_f32_16x16x32_bf16 v[56:59], a[12:15], v[196:199], v[56:59]
    ds_read_b64_tr_b16 a[54:55], v4 offset:44256
    s_waitcnt lgkmcnt(7)
    v_xor_b32 v136, v136, v166
    v_xor_b32 v138, v138, v166
    v_mfma_f32_16x16x32_bf16 v[56:59], a[24:27], v[200:203], v[56:59]
    ds_read_b64_tr_b16 a[56:57], v5 offset:43520
    v_mfma_f32_16x16x32_bf16 v[60:63], a[28:31], v[200:203], v[60:63]
    ds_read_b128 v[236:239], v129 offset:128
    s_add_u32 m0, s45, 18624
    v_mfma_f32_16x16x32_bf16 v[64:67], a[32:35], v[200:203], v[64:67]
    buffer_load_dwordx4 v26, s[12:15], s46 offen offset:0 lds
    v_mfma_f32_16x16x32_bf16 v[68:71], a[0:3], v[204:207], v[68:71]
    ds_read_b64_tr_b16 a[58:59], v5 offset:44288
    ds_read_b64_tr_b16 a[60:61], v4 offset:49664
    v_mfma_f32_16x16x32_bf16 v[72:75], a[4:7], v[204:207], v[72:75]
    ds_read_b128 v[240:243], v130 offset:0
    v_lshlrev_b32_sdwa v116, 4, v136 dst_sel:DWORD dst_unused:UNUSED_PAD src0_sel:DWORD src1_sel:WORD_0
    v_lshlrev_b32_sdwa v117, 4, v138 dst_sel:DWORD dst_unused:UNUSED_PAD src0_sel:DWORD src1_sel:WORD_0
    v_mfma_f32_16x16x32_bf16 v[76:79], a[8:11], v[204:207], v[76:79]
    ds_read_b64_tr_b16 a[62:63], v4 offset:50432
    v_mfma_f32_16x16x32_bf16 v[76:79], a[20:23], v[208:211], v[76:79]
    ds_read_b64_tr_b16 a[64:65], v4 offset:49696
    ds_read_b64_tr_b16 a[66:67], v4 offset:50464
    v_mfma_f32_16x16x32_bf16 v[72:75], a[16:19], v[208:211], v[72:75]
    ds_read_b128 v[244:247], v130 offset:64
    v_mfma_f32_16x16x32_bf16 v[68:71], a[12:15], v[208:211], v[68:71]
    buffer_load_dwordx4 v26, s[12:15], s46 offen offset:1024 lds
    s_add_u32 s46, s46, 18432
    v_mfma_f32_16x16x32_bf16 v[68:71], a[24:27], v[212:215], v[68:71]
    ds_read_b64_tr_b16 a[68:69], v5 offset:49728
    ds_read_b64_tr_b16 a[70:71], v5 offset:50496
    v_mfma_f32_16x16x32_bf16 v[72:75], a[28:31], v[212:215], v[72:75]
    ds_read_b128 v[248:251], v130 offset:128
    v_lshlrev_b32_sdwa v118, 4, v136 dst_sel:DWORD dst_unused:UNUSED_PAD src0_sel:DWORD src1_sel:WORD_1
    v_mfma_f32_16x16x32_bf16 v[76:79], a[32:35], v[212:215], v[76:79]
    s_waitcnt vmcnt(5)
    s_waitcnt lgkmcnt(1)
    s_barrier
    v_mfma_f32_16x16x32_bf16 v[44:47], a[36:39], v[216:219], v[44:47]
    ds_read_b64_tr_b16 a[72:73], v4 offset:0
    v_mfma_f32_16x16x32_bf16 v[48:51], a[40:43], v[216:219], v[48:51]
    ds_read_b128 v[180:183], v116 offset:0
    s_add_u32 m0, s44, 37248
    ds_read_b128 v[136:139], v172 offset:1792
    v_mfma_f32_16x16x32_bf16 v[52:55], a[44:47], v[216:219], v[52:55]
    buffer_load_dwordx4 v7, s[12:15], s46 offen offset:0 lds
    v_mfma_f32_16x16x32_bf16 v[52:55], a[56:59], v[220:223], v[52:55]
    ds_read_b64_tr_b16 a[74:75], v4 offset:768
    v_mfma_f32_16x16x32_bf16 v[48:51], a[52:55], v[220:223], v[48:51]
    ds_read_b128 v[184:187], v116 offset:64
    v_mfma_f32_16x16x32_bf16 v[44:47], a[48:51], v[220:223], v[44:47]
    ds_read_b64_tr_b16 a[76:77], v4 offset:32
    v_mfma_f32_16x16x32_bf16 v[44:47], a[60:63], v[224:227], v[44:47]
    ds_read_b64_tr_b16 a[78:79], v4 offset:800
    ds_read_b64_tr_b16 a[80:81], v5 offset:64
    v_mfma_f32_16x16x32_bf16 v[48:51], a[64:67], v[224:227], v[48:51]
    ds_read_b128 v[188:191], v116 offset:128
    v_mfma_f32_16x16x32_bf16 v[52:55], a[68:71], v[224:227], v[52:55]
    buffer_load_dwordx4 v7, s[12:15], s46 offen offset:1024 lds
    v_mfma_f32_16x16x32_bf16 v[56:59], a[36:39], v[228:231], v[56:59]
    ds_read_b64_tr_b16 a[82:83], v5 offset:832
    v_mfma_f32_16x16x32_bf16 v[60:63], a[40:43], v[228:231], v[60:63]
    ds_read_b128 v[192:195], v117 offset:0
    v_mfma_f32_16x16x32_bf16 v[64:67], a[44:47], v[228:231], v[64:67]
    ds_read_b64_tr_b16 a[84:85], v4 offset:6208
    ds_read_b64_tr_b16 a[86:87], v4 offset:6976
    v_mfma_f32_16x16x32_bf16 v[64:67], a[56:59], v[232:235], v[64:67]
    buffer_load_dwordx4 v7, s[12:15], s46 offen offset:2048 lds
    v_mfma_f32_16x16x32_bf16 v[60:63], a[52:55], v[232:235], v[60:63]
    ds_read_b128 v[196:199], v117 offset:64
    ds_read_b64_tr_b16 a[88:89], v4 offset:6240
    v_mfma_f32_16x16x32_bf16 v[56:59], a[48:51], v[232:235], v[56:59]
    ds_read_b64_tr_b16 a[90:91], v4 offset:7008
    s_waitcnt lgkmcnt(7)
    v_xor_b32 v136, v136, v166
    v_xor_b32 v138, v138, v166
    v_mfma_f32_16x16x32_bf16 v[56:59], a[60:63], v[236:239], v[56:59]
    ds_read_b64_tr_b16 a[92:93], v5 offset:6272
    v_mfma_f32_16x16x32_bf16 v[60:63], a[64:67], v[236:239], v[60:63]
    ds_read_b128 v[200:203], v117 offset:128
    s_add_u32 m0, s45, 37248
    v_mfma_f32_16x16x32_bf16 v[64:67], a[68:71], v[236:239], v[64:67]
    buffer_load_dwordx4 v26, s[12:15], s46 offen offset:0 lds
    v_mfma_f32_16x16x32_bf16 v[68:71], a[36:39], v[240:243], v[68:71]
    ds_read_b64_tr_b16 a[94:95], v5 offset:7040
    ds_read_b64_tr_b16 a[96:97], v4 offset:12416
    v_mfma_f32_16x16x32_bf16 v[72:75], a[40:43], v[240:243], v[72:75]
    ds_read_b128 v[204:207], v118 offset:0
    v_lshlrev_b32_sdwa v122, 4, v136 dst_sel:DWORD dst_unused:UNUSED_PAD src0_sel:DWORD src1_sel:WORD_0
    v_lshlrev_b32_sdwa v123, 4, v138 dst_sel:DWORD dst_unused:UNUSED_PAD src0_sel:DWORD src1_sel:WORD_0
    v_mfma_f32_16x16x32_bf16 v[76:79], a[44:47], v[240:243], v[76:79]
    ds_read_b64_tr_b16 a[98:99], v4 offset:13184
    v_mfma_f32_16x16x32_bf16 v[76:79], a[56:59], v[244:247], v[76:79]
    ds_read_b64_tr_b16 a[100:101], v4 offset:12448
    ds_read_b64_tr_b16 a[102:103], v4 offset:13216
    v_mfma_f32_16x16x32_bf16 v[72:75], a[52:55], v[244:247], v[72:75]
    ds_read_b128 v[208:211], v118 offset:64
    v_mfma_f32_16x16x32_bf16 v[68:71], a[48:51], v[244:247], v[68:71]
    buffer_load_dwordx4 v26, s[12:15], s46 offen offset:1024 lds
    s_add_u32 s46, s46, 18432
    v_mfma_f32_16x16x32_bf16 v[68:71], a[60:63], v[248:251], v[68:71]
    ds_read_b64_tr_b16 a[104:105], v5 offset:12480
    ds_read_b64_tr_b16 a[106:107], v5 offset:13248
    v_mfma_f32_16x16x32_bf16 v[72:75], a[64:67], v[248:251], v[72:75]
    ds_read_b128 v[212:215], v118 offset:128
    v_lshlrev_b32_sdwa v124, 4, v136 dst_sel:DWORD dst_unused:UNUSED_PAD src0_sel:DWORD src1_sel:WORD_1
    v_mfma_f32_16x16x32_bf16 v[76:79], a[68:71], v[248:251], v[76:79]
    s_waitcnt vmcnt(5)
    s_waitcnt lgkmcnt(1)
    s_barrier
    v_mfma_f32_16x16x32_bf16 v[44:47], a[72:75], v[180:183], v[44:47]
    ds_read_b64_tr_b16 a[108:109], v4 offset:18624
    v_mfma_f32_16x16x32_bf16 v[48:51], a[76:79], v[180:183], v[48:51]
    ds_read_b128 v[216:219], v122 offset:0
    ds_read_b128 v[136:139], v172 offset:2048
    v_mfma_f32_16x16x32_bf16 v[52:55], a[80:83], v[180:183], v[52:55]
    ds_read_b64_tr_b16 a[110:111], v4 offset:19392
    v_mfma_f32_16x16x32_bf16 v[52:55], a[92:95], v[184:187], v[52:55]
    ds_read_b64_tr_b16 a[112:113], v4 offset:18656
    v_mfma_f32_16x16x32_bf16 v[48:51], a[88:91], v[184:187], v[48:51]
    ds_read_b128 v[220:223], v122 offset:64
    v_mfma_f32_16x16x32_bf16 v[44:47], a[84:87], v[184:187], v[44:47]
    ds_read_b64_tr_b16 a[114:115], v4 offset:19424
    v_mfma_f32_16x16x32_bf16 v[44:47], a[96:99], v[188:191], v[44:47]
    ds_read_b64_tr_b16 a[116:117], v5 offset:18688
    v_mfma_f32_16x16x32_bf16 v[48:51], a[100:103], v[188:191], v[48:51]
    ds_read_b128 v[224:227], v122 offset:128
    v_mfma_f32_16x16x32_bf16 v[52:55], a[104:107], v[188:191], v[52:55]
    ds_read_b64_tr_b16 a[118:119], v5 offset:19456
    v_mfma_f32_16x16x32_bf16 v[56:59], a[72:75], v[192:195], v[56:59]
    ds_read_b64_tr_b16 a[120:121], v4 offset:24832
    v_mfma_f32_16x16x32_bf16 v[60:63], a[76:79], v[192:195], v[60:63]
    ds_read_b128 v[228:231], v123 offset:0
    v_mfma_f32_16x16x32_bf16 v[64:67], a[80:83], v[192:195], v[64:67]
    ds_read_b64_tr_b16 a[122:123], v4 offset:25600
    s_waitcnt lgkmcnt(7)
    v_xor_b32 v136, v136, v166
    v_xor_b32 v138, v138, v166
    v_mfma_f32_16x16x32_bf16 v[64:67], a[92:95], v[196:199], v[64:67]
    ds_read_b64_tr_b16 a[124:125], v4 offset:24864
    v_mfma_f32_16x16x32_bf16 v[60:63], a[88:91], v[196:199], v[60:63]
    ds_read_b128 v[232:235], v123 offset:64
    v_mfma_f32_16x16x32_bf16 v[56:59], a[84:87], v[196:199], v[56:59]
    ds_read_b64_tr_b16 a[126:127], v4 offset:25632
    v_mfma_f32_16x16x32_bf16 v[56:59], a[96:99], v[200:203], v[56:59]
    ds_read_b64_tr_b16 a[128:129], v5 offset:24896
    v_mfma_f32_16x16x32_bf16 v[60:63], a[100:103], v[200:203], v[60:63]
    ds_read_b128 v[236:239], v123 offset:128
    v_mfma_f32_16x16x32_bf16 v[64:67], a[104:107], v[200:203], v[64:67]
    ds_read_b64_tr_b16 a[130:131], v5 offset:25664
    v_lshlrev_b32_sdwa v128, 4, v136 dst_sel:DWORD dst_unused:UNUSED_PAD src0_sel:DWORD src1_sel:WORD_0
    v_lshlrev_b32_sdwa v129, 4, v138 dst_sel:DWORD dst_unused:UNUSED_PAD src0_sel:DWORD src1_sel:WORD_0
    v_mfma_f32_16x16x32_bf16 v[68:71], a[72:75], v[204:207], v[68:71]
    ds_read_b64_tr_b16 a[132:133], v4 offset:31040
    v_mfma_f32_16x16x32_bf16 v[72:75], a[76:79], v[204:207], v[72:75]
    ds_read_b128 v[240:243], v124 offset:0
    v_mfma_f32_16x16x32_bf16 v[76:79], a[80:83], v[204:207], v[76:79]
    ds_read_b64_tr_b16 a[134:135], v4 offset:31808
    v_mfma_f32_16x16x32_bf16 v[76:79], a[92:95], v[208:211], v[76:79]
    ds_read_b64_tr_b16 a[136:137], v4 offset:31072
    v_mfma_f32_16x16x32_bf16 v[72:75], a[88:91], v[208:211], v[72:75]
    ds_read_b128 v[244:247], v124 offset:64
    v_mfma_f32_16x16x32_bf16 v[68:71], a[84:87], v[208:211], v[68:71]
    ds_read_b64_tr_b16 a[138:139], v4 offset:31840
    v_lshlrev_b32_sdwa v130, 4, v136 dst_sel:DWORD dst_unused:UNUSED_PAD src0_sel:DWORD src1_sel:WORD_1
    v_mfma_f32_16x16x32_bf16 v[68:71], a[96:99], v[212:215], v[68:71]
    ds_read_b64_tr_b16 a[140:141], v5 offset:31104
    ds_read_b64_tr_b16 a[142:143], v5 offset:31872
    v_mfma_f32_16x16x32_bf16 v[72:75], a[100:103], v[212:215], v[72:75]
    ds_read_b128 v[248:251], v124 offset:128
    v_mfma_f32_16x16x32_bf16 v[76:79], a[104:107], v[212:215], v[76:79]
    s_waitcnt vmcnt(0)
    s_waitcnt lgkmcnt(1)
    s_barrier
    v_mfma_f32_16x16x32_bf16 v[44:47], a[108:111], v[216:219], v[44:47]
    ds_read_b64_tr_b16 a[0:1], v4 offset:37248
    s_lshl_b32 s55, s55, 1
    v_mfma_f32_16x16x32_bf16 v[48:51], a[112:115], v[216:219], v[48:51]
    ds_read_b128 v[180:183], v128 offset:0
    s_mul_i32 s47, s30, 6656
    v_mfma_f32_16x16x32_bf16 v[52:55], a[116:119], v[216:219], v[52:55]
    ds_read_b64_tr_b16 a[2:3], v4 offset:38016
    v_lshrrev_b32 v38, 4, v6
    v_mfma_f32_16x16x32_bf16 v[52:55], a[128:131], v[220:223], v[52:55]
    ds_read_b64_tr_b16 a[4:5], v4 offset:37280
    s_add_u32 s47, s47, 107616
    v_mfma_f32_16x16x32_bf16 v[48:51], a[124:127], v[220:223], v[48:51]
    ds_read_b128 v[184:187], v128 offset:64
    v_mul_u32_u24 v39, 43, v38
    v_mfma_f32_16x16x32_bf16 v[44:47], a[120:123], v[220:223], v[44:47]
    ds_read_b64_tr_b16 a[6:7], v4 offset:38048
    v_add_u32 v40, 128, v38
    v_mfma_f32_16x16x32_bf16 v[44:47], a[132:135], v[224:227], v[44:47]
    ds_read_b64_tr_b16 a[8:9], v5 offset:37312
    s_lshl_b32 s48, s29, 3
    v_mfma_f32_16x16x32_bf16 v[48:51], a[136:139], v[224:227], v[48:51]
    ds_read_b128 v[188:191], v128 offset:128
    v_lshrrev_b32 v39, 9, v39
    v_mfma_f32_16x16x32_bf16 v[52:55], a[140:143], v[224:227], v[52:55]
    ds_read_b64_tr_b16 a[10:11], v5 offset:38080
    v_mul_u32_u24 v41, 2731, v40
    v_mfma_f32_16x16x32_bf16 v[56:59], a[108:111], v[228:231], v[56:59]
    ds_read_b64_tr_b16 a[12:13], v4 offset:43456
    v_mad_i32_i24 v38, v39, -12, v38
    v_mfma_f32_16x16x32_bf16 v[60:63], a[112:115], v[228:231], v[60:63]
    ds_read_b128 v[192:195], v129 offset:0
    v_lshrrev_b32 v41, 16, v41
    v_mfma_f32_16x16x32_bf16 v[64:67], a[116:119], v[228:231], v[64:67]
    ds_read_b64_tr_b16 a[14:15], v4 offset:44224
    v_add_u32 v39, s48, v39
    v_mfma_f32_16x16x32_bf16 v[64:67], a[128:131], v[232:235], v[64:67]
    ds_read_b64_tr_b16 a[16:17], v4 offset:43488
    v_mul_u32_u24 v42, 24, v41
    v_mfma_f32_16x16x32_bf16 v[60:63], a[124:127], v[232:235], v[60:63]
    ds_read_b128 v[196:199], v129 offset:64
    v_mul_u32_u24 v18, 208, v39
    v_mfma_f32_16x16x32_bf16 v[56:59], a[120:123], v[232:235], v[56:59]
    ds_read_b64_tr_b16 a[18:19], v4 offset:44256
    v_sub_u32 v40, v40, v42
    v_mfma_f32_16x16x32_bf16 v[56:59], a[132:135], v[236:239], v[56:59]
    ds_read_b64_tr_b16 a[20:21], v5 offset:43520
    v_add_u32 v41, s48, v41
    v_mfma_f32_16x16x32_bf16 v[60:63], a[136:139], v[236:239], v[60:63]
    ds_read_b128 v[200:203], v129 offset:128
    v_mul_u32_u24 v20, s2, v39
    v_mfma_f32_16x16x32_bf16 v[64:67], a[140:143], v[236:239], v[64:67]
    ds_read_b64_tr_b16 a[22:23], v5 offset:44288
    v_lshlrev_b32 v38, 4, v38
    v_mfma_f32_16x16x32_bf16 v[68:71], a[108:111], v[240:243], v[68:71]
    ds_read_b64_tr_b16 a[24:25], v4 offset:49664
    v_mul_u32_u24 v19, 208, v41
    v_mfma_f32_16x16x32_bf16 v[72:75], a[112:115], v[240:243], v[72:75]
    ds_read_b128 v[204:207], v130 offset:0
    v_mul_u32_u24 v21, s2, v41
    v_mfma_f32_16x16x32_bf16 v[76:79], a[116:119], v[240:243], v[76:79]
    ds_read_b64_tr_b16 a[26:27], v4 offset:50432
    v_lshlrev_b32 v40, 3, v40
    v_mfma_f32_16x16x32_bf16 v[76:79], a[128:131], v[244:247], v[76:79]
    ds_read_b64_tr_b16 a[28:29], v4 offset:49696
    v_add3_u32 v18, v18, s47, v38
    v_mfma_f32_16x16x32_bf16 v[72:75], a[124:127], v[244:247], v[72:75]
    ds_read_b128 v[208:211], v130 offset:64
    v_add_u32 v20, v20, v38
    v_mfma_f32_16x16x32_bf16 v[68:71], a[120:123], v[244:247], v[68:71]
    ds_read_b64_tr_b16 a[30:31], v4 offset:50464
    v_add3_u32 v19, v19, s47, v40
    s_waitcnt lgkmcnt(7)
    v_mfma_f32_16x16x32_bf16 v[68:71], a[132:135], v[248:251], v[68:71]
    ds_read_b64_tr_b16 a[32:33], v5 offset:49728
    ds_read_b64_tr_b16 a[34:35], v5 offset:50496
    v_mfma_f32_16x16x32_bf16 v[72:75], a[136:139], v[248:251], v[72:75]
    ds_read_b128 v[212:215], v130 offset:128
    v_mfma_f32_16x16x32_bf16 v[76:79], a[140:143], v[248:251], v[76:79]
    v_add_u32 v21, v21, v40
    v_bfe_u32 v38, v6, 4, 2
    v_mfma_f32_16x16x32_bf16 v[44:47], a[0:3], v[180:183], v[44:47]
    v_bfe_u32 v39, v6, 6, 2
    v_lshl_add_u32 v38, v38, 2, v39
    v_mfma_f32_16x16x32_bf16 v[48:51], a[4:7], v[180:183], v[48:51]
    v_lshrrev_b32 v39, 8, v6
    v_mfma_f32_16x16x32_bf16 v[52:55], a[8:11], v[180:183], v[52:55]
    v_mul_u32_u24 v38, 208, v38
    s_waitcnt lgkmcnt(7)
    v_mfma_f32_16x16x32_bf16 v[52:55], a[20:23], v[184:187], v[52:55]
    s_lshl4_add_u32 s49, s48, s47
    v_mfma_f32_16x16x32_bf16 v[48:51], a[16:19], v[184:187], v[48:51]
    v_lshl_add_u32 v38, v39, 3, v38
    v_mfma_f32_16x16x32_bf16 v[44:47], a[12:15], v[184:187], v[44:47]
    s_lshl2_add_u32 s48, s48, s47
    s_waitcnt lgkmcnt(6)
    v_mfma_f32_16x16x32_bf16 v[44:47], a[24:27], v[188:191], v[44:47]
    v_add_u32 v16, s49, v38
    s_waitcnt lgkmcnt(3)
    v_mfma_f32_16x16x32_bf16 v[48:51], a[28:31], v[188:191], v[48:51]
    v_add_u32 v17, s48, v38
    s_waitcnt lgkmcnt(1)
    v_mfma_f32_16x16x32_bf16 v[52:55], a[32:35], v[188:191], v[52:55]
    v_mfma_f32_16x16x32_bf16 v[56:59], a[0:3], v[192:195], v[56:59]
    v_mfma_f32_16x16x32_bf16 v[60:63], a[4:7], v[192:195], v[60:63]
    v_mfma_f32_16x16x32_bf16 v[64:67], a[8:11], v[192:195], v[64:67]
    v_mfma_f32_16x16x32_bf16 v[64:67], a[20:23], v[196:199], v[64:67]
    v_cvt_pk_bf16_f32 v32, v44, v45
    v_cvt_pk_bf16_f32 v33, v46, v47
    v_mfma_f32_16x16x32_bf16 v[60:63], a[16:19], v[196:199], v[60:63]
    v_cvt_pk_bf16_f32 v34, v48, v49
    v_cvt_pk_bf16_f32 v35, v50, v51
    v_mfma_f32_16x16x32_bf16 v[56:59], a[12:15], v[196:199], v[56:59]
    v_cvt_pk_bf16_f32 v36, v52, v53
    v_cvt_pk_bf16_f32 v37, v54, v55
    v_mfma_f32_16x16x32_bf16 v[56:59], a[24:27], v[200:203], v[56:59]
    ds_write_b64 v16, v[32:33] offset:0
    v_mfma_f32_16x16x32_bf16 v[60:63], a[28:31], v[200:203], v[60:63]
    ds_write_b64 v16, v[34:35] offset:32
    v_mfma_f32_16x16x32_bf16 v[64:67], a[32:35], v[200:203], v[64:67]
    ds_write_b64 v17, v[36:37] offset:64
    v_mfma_f32_16x16x32_bf16 v[68:71], a[0:3], v[204:207], v[68:71]
    v_mfma_f32_16x16x32_bf16 v[72:75], a[4:7], v[204:207], v[72:75]
    s_waitcnt lgkmcnt(0)
    s_barrier
    ds_read_b128 v[38:41], v18 offset:0
    v_mfma_f32_16x16x32_bf16 v[76:79], a[8:11], v[204:207], v[76:79]
    ds_read_b64 v[42:43], v19 offset:0
    v_mfma_f32_16x16x32_bf16 v[76:79], a[20:23], v[208:211], v[76:79]
    v_cvt_pk_bf16_f32 v32, v56, v57
    v_cvt_pk_bf16_f32 v33, v58, v59
    v_mfma_f32_16x16x32_bf16 v[72:75], a[16:19], v[208:211], v[72:75]
    v_cvt_pk_bf16_f32 v34, v60, v61
    v_cvt_pk_bf16_f32 v35, v62, v63
    v_mfma_f32_16x16x32_bf16 v[68:71], a[12:15], v[208:211], v[68:71]
    v_cvt_pk_bf16_f32 v36, v64, v65
    v_cvt_pk_bf16_f32 v37, v66, v67
    v_mfma_f32_16x16x32_bf16 v[68:71], a[24:27], v[212:215], v[68:71]
    ds_write_b64 v16, v[32:33] offset:3328
    v_mfma_f32_16x16x32_bf16 v[72:75], a[28:31], v[212:215], v[72:75]
    ds_write_b64 v16, v[34:35] offset:3360
    v_mfma_f32_16x16x32_bf16 v[76:79], a[32:35], v[212:215], v[76:79]
    ds_write_b64 v17, v[36:37] offset:3392
    s_waitcnt lgkmcnt(4)
    buffer_store_dwordx4 v[38:41], v20, s[16:19], s31 offen sc1
    s_waitcnt lgkmcnt(3)
    buffer_store_dwordx2 v[42:43], v21, s[16:19], s31 offen sc1
    s_add_u32 s31, s31, s55
    s_waitcnt lgkmcnt(0)
    s_barrier
    ds_read_b128 v[24:27], v18 offset:3328
    ds_read_b64 v[28:29], v19 offset:3328
    v_cvt_pk_bf16_f32 v32, v68, v69
    v_cvt_pk_bf16_f32 v33, v70, v71
    v_cvt_pk_bf16_f32 v34, v72, v73
    v_cvt_pk_bf16_f32 v35, v74, v75
    ds_write_b64 v16, v[32:33] offset:0
    s_waitcnt lgkmcnt(2)
    buffer_store_dwordx4 v[24:27], v20, s[16:19], s31 offen sc1
    s_waitcnt lgkmcnt(1)
    buffer_store_dwordx2 v[28:29], v21, s[16:19], s31 offen sc1
    s_add_u32 s31, s31, s55
    s_cmp_lg_u32 s54, 0
    v_cvt_pk_bf16_f32 v36, v76, v77
    v_cvt_pk_bf16_f32 v37, v78, v79
    ds_write_b64 v16, v[34:35] offset:32
    ds_write_b64 v17, v[36:37] offset:64
    s_waitcnt lgkmcnt(0)
    s_barrier
    ds_read_b128 v[38:41], v18 offset:0
    ds_read_b64 v[42:43], v19 offset:0
    s_waitcnt lgkmcnt(1)
    buffer_store_dwordx4 v[38:41], v20, s[16:19], s31 offen sc1
    s_waitcnt lgkmcnt(0)
    buffer_store_dwordx2 v[42:43], v21, s[16:19], s31 offen sc1
    s_cbranch_scc1 L_gS
    s_endpgm
L_cold:
L_gW:
    s_waitcnt vmcnt(0) lgkmcnt(0)
    v_mbcnt_lo_u32_b32 v16, -1, 0
    v_mbcnt_hi_u32_b32 v16, -1, v16
    v_lshlrev_b32 v6, 4, v16
    v_lshrrev_b32 v17, 4, v16
    v_and_b32 v16, 15, v16
    v_and_b32 v4, 1, v17
    v_mul_u32_u24 v4, 3104, v4
    v_lshrrev_b32 v5, 1, v17
    v_lshlrev_b32 v5, 3, v5
    v_lshrrev_b32 v12, 2, v16
    v_add_u32 v5, v5, v12
    v_mul_u32_u24 v5, 192, v5
    v_and_b32 v12, 3, v16
    v_lshl_add_u32 v4, v12, 3, v4
    v_add_u32 v4, v4, v5
    s_mul_i32 s44, s28, 18624
    s_lshl_b32 s48, s29, 5
    s_add_u32 s48, s48, s44
    v_add_u32 v5, s48, v4
    s_lshl_b32 s48, s29, 7
    s_add_u32 s48, s48, s44
    v_add_u32 v4, s48, v4
    s_mov_b32 s46, 0
    s_call_b64 s[52:53], L_gD
    ds_read_b64_tr_b16 a[0:1], v4 offset:0
    ds_read_b64_tr_b16 a[2:3], v4 offset:768
    ds_read_b64_tr_b16 a[4:5], v4 offset:32
    ds_read_b64_tr_b16 a[6:7], v4 offset:800
    ds_read_b64_tr_b16 a[8:9], v5 offset:64
    ds_read_b64_tr_b16 a[10:11], v5 offset:832
    ds_read_b64_tr_b16 a[12:13], v4 offset:6208
    ds_read_b64_tr_b16 a[14:15], v4 offset:6976
    ds_read_b64_tr_b16 a[16:17], v4 offset:6240
    ds_read_b64_tr_b16 a[18:19], v4 offset:7008
    ds_read_b64_tr_b16 a[20:21], v5 offset:6272
    ds_read_b64_tr_b16 a[22:23], v5 offset:7040
    ds_read_b64_tr_b16 a[24:25], v4 offset:12416
    ds_read_b64_tr_b16 a[26:27], v4 offset:13184
    ds_read_b64_tr_b16 a[28:29], v4 offset:12448
    ds_read_b64_tr_b16 a[30:31], v4 offset:13216
    ds_read_b64_tr_b16 a[32:33], v5 offset:12480
    ds_read_b64_tr_b16 a[34:35], v5 offset:13248
    s_call_b64 s[52:53], L_gD
    ds_read_b64_tr_b16 a[36:37], v4 offset:0
    ds_read_b64_tr_b16 a[38:39], v4 offset:768
    ds_read_b64_tr_b16 a[40:41], v4 offset:32
    ds_read_b64_tr_b16 a[42:43], v4 offset:800
    ds_read_b64_tr_b16 a[44:45], v5 offset:64
    ds_read_b64_tr_b16 a[46:47], v5 offset:832
    ds_read_b64_tr_b16 a[48:49], v4 offset:6208
    ds_read_b64_tr_b16 a[50:51], v4 offset:6976
    ds_read_b64_tr_b16 a[52:53], v4 offset:6240
    ds_read_b64_tr_b16 a[54:55], v4 offset:7008
    ds_read_b64_tr_b16 a[56:57], v5 offset:6272
    ds_read_b64_tr_b16 a[58:59], v5 offset:7040
    ds_read_b64_tr_b16 a[60:61], v4 offset:12416
    ds_read_b64_tr_b16 a[62:63], v4 offset:13184
    ds_read_b64_tr_b16 a[64:65], v4 offset:12448
    ds_read_b64_tr_b16 a[66:67], v4 offset:13216
    ds_read_b64_tr_b16 a[68:69], v5 offset:12480
    ds_read_b64_tr_b16 a[70:71], v5 offset:13248
    s_call_b64 s[52:53], L_gD
    ds_read_b64_tr_b16 a[72:73], v4 offset:0
    ds_read_b64_tr_b16 a[74:75], v4 offset:768
    ds_read_b64_tr_b16 a[76:77], v4 offset:32
    ds_read_b64_tr_b16 a[78:79], v4 offset:800
    ds_read_b64_tr_b16 a[80:81], v5 offset:64
    ds_read_b64_tr_b16 a[82:83], v5 offset:832
    ds_read_b64_tr_b16 a[84:85], v4 offset:6208
    ds_read_b64_tr_b16 a[86:87], v4 offset:6976
    ds_read_b64_tr_b16 a[88:89], v4 offset:6240
    ds_read_b64_tr_b16 a[90:91], v4 offset:7008
    ds_read_b64_tr_b16 a[92:93], v5 offset:6272
    ds_read_b64_tr_b16 a[94:95], v5 offset:7040
    ds_read_b64_tr_b16 a[96:97], v4 offset:12416
    ds_read_b64_tr_b16 a[98:99], v4 offset:13184
    ds_read_b64_tr_b16 a[100:101], v4 offset:12448
    ds_read_b64_tr_b16 a[102:103], v4 offset:13216
    ds_read_b64_tr_b16 a[104:105], v5 offset:12480
    ds_read_b64_tr_b16 a[106:107], v5 offset:13248
    s_call_b64 s[52:53], L_gD
    ds_read_b64_tr_b16 a[108:109], v4 offset:0
    ds_read_b64_tr_b16 a[110:111], v4 offset:768
    ds_read_b64_tr_b16 a[112:113], v4 offset:32
    ds_read_b64_tr_b16 a[114:115], v4 offset:800
    ds_read_b64_tr_b16 a[116:117], v5 offset:64
    ds_read_b64_tr_b16 a[118:119], v5 offset:832
    ds_read_b64_tr_b16 a[120:121], v4 offset:6208
    ds_read_b64_tr_b16 a[122:123], v4 offset:6976
    ds_read_b64_tr_b16 a[124:125], v4 offset:6240
    ds_read_b64_tr_b16 a[126:127], v4 offset:7008
    ds_read_b64_tr_b16 a[128:129], v5 offset:6272
    ds_read_b64_tr_b16 a[130:131], v5 offset:7040
    ds_read_b64_tr_b16 a[132:133], v4 offset:12416
    ds_read_b64_tr_b16 a[134:135], v4 offset:13184
    ds_read_b64_tr_b16 a[136:137], v4 offset:12448
    ds_read_b64_tr_b16 a[138:139], v4 offset:13216
    ds_read_b64_tr_b16 a[140:141], v5 offset:12480
    ds_read_b64_tr_b16 a[142:143], v5 offset:13248
    s_call_b64 s[52:53], L_gD
    ds_read_b64_tr_b16 a[144:145], v4 offset:0
    ds_read_b64_tr_b16 a[146:147], v4 offset:768
    ds_read_b64_tr_b16 a[148:149], v4 offset:32
    ds_read_b64_tr_b16 a[150:151], v4 offset:800
    ds_read_b64_tr_b16 a[152:153], v5 offset:64
    ds_read_b64_tr_b16 a[154:155], v5 offset:832
    ds_read_b64_tr_b16 a[156:157], v4 offset:6208
    ds_read_b64_tr_b16 a[158:159], v4 offset:6976
    ds_read_b64_tr_b16 a[160:161], v4 offset:6240
    ds_read_b64_tr_b16 a[162:163], v4 offset:7008
    ds_read_b64_tr_b16 a[164:165], v5 offset:6272
    ds_read_b64_tr_b16 a[166:167], v5 offset:7040
    ds_read_b64_tr_b16 a[168:169], v4 offset:12416
    ds_read_b64_tr_b16 a[170:171], v4 offset:13184
    ds_read_b64_tr_b16 a[172:173], v4 offset:12448
    ds_read_b64_tr_b16 a[174:175], v4 offset:13216
    ds_read_b64_tr_b16 a[176:177], v5 offset:12480
    ds_read_b64_tr_b16 a[178:179], v5 offset:13248
    s_call_b64 s[52:53], L_gD
    ds_read_b64_tr_b16 a[180:181], v4 offset:0
    ds_read_b64_tr_b16 a[182:183], v4 offset:768
    ds_read_b64_tr_b16 a[184:185], v4 offset:32
    ds_read_b64_tr_b16 a[186:187], v4 offset:800
    ds_read_b64_tr_b16 a[188:189], v5 offset:64
    ds_read_b64_tr_b16 a[190:191], v5 offset:832
    ds_read_b64_tr_b16 a[192:193], v4 offset:6208
    ds_read_b64_tr_b16 a[194:195], v4 offset:6976
    ds_read_b64_tr_b16 a[196:197], v4 offset:6240
    ds_read_b64_tr_b16 a[198:199], v4 offset:7008
    ds_read_b64_tr_b16 a[200:201], v5 offset:6272
    ds_read_b64_tr_b16 a[202:203], v5 offset:7040
    ds_read_b64_tr_b16 a[204:205], v4 offset:12416
    ds_read_b64_tr_b16 a[206:207], v4 offset:13184
    ds_read_b64_tr_b16 a[208:209], v4 offset:12448
    ds_read_b64_tr_b16 a[210:211], v4 offset:13216
    ds_read_b64_tr_b16 a[212:213], v5 offset:12480
    ds_read_b64_tr_b16 a[214:215], v5 offset:13248
    s_call_b64 s[52:53], L_gD
    ds_read_b64_tr_b16 a[216:217], v4 offset:0
    ds_read_b64_tr_b16 a[218:219], v4 offset:768
    ds_read_b64_tr_b16 a[220:221], v4 offset:32
    ds_read_b64_tr_b16 a[222:223], v4 offset:800
    ds_read_b64_tr_b16 a[224:225], v5 offset:64
    ds_read_b64_tr_b16 a[226:227], v5 offset:832
    ds_read_b64_tr_b16 a[228:229], v4 offset:6208
    ds_read_b64_tr_b16 a[230:231], v4 offset:6976
    ds_read_b64_tr_b16 a[232:233], v4 offset:6240
    ds_read_b64_tr_b16 a[234:235], v4 offset:7008
    ds_read_b64_tr_b16 a[236:237], v5 offset:6272
    ds_read_b64_tr_b16 a[238:239], v5 offset:7040
    ds_read_b64_tr_b16 a[240:241], v4 offset:12416
    ds_read_b64_tr_b16 a[242:243], v4 offset:13184
    ds_read_b64_tr_b16 a[244:245], v4 offset:12448
    ds_read_b64_tr_b16 a[246:247], v4 offset:13216
    ds_read_b64_tr_b16 a[248:249], v5 offset:12480
    ds_read_b64_tr_b16 a[250:251], v5 offset:13248
    s_call_b64 s[52:53], L_gD
    ds_read_b64_tr_b16 a[252:253], v4 offset:0
    ds_read_b64_tr_b16 a[254:255], v4 offset:768
    ds_read_b64_tr_b16 v[188:189], v4 offset:32
    ds_read_b64_tr_b16 v[190:191], v4 offset:800
    ds_read_b64_tr_b16 v[192:193], v5 offset:64
    ds_read_b64_tr_b16 v[194:195], v5 offset:832
    ds_read_b64_tr_b16 v[196:197], v4 offset:6208
    ds_read_b64_tr_b16 v[198:199], v4 offset:6976
    ds_read_b64_tr_b16 v[200:201], v4 offset:6240
    ds_read_b64_tr_b16 v[202:203], v4 offset:7008
    ds_read_b64_tr_b16 v[204:205], v5 offset:6272
    ds_read_b64_tr_b16 v[206:207], v5 offset:7040
    ds_read_b64_tr_b16 v[208:209], v4 offset:12416
    ds_read_b64_tr_b16 v[210:211], v4 offset:13184
    ds_read_b64_tr_b16 v[212:213], v4 offset:12448
    ds_read_b64_tr_b16 v[214:215], v4 offset:13216
    ds_read_b64_tr_b16 v[216:217], v5 offset:12480
    ds_read_b64_tr_b16 v[218:219], v5 offset:13248
    s_call_b64 s[52:53], L_gD
    ds_read_b64_tr_b16 v[220:221], v4 offset:0
    ds_read_b64_tr_b16 v[222:223], v4 offset:768
    ds_read_b64_tr_b16 v[224:225], v4 offset:32
    ds_read_b64_tr_b16 v[226:227], v4 offset:800
    ds_read_b64_tr_b16 v[228:229], v5 offset:64
    ds_read_b64_tr_b16 v[230:231], v5 offset:832
    ds_read_b64_tr_b16 v[232:233], v4 offset:6208
    ds_read_b64_tr_b16 v[234:235], v4 offset:6976
    ds_read_b64_tr_b16 v[236:237], v4 offset:6240
    ds_read_b64_tr_b16 v[238:239], v4 offset:7008
    ds_read_b64_tr_b16 v[240:241], v5 offset:6272
    ds_read_b64_tr_b16 v[242:243], v5 offset:7040
    ds_read_b64_tr_b16 v[244:245], v4 offset:12416
    ds_read_b64_tr_b16 v[246:247], v4 offset:13184
    ds_read_b64_tr_b16 v[248:249], v4 offset:12448
    ds_read_b64_tr_b16 v[250:251], v4 offset:13216
    ds_read_b64_tr_b16 v[252:253], v5 offset:12480
    ds_read_b64_tr_b16 v[254:255], v5 offset:13248
    s_branch L_g0
L_gD:
    s_waitcnt lgkmcnt(0)
    s_add_u32 m0, s44, 0
    s_nop 0
    buffer_load_dwordx4 v6, s[12:15], s46 offen offset:0 lds
    buffer_load_dwordx4 v6, s[12:15], s46 offen offset:1024 lds
    buffer_load_dwordx4 v6, s[12:15], s46 offen offset:2048 lds
    s_add_u32 s46, s46, 3072
    s_add_u32 m0, s44, 3104
    s_nop 0
    buffer_load_dwordx4 v6, s[12:15], s46 offen offset:0 lds
    buffer_load_dwordx4 v6, s[12:15], s46 offen offset:1024 lds
    buffer_load_dwordx4 v6, s[12:15], s46 offen offset:2048 lds
    s_add_u32 s46, s46, 3072
    s_add_u32 m0, s44, 6208
    s_nop 0
    buffer_load_dwordx4 v6, s[12:15], s46 offen offset:0 lds
    buffer_load_dwordx4 v6, s[12:15], s46 offen offset:1024 lds
    buffer_load_dwordx4 v6, s[12:15], s46 offen offset:2048 lds
    s_add_u32 s46, s46, 3072
    s_add_u32 m0, s44, 9312
    s_nop 0
    buffer_load_dwordx4 v6, s[12:15], s46 offen offset:0 lds
    buffer_load_dwordx4 v6, s[12:15], s46 offen offset:1024 lds
    buffer_load_dwordx4 v6, s[12:15], s46 offen offset:2048 lds
    s_add_u32 s46, s46, 3072
    s_add_u32 m0, s44, 12416
    s_nop 0
    buffer_load_dwordx4 v6, s[12:15], s46 offen offset:0 lds
    buffer_load_dwordx4 v6, s[12:15], s46 offen offset:1024 lds
    buffer_load_dwordx4 v6, s[12:15], s46 offen offset:2048 lds
    s_add_u32 s46, s46, 3072
    s_add_u32 m0, s44, 15520
    s_nop 0
    buffer_load_dwordx4 v6, s[12:15], s46 offen offset:0 lds
    buffer_load_dwordx4 v6, s[12:15], s46 offen offset:1024 lds
    buffer_load_dwordx4 v6, s[12:15], s46 offen offset:2048 lds
    s_add_u32 s46, s46, 3072
    s_waitcnt vmcnt(0)
    s_setpc_b64 s[52:53]
L_gN:
    s_waitcnt vmcnt(0)
    s_barrier
    s_movk_i32 s54, 0x7f
L_g0:
    v_mbcnt_lo_u32_b32 v16, -1, 0
    v_mbcnt_hi_u32_b32 v16, -1, v16
    v_lshlrev_b32 v6, 4, v16
    v_lshrrev_b32 v17, 4, v16
    v_and_b32 v16, 15, v16
    s_bfe_u32 s56, s23, 0x10010
    s_and_b32 s59, s23, 0xff
    s_bfe_u32 s58, s23, 0x80008
    s_and_b32 s47, s22, 15
    s_bfe_u32 s57, s22, 0x40004
    s_bfe_u32 s64, s23, 0x10011
    s_cselect_b32 s48, 1, s47
    s_cselect_b32 s65, 2.0, 1.0
    s_cmp_eq_u32 s30, 0
    s_cselect_b32 s57, s47, s57
    s_cselect_b32 s47, 0, s48
    s_cselect_b32 s31, s26, s27
    s_add_u32 s58, s58, s47
    v_add_u32 v32, s59, v16
    v_mov_b32 v33, s58
    v_cvt_f32_u32 v32, v32
    v_cvt_f32_u32 v33, v33
    s_cmp_eq_u32 s56, 0
    s_cselect_b32 s60, 224, 1
    s_cselect_b32 s61, 1, 224
    s_cselect_b32 s62, s65, 0
    s_cselect_b32 s63, 0, s65
    s_cselect_b64 vcc, -1, 0
    s_lshl_b32 s60, s60, s64
    v_cndmask_b32 v19, v32, v33, vcc
    v_cndmask_b32 v20, v33, v32, vcc
    v_mul_u32_u24 v32, s61, v16
    v_mul_u32_u24 v21, 36, v32
    v_mul_u32_u24 v32, 192, v32
    v_and_b32 v18, 1, v17
    v_lshrrev_b32 v33, 1, v17
    v_lshl_add_u32 v18, v18, 1, v33
    v_lshlrev_b32 v22, 4, v18
    s_lshl_b32 s48, s29, 7
    v_add3_u32 v9, v32, s48, v22
    s_lshl_b32 s48, s29, 5
    s_add_u32 s48, s48, 64
    v_lshlrev_b32 v33, 3, v17
    v_add3_u32 v10, v32, s48, v33
    s_mul_i32 s32, s31, 3
    s_lshr_b32 s32, s32, 4
    s_mov_b32 s65, 0x435f435f
    s_bfm_b32 s47, s57, 0
    s_bitset1_b32 s47, 31
    s_and_b32 s54, s54, s47
L_gt:
    s_and_b32 s47, s54, 0xff
    s_cbranch_scc0 L_end
    s_bitcmp1_b32 s54, 0
    s_cbranch_scc0 L_gn
    buffer_load_dwordx4 v[24:27], v21, s[8:11], s32 offen offset:4
    buffer_load_dwordx4 v[28:31], v21, s[8:11], s32 offen offset:20
    buffer_load_dword v23, v21, s[8:11], s32 offen
    s_lshr_b32 s66, s54, 31
    s_mov_b32 s67, 0
    s_mov_b32 s64, 0
    s_waitcnt vmcnt(0) lgkmcnt(0)
    v_add_f32 v34, -1.0, v19
    v_add_f32 v35, -1.0, v20
    v_lshlrev_b32 v32, 16, v23
    v_and_b32 v33, 0xffff0000, v23
    v_add_f32 v32, v32, v34
    v_add_f32 v33, v33, v35
    v_cvt_pk_bf16_f32 v34, v34, v35
    v_cvt_pk_bf16_f32 v23, v32, v33
    v_cmp_ne_u32 vcc, v34, v23
    v_pk_max_i16 v23, v23, 0
    v_pk_min_i16 v23, v23, s65
    s_or_b64 s[66:67], s[66:67], vcc
    v_add_f32 v34, -1.0, v19
    v_add_f32 v35, 0.0, v20
    v_lshlrev_b32 v32, 16, v24
    v_and_b32 v33, 0xffff0000, v24
    v_add_f32 v32, v32, v34
    v_add_f32 v33, v33, v35
    v_cvt_pk_bf16_f32 v34, v34, v35
    v_cvt_pk_bf16_f32 v24, v32, v33
    v_cmp_ne_u32 vcc, v34, v24
    v_pk_max_i16 v24, v24, 0
    v_pk_min_i16 v24, v24, s65
    s_or_b64 s[66:67], s[66:67], vcc
    v_add_f32 v34, -1.0, v19
    v_add_f32 v35, 1.0, v20
    v_lshlrev_b32 v32, 16, v25
    v_and_b32 v33, 0xffff0000, v25
    v_add_f32 v32, v32, v34
    v_add_f32 v33, v33, v35
    v_cvt_pk_bf16_f32 v34, v34, v35
    v_cvt_pk_bf16_f32 v25, v32, v33
    v_cmp_ne_u32 vcc, v34, v25
    v_pk_max_i16 v25, v25, 0
    v_pk_min_i16 v25, v25, s65
    s_or_b64 s[66:67], s[66:67], vcc
    v_add_f32 v34, 0.0, v19
    v_add_f32 v35, -1.0, v20
    v_lshlrev_b32 v32, 16, v26
    v_and_b32 v33, 0xffff0000, v26
    v_add_f32 v32, v32, v34
    v_add_f32 v33, v33, v35
    v_cvt_pk_bf16_f32 v34, v34, v35
    v_cvt_pk_bf16_f32 v26, v32, v33
    v_cmp_ne_u32 vcc, v34, v26
    v_pk_max_i16 v26, v26, 0
    v_pk_min_i16 v26, v26, s65
    s_or_b64 s[66:67], s[66:67], vcc
    v_add_f32 v34, 0.0, v19
    v_add_f32 v35, 0.0, v20
    v_lshlrev_b32 v32, 16, v27
    v_and_b32 v33, 0xffff0000, v27
    v_add_f32 v32, v32, v34
    v_add_f32 v33, v33, v35
    v_cvt_pk_bf16_f32 v34, v34, v35
    v_cvt_pk_bf16_f32 v27, v32, v33
    v_cmp_ne_u32 vcc, v34, v27
    v_pk_max_i16 v27, v27, 0
    v_pk_min_i16 v27, v27, s65
    s_or_b64 s[66:67], s[66:67], vcc
    v_add_f32 v34, 0.0, v19
    v_add_f32 v35, 1.0, v20
    v_lshlrev_b32 v32, 16, v28
    v_and_b32 v33, 0xffff0000, v28
    v_add_f32 v32, v32, v34
    v_add_f32 v33, v33, v35
    v_cvt_pk_bf16_f32 v34, v34, v35
    v_cvt_pk_bf16_f32 v28, v32, v33
    v_cmp_ne_u32 vcc, v34, v28
    v_pk_max_i16 v28, v28, 0
    v_pk_min_i16 v28, v28, s65
    s_or_b64 s[66:67], s[66:67], vcc
    v_add_f32 v34, 1.0, v19
    v_add_f32 v35, -1.0, v20
    v_lshlrev_b32 v32, 16, v29
    v_and_b32 v33, 0xffff0000, v29
    v_add_f32 v32, v32, v34
    v_add_f32 v33, v33, v35
    v_cvt_pk_bf16_f32 v34, v34, v35
    v_cvt_pk_bf16_f32 v29, v32, v33
    v_cmp_ne_u32 vcc, v34, v29
    v_pk_max_i16 v29, v29, 0
    v_pk_min_i16 v29, v29, s65
    s_or_b64 s[66:67], s[66:67], vcc
    v_add_f32 v34, 1.0, v19
    v_add_f32 v35, 0.0, v20
    v_lshlrev_b32 v32, 16, v30
    v_and_b32 v33, 0xffff0000, v30
    v_add_f32 v32, v32, v34
    v_add_f32 v33, v33, v35
    v_cvt_pk_bf16_f32 v34, v34, v35
    v_cvt_pk_bf16_f32 v30, v32, v33
    v_cmp_ne_u32 vcc, v34, v30
    v_pk_max_i16 v30, v30, 0
    v_pk_min_i16 v30, v30, s65
    s_or_b64 s[66:67], s[66:67], vcc
    v_add_f32 v34, 1.0, v19
    v_add_f32 v35, 1.0, v20
    v_lshlrev_b32 v32, 16, v31
    v_and_b32 v33, 0xffff0000, v31
    v_add_f32 v32, v32, v34
    v_add_f32 v33, v33, v35
    v_cvt_pk_bf16_f32 v34, v34, v35
    v_cvt_pk_bf16_f32 v31, v32, v33
    v_cmp_ne_u32 vcc, v34, v31
    v_pk_max_i16 v31, v31, 0
    v_pk_min_i16 v31, v31, s65
    s_or_b64 s[66:67], s[66:67], vcc
    s_cbranch_scc0 L_gn
    s_movk_i32 s49, 224
    v_lshlrev_b32 v32, 16, v31
    v_and_b32 v33, 0xffff0000, v31
    v_fract_f32 v36, v32
    v_fract_f32 v37, v33
    v_cvt_u32_f32 v32, v32
    v_cvt_u32_f32 v33, v33
    v_mad_u32_u24 v40, v32, s49, v33
    v_mul_u32_u24 v40, 192, v40
    v_add_u32 v40, v40, v22
    v_or_b32 v36, v36, v37
    v_cmp_ne_u32 vcc, 0, v36
    buffer_load_dwordx4 v[176:179], v40, s[4:7], 0 offen offset:0
    buffer_load_dwordx4 v[180:183], v40, s[4:7], 0 offen offset:64
    buffer_load_dwordx4 v[184:187], v40, s[4:7], 0 offen offset:128
    s_cmp_lg_u64 vcc, 0
    s_addc_u32 s64, s64, s64
    v_lshlrev_b32 v32, 16, v30
    v_and_b32 v33, 0xffff0000, v30
    v_fract_f32 v36, v32
    v_fract_f32 v37, v33
    v_cvt_u32_f32 v32, v32
    v_cvt_u32_f32 v33, v33
    v_mad_u32_u24 v40, v32, s49, v33
    v_mul_u32_u24 v40, 192, v40
    v_add_u32 v40, v40, v22
    v_or_b32 v36, v36, v37
    v_cmp_ne_u32 vcc, 0, v36
    buffer_load_dwordx4 v[164:167], v40, s[4:7], 0 offen offset:0
    buffer_load_dwordx4 v[168:171], v40, s[4:7], 0 offen offset:64
    buffer_load_dwordx4 v[172:175], v40, s[4:7], 0 offen offset:128
    s_cmp_lg_u64 vcc, 0
    s_addc_u32 s64, s64, s64
    v_lshlrev_b32 v32, 16, v29
    v_and_b32 v33, 0xffff0000, v29
    v_fract_f32 v36, v32
    v_fract_f32 v37, v33
    v_cvt_u32_f32 v32, v32
    v_cvt_u32_f32 v33, v33
    v_mad_u32_u24 v40, v32, s49, v33
    v_mul_u32_u24 v40, 192, v40
    v_add_u32 v40, v40, v22
    v_or_b32 v36, v36, v37
    v_cmp_ne_u32 vcc, 0, v36
    buffer_load_dwordx4 v[152:155], v40, s[4:7], 0 offen offset:0
    buffer_load_dwordx4 v[156:159], v40, s[4:7], 0 offen offset:64
    buffer_load_dwordx4 v[160:163], v40, s[4:7], 0 offen offset:128
    s_cmp_lg_u64 vcc, 0
    s_addc_u32 s64, s64, s64
    v_lshlrev_b32 v32, 16, v28
    v_and_b32 v33, 0xffff0000, v28
    v_fract_f32 v36, v32
    v_fract_f32 v37, v33
    v_cvt_u32_f32 v32, v32
    v_cvt_u32_f32 v33, v33
    v_mad_u32_u24 v40, v32, s49, v33
    v_mul_u32_u24 v40, 192, v40
    v_add_u32 v40, v40, v22
    v_or_b32 v36, v36, v37
    v_cmp_ne_u32 vcc, 0, v36
    buffer_load_dwordx4 v[140:143], v40, s[4:7], 0 offen offset:0
    buffer_load_dwordx4 v[144:147], v40, s[4:7], 0 offen offset:64
    buffer_load_dwordx4 v[148:151], v40, s[4:7], 0 offen offset:128
    s_cmp_lg_u64 vcc, 0
    s_addc_u32 s64, s64, s64
    v_lshlrev_b32 v32, 16, v27
    v_and_b32 v33, 0xffff0000, v27
    v_fract_f32 v36, v32
    v_fract_f32 v37, v33
    v_cvt_u32_f32 v32, v32
    v_cvt_u32_f32 v33, v33
    v_mad_u32_u24 v40, v32, s49, v33
    v_mul_u32_u24 v40, 192, v40
    v_add_u32 v40, v40, v22
    v_or_b32 v36, v36, v37
    v_cmp_ne_u32 vcc, 0, v36
    buffer_load_dwordx4 v[128:131], v40, s[4:7], 0 offen offset:0
    buffer_load_dwordx4 v[132:135], v40, s[4:7], 0 offen offset:64
    buffer_load_dwordx4 v[136:139], v40, s[4:7], 0 offen offset:128
    s_cmp_lg_u64 vcc, 0
    s_addc_u32 s64, s64, s64
    v_lshlrev_b32 v32, 16, v26
    v_and_b32 v33, 0xffff0000, v26
    v_fract_f32 v36, v32
    v_fract_f32 v37, v33
    v_cvt_u32_f32 v32, v32
    v_cvt_u32_f32 v33, v33
    v_mad_u32_u24 v40, v32, s49, v33
    v_mul_u32_u24 v40, 192, v40
    v_add_u32 v40, v40, v22
    v_or_b32 v36, v36, v37
    v_cmp_ne_u32 vcc, 0, v36
    buffer_load_dwordx4 v[116:119], v40, s[4:7], 0 offen offset:0
    buffer_load_dwordx4 v[120:123], v40, s[4:7], 0 offen offset:64
    buffer_load_dwordx4 v[124:127], v40, s[4:7], 0 offen offset:128
    s_cmp_lg_u64 vcc, 0
    s_addc_u32 s64, s64, s64
    v_lshlrev_b32 v32, 16, v25
    v_and_b32 v33, 0xffff0000, v25
    v_fract_f32 v36, v32
    v_fract_f32 v37, v33
    v_cvt_u32_f32 v32, v32
    v_cvt_u32_f32 v33, v33
    v_mad_u32_u24 v40, v32, s49, v33
    v_mul_u32_u24 v40, 192, v40
    v_add_u32 v40, v40, v22
    v_or_b32 v36, v36, v37
    v_cmp_ne_u32 vcc, 0, v36
    buffer_load_dwordx4 v[104:107], v40, s[4:7], 0 offen offset:0
    buffer_load_dwordx4 v[108:111], v40, s[4:7], 0 offen offset:64
    buffer_load_dwordx4 v[112:115], v40, s[4:7], 0 offen offset:128
    s_cmp_lg_u64 vcc, 0
    s_addc_u32 s64, s64, s64
    v_lshlrev_b32 v32, 16, v24
    v_and_b32 v33, 0xffff0000, v24
    v_fract_f32 v36, v32
    v_fract_f32 v37, v33
    v_cvt_u32_f32 v32, v32
    v_cvt_u32_f32 v33, v33
    v_mad_u32_u24 v40, v32, s49, v33
    v_mul_u32_u24 v40, 192, v40
    v_add_u32 v40, v40, v22
    v_or_b32 v36, v36, v37
    v_cmp_ne_u32 vcc, 0, v36
    buffer_load_dwordx4 v[92:95], v40, s[4:7], 0 offen offset:0
    buffer_load_dwordx4 v[96:99], v40, s[4:7], 0 offen offset:64
    buffer_load_dwordx4 v[100:103], v40, s[4:7], 0 offen offset:128
    s_cmp_lg_u64 vcc, 0
    s_addc_u32 s64, s64, s64
    v_lshlrev_b32 v32, 16, v23
    v_and_b32 v33, 0xffff0000, v23
    v_fract_f32 v36, v32
    v_fract_f32 v37, v33
    v_cvt_u32_f32 v32, v32
    v_cvt_u32_f32 v33, v33
    v_mad_u32_u24 v40, v32, s49, v33
    v_mul_u32_u24 v40, 192, v40
    v_add_u32 v40, v40, v22
    v_or_b32 v36, v36, v37
    v_cmp_ne_u32 vcc, 0, v36
    buffer_load_dwordx4 v[80:83], v40, s[4:7], 0 offen offset:0
    buffer_load_dwordx4 v[84:87], v40, s[4:7], 0 offen offset:64
    buffer_load_dwordx4 v[88:91], v40, s[4:7], 0 offen offset:128
    s_cmp_lg_u64 vcc, 0
    s_addc_u32 s64, s64, s64
    s_bitcmp1_b32 s64, 0
    s_cbranch_scc0 L_gs0
    v_mov_b32 v43, v23
    s_call_b64 s[52:53], L_gI
    v_cvt_pk_bf16_f32 v80, v44, v45
    v_cvt_pk_bf16_f32 v81, v46, v47
    v_cvt_pk_bf16_f32 v82, v48, v49
    v_cvt_pk_bf16_f32 v83, v50, v51
    v_cvt_pk_bf16_f32 v84, v52, v53
    v_cvt_pk_bf16_f32 v85, v54, v55
    v_cvt_pk_bf16_f32 v86, v56, v57
    v_cvt_pk_bf16_f32 v87, v58, v59
    v_cvt_pk_bf16_f32 v88, v60, v61
    v_cvt_pk_bf16_f32 v89, v62, v63
    v_cvt_pk_bf16_f32 v90, v64, v65
    v_cvt_pk_bf16_f32 v91, v66, v67
L_gs0:
    s_bitcmp1_b32 s64, 1
    s_cbranch_scc0 L_gs1
    v_mov_b32 v43, v24
    s_call_b64 s[52:53], L_gI
    v_cvt_pk_bf16_f32 v92, v44, v45
    v_cvt_pk_bf16_f32 v93, v46, v47
    v_cvt_pk_bf16_f32 v94, v48, v49
    v_cvt_pk_bf16_f32 v95, v50, v51
    v_cvt_pk_bf16_f32 v96, v52, v53
    v_cvt_pk_bf16_f32 v97, v54, v55
    v_cvt_pk_bf16_f32 v98, v56, v57
    v_cvt_pk_bf16_f32 v99, v58, v59
    v_cvt_pk_bf16_f32 v100, v60, v61
    v_cvt_pk_bf16_f32 v101, v62, v63
    v_cvt_pk_bf16_f32 v102, v64, v65
    v_cvt_pk_bf16_f32 v103, v66, v67
L_gs1:
    s_bitcmp1_b32 s64, 2
    s_cbranch_scc0 L_gs2
    v_mov_b32 v43, v25
    s_call_b64 s[52:53], L_gI
    v_cvt_pk_bf16_f32 v104, v44, v45
    v_cvt_pk_bf16_f32 v105, v46, v47
    v_cvt_pk_bf16_f32 v106, v48, v49
    v_cvt_pk_bf16_f32 v107, v50, v51
    v_cvt_pk_bf16_f32 v108, v52, v53
    v_cvt_pk_bf16_f32 v109, v54, v55
    v_cvt_pk_bf16_f32 v110, v56, v57
    v_cvt_pk_bf16_f32 v111, v58, v59
    v_cvt_pk_bf16_f32 v112, v60, v61
    v_cvt_pk_bf16_f32 v113, v62, v63
    v_cvt_pk_bf16_f32 v114, v64, v65
    v_cvt_pk_bf16_f32 v115, v66, v67
L_gs2:
    s_bitcmp1_b32 s64, 3
    s_cbranch_scc0 L_gs3
    v_mov_b32 v43, v26
    s_call_b64 s[52:53], L_gI
    v_cvt_pk_bf16_f32 v116, v44, v45
    v_cvt_pk_bf16_f32 v117, v46, v47
    v_cvt_pk_bf16_f32 v118, v48, v49
    v_cvt_pk_bf16_f32 v119, v50, v51
    v_cvt_pk_bf16_f32 v120, v52, v53
    v_cvt_pk_bf16_f32 v121, v54, v55
    v_cvt_pk_bf16_f32 v122, v56, v57
    v_cvt_pk_bf16_f32 v123, v58, v59
    v_cvt_pk_bf16_f32 v124, v60, v61
    v_cvt_pk_bf16_f32 v125, v62, v63
    v_cvt_pk_bf16_f32 v126, v64, v65
    v_cvt_pk_bf16_f32 v127, v66, v67
L_gs3:
    s_bitcmp1_b32 s64, 4
    s_cbranch_scc0 L_gs4
    v_mov_b32 v43, v27
    s_call_b64 s[52:53], L_gI
    v_cvt_pk_bf16_f32 v128, v44, v45
    v_cvt_pk_bf16_f32 v129, v46, v47
    v_cvt_pk_bf16_f32 v130, v48, v49
    v_cvt_pk_bf16_f32 v131, v50, v51
    v_cvt_pk_bf16_f32 v132, v52, v53
    v_cvt_pk_bf16_f32 v133, v54, v55
    v_cvt_pk_bf16_f32 v134, v56, v57
    v_cvt_pk_bf16_f32 v135, v58, v59
    v_cvt_pk_bf16_f32 v136, v60, v61
    v_cvt_pk_bf16_f32 v137, v62, v63
    v_cvt_pk_bf16_f32 v138, v64, v65
    v_cvt_pk_bf16_f32 v139, v66, v67
L_gs4:
    s_bitcmp1_b32 s64, 5
    s_cbranch_scc0 L_gs5
    v_mov_b32 v43, v28
    s_call_b64 s[52:53], L_gI
    v_cvt_pk_bf16_f32 v140, v44, v45
    v_cvt_pk_bf16_f32 v141, v46, v47
    v_cvt_pk_bf16_f32 v142, v48, v49
    v_cvt_pk_bf16_f32 v143, v50, v51
    v_cvt_pk_bf16_f32 v144, v52, v53
    v_cvt_pk_bf16_f32 v145, v54, v55
    v_cvt_pk_bf16_f32 v146, v56, v57
    v_cvt_pk_bf16_f32 v147, v58, v59
    v_cvt_pk_bf16_f32 v148, v60, v61
    v_cvt_pk_bf16_f32 v149, v62, v63
    v_cvt_pk_bf16_f32 v150, v64, v65
    v_cvt_pk_bf16_f32 v151, v66, v67
L_gs5:
    s_bitcmp1_b32 s64, 6
    s_cbranch_scc0 L_gs6
    v_mov_b32 v43, v29
    s_call_b64 s[52:53], L_gI
    v_cvt_pk_bf16_f32 v152, v44, v45
    v_cvt_pk_bf16_f32 v153, v46, v47
    v_cvt_pk_bf16_f32 v154, v48, v49
    v_cvt_pk_bf16_f32 v155, v50, v51
    v_cvt_pk_bf16_f32 v156, v52, v53
    v_cvt_pk_bf16_f32 v157, v54, v55
    v_cvt_pk_bf16_f32 v158, v56, v57
    v_cvt_pk_bf16_f32 v159, v58, v59
    v_cvt_pk_bf16_f32 v160, v60, v61
    v_cvt_pk_bf16_f32 v161, v62, v63
    v_cvt_pk_bf16_f32 v162, v64, v65
    v_cvt_pk_bf16_f32 v163, v66, v67
L_gs6:
    s_bitcmp1_b32 s64, 7
    s_cbranch_scc0 L_gs7
    v_mov_b32 v43, v30
    s_call_b64 s[52:53], L_gI
    v_cvt_pk_bf16_f32 v164, v44, v45
    v_cvt_pk_bf16_f32 v165, v46, v47
    v_cvt_pk_bf16_f32 v166, v48, v49
    v_cvt_pk_bf16_f32 v167, v50, v51
    v_cvt_pk_bf16_f32 v168, v52, v53
    v_cvt_pk_bf16_f32 v169, v54, v55
    v_cvt_pk_bf16_f32 v170, v56, v57
    v_cvt_pk_bf16_f32 v171, v58, v59
    v_cvt_pk_bf16_f32 v172, v60, v61
    v_cvt_pk_bf16_f32 v173, v62, v63
    v_cvt_pk_bf16_f32 v174, v64, v65
    v_cvt_pk_bf16_f32 v175, v66, v67
L_gs7:
    s_bitcmp1_b32 s64, 8
    s_cbranch_scc0 L_gs8
    v_mov_b32 v43, v31
    s_call_b64 s[52:53], L_gI
    v_cvt_pk_bf16_f32 v176, v44, v45
    v_cvt_pk_bf16_f32 v177, v46, v47
    v_cvt_pk_bf16_f32 v178, v48, v49
    v_cvt_pk_bf16_f32 v179, v50, v51
    v_cvt_pk_bf16_f32 v180, v52, v53
    v_cvt_pk_bf16_f32 v181, v54, v55
    v_cvt_pk_bf16_f32 v182, v56, v57
    v_cvt_pk_bf16_f32 v183, v58, v59
    v_cvt_pk_bf16_f32 v184, v60, v61
    v_cvt_pk_bf16_f32 v185, v62, v63
    v_cvt_pk_bf16_f32 v186, v64, v65
    v_cvt_pk_bf16_f32 v187, v66, v67
L_gs8:
    s_waitcnt vmcnt(0)
    v_mfma_f32_16x16x32_bf16 v[44:47], a[0:3], v[80:83], 0
    v_mfma_f32_16x16x32_bf16 v[48:51], a[4:7], v[80:83], 0
    v_mfma_f32_16x16x32_bf16 v[52:55], a[8:11], v[80:83], 0
    v_mfma_f32_16x16x32_bf16 v[52:55], a[20:23], v[84:87], v[52:55]
    v_mfma_f32_16x16x32_bf16 v[48:51], a[16:19], v[84:87], v[48:51]
    v_mfma_f32_16x16x32_bf16 v[44:47], a[12:15], v[84:87], v[44:47]
    v_mfma_f32_16x16x32_bf16 v[44:47], a[24:27], v[88:91], v[44:47]
    v_mfma_f32_16x16x32_bf16 v[48:51], a[28:31], v[88:91], v[48:51]
    v_mfma_f32_16x16x32_bf16 v[52:55], a[32:35], v[88:91], v[52:55]
    v_mfma_f32_16x16x32_bf16 v[44:47], a[36:39], v[92:95], v[44:47]
    v_mfma_f32_16x16x32_bf16 v[48:51], a[40:43], v[92:95], v[48:51]
    v_mfma_f32_16x16x32_bf16 v[52:55], a[44:47], v[92:95], v[52:55]
    v_mfma_f32_16x16x32_bf16 v[52:55], a[56:59], v[96:99], v[52:55]
    v_mfma_f32_16x16x32_bf16 v[48:51], a[52:55], v[96:99], v[48:51]
    v_mfma_f32_16x16x32_bf16 v[44:47], a[48:51], v[96:99], v[44:47]
    v_mfma_f32_16x16x32_bf16 v[44:47], a[60:63], v[100:103], v[44:47]
    v_mfma_f32_16x16x32_bf16 v[48:51], a[64:67], v[100:103], v[48:51]
    v_mfma_f32_16x16x32_bf16 v[52:55], a[68:71], v[100:103], v[52:55]
    v_mfma_f32_16x16x32_bf16 v[44:47], a[72:75], v[104:107], v[44:47]
    v_mfma_f32_16x16x32_bf16 v[48:51], a[76:79], v[104:107], v[48:51]
    v_mfma_f32_16x16x32_bf16 v[52:55], a[80:83], v[104:107], v[52:55]
    v_mfma_f32_16x16x32_bf16 v[52:55], a[92:95], v[108:111], v[52:55]
    v_mfma_f32_16x16x32_bf16 v[48:51], a[88:91], v[108:111], v[48:51]
    v_mfma_f32_16x16x32_bf16 v[44:47], a[84:87], v[108:111], v[44:47]
    v_mfma_f32_16x16x32_bf16 v[44:47], a[96:99], v[112:115], v[44:47]
    v_mfma_f32_16x16x32_bf16 v[48:51], a[100:103], v[112:115], v[48:51]
    v_mfma_f32_16x16x32_bf16 v[52:55], a[104:107], v[112:115], v[52:55]
    v_mfma_f32_16x16x32_bf16 v[44:47], a[108:111], v[116:119], v[44:47]
    v_mfma_f32_16x16x32_bf16 v[48:51], a[112:115], v[116:119], v[48:51]
    v_mfma_f32_16x16x32_bf16 v[52:55], a[116:119], v[116:119], v[52:55]
    v_mfma_f32_16x16x32_bf16 v[52:55], a[128:131], v[120:123], v[52:55]
    v_mfma_f32_16x16x32_bf16 v[48:51], a[124:127], v[120:123], v[48:51]
    v_mfma_f32_16x16x32_bf16 v[44:47], a[120:123], v[120:123], v[44:47]
    v_mfma_f32_16x16x32_bf16 v[44:47], a[132:135], v[124:127], v[44:47]
    v_mfma_f32_16x16x32_bf16 v[48:51], a[136:139], v[124:127], v[48:51]
    v_mfma_f32_16x16x32_bf16 v[52:55], a[140:143], v[124:127], v[52:55]
    v_mfma_f32_16x16x32_bf16 v[44:47], a[144:147], v[128:131], v[44:47]
    v_mfma_f32_16x16x32_bf16 v[48:51], a[148:151], v[128:131], v[48:51]
    v_mfma_f32_16x16x32_bf16 v[52:55], a[152:155], v[128:131], v[52:55]
    v_mfma_f32_16x16x32_bf16 v[52:55], a[164:167], v[132:135], v[52:55]
    v_mfma_f32_16x16x32_bf16 v[48:51], a[160:163], v[132:135], v[48:51]
    v_mfma_f32_16x16x32_bf16 v[44:47], a[156:159], v[132:135], v[44:47]
    v_mfma_f32_16x16x32_bf16 v[44:47], a[168:171], v[136:139], v[44:47]
    v_mfma_f32_16x16x32_bf16 v[48:51], a[172:175], v[136:139], v[48:51]
    v_mfma_f32_16x16x32_bf16 v[52:55], a[176:179], v[136:139], v[52:55]
    v_mfma_f32_16x16x32_bf16 v[44:47], a[180:183], v[140:143], v[44:47]
    v_mfma_f32_16x16x32_bf16 v[48:51], a[184:187], v[140:143], v[48:51]
    v_mfma_f32_16x16x32_bf16 v[52:55], a[188:191], v[140:143], v[52:55]
    v_mfma_f32_16x16x32_bf16 v[52:55], a[200:203], v[144:147], v[52:55]
    v_mfma_f32_16x16x32_bf16 v[48:51], a[196:199], v[144:147], v[48:51]
    v_mfma_f32_16x16x32_bf16 v[44:47], a[192:195], v[144:147], v[44:47]
    v_mfma_f32_16x16x32_bf16 v[44:47], a[204:207], v[148:151], v[44:47]
    v_mfma_f32_16x16x32_bf16 v[48:51], a[208:211], v[148:151], v[48:51]
    v_mfma_f32_16x16x32_bf16 v[52:55], a[212:215], v[148:151], v[52:55]
    v_mfma_f32_16x16x32_bf16 v[44:47], a[216:219], v[152:155], v[44:47]
    v_mfma_f32_16x16x32_bf16 v[48:51], a[220:223], v[152:155], v[48:51]
    v_mfma_f32_16x16x32_bf16 v[52:55], a[224:227], v[152:155], v[52:55]
    v_mfma_f32_16x16x32_bf16 v[52:55], a[236:239], v[156:159], v[52:55]
    v_mfma_f32_16x16x32_bf16 v[48:51], a[232:235], v[156:159], v[48:51]
    v_mfma_f32_16x16x32_bf16 v[44:47], a[228:231], v[156:159], v[44:47]
    v_mfma_f32_16x16x32_bf16 v[44:47], a[240:243], v[160:163], v[44:47]
    v_mfma_f32_16x16x32_bf16 v[48:51], a[244:247], v[160:163], v[48:51]
    v_mfma_f32_16x16x32_bf16 v[52:55], a[248:251], v[160:163], v[52:55]
    v_mfma_f32_16x16x32_bf16 v[44:47], a[252:255], v[164:167], v[44:47]
    v_mfma_f32_16x16x32_bf16 v[48:51], v[188:191], v[164:167], v[48:51]
    v_mfma_f32_16x16x32_bf16 v[52:55], v[192:195], v[164:167], v[52:55]
    v_mfma_f32_16x16x32_bf16 v[52:55], v[204:207], v[168:171], v[52:55]
    v_mfma_f32_16x16x32_bf16 v[48:51], v[200:203], v[168:171], v[48:51]
    v_mfma_f32_16x16x32_bf16 v[44:47], v[196:199], v[168:171], v[44:47]
    v_mfma_f32_16x16x32_bf16 v[44:47], v[208:211], v[172:175], v[44:47]
    v_mfma_f32_16x16x32_bf16 v[48:51], v[212:215], v[172:175], v[48:51]
    v_mfma_f32_16x16x32_bf16 v[52:55], v[216:219], v[172:175], v[52:55]
    v_mfma_f32_16x16x32_bf16 v[44:47], v[220:223], v[176:179], v[44:47]
    v_mfma_f32_16x16x32_bf16 v[48:51], v[224:227], v[176:179], v[48:51]
    v_mfma_f32_16x16x32_bf16 v[52:55], v[228:231], v[176:179], v[52:55]
    v_mfma_f32_16x16x32_bf16 v[52:55], v[240:243], v[180:183], v[52:55]
    v_mfma_f32_16x16x32_bf16 v[48:51], v[236:239], v[180:183], v[48:51]
    v_mfma_f32_16x16x32_bf16 v[44:47], v[232:235], v[180:183], v[44:47]
    v_mfma_f32_16x16x32_bf16 v[44:47], v[244:247], v[184:187], v[44:47]
    v_mfma_f32_16x16x32_bf16 v[48:51], v[248:251], v[184:187], v[48:51]
    v_mfma_f32_16x16x32_bf16 v[52:55], v[252:255], v[184:187], v[52:55]
    s_nop 5
    v_cvt_pk_bf16_f32 v32, v44, v45
    v_cvt_pk_bf16_f32 v33, v46, v47
    v_cvt_pk_bf16_f32 v34, v48, v49
    v_cvt_pk_bf16_f32 v35, v50, v51
    v_cvt_pk_bf16_f32 v36, v52, v53
    v_cvt_pk_bf16_f32 v37, v54, v55
    v_permlane16_swap_b32 v32, v34
    v_permlane16_swap_b32 v33, v35
    buffer_store_dwordx4 v[32:35], v9, s[16:19], s31 offen sc1
    buffer_store_dwordx2 v[36:37], v10, s[16:19], s31 offen sc1
L_gn:
    s_ashr_i32 s54, s54, 1
    s_bitset0_b32 s54, 30
    s_mul_i32 s47, s60, 36
    s_add_u32 s32, s32, s47
    s_mul_i32 s47, s60, 192
    s_add_u32 s31, s31, s47
    v_add_f32 v19, s62, v19
    v_add_f32 v20, s63, v20
    s_branch L_gt
L_gI:
    v_lshlrev_b32 v32, 16, v43
    v_and_b32 v33, 0xffff0000, v43
    v_fract_f32 v36, v32
    v_fract_f32 v37, v33
    v_cvt_u32_f32 v32, v32
    v_cvt_u32_f32 v33, v33
    v_mad_u32_u24 v40, v32, s49, v33
    v_mul_u32_u24 v40, 192, v40
    v_add_u32 v40, v40, v22
    v_sub_f32 v38, 1.0, v36
    v_sub_f32 v39, 1.0, v37
    v_cvt_pk_bf16_f32 v32, v38, v39
    v_lshlrev_b32 v38, 16, v32
    v_and_b32 v39, 0xffff0000, v32
    v_mul_f32 v1, v38, v39
    v_mul_f32 v2, v38, v37
    v_mul_f32 v3, v36, v39
    v_mul_f32 v15, v36, v37
    v_cvt_pk_bf16_f32 v32, v1, v2
    v_cvt_pk_bf16_f32 v33, v3, v15
    v_lshlrev_b32 v1, 16, v32
    v_and_b32 v2, 0xffff0000, v32
    v_lshlrev_b32 v3, 16, v33
    v_and_b32 v15, 0xffff0000, v33
    v_cmp_neq_f32 vcc, 0, v37
    v_mov_b32 v32, 192
    v_mov_b32 v33, 43008
    v_cndmask_b32 v41, 0, v32, vcc
    v_cmp_neq_f32 vcc, 0, v36
    v_mov_b32 v44, 0
    v_mov_b32 v45, 0
    v_mov_b32 v46, 0
    v_mov_b32 v47, 0
    v_mov_b32 v48, 0
    v_mov_b32 v49, 0
    v_mov_b32 v50, 0
    v_mov_b32 v51, 0
    v_mov_b32 v52, 0
    v_mov_b32 v53, 0
    v_mov_b32 v54, 0
    v_mov_b32 v55, 0
    v_mov_b32 v56, 0
    v_mov_b32 v57, 0
    v_mov_b32 v58, 0
    v_mov_b32 v59, 0
    v_mov_b32 v60, 0
    v_mov_b32 v61, 0
    v_mov_b32 v62, 0
    v_mov_b32 v63, 0
    v_mov_b32 v64, 0
    v_mov_b32 v65, 0
    v_mov_b32 v66, 0
    v_mov_b32 v67, 0
    v_cndmask_b32 v42, 0, v33, vcc
    v_sub_u32 v42, v42, v41
    s_mov_b32 s47, 4
L_gl:
    buffer_load_dwordx4 v[68:71], v40, s[4:7], 0 offen offset:0
    buffer_load_dwordx4 v[72:75], v40, s[4:7], 0 offen offset:64
    buffer_load_dwordx4 v[76:79], v40, s[4:7], 0 offen offset:128
    v_add_u32 v40, v40, v41
    v_swap_b32 v41, v42
    s_waitcnt vmcnt(0)
    v_lshlrev_b32 v32, 16, v68
    v_and_b32 v33, 0xffff0000, v68
    v_fmac_f32 v44, v1, v32
    v_fmac_f32 v45, v1, v33
    v_lshlrev_b32 v32, 16, v69
    v_and_b32 v33, 0xffff0000, v69
    v_fmac_f32 v46, v1, v32
    v_fmac_f32 v47, v1, v33
    v_lshlrev_b32 v32, 16, v70
    v_and_b32 v33, 0xffff0000, v70
    v_fmac_f32 v48, v1, v32
    v_fmac_f32 v49, v1, v33
    v_lshlrev_b32 v32, 16, v71
    v_and_b32 v33, 0xffff0000, v71
    v_fmac_f32 v50, v1, v32
    v_fmac_f32 v51, v1, v33
    v_lshlrev_b32 v32, 16, v72
    v_and_b32 v33, 0xffff0000, v72
    v_fmac_f32 v52, v1, v32
    v_fmac_f32 v53, v1, v33
    v_lshlrev_b32 v32, 16, v73
    v_and_b32 v33, 0xffff0000, v73
    v_fmac_f32 v54, v1, v32
    v_fmac_f32 v55, v1, v33
    v_lshlrev_b32 v32, 16, v74
    v_and_b32 v33, 0xffff0000, v74
    v_fmac_f32 v56, v1, v32
    v_fmac_f32 v57, v1, v33
    v_lshlrev_b32 v32, 16, v75
    v_and_b32 v33, 0xffff0000, v75
    v_fmac_f32 v58, v1, v32
    v_fmac_f32 v59, v1, v33
    v_lshlrev_b32 v32, 16, v76
    v_and_b32 v33, 0xffff0000, v76
    v_fmac_f32 v60, v1, v32
    v_fmac_f32 v61, v1, v33
    v_lshlrev_b32 v32, 16, v77
    v_and_b32 v33, 0xffff0000, v77
    v_fmac_f32 v62, v1, v32
    v_fmac_f32 v63, v1, v33
    v_lshlrev_b32 v32, 16, v78
    v_and_b32 v33, 0xffff0000, v78
    v_fmac_f32 v64, v1, v32
    v_fmac_f32 v65, v1, v33
    v_lshlrev_b32 v32, 16, v79
    v_and_b32 v33, 0xffff0000, v79
    v_fmac_f32 v66, v1, v32
    v_fmac_f32 v67, v1, v33
    v_mov_b32 v1, v2
    v_mov_b32 v2, v3
    v_mov_b32 v3, v15
    s_sub_u32 s47, s47, 1
    s_cmp_lg_u32 s47, 0
    s_cbranch_scc1 L_gl
    s_setpc_b64 s[52:53]
.p2align 7
L_ctab:
    .long 0x0, 0x18000c0, 0x400000, 0x0
    .long 0x3100008, 0x49003d0, 0x3400300, 0x10
    .long 0x6200010, 0x7a006e0, 0x6400600, 0x20
    .long 0x9300018, 0xab009f0, 0x9400900, 0x30
    .long 0xc000c0, 0x2400180, 0x10000c0, 0x40
    .long 0x3d000c8, 0x5500490, 0x40003c0, 0x50
    .long 0x6e000d0, 0x86007a0, 0x70006c0, 0x60
    .long 0x9f000d8, 0xb700ab0, 0xa0009c0, 0x70
    .long 0x1800180, 0x3100240, 0x1c00180, 0x80
    .long 0x4900188, 0x6200550, 0x4c00480, 0x1f80
    .long 0x7a00190, 0x9300860, 0x7c00780, 0x1f90
    .long 0xab00198, 0xc000b70, 0xac00a80, 0x1fa0
    .long 0x2400240, 0x3d00310, 0x2800240, 0x1fb0
    .long 0x5500248, 0x6e00620, 0x5800540, 0x1fc0
    .long 0x8600250, 0x9f00930, 0x8800840, 0x1fd0
    .long 0xb700258, 0xcc00c00, 0xb800b40, 0x1fe0
    .long 0x200c20, 0x1a000e0, 0x480020, 0x1ff0
    .long 0x3300c28, 0x4b003f0, 0x3480320, 0x2000
    .long 0x6000c30, 0x78006c0, 0x6480620, 0x3f00
    .long 0x9100c38, 0xa9009d0, 0x9480920, 0x3f10
    .long 0xe00ce0, 0x26001a0, 0x10800e0, 0x3f20
    .long 0x3f00ce8, 0x57004b0, 0x40803e0, 0x3f30
    .long 0x6c00cf0, 0x8400780, 0x70806e0, 0x3f40
    .long 0x9d00cf8, 0xb500a90, 0xa0809e0, 0x3f50
    .long 0x1a00da0, 0x3300260, 0x1c801a0, 0x3f60
    .long 0x4b00da8, 0x6000570, 0x4c804a0, 0x3f70
    .long 0x7800db0, 0x9100840, 0x7c807a0, 0x3f80
    .long 0xa900db8, 0xc200b50, 0xac80aa0, 0x5e80
    .long 0x2600e60, 0x3f00330, 0x2880260, 0x5e90
    .long 0x5700e68, 0x6c00600, 0x5880560, 0x5ea0
    .long 0x8400e70, 0x9d00910, 0x8880860, 0x5eb0
    .long 0xb500e78, 0xce00c20, 0xb880b60, 0x5ec0
    .long 0x100600, 0x19000d0, 0x500010, 0x5ed0
    .long 0x3000608, 0x48003c0, 0x3500310, 0x5ee0
    .long 0x6300610, 0x7b006f0, 0x6500610, 0x5ef0
    .long 0x9200618, 0xaa009e0, 0x9500910, 0x5f00
    .long 0xd006c0, 0x2500190, 0x11000d0, 0x7e00
    .long 0x3c006c8, 0x5400480, 0x41003d0, 0x7e10
    .long 0x6f006d0, 0x87007b0, 0x71006d0, 0x7e20
    .long 0x9e006d8, 0xb600aa0, 0xa1009d0, 0x7e30
    .long 0x1900780, 0x3000250, 0x1d00190, 0x7e40
    .long 0x4800788, 0x6300540, 0x4d00490, 0x7e50
    .long 0x7b00790, 0x9200870, 0x7d00790, 0x7e60
    .long 0xaa00798, 0xc100b60, 0xad00a90, 0x7e70
    .long 0x2500840, 0x3c00300, 0x2900250, 0x7e80
    .long 0x5400848, 0x6f00630, 0x5900550, 0x9d80
    .long 0x8700850, 0x9e00920, 0x8900850, 0x9d90
    .long 0xb600858, 0xcd00c10, 0xb900b50, 0x9da0
    .long 0x301220, 0x1b000f0, 0x580030, 0x9db0
    .long 0x3201228, 0x4a003e0, 0x3580330, 0x9dc0
    .long 0x6101230, 0x79006d0, 0x6580630, 0x9dd0
    .long 0x9001238, 0xa8009c0, 0x9580930, 0x9de0
    .long 0xf012e0, 0x27001b0, 0x11800f0, 0x9df0
    .long 0x3e012e8, 0x56004a0, 0x41803f0, 0x9e00
    .long 0x6d012f0, 0x8500790, 0x71806f0, 0xbd00
    .long 0x9c012f8, 0xb400a80, 0xa1809f0, 0xbd10
    .long 0x1b013a0, 0x3200270, 0x1d801b0, 0xbd20
    .long 0x4a013a8, 0x6100560, 0x4d804b0, 0xbd30
    .long 0x79013b0, 0x9000850, 0x7d807b0, 0xbd40
    .long 0xa8013b8, 0xc300b40, 0xad80ab0, 0xbd50
    .long 0x2701460, 0x3e00320, 0x2980270, 0xbd60
    .long 0x5601468, 0x6d00610, 0x5980570, 0xbd70
    .long 0x8501470, 0x9c00900, 0x8980870, 0xbd80
    .long 0xb401478, 0xcf00c30, 0xb980b70, 0xbd80
    .long 0xc000000, 0x0, 0x1e401e0, 0x0
    .long 0xcc000c0, 0x20, 0x1e40208, 0x0
    .long 0x19800180, 0x40, 0x147001e4, 0x0
    .long 0x1a400240, 0x60, 0x149801e4, 0x0
    .long 0x27000310, 0x80, 0x1e401e4, 0x0
    .long 0x27c003d0, 0xa0, 0x1e401e4, 0x0
    .long 0x34800490, 0xc0, 0x1e401e4, 0x0
    .long 0x35400550, 0xe0, 0x1e401e4, 0x0
    .long 0x42000620, 0x100, 0x1e401e4, 0x0
    .long 0x42c006e0, 0x120, 0x1e401e4, 0x0
    .long 0x420007a0, 0x140, 0x1e401e4, 0x0
    .long 0x42c00860, 0x160, 0x1e401e4, 0x0
    .long 0x42000930, 0x5cd00180, 0x1e401e4, 0x0
    .long 0x42c009f0, 0x5cd001a0, 0x1e401e4, 0x0
    .long 0x42000ab0, 0x5cd001c0, 0x1e401e4, 0x3f80
    .long 0x42c00b70, 0x5cd001e8, 0x1e401e4, 0x3f800000
    .long 0xc200020, 0x5cd00008, 0x1e401e4, 0x0
    .long 0xce000e0, 0x5cd00028, 0x1e401e4, 0x0
    .long 0x19a001a0, 0x5cd00048, 0x1e401e4, 0x0
    .long 0x1a600260, 0x5cd00068, 0x1e401e4, 0x0
    .long 0x27200330, 0x5cd00088, 0x1e42700, 0x0
    .long 0x27e003f0, 0x5cd000a8, 0x1e42728, 0x0
    .long 0x34a004b0, 0x5cd000c8, 0x399001e4, 0x0
    .long 0x35600570, 0x5cd000e8, 0x39b801e4, 0x0
    .long 0x42200600, 0x12900108, 0x1e401e4, 0x0
    .long 0x42e006c0, 0x12900128, 0x1e401e4, 0x0
    .long 0x42200780, 0x12900148, 0x1e401e4, 0x0
    .long 0x42e00840, 0x12900168, 0x1e401e4, 0x0
    .long 0x42200910, 0x12900188, 0x1e401e4, 0x0
    .long 0x42e009d0, 0x129001a8, 0x1e401e4, 0x0
    .long 0x42200a90, 0x129001c8, 0x1e401e4, 0x3f80
    .long 0x42e00b50, 0x129001f0, 0x1e401e4, 0x3f800000
    .long 0xc100010, 0x12900010, 0x1e401e4, 0x0
    .long 0xcd000d0, 0x12900030, 0x1e401e4, 0x0
    .long 0x19900190, 0x12900050, 0x1e401e4, 0x0
    .long 0x1a500250, 0x12900070, 0x1e401e4, 0x0
    .long 0x27100300, 0x6f600090, 0x1e401e4, 0x0
    .long 0x27d003c0, 0x6f6000b0, 0x1e401e4, 0x0
    .long 0x34900480, 0x6f6000d0, 0x1e401e4, 0x0
    .long 0x35500540, 0x6f6000f0, 0x1e401e4, 0x0
    .long 0x42100630, 0x6f600110, 0x1e44c20, 0x0
    .long 0x42d006f0, 0x6f600130, 0x1e44c48, 0x0
    .long 0x421007b0, 0x6f600150, 0x1e401e4, 0x0
    .long 0x42d00870, 0x6f600170, 0x1e401e4, 0x0
    .long 0x42100920, 0x6f600190, 0x1e401e4, 0x0
    .long 0x42d009e0, 0x6f6001b0, 0x1e401e4, 0x0
    .long 0x42100aa0, 0x6f6001d0, 0x1e401e4, 0x3f80
    .long 0x42d00b60, 0x6f6001f8, 0x1e401e4, 0x3f800000
    .long 0xc300030, 0x25200018, 0x1e401e4, 0x0
    .long 0xcf000f0, 0x25200038, 0x1e401e4, 0x0
    .long 0x19b001b0, 0x25200058, 0x1e401e4, 0x0
    .long 0x1a700270, 0x25200078, 0x1e401e4, 0x0
    .long 0x27300320, 0x25200098, 0x1e401e4, 0x0
    .long 0x27f003e0, 0x252000b8, 0x1e401e4, 0x0
    .long 0x34b004a0, 0x252000d8, 0x1e401e4, 0x0
    .long 0x35700560, 0x252000f8, 0x1e401e4, 0x0
    .long 0x42300610, 0x25200118, 0x1e401e4, 0x0
    .long 0x42f006d0, 0x25200138, 0x1e401e4, 0x0
    .long 0x42300790, 0x25200158, 0x1e401e4, 0x0
    .long 0x42f00850, 0x25200178, 0x1e401e4, 0x0
    .long 0x42300900, 0x81f00198, 0x1e401e4, 0x0
    .long 0x42f009c0, 0x81f001b8, 0x1e401e4, 0x0
    .long 0x42300a80, 0x81f001d8, 0x1e401e4, 0x3f80
    .long 0x42f00b40, 0x81f00200, 0x1e401e4, 0x3f800000
    .long 0x0, 0x0, 0x0, 0x0
    .long 0x20, 0x4, 0x0, 0x3000000
    .long 0x8, 0x8, 0x0, 0x6000000
    .long 0x28, 0xc, 0x0, 0x0
    .long 0x0, 0x1, 0x0, 0x3000001
    .long 0x20, 0x5, 0x0, 0x6000001
    .long 0x8, 0x9, 0x0, 0x1
    .long 0x28, 0xd, 0x0, 0x3000001
    .long 0x0, 0x2, 0x0, 0x6000002
    .long 0x20, 0x6, 0x0, 0x2
    .long 0x8, 0xa, 0x0, 0x3000002
    .long 0x28, 0xe, 0x0, 0x6000002
    .long 0x0, 0x3, 0x0, 0x9000003
    .long 0x20, 0x7, 0x0, 0xc000003
    .long 0x8, 0xb, 0x0, 0xf000003
    .long 0x28, 0xf, 0x0, 0x9000003
    .long 0x0, 0x0, 0x20002, 0xc000004
    .long 0x20, 0x4, 0x20002, 0xf000004
    .long 0x8, 0x8, 0x20002, 0x9000004
    .long 0x28, 0xc, 0x20002, 0xc000004
    .long 0x0, 0x1, 0x20002, 0xf000005
    .long 0x20, 0x5, 0x20002, 0x9000005
    .long 0x8, 0x9, 0x20002, 0xc000005
    .long 0x28, 0xd, 0x20002, 0xf000005
    .long 0x0, 0x2, 0x20002, 0x80006
    .long 0x20, 0x6, 0x20002, 0x3080006
    .long 0x8, 0xa, 0x20002, 0x6080006
    .long 0x28, 0xe, 0x20002, 0x80006
    .long 0x0, 0x3, 0x20002, 0x3080007
    .long 0x20, 0x7, 0x20002, 0x6080007
    .long 0x8, 0xb, 0x20002, 0x80007
    .long 0x28, 0xf, 0x20002, 0x3080007
    .long 0x0, 0x0, 0x10001, 0x6080008
    .long 0x20, 0x4, 0x10001, 0x80008
    .long 0x8, 0x8, 0x10001, 0x3080008
    .long 0x28, 0xc, 0x10001, 0x6080008
    .long 0x0, 0x1, 0x10001, 0x9080009
    .long 0x20, 0x5, 0x10001, 0xc080009
    .long 0x8, 0x9, 0x10001, 0xf080009
    .long 0x28, 0xd, 0x10001, 0x9080009
    .long 0x0, 0x2, 0x10001, 0xc08000a
    .long 0x20, 0x6, 0x10001, 0xf08000a
    .long 0x8, 0xa, 0x10001, 0x908000a
    .long 0x28, 0xe, 0x10001, 0xc08000a
    .long 0x0, 0x3, 0x10001, 0xf08000b
    .long 0x20, 0x7, 0x10001, 0x908000b
    .long 0x8, 0xb, 0x10001, 0xc08000b
    .long 0x28, 0xf, 0x10001, 0xf08000b
    .long 0x0, 0x0, 0x30003, 0x10000c
    .long 0x20, 0x4, 0x30003, 0x310000c
    .long 0x8, 0x8, 0x30003, 0x610000c
    .long 0x28, 0xc, 0x30003, 0x10000c
    .long 0x0, 0x1, 0x30003, 0x310000d
    .long 0x20, 0x5, 0x30003, 0x610000d
    .long 0x8, 0x9, 0x30003, 0x10000d
    .long 0x28, 0xd, 0x30003, 0x310000d
    .long 0x0, 0x2, 0x30003, 0x610000e
    .long 0x20, 0x6, 0x30003, 0x10000e
    .long 0x8, 0xa, 0x30003, 0x310000e
    .long 0x28, 0xe, 0x30003, 0x610000e
    .long 0x0, 0x3, 0x30003, 0x910000f
    .long 0x20, 0x7, 0x30003, 0xc10000f
    .long 0x8, 0xb, 0x30003, 0xf10000f
    .long 0x28, 0xf, 0x30003, 0x910000f
    .long 0xc0c0100, 0xc0c0c0c, 0xc0c0302, 0xc0c0c0c
    .long 0xc0c0c0c, 0xc0c0c0c, 0xc0c0c0c, 0xc0c0c0c
    .long 0xc0c0c0c, 0xc0c0c0c, 0xc0c0c0c, 0xc0c0c0c
    .long 0xc0c0c0c, 0xc0c0c0c, 0xc0c0c0c, 0xc0c0c0c
    .long 0x1000c0c, 0xc0c0c0c, 0x3020c0c, 0xc0c0c0c
    .long 0xc0c0c0c, 0xc0c0c0c, 0xc0c0c0c, 0xc0c0c0c
    .long 0xc0c0c0c, 0xc0c0c0c, 0xc0c0c0c, 0xc0c0c0c
    .long 0xc0c0c0c, 0xc0c0c0c, 0xc0c0c0c, 0xc0c0c0c
    .long 0xc0c0c0c, 0xc0c0100, 0xc0c0c0c, 0xc0c0302
    .long 0xc0c0c0c, 0xc0c0c0c, 0xc0c0c0c, 0xc0c0c0c
    .long 0xc0c0c0c, 0xc0c0c0c, 0xc0c0c0c, 0xc0c0c0c
    .long 0xc0c0c0c, 0xc0c0c0c, 0xc0c0c0c, 0xc0c0c0c
    .long 0xc0c0c0c, 0x1000c0c, 0xc0c0c0c, 0x3020c0c
    .long 0xc0c0c0c, 0xc0c0c0c, 0xc0c0c0c, 0xc0c0c0c
    .long 0xc0c0c0c, 0xc0c0c0c, 0xc0c0c0c, 0xc0c0c0c
    .long 0xc0c0c0c, 0xc0c0c0c, 0xc0c0c0c, 0xc0c0c0c
    .long 0xc0c0c0c, 0xc0c0c0c, 0xc0c0c0c, 0xc0c0c0c
    .long 0xc0c0100, 0xc0c0c0c, 0xc0c0302, 0xc0c0c0c
    .long 0xc0c0c0c, 0xc0c0c0c, 0xc0c0c0c, 0xc0c0c0c
    .long 0xc0c0c0c, 0xc0c0c0c, 0xc0c0c0c, 0xc0c0c0c
    .long 0xc0c0c0c, 0xc0c0c0c, 0xc0c0c0c, 0xc0c0c0c
    .long 0x1000c0c, 0xc0c0c0c, 0x3020c0c, 0xc0c0c0c
    .long 0xc0c0c0c, 0xc0c0c0c, 0xc0c0c0c, 0xc0c0c0c
    .long 0xc0c0c0c, 0xc0c0c0c, 0xc0c0c0c, 0xc0c0c0c
    .long 0xc0c0c0c, 0xc0c0c0c, 0xc0c0c0c, 0xc0c0c0c
    .long 0xc0c0c0c, 0xc0c0100, 0xc0c0c0c, 0xc0c0302
    .long 0xc0c0c0c, 0xc0c0c0c, 0xc0c0c0c, 0xc0c0c0c
    .long 0xc0c0c0c, 0xc0c0c0c, 0xc0c0c0c, 0xc0c0c0c
    .long 0xc0c0c0c, 0xc0c0c0c, 0xc0c0c0c, 0xc0c0c0c
    .long 0xc0c0c0c, 0x1000c0c, 0xc0c0c0c, 0x3020c0c
    .long 0xc0c0c0c, 0xc0c0c0c, 0xc0c0c0c, 0xc0c0c0c
    .long 0xc0c0c0c, 0xc0c0c0c, 0xc0c0c0c, 0xc0c0c0c
    .long 0xc0c0c0c, 0xc0c0c0c, 0xc0c0c0c, 0xc0c0c0c
    .long 0xc0c0c0c, 0xc0c0c0c, 0xc0c0c0c, 0xc0c0c0c
    .long 0xc0c0100, 0xc0c0c0c, 0xc0c0302, 0xc0c0c0c
    .long 0xc0c0c0c, 0xc0c0c0c, 0xc0c0c0c, 0xc0c0c0c
    .long 0xc0c0c0c, 0xc0c0c0c, 0xc0c0c0c, 0xc0c0c0c
    .long 0xc0c0c0c, 0xc0c0c0c, 0xc0c0c0c, 0xc0c0c0c
    .long 0x1000c0c, 0xc0c0c0c, 0x3020c0c, 0xc0c0c0c
    .long 0xc0c0c0c, 0xc0c0c0c, 0xc0c0c0c, 0xc0c0c0c
    .long 0xc0c0c0c, 0xc0c0c0c, 0xc0c0c0c, 0xc0c0c0c
    .long 0xc0c0c0c, 0xc0c0c0c, 0xc0c0c0c, 0xc0c0c0c
    .long 0xc0c0c0c, 0xc0c0100, 0xc0c0c0c, 0xc0c0302
    .long 0xc0c0c0c, 0xc0c0c0c, 0xc0c0c0c, 0xc0c0c0c
    .long 0xc0c0c0c, 0xc0c0c0c, 0xc0c0c0c, 0xc0c0c0c
    .long 0xc0c0c0c, 0xc0c0c0c, 0xc0c0c0c, 0xc0c0c0c
    .long 0xc0c0c0c, 0x1000c0c, 0xc0c0c0c, 0x3020c0c
    .long 0xc0c0c0c, 0xc0c0c0c, 0xc0c0c0c, 0xc0c0c0c
    .long 0xc0c0c0c, 0xc0c0c0c, 0xc0c0c0c, 0xc0c0c0c
    .long 0xc0c0c0c, 0xc0c0c0c, 0xc0c0c0c, 0xc0c0c0c
    .long 0xc0c0c0c, 0xc0c0c0c, 0xc0c0c0c, 0xc0c0c0c
    .long 0xc0c0100, 0xc0c0c0c, 0xc0c0302, 0xc0c0c0c
    .long 0xc0c0c0c, 0xc0c0c0c, 0xc0c0c0c, 0xc0c0c0c
    .long 0xc0c0c0c, 0xc0c0c0c, 0xc0c0c0c, 0xc0c0c0c
    .long 0xc0c0c0c, 0xc0c0c0c, 0xc0c0c0c, 0xc0c0c0c
    .long 0x1000c0c, 0xc0c0c0c, 0x3020c0c, 0xc0c0c0c
    .long 0xc0c0c0c, 0xc0c0c0c, 0xc0c0c0c, 0xc0c0c0c
    .long 0xc0c0c0c, 0xc0c0c0c, 0xc0c0c0c, 0xc0c0c0c
    .long 0xc0c0c0c, 0xc0c0c0c, 0xc0c0c0c, 0xc0c0c0c
    .long 0xc0c0c0c, 0xc0c0100, 0xc0c0c0c, 0xc0c0302
    .long 0xc0c0c0c, 0xc0c0c0c, 0xc0c0c0c, 0xc0c0c0c
    .long 0xc0c0c0c, 0xc0c0c0c, 0xc0c0c0c, 0xc0c0c0c
    .long 0xc0c0c0c, 0xc0c0c0c, 0xc0c0c0c, 0xc0c0c0c
    .long 0xc0c0c0c, 0x1000c0c, 0xc0c0c0c, 0x3020c0c
.p2align 6
L_runtab:
    .long 0x15a800, 0x925800, 0x55, 0x2200, 0x87543021, 0x6, 0x165000, 0x199800, 0x3dff, 0x0, 0x0, 0x0, 0x0, 0x0, 0x42f00, 0xa
    .long 0x295800, 0x925800, 0x55, 0x4000, 0x87543021, 0x6, 0x2a0000, 0x2d4800, 0x3dff, 0x0, 0x0, 0x0, 0x0, 0x0, 0x7e000, 0xa
    .long 0x3d0800, 0x925800, 0x55, 0x5e00, 0x87543021, 0x6, 0x3db000, 0x40f800, 0x3e7f, 0x0, 0x0, 0x0, 0x0, 0x0, 0xb9100, 0xa
    .long 0x50b800, 0x925800, 0x55, 0x7c00, 0x87543021, 0x6, 0x516000, 0x54a800, 0x3e7f, 0x0, 0x0, 0x0, 0x0, 0x0, 0xf4200, 0xa
    .long 0x5dd800, 0x925800, 0x55, 0x9000, 0x87543021, 0x6, 0x5e8000, 0x61c800, 0x3eff, 0x0, 0x0, 0x0, 0x0, 0x0, 0x11b800, 0xa
    .long 0x6af800, 0x925800, 0x55, 0xa400, 0x87543021, 0x6, 0x6ba000, 0x6ee800, 0x3eff, 0x0, 0x0, 0x0, 0x0, 0x0, 0x142e00, 0xa
    .long 0x781800, 0x925800, 0x55, 0xb800, 0x87543021, 0x6, 0x78c000, 0x7c0800, 0x3eff, 0x0, 0x0, 0x0, 0x0, 0x0, 0x16a400, 0xa
    .long 0x853800, 0x925800, 0x55, 0xcc00, 0x87543021, 0x6, 0x85e000, 0x892800, 0x3eff, 0x0, 0x0, 0x0, 0x0, 0x0, 0x191a00, 0xa
    .long 0x1c3800, 0x925800, 0x55, 0x2c00, 0x87543021, 0x6, 0x1ce000, 0x202800, 0x3dff, 0x0, 0x0, 0x0, 0x0, 0x0, 0x56a00, 0xa
    .long 0x2fe800, 0x925800, 0x55, 0x4a00, 0x87543021, 0x6, 0x309000, 0x33d800, 0x3e7f, 0x0, 0x0, 0x0, 0x0, 0x0, 0x91b00, 0xa
    .long 0x439800, 0x925800, 0x55, 0x6800, 0x87543021, 0x6, 0x444000, 0x478800, 0x3e7f, 0x0, 0x0, 0x0, 0x0, 0x0, 0xccc00, 0xa
    .long 0x574800, 0x925800, 0x55, 0x8600, 0x87543021, 0x6, 0x57f000, 0x5b3800, 0x3eff, 0x0, 0x0, 0x0, 0x0, 0x0, 0x107d00, 0xa
    .long 0x646800, 0x925800, 0x55, 0x9a00, 0x87543021, 0x6, 0x651000, 0x685800, 0x3eff, 0x0, 0x0, 0x0, 0x0, 0x0, 0x12f300, 0xa
    .long 0x718800, 0x925800, 0x55, 0xae00, 0x87543021, 0x6, 0x723000, 0x757800, 0x3eff, 0x0, 0x0, 0x0, 0x0, 0x0, 0x156900, 0xa
    .long 0x7ea800, 0x925800, 0x55, 0xc200, 0x87543021, 0x6, 0x7f5000, 0x829800, 0x3eff, 0x0, 0x0, 0x0, 0x0, 0x0, 0x17df00, 0xa
    .long 0x8bc800, 0x925800, 0x55, 0xd600, 0x87543021, 0x6, 0x8c7000, 0x8fb800, 0x3eff, 0x0, 0x0, 0x0, 0x0, 0x0, 0x1a5500, 0xa
    .long 0x22c800, 0x925800, 0x55, 0x3600, 0x87543021, 0x6, 0x237000, 0x26b800, 0x3dff, 0x0, 0x0, 0x0, 0x0, 0x0, 0x6a500, 0xa
    .long 0x367800, 0x925800, 0x55, 0x5400, 0x87543021, 0x6, 0x372000, 0x3a6800, 0x3e7f, 0x0, 0x0, 0x0, 0x0, 0x0, 0xa5600, 0xa
    .long 0x4a2800, 0x925800, 0x55, 0x7200, 0x87543021, 0x6, 0x4ad000, 0x4e1800, 0x3e7f, 0x0, 0x0, 0x0, 0x0, 0x0, 0xe0700, 0xa
    .long 0x45c0, 0xa740, 0x55, 0x15e00, 0x85741063, 0x2, 0x4680, 0x4a40, 0x3e7f, 0x0, 0x0, 0x0, 0x0, 0x0, 0xd38, 0xa
    .long 0x5c40, 0xa740, 0x55, 0x17c00, 0x85741063, 0x2, 0x5d00, 0x60c0, 0x3e7f, 0x0, 0x0, 0x0, 0x0, 0x0, 0x1170, 0xa
    .long 0x72c0, 0xa740, 0x55, 0x19a00, 0x85741063, 0x2, 0x7380, 0x7740, 0x3eff, 0x0, 0x0, 0x0, 0x0, 0x0, 0x15a8, 0xa
    .long 0x8940, 0xa740, 0x55, 0x1b800, 0x85741063, 0x2, 0x8a00, 0x8dc0, 0x3eff, 0x0, 0x0, 0x0, 0x0, 0x0, 0x19e0, 0xa
    .long 0x9840, 0xa740, 0x55, 0x1cc00, 0x85741063, 0x2, 0x9900, 0x9cc0, 0x3eff, 0x0, 0x0, 0x0, 0x0, 0x0, 0x1cb0, 0xa
    .long 0x18c0, 0xa740, 0x55, 0x12200, 0x85741063, 0x2, 0x1980, 0x1d40, 0x3dff, 0x0, 0x0, 0x0, 0x0, 0x0, 0x4c8, 0xa
    .long 0x27c0, 0xa740, 0x55, 0x13600, 0x85741063, 0x2, 0x2880, 0x2c40, 0x3dff, 0x0, 0x0, 0x0, 0x0, 0x0, 0x798, 0xa
    .long 0x36c0, 0xa740, 0x55, 0x14a00, 0x85741063, 0x2, 0x3780, 0x3b40, 0x3e7f, 0x0, 0x0, 0x0, 0x0, 0x0, 0xa68, 0xa
    .long 0x4d40, 0xa740, 0x55, 0x16800, 0x85741063, 0x2, 0x4e00, 0x51c0, 0x3e7f, 0x0, 0x0, 0x0, 0x0, 0x0, 0xea0, 0xa
    .long 0x63c0, 0xa740, 0x55, 0x18600, 0x85741063, 0x2, 0x6480, 0x6840, 0x3eff, 0x0, 0x0, 0x0, 0x0, 0x0, 0x12d8, 0xa
    .long 0x7a40, 0xa740, 0x55, 0x1a400, 0x85741063, 0x2, 0x7b00, 0x7ec0, 0x3eff, 0x0, 0x0, 0x0, 0x0, 0x0, 0x1710, 0xa
    .long 0x90c0, 0xa740, 0x55, 0x1c200, 0x85741063, 0x2, 0x9180, 0x9540, 0x3eff, 0x0, 0x0, 0x0, 0x0, 0x0, 0x1b48, 0xa
    .long 0x9fc0, 0xa740, 0x55, 0x1d600, 0x85741063, 0x2, 0xa080, 0xa440, 0x3eff, 0x0, 0x0, 0x0, 0x0, 0x0, 0x1e18, 0xa
    .long 0x2040, 0xa740, 0x55, 0x12c00, 0x85741063, 0x2, 0x2100, 0x24c0, 0x3dff, 0x0, 0x0, 0x0, 0x0, 0x0, 0x630, 0xa
    .long 0x2f40, 0xa740, 0x55, 0x14000, 0x85741063, 0x2, 0x3000, 0x33c0, 0x3dff, 0x0, 0x0, 0x0, 0x0, 0x0, 0x900, 0xa
    .long 0x3e40, 0xa740, 0x55, 0x15400, 0x85741063, 0x2, 0x3f00, 0x42c0, 0x3e7f, 0x0, 0x0, 0x0, 0x0, 0x0, 0xbd0, 0xa
    .long 0x54c0, 0xa740, 0x55, 0x17200, 0x85741063, 0x2, 0x5580, 0x5940, 0x3e7f, 0x0, 0x0, 0x0, 0x0, 0x0, 0x1008, 0xa
    .long 0x6b40, 0xa740, 0x55, 0x19000, 0x85741063, 0x2, 0x6c00, 0x6fc0, 0x3eff, 0x0, 0x0, 0x0, 0x0, 0x0, 0x1440, 0xa
    .long 0x81c0, 0xa740, 0x55, 0x1ae00, 0x85741063, 0x2, 0x8280, 0x8640, 0x3eff, 0x0, 0x0, 0x0, 0x0, 0x0, 0x1878, 0xa
    .long 0xa80, 0xf00, 0x12, 0x1fe31000, 0x6ac0, 0x18a, 0xc00, 0xcc0, 0xbf800000, 0x41700000, 0xf4, 0xe, 0x7, 0x5b80, 0x240, 0x3
    .long 0xcc0, 0x1140, 0x12, 0x1fe31300, 0x6ac0, 0x18a, 0xe40, 0xf00, 0xbf800000, 0x41900000, 0xf4, 0x11, 0x7, 0x5b80, 0x2ac, 0x3
    .long 0xf00, 0x1440, 0x22, 0x1fe31600, 0x7a00, 0x175, 0x1080, 0x1140, 0xbf800000, 0x41a80000, 0xf4, 0x14, 0x8, 0x6ac0, 0x318, 0x4
    .long 0x1200, 0x1740, 0x22, 0x1fe31a00, 0x7a00, 0x175, 0x1380, 0x1440, 0xbf800000, 0x41c80000, 0xf4, 0x18, 0x8, 0x6ac0, 0x3a8, 0x4
    .long 0x1500, 0x1a40, 0x22, 0x1fe31e00, 0x7a00, 0x175, 0x1680, 0x1740, 0xbf800000, 0x41e80000, 0xf4, 0x1c, 0x8, 0x6ac0, 0x438, 0x4
    .long 0x4d40, 0x5700, 0x66, 0xe36810, 0xd580, 0xfb, 0xace00, 0xacec0, 0x41700000, 0x42ce0000, 0x0, 0x67, 0xe, 0xc640, 0x206a0, 0xc
    .long 0x5f40, 0x6900, 0x66, 0xe38010, 0xd580, 0xfb, 0xae000, 0xae0c0, 0x41700000, 0x42fe0000, 0x0, 0x7f, 0xe, 0xc640, 0x20a00, 0xc
    .long 0x7140, 0x7b00, 0x66, 0xe39810, 0xd580, 0xfb, 0xaf200, 0xaf2c0, 0x41700000, 0x43170000, 0x0, 0x97, 0xe, 0xc640, 0x20d60, 0xc
    .long 0x8340, 0x8d00, 0x66, 0xe3b010, 0xd580, 0xfb, 0xb0400, 0xb04c0, 0x41700000, 0x432f0000, 0x0, 0xaf, 0xe, 0xc640, 0x210c0, 0xc
    .long 0x9540, 0x9f00, 0x66, 0xe3c810, 0xd580, 0xfb, 0xb1600, 0xb16c0, 0x41700000, 0x43470000, 0x0, 0xc7, 0xe, 0xc640, 0x21420, 0xc
    .long 0x1680, 0x21c0, 0x66, 0xe32010, 0xf400, 0xd3, 0xa9800, 0xa98c0, 0x41700000, 0x41f80000, 0xf4, 0x1e, 0x10, 0xe4c0, 0x1fc80, 0xc
    .long 0x2940, 0x3300, 0x66, 0xe33810, 0xd580, 0xfb, 0xaaa00, 0xaaac0, 0x41700000, 0x425c0000, 0x0, 0x37, 0xe, 0xc640, 0x1ffe0, 0xc
    .long 0x3b40, 0x4500, 0x66, 0xe35010, 0xd580, 0xfb, 0xabc00, 0xabcc0, 0x41700000, 0x429e0000, 0x0, 0x4f, 0xe, 0xc640, 0x20340, 0xc
    .long 0x5640, 0x6000, 0x66, 0xe37410, 0xd580, 0xfb, 0xad700, 0xad7c0, 0x41700000, 0x42e60000, 0x0, 0x73, 0xe, 0xc640, 0x20850, 0xc
    .long 0x6840, 0x7200, 0x66, 0xe38c10, 0xd580, 0xfb, 0xae900, 0xae9c0, 0x41700000, 0x430b0000, 0x0, 0x8b, 0xe, 0xc640, 0x20bb0, 0xc
    .long 0x7a40, 0x8400, 0x66, 0xe3a410, 0xd580, 0xfb, 0xafb00, 0xafbc0, 0x41700000, 0x43230000, 0x0, 0xa3, 0xe, 0xc640, 0x20f10, 0xc
    .long 0x8c40, 0x9600, 0x66, 0xe3bc10, 0xd580, 0xfb, 0xb0d00, 0xb0dc0, 0x41700000, 0x433b0000, 0x0, 0xbb, 0xe, 0xc640, 0x21270, 0xc
    .long 0x9e40, 0xa740, 0x66, 0xe3d410, 0xd580, 0xfb, 0xb1f00, 0xb1fc0, 0x41700000, 0x43530000, 0x0, 0xd3, 0xe, 0xc640, 0x215d0, 0xc
    .long 0x2040, 0x2a00, 0x66, 0xe32c10, 0xd580, 0xfb, 0xaa100, 0xaa1c0, 0x41700000, 0x422c0000, 0x0, 0x2b, 0xe, 0xc640, 0x1fe30, 0xc
    .long 0x3240, 0x3c00, 0x66, 0xe34410, 0xd580, 0xfb, 0xab300, 0xab3c0, 0x41700000, 0x42860000, 0x0, 0x43, 0xe, 0xc640, 0x20190, 0xc
    .long 0x4440, 0x4e00, 0x66, 0xe35c10, 0xd580, 0xfb, 0xac500, 0xac5c0, 0x41700000, 0x42b60000, 0x0, 0x5b, 0xe, 0xc640, 0x204f0, 0xc
    .long 0xfffeb000, 0x2a000, 0x12, 0x1fe20000, 0x6ac0, 0x18a, 0x0, 0xa800, 0xbf800000, 0xbf800000, 0xf4, 0xfffffffe, 0x7, 0x5b80, 0x0, 0x3
    .long 0xa800, 0x49800, 0x12, 0x1fe20300, 0x6ac0, 0x18a, 0x1f800, 0x2a000, 0x40000000, 0xbf800000, 0xf4, 0x1, 0x7, 0x5b80, 0x5e80, 0x3
    .long 0x2a000, 0x69000, 0x12, 0x1fe20600, 0x6ac0, 0x18a, 0x3f000, 0x49800, 0x40a00000, 0xbf800000, 0xf4, 0x4, 0x7, 0x5b80, 0xbd00, 0x3
    .long 0x49800, 0x93000, 0x22, 0x1fe20900, 0x7a00, 0x175, 0x5e800, 0x69000, 0x41000000, 0xbf800000, 0xf4, 0x7, 0x8, 0x6ac0, 0x11b80, 0x4
    .long 0x73800, 0xbd000, 0x22, 0x1fe20d00, 0x7a00, 0x175, 0x88800, 0x93000, 0x41400000, 0xbf800000, 0xf4, 0xb, 0x8, 0x6ac0, 0x19980, 0x4
    .long 0x9d800, 0xe7000, 0x22, 0x1fe21100, 0x7a00, 0x175, 0xb2800, 0xbd000, 0x41800000, 0xbf800000, 0xf4, 0xf, 0x8, 0x6ac0, 0x21780, 0x4
    .long 0xc7800, 0x111000, 0x22, 0x1fe21500, 0x7a00, 0x175, 0xdc800, 0xe7000, 0x41a00000, 0xbf800000, 0xf4, 0x13, 0x8, 0x6ac0, 0x29580, 0x4
    .long 0xf1800, 0x13b000, 0x22, 0x1fe21900, 0x7a00, 0x175, 0x106800, 0x111000, 0x41c00000, 0xbf800000, 0xf4, 0x17, 0x8, 0x6ac0, 0x31380, 0x4
    .long 0x11b800, 0x16f800, 0x23, 0x1fe21d00, 0x8940, 0x161, 0x130800, 0x13b000, 0x41e00000, 0xbf800000, 0xf4, 0x1b, 0x9, 0x7a00, 0x39180, 0x5
    .long 0x5b3800, 0x63c000, 0x66, 0x1e28c20, 0xd580, 0xfb, 0x5bf800, 0x5ca000, 0x430b0000, 0x41f80000, 0x0, 0x8b, 0xe, 0xc640, 0x113e80, 0xc
    .long 0x7ab800, 0x834000, 0x66, 0xe2bc10, 0xd580, 0xfb, 0x7b6c00, 0x7c1400, 0x433b0000, 0x41700000, 0x0, 0xbb, 0xe, 0xc640, 0x172440, 0xc
    .long 0x8a7800, 0x925800, 0x66, 0x1e2d420, 0xd580, 0xfb, 0x8b3800, 0x8be000, 0x43530000, 0x41f80000, 0x0, 0xd3, 0xe, 0xc640, 0x1a1a80, 0xc
    .long 0x13b000, 0x1c3800, 0x55, 0x7e22080, 0xd580, 0xfb, 0x156000, 0x160800, 0x41f80000, 0x42fe0000, 0xf4, 0x1e, 0xe, 0xc640, 0x40200, 0xa
    .long 0x93000, 0xf1800, 0x33, 0xe21010, 0x9880, 0x14d, 0xa8c00, 0xb3400, 0x41700000, 0x41700000, 0xf4, 0xe, 0xa, 0x8940, 0x1fa40, 0x6
    .long 0x241800, 0x2ca000, 0x66, 0xe23810, 0xd580, 0xfb, 0x24cc00, 0x257400, 0x425c0000, 0x41700000, 0x0, 0x37, 0xe, 0xc640, 0x6e640, 0xc
    .long 0x33d800, 0x3c6000, 0x66, 0x1e25020, 0xd580, 0xfb, 0x349800, 0x354000, 0x429e0000, 0x41f80000, 0x0, 0x4f, 0xe, 0xc640, 0x9dc80, 0xc
    .long 0x4b7800, 0x540000, 0x66, 0xe27410, 0xd580, 0xfb, 0x4c2c00, 0x4cd400, 0x42e60000, 0x41700000, 0x0, 0x73, 0xe, 0xc640, 0xe4840, 0xc
    .long 0x631800, 0x6ba000, 0x66, 0xe29810, 0xd580, 0xfb, 0x63cc00, 0x647400, 0x43170000, 0x41700000, 0x0, 0x97, 0xe, 0xc640, 0x12b640, 0xc
    .long 0x72d800, 0x7b6000, 0x66, 0x1e2b020, 0xd580, 0xfb, 0x739800, 0x744000, 0x432f0000, 0x41f80000, 0x0, 0xaf, 0xe, 0xc640, 0x15ac80, 0xc
    .long 0x13b000, 0x1c3800, 0x55, 0x2e22030, 0xd580, 0xfb, 0x152400, 0x15cc00, 0x41f80000, 0x423c0000, 0xf4, 0x1e, 0xe, 0xc640, 0x3f6c0, 0xa
    .long 0x13b000, 0x1c3800, 0x55, 0x8e22090, 0xd580, 0xfb, 0x156c00, 0x161400, 0x41f80000, 0x430f0000, 0xf4, 0x1e, 0xe, 0xc640, 0x40440, 0xa
    .long 0xd2000, 0x15a800, 0x55, 0xe21610, 0xd580, 0xfb, 0xe7c00, 0xf2400, 0x41a80000, 0x41700000, 0xf4, 0x14, 0xe, 0xc640, 0x2b740, 0xa
    .long 0x241800, 0x2ca000, 0x66, 0x1e23820, 0xd580, 0xfb, 0x24d800, 0x258000, 0x425c0000, 0x41f80000, 0x0, 0x37, 0xe, 0xc640, 0x6e880, 0xc
    .long 0x3bb800, 0x444000, 0x66, 0xe25c10, 0xd580, 0xfb, 0x3c6c00, 0x3d1400, 0x42b60000, 0x41700000, 0x0, 0x5b, 0xe, 0xc640, 0xb5440, 0xc
    .long 0x4b7800, 0x540000, 0x66, 0x1e27420, 0xd580, 0xfb, 0x4c3800, 0x4ce000, 0x42e60000, 0x41f80000, 0x0, 0x73, 0xe, 0xc640, 0xe4a80, 0xc
    .long 0x631800, 0x6ba000, 0x66, 0x1e29820, 0xd580, 0xfb, 0x63d800, 0x648000, 0x43170000, 0x41f80000, 0x0, 0x97, 0xe, 0xc640, 0x12b880, 0xc
    .long 0x7ab800, 0x834000, 0x66, 0x1e2bc20, 0xd580, 0xfb, 0x7b7800, 0x7c2000, 0x433b0000, 0x41f80000, 0x0, 0xbb, 0xe, 0xc640, 0x172680, 0xc
    .long 0x13b000, 0x1c3800, 0x55, 0x3e22040, 0xd580, 0xfb, 0x153000, 0x15d800, 0x41f80000, 0x427c0000, 0xf4, 0x1e, 0xe, 0xc640, 0x3f900, 0xa
    .long 0x13b000, 0x1c3800, 0x55, 0x9e220a0, 0xd580, 0xfb, 0x157800, 0x162000, 0x41f80000, 0x431f0000, 0xf4, 0x1e, 0xe, 0xc640, 0x40680, 0xa
    .long 0x13b000, 0x1d8800, 0x66, 0xe22010, 0xf400, 0xd3, 0x150c00, 0x15b400, 0x41f80000, 0x41700000, 0xf4, 0x1e, 0x10, 0xe4c0, 0x3f240, 0xc
    .long 0x2bf800, 0x348000, 0x66, 0xe24410, 0xd580, 0xfb, 0x2cac00, 0x2d5400, 0x42860000, 0x41700000, 0x0, 0x43, 0xe, 0xc640, 0x86040, 0xc
    .long 0x439800, 0x4c2000, 0x66, 0xe26810, 0xd580, 0xfb, 0x444c00, 0x44f400, 0x42ce0000, 0x41700000, 0x0, 0x67, 0xe, 0xc640, 0xcce40, 0xc
    .long 0x535800, 0x5be000, 0x66, 0xe28010, 0xd580, 0xfb, 0x540c00, 0x54b400, 0x42fe0000, 0x41700000, 0x0, 0x7f, 0xe, 0xc640, 0xfc240, 0xc
    .long 0x6af800, 0x738000, 0x66, 0xe2a410, 0xd580, 0xfb, 0x6bac00, 0x6c5400, 0x43230000, 0x41700000, 0x0, 0xa3, 0xe, 0xc640, 0x143040, 0xc
    .long 0x829800, 0x8b2000, 0x66, 0xe2c810, 0xd580, 0xfb, 0x834c00, 0x83f400, 0x43470000, 0x41700000, 0x0, 0xc7, 0xe, 0xc640, 0x189e40, 0xc
    .long 0x13b000, 0x1c3800, 0x55, 0x4e22050, 0xd580, 0xfb, 0x153c00, 0x15e400, 0x41f80000, 0x429e0000, 0xf4, 0x1e, 0xe, 0xc640, 0x3fb40, 0xa
    .long 0x13b000, 0x1c3800, 0x55, 0xae220b0, 0xd580, 0xfb, 0x158400, 0x162c00, 0x41f80000, 0x432f0000, 0xf4, 0x1e, 0xe, 0xc640, 0x408c0, 0xa
    .long 0x13b000, 0x1d8800, 0x66, 0x1e22020, 0xf400, 0xd3, 0x151800, 0x15c000, 0x41f80000, 0x41f80000, 0xf4, 0x1e, 0x10, 0xe4c0, 0x3f480, 0xc
    .long 0x2bf800, 0x348000, 0x66, 0x1e24420, 0xd580, 0xfb, 0x2cb800, 0x2d6000, 0x42860000, 0x41f80000, 0x0, 0x43, 0xe, 0xc640, 0x86280, 0xc
    .long 0x3bb800, 0x444000, 0x66, 0x1e25c20, 0xd580, 0xfb, 0x3c7800, 0x3d2000, 0x42b60000, 0x41f80000, 0x0, 0x5b, 0xe, 0xc640, 0xb5680, 0xc
    .long 0x535800, 0x5be000, 0x66, 0x1e28020, 0xd580, 0xfb, 0x541800, 0x54c000, 0x42fe0000, 0x41f80000, 0x0, 0x7f, 0xe, 0xc640, 0xfc480, 0xc
    .long 0x6af800, 0x738000, 0x66, 0x1e2a420, 0xd580, 0xfb, 0x6bb800, 0x6c6000, 0x43230000, 0x41f80000, 0x0, 0xa3, 0xe, 0xc640, 0x143280, 0xc
    .long 0x829800, 0x8b2000, 0x66, 0x1e2c820, 0xd580, 0xfb, 0x835800, 0x840000, 0x43470000, 0x41f80000, 0x0, 0xc7, 0xe, 0xc640, 0x18a080, 0xc
    .long 0x13b000, 0x1c3800, 0x55, 0x5e22060, 0xd580, 0xfb, 0x154800, 0x15f000, 0x41f80000, 0x42be0000, 0xf4, 0x1e, 0xe, 0xc640, 0x3fd80, 0xa
    .long 0x13b000, 0x1c3800, 0x55, 0xbe220c0, 0xd580, 0xfb, 0x159000, 0x163800, 0x41f80000, 0x433f0000, 0xf4, 0x1e, 0xe, 0xc640, 0x40b00, 0xa
    .long 0x1c3800, 0x24c000, 0x66, 0xe22c10, 0xd580, 0xfb, 0x1cec00, 0x1d9400, 0x422c0000, 0x41700000, 0x0, 0x2b, 0xe, 0xc640, 0x56c40, 0xc
    .long 0x33d800, 0x3c6000, 0x66, 0xe25010, 0xd580, 0xfb, 0x348c00, 0x353400, 0x429e0000, 0x41700000, 0x0, 0x4f, 0xe, 0xc640, 0x9da40, 0xc
    .long 0x439800, 0x4c2000, 0x66, 0x1e26820, 0xd580, 0xfb, 0x445800, 0x450000, 0x42ce0000, 0x41f80000, 0x0, 0x67, 0xe, 0xc640, 0xcd080, 0xc
    .long 0x5b3800, 0x63c000, 0x66, 0xe28c10, 0xd580, 0xfb, 0x5bec00, 0x5c9400, 0x430b0000, 0x41700000, 0x0, 0x8b, 0xe, 0xc640, 0x113c40, 0xc
    .long 0x72d800, 0x7b6000, 0x66, 0xe2b010, 0xd580, 0xfb, 0x738c00, 0x743400, 0x432f0000, 0x41700000, 0x0, 0xaf, 0xe, 0xc640, 0x15aa40, 0xc
    .long 0x8a7800, 0x925800, 0x66, 0xe2d410, 0xd580, 0xfb, 0x8b2c00, 0x8bd400, 0x43530000, 0x41700000, 0x0, 0xd3, 0xe, 0xc640, 0x1a1840, 0xc
    .long 0x13b000, 0x1c3800, 0x55, 0x6e22070, 0xd580, 0xfb, 0x155400, 0x15fc00, 0x41f80000, 0x42de0000, 0xf4, 0x1e, 0xe, 0xc640, 0x3ffc0, 0xa
    .long 0x13b000, 0x1c3800, 0x55, 0xce220d0, 0xd580, 0xfb, 0x159c00, 0x164400, 0x41f80000, 0x434f0000, 0xf4, 0x1e, 0xe, 0xc640, 0x40d40, 0xa
    .long 0x1c3800, 0x24c000, 0x66, 0x1e22c20, 0xd580, 0xfb, 0x1cf800, 0x1da000, 0x422c0000, 0x41f80000, 0x0, 0x2b, 0xe, 0xc640, 0x56e80, 0xc
    .long 0x3fa800, 0x925800, 0x77, 0x6240, 0x3dff3e7f, 0x3dff3e7f, 0x408000, 0x451800, 0x0, 0x0, 0x0, 0x0, 0x0, 0x0, 0x0, 0x0
    .long 0x646800, 0x925800, 0x77, 0x9a60, 0x3e7f3eff, 0x3e7f3eff, 0x655800, 0x69f000, 0x0, 0x0, 0x0, 0x0, 0x0, 0x0, 0x0, 0x0
    .long 0x1ae800, 0x925800, 0x77, 0x2a80, 0x3e7f3dff, 0x3e7f3dff, 0x1bf000, 0x208800, 0x0, 0x0, 0x0, 0x0, 0x0, 0x0, 0x0, 0x0
    .long 0x3fa800, 0x925800, 0x77, 0x62a0, 0x3eff3e7f, 0x3eff3e7f, 0x40c800, 0x456000, 0x0, 0x0, 0x0, 0x0, 0x0, 0x0, 0x0, 0x0
    .long 0x6d9800, 0x925800, 0x77, 0xa880, 0x3e7f3eff, 0x3e7f3eff, 0x6ea000, 0x733800, 0x0, 0x0, 0x0, 0x0, 0x0, 0x0, 0x0, 0x0
    .long 0x241800, 0x925800, 0x77, 0x38b0, 0x3eff3dff, 0x3eff3dff, 0x254400, 0x29dc00, 0x0, 0x0, 0x0, 0x0, 0x0, 0x0, 0x0, 0x0
    .long 0x5b3800, 0x925800, 0x77, 0x8cb0, 0x3eff3eff, 0x3eff3eff, 0x5c6400, 0x60fc00, 0x0, 0x0, 0x0, 0x0, 0x0, 0x0, 0x0, 0x0
    .long 0x1ae800, 0x925800, 0x77, 0x2a30, 0x3dff3dff, 0x3dff3dff, 0x1bb400, 0x204c00, 0x0, 0x0, 0x0, 0x0, 0x0, 0x0, 0x0, 0x0
    .long 0x3fa800, 0x925800, 0x77, 0x6250, 0x3e7f3e7f, 0x3e7f3e7f, 0x408c00, 0x452400, 0x0, 0x0, 0x0, 0x0, 0x0, 0x0, 0x0, 0x0
    .long 0x6d9800, 0x925800, 0x77, 0xa830, 0x3dff3eff, 0x3dff3eff, 0x6e6400, 0x72fc00, 0x0, 0x0, 0x0, 0x0, 0x0, 0x0, 0x0, 0x0
    .long 0x1ae800, 0x925800, 0x77, 0x2a90, 0x3eff3dff, 0x3eff3dff, 0x1bfc00, 0x209400, 0x0, 0x0, 0x0, 0x0, 0x0, 0x0, 0x0, 0x0
    .long 0x48d800, 0x925800, 0x77, 0x7070, 0x3e7f3e7f, 0x3e7f3e7f, 0x49d400, 0x4e6c00, 0x0, 0x0, 0x0, 0x0, 0x0, 0x0, 0x0, 0x0
    .long 0x6d9800, 0x925800, 0x77, 0xa890, 0x3eff3eff, 0x3eff3eff, 0x6eac00, 0x734400, 0x0, 0x0, 0x0, 0x0, 0x0, 0x0, 0x0, 0x0
    .long 0x241800, 0x925800, 0x77, 0x38c0, 0x3eff3dff, 0x3eff3dff, 0x255000, 0x29e800, 0x0, 0x0, 0x0, 0x0, 0x0, 0x0, 0x0, 0x0
    .long 0x5b3800, 0x925800, 0x77, 0x8cc0, 0x3eff3eff, 0x3eff3eff, 0x5c7000, 0x610800, 0x0, 0x0, 0x0, 0x0, 0x0, 0x0, 0x0, 0x0
    .long 0x1ae800, 0x925800, 0x77, 0x2a40, 0x3dff3dff, 0x3dff3dff, 0x1bc000, 0x205800, 0x0, 0x0, 0x0, 0x0, 0x0, 0x0, 0x0, 0x0
    .long 0x3fa800, 0x925800, 0x77, 0x6260, 0x3e7f3e7f, 0x3e7f3e7f, 0x409800, 0x453000, 0x0, 0x0, 0x0, 0x0, 0x0, 0x0, 0x0, 0x0
    .long 0x6d9800, 0x925800, 0x77, 0xa840, 0x3dff3eff, 0x3dff3eff, 0x6e7000, 0x730800, 0x0, 0x0, 0x0, 0x0, 0x0, 0x0, 0x0, 0x0
    .long 0x1ae800, 0x925800, 0x77, 0x2aa0, 0x3eff3dff, 0x3eff3dff, 0x1c0800, 0x20a000, 0x0, 0x0, 0x0, 0x0, 0x0, 0x0, 0x0, 0x0
    .long 0x48d800, 0x925800, 0x77, 0x7080, 0x3e7f3e7f, 0x3e7f3e7f, 0x49e000, 0x4e7800, 0x0, 0x0, 0x0, 0x0, 0x0, 0x0, 0x0, 0x0
    .long 0x6d9800, 0x925800, 0x77, 0xa8a0, 0x3eff3eff, 0x3eff3eff, 0x6eb800, 0x735000, 0x0, 0x0, 0x0, 0x0, 0x0, 0x0, 0x0, 0x0
    .long 0x241800, 0x925800, 0x77, 0x38d0, 0x3eff3dff, 0x3eff3dff, 0x255c00, 0x29f400, 0x0, 0x0, 0x0, 0x0, 0x0, 0x0, 0x0, 0x0
    .long 0x5b3800, 0x925800, 0x77, 0x8cd0, 0x3eff3eff, 0x3eff3eff, 0x5c7c00, 0x611400, 0x0, 0x0, 0x0, 0x0, 0x0, 0x0, 0x0, 0x0
    .long 0x1ae800, 0x925800, 0x77, 0x2a50, 0x3e7f3dff, 0x3e7f3dff, 0x1bcc00, 0x206400, 0x0, 0x0, 0x0, 0x0, 0x0, 0x0, 0x0, 0x0
    .long 0x48d800, 0x925800, 0x77, 0x7030, 0x3dff3e7f, 0x3dff3e7f, 0x49a400, 0x4e3c00, 0x0, 0x0, 0x0, 0x0, 0x0, 0x0, 0x0, 0x0
    .long 0x6d9800, 0x925800, 0x77, 0xa850, 0x3e7f3eff, 0x3e7f3eff, 0x6e7c00, 0x731400, 0x0, 0x0, 0x0, 0x0, 0x0, 0x0, 0x0, 0x0
    .long 0x241800, 0x925800, 0x77, 0x3870, 0x3e7f3dff, 0x3e7f3dff, 0x251400, 0x29ac00, 0x0, 0x0, 0x0, 0x0, 0x0, 0x0, 0x0, 0x0
    .long 0x48d800, 0x925800, 0x77, 0x7090, 0x3eff3e7f, 0x3eff3e7f, 0x49ec00, 0x4e8400, 0x0, 0x0, 0x0, 0x0, 0x0, 0x0, 0x0, 0x0
    .long 0x76c800, 0x925800, 0x77, 0xb670, 0x3e7f3eff, 0x3e7f3eff, 0x77c400, 0x7c5c00, 0x0, 0x0, 0x0, 0x0, 0x0, 0x0, 0x0, 0x0
    .long 0x2d4800, 0x925800, 0x77, 0x46b0, 0x3eff3e7f, 0x3eff3e7f, 0x2e7400, 0x330c00, 0x0, 0x0, 0x0, 0x0, 0x0, 0x0, 0x0, 0x0
    .long 0x646800, 0x925800, 0x77, 0x9ab0, 0x3eff3eff, 0x3eff3eff, 0x659400, 0x6a2c00, 0x0, 0x0, 0x0, 0x0, 0x0, 0x0, 0x0, 0x0
    .long 0x1ae800, 0x925800, 0x77, 0x2a60, 0x3e7f3dff, 0x3e7f3dff, 0x1bd800, 0x207000, 0x0, 0x0, 0x0, 0x0, 0x0, 0x0, 0x0, 0x0
    .long 0x48d800, 0x925800, 0x77, 0x7040, 0x3dff3e7f, 0x3dff3e7f, 0x49b000, 0x4e4800, 0x0, 0x0, 0x0, 0x0, 0x0, 0x0, 0x0, 0x0
    .long 0x6d9800, 0x925800, 0x77, 0xa860, 0x3e7f3eff, 0x3e7f3eff, 0x6e8800, 0x732000, 0x0, 0x0, 0x0, 0x0, 0x0, 0x0, 0x0, 0x0
    .long 0x241800, 0x925800, 0x77, 0x3880, 0x3e7f3dff, 0x3e7f3dff, 0x252000, 0x29b800, 0x0, 0x0, 0x0, 0x0, 0x0, 0x0, 0x0, 0x0
    .long 0x48d800, 0x925800, 0x77, 0x70a0, 0x3eff3e7f, 0x3eff3e7f, 0x49f800, 0x4e9000, 0x0, 0x0, 0x0, 0x0, 0x0, 0x0, 0x0, 0x0
    .long 0x76c800, 0x925800, 0x77, 0xb680, 0x3e7f3eff, 0x3e7f3eff, 0x77d000, 0x7c6800, 0x0, 0x0, 0x0, 0x0, 0x0, 0x0, 0x0, 0x0
    .long 0x2d4800, 0x925800, 0x77, 0x46c0, 0x3eff3e7f, 0x3eff3e7f, 0x2e8000, 0x331800, 0x0, 0x0, 0x0, 0x0, 0x0, 0x0, 0x0, 0x0
    .long 0x646800, 0x925800, 0x77, 0x9ac0, 0x3eff3eff, 0x3eff3eff, 0x65a000, 0x6a3800, 0x0, 0x0, 0x0, 0x0, 0x0, 0x0, 0x0, 0x0
    .long 0x241800, 0x925800, 0x77, 0x3830, 0x3dff3dff, 0x3dff3dff, 0x24e400, 0x297c00, 0x0, 0x0, 0x0, 0x0, 0x0, 0x0, 0x0, 0x0
    .long 0x48d800, 0x925800, 0x77, 0x7050, 0x3e7f3e7f, 0x3e7f3e7f, 0x49bc00, 0x4e5400, 0x0, 0x0, 0x0, 0x0, 0x0, 0x0, 0x0, 0x0
    .long 0x76c800, 0x925800, 0x77, 0xb630, 0x3dff3eff, 0x3dff3eff, 0x779400, 0x7c2c00, 0x0, 0x0, 0x0, 0x0, 0x0, 0x0, 0x0, 0x0
    .long 0x241800, 0x925800, 0x77, 0x3890, 0x3eff3dff, 0x3eff3dff, 0x252c00, 0x29c400, 0x0, 0x0, 0x0, 0x0, 0x0, 0x0, 0x0, 0x0
    .long 0x520800, 0x925800, 0x77, 0x7e70, 0x3e7f3e7f, 0x3e7f3eff, 0x530400, 0x579c00, 0x0, 0x0, 0x0, 0x0, 0x0, 0x0, 0x0, 0x0
    .long 0x76c800, 0x925800, 0x77, 0xb690, 0x3eff3eff, 0x3eff3eff, 0x77dc00, 0x7c7400, 0x0, 0x0, 0x0, 0x0, 0x0, 0x0, 0x0, 0x0
    .long 0x2d4800, 0x925800, 0x77, 0x46d0, 0x3eff3e7f, 0x3eff3e7f, 0x2e8c00, 0x332400, 0x0, 0x0, 0x0, 0x0, 0x0, 0x0, 0x0, 0x0
    .long 0x646800, 0x925800, 0x77, 0x9ad0, 0x3eff3eff, 0x3eff3eff, 0x65ac00, 0x6a4400, 0x0, 0x0, 0x0, 0x0, 0x0, 0x0, 0x0, 0x0
    .long 0x241800, 0x925800, 0x77, 0x3840, 0x3dff3dff, 0x3dff3dff, 0x24f000, 0x298800, 0x0, 0x0, 0x0, 0x0, 0x0, 0x0, 0x0, 0x0
    .long 0x48d800, 0x925800, 0x77, 0x7060, 0x3e7f3e7f, 0x3e7f3e7f, 0x49c800, 0x4e6000, 0x0, 0x0, 0x0, 0x0, 0x0, 0x0, 0x0, 0x0
    .long 0x76c800, 0x925800, 0x77, 0xb640, 0x3dff3eff, 0x3dff3eff, 0x77a000, 0x7c3800, 0x0, 0x0, 0x0, 0x0, 0x0, 0x0, 0x0, 0x0
    .long 0x241800, 0x925800, 0x77, 0x38a0, 0x3eff3dff, 0x3eff3dff, 0x253800, 0x29d000, 0x0, 0x0, 0x0, 0x0, 0x0, 0x0, 0x0, 0x0
    .long 0x520800, 0x925800, 0x77, 0x7e80, 0x3e7f3e7f, 0x3e7f3eff, 0x531000, 0x57a800, 0x0, 0x0, 0x0, 0x0, 0x0, 0x0, 0x0, 0x0
    .long 0x76c800, 0x925800, 0x77, 0xb6a0, 0x3eff3eff, 0x3eff3eff, 0x77e800, 0x7c8000, 0x0, 0x0, 0x0, 0x0, 0x0, 0x0, 0x0, 0x0
    .long 0x367800, 0x925800, 0x77, 0x54b0, 0x3eff3e7f, 0x3eff3e7f, 0x37a400, 0x3c3c00, 0x0, 0x0, 0x0, 0x0, 0x0, 0x0, 0x0, 0x0
    .long 0x6d9800, 0x925800, 0x77, 0xa8b0, 0x3eff3eff, 0x3eff3eff, 0x6ec400, 0x735c00, 0x0, 0x0, 0x0, 0x0, 0x0, 0x0, 0x0, 0x0
    .long 0x241800, 0x925800, 0x77, 0x3850, 0x3e7f3dff, 0x3e7f3dff, 0x24fc00, 0x299400, 0x0, 0x0, 0x0, 0x0, 0x0, 0x0, 0x0, 0x0
    .long 0x520800, 0x925800, 0x77, 0x7e30, 0x3dff3e7f, 0x3dff3eff, 0x52d400, 0x576c00, 0x0, 0x0, 0x0, 0x0, 0x0, 0x0, 0x0, 0x0
    .long 0x76c800, 0x925800, 0x77, 0xb650, 0x3e7f3eff, 0x3e7f3eff, 0x77ac00, 0x7c4400, 0x0, 0x0, 0x0, 0x0, 0x0, 0x0, 0x0, 0x0
    .long 0x2d4800, 0x925800, 0x77, 0x4670, 0x3e7f3e7f, 0x3e7f3e7f, 0x2e4400, 0x32dc00, 0x0, 0x0, 0x0, 0x0, 0x0, 0x0, 0x0, 0x0
    .long 0x520800, 0x925800, 0x77, 0x7e90, 0x3eff3e7f, 0x3eff3eff, 0x531c00, 0x57b400, 0x0, 0x0, 0x0, 0x0, 0x0, 0x0, 0x0, 0x0
    .long 0x7ff800, 0x925800, 0x77, 0xc470, 0x3e7f3eff, 0x3e7f3eff, 0x80f400, 0x858c00, 0x0, 0x0, 0x0, 0x0, 0x0, 0x0, 0x0, 0x0
    .long 0x367800, 0x925800, 0x77, 0x54c0, 0x3eff3e7f, 0x3eff3e7f, 0x37b000, 0x3c4800, 0x0, 0x0, 0x0, 0x0, 0x0, 0x0, 0x0, 0x0
    .long 0x6d9800, 0x925800, 0x77, 0xa8c0, 0x3eff3eff, 0x3eff3eff, 0x6ed000, 0x736800, 0x0, 0x0, 0x0, 0x0, 0x0, 0x0, 0x0, 0x0
    .long 0x241800, 0x925800, 0x77, 0x3860, 0x3e7f3dff, 0x3e7f3dff, 0x250800, 0x29a000, 0x0, 0x0, 0x0, 0x0, 0x0, 0x0, 0x0, 0x0
    .long 0x520800, 0x925800, 0x77, 0x7e40, 0x3dff3e7f, 0x3dff3eff, 0x52e000, 0x577800, 0x0, 0x0, 0x0, 0x0, 0x0, 0x0, 0x0, 0x0
    .long 0x76c800, 0x925800, 0x77, 0xb660, 0x3e7f3eff, 0x3e7f3eff, 0x77b800, 0x7c5000, 0x0, 0x0, 0x0, 0x0, 0x0, 0x0, 0x0, 0x0
    .long 0x2d4800, 0x925800, 0x77, 0x4680, 0x3e7f3e7f, 0x3e7f3e7f, 0x2e5000, 0x32e800, 0x0, 0x0, 0x0, 0x0, 0x0, 0x0, 0x0, 0x0
    .long 0x520800, 0x925800, 0x77, 0x7ea0, 0x3eff3e7f, 0x3eff3eff, 0x532800, 0x57c000, 0x0, 0x0, 0x0, 0x0, 0x0, 0x0, 0x0, 0x0
    .long 0x7ff800, 0x925800, 0x77, 0xc480, 0x3e7f3eff, 0x3e7f3eff, 0x810000, 0x859800, 0x0, 0x0, 0x0, 0x0, 0x0, 0x0, 0x0, 0x0
    .long 0x367800, 0x925800, 0x77, 0x54d0, 0x3eff3e7f, 0x3eff3e7f, 0x37bc00, 0x3c5400, 0x0, 0x0, 0x0, 0x0, 0x0, 0x0, 0x0, 0x0
    .long 0x6d9800, 0x925800, 0x77, 0xa8d0, 0x3eff3eff, 0x3eff3eff, 0x6edc00, 0x737400, 0x0, 0x0, 0x0, 0x0, 0x0, 0x0, 0x0, 0x0
    .long 0x2d4800, 0x925800, 0x77, 0x4630, 0x3dff3e7f, 0x3dff3e7f, 0x2e1400, 0x32ac00, 0x0, 0x0, 0x0, 0x0, 0x0, 0x0, 0x0, 0x0
    .long 0x520800, 0x925800, 0x77, 0x7e50, 0x3e7f3e7f, 0x3e7f3eff, 0x52ec00, 0x578400, 0x0, 0x0, 0x0, 0x0, 0x0, 0x0, 0x0, 0x0
    .long 0x7ff800, 0x925800, 0x77, 0xc430, 0x3dff3eff, 0x3dff3eff, 0x80c400, 0x855c00, 0x0, 0x0, 0x0, 0x0, 0x0, 0x0, 0x0, 0x0
    .long 0x2d4800, 0x925800, 0x77, 0x4690, 0x3eff3e7f, 0x3eff3e7f, 0x2e5c00, 0x32f400, 0x0, 0x0, 0x0, 0x0, 0x0, 0x0, 0x0, 0x0
    .long 0x5b3800, 0x925800, 0x77, 0x8c70, 0x3e7f3eff, 0x3e7f3eff, 0x5c3400, 0x60cc00, 0x0, 0x0, 0x0, 0x0, 0x0, 0x0, 0x0, 0x0
    .long 0x7ff800, 0x925800, 0x77, 0xc490, 0x3eff3eff, 0x3eff3eff, 0x810c00, 0x85a400, 0x0, 0x0, 0x0, 0x0, 0x0, 0x0, 0x0, 0x0
    .long 0x3fa800, 0x925800, 0x77, 0x62b0, 0x3eff3e7f, 0x3eff3e7f, 0x40d400, 0x456c00, 0x0, 0x0, 0x0, 0x0, 0x0, 0x0, 0x0, 0x0
    .long 0x76c800, 0x925800, 0x77, 0xb6b0, 0x3eff3eff, 0x3eff3eff, 0x77f400, 0x7c8c00, 0x0, 0x0, 0x0, 0x0, 0x0, 0x0, 0x0, 0x0
    .long 0x2d4800, 0x925800, 0x77, 0x4640, 0x3dff3e7f, 0x3dff3e7f, 0x2e2000, 0x32b800, 0x0, 0x0, 0x0, 0x0, 0x0, 0x0, 0x0, 0x0
    .long 0x520800, 0x925800, 0x77, 0x7e60, 0x3e7f3e7f, 0x3e7f3eff, 0x52f800, 0x579000, 0x0, 0x0, 0x0, 0x0, 0x0, 0x0, 0x0, 0x0
    .long 0x7ff800, 0x925800, 0x77, 0xc440, 0x3dff3eff, 0x3dff3eff, 0x80d000, 0x856800, 0x0, 0x0, 0x0, 0x0, 0x0, 0x0, 0x0, 0x0
    .long 0x2d4800, 0x925800, 0x77, 0x46a0, 0x3eff3e7f, 0x3eff3e7f, 0x2e6800, 0x330000, 0x0, 0x0, 0x0, 0x0, 0x0, 0x0, 0x0, 0x0
    .long 0x5b3800, 0x925800, 0x77, 0x8c80, 0x3e7f3eff, 0x3e7f3eff, 0x5c4000, 0x60d800, 0x0, 0x0, 0x0, 0x0, 0x0, 0x0, 0x0, 0x0
    .long 0x7ff800, 0x925800, 0x77, 0xc4a0, 0x3eff3eff, 0x3eff3eff, 0x811800, 0x85b000, 0x0, 0x0, 0x0, 0x0, 0x0, 0x0, 0x0, 0x0
    .long 0x3fa800, 0x925800, 0x77, 0x62c0, 0x3eff3e7f, 0x3eff3e7f, 0x40e000, 0x457800, 0x0, 0x0, 0x0, 0x0, 0x0, 0x0, 0x0, 0x0
    .long 0x76c800, 0x925800, 0x77, 0xb6c0, 0x3eff3eff, 0x3eff3eff, 0x780000, 0x7c9800, 0x0, 0x0, 0x0, 0x0, 0x0, 0x0, 0x0, 0x0
    .long 0x2d4800, 0x925800, 0x77, 0x4650, 0x3e7f3e7f, 0x3e7f3e7f, 0x2e2c00, 0x32c400, 0x0, 0x0, 0x0, 0x0, 0x0, 0x0, 0x0, 0x0
    .long 0x5b3800, 0x925800, 0x77, 0x8c30, 0x3dff3eff, 0x3dff3eff, 0x5c0400, 0x609c00, 0x0, 0x0, 0x0, 0x0, 0x0, 0x0, 0x0, 0x0
    .long 0x7ff800, 0x925800, 0x77, 0xc450, 0x3e7f3eff, 0x3e7f3eff, 0x80dc00, 0x857400, 0x0, 0x0, 0x0, 0x0, 0x0, 0x0, 0x0, 0x0
    .long 0x367800, 0x925800, 0x77, 0x5470, 0x3e7f3e7f, 0x3e7f3e7f, 0x377400, 0x3c0c00, 0x0, 0x0, 0x0, 0x0, 0x0, 0x0, 0x0, 0x0
    .long 0x5b3800, 0x925800, 0x77, 0x8c90, 0x3eff3eff, 0x3eff3eff, 0x5c4c00, 0x60e400, 0x0, 0x0, 0x0, 0x0, 0x0, 0x0, 0x0, 0x0
    .long 0x892800, 0x925800, 0x77, 0xd270, 0x3e7f3eff, 0x3e7f3eff, 0x8a2400, 0x8ebc00, 0x0, 0x0, 0x0, 0x0, 0x0, 0x0, 0x0, 0x0
    .long 0x3fa800, 0x925800, 0x77, 0x62d0, 0x3eff3e7f, 0x3eff3e7f, 0x40ec00, 0x458400, 0x0, 0x0, 0x0, 0x0, 0x0, 0x0, 0x0, 0x0
    .long 0x76c800, 0x925800, 0x77, 0xb6d0, 0x3eff3eff, 0x3eff3eff, 0x780c00, 0x7ca400, 0x0, 0x0, 0x0, 0x0, 0x0, 0x0, 0x0, 0x0
    .long 0x2d4800, 0x925800, 0x77, 0x4660, 0x3e7f3e7f, 0x3e7f3e7f, 0x2e3800, 0x32d000, 0x0, 0x0, 0x0, 0x0, 0x0, 0x0, 0x0, 0x0
    .long 0x5b3800, 0x925800, 0x77, 0x8c40, 0x3dff3eff, 0x3dff3eff, 0x5c1000, 0x60a800, 0x0, 0x0, 0x0, 0x0, 0x0, 0x0, 0x0, 0x0
    .long 0x7ff800, 0x925800, 0x77, 0xc460, 0x3e7f3eff, 0x3e7f3eff, 0x80e800, 0x858000, 0x0, 0x0, 0x0, 0x0, 0x0, 0x0, 0x0, 0x0
    .long 0x367800, 0x925800, 0x77, 0x5480, 0x3e7f3e7f, 0x3e7f3e7f, 0x378000, 0x3c1800, 0x0, 0x0, 0x0, 0x0, 0x0, 0x0, 0x0, 0x0
    .long 0x5b3800, 0x925800, 0x77, 0x8ca0, 0x3eff3eff, 0x3eff3eff, 0x5c5800, 0x60f000, 0x0, 0x0, 0x0, 0x0, 0x0, 0x0, 0x0, 0x0
    .long 0x892800, 0x925800, 0x77, 0xd280, 0x3e7f3eff, 0x3e7f3eff, 0x8a3000, 0x8ec800, 0x0, 0x0, 0x0, 0x0, 0x0, 0x0, 0x0, 0x0
    .long 0x48d800, 0x925800, 0x77, 0x70b0, 0x3eff3e7f, 0x3eff3e7f, 0x4a0400, 0x4e9c00, 0x0, 0x0, 0x0, 0x0, 0x0, 0x0, 0x0, 0x0
    .long 0x7ff800, 0x925800, 0x77, 0xc4b0, 0x3eff3eff, 0x3eff3eff, 0x812400, 0x85bc00, 0x0, 0x0, 0x0, 0x0, 0x0, 0x0, 0x0, 0x0
    .long 0x367800, 0x925800, 0x77, 0x5430, 0x3dff3e7f, 0x3dff3e7f, 0x374400, 0x3bdc00, 0x0, 0x0, 0x0, 0x0, 0x0, 0x0, 0x0, 0x0
    .long 0x5b3800, 0x925800, 0x77, 0x8c50, 0x3e7f3eff, 0x3e7f3eff, 0x5c1c00, 0x60b400, 0x0, 0x0, 0x0, 0x0, 0x0, 0x0, 0x0, 0x0
    .long 0x892800, 0x925800, 0x77, 0xd230, 0x3dff3eff, 0x3dff3eff, 0x89f400, 0x8e8c00, 0x0, 0x0, 0x0, 0x0, 0x0, 0x0, 0x0, 0x0
    .long 0x367800, 0x925800, 0x77, 0x5490, 0x3eff3e7f, 0x3eff3e7f, 0x378c00, 0x3c2400, 0x0, 0x0, 0x0, 0x0, 0x0, 0x0, 0x0, 0x0
    .long 0x646800, 0x925800, 0x77, 0x9a70, 0x3e7f3eff, 0x3e7f3eff, 0x656400, 0x69fc00, 0x0, 0x0, 0x0, 0x0, 0x0, 0x0, 0x0, 0x0
    .long 0x892800, 0x925800, 0x77, 0xd290, 0x3eff3eff, 0x3eff3eff, 0x8a3c00, 0x8ed400, 0x0, 0x0, 0x0, 0x0, 0x0, 0x0, 0x0, 0x0
    .long 0x48d800, 0x925800, 0x77, 0x70c0, 0x3eff3e7f, 0x3eff3e7f, 0x4a1000, 0x4ea800, 0x0, 0x0, 0x0, 0x0, 0x0, 0x0, 0x0, 0x0
    .long 0x7ff800, 0x925800, 0x77, 0xc4c0, 0x3eff3eff, 0x3eff3eff, 0x813000, 0x85c800, 0x0, 0x0, 0x0, 0x0, 0x0, 0x0, 0x0, 0x0
    .long 0x367800, 0x925800, 0x77, 0x5440, 0x3dff3e7f, 0x3dff3e7f, 0x375000, 0x3be800, 0x0, 0x0, 0x0, 0x0, 0x0, 0x0, 0x0, 0x0
    .long 0x5b3800, 0x925800, 0x77, 0x8c60, 0x3e7f3eff, 0x3e7f3eff, 0x5c2800, 0x60c000, 0x0, 0x0, 0x0, 0x0, 0x0, 0x0, 0x0, 0x0
    .long 0x892800, 0x925800, 0x77, 0xd240, 0x3dff3eff, 0x3dff3eff, 0x8a0000, 0x8e9800, 0x0, 0x0, 0x0, 0x0, 0x0, 0x0, 0x0, 0x0
    .long 0x367800, 0x925800, 0x77, 0x54a0, 0x3eff3e7f, 0x3eff3e7f, 0x379800, 0x3c3000, 0x0, 0x0, 0x0, 0x0, 0x0, 0x0, 0x0, 0x0
    .long 0x646800, 0x925800, 0x77, 0x9a80, 0x3e7f3eff, 0x3e7f3eff, 0x657000, 0x6a0800, 0x0, 0x0, 0x0, 0x0, 0x0, 0x0, 0x0, 0x0
    .long 0x892800, 0x925800, 0x77, 0xd2a0, 0x3eff3eff, 0x3eff3eff, 0x8a4800, 0x8ee000, 0x0, 0x0, 0x0, 0x0, 0x0, 0x0, 0x0, 0x0
    .long 0x48d800, 0x925800, 0x77, 0x70d0, 0x3eff3e7f, 0x3eff3e7f, 0x4a1c00, 0x4eb400, 0x0, 0x0, 0x0, 0x0, 0x0, 0x0, 0x0, 0x0
    .long 0x7ff800, 0x925800, 0x77, 0xc4d0, 0x3eff3eff, 0x3eff3eff, 0x813c00, 0x85d400, 0x0, 0x0, 0x0, 0x0, 0x0, 0x0, 0x0, 0x0
    .long 0x367800, 0x925800, 0x77, 0x5450, 0x3e7f3e7f, 0x3e7f3e7f, 0x375c00, 0x3bf400, 0x0, 0x0, 0x0, 0x0, 0x0, 0x0, 0x0, 0x0
    .long 0x646800, 0x925800, 0x77, 0x9a30, 0x3dff3eff, 0x3dff3eff, 0x653400, 0x69cc00, 0x0, 0x0, 0x0, 0x0, 0x0, 0x0, 0x0, 0x0
    .long 0x892800, 0x925800, 0x77, 0xd250, 0x3e7f3eff, 0x3e7f3eff, 0x8a0c00, 0x8ea400, 0x0, 0x0, 0x0, 0x0, 0x0, 0x0, 0x0, 0x0
    .long 0x3fa800, 0x925800, 0x77, 0x6270, 0x3e7f3e7f, 0x3e7f3e7f, 0x40a400, 0x453c00, 0x0, 0x0, 0x0, 0x0, 0x0, 0x0, 0x0, 0x0
    .long 0x646800, 0x925800, 0x77, 0x9a90, 0x3eff3eff, 0x3eff3eff, 0x657c00, 0x6a1400, 0x0, 0x0, 0x0, 0x0, 0x0, 0x0, 0x0, 0x0
    .long 0x1ae800, 0x925800, 0x77, 0x2ab0, 0x3eff3dff, 0x3eff3dff, 0x1c1400, 0x20ac00, 0x0, 0x0, 0x0, 0x0, 0x0, 0x0, 0x0, 0x0
    .long 0x520800, 0x925800, 0x77, 0x7eb0, 0x3eff3e7f, 0x3eff3eff, 0x533400, 0x57cc00, 0x0, 0x0, 0x0, 0x0, 0x0, 0x0, 0x0, 0x0
    .long 0x892800, 0x925800, 0x77, 0xd2b0, 0x3eff3eff, 0x3eff3eff, 0x8a5400, 0x8eec00, 0x0, 0x0, 0x0, 0x0, 0x0, 0x0, 0x0, 0x0
    .long 0x367800, 0x925800, 0x77, 0x5460, 0x3e7f3e7f, 0x3e7f3e7f, 0x376800, 0x3c0000, 0x0, 0x0, 0x0, 0x0, 0x0, 0x0, 0x0, 0x0
    .long 0x646800, 0x925800, 0x77, 0x9a40, 0x3dff3eff, 0x3dff3eff, 0x654000, 0x69d800, 0x0, 0x0, 0x0, 0x0, 0x0, 0x0, 0x0, 0x0
    .long 0x892800, 0x925800, 0x77, 0xd260, 0x3e7f3eff, 0x3e7f3eff, 0x8a1800, 0x8eb000, 0x0, 0x0, 0x0, 0x0, 0x0, 0x0, 0x0, 0x0
    .long 0x3fa800, 0x925800, 0x77, 0x6280, 0x3e7f3e7f, 0x3e7f3e7f, 0x40b000, 0x454800, 0x0, 0x0, 0x0, 0x0, 0x0, 0x0, 0x0, 0x0
    .long 0x646800, 0x925800, 0x77, 0x9aa0, 0x3eff3eff, 0x3eff3eff, 0x658800, 0x6a2000, 0x0, 0x0, 0x0, 0x0, 0x0, 0x0, 0x0, 0x0
    .long 0x1ae800, 0x925800, 0x77, 0x2ac0, 0x3eff3dff, 0x3eff3dff, 0x1c2000, 0x20b800, 0x0, 0x0, 0x0, 0x0, 0x0, 0x0, 0x0, 0x0
    .long 0x520800, 0x925800, 0x77, 0x7ec0, 0x3eff3e7f, 0x3eff3eff, 0x534000, 0x57d800, 0x0, 0x0, 0x0, 0x0, 0x0, 0x0, 0x0, 0x0
    .long 0x892800, 0x925800, 0x77, 0xd2c0, 0x3eff3eff, 0x3eff3eff, 0x8a6000, 0x8ef800, 0x0, 0x0, 0x0, 0x0, 0x0, 0x0, 0x0, 0x0
    .long 0x3fa800, 0x925800, 0x77, 0x6230, 0x3dff3e7f, 0x3dff3e7f, 0x407400, 0x450c00, 0x0, 0x0, 0x0, 0x0, 0x0, 0x0, 0x0, 0x0
    .long 0x646800, 0x925800, 0x77, 0x9a50, 0x3e7f3eff, 0x3e7f3eff, 0x654c00, 0x69e400, 0x0, 0x0, 0x0, 0x0, 0x0, 0x0, 0x0, 0x0
    .long 0x1ae800, 0x925800, 0x77, 0x2a70, 0x3e7f3dff, 0x3e7f3dff, 0x1be400, 0x207c00, 0x0, 0x0, 0x0, 0x0, 0x0, 0x0, 0x0, 0x0
    .long 0x3fa800, 0x925800, 0x77, 0x6290, 0x3eff3e7f, 0x3eff3e7f, 0x40bc00, 0x455400, 0x0, 0x0, 0x0, 0x0, 0x0, 0x0, 0x0, 0x0
    .long 0x6d9800, 0x925800, 0x77, 0xa870, 0x3e7f3eff, 0x3e7f3eff, 0x6e9400, 0x732c00, 0x0, 0x0, 0x0, 0x0, 0x0, 0x0, 0x0, 0x0
    .long 0x1ae800, 0x925800, 0x77, 0x2ad0, 0x3eff3dff, 0x3eff3dff, 0x1c2c00, 0x20c400, 0x0, 0x0, 0x0, 0x0, 0x0, 0x0, 0x0, 0x0
    .long 0x520800, 0x925800, 0x77, 0x7ed0, 0x3eff3e7f, 0x3eff3eff, 0x534c00, 0x57e400, 0x0, 0x0, 0x0, 0x0, 0x0, 0x0, 0x0, 0x0
    .long 0x892800, 0x925800, 0x77, 0xd2d0, 0x3eff3eff, 0x3eff3eff, 0x8a6c00, 0x8f0400, 0x0, 0x0, 0x0, 0x0, 0x0, 0x0, 0x0, 0x0
.section .rodata,"a"
.p2align 6
.amdhsa_kernel standalone__deformable_dcnv1__vision_kernel
  .amdhsa_next_free_vgpr 512
  .amdhsa_next_free_sgpr 102
  .amdhsa_accum_offset 256
  .amdhsa_group_segment_fixed_size 0
  .amdhsa_kernarg_size 48
  .amdhsa_user_sgpr_count 2
  .amdhsa_user_sgpr_kernarg_segment_ptr 1
  .amdhsa_system_sgpr_workgroup_id_x 1
  .amdhsa_float_denorm_mode_32 3
.end_amdhsa_kernel
```

```asm
; @launch grid=(256,1,1) block=(256,1,1) lds=163840
.amdgcn_target "amdgcn-amd-amdhsa--gfx950"
.text
.globl standalone__deformable_dcnv1__vision_kernel
.p2align 12
.p2align 8
.type standalone__deformable_dcnv1__vision_kernel,@function
standalone__deformable_dcnv1__vision_kernel:
    s_cmp_ge_u32 s2, 256
    s_cbranch_scc1 L_end
    s_getpc_b64 s[40:41]
L_pc:
    v_and_b32 v32, 63, v0
    s_lshl_b32 s47, s2, 6
    v_lshlrev_b32 v13, 7, v32
    s_add_u32 s47, s47, L_runtab-L_pc
    s_add_u32 s54, s47, 32
    s_load_dwordx8 s[20:27], s[40:41], s47
    s_load_dwordx8 s[68:75], s[40:41], s54
    s_load_dwordx2 s[12:13], s[0:1], 16
    s_load_dwordx2 s[4:5], s[0:1], 0
    s_load_dwordx2 s[8:9], s[0:1], 8
    s_load_dwordx2 s[16:17], s[0:1], 24
    v_lshrrev_b32 v33, 6, v0
    v_lshlrev_b32 v6, 4, v32
    v_readfirstlane_b32 s28, v33
    v_add_u32 v12, L_ctab-L_pc, v6
    s_lshr_b32 s47, s2, 3
    global_load_dwordx4 v[16:19], v12, s[40:41]
    s_bfe_u32 s48, s2, 0x10007
    s_lshl1_add_u32 s49, s28, s48
    s_lshl_b32 s49, s49, 13
    s_and_b32 s48, s47, 15
    v_add_u32 v33, s49, v13
    v_min_u32 v33, L_cold-L_pc, v33
    s_lshl_b32 exec_lo, 0x10001, s48
    s_mov_b32 exec_hi, exec_lo
    global_load_dword v15, v33, s[40:41]
    s_mov_b64 exec, -1
    s_mov_b32 s6, 9633792
    s_mov_b32 s7, 0x00020000
    s_mov_b32 s10, 1806336
    s_mov_b32 s11, s7
    s_mov_b32 s14, 165888
    s_mov_b32 s15, s7
    s_mov_b32 s18, s6
    s_mov_b32 s19, s7
    s_and_b32 s29, s28, 1
    s_lshr_b32 s30, s28, 1
    s_lshl2_add_u32 s49, s47, s28
    s_mulk_i32 s49, 1280
    s_addk_i32 s49, 12288
    s_cmpk_lt_u32 s2, 38
    s_cselect_b32 s47, 40, 16
    s_cmpk_lt_u32 s2, 113
    s_cselect_b32 s47, s47, 0
    s_cmp_eq_u32 s28, 3
    s_cselect_b32 s47, s47, 0
    v_subrev_u32 v35, s47, v0
    s_lshl_b32 s33, s28, 6
    v_mul_u32_u24 v36, 5462, v35
    s_mul_i32 s44, s28, 3104
    v_lshrrev_b32 v36, 16, v36
    s_sub_u32 s33, s33, s47
    v_mad_i32_i24 v33, v36, -12, v35
    v_bfe_u32 v34, v36, 2, 2
    s_lshl_b32 s33, s33, 4
    v_xor_b32 v33, v33, v34
    s_mul_i32 s46, s28, 3072
    v_lshlrev_b32 v8, 4, v33
    s_movk_i32 s48, 223
    v_mov_b32 v35, 2130706432
    s_cmpk_lt_u32 s2, 113
    v_add_u32 v7, s46, v6
    s_cbranch_scc1 L_X
    v_cmp_gt_u32 vcc, 18, v36
    s_add_u32 s44, s44, 65536
    s_mul_i32 s45, s30, 93120
    s_sub_u32 s45, s44, s45
    s_cmp_eq_u32 s30, 0
    v_cndmask_b32 v8, v35, v8, vcc
    s_waitcnt lgkmcnt(0)
    s_cselect_b32 s31, s26, s27
    s_cselect_b32 s35, s24, s25
    s_mov_b64 exec, 0x3ff
    buffer_load_dword v13, v13, s[12:15], s49 offen
    s_mov_b64 exec, -1
    s_add_u32 m0, s44, 0
    s_mov_b32 s46, 0
    buffer_load_dwordx4 v7, s[12:15], s46 offen offset:0 lds
    buffer_load_dwordx4 v7, s[12:15], s46 offen offset:1024 lds
    buffer_load_dwordx4 v7, s[12:15], s46 offen offset:2048 lds
    s_and_b32 s47, s23, 0xff
    v_add3_u32 v34, v36, s47, -1
    v_min_u32 v34, s48, v34
    v_mul_u32_u24 v34, 192, v34
    v_add_u32 v8, v34, v8
    s_add_u32 m0, s44, 12416
    s_mov_b32 s46, 12288
    buffer_load_dwordx4 v7, s[12:15], s46 offen offset:0 lds
    buffer_load_dwordx4 v7, s[12:15], s46 offen offset:1024 lds
    buffer_load_dwordx4 v7, s[12:15], s46 offen offset:2048 lds
    s_add_u32 m0, s33, 0
    s_add_u32 s56, s20, 0
    buffer_load_dwordx4 v8, s[4:7], s56 offen lds
    s_add_u32 m0, s33, 28672
    s_add_u32 s63, s20, 301056
    buffer_load_dwordx4 v8, s[4:7], s63 offen lds
    s_add_u32 m0, s33, 4096
    s_add_u32 s57, s20, 43008
    buffer_load_dwordx4 v8, s[4:7], s57 offen lds
    s_add_u32 m0, s33, 32768
    s_add_u32 s64, s20, 344064
    buffer_load_dwordx4 v8, s[4:7], s64 offen lds
    s_add_u32 m0, s33, 8192
    s_add_u32 s58, s20, 86016
    buffer_load_dwordx4 v8, s[4:7], s58 offen lds
    s_add_u32 m0, s33, 36864
    s_add_u32 s65, s20, 387072
    buffer_load_dwordx4 v8, s[4:7], s65 offen lds
    s_branch L_N2
L_X:
    s_cmpk_ge_u32 s2, 38
    s_cselect_b32 s60, 1, 0
    s_cselect_b32 s43, 1, 5
    s_cselect_b32 s42, 0, -9
    s_sub_u32 s47, s2, 19
    s_movk_i32 s36, 192
    s_mov_b32 s38, 43008
    s_movk_i32 s39, 8064
    s_cmpk_lt_u32 s47, 40
    s_cselect_b32 s56, 1, 0
    s_cselect_b32 s55, s36, s38
    s_cselect_b32 s2, s38, s36
    s_cselect_b32 s37, 36, s39
    s_cselect_b32 s39, s39, 36
    s_lshl_b32 s47, s60, 10
    v_add_u32 v42, s47, v12
    global_load_dwordx4 v[164:167], v42, s[40:41] offset:1024
    global_load_dwordx4 v[168:171], v42, s[40:41] offset:2048
    v_mul_u32_u24 v40, 86, v32
    s_lshl2_add_u32 s47, s39, -36
    v_mul_u32_u24 v37, 12, v32
    s_mul_i32 s43, s43, s37
    v_lshrrev_b32 v40, 8, v40
    s_lshl_b32 s36, s39, 4
    s_mul_i32 s42, s42, s37
    v_lshrrev_b32 v41, 2, v40
    v_mad_u32_u24 v37, v40, s47, v37
    s_sub_u32 s43, s43, s36
    v_lshrrev_b32 v34, 3, v40
    v_and_b32 v33, 4, v41
    v_mad_i32_i24 v37, v41, s43, v37
    s_lshl_b32 s37, s37, 1
    v_lshl_or_b32 v38, v33, 4, v41
    v_mad_i32_i24 v37, v34, s42, v37
    s_lshl_b32 s37, s37, s60
    v_add_u32 v33, s28, v41
    v_mad_i32_i24 v39, v40, -3, v32
    v_and_b32 v33, 3, v33
    v_and_b32 v40, 3, v40
    v_mad_u32_u24 v37, v33, s39, v37
    v_lshl_add_u32 v40, v40, 2, v33
    s_cmp_eq_u32 s60, 0
    s_cbranch_scc0 L_Xz
    s_mul_i32 s47, s28, 11872
    v_mov_b32 v100, 0
    v_mov_b32 v101, 0
    v_mov_b32 v102, 0
    v_mov_b32 v103, 0
    v_add_u32 v104, s47, v6
    ds_write_b128 v104, v[100:103] offset:41472
    ds_write_b128 v104, v[100:103] offset:42496
    ds_write_b128 v104, v[100:103] offset:43520
    ds_write_b128 v104, v[100:103] offset:44544
    ds_write_b128 v104, v[100:103] offset:45568
L_Xz:
    s_waitcnt lgkmcnt(0)
    v_cmp_gt_u32 vcc, s75, v38
    v_add_u32 v38, 4, v38
    s_mov_b32 s32, s74
    v_cndmask_b32 v34, v35, v37, vcc
    buffer_load_dwordx3 v[232:234], v34, s[8:11], s32 offen
    v_cmp_gt_u32 vcc, s75, v38
    v_add_u32 v38, 4, v38
    s_add_u32 s32, s32, s37
    v_cndmask_b32 v34, v35, v37, vcc
    buffer_load_dwordx3 v[236:238], v34, s[8:11], s32 offen
    v_cmp_gt_u32 vcc, s75, v38
    v_add_u32 v38, 4, v38
    s_add_u32 s32, s32, s37
    v_cndmask_b32 v34, v35, v37, vcc
    buffer_load_dwordx3 v[240:242], v34, s[8:11], s32 offen
    s_bfe_i32 s43, s23, 0x90014
    s_mov_b64 exec, 0x3ff
    buffer_load_dword v13, v13, s[12:15], s49 offen
    s_mov_b64 exec, -1
    v_add_u32 v34, s43, v36
    s_cmp_eq_u32 s60, 0
    v_med3_i32 v34, v34, 0, s48
    v_mad_u32_u24 v8, v34, s2, v8
    s_cbranch_scc0 L_Xp
    s_add_u32 m0, s44, 88992
    s_bfe_u32 s46, s24, 0x40000
    s_mul_i32 s46, s46, 18432
    buffer_load_dwordx4 v7, s[12:15], s46 offen offset:0 lds
    s_branch L_S
L_Xp:
    s_add_u32 m0, s33, 0
    s_max_i32 s47, s20, 0
    s_add_u32 s20, s20, s55
    buffer_load_dwordx4 v8, s[4:7], s47 offen lds
    s_add_u32 m0, s33, 3904
    s_max_i32 s47, s20, 0
    s_add_u32 s20, s20, s55
    buffer_load_dwordx4 v8, s[4:7], s47 offen lds
    s_branch L_P
L_N2:
    s_add_u32 s59, s20, 129024
    s_add_u32 s60, s20, 172032
    s_add_u32 s61, s20, 215040
    s_add_u32 s62, s20, 258048
    s_add_u32 s66, s20, 430080
    s_add_u32 s67, s20, 473088
    s_add_u32 s68, s20, 516096
    s_add_u32 s69, s20, 559104
    s_add_u32 s70, s20, 602112
    s_add_u32 s71, s20, 645120
    s_min_i32 s71, s71, s21
    s_lshl_b32 s48, s29, 7
    s_lshl_b32 s49, s29, 5
    s_add_u32 s47, s48, 65536
    s_waitcnt vmcnt(14)
    v_add_u32_sdwa v4, s47, v16 dst_sel:DWORD dst_unused:UNUSED_PAD src0_sel:DWORD src1_sel:WORD_0
    s_add_u32 s47, s49, 65536
    v_add_u32_sdwa v5, s47, v16 dst_sel:DWORD dst_unused:UNUSED_PAD src0_sel:DWORD src1_sel:WORD_0
    s_mul_i32 s47, s30, 28672
    v_add_u32_sdwa v1, s47, v16 dst_sel:DWORD dst_unused:UNUSED_PAD src0_sel:DWORD src1_sel:WORD_1
    v_add_u32_sdwa v2, s47, v17 dst_sel:DWORD dst_unused:UNUSED_PAD src0_sel:DWORD src1_sel:WORD_0
    v_add_u32_sdwa v3, s47, v17 dst_sel:DWORD dst_unused:UNUSED_PAD src0_sel:DWORD src1_sel:WORD_1
    v_mov_b32 v14, v19
    s_mul_i32 s32, s31, 3
    s_lshr_b32 s32, s32, 4
    s_cmp_eq_u32 s28, 1
    s_cbranch_scc0 L_N2_n0
    s_call_b64 s[78:79], L_N2_t0
L_N2_n0:
    s_cmp_eq_u32 s28, 2
    s_cbranch_scc0 L_N2_n1
    s_call_b64 s[78:79], L_N2_t1
L_N2_n1:
    s_waitcnt vmcnt(6)
    s_barrier
    ds_read_b64_tr_b16 a[0:1], v4 offset:0
    ds_read_b64_tr_b16 a[2:3], v4 offset:768
    ds_read_b64_tr_b16 a[4:5], v4 offset:32
    ds_read_b64_tr_b16 a[6:7], v4 offset:800
    ds_read_b64_tr_b16 a[8:9], v5 offset:64
    ds_read_b64_tr_b16 a[10:11], v5 offset:832
    ds_read_b64_tr_b16 a[12:13], v4 offset:6208
    ds_read_b64_tr_b16 a[14:15], v4 offset:6976
    ds_read_b64_tr_b16 a[16:17], v4 offset:6240
    ds_read_b64_tr_b16 a[18:19], v4 offset:7008
    ds_read_b64_tr_b16 a[20:21], v5 offset:6272
    ds_read_b64_tr_b16 a[22:23], v5 offset:7040
    ds_read_b64_tr_b16 a[24:25], v4 offset:12416
    ds_read_b64_tr_b16 a[26:27], v4 offset:13184
    ds_read_b64_tr_b16 a[28:29], v4 offset:12448
    ds_read_b64_tr_b16 a[30:31], v4 offset:13216
    ds_read_b64_tr_b16 a[32:33], v5 offset:12480
    ds_read_b64_tr_b16 a[34:35], v5 offset:13248
    ds_read_b64_tr_b16 a[36:37], v4 offset:18624
    ds_read_b64_tr_b16 a[38:39], v4 offset:19392
    ds_read_b64_tr_b16 a[40:41], v4 offset:18656
    ds_read_b64_tr_b16 a[42:43], v4 offset:19424
    ds_read_b64_tr_b16 a[44:45], v5 offset:18688
    ds_read_b64_tr_b16 a[46:47], v5 offset:19456
    s_add_u32 m0, s44, 24832
    s_mov_b32 s46, 24576
    buffer_load_dwordx4 v7, s[12:15], s46 offen offset:0 lds
    buffer_load_dwordx4 v7, s[12:15], s46 offen offset:1024 lds
    buffer_load_dwordx4 v7, s[12:15], s46 offen offset:2048 lds
    s_add_u32 m0, s44, 37248
    s_mov_b32 s46, 36864
    buffer_load_dwordx4 v7, s[12:15], s46 offen offset:0 lds
    buffer_load_dwordx4 v7, s[12:15], s46 offen offset:1024 lds
    buffer_load_dwordx4 v7, s[12:15], s46 offen offset:2048 lds
    s_add_u32 m0, s44, 49664
    s_mov_b32 s46, 49152
    buffer_load_dwordx4 v7, s[12:15], s46 offen offset:0 lds
    buffer_load_dwordx4 v7, s[12:15], s46 offen offset:1024 lds
    buffer_load_dwordx4 v7, s[12:15], s46 offen offset:2048 lds
    s_waitcnt vmcnt(9)
    s_barrier
    ds_read_b128 v[80:83], v1 offset:0
    ds_read_b128 v[116:119], v1 offset:4096
    ds_read_b128 v[152:155], v1 offset:8192
    ds_read_b128 v[84:87], v1 offset:64
    ds_read_b128 v[120:123], v1 offset:4160
    ds_read_b128 v[156:159], v1 offset:8256
    s_waitcnt lgkmcnt(5)
    v_mfma_f32_16x16x32_bf16 v[44:47], a[0:3], v[80:83], 0
    ds_read_b128 v[88:91], v1 offset:128
    v_mfma_f32_16x16x32_bf16 v[48:51], a[4:7], v[80:83], 0
    s_add_u32 m0, s33, 12288
    v_mfma_f32_16x16x32_bf16 v[52:55], a[8:11], v[80:83], 0
    buffer_load_dwordx4 v8, s[4:7], s59 offen lds
    s_waitcnt lgkmcnt(5)
    v_mfma_f32_16x16x32_bf16 v[64:67], a[8:11], v[116:119], 0
    ds_read_b128 v[124:127], v1 offset:4224
    v_mfma_f32_16x16x32_bf16 v[60:63], a[4:7], v[116:119], 0
    ds_read_b128 v[160:163], v1 offset:8320
    v_mfma_f32_16x16x32_bf16 v[56:59], a[0:3], v[116:119], 0
    s_add_u32 m0, s33, 40960
    ds_read_b128 v[92:95], v2 offset:0
    ds_read_b128 v[128:131], v2 offset:4096
    ds_read_b128 v[164:167], v2 offset:8192
    s_waitcnt lgkmcnt(7)
    v_mfma_f32_16x16x32_bf16 v[68:71], a[0:3], v[152:155], 0
    buffer_load_dwordx4 v8, s[4:7], s66 offen lds
    s_waitcnt vmcnt(8)
    s_barrier
    v_mfma_f32_16x16x32_bf16 v[72:75], a[4:7], v[152:155], 0
    ds_read_b128 v[96:99], v2 offset:64
    v_mfma_f32_16x16x32_bf16 v[76:79], a[8:11], v[152:155], 0
    ds_read_b64_tr_b16 a[48:49], v4 offset:24832
    v_mfma_f32_16x16x32_bf16 v[44:47], a[12:15], v[84:87], v[44:47]
    s_add_u32 m0, s44, 62080
    s_mov_b32 s46, 61440
    v_mfma_f32_16x16x32_bf16 v[48:51], a[16:19], v[84:87], v[48:51]
    buffer_load_dwordx4 v7, s[12:15], s46 offen offset:0 lds
    v_mfma_f32_16x16x32_bf16 v[52:55], a[20:23], v[84:87], v[52:55]
    ds_read_b64_tr_b16 a[50:51], v4 offset:25600
    v_mfma_f32_16x16x32_bf16 v[64:67], a[20:23], v[120:123], v[64:67]
    ds_read_b64_tr_b16 a[52:53], v4 offset:24864
    v_mfma_f32_16x16x32_bf16 v[60:63], a[16:19], v[120:123], v[60:63]
    ds_read_b64_tr_b16 a[54:55], v4 offset:25632
    v_mfma_f32_16x16x32_bf16 v[56:59], a[12:15], v[120:123], v[56:59]
    ds_read_b64_tr_b16 a[56:57], v5 offset:24896
    s_waitcnt lgkmcnt(7)
    v_mfma_f32_16x16x32_bf16 v[68:71], a[12:15], v[156:159], v[68:71]
    buffer_load_dwordx4 v7, s[12:15], s46 offen offset:1024 lds
    v_mfma_f32_16x16x32_bf16 v[72:75], a[16:19], v[156:159], v[72:75]
    ds_read_b64_tr_b16 a[58:59], v5 offset:25664
    v_mfma_f32_16x16x32_bf16 v[76:79], a[20:23], v[156:159], v[76:79]
    ds_read_b128 v[132:135], v2 offset:4160
    v_mfma_f32_16x16x32_bf16 v[44:47], a[24:27], v[88:91], v[44:47]
    ds_read_b128 v[168:171], v2 offset:8256
    v_mfma_f32_16x16x32_bf16 v[48:51], a[28:31], v[88:91], v[48:51]
    buffer_load_dwordx4 v7, s[12:15], s46 offen offset:2048 lds
    v_mfma_f32_16x16x32_bf16 v[52:55], a[32:35], v[88:91], v[52:55]
    ds_read_b128 v[100:103], v2 offset:128
    v_mfma_f32_16x16x32_bf16 v[64:67], a[32:35], v[124:127], v[64:67]
    ds_read_b64_tr_b16 a[60:61], v4 offset:31040
    ds_read_b64_tr_b16 a[62:63], v4 offset:31808
    v_mfma_f32_16x16x32_bf16 v[60:63], a[28:31], v[124:127], v[60:63]
    s_add_u32 m0, s44, 74496
    s_mov_b32 s46, 73728
    v_mfma_f32_16x16x32_bf16 v[56:59], a[24:27], v[124:127], v[56:59]
    buffer_load_dwordx4 v7, s[12:15], s46 offen offset:0 lds
    v_mfma_f32_16x16x32_bf16 v[68:71], a[24:27], v[160:163], v[68:71]
    ds_read_b64_tr_b16 a[64:65], v4 offset:31072
    v_mfma_f32_16x16x32_bf16 v[72:75], a[28:31], v[160:163], v[72:75]
    ds_read_b64_tr_b16 a[66:67], v4 offset:31840
    v_mfma_f32_16x16x32_bf16 v[76:79], a[32:35], v[160:163], v[76:79]
    ds_read_b64_tr_b16 a[68:69], v5 offset:31104
    s_waitcnt vmcnt(6)
    s_barrier
    v_mfma_f32_16x16x32_bf16 v[44:47], a[36:39], v[92:95], v[44:47]
    ds_read_b64_tr_b16 a[70:71], v5 offset:31872
    v_mfma_f32_16x16x32_bf16 v[48:51], a[40:43], v[92:95], v[48:51]
    ds_read_b128 v[136:139], v2 offset:4224
    v_mfma_f32_16x16x32_bf16 v[52:55], a[44:47], v[92:95], v[52:55]
    ds_read_b128 v[172:175], v2 offset:8320
    v_mfma_f32_16x16x32_bf16 v[64:67], a[44:47], v[128:131], v[64:67]
    buffer_load_dwordx4 v7, s[12:15], s46 offen offset:1024 lds
    v_mfma_f32_16x16x32_bf16 v[60:63], a[40:43], v[128:131], v[60:63]
    ds_read_b128 v[104:107], v3 offset:0
    v_mfma_f32_16x16x32_bf16 v[56:59], a[36:39], v[128:131], v[56:59]
    ds_read_b64_tr_b16 a[72:73], v4 offset:37248
    ds_read_b64_tr_b16 a[74:75], v4 offset:38016
    s_waitcnt lgkmcnt(7)
    v_mfma_f32_16x16x32_bf16 v[68:71], a[36:39], v[164:167], v[68:71]
    buffer_load_dwordx4 v7, s[12:15], s46 offen offset:2048 lds
    v_mfma_f32_16x16x32_bf16 v[72:75], a[40:43], v[164:167], v[72:75]
    ds_read_b64_tr_b16 a[76:77], v4 offset:37280
    v_mfma_f32_16x16x32_bf16 v[76:79], a[44:47], v[164:167], v[76:79]
    ds_read_b64_tr_b16 a[78:79], v4 offset:38048
    ds_read_b64_tr_b16 a[80:81], v5 offset:37312
    v_mfma_f32_16x16x32_bf16 v[44:47], a[48:51], v[96:99], v[44:47]
    s_add_u32 m0, s45, 86912
    s_mov_b32 s46, 86016
    ds_read_b64_tr_b16 a[82:83], v5 offset:38080
    v_mfma_f32_16x16x32_bf16 v[48:51], a[52:55], v[96:99], v[48:51]
    buffer_load_dwordx4 v7, s[12:15], s46 offen offset:0 lds
    v_mfma_f32_16x16x32_bf16 v[52:55], a[56:59], v[96:99], v[52:55]
    ds_read_b128 v[140:143], v3 offset:4096
    v_mfma_f32_16x16x32_bf16 v[64:67], a[56:59], v[132:135], v[64:67]
    ds_read_b128 v[176:179], v3 offset:8192
    v_mfma_f32_16x16x32_bf16 v[60:63], a[52:55], v[132:135], v[60:63]
    ds_read_b128 v[108:111], v3 offset:64
    v_mfma_f32_16x16x32_bf16 v[56:59], a[48:51], v[132:135], v[56:59]
    ds_read_b64_tr_b16 a[84:85], v4 offset:43456
    ds_read_b64_tr_b16 a[86:87], v4 offset:44224
    v_mfma_f32_16x16x32_bf16 v[68:71], a[48:51], v[168:171], v[68:71]
    buffer_load_dwordx4 v7, s[12:15], s46 offen offset:1024 lds
    v_mfma_f32_16x16x32_bf16 v[72:75], a[52:55], v[168:171], v[72:75]
    ds_read_b64_tr_b16 a[88:89], v4 offset:43488
    v_mfma_f32_16x16x32_bf16 v[76:79], a[56:59], v[168:171], v[76:79]
    ds_read_b64_tr_b16 a[90:91], v4 offset:44256
    v_mfma_f32_16x16x32_bf16 v[44:47], a[60:63], v[100:103], v[44:47]
    ds_read_b64_tr_b16 a[92:93], v5 offset:43520
    ds_read_b64_tr_b16 a[94:95], v5 offset:44288
    v_mfma_f32_16x16x32_bf16 v[48:51], a[64:67], v[100:103], v[48:51]
    buffer_load_dwordx4 v7, s[12:15], s46 offen offset:2048 lds
    s_waitcnt lgkmcnt(7)
    v_mfma_f32_16x16x32_bf16 v[52:55], a[68:71], v[100:103], v[52:55]
    ds_read_b128 v[144:147], v3 offset:4160
    v_mfma_f32_16x16x32_bf16 v[64:67], a[68:71], v[136:139], v[64:67]
    ds_read_b128 v[180:183], v3 offset:8256
    ds_read_b128 v[112:115], v3 offset:128
    v_mfma_f32_16x16x32_bf16 v[60:63], a[64:67], v[136:139], v[60:63]
    s_add_u32 m0, s44, 6208
    s_mov_b32 s46, 98304
    ds_read_b64_tr_b16 a[96:97], v4 offset:49664
    v_mfma_f32_16x16x32_bf16 v[56:59], a[60:63], v[136:139], v[56:59]
    buffer_load_dwordx4 v7, s[12:15], s46 offen offset:0 lds
    v_mfma_f32_16x16x32_bf16 v[68:71], a[60:63], v[172:175], v[68:71]
    ds_read_b64_tr_b16 a[98:99], v4 offset:50432
    v_mfma_f32_16x16x32_bf16 v[72:75], a[64:67], v[172:175], v[72:75]
    ds_read_b64_tr_b16 a[100:101], v4 offset:49696
    v_mfma_f32_16x16x32_bf16 v[76:79], a[68:71], v[172:175], v[76:79]
    ds_read_b64_tr_b16 a[102:103], v4 offset:50464
    s_waitcnt vmcnt(7)
    s_barrier
    v_mfma_f32_16x16x32_bf16 v[44:47], a[72:75], v[104:107], v[44:47]
    ds_read_b64_tr_b16 a[104:105], v5 offset:49728
    v_mfma_f32_16x16x32_bf16 v[48:51], a[76:79], v[104:107], v[48:51]
    ds_read_b64_tr_b16 a[106:107], v5 offset:50496
    v_mfma_f32_16x16x32_bf16 v[52:55], a[80:83], v[104:107], v[52:55]
    ds_read_b128 v[148:151], v3 offset:4224
    ds_read_b128 v[184:187], v3 offset:8320
    v_mfma_f32_16x16x32_bf16 v[64:67], a[80:83], v[140:143], v[64:67]
    buffer_load_dwordx4 v7, s[12:15], s46 offen offset:1024 lds
    v_mfma_f32_16x16x32_bf16 v[60:63], a[76:79], v[140:143], v[60:63]
    v_add_u32 v4, 55872, v4
    v_add_u32 v5, 55872, v5
    v_mfma_f32_16x16x32_bf16 v[56:59], a[72:75], v[140:143], v[56:59]
    ds_read_b64_tr_b16 a[108:109], v4 offset:0
    v_mfma_f32_16x16x32_bf16 v[68:71], a[72:75], v[176:179], v[68:71]
    buffer_load_dwordx4 v7, s[12:15], s46 offen offset:2048 lds
    v_mfma_f32_16x16x32_bf16 v[72:75], a[76:79], v[176:179], v[72:75]
    ds_read_b64_tr_b16 a[110:111], v4 offset:768
    v_mfma_f32_16x16x32_bf16 v[76:79], a[80:83], v[176:179], v[76:79]
    ds_read_b64_tr_b16 a[112:113], v4 offset:32
    s_waitcnt lgkmcnt(7)
    v_mfma_f32_16x16x32_bf16 v[44:47], a[84:87], v[108:111], v[44:47]
    s_add_u32 m0, s33, 16384
    ds_read_b64_tr_b16 a[114:115], v4 offset:800
    v_mfma_f32_16x16x32_bf16 v[48:51], a[88:91], v[108:111], v[48:51]
    buffer_load_dwordx4 v8, s[4:7], s60 offen lds
    v_mfma_f32_16x16x32_bf16 v[52:55], a[92:95], v[108:111], v[52:55]
    ds_read_b64_tr_b16 a[116:117], v5 offset:64
    v_mfma_f32_16x16x32_bf16 v[64:67], a[92:95], v[144:147], v[64:67]
    ds_read_b64_tr_b16 a[118:119], v5 offset:832
    v_mfma_f32_16x16x32_bf16 v[60:63], a[88:91], v[144:147], v[60:63]
    ds_read_b128 v[80:83], v1 offset:12288
    v_mfma_f32_16x16x32_bf16 v[56:59], a[84:87], v[144:147], v[56:59]
    s_add_u32 m0, s33, 45056
    ds_read_b64_tr_b16 a[120:121], v4 offset:6208
    v_mfma_f32_16x16x32_bf16 v[68:71], a[84:87], v[180:183], v[68:71]
    buffer_load_dwordx4 v8, s[4:7], s67 offen lds
    v_mfma_f32_16x16x32_bf16 v[72:75], a[88:91], v[180:183], v[72:75]
    ds_read_b64_tr_b16 a[122:123], v4 offset:6976
    v_mfma_f32_16x16x32_bf16 v[76:79], a[92:95], v[180:183], v[76:79]
    ds_read_b64_tr_b16 a[124:125], v4 offset:6240
    ds_read_b64_tr_b16 a[126:127], v4 offset:7008
    v_mfma_f32_16x16x32_bf16 v[44:47], a[96:99], v[112:115], v[44:47]
    s_add_u32 m0, s44, 18624
    s_mov_b32 s46, 110592
    v_mfma_f32_16x16x32_bf16 v[48:51], a[100:103], v[112:115], v[48:51]
    buffer_load_dwordx4 v7, s[12:15], s46 offen offset:0 lds
    s_waitcnt lgkmcnt(7)
    v_mfma_f32_16x16x32_bf16 v[52:55], a[104:107], v[112:115], v[52:55]
    ds_read_b64_tr_b16 a[128:129], v5 offset:6272
    v_mfma_f32_16x16x32_bf16 v[64:67], a[104:107], v[148:151], v[64:67]
    ds_read_b64_tr_b16 a[130:131], v5 offset:7040
    v_mfma_f32_16x16x32_bf16 v[60:63], a[100:103], v[148:151], v[60:63]
    ds_read_b128 v[84:87], v1 offset:12352
    ds_read_b64_tr_b16 a[132:133], v4 offset:12416
    v_mfma_f32_16x16x32_bf16 v[56:59], a[96:99], v[148:151], v[56:59]
    buffer_load_dwordx4 v7, s[12:15], s46 offen offset:1024 lds
    v_mfma_f32_16x16x32_bf16 v[68:71], a[96:99], v[184:187], v[68:71]
    ds_read_b64_tr_b16 a[134:135], v4 offset:13184
    v_mfma_f32_16x16x32_bf16 v[72:75], a[100:103], v[184:187], v[72:75]
    ds_read_b64_tr_b16 a[136:137], v4 offset:12448
    v_mfma_f32_16x16x32_bf16 v[76:79], a[104:107], v[184:187], v[76:79]
    ds_read_b64_tr_b16 a[138:139], v4 offset:13216
    s_waitcnt vmcnt(7)
    s_barrier
    v_mfma_f32_16x16x32_bf16 v[44:47], a[108:111], v[116:119], v[44:47]
    ds_read_b64_tr_b16 a[140:141], v5 offset:12480
    v_mfma_f32_16x16x32_bf16 v[48:51], a[112:115], v[116:119], v[48:51]
    ds_read_b64_tr_b16 a[142:143], v5 offset:13248
    s_waitcnt lgkmcnt(7)
    v_mfma_f32_16x16x32_bf16 v[52:55], a[116:119], v[116:119], v[52:55]
    ds_read_b128 v[88:91], v1 offset:12416
    s_branch L_N2_s0
L_N2_t0:
    s_setpc_b64 s[78:79]
L_N2_s0:
    v_mfma_f32_16x16x32_bf16 v[64:67], a[116:119], v[152:155], v[64:67]
    buffer_load_dwordx4 v7, s[12:15], s46 offen offset:2048 lds
    v_mfma_f32_16x16x32_bf16 v[60:63], a[112:115], v[152:155], v[60:63]
    ds_read_b64_tr_b16 a[144:145], v4 offset:18624
    ds_read_b64_tr_b16 a[146:147], v4 offset:19392
    v_mfma_f32_16x16x32_bf16 v[56:59], a[108:111], v[152:155], v[56:59]
    s_add_u32 m0, s44, 31040
    s_mov_b32 s46, 122880
    v_mfma_f32_16x16x32_bf16 v[68:71], a[108:111], v[80:83], v[68:71]
    buffer_load_dwordx4 v7, s[12:15], s46 offen offset:0 lds
    v_mfma_f32_16x16x32_bf16 v[72:75], a[112:115], v[80:83], v[72:75]
    ds_read_b64_tr_b16 a[148:149], v4 offset:18656
    v_mfma_f32_16x16x32_bf16 v[76:79], a[116:119], v[80:83], v[76:79]
    ds_read_b64_tr_b16 a[150:151], v4 offset:19424
    v_mfma_f32_16x16x32_bf16 v[44:47], a[120:123], v[120:123], v[44:47]
    ds_read_b64_tr_b16 a[152:153], v5 offset:18688
    v_mfma_f32_16x16x32_bf16 v[48:51], a[124:127], v[120:123], v[48:51]
    buffer_load_dwordx4 v7, s[12:15], s46 offen offset:1024 lds
    v_mfma_f32_16x16x32_bf16 v[52:55], a[128:131], v[120:123], v[52:55]
    ds_read_b64_tr_b16 a[154:155], v5 offset:19456
    v_mfma_f32_16x16x32_bf16 v[64:67], a[128:131], v[156:159], v[64:67]
    ds_read_b128 v[92:95], v2 offset:12288
    v_mfma_f32_16x16x32_bf16 v[60:63], a[124:127], v[156:159], v[60:63]
    ds_read_b64_tr_b16 a[156:157], v4 offset:24832
    v_mfma_f32_16x16x32_bf16 v[56:59], a[120:123], v[156:159], v[56:59]
    ds_read_b64_tr_b16 a[158:159], v4 offset:25600
    s_waitcnt lgkmcnt(7)
    v_mfma_f32_16x16x32_bf16 v[68:71], a[120:123], v[84:87], v[68:71]
    buffer_load_dwordx4 v7, s[12:15], s46 offen offset:2048 lds
    v_mfma_f32_16x16x32_bf16 v[72:75], a[124:127], v[84:87], v[72:75]
    ds_read_b64_tr_b16 a[160:161], v4 offset:24864
    v_mfma_f32_16x16x32_bf16 v[76:79], a[128:131], v[84:87], v[76:79]
    ds_read_b64_tr_b16 a[162:163], v4 offset:25632
    ds_read_b64_tr_b16 a[164:165], v5 offset:24896
    v_mfma_f32_16x16x32_bf16 v[44:47], a[132:135], v[124:127], v[44:47]
    s_add_u32 m0, s44, 43456
    s_mov_b32 s46, 135168
    v_mfma_f32_16x16x32_bf16 v[48:51], a[136:139], v[124:127], v[48:51]
    buffer_load_dwordx4 v7, s[12:15], s46 offen offset:0 lds
    v_mfma_f32_16x16x32_bf16 v[52:55], a[140:143], v[124:127], v[52:55]
    ds_read_b64_tr_b16 a[166:167], v5 offset:25664
    v_mfma_f32_16x16x32_bf16 v[64:67], a[140:143], v[160:163], v[64:67]
    ds_read_b128 v[96:99], v2 offset:12352
    v_mfma_f32_16x16x32_bf16 v[60:63], a[136:139], v[160:163], v[60:63]
    ds_read_b64_tr_b16 a[168:169], v4 offset:31040
    v_mfma_f32_16x16x32_bf16 v[56:59], a[132:135], v[160:163], v[56:59]
    buffer_load_dwordx4 v7, s[12:15], s46 offen offset:1024 lds
    v_mfma_f32_16x16x32_bf16 v[68:71], a[132:135], v[88:91], v[68:71]
    ds_read_b64_tr_b16 a[170:171], v4 offset:31808
    v_mfma_f32_16x16x32_bf16 v[72:75], a[136:139], v[88:91], v[72:75]
    ds_read_b64_tr_b16 a[172:173], v4 offset:31072
    v_mfma_f32_16x16x32_bf16 v[76:79], a[140:143], v[88:91], v[76:79]
    ds_read_b64_tr_b16 a[174:175], v4 offset:31840
    s_waitcnt vmcnt(10)
    s_barrier
    v_mfma_f32_16x16x32_bf16 v[44:47], a[144:147], v[128:131], v[44:47]
    ds_read_b64_tr_b16 a[176:177], v5 offset:31104
    s_waitcnt lgkmcnt(7)
    v_mfma_f32_16x16x32_bf16 v[48:51], a[148:151], v[128:131], v[48:51]
    ds_read_b64_tr_b16 a[178:179], v5 offset:31872
    v_mfma_f32_16x16x32_bf16 v[52:55], a[152:155], v[128:131], v[52:55]
    ds_read_b128 v[100:103], v2 offset:12416
    v_mfma_f32_16x16x32_bf16 v[64:67], a[152:155], v[164:167], v[64:67]
    buffer_load_dwordx4 v7, s[12:15], s46 offen offset:2048 lds
    v_mfma_f32_16x16x32_bf16 v[60:63], a[148:151], v[164:167], v[60:63]
    v_add_u32 v4, -55872, v4
    v_add_u32 v5, -55872, v5
    v_mfma_f32_16x16x32_bf16 v[56:59], a[144:147], v[164:167], v[56:59]
    ds_read_b64_tr_b16 a[180:181], v4 offset:0
    v_mfma_f32_16x16x32_bf16 v[68:71], a[144:147], v[92:95], v[68:71]
    ds_read_b64_tr_b16 a[182:183], v4 offset:768
    v_mfma_f32_16x16x32_bf16 v[72:75], a[148:151], v[92:95], v[72:75]
    ds_read_b64_tr_b16 a[184:185], v4 offset:32
    v_mfma_f32_16x16x32_bf16 v[76:79], a[152:155], v[92:95], v[76:79]
    s_add_u32 m0, s44, 55872
    s_mov_b32 s46, 147456
    v_mfma_f32_16x16x32_bf16 v[44:47], a[156:159], v[132:135], v[44:47]
    buffer_load_dwordx4 v7, s[12:15], s46 offen offset:0 lds
    v_mfma_f32_16x16x32_bf16 v[48:51], a[160:163], v[132:135], v[48:51]
    ds_read_b64_tr_b16 a[186:187], v4 offset:800
    s_waitcnt lgkmcnt(7)
    v_mfma_f32_16x16x32_bf16 v[52:55], a[164:167], v[132:135], v[52:55]
    ds_read_b64_tr_b16 a[188:189], v5 offset:64
    v_mfma_f32_16x16x32_bf16 v[64:67], a[164:167], v[168:171], v[64:67]
    ds_read_b64_tr_b16 a[190:191], v5 offset:832
    v_mfma_f32_16x16x32_bf16 v[60:63], a[160:163], v[168:171], v[60:63]
    ds_read_b128 v[104:107], v3 offset:12288
    v_mfma_f32_16x16x32_bf16 v[56:59], a[156:159], v[168:171], v[56:59]
    ds_read_b64_tr_b16 a[192:193], v4 offset:6208
    v_mfma_f32_16x16x32_bf16 v[68:71], a[156:159], v[96:99], v[68:71]
    ds_read_b64_tr_b16 a[194:195], v4 offset:6976
    v_mfma_f32_16x16x32_bf16 v[72:75], a[160:163], v[96:99], v[72:75]
    buffer_load_dwordx4 v7, s[12:15], s46 offen offset:1024 lds
    v_mfma_f32_16x16x32_bf16 v[76:79], a[164:167], v[96:99], v[76:79]
    ds_read_b64_tr_b16 a[196:197], v4 offset:6240
    v_mfma_f32_16x16x32_bf16 v[44:47], a[168:171], v[136:139], v[44:47]
    ds_read_b64_tr_b16 a[198:199], v4 offset:7008
    v_mfma_f32_16x16x32_bf16 v[48:51], a[172:175], v[136:139], v[48:51]
    ds_read_b64_tr_b16 a[200:201], v5 offset:6272
    s_waitcnt lgkmcnt(7)
    v_mfma_f32_16x16x32_bf16 v[52:55], a[176:179], v[136:139], v[52:55]
    ds_read_b64_tr_b16 a[202:203], v5 offset:7040
    v_mfma_f32_16x16x32_bf16 v[64:67], a[176:179], v[172:175], v[64:67]
    ds_read_b128 v[108:111], v3 offset:12352
    v_mfma_f32_16x16x32_bf16 v[60:63], a[172:175], v[172:175], v[60:63]
    buffer_load_dwordx4 v7, s[12:15], s46 offen offset:2048 lds
    v_mfma_f32_16x16x32_bf16 v[56:59], a[168:171], v[172:175], v[56:59]
    ds_read_b64_tr_b16 a[204:205], v4 offset:12416
    v_mfma_f32_16x16x32_bf16 v[68:71], a[168:171], v[100:103], v[68:71]
    ds_read_b64_tr_b16 a[206:207], v4 offset:13184
    v_mfma_f32_16x16x32_bf16 v[72:75], a[172:175], v[100:103], v[72:75]
    ds_read_b64_tr_b16 a[208:209], v4 offset:12448
    v_mfma_f32_16x16x32_bf16 v[76:79], a[176:179], v[100:103], v[76:79]
    ds_read_b64_tr_b16 a[210:211], v4 offset:13216
    s_waitcnt vmcnt(6)
    s_barrier
    v_mfma_f32_16x16x32_bf16 v[44:47], a[180:183], v[140:143], v[44:47]
    ds_read_b64_tr_b16 a[212:213], v5 offset:12480
    v_mfma_f32_16x16x32_bf16 v[48:51], a[184:187], v[140:143], v[48:51]
    ds_read_b64_tr_b16 a[214:215], v5 offset:13248
    s_waitcnt lgkmcnt(7)
    v_mfma_f32_16x16x32_bf16 v[52:55], a[188:191], v[140:143], v[52:55]
    ds_read_b128 v[112:115], v3 offset:12416
    s_add_u32 m0, s44, 68288
    s_mov_b32 s46, 159744
    v_mfma_f32_16x16x32_bf16 v[64:67], a[188:191], v[176:179], v[64:67]
    buffer_load_dwordx4 v7, s[12:15], s46 offen offset:0 lds
    v_mfma_f32_16x16x32_bf16 v[60:63], a[184:187], v[176:179], v[60:63]
    ds_read_b64_tr_b16 a[216:217], v4 offset:18624
    v_mfma_f32_16x16x32_bf16 v[56:59], a[180:183], v[176:179], v[56:59]
    ds_read_b64_tr_b16 a[218:219], v4 offset:19392
    v_mfma_f32_16x16x32_bf16 v[68:71], a[180:183], v[104:107], v[68:71]
    ds_read_b64_tr_b16 a[220:221], v4 offset:18656
    v_mfma_f32_16x16x32_bf16 v[72:75], a[184:187], v[104:107], v[72:75]
    buffer_load_dwordx4 v7, s[12:15], s46 offen offset:1024 lds
    v_mfma_f32_16x16x32_bf16 v[76:79], a[188:191], v[104:107], v[76:79]
    ds_read_b64_tr_b16 a[222:223], v4 offset:19424
    v_mfma_f32_16x16x32_bf16 v[44:47], a[192:195], v[144:147], v[44:47]
    ds_read_b64_tr_b16 a[224:225], v5 offset:18688
    v_mfma_f32_16x16x32_bf16 v[48:51], a[196:199], v[144:147], v[48:51]
    ds_read_b64_tr_b16 a[226:227], v5 offset:19456
    v_mfma_f32_16x16x32_bf16 v[52:55], a[200:203], v[144:147], v[52:55]
    ds_read_b128 v[116:119], v1 offset:16384
    v_mfma_f32_16x16x32_bf16 v[64:67], a[200:203], v[180:183], v[64:67]
    ds_read_b64_tr_b16 a[228:229], v4 offset:24832
    v_mfma_f32_16x16x32_bf16 v[60:63], a[196:199], v[180:183], v[60:63]
    buffer_load_dwordx4 v7, s[12:15], s46 offen offset:2048 lds
    v_mfma_f32_16x16x32_bf16 v[56:59], a[192:195], v[180:183], v[56:59]
    ds_read_b64_tr_b16 a[230:231], v4 offset:25600
    s_waitcnt lgkmcnt(7)
    v_mfma_f32_16x16x32_bf16 v[68:71], a[192:195], v[108:111], v[68:71]
    ds_read_b64_tr_b16 a[232:233], v4 offset:24864
    v_mfma_f32_16x16x32_bf16 v[72:75], a[196:199], v[108:111], v[72:75]
    ds_read_b64_tr_b16 a[234:235], v4 offset:25632
    v_mfma_f32_16x16x32_bf16 v[76:79], a[200:203], v[108:111], v[76:79]
    s_add_u32 m0, s33, 20480
    v_mfma_f32_16x16x32_bf16 v[44:47], a[204:207], v[148:151], v[44:47]
    buffer_load_dwordx4 v8, s[4:7], s61 offen lds
    v_mfma_f32_16x16x32_bf16 v[48:51], a[208:211], v[148:151], v[48:51]
    ds_read_b64_tr_b16 a[236:237], v5 offset:24896
    v_mfma_f32_16x16x32_bf16 v[52:55], a[212:215], v[148:151], v[52:55]
    ds_read_b64_tr_b16 a[238:239], v5 offset:25664
    v_mfma_f32_16x16x32_bf16 v[64:67], a[212:215], v[184:187], v[64:67]
    ds_read_b128 v[120:123], v1 offset:16448
    v_mfma_f32_16x16x32_bf16 v[60:63], a[208:211], v[184:187], v[60:63]
    s_add_u32 m0, s33, 49152
    ds_read_b64_tr_b16 a[240:241], v4 offset:31040
    v_mfma_f32_16x16x32_bf16 v[56:59], a[204:207], v[184:187], v[56:59]
    buffer_load_dwordx4 v8, s[4:7], s68 offen lds
    v_mfma_f32_16x16x32_bf16 v[68:71], a[204:207], v[112:115], v[68:71]
    ds_read_b64_tr_b16 a[242:243], v4 offset:31808
    v_mfma_f32_16x16x32_bf16 v[72:75], a[208:211], v[112:115], v[72:75]
    ds_read_b64_tr_b16 a[244:245], v4 offset:31072
    v_mfma_f32_16x16x32_bf16 v[76:79], a[212:215], v[112:115], v[76:79]
    ds_read_b64_tr_b16 a[246:247], v4 offset:31840
    s_waitcnt vmcnt(8)
    s_barrier
    v_mfma_f32_16x16x32_bf16 v[44:47], a[216:219], v[152:155], v[44:47]
    ds_read_b64_tr_b16 a[248:249], v5 offset:31104
    s_waitcnt lgkmcnt(7)
    v_mfma_f32_16x16x32_bf16 v[48:51], a[220:223], v[152:155], v[48:51]
    ds_read_b64_tr_b16 a[250:251], v5 offset:31872
    v_mfma_f32_16x16x32_bf16 v[52:55], a[224:227], v[152:155], v[52:55]
    ds_read_b128 v[124:127], v1 offset:16512
    s_add_u32 m0, s33, 24576
    v_mfma_f32_16x16x32_bf16 v[64:67], a[224:227], v[80:83], v[64:67]
    buffer_load_dwordx4 v8, s[4:7], s62 offen lds
    v_mfma_f32_16x16x32_bf16 v[60:63], a[220:223], v[80:83], v[60:63]
    ds_read_b64_tr_b16 a[252:253], v4 offset:37248
    v_mfma_f32_16x16x32_bf16 v[56:59], a[216:219], v[80:83], v[56:59]
    ds_read_b64_tr_b16 a[254:255], v4 offset:38016
    v_mfma_f32_16x16x32_bf16 v[68:71], a[216:219], v[116:119], v[68:71]
    ds_read_b64_tr_b16 v[188:189], v4 offset:37280
    v_mfma_f32_16x16x32_bf16 v[72:75], a[220:223], v[116:119], v[72:75]
    ds_read_b64_tr_b16 v[190:191], v4 offset:38048
    v_mfma_f32_16x16x32_bf16 v[76:79], a[224:227], v[116:119], v[76:79]
    s_add_u32 m0, s33, 53248
    v_mfma_f32_16x16x32_bf16 v[44:47], a[228:231], v[156:159], v[44:47]
    buffer_load_dwordx4 v8, s[4:7], s69 offen lds
    v_mfma_f32_16x16x32_bf16 v[48:51], a[232:235], v[156:159], v[48:51]
    ds_read_b64_tr_b16 v[192:193], v5 offset:37312
    s_waitcnt lgkmcnt(7)
    v_mfma_f32_16x16x32_bf16 v[52:55], a[236:239], v[156:159], v[52:55]
    ds_read_b64_tr_b16 v[194:195], v5 offset:38080
    v_mfma_f32_16x16x32_bf16 v[64:67], a[236:239], v[84:87], v[64:67]
    ds_read_b128 v[128:131], v2 offset:16384
    v_mfma_f32_16x16x32_bf16 v[60:63], a[232:235], v[84:87], v[60:63]
    ds_read_b64_tr_b16 v[196:197], v4 offset:43456
    v_mfma_f32_16x16x32_bf16 v[56:59], a[228:231], v[84:87], v[56:59]
    ds_read_b64_tr_b16 v[198:199], v4 offset:44224
    v_mfma_f32_16x16x32_bf16 v[68:71], a[228:231], v[120:123], v[68:71]
    s_add_u32 m0, s33, 57344
    ds_read_b64_tr_b16 v[200:201], v4 offset:43488
    v_mfma_f32_16x16x32_bf16 v[72:75], a[232:235], v[120:123], v[72:75]
    buffer_load_dwordx4 v8, s[4:7], s70 offen lds
    v_mfma_f32_16x16x32_bf16 v[76:79], a[236:239], v[120:123], v[76:79]
    ds_read_b64_tr_b16 v[202:203], v4 offset:44256
    v_mfma_f32_16x16x32_bf16 v[44:47], a[240:243], v[160:163], v[44:47]
    ds_read_b64_tr_b16 v[204:205], v5 offset:43520
    v_mfma_f32_16x16x32_bf16 v[48:51], a[244:247], v[160:163], v[48:51]
    ds_read_b64_tr_b16 v[206:207], v5 offset:44288
    s_waitcnt lgkmcnt(7)
    v_mfma_f32_16x16x32_bf16 v[52:55], a[248:251], v[160:163], v[52:55]
    ds_read_b128 v[132:135], v2 offset:16448
    v_mfma_f32_16x16x32_bf16 v[64:67], a[248:251], v[88:91], v[64:67]
    s_add_u32 m0, s33, 61440
    v_mfma_f32_16x16x32_bf16 v[60:63], a[244:247], v[88:91], v[60:63]
    buffer_load_dwordx4 v8, s[4:7], s71 offen lds
    v_mfma_f32_16x16x32_bf16 v[56:59], a[240:243], v[88:91], v[56:59]
    ds_read_b64_tr_b16 v[208:209], v4 offset:49664
    v_mfma_f32_16x16x32_bf16 v[68:71], a[240:243], v[124:127], v[68:71]
    ds_read_b64_tr_b16 v[210:211], v4 offset:50432
    v_mfma_f32_16x16x32_bf16 v[72:75], a[244:247], v[124:127], v[72:75]
    ds_read_b64_tr_b16 v[212:213], v4 offset:49696
    v_mfma_f32_16x16x32_bf16 v[76:79], a[248:251], v[124:127], v[76:79]
    ds_read_b64_tr_b16 v[214:215], v4 offset:50464
    s_waitcnt vmcnt(6)
    s_barrier
    v_mfma_f32_16x16x32_bf16 v[44:47], a[252:255], v[164:167], v[44:47]
    ds_read_b64_tr_b16 v[216:217], v5 offset:49728
    v_mfma_f32_16x16x32_bf16 v[48:51], v[188:191], v[164:167], v[48:51]
    ds_read_b64_tr_b16 v[218:219], v5 offset:50496
    v_mfma_f32_16x16x32_bf16 v[52:55], v[192:195], v[164:167], v[52:55]
    ds_read_b128 v[136:139], v2 offset:16512
    v_mfma_f32_16x16x32_bf16 v[64:67], v[192:195], v[92:95], v[64:67]
    v_add_u32 v4, 55872, v4
    v_add_u32 v5, 55872, v5
    v_mfma_f32_16x16x32_bf16 v[60:63], v[188:191], v[92:95], v[60:63]
    ds_read_b64_tr_b16 v[220:221], v4 offset:0
    v_mfma_f32_16x16x32_bf16 v[56:59], a[252:255], v[92:95], v[56:59]
    ds_read_b64_tr_b16 v[222:223], v4 offset:768
    buffer_load_dwordx4 v[16:19], v14, s[8:11], s32 offen offset:0
    s_waitcnt lgkmcnt(7)
    v_mfma_f32_16x16x32_bf16 v[68:71], a[252:255], v[128:131], v[68:71]
    ds_read_b64_tr_b16 v[224:225], v4 offset:32
    v_mfma_f32_16x16x32_bf16 v[72:75], v[188:191], v[128:131], v[72:75]
    ds_read_b64_tr_b16 v[226:227], v4 offset:800
    v_mfma_f32_16x16x32_bf16 v[76:79], v[192:195], v[128:131], v[76:79]
    ds_read_b64_tr_b16 v[228:229], v5 offset:64
    buffer_load_dwordx4 v[20:23], v14, s[8:11], s32 offen offset:144
    v_mfma_f32_16x16x32_bf16 v[44:47], v[196:199], v[168:171], v[44:47]
    ds_read_b64_tr_b16 v[230:231], v5 offset:832
    v_mfma_f32_16x16x32_bf16 v[48:51], v[200:203], v[168:171], v[48:51]
    ds_read_b128 v[140:143], v3 offset:16384
    v_mfma_f32_16x16x32_bf16 v[52:55], v[204:207], v[168:171], v[52:55]
    ds_read_b64_tr_b16 v[232:233], v4 offset:6208
    buffer_load_dwordx4 v[24:27], v14, s[8:11], s32 offen offset:288
    v_mfma_f32_16x16x32_bf16 v[64:67], v[204:207], v[96:99], v[64:67]
    ds_read_b64_tr_b16 v[234:235], v4 offset:6976
    v_mfma_f32_16x16x32_bf16 v[60:63], v[200:203], v[96:99], v[60:63]
    ds_read_b64_tr_b16 v[236:237], v4 offset:6240
    v_mfma_f32_16x16x32_bf16 v[56:59], v[196:199], v[96:99], v[56:59]
    ds_read_b64_tr_b16 v[238:239], v4 offset:7008
    buffer_load_dwordx4 v[28:31], v14, s[8:11], s32 offen offset:432
    v_mfma_f32_16x16x32_bf16 v[68:71], v[196:199], v[132:135], v[68:71]
    ds_read_b64_tr_b16 v[240:241], v5 offset:6272
    v_mfma_f32_16x16x32_bf16 v[72:75], v[200:203], v[132:135], v[72:75]
    ds_read_b64_tr_b16 v[242:243], v5 offset:7040
    v_mfma_f32_16x16x32_bf16 v[76:79], v[204:207], v[132:135], v[76:79]
    ds_read_b128 v[144:147], v3 offset:16448
    v_mfma_f32_16x16x32_bf16 v[44:47], v[208:211], v[172:175], v[44:47]
    ds_read_b64_tr_b16 v[244:245], v4 offset:12416
    s_waitcnt lgkmcnt(7)
    v_mfma_f32_16x16x32_bf16 v[48:51], v[212:215], v[172:175], v[48:51]
    ds_read_b64_tr_b16 v[246:247], v4 offset:13184
    v_mfma_f32_16x16x32_bf16 v[52:55], v[216:219], v[172:175], v[52:55]
    ds_read_b64_tr_b16 v[248:249], v4 offset:12448
    v_mfma_f32_16x16x32_bf16 v[64:67], v[216:219], v[100:103], v[64:67]
    ds_read_b64_tr_b16 v[250:251], v4 offset:13216
    v_mfma_f32_16x16x32_bf16 v[60:63], v[212:215], v[100:103], v[60:63]
    ds_read_b64_tr_b16 v[252:253], v5 offset:12480
    v_mfma_f32_16x16x32_bf16 v[56:59], v[208:211], v[100:103], v[56:59]
    ds_read_b64_tr_b16 v[254:255], v5 offset:13248
    ds_read_b128 v[148:151], v3 offset:16512
    v_mfma_f32_16x16x32_bf16 v[68:71], v[208:211], v[136:139], v[68:71]
    v_mfma_f32_16x16x32_bf16 v[72:75], v[212:215], v[136:139], v[72:75]
    v_mfma_f32_16x16x32_bf16 v[76:79], v[216:219], v[136:139], v[76:79]
    v_mfma_f32_16x16x32_bf16 v[44:47], v[220:223], v[176:179], v[44:47]
    s_mul_i32 s47, s30, 8064
    s_lshl_b32 s48, s29, 3
    v_mfma_f32_16x16x32_bf16 v[48:51], v[224:227], v[176:179], v[48:51]
    v_bfe_u32 v38, v6, 4, 2
    v_bfe_u32 v39, v6, 6, 2
    v_mfma_f32_16x16x32_bf16 v[52:55], v[228:231], v[176:179], v[52:55]
    v_lshl_add_u32 v38, v38, 2, v39
    s_add_u32 s47, s47, 65536
    s_waitcnt lgkmcnt(7)
    v_mfma_f32_16x16x32_bf16 v[52:55], v[240:243], v[180:183], v[52:55]
    v_lshrrev_b32 v39, 8, v6
    v_mul_u32_u24 v10, 72, v38
    v_mfma_f32_16x16x32_bf16 v[48:51], v[236:239], v[180:183], v[48:51]
    v_mul_u32_u24 v9, 192, v38
    s_lshl2_add_u32 s49, s48, s47
    v_mfma_f32_16x16x32_bf16 v[44:47], v[232:235], v[180:183], v[44:47]
    v_lshl_add_u32 v10, v39, 3, v10
    v_and_b32 v38, 1, v39
    s_waitcnt lgkmcnt(5)
    v_mfma_f32_16x16x32_bf16 v[44:47], v[244:247], v[184:187], v[44:47]
    v_lshrrev_b32 v39, 1, v39
    v_add_u32 v10, s49, v10
    s_waitcnt lgkmcnt(3)
    v_mfma_f32_16x16x32_bf16 v[48:51], v[248:251], v[184:187], v[48:51]
    v_lshl_add_u32 v38, v38, 1, v39
    v_lshrrev_b32 v39, 7, v6
    s_waitcnt lgkmcnt(1)
    v_mfma_f32_16x16x32_bf16 v[52:55], v[252:255], v[184:187], v[52:55]
    v_add_u32 v38, s48, v38
    v_add_u32 v39, s48, v39
    v_mfma_f32_16x16x32_bf16 v[56:59], v[220:223], v[104:107], v[56:59]
    v_lshl_add_u32 v9, v38, 4, v9
    v_bfe_u32 v38, v6, 1, 6
    v_mfma_f32_16x16x32_bf16 v[60:63], v[224:227], v[104:107], v[60:63]
    v_mul_u32_u24 v4, 72, v39
    v_mul_u32_u24 v5, 192, v39
    v_mfma_f32_16x16x32_bf16 v[64:67], v[228:231], v[104:107], v[64:67]
    v_add3_u32 v4, v4, s47, v38
    v_add3_u32 v5, v5, 64, v38
    v_mfma_f32_16x16x32_bf16 v[64:67], v[240:243], v[108:111], v[64:67]
    s_mov_b32 s46, s31
    v_mfma_f32_16x16x32_bf16 v[60:63], v[236:239], v[108:111], v[60:63]
    v_mfma_f32_16x16x32_bf16 v[56:59], v[232:235], v[108:111], v[56:59]
    v_mfma_f32_16x16x32_bf16 v[56:59], v[244:247], v[112:115], v[56:59]
    v_mfma_f32_16x16x32_bf16 v[60:63], v[248:251], v[112:115], v[60:63]
    v_cvt_pk_bf16_f32 v32, v44, v45
    v_cvt_pk_bf16_f32 v33, v46, v47
    v_mfma_f32_16x16x32_bf16 v[64:67], v[252:255], v[112:115], v[64:67]
    v_cvt_pk_bf16_f32 v34, v48, v49
    v_cvt_pk_bf16_f32 v35, v50, v51
    v_mfma_f32_16x16x32_bf16 v[68:71], v[220:223], v[140:143], v[68:71]
    v_cvt_pk_bf16_f32 v36, v52, v53
    v_cvt_pk_bf16_f32 v37, v54, v55
    v_mfma_f32_16x16x32_bf16 v[72:75], v[224:227], v[140:143], v[72:75]
    v_permlane16_swap_b32 v32, v34
    v_permlane16_swap_b32 v33, v35
    v_mfma_f32_16x16x32_bf16 v[76:79], v[228:231], v[140:143], v[76:79]
    ds_write_b64 v10, v[36:37] offset:0
    v_mfma_f32_16x16x32_bf16 v[76:79], v[240:243], v[144:147], v[76:79]
    buffer_store_dwordx4 v[32:35], v9, s[16:19], s31 offen sc1
    s_add_u32 s31, s31, 43008
    v_mfma_f32_16x16x32_bf16 v[72:75], v[236:239], v[144:147], v[72:75]
    v_mfma_f32_16x16x32_bf16 v[68:71], v[232:235], v[144:147], v[68:71]
    s_waitcnt lgkmcnt(1)
    v_mfma_f32_16x16x32_bf16 v[68:71], v[244:247], v[148:151], v[68:71]
    v_mfma_f32_16x16x32_bf16 v[72:75], v[248:251], v[148:151], v[72:75]
    v_mfma_f32_16x16x32_bf16 v[76:79], v[252:255], v[148:151], v[76:79]
    v_mfma_f32_16x16x32_bf16 v[44:47], a[0:3], v[80:83], 0
    v_mfma_f32_16x16x32_bf16 v[48:51], a[4:7], v[80:83], 0
    v_mfma_f32_16x16x32_bf16 v[52:55], a[8:11], v[80:83], 0
    v_mfma_f32_16x16x32_bf16 v[52:55], a[20:23], v[84:87], v[52:55]
    v_mfma_f32_16x16x32_bf16 v[48:51], a[16:19], v[84:87], v[48:51]
    v_mfma_f32_16x16x32_bf16 v[44:47], a[12:15], v[84:87], v[44:47]
    v_mfma_f32_16x16x32_bf16 v[44:47], a[24:27], v[88:91], v[44:47]
    v_mfma_f32_16x16x32_bf16 v[48:51], a[28:31], v[88:91], v[48:51]
    v_mfma_f32_16x16x32_bf16 v[52:55], a[32:35], v[88:91], v[52:55]
    v_mfma_f32_16x16x32_bf16 v[44:47], a[36:39], v[92:95], v[44:47]
    v_mfma_f32_16x16x32_bf16 v[48:51], a[40:43], v[92:95], v[48:51]
    v_mfma_f32_16x16x32_bf16 v[52:55], a[44:47], v[92:95], v[52:55]
    v_mfma_f32_16x16x32_bf16 v[52:55], a[56:59], v[96:99], v[52:55]
    v_mfma_f32_16x16x32_bf16 v[48:51], a[52:55], v[96:99], v[48:51]
    v_mfma_f32_16x16x32_bf16 v[44:47], a[48:51], v[96:99], v[44:47]
    v_cvt_pk_bf16_f32 v32, v56, v57
    v_cvt_pk_bf16_f32 v33, v58, v59
    v_mfma_f32_16x16x32_bf16 v[44:47], a[60:63], v[100:103], v[44:47]
    v_cvt_pk_bf16_f32 v34, v60, v61
    v_cvt_pk_bf16_f32 v35, v62, v63
    v_mfma_f32_16x16x32_bf16 v[48:51], a[64:67], v[100:103], v[48:51]
    v_cvt_pk_bf16_f32 v36, v64, v65
    v_cvt_pk_bf16_f32 v37, v66, v67
    v_mfma_f32_16x16x32_bf16 v[52:55], a[68:71], v[100:103], v[52:55]
    v_permlane16_swap_b32 v32, v34
    v_permlane16_swap_b32 v33, v35
    v_mfma_f32_16x16x32_bf16 v[44:47], a[72:75], v[104:107], v[44:47]
    ds_write_b64 v10, v[36:37] offset:1152
    v_mfma_f32_16x16x32_bf16 v[48:51], a[76:79], v[104:107], v[48:51]
    buffer_store_dwordx4 v[32:35], v9, s[16:19], s31 offen sc1
    s_add_u32 s31, s31, 43008
    v_mfma_f32_16x16x32_bf16 v[52:55], a[80:83], v[104:107], v[52:55]
    v_mfma_f32_16x16x32_bf16 v[52:55], a[92:95], v[108:111], v[52:55]
    v_mfma_f32_16x16x32_bf16 v[48:51], a[88:91], v[108:111], v[48:51]
    v_mfma_f32_16x16x32_bf16 v[44:47], a[84:87], v[108:111], v[44:47]
    v_mfma_f32_16x16x32_bf16 v[44:47], a[96:99], v[112:115], v[44:47]
    v_mfma_f32_16x16x32_bf16 v[48:51], a[100:103], v[112:115], v[48:51]
    v_mfma_f32_16x16x32_bf16 v[52:55], a[104:107], v[112:115], v[52:55]
    v_mfma_f32_16x16x32_bf16 v[44:47], a[108:111], v[116:119], v[44:47]
    v_mfma_f32_16x16x32_bf16 v[48:51], a[112:115], v[116:119], v[48:51]
    v_mfma_f32_16x16x32_bf16 v[52:55], a[116:119], v[116:119], v[52:55]
    v_mfma_f32_16x16x32_bf16 v[52:55], a[128:131], v[120:123], v[52:55]
    v_mfma_f32_16x16x32_bf16 v[48:51], a[124:127], v[120:123], v[48:51]
    v_mfma_f32_16x16x32_bf16 v[44:47], a[120:123], v[120:123], v[44:47]
    v_mfma_f32_16x16x32_bf16 v[44:47], a[132:135], v[124:127], v[44:47]
    v_mfma_f32_16x16x32_bf16 v[48:51], a[136:139], v[124:127], v[48:51]
    v_mfma_f32_16x16x32_bf16 v[52:55], a[140:143], v[124:127], v[52:55]
    v_mfma_f32_16x16x32_bf16 v[44:47], a[144:147], v[128:131], v[44:47]
    v_mfma_f32_16x16x32_bf16 v[48:51], a[148:151], v[128:131], v[48:51]
    v_mfma_f32_16x16x32_bf16 v[52:55], a[152:155], v[128:131], v[52:55]
    s_waitcnt vmcnt(10)
    s_waitcnt lgkmcnt(0)
    s_barrier
    v_mfma_f32_16x16x32_bf16 v[52:55], a[164:167], v[132:135], v[52:55]
    ds_read_b128 v[152:155], v1 offset:20480
    v_mfma_f32_16x16x32_bf16 v[48:51], a[160:163], v[132:135], v[48:51]
    ds_read_b128 v[156:159], v1 offset:20544
    v_mfma_f32_16x16x32_bf16 v[44:47], a[156:159], v[132:135], v[44:47]
    ds_read_b128 v[160:163], v1 offset:20608
    v_mfma_f32_16x16x32_bf16 v[44:47], a[168:171], v[136:139], v[44:47]
    ds_read_b128 v[164:167], v2 offset:20480
    v_mfma_f32_16x16x32_bf16 v[48:51], a[172:175], v[136:139], v[48:51]
    ds_read_b128 v[168:171], v2 offset:20544
    v_mfma_f32_16x16x32_bf16 v[52:55], a[176:179], v[136:139], v[52:55]
    ds_read_b128 v[172:175], v2 offset:20608
    v_mfma_f32_16x16x32_bf16 v[44:47], a[180:183], v[140:143], v[44:47]
    ds_read_b128 v[176:179], v3 offset:20480
    v_mfma_f32_16x16x32_bf16 v[48:51], a[184:187], v[140:143], v[48:51]
    ds_read_b128 v[180:183], v3 offset:20544
    v_mfma_f32_16x16x32_bf16 v[52:55], a[188:191], v[140:143], v[52:55]
    ds_read_b128 v[184:187], v3 offset:20608
    v_mfma_f32_16x16x32_bf16 v[52:55], a[200:203], v[144:147], v[52:55]
    ds_read_b64 v[38:39], v4 offset:0
    v_mfma_f32_16x16x32_bf16 v[48:51], a[196:199], v[144:147], v[48:51]
    ds_read_b64 v[40:41], v4 offset:1152
    v_mfma_f32_16x16x32_bf16 v[44:47], a[192:195], v[144:147], v[44:47]
    v_mfma_f32_16x16x32_bf16 v[44:47], a[204:207], v[148:151], v[44:47]
    v_mfma_f32_16x16x32_bf16 v[48:51], a[208:211], v[148:151], v[48:51]
    v_mfma_f32_16x16x32_bf16 v[52:55], a[212:215], v[148:151], v[52:55]
    s_waitcnt lgkmcnt(7)
    v_mfma_f32_16x16x32_bf16 v[44:47], a[216:219], v[152:155], v[44:47]
    v_mfma_f32_16x16x32_bf16 v[48:51], a[220:223], v[152:155], v[48:51]
    v_mfma_f32_16x16x32_bf16 v[52:55], a[224:227], v[152:155], v[52:55]
    v_mfma_f32_16x16x32_bf16 v[52:55], a[236:239], v[156:159], v[52:55]
    s_waitcnt lgkmcnt(1)
    buffer_store_dwordx2 v[38:39], v5, s[16:19], s46 offen sc1
    s_add_u32 s46, s46, 43008
    v_mfma_f32_16x16x32_bf16 v[48:51], a[232:235], v[156:159], v[48:51]
    v_mfma_f32_16x16x32_bf16 v[44:47], a[228:231], v[156:159], v[44:47]
    v_mfma_f32_16x16x32_bf16 v[44:47], a[240:243], v[160:163], v[44:47]
    v_mfma_f32_16x16x32_bf16 v[48:51], a[244:247], v[160:163], v[48:51]
    v_mfma_f32_16x16x32_bf16 v[52:55], a[248:251], v[160:163], v[52:55]
    v_mfma_f32_16x16x32_bf16 v[44:47], a[252:255], v[164:167], v[44:47]
    v_mfma_f32_16x16x32_bf16 v[48:51], v[188:191], v[164:167], v[48:51]
    s_waitcnt lgkmcnt(0)
    buffer_store_dwordx2 v[40:41], v5, s[16:19], s46 offen sc1
    s_add_u32 s46, s46, 43008
    v_mfma_f32_16x16x32_bf16 v[52:55], v[192:195], v[164:167], v[52:55]
    v_mfma_f32_16x16x32_bf16 v[52:55], v[204:207], v[168:171], v[52:55]
    v_cvt_pk_bf16_f32 v32, v68, v69
    v_cvt_pk_bf16_f32 v33, v70, v71
    v_mfma_f32_16x16x32_bf16 v[48:51], v[200:203], v[168:171], v[48:51]
    v_cvt_pk_bf16_f32 v34, v72, v73
    v_cvt_pk_bf16_f32 v35, v74, v75
    v_mfma_f32_16x16x32_bf16 v[44:47], v[196:199], v[168:171], v[44:47]
    v_cvt_pk_bf16_f32 v36, v76, v77
    v_cvt_pk_bf16_f32 v37, v78, v79
    v_mfma_f32_16x16x32_bf16 v[44:47], v[208:211], v[172:175], v[44:47]
    v_permlane16_swap_b32 v32, v34
    v_permlane16_swap_b32 v33, v35
    v_mfma_f32_16x16x32_bf16 v[48:51], v[212:215], v[172:175], v[48:51]
    ds_write_b64 v10, v[36:37] offset:2304
    v_mfma_f32_16x16x32_bf16 v[52:55], v[216:219], v[172:175], v[52:55]
    buffer_store_dwordx4 v[32:35], v9, s[16:19], s31 offen sc1
    s_add_u32 s31, s31, 43008
    v_mfma_f32_16x16x32_bf16 v[44:47], v[220:223], v[176:179], v[44:47]
    v_mfma_f32_16x16x32_bf16 v[48:51], v[224:227], v[176:179], v[48:51]
    v_mfma_f32_16x16x32_bf16 v[52:55], v[228:231], v[176:179], v[52:55]
    v_mfma_f32_16x16x32_bf16 v[52:55], v[240:243], v[180:183], v[52:55]
    v_mfma_f32_16x16x32_bf16 v[48:51], v[236:239], v[180:183], v[48:51]
    v_mfma_f32_16x16x32_bf16 v[44:47], v[232:235], v[180:183], v[44:47]
    v_mfma_f32_16x16x32_bf16 v[44:47], v[244:247], v[184:187], v[44:47]
    v_mfma_f32_16x16x32_bf16 v[48:51], v[248:251], v[184:187], v[48:51]
    v_mfma_f32_16x16x32_bf16 v[52:55], v[252:255], v[184:187], v[52:55]
    v_mfma_f32_16x16x32_bf16 v[56:59], a[0:3], v[116:119], 0
    v_mfma_f32_16x16x32_bf16 v[60:63], a[4:7], v[116:119], 0
    v_mfma_f32_16x16x32_bf16 v[64:67], a[8:11], v[116:119], 0
    v_mfma_f32_16x16x32_bf16 v[64:67], a[20:23], v[120:123], v[64:67]
    v_mfma_f32_16x16x32_bf16 v[60:63], a[16:19], v[120:123], v[60:63]
    v_mfma_f32_16x16x32_bf16 v[56:59], a[12:15], v[120:123], v[56:59]
    v_mfma_f32_16x16x32_bf16 v[56:59], a[24:27], v[124:127], v[56:59]
    v_mfma_f32_16x16x32_bf16 v[60:63], a[28:31], v[124:127], v[60:63]
    v_mfma_f32_16x16x32_bf16 v[64:67], a[32:35], v[124:127], v[64:67]
    v_mfma_f32_16x16x32_bf16 v[56:59], a[36:39], v[128:131], v[56:59]
    v_mfma_f32_16x16x32_bf16 v[60:63], a[40:43], v[128:131], v[60:63]
    v_mfma_f32_16x16x32_bf16 v[64:67], a[44:47], v[128:131], v[64:67]
    v_mfma_f32_16x16x32_bf16 v[64:67], a[56:59], v[132:135], v[64:67]
    v_cvt_pk_bf16_f32 v32, v44, v45
    v_cvt_pk_bf16_f32 v33, v46, v47
    v_mfma_f32_16x16x32_bf16 v[60:63], a[52:55], v[132:135], v[60:63]
    v_cvt_pk_bf16_f32 v34, v48, v49
    v_cvt_pk_bf16_f32 v35, v50, v51
    v_mfma_f32_16x16x32_bf16 v[56:59], a[48:51], v[132:135], v[56:59]
    v_cvt_pk_bf16_f32 v36, v52, v53
    v_cvt_pk_bf16_f32 v37, v54, v55
    v_mfma_f32_16x16x32_bf16 v[56:59], a[60:63], v[136:139], v[56:59]
    v_permlane16_swap_b32 v32, v34
    v_permlane16_swap_b32 v33, v35
    v_mfma_f32_16x16x32_bf16 v[60:63], a[64:67], v[136:139], v[60:63]
    ds_write_b64 v10, v[36:37] offset:3456
    v_mfma_f32_16x16x32_bf16 v[64:67], a[68:71], v[136:139], v[64:67]
    buffer_store_dwordx4 v[32:35], v9, s[16:19], s31 offen sc1
    s_add_u32 s31, s31, 43008
    v_mfma_f32_16x16x32_bf16 v[56:59], a[72:75], v[140:143], v[56:59]
    v_mfma_f32_16x16x32_bf16 v[60:63], a[76:79], v[140:143], v[60:63]
    v_mfma_f32_16x16x32_bf16 v[64:67], a[80:83], v[140:143], v[64:67]
    v_mfma_f32_16x16x32_bf16 v[64:67], a[92:95], v[144:147], v[64:67]
    v_mfma_f32_16x16x32_bf16 v[60:63], a[88:91], v[144:147], v[60:63]
    v_mfma_f32_16x16x32_bf16 v[56:59], a[84:87], v[144:147], v[56:59]
    v_mfma_f32_16x16x32_bf16 v[56:59], a[96:99], v[148:151], v[56:59]
    v_mfma_f32_16x16x32_bf16 v[60:63], a[100:103], v[148:151], v[60:63]
    v_mfma_f32_16x16x32_bf16 v[64:67], a[104:107], v[148:151], v[64:67]
    v_mfma_f32_16x16x32_bf16 v[56:59], a[108:111], v[152:155], v[56:59]
    v_mfma_f32_16x16x32_bf16 v[60:63], a[112:115], v[152:155], v[60:63]
    v_mfma_f32_16x16x32_bf16 v[64:67], a[116:119], v[152:155], v[64:67]
    v_mfma_f32_16x16x32_bf16 v[64:67], a[128:131], v[156:159], v[64:67]
    v_mfma_f32_16x16x32_bf16 v[60:63], a[124:127], v[156:159], v[60:63]
    v_mfma_f32_16x16x32_bf16 v[56:59], a[120:123], v[156:159], v[56:59]
    v_mfma_f32_16x16x32_bf16 v[56:59], a[132:135], v[160:163], v[56:59]
    s_branch L_N2_s1
L_N2_t1:
    s_setpc_b64 s[78:79]
L_N2_s1:
    v_mfma_f32_16x16x32_bf16 v[60:63], a[136:139], v[160:163], v[60:63]
    v_mfma_f32_16x16x32_bf16 v[64:67], a[140:143], v[160:163], v[64:67]
    v_mfma_f32_16x16x32_bf16 v[56:59], a[144:147], v[164:167], v[56:59]
    s_waitcnt vmcnt(10)
    s_waitcnt lgkmcnt(0)
    s_barrier
    v_mfma_f32_16x16x32_bf16 v[60:63], a[148:151], v[164:167], v[60:63]
    ds_read_b128 v[80:83], v1 offset:24576
    v_mfma_f32_16x16x32_bf16 v[64:67], a[152:155], v[164:167], v[64:67]
    ds_read_b128 v[84:87], v1 offset:24640
    v_mfma_f32_16x16x32_bf16 v[64:67], a[164:167], v[168:171], v[64:67]
    ds_read_b128 v[88:91], v1 offset:24704
    v_mfma_f32_16x16x32_bf16 v[60:63], a[160:163], v[168:171], v[60:63]
    ds_read_b128 v[92:95], v2 offset:24576
    v_mfma_f32_16x16x32_bf16 v[56:59], a[156:159], v[168:171], v[56:59]
    ds_read_b128 v[96:99], v2 offset:24640
    v_mfma_f32_16x16x32_bf16 v[56:59], a[168:171], v[172:175], v[56:59]
    ds_read_b128 v[100:103], v2 offset:24704
    v_mfma_f32_16x16x32_bf16 v[60:63], a[172:175], v[172:175], v[60:63]
    ds_read_b128 v[104:107], v3 offset:24576
    v_mfma_f32_16x16x32_bf16 v[64:67], a[176:179], v[172:175], v[64:67]
    ds_read_b128 v[108:111], v3 offset:24640
    v_mfma_f32_16x16x32_bf16 v[56:59], a[180:183], v[176:179], v[56:59]
    ds_read_b128 v[112:115], v3 offset:24704
    v_mfma_f32_16x16x32_bf16 v[60:63], a[184:187], v[176:179], v[60:63]
    ds_read_b64 v[38:39], v4 offset:2304
    v_mfma_f32_16x16x32_bf16 v[64:67], a[188:191], v[176:179], v[64:67]
    ds_read_b64 v[40:41], v4 offset:3456
    v_mfma_f32_16x16x32_bf16 v[64:67], a[200:203], v[180:183], v[64:67]
    v_mfma_f32_16x16x32_bf16 v[60:63], a[196:199], v[180:183], v[60:63]
    v_mfma_f32_16x16x32_bf16 v[56:59], a[192:195], v[180:183], v[56:59]
    v_mfma_f32_16x16x32_bf16 v[56:59], a[204:207], v[184:187], v[56:59]
    v_mfma_f32_16x16x32_bf16 v[60:63], a[208:211], v[184:187], v[60:63]
    v_mfma_f32_16x16x32_bf16 v[64:67], a[212:215], v[184:187], v[64:67]
    s_waitcnt lgkmcnt(7)
    v_mfma_f32_16x16x32_bf16 v[56:59], a[216:219], v[80:83], v[56:59]
    v_mfma_f32_16x16x32_bf16 v[60:63], a[220:223], v[80:83], v[60:63]
    s_waitcnt lgkmcnt(1)
    buffer_store_dwordx2 v[38:39], v5, s[16:19], s46 offen sc1
    s_add_u32 s46, s46, 43008
    v_mfma_f32_16x16x32_bf16 v[64:67], a[224:227], v[80:83], v[64:67]
    v_mfma_f32_16x16x32_bf16 v[64:67], a[236:239], v[84:87], v[64:67]
    v_mfma_f32_16x16x32_bf16 v[60:63], a[232:235], v[84:87], v[60:63]
    v_mfma_f32_16x16x32_bf16 v[56:59], a[228:231], v[84:87], v[56:59]
    v_mfma_f32_16x16x32_bf16 v[56:59], a[240:243], v[88:91], v[56:59]
    v_mfma_f32_16x16x32_bf16 v[60:63], a[244:247], v[88:91], v[60:63]
    v_mfma_f32_16x16x32_bf16 v[64:67], a[248:251], v[88:91], v[64:67]
    s_waitcnt lgkmcnt(0)
    buffer_store_dwordx2 v[40:41], v5, s[16:19], s46 offen sc1
    s_add_u32 s46, s46, 43008
    v_mfma_f32_16x16x32_bf16 v[56:59], a[252:255], v[92:95], v[56:59]
    v_mfma_f32_16x16x32_bf16 v[60:63], v[188:191], v[92:95], v[60:63]
    v_mfma_f32_16x16x32_bf16 v[64:67], v[192:195], v[92:95], v[64:67]
    v_mfma_f32_16x16x32_bf16 v[64:67], v[204:207], v[96:99], v[64:67]
    v_mfma_f32_16x16x32_bf16 v[60:63], v[200:203], v[96:99], v[60:63]
    v_mfma_f32_16x16x32_bf16 v[56:59], v[196:199], v[96:99], v[56:59]
    v_mfma_f32_16x16x32_bf16 v[56:59], v[208:211], v[100:103], v[56:59]
    v_mfma_f32_16x16x32_bf16 v[60:63], v[212:215], v[100:103], v[60:63]
    v_mfma_f32_16x16x32_bf16 v[64:67], v[216:219], v[100:103], v[64:67]
    v_mfma_f32_16x16x32_bf16 v[56:59], v[220:223], v[104:107], v[56:59]
    v_mfma_f32_16x16x32_bf16 v[60:63], v[224:227], v[104:107], v[60:63]
    v_mfma_f32_16x16x32_bf16 v[64:67], v[228:231], v[104:107], v[64:67]
    v_mfma_f32_16x16x32_bf16 v[64:67], v[240:243], v[108:111], v[64:67]
    v_mfma_f32_16x16x32_bf16 v[60:63], v[236:239], v[108:111], v[60:63]
    v_mfma_f32_16x16x32_bf16 v[56:59], v[232:235], v[108:111], v[56:59]
    v_mfma_f32_16x16x32_bf16 v[56:59], v[244:247], v[112:115], v[56:59]
    v_mfma_f32_16x16x32_bf16 v[60:63], v[248:251], v[112:115], v[60:63]
    v_mfma_f32_16x16x32_bf16 v[64:67], v[252:255], v[112:115], v[64:67]
    v_mfma_f32_16x16x32_bf16 v[68:71], a[0:3], v[152:155], 0
    v_mfma_f32_16x16x32_bf16 v[72:75], a[4:7], v[152:155], 0
    v_mfma_f32_16x16x32_bf16 v[76:79], a[8:11], v[152:155], 0
    v_mfma_f32_16x16x32_bf16 v[76:79], a[20:23], v[156:159], v[76:79]
    v_mfma_f32_16x16x32_bf16 v[72:75], a[16:19], v[156:159], v[72:75]
    v_mfma_f32_16x16x32_bf16 v[68:71], a[12:15], v[156:159], v[68:71]
    v_mfma_f32_16x16x32_bf16 v[68:71], a[24:27], v[160:163], v[68:71]
    v_cvt_pk_bf16_f32 v32, v56, v57
    v_cvt_pk_bf16_f32 v33, v58, v59
    v_mfma_f32_16x16x32_bf16 v[72:75], a[28:31], v[160:163], v[72:75]
    v_cvt_pk_bf16_f32 v34, v60, v61
    v_cvt_pk_bf16_f32 v35, v62, v63
    v_mfma_f32_16x16x32_bf16 v[76:79], a[32:35], v[160:163], v[76:79]
    v_cvt_pk_bf16_f32 v36, v64, v65
    v_cvt_pk_bf16_f32 v37, v66, v67
    v_mfma_f32_16x16x32_bf16 v[68:71], a[36:39], v[164:167], v[68:71]
    v_permlane16_swap_b32 v32, v34
    v_permlane16_swap_b32 v33, v35
    v_mfma_f32_16x16x32_bf16 v[72:75], a[40:43], v[164:167], v[72:75]
    ds_write_b64 v10, v[36:37] offset:4608
    v_mfma_f32_16x16x32_bf16 v[76:79], a[44:47], v[164:167], v[76:79]
    buffer_store_dwordx4 v[32:35], v9, s[16:19], s31 offen sc1
    s_add_u32 s31, s31, 43008
    v_mfma_f32_16x16x32_bf16 v[76:79], a[56:59], v[168:171], v[76:79]
    v_mfma_f32_16x16x32_bf16 v[72:75], a[52:55], v[168:171], v[72:75]
    v_mfma_f32_16x16x32_bf16 v[68:71], a[48:51], v[168:171], v[68:71]
    v_mfma_f32_16x16x32_bf16 v[68:71], a[60:63], v[172:175], v[68:71]
    v_mfma_f32_16x16x32_bf16 v[72:75], a[64:67], v[172:175], v[72:75]
    v_mfma_f32_16x16x32_bf16 v[76:79], a[68:71], v[172:175], v[76:79]
    v_mfma_f32_16x16x32_bf16 v[68:71], a[72:75], v[176:179], v[68:71]
    v_mfma_f32_16x16x32_bf16 v[72:75], a[76:79], v[176:179], v[72:75]
    v_mfma_f32_16x16x32_bf16 v[76:79], a[80:83], v[176:179], v[76:79]
    v_mfma_f32_16x16x32_bf16 v[76:79], a[92:95], v[180:183], v[76:79]
    v_mfma_f32_16x16x32_bf16 v[72:75], a[88:91], v[180:183], v[72:75]
    ds_read_b128 v[116:119], v1 offset:28672
    v_mfma_f32_16x16x32_bf16 v[68:71], a[84:87], v[180:183], v[68:71]
    ds_read_b128 v[120:123], v1 offset:28736
    v_mfma_f32_16x16x32_bf16 v[68:71], a[96:99], v[184:187], v[68:71]
    ds_read_b128 v[124:127], v1 offset:28800
    v_mfma_f32_16x16x32_bf16 v[72:75], a[100:103], v[184:187], v[72:75]
    ds_read_b128 v[128:131], v2 offset:28672
    v_mfma_f32_16x16x32_bf16 v[76:79], a[104:107], v[184:187], v[76:79]
    ds_read_b128 v[132:135], v2 offset:28736
    v_mfma_f32_16x16x32_bf16 v[68:71], a[108:111], v[80:83], v[68:71]
    ds_read_b128 v[136:139], v2 offset:28800
    v_mfma_f32_16x16x32_bf16 v[72:75], a[112:115], v[80:83], v[72:75]
    ds_read_b128 v[140:143], v3 offset:28672
    v_mfma_f32_16x16x32_bf16 v[76:79], a[116:119], v[80:83], v[76:79]
    ds_read_b128 v[144:147], v3 offset:28736
    v_mfma_f32_16x16x32_bf16 v[76:79], a[128:131], v[84:87], v[76:79]
    ds_read_b128 v[148:151], v3 offset:28800
    v_mfma_f32_16x16x32_bf16 v[72:75], a[124:127], v[84:87], v[72:75]
    s_mov_b32 s47, 0x7fff7fff
    s_waitcnt vmcnt(12)
    v_and_b32 v15, s47, v16
    v_mfma_f32_16x16x32_bf16 v[68:71], a[120:123], v[84:87], v[68:71]
    v_and_b32 v0, s47, v17
    v_pk_max_u16 v12, v15, s35
    v_mfma_f32_16x16x32_bf16 v[68:71], a[132:135], v[88:91], v[68:71]
    v_pk_max_u16 v13, v0, s35
    v_and_b32 v15, s47, v18
    v_mfma_f32_16x16x32_bf16 v[72:75], a[136:139], v[88:91], v[72:75]
    v_and_b32 v0, s47, v19
    v_pk_max_u16 v12, v15, v12
    v_mfma_f32_16x16x32_bf16 v[76:79], a[140:143], v[88:91], v[76:79]
    v_pk_max_u16 v13, v0, v13
    s_waitcnt vmcnt(11)
    v_and_b32 v15, s47, v20
    v_mfma_f32_16x16x32_bf16 v[68:71], a[144:147], v[92:95], v[68:71]
    v_and_b32 v0, s47, v21
    v_pk_max_u16 v12, v15, v12
    v_mfma_f32_16x16x32_bf16 v[72:75], a[148:151], v[92:95], v[72:75]
    v_pk_max_u16 v13, v0, v13
    v_and_b32 v15, s47, v22
    v_mfma_f32_16x16x32_bf16 v[76:79], a[152:155], v[92:95], v[76:79]
    v_and_b32 v0, s47, v23
    v_pk_max_u16 v12, v15, v12
    v_mfma_f32_16x16x32_bf16 v[76:79], a[164:167], v[96:99], v[76:79]
    v_pk_max_u16 v13, v0, v13
    s_waitcnt vmcnt(10)
    v_and_b32 v15, s47, v24
    v_mfma_f32_16x16x32_bf16 v[72:75], a[160:163], v[96:99], v[72:75]
    v_and_b32 v0, s47, v25
    v_pk_max_u16 v12, v15, v12
    v_mfma_f32_16x16x32_bf16 v[68:71], a[156:159], v[96:99], v[68:71]
    v_pk_max_u16 v13, v0, v13
    v_and_b32 v15, s47, v26
    v_mfma_f32_16x16x32_bf16 v[68:71], a[168:171], v[100:103], v[68:71]
    v_and_b32 v0, s47, v27
    v_pk_max_u16 v12, v15, v12
    v_mfma_f32_16x16x32_bf16 v[72:75], a[172:175], v[100:103], v[72:75]
    v_pk_max_u16 v13, v0, v13
    s_waitcnt vmcnt(9)
    v_and_b32 v15, s47, v28
    v_mfma_f32_16x16x32_bf16 v[76:79], a[176:179], v[100:103], v[76:79]
    v_and_b32 v0, s47, v29
    v_pk_max_u16 v12, v15, v12
    v_mfma_f32_16x16x32_bf16 v[68:71], a[180:183], v[104:107], v[68:71]
    v_pk_max_u16 v13, v0, v13
    v_and_b32 v15, s47, v30
    v_mfma_f32_16x16x32_bf16 v[72:75], a[184:187], v[104:107], v[72:75]
    v_and_b32 v0, s47, v31
    v_pk_max_u16 v12, v15, v12
    v_mfma_f32_16x16x32_bf16 v[76:79], a[188:191], v[104:107], v[76:79]
    v_pk_max_u16 v13, v0, v13
    v_pk_max_u16 v12, v12, v13
    v_mfma_f32_16x16x32_bf16 v[76:79], a[200:203], v[108:111], v[76:79]
    v_cmp_ne_u32 vcc, s35, v12
    v_mfma_f32_16x16x32_bf16 v[72:75], a[196:199], v[108:111], v[72:75]
    v_mfma_f32_16x16x32_bf16 v[68:71], a[192:195], v[108:111], v[68:71]
    v_mfma_f32_16x16x32_bf16 v[68:71], a[204:207], v[112:115], v[68:71]
    v_mfma_f32_16x16x32_bf16 v[72:75], a[208:211], v[112:115], v[72:75]
    v_mfma_f32_16x16x32_bf16 v[76:79], a[212:215], v[112:115], v[76:79]
    s_waitcnt lgkmcnt(7)
    v_mfma_f32_16x16x32_bf16 v[68:71], a[216:219], v[116:119], v[68:71]
    v_mfma_f32_16x16x32_bf16 v[72:75], a[220:223], v[116:119], v[72:75]
    v_mfma_f32_16x16x32_bf16 v[76:79], a[224:227], v[116:119], v[76:79]
    v_mfma_f32_16x16x32_bf16 v[76:79], a[236:239], v[120:123], v[76:79]
    v_mfma_f32_16x16x32_bf16 v[72:75], a[232:235], v[120:123], v[72:75]
    v_mfma_f32_16x16x32_bf16 v[68:71], a[228:231], v[120:123], v[68:71]
    s_waitcnt lgkmcnt(6)
    v_mfma_f32_16x16x32_bf16 v[68:71], a[240:243], v[124:127], v[68:71]
    v_mfma_f32_16x16x32_bf16 v[72:75], a[244:247], v[124:127], v[72:75]
    v_mfma_f32_16x16x32_bf16 v[76:79], a[248:251], v[124:127], v[76:79]
    s_waitcnt lgkmcnt(5)
    v_mfma_f32_16x16x32_bf16 v[68:71], a[252:255], v[128:131], v[68:71]
    v_mfma_f32_16x16x32_bf16 v[72:75], v[188:191], v[128:131], v[72:75]
    v_mfma_f32_16x16x32_bf16 v[76:79], v[192:195], v[128:131], v[76:79]
    s_waitcnt lgkmcnt(4)
    v_mfma_f32_16x16x32_bf16 v[76:79], v[204:207], v[132:135], v[76:79]
    v_mfma_f32_16x16x32_bf16 v[72:75], v[200:203], v[132:135], v[72:75]
    v_mfma_f32_16x16x32_bf16 v[68:71], v[196:199], v[132:135], v[68:71]
    s_waitcnt lgkmcnt(3)
    v_mfma_f32_16x16x32_bf16 v[68:71], v[208:211], v[136:139], v[68:71]
    v_mfma_f32_16x16x32_bf16 v[72:75], v[212:215], v[136:139], v[72:75]
    v_mfma_f32_16x16x32_bf16 v[76:79], v[216:219], v[136:139], v[76:79]
    s_waitcnt lgkmcnt(2)
    v_mfma_f32_16x16x32_bf16 v[68:71], v[220:223], v[140:143], v[68:71]
    v_mfma_f32_16x16x32_bf16 v[72:75], v[224:227], v[140:143], v[72:75]
    v_mfma_f32_16x16x32_bf16 v[76:79], v[228:231], v[140:143], v[76:79]
    s_waitcnt lgkmcnt(1)
    v_mfma_f32_16x16x32_bf16 v[76:79], v[240:243], v[144:147], v[76:79]
    v_mfma_f32_16x16x32_bf16 v[72:75], v[236:239], v[144:147], v[72:75]
    v_mfma_f32_16x16x32_bf16 v[68:71], v[232:235], v[144:147], v[68:71]
    s_waitcnt lgkmcnt(0)
    v_mfma_f32_16x16x32_bf16 v[68:71], v[244:247], v[148:151], v[68:71]
    v_mfma_f32_16x16x32_bf16 v[72:75], v[248:251], v[148:151], v[72:75]
    v_mfma_f32_16x16x32_bf16 v[76:79], v[252:255], v[148:151], v[76:79]
    v_mfma_f32_16x16x32_bf16 v[44:47], a[0:3], v[80:83], 0
    v_mfma_f32_16x16x32_bf16 v[48:51], a[4:7], v[80:83], 0
    v_mfma_f32_16x16x32_bf16 v[52:55], a[8:11], v[80:83], 0
    v_mfma_f32_16x16x32_bf16 v[52:55], a[20:23], v[84:87], v[52:55]
    v_mfma_f32_16x16x32_bf16 v[48:51], a[16:19], v[84:87], v[48:51]
    v_mfma_f32_16x16x32_bf16 v[44:47], a[12:15], v[84:87], v[44:47]
    v_mfma_f32_16x16x32_bf16 v[44:47], a[24:27], v[88:91], v[44:47]
    v_cvt_pk_bf16_f32 v32, v68, v69
    v_cvt_pk_bf16_f32 v33, v70, v71
    v_mfma_f32_16x16x32_bf16 v[48:51], a[28:31], v[88:91], v[48:51]
    v_cvt_pk_bf16_f32 v34, v72, v73
    v_cvt_pk_bf16_f32 v35, v74, v75
    v_mfma_f32_16x16x32_bf16 v[52:55], a[32:35], v[88:91], v[52:55]
    v_cvt_pk_bf16_f32 v36, v76, v77
    v_cvt_pk_bf16_f32 v37, v78, v79
    v_mfma_f32_16x16x32_bf16 v[44:47], a[36:39], v[92:95], v[44:47]
    v_permlane16_swap_b32 v32, v34
    v_permlane16_swap_b32 v33, v35
    v_mfma_f32_16x16x32_bf16 v[48:51], a[40:43], v[92:95], v[48:51]
    ds_write_b64 v10, v[36:37] offset:5760
    v_mfma_f32_16x16x32_bf16 v[52:55], a[44:47], v[92:95], v[52:55]
    buffer_store_dwordx4 v[32:35], v9, s[16:19], s31 offen sc1
    s_add_u32 s31, s31, 43008
    v_mfma_f32_16x16x32_bf16 v[52:55], a[56:59], v[96:99], v[52:55]
    v_mfma_f32_16x16x32_bf16 v[48:51], a[52:55], v[96:99], v[48:51]
    v_mfma_f32_16x16x32_bf16 v[44:47], a[48:51], v[96:99], v[44:47]
    v_mfma_f32_16x16x32_bf16 v[44:47], a[60:63], v[100:103], v[44:47]
    v_mfma_f32_16x16x32_bf16 v[48:51], a[64:67], v[100:103], v[48:51]
    v_mfma_f32_16x16x32_bf16 v[52:55], a[68:71], v[100:103], v[52:55]
    v_mfma_f32_16x16x32_bf16 v[44:47], a[72:75], v[104:107], v[44:47]
    v_mfma_f32_16x16x32_bf16 v[48:51], a[76:79], v[104:107], v[48:51]
    v_mfma_f32_16x16x32_bf16 v[52:55], a[80:83], v[104:107], v[52:55]
    v_mfma_f32_16x16x32_bf16 v[52:55], a[92:95], v[108:111], v[52:55]
    v_mfma_f32_16x16x32_bf16 v[48:51], a[88:91], v[108:111], v[48:51]
    ds_read_b128 v[152:155], v1 offset:32768
    v_mfma_f32_16x16x32_bf16 v[44:47], a[84:87], v[108:111], v[44:47]
    ds_read_b128 v[156:159], v1 offset:32832
    v_mfma_f32_16x16x32_bf16 v[44:47], a[96:99], v[112:115], v[44:47]
    ds_read_b128 v[160:163], v1 offset:32896
    v_mfma_f32_16x16x32_bf16 v[48:51], a[100:103], v[112:115], v[48:51]
    ds_read_b128 v[164:167], v2 offset:32768
    v_mfma_f32_16x16x32_bf16 v[52:55], a[104:107], v[112:115], v[52:55]
    ds_read_b128 v[168:171], v2 offset:32832
    v_mfma_f32_16x16x32_bf16 v[44:47], a[108:111], v[116:119], v[44:47]
    ds_read_b128 v[172:175], v2 offset:32896
    v_mfma_f32_16x16x32_bf16 v[48:51], a[112:115], v[116:119], v[48:51]
    ds_read_b128 v[176:179], v3 offset:32768
    v_mfma_f32_16x16x32_bf16 v[52:55], a[116:119], v[116:119], v[52:55]
    ds_read_b128 v[180:183], v3 offset:32832
    v_mfma_f32_16x16x32_bf16 v[52:55], a[128:131], v[120:123], v[52:55]
    ds_read_b128 v[184:187], v3 offset:32896
    v_mfma_f32_16x16x32_bf16 v[48:51], a[124:127], v[120:123], v[48:51]
    s_mul_i32 s47, s30, 6656
    v_lshrrev_b32 v26, 4, v6
    v_mfma_f32_16x16x32_bf16 v[44:47], a[120:123], v[120:123], v[44:47]
    s_add_u32 s47, s47, 81664
    v_mul_u32_u24 v27, 43, v26
    v_mfma_f32_16x16x32_bf16 v[44:47], a[132:135], v[124:127], v[44:47]
    v_add_u32 v28, 128, v26
    s_lshl_b32 s48, s29, 3
    v_mfma_f32_16x16x32_bf16 v[48:51], a[136:139], v[124:127], v[48:51]
    s_waitcnt lgkmcnt(9)
    s_barrier
    v_lshrrev_b32 v27, 9, v27
    v_mfma_f32_16x16x32_bf16 v[52:55], a[140:143], v[124:127], v[52:55]
    ds_read_b64 v[38:39], v4 offset:4608
    v_mfma_f32_16x16x32_bf16 v[44:47], a[144:147], v[128:131], v[44:47]
    ds_read_b64 v[40:41], v4 offset:5760
    v_mfma_f32_16x16x32_bf16 v[48:51], a[148:151], v[128:131], v[48:51]
    v_mul_u32_u24 v29, 2731, v28
    v_mad_i32_i24 v26, v27, -12, v26
    v_mfma_f32_16x16x32_bf16 v[52:55], a[152:155], v[128:131], v[52:55]
    v_lshrrev_b32 v29, 16, v29
    v_add_u32 v27, s48, v27
    v_mfma_f32_16x16x32_bf16 v[52:55], a[164:167], v[132:135], v[52:55]
    v_mul_u32_u24 v30, 24, v29
    v_mul_u32_u24 v22, 208, v27
    v_mfma_f32_16x16x32_bf16 v[48:51], a[160:163], v[132:135], v[48:51]
    v_sub_u32 v28, v28, v30
    v_add_u32 v29, s48, v29
    v_mfma_f32_16x16x32_bf16 v[44:47], a[156:159], v[132:135], v[44:47]
    v_mul_u32_u24 v24, 192, v27
    v_lshlrev_b32 v26, 4, v26
    v_mfma_f32_16x16x32_bf16 v[44:47], a[168:171], v[136:139], v[44:47]
    v_mul_u32_u24 v23, 208, v29
    v_mul_u32_u24 v25, 192, v29
    v_mfma_f32_16x16x32_bf16 v[48:51], a[172:175], v[136:139], v[48:51]
    v_lshlrev_b32 v28, 3, v28
    v_add3_u32 v22, v22, s47, v26
    v_mfma_f32_16x16x32_bf16 v[52:55], a[176:179], v[136:139], v[52:55]
    s_waitcnt lgkmcnt(1)
    buffer_store_dwordx2 v[38:39], v5, s[16:19], s46 offen sc1
    s_add_u32 s46, s46, 43008
    v_mfma_f32_16x16x32_bf16 v[44:47], a[180:183], v[140:143], v[44:47]
    v_add_u32 v24, v24, v26
    v_add3_u32 v23, v23, s47, v28
    v_mfma_f32_16x16x32_bf16 v[48:51], a[184:187], v[140:143], v[48:51]
    v_add_u32 v25, v25, v28
    v_bfe_u32 v26, v6, 4, 2
    v_mfma_f32_16x16x32_bf16 v[52:55], a[188:191], v[140:143], v[52:55]
    v_bfe_u32 v27, v6, 6, 2
    v_lshl_add_u32 v26, v26, 2, v27
    v_mfma_f32_16x16x32_bf16 v[52:55], a[200:203], v[144:147], v[52:55]
    v_lshrrev_b32 v27, 8, v6
    v_mul_u32_u24 v26, 208, v26
    v_mfma_f32_16x16x32_bf16 v[48:51], a[196:199], v[144:147], v[48:51]
    s_lshl4_add_u32 s49, s48, s47
    v_lshl_add_u32 v26, v27, 3, v26
    v_mfma_f32_16x16x32_bf16 v[44:47], a[192:195], v[144:147], v[44:47]
    s_lshl2_add_u32 s48, s48, s47
    v_add_u32 v20, s49, v26
    v_mfma_f32_16x16x32_bf16 v[44:47], a[204:207], v[148:151], v[44:47]
    s_waitcnt lgkmcnt(0)
    buffer_store_dwordx2 v[40:41], v5, s[16:19], s46 offen sc1
    s_add_u32 s46, s46, 43008
    v_mfma_f32_16x16x32_bf16 v[48:51], a[208:211], v[148:151], v[48:51]
    v_add_u32 v21, s48, v26
    v_mfma_f32_16x16x32_bf16 v[52:55], a[212:215], v[148:151], v[52:55]
    v_mfma_f32_16x16x32_bf16 v[44:47], a[216:219], v[152:155], v[44:47]
    v_mfma_f32_16x16x32_bf16 v[48:51], a[220:223], v[152:155], v[48:51]
    v_mfma_f32_16x16x32_bf16 v[52:55], a[224:227], v[152:155], v[52:55]
    v_mfma_f32_16x16x32_bf16 v[52:55], a[236:239], v[156:159], v[52:55]
    v_mfma_f32_16x16x32_bf16 v[48:51], a[232:235], v[156:159], v[48:51]
    v_mfma_f32_16x16x32_bf16 v[44:47], a[228:231], v[156:159], v[44:47]
    v_mfma_f32_16x16x32_bf16 v[44:47], a[240:243], v[160:163], v[44:47]
    v_mfma_f32_16x16x32_bf16 v[48:51], a[244:247], v[160:163], v[48:51]
    v_mfma_f32_16x16x32_bf16 v[52:55], a[248:251], v[160:163], v[52:55]
    v_mfma_f32_16x16x32_bf16 v[44:47], a[252:255], v[164:167], v[44:47]
    v_mfma_f32_16x16x32_bf16 v[44:47], v[196:199], v[168:171], v[44:47]
    v_mfma_f32_16x16x32_bf16 v[44:47], v[208:211], v[172:175], v[44:47]
    v_mfma_f32_16x16x32_bf16 v[44:47], v[220:223], v[176:179], v[44:47]
    v_mfma_f32_16x16x32_bf16 v[44:47], v[232:235], v[180:183], v[44:47]
    v_mfma_f32_16x16x32_bf16 v[44:47], v[244:247], v[184:187], v[44:47]
    v_mfma_f32_16x16x32_bf16 v[48:51], v[188:191], v[164:167], v[48:51]
    v_mfma_f32_16x16x32_bf16 v[48:51], v[200:203], v[168:171], v[48:51]
    v_mfma_f32_16x16x32_bf16 v[48:51], v[212:215], v[172:175], v[48:51]
    v_mfma_f32_16x16x32_bf16 v[48:51], v[224:227], v[176:179], v[48:51]
    v_mfma_f32_16x16x32_bf16 v[48:51], v[236:239], v[180:183], v[48:51]
    s_nop 2
    v_cvt_pk_bf16_f32 v32, v44, v45
    v_cvt_pk_bf16_f32 v33, v46, v47
    v_mfma_f32_16x16x32_bf16 v[48:51], v[248:251], v[184:187], v[48:51]
    ds_write_b64 v20, v[32:33] offset:0
    v_mfma_f32_16x16x32_bf16 v[52:55], v[192:195], v[164:167], v[52:55]
    v_mfma_f32_16x16x32_bf16 v[52:55], v[204:207], v[168:171], v[52:55]
    v_mfma_f32_16x16x32_bf16 v[52:55], v[216:219], v[172:175], v[52:55]
    v_mfma_f32_16x16x32_bf16 v[52:55], v[228:231], v[176:179], v[52:55]
    v_mfma_f32_16x16x32_bf16 v[52:55], v[240:243], v[180:183], v[52:55]
    s_nop 1
    v_cvt_pk_bf16_f32 v34, v48, v49
    v_cvt_pk_bf16_f32 v35, v50, v51
    v_mfma_f32_16x16x32_bf16 v[52:55], v[252:255], v[184:187], v[52:55]
    ds_write_b64 v20, v[34:35] offset:32
    s_nop 6
    v_cvt_pk_bf16_f32 v36, v52, v53
    v_cvt_pk_bf16_f32 v37, v54, v55
    ds_write_b64 v21, v[36:37] offset:64
    s_waitcnt lgkmcnt(0)
    s_barrier
    ds_read_b128 v[26:29], v22 offset:0
    ds_read_b64 v[30:31], v23 offset:0
    s_waitcnt lgkmcnt(1)
    buffer_store_dwordx4 v[26:29], v24, s[16:19], s31 offen sc1
    s_waitcnt lgkmcnt(0)
    buffer_store_dwordx2 v[30:31], v25, s[16:19], s31 offen sc1
    s_cbranch_vccnz L_gN
L_fin:
L_end:
    s_endpgm
.p2align 6
L_S:
    ds_write_b128 v104, v[100:103] offset:46592
    buffer_load_dwordx4 v7, s[12:15], s46 offen offset:1024 lds
    s_cmp_eq_u32 s56, 0
    s_mov_b32 s59, 0x01000c0c
    s_cselect_b32 s59, 0x03020c0c, s59
    s_cselect_b32 s49, 1.0, 0
    s_movk_i32 s36, 0x102
    s_cselect_b32 s36, 0x832, s36
    s_movk_i32 s37, 0x543
    ds_write_b128 v104, v[100:103] offset:47616
    s_cselect_b32 s37, 0x640, s37
    s_movk_i32 s38, 0x768
    s_cselect_b32 s38, 0x751, s38
    s_lshl_b32 s42, s56, 4
    v_mad_u32_u24 v180, v39, s56, v40
    v_add_u32 v181, 1, v40
    v_cmp_gt_u32 vcc, 14, v40
    ds_write_b128 v104, v[100:103] offset:48640
    v_add_u32 v180, -1, v180
    v_lshrrev_b32 v181, 4, v181
    v_mov_b32 v182, 0x41880000
    v_cvt_f32_i32 v20, v180
    buffer_load_dwordx4 v7, s[12:15], s46 offen offset:2048 lds
    v_lshl_add_u32 v181, v40, 2, v181
    v_mov_b32 v23, 0x416fffff
    v_lshlrev_b32 v180, 2, v39
    ds_write_b128 v104, v[100:103] offset:49664
    v_add_f32 v21, s49, v20
    v_cndmask_b32 v23, v182, v23, vcc
    s_mov_b32 s47, 41472
    v_bfe_u32 v24, s36, v180, 4
    v_bfe_u32 v25, s37, v180, 4
    v_bfe_u32 v26, s38, v180, 4
    s_add_u32 m0, s44, 101408
    s_add_u32 s64, s46, 12288
    s_bfe_u32 s65, s24, 0x40004
    s_mul_i32 s65, s65, 18432
    s_sub_u32 s46, s65, 6144
    s_cmp_eq_u32 s30, 0
    s_cselect_b32 s46, s64, s46
    buffer_load_dwordx4 v7, s[12:15], s46 offen offset:0 lds
    v_add_f32 v22, s49, v21
    ds_write_b128 v104, v[100:103] offset:50688
    s_waitcnt vmcnt(9)
    v_add_u32_sdwa v182, s47, v165 dst_sel:DWORD dst_unused:UNUSED_PAD src0_sel:DWORD src1_sel:WORD_1
    s_movk_i32 s48, 528
    v_lshl_add_u32 v181, v181, 3, v182
    s_mul_i32 s61, s30, 23760
    v_mad_u32_u24 v24, v24, s48, v181
    v_mad_u32_u24 v25, v25, s48, v181
    v_mad_u32_u24 v26, v26, s48, v181
    ds_write_b128 v104, v[100:103] offset:51712
    buffer_load_dwordx4 v7, s[12:15], s46 offen offset:1024 lds
    s_add_u32 s61, s61, s47
    s_mul_i32 s47, s30, 17280
    v_add_u32_sdwa v3, s61, v165 dst_sel:DWORD dst_unused:UNUSED_PAD src0_sel:DWORD src1_sel:WORD_0
    v_add_u32_sdwa v9, s61, v166 dst_sel:DWORD dst_unused:UNUSED_PAD src0_sel:DWORD src1_sel:WORD_0
    v_add_u32_sdwa v10, s61, v166 dst_sel:DWORD dst_unused:UNUSED_PAD src0_sel:DWORD src1_sel:WORD_1
    v_add_u32_sdwa v1, s47, v164 dst_sel:DWORD dst_unused:UNUSED_PAD src0_sel:DWORD src1_sel:WORD_0
    v_add_u32_sdwa v2, s47, v164 dst_sel:DWORD dst_unused:UNUSED_PAD src0_sel:DWORD src1_sel:WORD_1
    ds_write_b128 v104, v[100:103] offset:52352
    s_lshl_b32 s48, s29, 7
    s_lshl_b32 s49, s29, 5
    buffer_load_dwordx4 v7, s[12:15], s46 offen offset:2048 lds
    s_add_u32 s47, s48, 88992
    v_add_u32_sdwa v4, s47, v16 dst_sel:DWORD dst_unused:UNUSED_PAD src0_sel:DWORD src1_sel:WORD_0
    s_add_u32 s47, s49, 88992
    v_add_u32_sdwa v5, s47, v16 dst_sel:DWORD dst_unused:UNUSED_PAD src0_sel:DWORD src1_sel:WORD_0
    s_lshl2_add_u32 s47, s28, 163488
    v_mov_b32 v27, s47
    s_mov_b32 s54, 0
    s_cmp_eq_u32 s30, 0
    s_cselect_b32 s31, s26, s27
    s_branch L_S1
.p2align 12
L_S1:
    s_waitcnt lgkmcnt(0)
    s_barrier
    s_add_u32 m0, s44, 113824
    s_add_u32 s46, s65, 6144
    buffer_load_dwordx4 v7, s[12:15], s46 offen offset:0 lds
    buffer_load_dwordx4 v7, s[12:15], s46 offen offset:1024 lds
    buffer_load_dwordx4 v7, s[12:15], s46 offen offset:2048 lds
    s_waitcnt vmcnt(10)
    v_mov_b32 v235, v240
    s_mul_i32 s48, s55, 0
    s_add_u32 m0, s33, 0
    s_add_u32 s48, s48, s20
    buffer_load_dwordx4 v8, s[4:7], s48 offen lds
    v_perm_b32 v180, v232, v232, s59
    v_perm_b32 v184, v233, v233, s59
    v_perm_b32 v188, v234, v234, s59
    v_bfe_u32 v183, v232, s42, 15
    v_bfe_u32 v187, v233, s42, 15
    v_bfe_u32 v191, v234, s42, 15
    v_add_f32 v180, v180, v20
    v_add_f32 v184, v184, v21
    v_add_f32 v188, v188, v22
    v_cvt_pk_bf16_f32 v180, v180, v180
    v_cvt_pk_bf16_f32 v184, v184, v184
    s_mul_i32 s48, s55, 5
    s_add_u32 m0, s33, 17280
    s_add_u32 s48, s48, s20
    buffer_load_dwordx4 v8, s[4:7], s48 offen lds
    v_cvt_pk_bf16_f32 v188, v188, v188
    v_lshlrev_b32 v232, 16, v180
    v_lshlrev_b32 v233, 16, v184
    v_lshlrev_b32 v234, 16, v188
    v_med3_i32 v180, v232, 0, v23
    v_med3_i32 v184, v233, 0, v23
    v_med3_i32 v188, v234, 0, v23
    v_fract_f32 v181, v180
    v_fract_f32 v185, v184
    v_fract_f32 v189, v188
    v_cvt_u32_f32 v182, v180
    s_mul_i32 s48, s55, 1
    s_add_u32 m0, s33, 3456
    s_add_u32 s48, s48, s20
    buffer_load_dwordx4 v8, s[4:7], s48 offen lds
    v_cvt_u32_f32 v186, v184
    v_cvt_u32_f32 v190, v188
    v_sub_f32 v180, 1.0, v181
    v_sub_f32 v184, 1.0, v185
    v_sub_f32 v188, 1.0, v189
    v_max3_u32 v183, v183, v187, v191
    v_max3_i32 v232, v232, v233, v234
    v_cmp_lt_u32 vcc, s68, v183
    v_cmp_gt_i32 s[66:67], v232, v23
    v_lshl_add_u32 v182, v182, 1, v24
    v_lshl_add_u32 v186, v186, 1, v25
    s_mul_i32 s48, s55, 6
    s_add_u32 m0, s33, 20736
    s_add_u32 s48, s48, s20
    buffer_load_dwordx4 v8, s[4:7], s48 offen lds
    v_lshl_add_u32 v190, v190, 1, v26
    v_cvt_pk_bf16_f32 v180, v180, v181
    v_cvt_pk_bf16_f32 v184, v184, v185
    v_cvt_pk_bf16_f32 v188, v188, v189
    s_or_b64 vcc, vcc, s[66:67]
    s_cselect_b32 s47, 3, 0
    s_or_b32 s54, s54, s47
    v_perm_b32 v192, v236, v236, s59
    v_perm_b32 v196, v237, v237, s59
    v_perm_b32 v200, v238, v238, s59
    v_bfe_u32 v195, v236, s42, 15
    v_bfe_u32 v199, v237, s42, 15
    v_bfe_u32 v203, v238, s42, 15
    s_mul_i32 s48, s55, 2
    s_add_u32 m0, s33, 6912
    s_add_u32 s48, s48, s20
    buffer_load_dwordx4 v8, s[4:7], s48 offen lds
    v_add_f32 v192, v192, v20
    v_add_f32 v196, v196, v21
    v_add_f32 v200, v200, v22
    v_cvt_pk_bf16_f32 v192, v192, v192
    v_cvt_pk_bf16_f32 v196, v196, v196
    v_cvt_pk_bf16_f32 v200, v200, v200
    v_lshlrev_b32 v236, 16, v192
    v_lshlrev_b32 v237, 16, v196
    v_lshlrev_b32 v238, 16, v200
    v_med3_i32 v192, v236, 0, v23
    v_med3_i32 v196, v237, 0, v23
    s_mul_i32 s48, s55, 7
    s_add_u32 m0, s33, 24192
    s_add_u32 s48, s48, s20
    buffer_load_dwordx4 v8, s[4:7], s48 offen lds
    v_med3_i32 v200, v238, 0, v23
    v_fract_f32 v193, v192
    v_fract_f32 v197, v196
    v_fract_f32 v201, v200
    v_cvt_u32_f32 v194, v192
    v_cvt_u32_f32 v198, v196
    v_cvt_u32_f32 v202, v200
    v_sub_f32 v192, 1.0, v193
    v_sub_f32 v196, 1.0, v197
    v_sub_f32 v200, 1.0, v201
    v_max3_u32 v195, v195, v199, v203
    v_max3_i32 v236, v236, v237, v238
    v_cmp_lt_u32 vcc, s68, v195
    v_cmp_gt_i32 s[66:67], v236, v23
    v_lshl_add_u32 v194, v194, 1, v24
    v_lshl_add_u32 v198, v198, 1, v25
    v_lshl_add_u32 v202, v202, 1, v26
    v_cvt_pk_bf16_f32 v192, v192, v193
    v_cvt_pk_bf16_f32 v196, v196, v197
    v_cvt_pk_bf16_f32 v200, v200, v201
    s_or_b64 vcc, vcc, s[66:67]
    s_cselect_b32 s47, 12, 0
    s_or_b32 s54, s54, s47
    v_perm_b32 v204, v240, v240, s59
    v_perm_b32 v208, v241, v241, s59
    v_perm_b32 v212, v242, v242, s59
    v_bfe_u32 v207, v240, s42, 15
    v_bfe_u32 v211, v241, s42, 15
    v_bfe_u32 v215, v242, s42, 15
    v_add_f32 v204, v204, v20
    v_add_f32 v208, v208, v21
    v_add_f32 v212, v212, v22
    v_cvt_pk_bf16_f32 v204, v204, v204
    v_cvt_pk_bf16_f32 v208, v208, v208
    v_cvt_pk_bf16_f32 v212, v212, v212
    v_lshlrev_b32 v240, 16, v204
    v_lshlrev_b32 v241, 16, v208
    v_lshlrev_b32 v242, 16, v212
    v_med3_i32 v204, v240, 0, v23
    v_med3_i32 v208, v241, 0, v23
    v_med3_i32 v212, v242, 0, v23
    v_fract_f32 v205, v204
    v_fract_f32 v209, v208
    v_fract_f32 v213, v212
    v_cvt_u32_f32 v206, v204
    v_cvt_u32_f32 v210, v208
    v_cvt_u32_f32 v214, v212
    v_sub_f32 v204, 1.0, v205
    v_sub_f32 v208, 1.0, v209
    v_sub_f32 v212, 1.0, v213
    v_max3_u32 v207, v207, v211, v215
    v_max3_i32 v240, v240, v241, v242
    v_cmp_lt_u32 vcc, s68, v207
    v_cmp_gt_i32 s[66:67], v240, v23
    v_lshl_add_u32 v206, v206, 1, v24
    v_lshl_add_u32 v210, v210, 1, v25
    v_lshl_add_u32 v214, v214, 1, v26
    v_cvt_pk_bf16_f32 v204, v204, v205
    v_cvt_pk_bf16_f32 v208, v208, v209
    v_cvt_pk_bf16_f32 v212, v212, v213
    s_or_b64 vcc, vcc, s[66:67]
    s_cselect_b32 s47, 48, 0
    s_or_b32 s54, s54, s47
    s_mov_b32 exec_hi, 0xffff
    ds_write_b16 v182, v180 offset:0
    ds_write_b16_d16_hi v182, v180 offset:2
    ds_write_b16 v186, v184 offset:0
    ds_write_b16_d16_hi v186, v184 offset:2
    ds_write_b16 v190, v188 offset:0
    ds_write_b16_d16_hi v190, v188 offset:2
    s_mov_b64 exec, -1
    s_mov_b32 exec_hi, 0xffff
    ds_write_b16 v194, v192 offset:9504
    ds_write_b16_d16_hi v194, v192 offset:9506
    ds_write_b16 v198, v196 offset:9504
    ds_write_b16_d16_hi v198, v196 offset:9506
    ds_write_b16 v202, v200 offset:9504
    ds_write_b16_d16_hi v202, v200 offset:9506
    s_mov_b64 exec, -1
    s_mov_b64 exec, 0xffffff
    ds_write_b16 v206, v204 offset:19008
    ds_write_b16_d16_hi v206, v204 offset:19010
    ds_write_b16 v210, v208 offset:19008
    ds_write_b16_d16_hi v210, v208 offset:19010
    ds_write_b16 v214, v212 offset:19008
    ds_write_b16_d16_hi v214, v212 offset:19010
    s_mov_b64 exec, -1
    v_mov_b32 v12, s54
    ds_write_b32 v27, v12
    s_waitcnt vmcnt(6)
    s_barrier
    s_mul_i32 s48, s55, 3
    s_add_u32 m0, s33, 10368
    s_add_u32 s48, s48, s20
    buffer_load_dwordx4 v8, s[4:7], s48 offen lds
    ds_read_b64_tr_b16 a[0:1], v4 offset:0
    ds_read_b64_tr_b16 a[2:3], v4 offset:768
    ds_read_b64_tr_b16 a[4:5], v4 offset:32
    ds_read_b64_tr_b16 a[6:7], v4 offset:800
    ds_read_b64_tr_b16 a[8:9], v5 offset:64
    ds_read_b64_tr_b16 a[10:11], v5 offset:832
    ds_read_b64_tr_b16 a[12:13], v4 offset:6208
    ds_read_b64_tr_b16 a[14:15], v4 offset:6976
    ds_read_b64_tr_b16 a[16:17], v4 offset:6240
    ds_read_b64_tr_b16 a[18:19], v4 offset:7008
    s_mul_i32 s48, s55, 8
    s_add_u32 m0, s33, 27648
    s_add_u32 s48, s48, s20
    buffer_load_dwordx4 v8, s[4:7], s48 offen lds
    ds_read_b64_tr_b16 a[20:21], v5 offset:6272
    ds_read_b64_tr_b16 a[22:23], v5 offset:7040
    ds_read_b64_tr_b16 a[24:25], v4 offset:12416
    ds_read_b64_tr_b16 a[26:27], v4 offset:13184
    ds_read_b64_tr_b16 a[28:29], v4 offset:12448
    ds_read_b64_tr_b16 a[30:31], v4 offset:13216
    ds_read_b64_tr_b16 a[32:33], v5 offset:12480
    ds_read_b64_tr_b16 a[34:35], v5 offset:13248
    ds_read_b64_tr_b16 a[36:37], v4 offset:18624
    ds_read_b64_tr_b16 a[38:39], v4 offset:19392
    s_mul_i32 s48, s55, 4
    s_add_u32 m0, s33, 13824
    s_add_u32 s48, s48, s20
    buffer_load_dwordx4 v8, s[4:7], s48 offen lds
    ds_read_b64_tr_b16 a[40:41], v4 offset:18656
    ds_read_b64_tr_b16 a[42:43], v4 offset:19424
    ds_read_b64_tr_b16 a[44:45], v5 offset:18688
    ds_read_b64_tr_b16 a[46:47], v5 offset:19456
    ds_read_b64_tr_b16 a[48:49], v4 offset:24832
    ds_read_b64_tr_b16 a[50:51], v4 offset:25600
    ds_read_b64_tr_b16 a[52:53], v4 offset:24864
    ds_read_b64_tr_b16 a[54:55], v4 offset:25632
    ds_read_b64_tr_b16 a[56:57], v5 offset:24896
    ds_read_b64_tr_b16 a[58:59], v5 offset:25664
    s_mul_i32 s48, s55, 9
    s_add_u32 m0, s33, 31104
    s_add_u32 s48, s48, s20
    buffer_load_dwordx4 v8, s[4:7], s48 offen lds
    ds_read_b64_tr_b16 a[60:61], v4 offset:31040
    ds_read_b64_tr_b16 a[62:63], v4 offset:31808
    ds_read_b64_tr_b16 a[64:65], v4 offset:31072
    ds_read_b64_tr_b16 a[66:67], v4 offset:31840
    ds_read_b64_tr_b16 a[68:69], v5 offset:31104
    ds_read_b64_tr_b16 a[70:71], v5 offset:31872
    v_add_u32 v4, 37248, v4
    v_add_u32 v5, 37248, v5
    s_cmp_eq_u32 s28, 1
    s_cbranch_scc0 L_S1_n0
    s_call_b64 s[78:79], L_S1_t0
L_S1_n0:
    s_cmp_eq_u32 s28, 2
    s_cbranch_scc0 L_S1_n1
    s_call_b64 s[78:79], L_S1_t1
L_S1_n1:
    s_waitcnt vmcnt(6)
    s_waitcnt lgkmcnt(0)
    s_barrier
    ds_read_b128 a[144:147], v1 offset:0
    ds_read_b128 a[148:151], v1 offset:64
    ds_read_b128 a[152:155], v1 offset:128
    ds_read_b128 a[156:159], v1 offset:3456
    ds_read_b128 a[160:163], v1 offset:3520
    ds_read_b128 a[164:167], v1 offset:3584
    s_waitcnt lgkmcnt(5)
    v_mfma_f32_16x16x32_bf16 v[116:119], a[144:147], a[0:3], 0
    s_add_u32 m0, s44, 126240
    s_bfe_u32 s46, s24, 0x40008
    s_mul_i32 s46, s46, 18432
    v_mfma_f32_16x16x32_bf16 v[120:123], a[144:147], a[4:7], 0
    buffer_load_dwordx4 v7, s[12:15], s46 offen offset:0 lds
    v_mfma_f32_16x16x32_bf16 v[124:127], a[144:147], a[8:11], 0
    s_waitcnt lgkmcnt(4)
    v_mfma_f32_16x16x32_bf16 v[116:119], a[148:151], a[12:15], v[116:119]
    v_mfma_f32_16x16x32_bf16 v[120:123], a[148:151], a[16:19], v[120:123]
    v_mfma_f32_16x16x32_bf16 v[124:127], a[148:151], a[20:23], v[124:127]
    buffer_load_dwordx4 v7, s[12:15], s46 offen offset:1024 lds
    s_waitcnt lgkmcnt(3)
    v_mfma_f32_16x16x32_bf16 v[116:119], a[152:155], a[24:27], v[116:119]
    v_mfma_f32_16x16x32_bf16 v[120:123], a[152:155], a[28:31], v[120:123]
    v_mfma_f32_16x16x32_bf16 v[124:127], a[152:155], a[32:35], v[124:127]
    v_mfma_f32_16x16x32_bf16 v[128:131], a[144:147], a[36:39], 0
    buffer_load_dwordx4 v7, s[12:15], s46 offen offset:2048 lds
    v_mfma_f32_16x16x32_bf16 v[132:135], a[144:147], a[40:43], 0
    v_mfma_f32_16x16x32_bf16 v[136:139], a[144:147], a[44:47], 0
    s_nop 1
    v_cvt_pk_bf16_f32 v140, v116, v117
    v_cvt_pk_bf16_f32 v141, v118, v119
    v_mfma_f32_16x16x32_bf16 v[128:131], a[148:151], a[48:51], v[128:131]
    ds_read_b64 v[216:217], v3 offset:0
    v_mfma_f32_16x16x32_bf16 v[132:135], a[148:151], a[52:55], v[132:135]
    v_cvt_pk_bf16_f32 v144, v120, v121
    v_cvt_pk_bf16_f32 v145, v122, v123
    v_mfma_f32_16x16x32_bf16 v[136:139], a[148:151], a[56:59], v[136:139]
    ds_read_b64 v[218:219], v3 offset:528
    s_add_u32 m0, s44, 138656
    s_add_u32 s64, s46, 12288
    s_bfe_u32 s65, s24, 0x4000c
    s_mul_i32 s65, s65, 18432
    v_mfma_f32_16x16x32_bf16 v[128:131], a[152:155], a[60:63], v[128:131]
    v_cvt_pk_bf16_f32 v148, v124, v125
    v_cvt_pk_bf16_f32 v149, v126, v127
    s_sub_u32 s46, s65, 6144
    s_cmp_eq_u32 s30, 0
    s_cselect_b32 s46, s64, s46
    v_mfma_f32_16x16x32_bf16 v[132:135], a[152:155], a[64:67], v[132:135]
    buffer_load_dwordx4 v7, s[12:15], s46 offen offset:0 lds
    v_mfma_f32_16x16x32_bf16 v[136:139], a[152:155], a[68:71], v[136:139]
    buffer_load_dwordx4 v7, s[12:15], s46 offen offset:1024 lds
    s_waitcnt lgkmcnt(4)
    v_mfma_f32_16x16x32_bf16 v[116:119], a[156:159], a[0:3], 0
    v_mfma_f32_16x16x32_bf16 v[120:123], a[156:159], a[4:7], 0
    v_mfma_f32_16x16x32_bf16 v[124:127], a[156:159], a[8:11], 0
    v_cvt_pk_bf16_f32 v142, v128, v129
    v_cvt_pk_bf16_f32 v143, v130, v131
    s_waitcnt lgkmcnt(3)
    v_mfma_f32_16x16x32_bf16 v[116:119], a[160:163], a[12:15], v[116:119]
    buffer_load_dwordx4 v7, s[12:15], s46 offen offset:2048 lds
    v_mfma_f32_16x16x32_bf16 v[120:123], a[160:163], a[16:19], v[120:123]
    v_cvt_pk_bf16_f32 v146, v132, v133
    v_cvt_pk_bf16_f32 v147, v134, v135
    s_add_u32 m0, s44, 151072
    s_add_u32 s46, s65, 6144
    v_mfma_f32_16x16x32_bf16 v[124:127], a[160:163], a[20:23], v[124:127]
    buffer_load_dwordx4 v7, s[12:15], s46 offen offset:0 lds
    s_waitcnt lgkmcnt(2)
    v_mfma_f32_16x16x32_bf16 v[116:119], a[164:167], a[24:27], v[116:119]
    v_cvt_pk_bf16_f32 v150, v136, v137
    v_cvt_pk_bf16_f32 v151, v138, v139
    v_mfma_f32_16x16x32_bf16 v[120:123], a[164:167], a[28:31], v[120:123]
    v_mfma_f32_16x16x32_bf16 v[124:127], a[164:167], a[32:35], v[124:127]
    s_waitcnt vmcnt(7)
    s_waitcnt lgkmcnt(0)
    s_barrier
    v_mfma_f32_16x16x32_bf16 v[44:47], v[140:143], v[216:219], 0
    buffer_load_dwordx4 v7, s[12:15], s46 offen offset:1024 lds
    v_mfma_f32_16x16x32_bf16 v[48:51], v[144:147], v[216:219], 0
    ds_read_b128 a[168:171], v1 offset:6912
    v_mfma_f32_16x16x32_bf16 v[52:55], v[148:151], v[216:219], 0
    ds_read_b128 a[172:175], v1 offset:6976
    v_mfma_f32_16x16x32_bf16 v[128:131], a[156:159], a[36:39], 0
    ds_read_b64 v[220:221], v3 offset:4752
    v_mfma_f32_16x16x32_bf16 v[132:135], a[156:159], a[40:43], 0
    ds_read_b64 v[222:223], v3 offset:5280
    v_mfma_f32_16x16x32_bf16 v[136:139], a[156:159], a[44:47], 0
    v_cvt_pk_bf16_f32 v140, v116, v117
    v_cvt_pk_bf16_f32 v141, v118, v119
    v_mfma_f32_16x16x32_bf16 v[128:131], a[160:163], a[48:51], v[128:131]
    buffer_load_dwordx4 v7, s[12:15], s46 offen offset:2048 lds
    v_mfma_f32_16x16x32_bf16 v[132:135], a[160:163], a[52:55], v[132:135]
    v_cvt_pk_bf16_f32 v144, v120, v121
    v_cvt_pk_bf16_f32 v145, v122, v123
    s_mul_i32 s48, s55, 10
    s_add_u32 m0, s33, 34560
    s_add_u32 s48, s48, s20
    v_mfma_f32_16x16x32_bf16 v[136:139], a[160:163], a[56:59], v[136:139]
    buffer_load_dwordx4 v8, s[4:7], s48 offen lds
    v_mfma_f32_16x16x32_bf16 v[128:131], a[164:167], a[60:63], v[128:131]
    v_cvt_pk_bf16_f32 v148, v124, v125
    v_cvt_pk_bf16_f32 v149, v126, v127
    v_mfma_f32_16x16x32_bf16 v[132:135], a[164:167], a[64:67], v[132:135]
    s_mul_i32 s48, s55, 11
    s_add_u32 m0, s33, 38016
    s_add_u32 s48, s48, s20
    s_min_u32 s48, s48, s21
    v_mfma_f32_16x16x32_bf16 v[136:139], a[164:167], a[68:71], v[136:139]
    buffer_load_dwordx4 v8, s[4:7], s48 offen lds
    s_waitcnt lgkmcnt(3)
    v_mfma_f32_16x16x32_bf16 v[116:119], a[168:171], a[0:3], 0
    ds_read_b128 a[176:179], v1 offset:7040
    v_mfma_f32_16x16x32_bf16 v[120:123], a[168:171], a[4:7], 0
    ds_read_b128 a[180:183], v1 offset:10368
    v_mfma_f32_16x16x32_bf16 v[124:127], a[168:171], a[8:11], 0
    v_cvt_pk_bf16_f32 v142, v128, v129
    v_cvt_pk_bf16_f32 v143, v130, v131
    s_add_u32 m0, s44, 88992
    s_bfe_u32 s46, s24, 0x40010
    s_mul_i32 s46, s46, 18432
    s_waitcnt lgkmcnt(4)
    v_mfma_f32_16x16x32_bf16 v[116:119], a[172:175], a[12:15], v[116:119]
    buffer_load_dwordx4 v7, s[12:15], s46 offen offset:0 lds
    v_mfma_f32_16x16x32_bf16 v[120:123], a[172:175], a[16:19], v[120:123]
    v_cvt_pk_bf16_f32 v146, v132, v133
    v_cvt_pk_bf16_f32 v147, v134, v135
    v_mfma_f32_16x16x32_bf16 v[124:127], a[172:175], a[20:23], v[124:127]
    ds_read_b128 a[184:187], v1 offset:10432
    s_waitcnt lgkmcnt(2)
    v_mfma_f32_16x16x32_bf16 v[116:119], a[176:179], a[24:27], v[116:119]
    v_cvt_pk_bf16_f32 v150, v136, v137
    v_cvt_pk_bf16_f32 v151, v138, v139
    v_mfma_f32_16x16x32_bf16 v[120:123], a[176:179], a[28:31], v[120:123]
    ds_read_b128 a[188:191], v1 offset:10496
    v_mfma_f32_16x16x32_bf16 v[124:127], a[176:179], a[32:35], v[124:127]
    ds_read_b128 a[192:195], v1 offset:13824
    v_mfma_f32_16x16x32_bf16 v[56:59], v[140:143], v[220:223], 0
    buffer_load_dwordx4 v7, s[12:15], s46 offen offset:1024 lds
    v_mfma_f32_16x16x32_bf16 v[60:63], v[144:147], v[220:223], 0
    ds_read_b128 a[196:199], v1 offset:13888
    v_mfma_f32_16x16x32_bf16 v[64:67], v[148:151], v[220:223], 0
    ds_read_b128 a[200:203], v1 offset:13952
    v_mfma_f32_16x16x32_bf16 v[128:131], a[168:171], a[36:39], 0
    ds_read_b64 v[216:217], v3 offset:9504
    v_mfma_f32_16x16x32_bf16 v[132:135], a[168:171], a[40:43], 0
    ds_read_b64 v[218:219], v3 offset:10032
    v_mfma_f32_16x16x32_bf16 v[136:139], a[168:171], a[44:47], 0
    v_cvt_pk_bf16_f32 v140, v116, v117
    v_cvt_pk_bf16_f32 v141, v118, v119
    v_mfma_f32_16x16x32_bf16 v[128:131], a[172:175], a[48:51], v[128:131]
    buffer_load_dwordx4 v7, s[12:15], s46 offen offset:2048 lds
    v_mfma_f32_16x16x32_bf16 v[132:135], a[172:175], a[52:55], v[132:135]
    v_cvt_pk_bf16_f32 v144, v120, v121
    v_cvt_pk_bf16_f32 v145, v122, v123
    v_mfma_f32_16x16x32_bf16 v[136:139], a[172:175], a[56:59], v[136:139]
    ds_read_b128 a[228:231], v2 offset:0
    v_mfma_f32_16x16x32_bf16 v[128:131], a[176:179], a[60:63], v[128:131]
    v_cvt_pk_bf16_f32 v148, v124, v125
    v_cvt_pk_bf16_f32 v149, v126, v127
    v_mfma_f32_16x16x32_bf16 v[132:135], a[176:179], a[64:67], v[132:135]
    s_add_u32 m0, s44, 101408
    s_add_u32 s64, s46, 12288
    s_bfe_u32 s65, s24, 0x40014
    s_mul_i32 s65, s65, 18432
    v_mfma_f32_16x16x32_bf16 v[136:139], a[176:179], a[68:71], v[136:139]
    s_sub_u32 s46, s65, 6144
    s_cmp_eq_u32 s30, 0
    s_cselect_b32 s46, s64, s46
    s_waitcnt lgkmcnt(7)
    v_mfma_f32_16x16x32_bf16 v[116:119], a[180:183], a[0:3], 0
    buffer_load_dwordx4 v7, s[12:15], s46 offen offset:0 lds
    s_waitcnt vmcnt(6)
    s_barrier
    v_mfma_f32_16x16x32_bf16 v[120:123], a[180:183], a[4:7], 0
    ds_read_b128 a[232:235], v2 offset:64
    ds_read_b64_tr_b16 a[72:73], v4 offset:0
    v_mfma_f32_16x16x32_bf16 v[124:127], a[180:183], a[8:11], 0
    v_cvt_pk_bf16_f32 v142, v128, v129
    v_cvt_pk_bf16_f32 v143, v130, v131
    v_mfma_f32_16x16x32_bf16 v[116:119], a[184:187], a[12:15], v[116:119]
    ds_read_b128 a[236:239], v2 offset:128
    v_mfma_f32_16x16x32_bf16 v[120:123], a[184:187], a[16:19], v[120:123]
    v_cvt_pk_bf16_f32 v146, v132, v133
    v_cvt_pk_bf16_f32 v147, v134, v135
    v_mfma_f32_16x16x32_bf16 v[124:127], a[184:187], a[20:23], v[124:127]
    ds_read_b64_tr_b16 a[74:75], v4 offset:768
    ds_read_b64_tr_b16 a[76:77], v4 offset:32
    s_waitcnt lgkmcnt(7)
    v_mfma_f32_16x16x32_bf16 v[116:119], a[188:191], a[24:27], v[116:119]
    v_cvt_pk_bf16_f32 v150, v136, v137
    v_cvt_pk_bf16_f32 v151, v138, v139
    v_mfma_f32_16x16x32_bf16 v[120:123], a[188:191], a[28:31], v[120:123]
    buffer_load_dwordx4 v7, s[12:15], s46 offen offset:1024 lds
    v_mfma_f32_16x16x32_bf16 v[124:127], a[188:191], a[32:35], v[124:127]
    ds_read_b64_tr_b16 a[78:79], v4 offset:800
    s_waitcnt lgkmcnt(7)
    v_mfma_f32_16x16x32_bf16 v[68:71], v[140:143], v[216:219], 0
    ds_read_b64_tr_b16 a[80:81], v5 offset:64
    v_mfma_f32_16x16x32_bf16 v[72:75], v[144:147], v[216:219], 0
    ds_read_b64_tr_b16 a[82:83], v5 offset:832
    v_mfma_f32_16x16x32_bf16 v[76:79], v[148:151], v[216:219], 0
    ds_read_b64_tr_b16 a[84:85], v4 offset:6208
    ds_read_b64_tr_b16 a[86:87], v4 offset:6976
    v_mfma_f32_16x16x32_bf16 v[128:131], a[180:183], a[36:39], 0
    ds_read_b64 v[220:221], v3 offset:14256
    v_mfma_f32_16x16x32_bf16 v[132:135], a[180:183], a[40:43], 0
    ds_read_b64 v[222:223], v3 offset:14784
    ds_read_b64_tr_b16 a[88:89], v4 offset:6240
    v_mfma_f32_16x16x32_bf16 v[136:139], a[180:183], a[44:47], 0
    v_cvt_pk_bf16_f32 v140, v116, v117
    v_cvt_pk_bf16_f32 v141, v118, v119
    v_mfma_f32_16x16x32_bf16 v[128:131], a[184:187], a[48:51], v[128:131]
    buffer_load_dwordx4 v7, s[12:15], s46 offen offset:2048 lds
    v_mfma_f32_16x16x32_bf16 v[132:135], a[184:187], a[52:55], v[132:135]
    v_cvt_pk_bf16_f32 v144, v120, v121
    v_cvt_pk_bf16_f32 v145, v122, v123
    v_mfma_f32_16x16x32_bf16 v[136:139], a[184:187], a[56:59], v[136:139]
    ds_read_b64_tr_b16 a[90:91], v4 offset:7008
    ds_read_b64_tr_b16 a[92:93], v5 offset:6272
    v_mfma_f32_16x16x32_bf16 v[128:131], a[188:191], a[60:63], v[128:131]
    v_cvt_pk_bf16_f32 v148, v124, v125
    v_cvt_pk_bf16_f32 v149, v126, v127
    s_add_u32 m0, s44, 113824
    s_add_u32 s46, s65, 6144
    v_mfma_f32_16x16x32_bf16 v[132:135], a[188:191], a[64:67], v[132:135]
    buffer_load_dwordx4 v7, s[12:15], s46 offen offset:0 lds
    v_mfma_f32_16x16x32_bf16 v[136:139], a[188:191], a[68:71], v[136:139]
    ds_read_b64_tr_b16 a[94:95], v5 offset:7040
    v_mfma_f32_16x16x32_bf16 v[116:119], a[192:195], a[0:3], 0
    ds_read_b64_tr_b16 a[96:97], v4 offset:12416
    v_mfma_f32_16x16x32_bf16 v[120:123], a[192:195], a[4:7], 0
    ds_read_b64_tr_b16 a[98:99], v4 offset:13184
    ds_read_b64_tr_b16 a[100:101], v4 offset:12448
    v_mfma_f32_16x16x32_bf16 v[124:127], a[192:195], a[8:11], 0
    v_cvt_pk_bf16_f32 v142, v128, v129
    v_cvt_pk_bf16_f32 v143, v130, v131
    v_mfma_f32_16x16x32_bf16 v[116:119], a[196:199], a[12:15], v[116:119]
    buffer_load_dwordx4 v7, s[12:15], s46 offen offset:1024 lds
    v_mfma_f32_16x16x32_bf16 v[120:123], a[196:199], a[16:19], v[120:123]
    v_cvt_pk_bf16_f32 v146, v132, v133
    v_cvt_pk_bf16_f32 v147, v134, v135
    v_mfma_f32_16x16x32_bf16 v[124:127], a[196:199], a[20:23], v[124:127]
    ds_read_b64_tr_b16 a[102:103], v4 offset:13216
    v_mfma_f32_16x16x32_bf16 v[116:119], a[200:203], a[24:27], v[116:119]
    v_cvt_pk_bf16_f32 v150, v136, v137
    v_cvt_pk_bf16_f32 v151, v138, v139
    v_mfma_f32_16x16x32_bf16 v[120:123], a[200:203], a[28:31], v[120:123]
    ds_read_b64_tr_b16 a[104:105], v5 offset:12480
    v_mfma_f32_16x16x32_bf16 v[124:127], a[200:203], a[32:35], v[124:127]
    ds_read_b64_tr_b16 a[106:107], v5 offset:13248
    s_waitcnt lgkmcnt(7)
    v_mfma_f32_16x16x32_bf16 v[80:83], v[140:143], v[220:223], 0
    buffer_load_dwordx4 v7, s[12:15], s46 offen offset:2048 lds
    v_mfma_f32_16x16x32_bf16 v[84:87], v[144:147], v[220:223], 0
    ds_read_b64_tr_b16 a[108:109], v4 offset:18624
    v_mfma_f32_16x16x32_bf16 v[88:91], v[148:151], v[220:223], 0
    ds_read_b64_tr_b16 a[110:111], v4 offset:19392
    ds_read_b64_tr_b16 a[112:113], v4 offset:18656
    v_mfma_f32_16x16x32_bf16 v[128:131], a[192:195], a[36:39], 0
    ds_read_b64 v[216:217], v3 offset:19008
    v_mfma_f32_16x16x32_bf16 v[132:135], a[192:195], a[40:43], 0
    ds_read_b64 v[218:219], v3 offset:19536
    v_mfma_f32_16x16x32_bf16 v[136:139], a[192:195], a[44:47], 0
    v_cvt_pk_bf16_f32 v140, v116, v117
    v_cvt_pk_bf16_f32 v141, v118, v119
    v_mfma_f32_16x16x32_bf16 v[128:131], a[196:199], a[48:51], v[128:131]
    ds_read_b64_tr_b16 a[114:115], v4 offset:19424
    ds_read_b64_tr_b16 a[116:117], v5 offset:18688
    v_mfma_f32_16x16x32_bf16 v[132:135], a[196:199], a[52:55], v[132:135]
    v_cvt_pk_bf16_f32 v144, v120, v121
    v_cvt_pk_bf16_f32 v145, v122, v123
    v_mfma_f32_16x16x32_bf16 v[136:139], a[196:199], a[56:59], v[136:139]
    ds_read_b64_tr_b16 a[118:119], v5 offset:19456
    v_mfma_f32_16x16x32_bf16 v[128:131], a[200:203], a[60:63], v[128:131]
    v_cvt_pk_bf16_f32 v148, v124, v125
    v_cvt_pk_bf16_f32 v149, v126, v127
    v_mfma_f32_16x16x32_bf16 v[132:135], a[200:203], a[64:67], v[132:135]
    ds_read_b64_tr_b16 a[120:121], v4 offset:24832
    v_mfma_f32_16x16x32_bf16 v[136:139], a[200:203], a[68:71], v[136:139]
    ds_read_b64_tr_b16 a[122:123], v4 offset:25600
    v_mfma_f32_16x16x32_bf16 v[116:119], a[228:231], a[0:3], 0
    ds_read_b64_tr_b16 a[124:125], v4 offset:24864
    v_mfma_f32_16x16x32_bf16 v[120:123], a[228:231], a[4:7], 0
    ds_read_b64_tr_b16 a[126:127], v4 offset:25632
    v_mfma_f32_16x16x32_bf16 v[124:127], a[228:231], a[8:11], 0
    v_cvt_pk_bf16_f32 v142, v128, v129
    v_cvt_pk_bf16_f32 v143, v130, v131
    v_mfma_f32_16x16x32_bf16 v[116:119], a[232:235], a[12:15], v[116:119]
    ds_read_b64_tr_b16 a[128:129], v5 offset:24896
    v_mfma_f32_16x16x32_bf16 v[120:123], a[232:235], a[16:19], v[120:123]
    v_cvt_pk_bf16_f32 v146, v132, v133
    v_cvt_pk_bf16_f32 v147, v134, v135
    v_mfma_f32_16x16x32_bf16 v[124:127], a[232:235], a[20:23], v[124:127]
    ds_read_b64_tr_b16 a[130:131], v5 offset:25664
    v_mfma_f32_16x16x32_bf16 v[116:119], a[236:239], a[24:27], v[116:119]
    v_cvt_pk_bf16_f32 v150, v136, v137
    v_cvt_pk_bf16_f32 v151, v138, v139
    v_mfma_f32_16x16x32_bf16 v[120:123], a[236:239], a[28:31], v[120:123]
    ds_read_b64_tr_b16 a[132:133], v4 offset:31040
    v_mfma_f32_16x16x32_bf16 v[124:127], a[236:239], a[32:35], v[124:127]
    ds_read_b64_tr_b16 a[134:135], v4 offset:31808
    s_waitcnt lgkmcnt(7)
    v_mfma_f32_16x16x32_bf16 v[92:95], v[140:143], v[216:219], 0
    ds_read_b64_tr_b16 a[136:137], v4 offset:31072
    v_mfma_f32_16x16x32_bf16 v[96:99], v[144:147], v[216:219], 0
    ds_read_b64_tr_b16 a[138:139], v4 offset:31840
    v_mfma_f32_16x16x32_bf16 v[100:103], v[148:151], v[216:219], 0
    ds_read_b64_tr_b16 a[140:141], v5 offset:31104
    v_mfma_f32_16x16x32_bf16 v[128:131], a[228:231], a[36:39], 0
    ds_read_b32 v220, v9 offset:0
    ds_read_b64_tr_b16 a[142:143], v5 offset:31872
    v_mfma_f32_16x16x32_bf16 v[132:135], a[228:231], a[40:43], 0
    ds_read_b32 v221, v10 offset:0
    v_add_u32 v4, -37248, v4
    v_mfma_f32_16x16x32_bf16 v[136:139], a[228:231], a[44:47], 0
    v_cvt_pk_bf16_f32 v140, v116, v117
    v_cvt_pk_bf16_f32 v141, v118, v119
    v_mfma_f32_16x16x32_bf16 v[128:131], a[232:235], a[48:51], v[128:131]
    ds_read_b32 v222, v9 offset:528
    v_add_u32 v5, -37248, v5
    v_mfma_f32_16x16x32_bf16 v[132:135], a[232:235], a[52:55], v[132:135]
    v_cvt_pk_bf16_f32 v144, v120, v121
    v_cvt_pk_bf16_f32 v145, v122, v123
    v_mfma_f32_16x16x32_bf16 v[136:139], a[232:235], a[56:59], v[136:139]
    ds_read_b32 v223, v10 offset:528
    v_mfma_f32_16x16x32_bf16 v[128:131], a[236:239], a[60:63], v[128:131]
    v_cvt_pk_bf16_f32 v148, v124, v125
    v_cvt_pk_bf16_f32 v149, v126, v127
    v_mfma_f32_16x16x32_bf16 v[132:135], a[236:239], a[64:67], v[132:135]
    v_mfma_f32_16x16x32_bf16 v[136:139], a[236:239], a[68:71], v[136:139]
    s_waitcnt vmcnt(0)
    s_waitcnt lgkmcnt(0)
    s_barrier
    s_branch L_S1_s0
L_S1_t0:
    s_setpc_b64 s[78:79]
L_S1_s0:
    v_mfma_f32_16x16x32_bf16 v[116:119], a[144:147], a[72:75], 0
    v_mfma_f32_16x16x32_bf16 v[120:123], a[144:147], a[76:79], 0
    v_mfma_f32_16x16x32_bf16 v[124:127], a[144:147], a[80:83], 0
    v_cvt_pk_bf16_f32 v142, v128, v129
    v_cvt_pk_bf16_f32 v143, v130, v131
    s_add_u32 m0, s44, 126240
    s_bfe_u32 s46, s24, 0x40018
    s_mul_i32 s46, s46, 18432
    v_mfma_f32_16x16x32_bf16 v[116:119], a[148:151], a[84:87], v[116:119]
    buffer_load_dwordx4 v7, s[12:15], s46 offen offset:0 lds
    v_mfma_f32_16x16x32_bf16 v[120:123], a[148:151], a[88:91], v[120:123]
    v_cvt_pk_bf16_f32 v146, v132, v133
    v_cvt_pk_bf16_f32 v147, v134, v135
    v_mfma_f32_16x16x32_bf16 v[124:127], a[148:151], a[92:95], v[124:127]
    v_mfma_f32_16x16x32_bf16 v[116:119], a[152:155], a[96:99], v[116:119]
    v_cvt_pk_bf16_f32 v150, v136, v137
    v_cvt_pk_bf16_f32 v151, v138, v139
    v_mfma_f32_16x16x32_bf16 v[120:123], a[152:155], a[100:103], v[120:123]
    v_mfma_f32_16x16x32_bf16 v[124:127], a[152:155], a[104:107], v[124:127]
    v_mfma_f32_16x16x32_bf16 v[104:107], v[220:223], v[140:143], 0
    v_mfma_f32_16x16x32_bf16 v[108:111], v[220:223], v[144:147], 0
    buffer_load_dwordx4 v7, s[12:15], s46 offen offset:1024 lds
    v_mfma_f32_16x16x32_bf16 v[112:115], v[220:223], v[148:151], 0
    v_mfma_f32_16x16x32_bf16 v[128:131], a[156:159], a[108:111], 0
    ds_read_b64 v[216:217], v3 offset:1056
    v_mfma_f32_16x16x32_bf16 v[132:135], a[156:159], a[112:115], 0
    ds_read_b64 v[218:219], v3 offset:1584
    v_mfma_f32_16x16x32_bf16 v[136:139], a[156:159], a[116:119], 0
    v_cvt_pk_bf16_f32 v140, v116, v117
    v_cvt_pk_bf16_f32 v141, v118, v119
    v_mfma_f32_16x16x32_bf16 v[128:131], a[160:163], a[120:123], v[128:131]
    ds_read_b128 a[204:207], v1 offset:17280
    v_mfma_f32_16x16x32_bf16 v[132:135], a[160:163], a[124:127], v[132:135]
    v_cvt_pk_bf16_f32 v144, v120, v121
    v_cvt_pk_bf16_f32 v145, v122, v123
    v_mfma_f32_16x16x32_bf16 v[136:139], a[160:163], a[128:131], v[136:139]
    ds_read_b128 a[208:211], v1 offset:17344
    ds_read_b128 a[212:215], v1 offset:17408
    v_mfma_f32_16x16x32_bf16 v[128:131], a[164:167], a[132:135], v[128:131]
    v_cvt_pk_bf16_f32 v148, v124, v125
    v_cvt_pk_bf16_f32 v149, v126, v127
    v_mfma_f32_16x16x32_bf16 v[132:135], a[164:167], a[136:139], v[132:135]
    buffer_load_dwordx4 v7, s[12:15], s46 offen offset:2048 lds
    v_mfma_f32_16x16x32_bf16 v[136:139], a[164:167], a[140:143], v[136:139]
    ds_read_b128 a[216:219], v1 offset:20736
    v_mfma_f32_16x16x32_bf16 v[116:119], a[156:159], a[72:75], 0
    ds_read_b128 a[220:223], v1 offset:20800
    v_mfma_f32_16x16x32_bf16 v[120:123], a[156:159], a[76:79], 0
    ds_read_b128 a[224:227], v1 offset:20864
    ds_read_b128 a[240:243], v2 offset:3456
    v_mfma_f32_16x16x32_bf16 v[124:127], a[156:159], a[80:83], 0
    v_cvt_pk_bf16_f32 v142, v128, v129
    v_cvt_pk_bf16_f32 v143, v130, v131
    ds_read_b128 a[244:247], v2 offset:3520
    v_mfma_f32_16x16x32_bf16 v[116:119], a[160:163], a[84:87], v[116:119]
    s_add_u32 m0, s44, 138656
    s_add_u32 s64, s46, 12288
    s_bfe_u32 s65, s24, 0x4001c
    s_mul_i32 s65, s65, 18432
    v_mfma_f32_16x16x32_bf16 v[120:123], a[160:163], a[88:91], v[120:123]
    v_cvt_pk_bf16_f32 v146, v132, v133
    v_cvt_pk_bf16_f32 v147, v134, v135
    s_sub_u32 s46, s65, 6144
    s_cmp_eq_u32 s30, 0
    s_cselect_b32 s46, s64, s46
    v_mfma_f32_16x16x32_bf16 v[124:127], a[160:163], a[92:95], v[124:127]
    buffer_load_dwordx4 v7, s[12:15], s46 offen offset:0 lds
    v_mfma_f32_16x16x32_bf16 v[116:119], a[164:167], a[96:99], v[116:119]
    v_cvt_pk_bf16_f32 v150, v136, v137
    v_cvt_pk_bf16_f32 v151, v138, v139
    v_mfma_f32_16x16x32_bf16 v[120:123], a[164:167], a[100:103], v[120:123]
    ds_read_b128 a[248:251], v2 offset:3584
    v_mfma_f32_16x16x32_bf16 v[124:127], a[164:167], a[104:107], v[124:127]
    ds_read_b128 a[228:231], v2 offset:6912
    s_waitcnt lgkmcnt(7)
    v_mfma_f32_16x16x32_bf16 v[44:47], v[140:143], v[216:219], v[44:47]
    ds_read_b128 a[232:235], v2 offset:6976
    v_mfma_f32_16x16x32_bf16 v[48:51], v[144:147], v[216:219], v[48:51]
    ds_read_b128 a[236:239], v2 offset:7040
    v_mfma_f32_16x16x32_bf16 v[52:55], v[148:151], v[216:219], v[52:55]
    buffer_load_dwordx4 v7, s[12:15], s46 offen offset:1024 lds
    v_mfma_f32_16x16x32_bf16 v[128:131], a[168:171], a[108:111], 0
    ds_read_b64 v[220:221], v3 offset:5808
    v_mov_b32 v14, 163488
    v_mfma_f32_16x16x32_bf16 v[132:135], a[168:171], a[112:115], 0
    ds_read_b64 v[222:223], v3 offset:6336
    v_mfma_f32_16x16x32_bf16 v[136:139], a[168:171], a[116:119], 0
    v_cvt_pk_bf16_f32 v140, v116, v117
    v_cvt_pk_bf16_f32 v141, v118, v119
    v_mfma_f32_16x16x32_bf16 v[128:131], a[172:175], a[120:123], v[128:131]
    ds_read_b128 v[228:231], v14
    v_mfma_f32_16x16x32_bf16 v[132:135], a[172:175], a[124:127], v[132:135]
    v_cvt_pk_bf16_f32 v144, v120, v121
    v_cvt_pk_bf16_f32 v145, v122, v123
    v_mfma_f32_16x16x32_bf16 v[136:139], a[172:175], a[128:131], v[136:139]
    ds_read_b64_tr_b16 a[0:1], v4 offset:0
    v_mfma_f32_16x16x32_bf16 v[128:131], a[176:179], a[132:135], v[128:131]
    v_cvt_pk_bf16_f32 v148, v124, v125
    v_cvt_pk_bf16_f32 v149, v126, v127
    v_mfma_f32_16x16x32_bf16 v[132:135], a[176:179], a[136:139], v[132:135]
    buffer_load_dwordx4 v7, s[12:15], s46 offen offset:2048 lds
    v_mfma_f32_16x16x32_bf16 v[136:139], a[176:179], a[140:143], v[136:139]
    ds_read_b64_tr_b16 a[2:3], v4 offset:768
    v_mfma_f32_16x16x32_bf16 v[116:119], a[168:171], a[72:75], 0
    ds_read_b64_tr_b16 a[4:5], v4 offset:32
    v_mfma_f32_16x16x32_bf16 v[120:123], a[168:171], a[76:79], 0
    ds_read_b64_tr_b16 a[6:7], v4 offset:800
    v_mfma_f32_16x16x32_bf16 v[124:127], a[168:171], a[80:83], 0
    v_cvt_pk_bf16_f32 v142, v128, v129
    v_cvt_pk_bf16_f32 v143, v130, v131
    v_mfma_f32_16x16x32_bf16 v[116:119], a[172:175], a[84:87], v[116:119]
    ds_read_b64_tr_b16 a[8:9], v5 offset:64
    ds_read_b64_tr_b16 a[10:11], v5 offset:832
    v_mfma_f32_16x16x32_bf16 v[120:123], a[172:175], a[88:91], v[120:123]
    v_cvt_pk_bf16_f32 v146, v132, v133
    v_cvt_pk_bf16_f32 v147, v134, v135
    s_add_u32 m0, s44, 151072
    s_add_u32 s46, s65, 6144
    v_mfma_f32_16x16x32_bf16 v[124:127], a[172:175], a[92:95], v[124:127]
    buffer_load_dwordx4 v7, s[12:15], s46 offen offset:0 lds
    v_mfma_f32_16x16x32_bf16 v[116:119], a[176:179], a[96:99], v[116:119]
    v_cvt_pk_bf16_f32 v150, v136, v137
    v_cvt_pk_bf16_f32 v151, v138, v139
    v_mfma_f32_16x16x32_bf16 v[120:123], a[176:179], a[100:103], v[120:123]
    ds_read_b64_tr_b16 a[12:13], v4 offset:6208
    v_mfma_f32_16x16x32_bf16 v[124:127], a[176:179], a[104:107], v[124:127]
    ds_read_b64_tr_b16 a[14:15], v4 offset:6976
    s_waitcnt lgkmcnt(7)
    v_mfma_f32_16x16x32_bf16 v[56:59], v[140:143], v[220:223], v[56:59]
    ds_read_b64_tr_b16 a[16:17], v4 offset:6240
    v_mfma_f32_16x16x32_bf16 v[60:63], v[144:147], v[220:223], v[60:63]
    ds_read_b64_tr_b16 a[18:19], v4 offset:7008
    v_mfma_f32_16x16x32_bf16 v[64:67], v[148:151], v[220:223], v[64:67]
    ds_read_b64_tr_b16 a[20:21], v5 offset:6272
    v_mfma_f32_16x16x32_bf16 v[128:131], a[180:183], a[108:111], 0
    ds_read_b64 v[216:217], v3 offset:10560
    ds_read_b64_tr_b16 a[22:23], v5 offset:7040
    v_mfma_f32_16x16x32_bf16 v[132:135], a[180:183], a[112:115], 0
    ds_read_b64 v[218:219], v3 offset:11088
    v_mfma_f32_16x16x32_bf16 v[136:139], a[180:183], a[116:119], 0
    v_cvt_pk_bf16_f32 v140, v116, v117
    v_cvt_pk_bf16_f32 v141, v118, v119
    v_mfma_f32_16x16x32_bf16 v[128:131], a[184:187], a[120:123], v[128:131]
    buffer_load_dwordx4 v7, s[12:15], s46 offen offset:1024 lds
    v_mfma_f32_16x16x32_bf16 v[132:135], a[184:187], a[124:127], v[132:135]
    v_cvt_pk_bf16_f32 v144, v120, v121
    v_cvt_pk_bf16_f32 v145, v122, v123
    v_mfma_f32_16x16x32_bf16 v[136:139], a[184:187], a[128:131], v[136:139]
    ds_read_b64_tr_b16 a[24:25], v4 offset:12416
    ds_read_b64_tr_b16 a[26:27], v4 offset:13184
    v_mfma_f32_16x16x32_bf16 v[128:131], a[188:191], a[132:135], v[128:131]
    v_cvt_pk_bf16_f32 v148, v124, v125
    v_cvt_pk_bf16_f32 v149, v126, v127
    v_mfma_f32_16x16x32_bf16 v[132:135], a[188:191], a[136:139], v[132:135]
    buffer_load_dwordx4 v7, s[12:15], s46 offen offset:2048 lds
    v_mfma_f32_16x16x32_bf16 v[136:139], a[188:191], a[140:143], v[136:139]
    ds_read_b64_tr_b16 a[28:29], v4 offset:12448
    v_mfma_f32_16x16x32_bf16 v[116:119], a[180:183], a[72:75], 0
    ds_read_b64_tr_b16 a[30:31], v4 offset:13216
    v_mfma_f32_16x16x32_bf16 v[120:123], a[180:183], a[76:79], 0
    ds_read_b64_tr_b16 a[32:33], v5 offset:12480
    v_mfma_f32_16x16x32_bf16 v[124:127], a[180:183], a[80:83], 0
    v_cvt_pk_bf16_f32 v142, v128, v129
    v_cvt_pk_bf16_f32 v143, v130, v131
    v_mfma_f32_16x16x32_bf16 v[116:119], a[184:187], a[84:87], v[116:119]
    ds_read_b64_tr_b16 a[34:35], v5 offset:13248
    v_mfma_f32_16x16x32_bf16 v[120:123], a[184:187], a[88:91], v[120:123]
    v_cvt_pk_bf16_f32 v146, v132, v133
    v_cvt_pk_bf16_f32 v147, v134, v135
    v_mfma_f32_16x16x32_bf16 v[124:127], a[184:187], a[92:95], v[124:127]
    ds_read_b64_tr_b16 a[36:37], v4 offset:18624
    v_mfma_f32_16x16x32_bf16 v[116:119], a[188:191], a[96:99], v[116:119]
    v_cvt_pk_bf16_f32 v150, v136, v137
    v_cvt_pk_bf16_f32 v151, v138, v139
    v_mfma_f32_16x16x32_bf16 v[120:123], a[188:191], a[100:103], v[120:123]
    ds_read_b64_tr_b16 a[38:39], v4 offset:19392
    v_mfma_f32_16x16x32_bf16 v[124:127], a[188:191], a[104:107], v[124:127]
    ds_read_b64_tr_b16 a[40:41], v4 offset:18656
    s_waitcnt lgkmcnt(7)
    v_mfma_f32_16x16x32_bf16 v[68:71], v[140:143], v[216:219], v[68:71]
    ds_read_b64_tr_b16 a[42:43], v4 offset:19424
    v_mfma_f32_16x16x32_bf16 v[72:75], v[144:147], v[216:219], v[72:75]
    ds_read_b64_tr_b16 a[44:45], v5 offset:18688
    v_mfma_f32_16x16x32_bf16 v[76:79], v[148:151], v[216:219], v[76:79]
    v_mfma_f32_16x16x32_bf16 v[128:131], a[192:195], a[108:111], 0
    ds_read_b64 v[220:221], v3 offset:15312
    v_mfma_f32_16x16x32_bf16 v[132:135], a[192:195], a[112:115], 0
    ds_read_b64 v[222:223], v3 offset:15840
    v_mfma_f32_16x16x32_bf16 v[136:139], a[192:195], a[116:119], 0
    v_cvt_pk_bf16_f32 v140, v116, v117
    v_cvt_pk_bf16_f32 v141, v118, v119
    v_mfma_f32_16x16x32_bf16 v[128:131], a[196:199], a[120:123], v[128:131]
    ds_read_b64_tr_b16 a[46:47], v5 offset:19456
    v_mfma_f32_16x16x32_bf16 v[132:135], a[196:199], a[124:127], v[132:135]
    v_cvt_pk_bf16_f32 v144, v120, v121
    v_cvt_pk_bf16_f32 v145, v122, v123
    v_mfma_f32_16x16x32_bf16 v[136:139], a[196:199], a[128:131], v[136:139]
    ds_read_b64_tr_b16 a[48:49], v4 offset:24832
    v_mfma_f32_16x16x32_bf16 v[128:131], a[200:203], a[132:135], v[128:131]
    v_cvt_pk_bf16_f32 v148, v124, v125
    v_cvt_pk_bf16_f32 v149, v126, v127
    v_mfma_f32_16x16x32_bf16 v[132:135], a[200:203], a[136:139], v[132:135]
    ds_read_b64_tr_b16 a[50:51], v4 offset:25600
    v_mfma_f32_16x16x32_bf16 v[136:139], a[200:203], a[140:143], v[136:139]
    ds_read_b64_tr_b16 a[52:53], v4 offset:24864
    v_mfma_f32_16x16x32_bf16 v[116:119], a[192:195], a[72:75], 0
    ds_read_b64_tr_b16 a[54:55], v4 offset:25632
    v_mfma_f32_16x16x32_bf16 v[120:123], a[192:195], a[76:79], 0
    ds_read_b64_tr_b16 a[56:57], v5 offset:24896
    v_mfma_f32_16x16x32_bf16 v[124:127], a[192:195], a[80:83], 0
    v_cvt_pk_bf16_f32 v142, v128, v129
    v_cvt_pk_bf16_f32 v143, v130, v131
    v_mfma_f32_16x16x32_bf16 v[116:119], a[196:199], a[84:87], v[116:119]
    ds_read_b64_tr_b16 a[58:59], v5 offset:25664
    v_mfma_f32_16x16x32_bf16 v[120:123], a[196:199], a[88:91], v[120:123]
    v_cvt_pk_bf16_f32 v146, v132, v133
    v_cvt_pk_bf16_f32 v147, v134, v135
    v_mfma_f32_16x16x32_bf16 v[124:127], a[196:199], a[92:95], v[124:127]
    ds_read_b64_tr_b16 a[60:61], v4 offset:31040
    v_mfma_f32_16x16x32_bf16 v[116:119], a[200:203], a[96:99], v[116:119]
    v_cvt_pk_bf16_f32 v150, v136, v137
    v_cvt_pk_bf16_f32 v151, v138, v139
    v_mfma_f32_16x16x32_bf16 v[120:123], a[200:203], a[100:103], v[120:123]
    ds_read_b64_tr_b16 a[62:63], v4 offset:31808
    v_mfma_f32_16x16x32_bf16 v[124:127], a[200:203], a[104:107], v[124:127]
    ds_read_b64_tr_b16 a[64:65], v4 offset:31072
    s_waitcnt lgkmcnt(7)
    v_mfma_f32_16x16x32_bf16 v[80:83], v[140:143], v[220:223], v[80:83]
    ds_read_b64_tr_b16 a[66:67], v4 offset:31840
    v_mfma_f32_16x16x32_bf16 v[84:87], v[144:147], v[220:223], v[84:87]
    ds_read_b64_tr_b16 a[68:69], v5 offset:31104
    v_mfma_f32_16x16x32_bf16 v[88:91], v[148:151], v[220:223], v[88:91]
    ds_read_b64_tr_b16 a[70:71], v5 offset:31872
    v_mfma_f32_16x16x32_bf16 v[128:131], a[204:207], a[108:111], 0
    ds_read_b64 v[216:217], v3 offset:20064
    v_mfma_f32_16x16x32_bf16 v[132:135], a[204:207], a[112:115], 0
    ds_read_b64 v[218:219], v3 offset:20592
    v_mfma_f32_16x16x32_bf16 v[136:139], a[204:207], a[116:119], 0
    v_cvt_pk_bf16_f32 v140, v116, v117
    v_cvt_pk_bf16_f32 v141, v118, v119
    v_mfma_f32_16x16x32_bf16 v[128:131], a[208:211], a[120:123], v[128:131]
    v_add_u32 v4, 37248, v4
    v_add_u32 v5, 37248, v5
    v_mfma_f32_16x16x32_bf16 v[132:135], a[208:211], a[124:127], v[132:135]
    v_cvt_pk_bf16_f32 v144, v120, v121
    v_cvt_pk_bf16_f32 v145, v122, v123
    v_mfma_f32_16x16x32_bf16 v[136:139], a[208:211], a[128:131], v[136:139]
    v_mfma_f32_16x16x32_bf16 v[128:131], a[212:215], a[132:135], v[128:131]
    v_cvt_pk_bf16_f32 v148, v124, v125
    v_cvt_pk_bf16_f32 v149, v126, v127
    v_mfma_f32_16x16x32_bf16 v[132:135], a[212:215], a[136:139], v[132:135]
    v_mfma_f32_16x16x32_bf16 v[136:139], a[212:215], a[140:143], v[136:139]
    s_waitcnt vmcnt(0)
    s_waitcnt lgkmcnt(0)
    s_barrier
    v_mfma_f32_16x16x32_bf16 v[116:119], a[156:159], a[0:3], 0
    ds_read_b64_tr_b16 a[72:73], v4 offset:0
    v_mfma_f32_16x16x32_bf16 v[120:123], a[156:159], a[4:7], 0
    ds_read_b64_tr_b16 a[74:75], v4 offset:768
    v_mfma_f32_16x16x32_bf16 v[124:127], a[156:159], a[8:11], 0
    v_cvt_pk_bf16_f32 v142, v128, v129
    v_cvt_pk_bf16_f32 v143, v130, v131
    s_add_u32 m0, s44, 88992
    s_bfe_u32 s46, s25, 0x40000
    s_mul_i32 s46, s46, 18432
    v_mfma_f32_16x16x32_bf16 v[116:119], a[160:163], a[12:15], v[116:119]
    buffer_load_dwordx4 v7, s[12:15], s46 offen offset:0 lds
    v_mfma_f32_16x16x32_bf16 v[120:123], a[160:163], a[16:19], v[120:123]
    v_cvt_pk_bf16_f32 v146, v132, v133
    v_cvt_pk_bf16_f32 v147, v134, v135
    v_mfma_f32_16x16x32_bf16 v[124:127], a[160:163], a[20:23], v[124:127]
    ds_read_b64_tr_b16 a[76:77], v4 offset:32
    v_mfma_f32_16x16x32_bf16 v[116:119], a[164:167], a[24:27], v[116:119]
    v_cvt_pk_bf16_f32 v150, v136, v137
    v_cvt_pk_bf16_f32 v151, v138, v139
    v_mfma_f32_16x16x32_bf16 v[120:123], a[164:167], a[28:31], v[120:123]
    buffer_load_dwordx4 v7, s[12:15], s46 offen offset:1024 lds
    v_mfma_f32_16x16x32_bf16 v[124:127], a[164:167], a[32:35], v[124:127]
    ds_read_b64_tr_b16 a[78:79], v4 offset:800
    v_mfma_f32_16x16x32_bf16 v[92:95], v[140:143], v[216:219], v[92:95]
    ds_read_b64_tr_b16 a[80:81], v5 offset:64
    v_mfma_f32_16x16x32_bf16 v[96:99], v[144:147], v[216:219], v[96:99]
    ds_read_b64_tr_b16 a[82:83], v5 offset:832
    v_mfma_f32_16x16x32_bf16 v[100:103], v[148:151], v[216:219], v[100:103]
    ds_read_b64_tr_b16 a[84:85], v4 offset:6208
    ds_read_b64_tr_b16 a[86:87], v4 offset:6976
    v_mfma_f32_16x16x32_bf16 v[128:131], a[156:159], a[36:39], 0
    ds_read_b64 v[220:221], v3 offset:2112
    v_mfma_f32_16x16x32_bf16 v[132:135], a[156:159], a[40:43], 0
    ds_read_b64 v[222:223], v3 offset:2640
    ds_read_b64_tr_b16 a[88:89], v4 offset:6240
    v_mfma_f32_16x16x32_bf16 v[136:139], a[156:159], a[44:47], 0
    v_cvt_pk_bf16_f32 v140, v116, v117
    v_cvt_pk_bf16_f32 v141, v118, v119
    ds_read_b64_tr_b16 a[90:91], v4 offset:7008
    v_mfma_f32_16x16x32_bf16 v[128:131], a[160:163], a[48:51], v[128:131]
    buffer_load_dwordx4 v7, s[12:15], s46 offen offset:2048 lds
    s_add_u32 m0, s44, 101408
    s_add_u32 s64, s46, 12288
    s_mov_b32 s46, 2130706432
    s_cmp_eq_u32 s30, 0
    v_mfma_f32_16x16x32_bf16 v[132:135], a[160:163], a[52:55], v[132:135]
    v_cvt_pk_bf16_f32 v144, v120, v121
    v_cvt_pk_bf16_f32 v145, v122, v123
    s_cselect_b32 s46, s64, s46
    v_mfma_f32_16x16x32_bf16 v[136:139], a[160:163], a[56:59], v[136:139]
    buffer_load_dwordx4 v7, s[12:15], s46 offen offset:0 lds
    v_mfma_f32_16x16x32_bf16 v[128:131], a[164:167], a[60:63], v[128:131]
    v_cvt_pk_bf16_f32 v148, v124, v125
    v_cvt_pk_bf16_f32 v149, v126, v127
    v_mfma_f32_16x16x32_bf16 v[132:135], a[164:167], a[64:67], v[132:135]
    ds_read_b64_tr_b16 a[92:93], v5 offset:6272
    v_mfma_f32_16x16x32_bf16 v[136:139], a[164:167], a[68:71], v[136:139]
    ds_read_b64_tr_b16 a[94:95], v5 offset:7040
    v_mfma_f32_16x16x32_bf16 v[116:119], a[168:171], a[0:3], 0
    ds_read_b64_tr_b16 a[96:97], v4 offset:12416
    v_mfma_f32_16x16x32_bf16 v[120:123], a[168:171], a[4:7], 0
    buffer_load_dwordx4 v7, s[12:15], s46 offen offset:1024 lds
    v_mfma_f32_16x16x32_bf16 v[124:127], a[168:171], a[8:11], 0
    v_cvt_pk_bf16_f32 v142, v128, v129
    v_cvt_pk_bf16_f32 v143, v130, v131
    v_mfma_f32_16x16x32_bf16 v[116:119], a[172:175], a[12:15], v[116:119]
    ds_read_b64_tr_b16 a[98:99], v4 offset:13184
    v_mfma_f32_16x16x32_bf16 v[120:123], a[172:175], a[16:19], v[120:123]
    v_cvt_pk_bf16_f32 v146, v132, v133
    v_cvt_pk_bf16_f32 v147, v134, v135
    v_mfma_f32_16x16x32_bf16 v[124:127], a[172:175], a[20:23], v[124:127]
    ds_read_b64_tr_b16 a[100:101], v4 offset:12448
    ds_read_b64_tr_b16 a[102:103], v4 offset:13216
    v_mfma_f32_16x16x32_bf16 v[116:119], a[176:179], a[24:27], v[116:119]
    v_cvt_pk_bf16_f32 v150, v136, v137
    v_cvt_pk_bf16_f32 v151, v138, v139
    v_mfma_f32_16x16x32_bf16 v[120:123], a[176:179], a[28:31], v[120:123]
    buffer_load_dwordx4 v7, s[12:15], s46 offen offset:2048 lds
    v_mfma_f32_16x16x32_bf16 v[124:127], a[176:179], a[32:35], v[124:127]
    ds_read_b64_tr_b16 a[104:105], v5 offset:12480
    s_waitcnt lgkmcnt(7)
    v_mfma_f32_16x16x32_bf16 v[44:47], v[140:143], v[220:223], v[44:47]
    ds_read_b64_tr_b16 a[106:107], v5 offset:13248
    v_mfma_f32_16x16x32_bf16 v[48:51], v[144:147], v[220:223], v[48:51]
    ds_read_b64_tr_b16 a[108:109], v4 offset:18624
    v_mfma_f32_16x16x32_bf16 v[52:55], v[148:151], v[220:223], v[52:55]
    ds_read_b64_tr_b16 a[110:111], v4 offset:19392
    v_mfma_f32_16x16x32_bf16 v[128:131], a[168:171], a[36:39], 0
    ds_read_b64 v[216:217], v3 offset:6864
    v_mfma_f32_16x16x32_bf16 v[132:135], a[168:171], a[40:43], 0
    ds_read_b64 v[218:219], v3 offset:7392
    v_mfma_f32_16x16x32_bf16 v[136:139], a[168:171], a[44:47], 0
    v_cvt_pk_bf16_f32 v140, v116, v117
    v_cvt_pk_bf16_f32 v141, v118, v119
    v_mfma_f32_16x16x32_bf16 v[128:131], a[172:175], a[48:51], v[128:131]
    ds_read_b64_tr_b16 a[112:113], v4 offset:18656
    v_mfma_f32_16x16x32_bf16 v[132:135], a[172:175], a[52:55], v[132:135]
    v_cvt_pk_bf16_f32 v144, v120, v121
    v_cvt_pk_bf16_f32 v145, v122, v123
    v_mfma_f32_16x16x32_bf16 v[136:139], a[172:175], a[56:59], v[136:139]
    ds_read_b64_tr_b16 a[114:115], v4 offset:19424
    ds_read_b64_tr_b16 a[116:117], v5 offset:18688
    v_mfma_f32_16x16x32_bf16 v[128:131], a[176:179], a[60:63], v[128:131]
    v_cvt_pk_bf16_f32 v148, v124, v125
    v_cvt_pk_bf16_f32 v149, v126, v127
    v_mfma_f32_16x16x32_bf16 v[132:135], a[176:179], a[64:67], v[132:135]
    ds_read_b64_tr_b16 a[118:119], v5 offset:19456
    v_mfma_f32_16x16x32_bf16 v[136:139], a[176:179], a[68:71], v[136:139]
    ds_read_b64_tr_b16 a[120:121], v4 offset:24832
    v_mfma_f32_16x16x32_bf16 v[116:119], a[180:183], a[0:3], 0
    ds_read_b64_tr_b16 a[122:123], v4 offset:25600
    v_mfma_f32_16x16x32_bf16 v[120:123], a[180:183], a[4:7], 0
    ds_read_b64_tr_b16 a[124:125], v4 offset:24864
    v_mfma_f32_16x16x32_bf16 v[124:127], a[180:183], a[8:11], 0
    v_cvt_pk_bf16_f32 v142, v128, v129
    v_cvt_pk_bf16_f32 v143, v130, v131
    v_mfma_f32_16x16x32_bf16 v[116:119], a[184:187], a[12:15], v[116:119]
    ds_read_b64_tr_b16 a[126:127], v4 offset:25632
    v_mfma_f32_16x16x32_bf16 v[120:123], a[184:187], a[16:19], v[120:123]
    v_cvt_pk_bf16_f32 v146, v132, v133
    v_cvt_pk_bf16_f32 v147, v134, v135
    v_mfma_f32_16x16x32_bf16 v[124:127], a[184:187], a[20:23], v[124:127]
    ds_read_b64_tr_b16 a[128:129], v5 offset:24896
    v_mfma_f32_16x16x32_bf16 v[116:119], a[188:191], a[24:27], v[116:119]
    v_cvt_pk_bf16_f32 v150, v136, v137
    v_cvt_pk_bf16_f32 v151, v138, v139
    v_mfma_f32_16x16x32_bf16 v[120:123], a[188:191], a[28:31], v[120:123]
    ds_read_b64_tr_b16 a[130:131], v5 offset:25664
    v_mfma_f32_16x16x32_bf16 v[124:127], a[188:191], a[32:35], v[124:127]
    ds_read_b64_tr_b16 a[132:133], v4 offset:31040
    s_waitcnt lgkmcnt(7)
    v_mfma_f32_16x16x32_bf16 v[56:59], v[140:143], v[216:219], v[56:59]
    ds_read_b64_tr_b16 a[134:135], v4 offset:31808
    v_mfma_f32_16x16x32_bf16 v[60:63], v[144:147], v[216:219], v[60:63]
    v_mfma_f32_16x16x32_bf16 v[64:67], v[148:151], v[216:219], v[64:67]
    ds_read_b64_tr_b16 a[136:137], v4 offset:31072
    v_mfma_f32_16x16x32_bf16 v[128:131], a[180:183], a[36:39], 0
    ds_read_b64 v[220:221], v3 offset:11616
    v_mfma_f32_16x16x32_bf16 v[132:135], a[180:183], a[40:43], 0
    ds_read_b64 v[222:223], v3 offset:12144
    v_mfma_f32_16x16x32_bf16 v[136:139], a[180:183], a[44:47], 0
    v_cvt_pk_bf16_f32 v140, v116, v117
    v_cvt_pk_bf16_f32 v141, v118, v119
    v_mfma_f32_16x16x32_bf16 v[128:131], a[184:187], a[48:51], v[128:131]
    ds_read_b64_tr_b16 a[138:139], v4 offset:31840
    v_mfma_f32_16x16x32_bf16 v[132:135], a[184:187], a[52:55], v[132:135]
    v_cvt_pk_bf16_f32 v144, v120, v121
    v_cvt_pk_bf16_f32 v145, v122, v123
    v_mfma_f32_16x16x32_bf16 v[136:139], a[184:187], a[56:59], v[136:139]
    ds_read_b64_tr_b16 a[140:141], v5 offset:31104
    v_mfma_f32_16x16x32_bf16 v[128:131], a[188:191], a[60:63], v[128:131]
    v_cvt_pk_bf16_f32 v148, v124, v125
    v_cvt_pk_bf16_f32 v149, v126, v127
    v_mfma_f32_16x16x32_bf16 v[132:135], a[188:191], a[64:67], v[132:135]
    ds_read_b64_tr_b16 a[142:143], v5 offset:31872
    v_mfma_f32_16x16x32_bf16 v[136:139], a[188:191], a[68:71], v[136:139]
    v_add_u32 v4, -37248, v4
    v_add_u32 v5, -37248, v5
    v_mfma_f32_16x16x32_bf16 v[116:119], a[192:195], a[0:3], 0
    s_waitcnt vmcnt(0)
    s_barrier
    v_mfma_f32_16x16x32_bf16 v[120:123], a[192:195], a[4:7], 0
    ds_read_b64_tr_b16 v[180:181], v4 offset:0
    v_mfma_f32_16x16x32_bf16 v[124:127], a[192:195], a[8:11], 0
    v_cvt_pk_bf16_f32 v142, v128, v129
    v_cvt_pk_bf16_f32 v143, v130, v131
    v_mfma_f32_16x16x32_bf16 v[116:119], a[196:199], a[12:15], v[116:119]
    ds_read_b64_tr_b16 v[182:183], v4 offset:768
    v_mfma_f32_16x16x32_bf16 v[120:123], a[196:199], a[16:19], v[120:123]
    v_cvt_pk_bf16_f32 v146, v132, v133
    v_cvt_pk_bf16_f32 v147, v134, v135
    v_mfma_f32_16x16x32_bf16 v[124:127], a[196:199], a[20:23], v[124:127]
    ds_read_b64_tr_b16 v[184:185], v4 offset:32
    ds_read_b64_tr_b16 v[186:187], v4 offset:800
    v_mfma_f32_16x16x32_bf16 v[116:119], a[200:203], a[24:27], v[116:119]
    v_cvt_pk_bf16_f32 v150, v136, v137
    v_cvt_pk_bf16_f32 v151, v138, v139
    v_mfma_f32_16x16x32_bf16 v[120:123], a[200:203], a[28:31], v[120:123]
    ds_read_b64_tr_b16 v[188:189], v5 offset:64
    v_mfma_f32_16x16x32_bf16 v[124:127], a[200:203], a[32:35], v[124:127]
    ds_read_b64_tr_b16 v[190:191], v5 offset:832
    s_waitcnt lgkmcnt(7)
    v_mfma_f32_16x16x32_bf16 v[68:71], v[140:143], v[220:223], v[68:71]
    ds_read_b64_tr_b16 v[192:193], v4 offset:6208
    v_mfma_f32_16x16x32_bf16 v[72:75], v[144:147], v[220:223], v[72:75]
    ds_read_b64_tr_b16 v[194:195], v4 offset:6976
    v_mfma_f32_16x16x32_bf16 v[76:79], v[148:151], v[220:223], v[76:79]
    ds_read_b64_tr_b16 v[196:197], v4 offset:6240
    ds_read_b64_tr_b16 v[198:199], v4 offset:7008
    v_mfma_f32_16x16x32_bf16 v[128:131], a[192:195], a[36:39], 0
    ds_read_b64 v[216:217], v3 offset:16368
    ds_read_b64_tr_b16 v[200:201], v5 offset:6272
    v_mfma_f32_16x16x32_bf16 v[132:135], a[192:195], a[40:43], 0
    ds_read_b64 v[218:219], v3 offset:16896
    v_mfma_f32_16x16x32_bf16 v[136:139], a[192:195], a[44:47], 0
    v_cvt_pk_bf16_f32 v140, v116, v117
    v_cvt_pk_bf16_f32 v141, v118, v119
    v_mfma_f32_16x16x32_bf16 v[128:131], a[196:199], a[48:51], v[128:131]
    ds_read_b64_tr_b16 v[202:203], v5 offset:7040
    v_mfma_f32_16x16x32_bf16 v[132:135], a[196:199], a[52:55], v[132:135]
    v_cvt_pk_bf16_f32 v144, v120, v121
    v_cvt_pk_bf16_f32 v145, v122, v123
    v_mfma_f32_16x16x32_bf16 v[136:139], a[196:199], a[56:59], v[136:139]
    ds_read_b64_tr_b16 v[204:205], v4 offset:12416
    ds_read_b64_tr_b16 v[206:207], v4 offset:13184
    v_mfma_f32_16x16x32_bf16 v[128:131], a[200:203], a[60:63], v[128:131]
    v_cvt_pk_bf16_f32 v148, v124, v125
    v_cvt_pk_bf16_f32 v149, v126, v127
    v_mfma_f32_16x16x32_bf16 v[132:135], a[200:203], a[64:67], v[132:135]
    ds_read_b64_tr_b16 v[208:209], v4 offset:12448
    v_mfma_f32_16x16x32_bf16 v[136:139], a[200:203], a[68:71], v[136:139]
    ds_read_b64_tr_b16 v[210:211], v4 offset:13216
    v_mfma_f32_16x16x32_bf16 v[116:119], a[204:207], a[0:3], 0
    ds_read_b64_tr_b16 v[212:213], v5 offset:12480
    v_mfma_f32_16x16x32_bf16 v[120:123], a[204:207], a[4:7], 0
    ds_read_b64_tr_b16 v[214:215], v5 offset:13248
    v_mfma_f32_16x16x32_bf16 v[124:127], a[204:207], a[8:11], 0
    v_cvt_pk_bf16_f32 v142, v128, v129
    v_cvt_pk_bf16_f32 v143, v130, v131
    v_mfma_f32_16x16x32_bf16 v[116:119], a[208:211], a[12:15], v[116:119]
    s_mul_i32 s47, s30, 8064
    s_lshl_b32 s48, s29, 3
    v_mfma_f32_16x16x32_bf16 v[120:123], a[208:211], a[16:19], v[120:123]
    v_cvt_pk_bf16_f32 v146, v132, v133
    v_cvt_pk_bf16_f32 v147, v134, v135
    v_mfma_f32_16x16x32_bf16 v[124:127], a[208:211], a[20:23], v[124:127]
    v_bfe_u32 v38, v6, 4, 4
    s_add_u32 s47, s47, 0
    v_mfma_f32_16x16x32_bf16 v[116:119], a[212:215], a[24:27], v[116:119]
    v_cvt_pk_bf16_f32 v150, v136, v137
    v_cvt_pk_bf16_f32 v151, v138, v139
    v_mfma_f32_16x16x32_bf16 v[120:123], a[212:215], a[28:31], v[120:123]
    v_lshrrev_b32 v39, 8, v6
    v_mul_u32_u24 v17, 72, v38
    v_mfma_f32_16x16x32_bf16 v[124:127], a[212:215], a[32:35], v[124:127]
    v_mul_u32_u24 v16, s2, v38
    s_lshl2_add_u32 s49, s48, s47
    s_waitcnt lgkmcnt(7)
    v_mfma_f32_16x16x32_bf16 v[80:83], v[140:143], v[216:219], v[80:83]
    v_mfma_f32_16x16x32_bf16 v[84:87], v[144:147], v[216:219], v[84:87]
    v_lshl_add_u32 v17, v39, 3, v17
    v_mfma_f32_16x16x32_bf16 v[88:91], v[148:151], v[216:219], v[88:91]
    v_and_b32 v38, 1, v39
    v_mfma_f32_16x16x32_bf16 v[128:131], a[204:207], a[36:39], 0
    ds_read_b64 v[220:221], v3 offset:21120
    v_lshrrev_b32 v39, 1, v39
    v_mfma_f32_16x16x32_bf16 v[132:135], a[204:207], a[40:43], 0
    ds_read_b64 v[222:223], v3 offset:21648
    v_mfma_f32_16x16x32_bf16 v[136:139], a[204:207], a[44:47], 0
    v_cvt_pk_bf16_f32 v140, v116, v117
    v_cvt_pk_bf16_f32 v141, v118, v119
    v_mfma_f32_16x16x32_bf16 v[128:131], a[208:211], a[48:51], v[128:131]
    v_add_u32 v17, s49, v17
    v_lshl_add_u32 v38, v38, 1, v39
    v_mfma_f32_16x16x32_bf16 v[132:135], a[208:211], a[52:55], v[132:135]
    v_cvt_pk_bf16_f32 v144, v120, v121
    v_cvt_pk_bf16_f32 v145, v122, v123
    v_mfma_f32_16x16x32_bf16 v[136:139], a[208:211], a[56:59], v[136:139]
    v_lshrrev_b32 v39, 7, v6
    v_add_u32 v38, s48, v38
    v_mfma_f32_16x16x32_bf16 v[128:131], a[212:215], a[60:63], v[128:131]
    v_cvt_pk_bf16_f32 v148, v124, v125
    v_cvt_pk_bf16_f32 v149, v126, v127
    v_mfma_f32_16x16x32_bf16 v[132:135], a[212:215], a[64:67], v[132:135]
    v_add_u32 v39, s48, v39
    v_lshl_add_u32 v16, v38, 4, v16
    v_mfma_f32_16x16x32_bf16 v[136:139], a[212:215], a[68:71], v[136:139]
    v_bfe_u32 v38, v6, 1, 6
    s_branch L_S1_s1
L_S1_t1:
    s_setpc_b64 s[78:79]
L_S1_s1:
    v_mfma_f32_16x16x32_bf16 v[116:119], a[240:243], a[0:3], 0
    v_mul_u32_u24 v18, 72, v39
    v_mfma_f32_16x16x32_bf16 v[120:123], a[240:243], a[4:7], 0
    v_mul_u32_u24 v19, s2, v39
    v_mfma_f32_16x16x32_bf16 v[124:127], a[240:243], a[8:11], 0
    v_cvt_pk_bf16_f32 v142, v128, v129
    v_cvt_pk_bf16_f32 v143, v130, v131
    v_mfma_f32_16x16x32_bf16 v[116:119], a[244:247], a[12:15], v[116:119]
    v_add3_u32 v18, v18, s47, v38
    v_mfma_f32_16x16x32_bf16 v[120:123], a[244:247], a[16:19], v[120:123]
    v_cvt_pk_bf16_f32 v146, v132, v133
    v_cvt_pk_bf16_f32 v147, v134, v135
    v_mfma_f32_16x16x32_bf16 v[124:127], a[244:247], a[20:23], v[124:127]
    v_add3_u32 v19, v19, 64, v38
    s_mov_b32 s46, s31
    v_mfma_f32_16x16x32_bf16 v[116:119], a[248:251], a[24:27], v[116:119]
    v_cvt_pk_bf16_f32 v150, v136, v137
    v_cvt_pk_bf16_f32 v151, v138, v139
    v_mfma_f32_16x16x32_bf16 v[120:123], a[248:251], a[28:31], v[120:123]
    v_or3_b32 v228, v228, v229, v230
    v_or_b32 v228, v228, v231
    v_mfma_f32_16x16x32_bf16 v[124:127], a[248:251], a[32:35], v[124:127]
    s_nop 0
    s_waitcnt lgkmcnt(0)
    v_mfma_f32_16x16x32_bf16 v[92:95], v[140:143], v[220:223], v[92:95]
    v_readfirstlane_b32 s54, v228
    v_mfma_f32_16x16x32_bf16 v[96:99], v[144:147], v[220:223], v[96:99]
    v_lshrrev_b32 v12, 8, v6
    v_mfma_f32_16x16x32_bf16 v[100:103], v[148:151], v[220:223], v[100:103]
    v_mfma_f32_16x16x32_bf16 v[128:131], a[240:243], a[36:39], 0
    ds_read_b32 v216, v9 offset:2112
    v_cmp_eq_u32 s[60:61], 0, v12
    v_mfma_f32_16x16x32_bf16 v[132:135], a[240:243], a[40:43], 0
    ds_read_b32 v217, v10 offset:2112
    v_cmp_eq_u32 s[62:63], 1, v12
    v_mfma_f32_16x16x32_bf16 v[136:139], a[240:243], a[44:47], 0
    v_cvt_pk_bf16_f32 v140, v116, v117
    v_cvt_pk_bf16_f32 v141, v118, v119
    v_mfma_f32_16x16x32_bf16 v[128:131], a[244:247], a[48:51], v[128:131]
    ds_read_b32 v218, v9 offset:2640
    v_cmp_eq_u32 s[64:65], 2, v12
    v_mfma_f32_16x16x32_bf16 v[132:135], a[244:247], a[52:55], v[132:135]
    v_cvt_pk_bf16_f32 v144, v120, v121
    v_cvt_pk_bf16_f32 v145, v122, v123
    v_mfma_f32_16x16x32_bf16 v[136:139], a[244:247], a[56:59], v[136:139]
    ds_read_b32 v219, v10 offset:2640
    v_cndmask_b32 v172, 0, v167, s[60:61]
    v_mfma_f32_16x16x32_bf16 v[128:131], a[248:251], a[60:63], v[128:131]
    v_cvt_pk_bf16_f32 v148, v124, v125
    v_cvt_pk_bf16_f32 v149, v126, v127
    v_cndmask_b32 v173, 0, v167, s[62:63]
    v_cndmask_b32 v174, 0, v167, s[64:65]
    v_mfma_f32_16x16x32_bf16 v[132:135], a[248:251], a[64:67], v[132:135]
    v_mfma_f32_16x16x32_bf16 v[136:139], a[248:251], a[68:71], v[136:139]
    v_mfma_f32_16x16x32_bf16 v[116:119], a[228:231], a[72:75], 0
    s_mul_i32 s47, s30, 6656
    v_mfma_f32_16x16x32_bf16 v[120:123], a[228:231], a[76:79], 0
    v_lshrrev_b32 v26, 4, v6
    v_mfma_f32_16x16x32_bf16 v[124:127], a[228:231], a[80:83], 0
    v_cvt_pk_bf16_f32 v142, v128, v129
    v_cvt_pk_bf16_f32 v143, v130, v131
    v_mfma_f32_16x16x32_bf16 v[116:119], a[232:235], a[84:87], v[116:119]
    s_add_u32 s47, s47, 16128
    v_mfma_f32_16x16x32_bf16 v[120:123], a[232:235], a[88:91], v[120:123]
    v_cvt_pk_bf16_f32 v146, v132, v133
    v_cvt_pk_bf16_f32 v147, v134, v135
    v_mfma_f32_16x16x32_bf16 v[124:127], a[232:235], a[92:95], v[124:127]
    v_mul_u32_u24 v27, 43, v26
    v_mfma_f32_16x16x32_bf16 v[116:119], a[236:239], a[96:99], v[116:119]
    v_cvt_pk_bf16_f32 v150, v136, v137
    v_cvt_pk_bf16_f32 v151, v138, v139
    v_mfma_f32_16x16x32_bf16 v[120:123], a[236:239], a[100:103], v[120:123]
    v_add_u32 v28, 128, v26
    v_mfma_f32_16x16x32_bf16 v[124:127], a[236:239], a[104:107], v[124:127]
    s_lshl_b32 s48, s29, 3
    s_waitcnt lgkmcnt(0)
    v_mfma_f32_16x16x32_bf16 v[104:107], v[216:219], v[140:143], v[104:107]
    v_mfma_f32_16x16x32_bf16 v[108:111], v[216:219], v[144:147], v[108:111]
    v_lshrrev_b32 v27, 9, v27
    v_mfma_f32_16x16x32_bf16 v[112:115], v[216:219], v[148:151], v[112:115]
    v_mul_u32_u24 v29, 2731, v28
    v_mfma_f32_16x16x32_bf16 v[128:131], a[228:231], a[108:111], 0
    ds_read_b32 v220, v9 offset:3168
    v_mfma_f32_16x16x32_bf16 v[132:135], a[228:231], a[112:115], 0
    ds_read_b32 v221, v10 offset:3168
    v_mad_i32_i24 v26, v27, -12, v26
    v_mfma_f32_16x16x32_bf16 v[136:139], a[228:231], a[116:119], 0
    v_cvt_pk_bf16_f32 v140, v116, v117
    v_cvt_pk_bf16_f32 v141, v118, v119
    v_mfma_f32_16x16x32_bf16 v[128:131], a[232:235], a[120:123], v[128:131]
    ds_read_b32 v222, v9 offset:3696
    v_lshrrev_b32 v29, 16, v29
    v_mfma_f32_16x16x32_bf16 v[132:135], a[232:235], a[124:127], v[132:135]
    v_cvt_pk_bf16_f32 v144, v120, v121
    v_cvt_pk_bf16_f32 v145, v122, v123
    v_mfma_f32_16x16x32_bf16 v[136:139], a[232:235], a[128:131], v[136:139]
    ds_read_b32 v223, v10 offset:3696
    v_mfma_f32_16x16x32_bf16 v[128:131], a[236:239], a[132:135], v[128:131]
    v_cvt_pk_bf16_f32 v148, v124, v125
    v_cvt_pk_bf16_f32 v149, v126, v127
    v_mfma_f32_16x16x32_bf16 v[132:135], a[236:239], a[136:139], v[132:135]
    v_add_u32 v27, s48, v27
    v_mul_u32_u24 v30, 24, v29
    v_mfma_f32_16x16x32_bf16 v[136:139], a[236:239], a[140:143], v[136:139]
    v_mul_u32_u24 v22, 208, v27
    v_mfma_f32_16x16x32_bf16 v[116:119], a[168:171], a[72:75], 0
    v_sub_u32 v28, v28, v30
    v_mfma_f32_16x16x32_bf16 v[120:123], a[168:171], a[76:79], 0
    v_mfma_f32_16x16x32_bf16 v[124:127], a[168:171], a[80:83], 0
    v_cvt_pk_bf16_f32 v142, v128, v129
    v_cvt_pk_bf16_f32 v143, v130, v131
    v_mfma_f32_16x16x32_bf16 v[116:119], a[172:175], a[84:87], v[116:119]
    v_add_u32 v29, s48, v29
    v_mfma_f32_16x16x32_bf16 v[120:123], a[172:175], a[88:91], v[120:123]
    v_cvt_pk_bf16_f32 v146, v132, v133
    v_cvt_pk_bf16_f32 v147, v134, v135
    v_mfma_f32_16x16x32_bf16 v[124:127], a[172:175], a[92:95], v[124:127]
    v_mul_u32_u24 v24, s2, v27
    v_mfma_f32_16x16x32_bf16 v[116:119], a[176:179], a[96:99], v[116:119]
    v_cvt_pk_bf16_f32 v150, v136, v137
    v_cvt_pk_bf16_f32 v151, v138, v139
    v_mfma_f32_16x16x32_bf16 v[120:123], a[176:179], a[100:103], v[120:123]
    v_lshlrev_b32 v26, 4, v26
    v_mul_u32_u24 v23, 208, v29
    v_mfma_f32_16x16x32_bf16 v[124:127], a[176:179], a[104:107], v[124:127]
    s_waitcnt lgkmcnt(0)
    v_mfma_f32_16x16x32_bf16 v[104:107], v[220:223], v[140:143], v[104:107]
    v_mul_u32_u24 v25, s2, v29
    v_mfma_f32_16x16x32_bf16 v[108:111], v[220:223], v[144:147], v[108:111]
    v_mfma_f32_16x16x32_bf16 v[112:115], v[220:223], v[148:151], v[112:115]
    v_lshlrev_b32 v28, 3, v28
    v_mfma_f32_16x16x32_bf16 v[128:131], a[168:171], a[108:111], 0
    ds_read_b64 v[216:217], v3 offset:3168
    v_mfma_f32_16x16x32_bf16 v[132:135], a[168:171], a[112:115], 0
    ds_read_b64 v[218:219], v3 offset:3696
    v_mfma_f32_16x16x32_bf16 v[136:139], a[168:171], a[116:119], 0
    v_cvt_pk_bf16_f32 v140, v116, v117
    v_cvt_pk_bf16_f32 v141, v118, v119
    v_mfma_f32_16x16x32_bf16 v[128:131], a[172:175], a[120:123], v[128:131]
    v_add3_u32 v22, v22, s47, v26
    v_add_u32 v24, v24, v26
    v_mfma_f32_16x16x32_bf16 v[132:135], a[172:175], a[124:127], v[132:135]
    v_cvt_pk_bf16_f32 v144, v120, v121
    v_cvt_pk_bf16_f32 v145, v122, v123
    v_add3_u32 v23, v23, s47, v28
    v_mfma_f32_16x16x32_bf16 v[136:139], a[172:175], a[128:131], v[136:139]
    v_cvt_pk_bf16_f32 v154, v104, v105
    v_cvt_pk_bf16_f32 v155, v106, v107
    v_mfma_f32_16x16x32_bf16 v[128:131], a[176:179], a[132:135], v[128:131]
    v_cvt_pk_bf16_f32 v148, v124, v125
    v_cvt_pk_bf16_f32 v149, v126, v127
    v_mfma_f32_16x16x32_bf16 v[132:135], a[176:179], a[136:139], v[132:135]
    v_cvt_pk_bf16_f32 v158, v108, v109
    v_cvt_pk_bf16_f32 v159, v110, v111
    v_mfma_f32_16x16x32_bf16 v[136:139], a[176:179], a[140:143], v[136:139]
    v_cvt_pk_bf16_f32 v162, v112, v113
    v_cvt_pk_bf16_f32 v163, v114, v115
    v_mfma_f32_16x16x32_bf16 v[116:119], a[168:171], v[180:183], 0
    ds_read_b64 v[224:225], v3 offset:4224
    v_add_u32 v25, v25, v28
    v_mfma_f32_16x16x32_bf16 v[120:123], a[168:171], v[184:187], 0
    v_mov_b32 v226, v172
    v_mov_b32 v227, 0
    v_bfe_u32 v26, v6, 4, 4
    v_mfma_f32_16x16x32_bf16 v[124:127], a[168:171], v[188:191], 0
    v_cvt_pk_bf16_f32 v142, v128, v129
    v_cvt_pk_bf16_f32 v143, v130, v131
    v_mfma_f32_16x16x32_bf16 v[116:119], a[172:175], v[192:195], v[116:119]
    v_lshrrev_b32 v27, 8, v6
    v_mul_u32_u24 v26, 208, v26
    v_mfma_f32_16x16x32_bf16 v[120:123], a[172:175], v[196:199], v[120:123]
    v_cvt_pk_bf16_f32 v146, v132, v133
    v_cvt_pk_bf16_f32 v147, v134, v135
    v_mfma_f32_16x16x32_bf16 v[124:127], a[172:175], v[200:203], v[124:127]
    s_lshl4_add_u32 s49, s48, s47
    v_lshl_add_u32 v26, v27, 3, v26
    v_mfma_f32_16x16x32_bf16 v[116:119], a[176:179], v[204:207], v[116:119]
    v_cvt_pk_bf16_f32 v150, v136, v137
    v_cvt_pk_bf16_f32 v151, v138, v139
    v_mfma_f32_16x16x32_bf16 v[120:123], a[176:179], v[208:211], v[120:123]
    s_lshl2_add_u32 s48, s48, s47
    v_mfma_f32_16x16x32_bf16 v[124:127], a[176:179], v[212:215], v[124:127]
    v_add_u32 v20, s49, v26
    s_waitcnt lgkmcnt(1)
    v_mfma_f32_16x16x32_bf16 v[44:47], v[140:143], v[216:219], v[44:47]
    v_mfma_f32_16x16x32_bf16 v[48:51], v[144:147], v[216:219], v[48:51]
    v_add_u32 v21, s48, v26
    v_mfma_f32_16x16x32_bf16 v[52:55], v[148:151], v[216:219], v[52:55]
    v_mfma_f32_16x16x32_bf16 v[128:131], a[180:183], a[72:75], 0
    v_mfma_f32_16x16x32_bf16 v[132:135], a[180:183], a[76:79], 0
    v_mfma_f32_16x16x32_bf16 v[136:139], a[180:183], a[80:83], 0
    v_cvt_pk_bf16_f32 v152, v116, v117
    v_cvt_pk_bf16_f32 v153, v118, v119
    v_mfma_f32_16x16x32_bf16 v[128:131], a[184:187], a[84:87], v[128:131]
    v_mfma_f32_16x16x32_bf16 v[132:135], a[184:187], a[88:91], v[132:135]
    v_cvt_pk_bf16_f32 v156, v120, v121
    v_cvt_pk_bf16_f32 v157, v122, v123
    v_mfma_f32_16x16x32_bf16 v[136:139], a[184:187], a[92:95], v[136:139]
    v_mfma_f32_16x16x32_bf16 v[128:131], a[188:191], a[96:99], v[128:131]
    v_cvt_pk_bf16_f32 v160, v124, v125
    v_cvt_pk_bf16_f32 v161, v126, v127
    v_mfma_f32_16x16x32_bf16 v[132:135], a[188:191], a[100:103], v[132:135]
    v_mfma_f32_16x16x32_bf16 v[136:139], a[188:191], a[104:107], v[136:139]
    s_waitcnt lgkmcnt(0)
    v_mfma_f32_16x16x32_bf16 v[44:47], v[152:155], v[224:227], v[44:47]
    v_mfma_f32_16x16x32_bf16 v[48:51], v[156:159], v[224:227], v[48:51]
    v_mfma_f32_16x16x32_bf16 v[52:55], v[160:163], v[224:227], v[52:55]
    v_mfma_f32_16x16x32_bf16 v[116:119], a[180:183], a[108:111], 0
    ds_read_b64 v[220:221], v3 offset:7920
    v_mfma_f32_16x16x32_bf16 v[120:123], a[180:183], a[112:115], 0
    ds_read_b64 v[222:223], v3 offset:8448
    v_mfma_f32_16x16x32_bf16 v[124:127], a[180:183], a[116:119], 0
    v_cvt_pk_bf16_f32 v140, v128, v129
    v_cvt_pk_bf16_f32 v141, v130, v131
    v_mfma_f32_16x16x32_bf16 v[116:119], a[184:187], a[120:123], v[116:119]
    v_mfma_f32_16x16x32_bf16 v[120:123], a[184:187], a[124:127], v[120:123]
    v_cvt_pk_bf16_f32 v144, v132, v133
    v_cvt_pk_bf16_f32 v145, v134, v135
    v_mfma_f32_16x16x32_bf16 v[124:127], a[184:187], a[128:131], v[124:127]
    v_cvt_pk_bf16_f32 v32, v44, v45
    v_cvt_pk_bf16_f32 v33, v46, v47
    v_mfma_f32_16x16x32_bf16 v[116:119], a[188:191], a[132:135], v[116:119]
    v_cvt_pk_bf16_f32 v148, v136, v137
    v_cvt_pk_bf16_f32 v149, v138, v139
    v_mfma_f32_16x16x32_bf16 v[120:123], a[188:191], a[136:139], v[120:123]
    v_cvt_pk_bf16_f32 v34, v48, v49
    v_cvt_pk_bf16_f32 v35, v50, v51
    v_mfma_f32_16x16x32_bf16 v[124:127], a[188:191], a[140:143], v[124:127]
    v_cvt_pk_bf16_f32 v36, v52, v53
    v_cvt_pk_bf16_f32 v37, v54, v55
    v_mfma_f32_16x16x32_bf16 v[128:131], a[180:183], v[180:183], 0
    ds_read_b64 v[224:225], v3 offset:8976
    v_mfma_f32_16x16x32_bf16 v[132:135], a[180:183], v[184:187], 0
    v_mov_b32 v227, v172
    v_mov_b32 v226, 0
    v_mfma_f32_16x16x32_bf16 v[136:139], a[180:183], v[188:191], 0
    v_cvt_pk_bf16_f32 v142, v116, v117
    v_cvt_pk_bf16_f32 v143, v118, v119
    v_mfma_f32_16x16x32_bf16 v[128:131], a[184:187], v[192:195], v[128:131]
    v_permlane16_swap_b32 v32, v34
    v_permlane16_swap_b32 v33, v35
    v_mfma_f32_16x16x32_bf16 v[132:135], a[184:187], v[196:199], v[132:135]
    v_cvt_pk_bf16_f32 v146, v120, v121
    v_cvt_pk_bf16_f32 v147, v122, v123
    v_mfma_f32_16x16x32_bf16 v[136:139], a[184:187], v[200:203], v[136:139]
    ds_write_b64 v17, v[36:37] offset:0
    v_mfma_f32_16x16x32_bf16 v[128:131], a[188:191], v[204:207], v[128:131]
    v_cvt_pk_bf16_f32 v150, v124, v125
    v_cvt_pk_bf16_f32 v151, v126, v127
    v_mfma_f32_16x16x32_bf16 v[132:135], a[188:191], v[208:211], v[132:135]
    buffer_store_dwordx4 v[32:35], v16, s[16:19], s31 offen sc1
    s_add_u32 s31, s31, s55
    v_mfma_f32_16x16x32_bf16 v[136:139], a[188:191], v[212:215], v[136:139]
    s_waitcnt lgkmcnt(2)
    v_mfma_f32_16x16x32_bf16 v[56:59], v[140:143], v[220:223], v[56:59]
    v_mfma_f32_16x16x32_bf16 v[60:63], v[144:147], v[220:223], v[60:63]
    v_mfma_f32_16x16x32_bf16 v[64:67], v[148:151], v[220:223], v[64:67]
    v_mfma_f32_16x16x32_bf16 v[116:119], a[192:195], a[72:75], 0
    v_mfma_f32_16x16x32_bf16 v[120:123], a[192:195], a[76:79], 0
    v_mfma_f32_16x16x32_bf16 v[124:127], a[192:195], a[80:83], 0
    v_cvt_pk_bf16_f32 v152, v128, v129
    v_cvt_pk_bf16_f32 v153, v130, v131
    v_mfma_f32_16x16x32_bf16 v[116:119], a[196:199], a[84:87], v[116:119]
    v_mfma_f32_16x16x32_bf16 v[120:123], a[196:199], a[88:91], v[120:123]
    v_cvt_pk_bf16_f32 v156, v132, v133
    v_cvt_pk_bf16_f32 v157, v134, v135
    v_mfma_f32_16x16x32_bf16 v[124:127], a[196:199], a[92:95], v[124:127]
    v_mfma_f32_16x16x32_bf16 v[116:119], a[200:203], a[96:99], v[116:119]
    v_cvt_pk_bf16_f32 v160, v136, v137
    v_cvt_pk_bf16_f32 v161, v138, v139
    v_mfma_f32_16x16x32_bf16 v[120:123], a[200:203], a[100:103], v[120:123]
    v_mfma_f32_16x16x32_bf16 v[124:127], a[200:203], a[104:107], v[124:127]
    s_waitcnt lgkmcnt(1)
    v_mfma_f32_16x16x32_bf16 v[56:59], v[152:155], v[224:227], v[56:59]
    v_mfma_f32_16x16x32_bf16 v[60:63], v[156:159], v[224:227], v[60:63]
    v_mfma_f32_16x16x32_bf16 v[64:67], v[160:163], v[224:227], v[64:67]
    v_mfma_f32_16x16x32_bf16 v[128:131], a[192:195], a[108:111], 0
    ds_read_b64 v[216:217], v3 offset:12672
    v_mfma_f32_16x16x32_bf16 v[132:135], a[192:195], a[112:115], 0
    ds_read_b64 v[218:219], v3 offset:13200
    v_mfma_f32_16x16x32_bf16 v[136:139], a[192:195], a[116:119], 0
    v_cvt_pk_bf16_f32 v140, v116, v117
    v_cvt_pk_bf16_f32 v141, v118, v119
    v_mfma_f32_16x16x32_bf16 v[128:131], a[196:199], a[120:123], v[128:131]
    v_mfma_f32_16x16x32_bf16 v[132:135], a[196:199], a[124:127], v[132:135]
    v_cvt_pk_bf16_f32 v144, v120, v121
    v_cvt_pk_bf16_f32 v145, v122, v123
    v_mfma_f32_16x16x32_bf16 v[136:139], a[196:199], a[128:131], v[136:139]
    v_cvt_pk_bf16_f32 v32, v56, v57
    v_cvt_pk_bf16_f32 v33, v58, v59
    v_mfma_f32_16x16x32_bf16 v[128:131], a[200:203], a[132:135], v[128:131]
    v_cvt_pk_bf16_f32 v148, v124, v125
    v_cvt_pk_bf16_f32 v149, v126, v127
    v_mfma_f32_16x16x32_bf16 v[132:135], a[200:203], a[136:139], v[132:135]
    v_cvt_pk_bf16_f32 v34, v60, v61
    v_cvt_pk_bf16_f32 v35, v62, v63
    v_mfma_f32_16x16x32_bf16 v[136:139], a[200:203], a[140:143], v[136:139]
    v_cvt_pk_bf16_f32 v36, v64, v65
    v_cvt_pk_bf16_f32 v37, v66, v67
    v_mfma_f32_16x16x32_bf16 v[116:119], a[192:195], v[180:183], 0
    ds_read_b64 v[224:225], v3 offset:13728
    v_mfma_f32_16x16x32_bf16 v[120:123], a[192:195], v[184:187], 0
    v_mov_b32 v226, v173
    v_mov_b32 v227, 0
    v_mfma_f32_16x16x32_bf16 v[124:127], a[192:195], v[188:191], 0
    v_cvt_pk_bf16_f32 v142, v128, v129
    v_cvt_pk_bf16_f32 v143, v130, v131
    v_mfma_f32_16x16x32_bf16 v[116:119], a[196:199], v[192:195], v[116:119]
    v_permlane16_swap_b32 v32, v34
    v_permlane16_swap_b32 v33, v35
    v_mfma_f32_16x16x32_bf16 v[120:123], a[196:199], v[196:199], v[120:123]
    v_cvt_pk_bf16_f32 v146, v132, v133
    v_cvt_pk_bf16_f32 v147, v134, v135
    v_mfma_f32_16x16x32_bf16 v[124:127], a[196:199], v[200:203], v[124:127]
    ds_write_b64 v17, v[36:37] offset:1152
    v_mfma_f32_16x16x32_bf16 v[116:119], a[200:203], v[204:207], v[116:119]
    v_cvt_pk_bf16_f32 v150, v136, v137
    v_cvt_pk_bf16_f32 v151, v138, v139
    v_mfma_f32_16x16x32_bf16 v[120:123], a[200:203], v[208:211], v[120:123]
    buffer_store_dwordx4 v[32:35], v16, s[16:19], s31 offen sc1
    s_add_u32 s31, s31, s55
    v_mfma_f32_16x16x32_bf16 v[124:127], a[200:203], v[212:215], v[124:127]
    s_waitcnt lgkmcnt(2)
    v_mfma_f32_16x16x32_bf16 v[68:71], v[140:143], v[216:219], v[68:71]
    v_mfma_f32_16x16x32_bf16 v[72:75], v[144:147], v[216:219], v[72:75]
    v_mfma_f32_16x16x32_bf16 v[76:79], v[148:151], v[216:219], v[76:79]
    v_mfma_f32_16x16x32_bf16 v[128:131], a[204:207], a[72:75], 0
    v_mfma_f32_16x16x32_bf16 v[132:135], a[204:207], a[76:79], 0
    v_mfma_f32_16x16x32_bf16 v[136:139], a[204:207], a[80:83], 0
    v_cvt_pk_bf16_f32 v152, v116, v117
    v_cvt_pk_bf16_f32 v153, v118, v119
    v_mfma_f32_16x16x32_bf16 v[128:131], a[208:211], a[84:87], v[128:131]
    v_mfma_f32_16x16x32_bf16 v[132:135], a[208:211], a[88:91], v[132:135]
    v_cvt_pk_bf16_f32 v156, v120, v121
    v_cvt_pk_bf16_f32 v157, v122, v123
    v_mfma_f32_16x16x32_bf16 v[136:139], a[208:211], a[92:95], v[136:139]
    v_mfma_f32_16x16x32_bf16 v[128:131], a[212:215], a[96:99], v[128:131]
    v_cvt_pk_bf16_f32 v160, v124, v125
    v_cvt_pk_bf16_f32 v161, v126, v127
    v_mfma_f32_16x16x32_bf16 v[132:135], a[212:215], a[100:103], v[132:135]
    v_mfma_f32_16x16x32_bf16 v[136:139], a[212:215], a[104:107], v[136:139]
    s_waitcnt lgkmcnt(1)
    v_mfma_f32_16x16x32_bf16 v[68:71], v[152:155], v[224:227], v[68:71]
    v_mfma_f32_16x16x32_bf16 v[72:75], v[156:159], v[224:227], v[72:75]
    v_mfma_f32_16x16x32_bf16 v[76:79], v[160:163], v[224:227], v[76:79]
    v_mfma_f32_16x16x32_bf16 v[116:119], a[204:207], a[108:111], 0
    ds_read_b64 v[220:221], v3 offset:17424
    v_mfma_f32_16x16x32_bf16 v[120:123], a[204:207], a[112:115], 0
    ds_read_b64 v[222:223], v3 offset:17952
    v_mfma_f32_16x16x32_bf16 v[124:127], a[204:207], a[116:119], 0
    v_cvt_pk_bf16_f32 v140, v128, v129
    v_cvt_pk_bf16_f32 v141, v130, v131
    v_mfma_f32_16x16x32_bf16 v[116:119], a[208:211], a[120:123], v[116:119]
    v_mfma_f32_16x16x32_bf16 v[120:123], a[208:211], a[124:127], v[120:123]
    v_cvt_pk_bf16_f32 v144, v132, v133
    v_cvt_pk_bf16_f32 v145, v134, v135
    v_mfma_f32_16x16x32_bf16 v[124:127], a[208:211], a[128:131], v[124:127]
    v_cvt_pk_bf16_f32 v32, v68, v69
    v_cvt_pk_bf16_f32 v33, v70, v71
    v_mfma_f32_16x16x32_bf16 v[116:119], a[212:215], a[132:135], v[116:119]
    v_cvt_pk_bf16_f32 v148, v136, v137
    v_cvt_pk_bf16_f32 v149, v138, v139
    v_mfma_f32_16x16x32_bf16 v[120:123], a[212:215], a[136:139], v[120:123]
    v_cvt_pk_bf16_f32 v34, v72, v73
    v_cvt_pk_bf16_f32 v35, v74, v75
    v_mfma_f32_16x16x32_bf16 v[124:127], a[212:215], a[140:143], v[124:127]
    v_cvt_pk_bf16_f32 v36, v76, v77
    v_cvt_pk_bf16_f32 v37, v78, v79
    v_mfma_f32_16x16x32_bf16 v[128:131], a[204:207], v[180:183], 0
    ds_read_b64 v[224:225], v3 offset:18480
    v_mfma_f32_16x16x32_bf16 v[132:135], a[204:207], v[184:187], 0
    v_mov_b32 v227, v173
    v_mov_b32 v226, 0
    v_mfma_f32_16x16x32_bf16 v[136:139], a[204:207], v[188:191], 0
    v_cvt_pk_bf16_f32 v142, v116, v117
    v_cvt_pk_bf16_f32 v143, v118, v119
    v_mfma_f32_16x16x32_bf16 v[128:131], a[208:211], v[192:195], v[128:131]
    v_permlane16_swap_b32 v32, v34
    v_permlane16_swap_b32 v33, v35
    v_mfma_f32_16x16x32_bf16 v[132:135], a[208:211], v[196:199], v[132:135]
    v_cvt_pk_bf16_f32 v146, v120, v121
    v_cvt_pk_bf16_f32 v147, v122, v123
    v_mfma_f32_16x16x32_bf16 v[136:139], a[208:211], v[200:203], v[136:139]
    ds_write_b64 v17, v[36:37] offset:2304
    v_mfma_f32_16x16x32_bf16 v[128:131], a[212:215], v[204:207], v[128:131]
    v_cvt_pk_bf16_f32 v150, v124, v125
    v_cvt_pk_bf16_f32 v151, v126, v127
    v_mfma_f32_16x16x32_bf16 v[132:135], a[212:215], v[208:211], v[132:135]
    buffer_store_dwordx4 v[32:35], v16, s[16:19], s31 offen sc1
    s_add_u32 s31, s31, s55
    v_mfma_f32_16x16x32_bf16 v[136:139], a[212:215], v[212:215], v[136:139]
    s_waitcnt lgkmcnt(2)
    v_mfma_f32_16x16x32_bf16 v[80:83], v[140:143], v[220:223], v[80:83]
    v_mfma_f32_16x16x32_bf16 v[84:87], v[144:147], v[220:223], v[84:87]
    v_mfma_f32_16x16x32_bf16 v[88:91], v[148:151], v[220:223], v[88:91]
    v_mfma_f32_16x16x32_bf16 v[116:119], a[216:219], a[72:75], 0
    s_waitcnt lgkmcnt(0)
    s_barrier
    v_mfma_f32_16x16x32_bf16 v[120:123], a[216:219], a[76:79], 0
    ds_read_b64 v[38:39], v18 offset:0
    v_mfma_f32_16x16x32_bf16 v[124:127], a[216:219], a[80:83], 0
    v_cvt_pk_bf16_f32 v152, v128, v129
    v_cvt_pk_bf16_f32 v153, v130, v131
    v_mfma_f32_16x16x32_bf16 v[116:119], a[220:223], a[84:87], v[116:119]
    ds_read_b64 v[40:41], v18 offset:1152
    v_mfma_f32_16x16x32_bf16 v[120:123], a[220:223], a[88:91], v[120:123]
    v_cvt_pk_bf16_f32 v156, v132, v133
    v_cvt_pk_bf16_f32 v157, v134, v135
    v_mfma_f32_16x16x32_bf16 v[124:127], a[220:223], a[92:95], v[124:127]
    ds_read_b64 v[42:43], v18 offset:2304
    v_mfma_f32_16x16x32_bf16 v[116:119], a[224:227], a[96:99], v[116:119]
    v_cvt_pk_bf16_f32 v160, v136, v137
    v_cvt_pk_bf16_f32 v161, v138, v139
    v_mfma_f32_16x16x32_bf16 v[120:123], a[224:227], a[100:103], v[120:123]
    v_mfma_f32_16x16x32_bf16 v[124:127], a[224:227], a[104:107], v[124:127]
    v_mfma_f32_16x16x32_bf16 v[80:83], v[152:155], v[224:227], v[80:83]
    v_mfma_f32_16x16x32_bf16 v[84:87], v[156:159], v[224:227], v[84:87]
    s_waitcnt lgkmcnt(2)
    buffer_store_dwordx2 v[38:39], v19, s[16:19], s46 offen sc1
    s_add_u32 s46, s46, s55
    v_mfma_f32_16x16x32_bf16 v[88:91], v[160:163], v[224:227], v[88:91]
    v_mfma_f32_16x16x32_bf16 v[128:131], a[216:219], a[108:111], 0
    ds_read_b64 v[216:217], v3 offset:22176
    v_mfma_f32_16x16x32_bf16 v[132:135], a[216:219], a[112:115], 0
    ds_read_b64 v[218:219], v3 offset:22704
    v_mfma_f32_16x16x32_bf16 v[136:139], a[216:219], a[116:119], 0
    v_cvt_pk_bf16_f32 v140, v116, v117
    v_cvt_pk_bf16_f32 v141, v118, v119
    v_mfma_f32_16x16x32_bf16 v[128:131], a[220:223], a[120:123], v[128:131]
    s_waitcnt lgkmcnt(3)
    buffer_store_dwordx2 v[40:41], v19, s[16:19], s46 offen sc1
    s_add_u32 s46, s46, s55
    v_mfma_f32_16x16x32_bf16 v[132:135], a[220:223], a[124:127], v[132:135]
    v_cvt_pk_bf16_f32 v144, v120, v121
    v_cvt_pk_bf16_f32 v145, v122, v123
    v_mfma_f32_16x16x32_bf16 v[136:139], a[220:223], a[128:131], v[136:139]
    v_cvt_pk_bf16_f32 v32, v80, v81
    v_cvt_pk_bf16_f32 v33, v82, v83
    v_mfma_f32_16x16x32_bf16 v[128:131], a[224:227], a[132:135], v[128:131]
    v_cvt_pk_bf16_f32 v148, v124, v125
    v_cvt_pk_bf16_f32 v149, v126, v127
    v_mfma_f32_16x16x32_bf16 v[132:135], a[224:227], a[136:139], v[132:135]
    s_waitcnt lgkmcnt(2)
    buffer_store_dwordx2 v[42:43], v19, s[16:19], s46 offen sc1
    s_add_u32 s46, s46, s55
    v_mfma_f32_16x16x32_bf16 v[136:139], a[224:227], a[140:143], v[136:139]
    v_cvt_pk_bf16_f32 v34, v84, v85
    v_cvt_pk_bf16_f32 v35, v86, v87
    v_mfma_f32_16x16x32_bf16 v[116:119], a[216:219], v[180:183], 0
    ds_read_b64 v[224:225], v3 offset:23232
    v_mfma_f32_16x16x32_bf16 v[120:123], a[216:219], v[184:187], 0
    v_mov_b32 v226, v174
    v_mov_b32 v227, 0
    v_mfma_f32_16x16x32_bf16 v[124:127], a[216:219], v[188:191], 0
    v_cvt_pk_bf16_f32 v142, v128, v129
    v_cvt_pk_bf16_f32 v143, v130, v131
    v_mfma_f32_16x16x32_bf16 v[116:119], a[220:223], v[192:195], v[116:119]
    v_cvt_pk_bf16_f32 v36, v88, v89
    v_cvt_pk_bf16_f32 v37, v90, v91
    v_mfma_f32_16x16x32_bf16 v[120:123], a[220:223], v[196:199], v[120:123]
    v_cvt_pk_bf16_f32 v146, v132, v133
    v_cvt_pk_bf16_f32 v147, v134, v135
    v_mfma_f32_16x16x32_bf16 v[124:127], a[220:223], v[200:203], v[124:127]
    v_permlane16_swap_b32 v32, v34
    v_permlane16_swap_b32 v33, v35
    v_mfma_f32_16x16x32_bf16 v[116:119], a[224:227], v[204:207], v[116:119]
    v_cvt_pk_bf16_f32 v150, v136, v137
    v_cvt_pk_bf16_f32 v151, v138, v139
    v_mfma_f32_16x16x32_bf16 v[120:123], a[224:227], v[208:211], v[120:123]
    ds_write_b64 v17, v[36:37] offset:3456
    v_mfma_f32_16x16x32_bf16 v[124:127], a[224:227], v[212:215], v[124:127]
    buffer_store_dwordx4 v[32:35], v16, s[16:19], s31 offen sc1
    s_add_u32 s31, s31, s55
    s_waitcnt lgkmcnt(2)
    v_mfma_f32_16x16x32_bf16 v[92:95], v[140:143], v[216:219], v[92:95]
    v_mfma_f32_16x16x32_bf16 v[96:99], v[144:147], v[216:219], v[96:99]
    v_mfma_f32_16x16x32_bf16 v[100:103], v[148:151], v[216:219], v[100:103]
    v_cvt_pk_bf16_f32 v152, v116, v117
    v_cvt_pk_bf16_f32 v153, v118, v119
    v_cvt_pk_bf16_f32 v156, v120, v121
    v_cvt_pk_bf16_f32 v157, v122, v123
    v_cvt_pk_bf16_f32 v160, v124, v125
    v_cvt_pk_bf16_f32 v161, v126, v127
    s_waitcnt lgkmcnt(1)
    v_mfma_f32_16x16x32_bf16 v[92:95], v[152:155], v[224:227], v[92:95]
    v_mfma_f32_16x16x32_bf16 v[96:99], v[156:159], v[224:227], v[96:99]
    v_mfma_f32_16x16x32_bf16 v[100:103], v[160:163], v[224:227], v[100:103]
    s_cmp_lg_u32 s54, 0
    s_nop 4
    v_cvt_pk_bf16_f32 v32, v92, v93
    v_cvt_pk_bf16_f32 v33, v94, v95
    v_cvt_pk_bf16_f32 v34, v96, v97
    v_cvt_pk_bf16_f32 v35, v98, v99
    ds_write_b64 v20, v[32:33] offset:0
    v_cvt_pk_bf16_f32 v36, v100, v101
    v_cvt_pk_bf16_f32 v37, v102, v103
    ds_write_b64 v20, v[34:35] offset:32
    ds_write_b64 v21, v[36:37] offset:64
    s_waitcnt lgkmcnt(0)
    s_barrier
    ds_read_b64 v[38:39], v18 offset:3456
    ds_read_b128 v[26:29], v22 offset:0
    ds_read_b64 v[30:31], v23 offset:0
    s_waitcnt lgkmcnt(2)
    buffer_store_dwordx2 v[38:39], v19, s[16:19], s46 offen sc1
    s_waitcnt lgkmcnt(1)
    buffer_store_dwordx4 v[26:29], v24, s[16:19], s31 offen sc1
    s_waitcnt lgkmcnt(0)
    buffer_store_dwordx2 v[30:31], v25, s[16:19], s31 offen sc1
    s_cbranch_scc0 L_end
L_gS:
    s_waitcnt vmcnt(0)
    s_barrier
    s_branch L_gW
.p2align 12
L_P:
    v_and_b32 v34, 28, v32
    s_add_u32 m0, s33, 7808
    s_min_i32 s39, s20, s21
    s_add_u32 s20, s20, s55
    buffer_load_dwordx4 v8, s[4:7], s39 offen lds
    v_mov_b32 v35, 0
    v_add_u32 v34, 163488, v34
    s_cmp_eq_u32 s56, 0
    ds_write_b32 v34, v35
    s_mov_b32 s57, 0x4000002
    s_cselect_b32 s57, 0x40002, s57
    s_cselect_b32 s35, 4.0, 0
    s_cselect_b32 s32, 0, 4.0
    s_cselect_b64 vcc, -1, 0
    s_cselect_b32 s47, 1, 0
    s_mul_i32 s48, s56, 244
    s_movk_i32 s49, 244
    v_mad_u32_u24 v56, v39, s56, v40
    v_mad_u32_u24 v59, v39, s47, v41
    v_cndmask_b32 v104, v40, v41, vcc
    v_add_u32 v56, 1, v56
    v_mul_u32_u24 v59, s49, v59
    v_cndmask_b32 v105, v41, v40, vcc
    v_add_u32 v57, s47, v56
    v_add_u32 v104, v104, v39
    s_add_u32 m0, s33, 11712
    s_min_i32 s39, s20, s21
    s_add_u32 s20, s20, s55
    buffer_load_dwordx4 v8, s[4:7], s39 offen lds
    v_add_u32 v58, s47, v57
    v_lshl_or_b32 v24, v105, 8, v104
    v_bfe_u32 v60, v56, 2, 2
    v_bfe_u32 v61, v57, 2, 2
    v_bfe_u32 v62, v58, 2, 2
    v_mad_u32_u24 v56, v56, 12, v60
    v_mad_u32_u24 v57, v57, 12, v61
    v_mad_u32_u24 v58, v58, 12, v62
    v_cvt_f32_u32 v104, v104
    v_cvt_f32_u32 v105, v105
    v_add3_u32 v56, v56, v59, s70
    s_add_u32 s70, s70, s48
    v_add3_u32 v57, v57, v59, s70
    s_add_u32 m0, s33, 15616
    s_min_i32 s39, s20, s21
    s_add_u32 s20, s20, s55
    buffer_load_dwordx4 v8, s[4:7], s39 offen lds
    s_add_u32 s70, s70, s48
    v_add3_u32 v58, v58, v59, s70
    s_add_u32 s70, s70, s48
    v_mov_b32 v59, 0x3d00000
    s_mov_b32 s47, 0x10001
    v_add_f32 v104, s68, v104
    v_add_f32 v105, s69, v105
    v_mad_u32_u24 v80, v56, s47, v59
    v_add_u32 v81, 1952, v56
    v_mad_u32_u24 v82, v57, s47, v59
    v_add_u32 v83, 1952, v57
    v_mad_u32_u24 v84, v58, s47, v59
    v_add_u32 v85, 1952, v58
    s_add_u32 m0, s33, 19520
    s_min_i32 s39, s20, s21
    s_add_u32 s20, s20, s55
    buffer_load_dwordx4 v8, s[4:7], s39 offen lds
    s_waitcnt vmcnt(10)
    v_lshrrev_b32 v23, 16, v167
    v_and_b32 v25, 0xffff, v167
    v_lshl_add_u32 v23, v40, 4, v23
    v_add_f32 v106, 1.0, v105
    v_lshl_or_b32 v24, v24, 16, v23
    v_add_u32 v23, 103008, v23
    v_add_f32 v107, 2.0, v105
    s_mov_b32 exec_hi, 0xffff
    ds_write_b64 v23, v[80:81] offset:0
    ds_write_b64 v23, v[82:83] offset:256
    ds_write_b64 v23, v[84:85] offset:512
    s_mov_b32 exec_hi, -1
    s_lshl_b32 s42, s56, 4
    s_add_u32 s44, s44, 107616
    s_mul_i32 s45, s30, 3104
    s_lshl_b32 s47, s29, 10
    s_add_u32 m0, s33, 23424
    s_min_i32 s39, s20, s21
    s_add_u32 s20, s20, s55
    buffer_load_dwordx4 v8, s[4:7], s39 offen lds
    s_add_u32 s45, s45, s47
    s_add_u32 s45, s45, 120032
    s_mul_i32 s48, s30, 3072
    s_add_u32 s47, s47, s48
    s_add_u32 s47, s47, 12288
    v_add_u32 v26, s47, v6
    s_mul_i32 s47, s30, 2304
    s_add_u32 s47, s47, 103008
    v_lshl_add_u32 v172, v165, 4, s47
    v_add_u32 v173, 16, v164
    v_mov_b32 v174, 0xf400f40
    s_lshl_b32 s48, s29, 7
    s_lshl_b32 s49, s29, 5
    s_add_u32 s47, s48, 107616
    v_add_u32_sdwa v4, s47, v16 dst_sel:DWORD dst_unused:UNUSED_PAD src0_sel:DWORD src1_sel:WORD_0
    s_add_u32 s47, s49, 107616
    v_add_u32_sdwa v5, s47, v16 dst_sel:DWORD dst_unused:UNUSED_PAD src0_sel:DWORD src1_sel:WORD_0
    v_mov_b32 v14, 163488
    s_lshl_b32 s38, s28, 12
    s_add_u32 s38, s38, 144864
    s_lshl_b32 s47, s30, 2
    s_cselect_b32 s31, s27, s26
    s_lshr_b32 s36, s22, s47
    s_and_b32 s36, s36, 15
    s_mov_b32 s52, 0x435f435f
    s_mov_b32 s46, 0
    s_waitcnt lgkmcnt(0)
    s_barrier
    v_cvt_pk_bf16_f32 v180, v104, v105
    v_cvt_pk_bf16_f32 v181, v104, v106
    v_cvt_pk_bf16_f32 v182, v104, v107
    v_pk_max_i16 v180, v180, 0
    v_pk_max_i16 v181, v181, 0
    v_pk_max_i16 v182, v182, 0
    v_mov_b32 v204, 0
    s_cmp_lt_u32 s72, 8
    s_cbranch_scc1 L_Pv
    s_add_u32 m0, s33, 27328
    s_min_i32 s47, s20, s21
    s_add_u32 s20, s20, s55
    buffer_load_dwordx4 v8, s[4:7], s47 offen lds
    s_waitcnt vmcnt(9)
L_Pv2:
    v_lshlrev_b32 v56, 16, v232
    v_lshlrev_b32 v58, 16, v233
    v_lshlrev_b32 v60, 16, v234
    v_and_b32 v57, 0xffff0000, v232
    v_and_b32 v59, 0xffff0000, v233
    v_and_b32 v61, 0xffff0000, v234
    v_add_f32 v56, v56, v104
    v_add_f32 v58, v58, v104
    v_add_f32 v60, v60, v104
    v_add_f32 v57, v57, v105
    v_add_f32 v59, v59, v106
    v_add_f32 v61, v61, v107
    v_cvt_pk_bf16_f32 v56, v56, v57
    v_cvt_pk_bf16_f32 v58, v58, v59
    v_cvt_pk_bf16_f32 v60, v60, v61
    v_pk_max_i16 v56, v56, 0
    v_pk_max_i16 v58, v58, 0
    v_pk_max_i16 v60, v60, 0
    v_cmp_ne_u32 s[58:59], v56, v180
    v_cmp_ne_u32 s[60:61], v58, v181
    v_cmp_ne_u32 s[62:63], v60, v182
    s_cmp_le_u32 s75, 4
    s_cbranch_scc0 L_Ps
    v_addc_co_u32 v205, vcc, 0, v204, s[58:59]
    v_addc_co_u32 v206, vcc, 0, v205, s[60:61]
    v_addc_co_u32 v213, vcc, 0, v206, s[62:63]
    s_branch L_Pk
L_Pv:
    s_waitcnt vmcnt(8)
    s_cmp_le_u32 s72, 7
    s_cbranch_scc1 L_l1
    s_add_u32 m0, s33, 27328
    s_min_i32 s47, s20, s21
    s_add_u32 s20, s20, s55
    buffer_load_dwordx4 v8, s[4:7], s47 offen lds
L_l1:
    s_branch L_Pv2
L_Ps:
    v_lshlrev_b32 v56, 16, v236
    v_add_f32 v108, s35, v104
    s_cmp_le_u32 s72, 8
    s_cbranch_scc1 L_l2
    s_add_u32 m0, s33, 31232
    s_min_i32 s47, s20, s21
    s_add_u32 s20, s20, s55
    buffer_load_dwordx4 v8, s[4:7], s47 offen lds
L_l2:
    v_addc_co_u32 v205, vcc, 0, v204, s[58:59]
    v_lshlrev_b32 v58, 16, v237
    v_add_f32 v109, s32, v105
    v_lshlrev_b32 v60, 16, v238
    v_addc_co_u32 v206, vcc, 0, v205, s[60:61]
    v_add_f32 v110, s32, v106
    v_and_b32 v57, 0xffff0000, v236
    v_add_f32 v111, s32, v107
    v_addc_co_u32 v207, vcc, 0, v206, s[62:63]
    v_and_b32 v59, 0xffff0000, v237
    v_cvt_pk_bf16_f32 v183, v108, v109
    v_and_b32 v61, 0xffff0000, v238
    v_cvt_pk_bf16_f32 v184, v108, v110
    v_add_f32 v56, v56, v108
    v_cvt_pk_bf16_f32 v185, v108, v111
    v_add_f32 v58, v58, v108
    v_pk_max_i16 v183, v183, 0
    v_add_f32 v60, v60, v108
    v_pk_max_i16 v184, v184, 0
    v_add_f32 v57, v57, v109
    v_pk_max_i16 v185, v185, 0
    v_add_f32 v59, v59, v110
    s_cmp_le_u32 s72, 9
    s_cbranch_scc1 L_l3
    s_add_u32 m0, s33, 35136
    s_min_i32 s47, s20, s21
    s_add_u32 s20, s20, s55
    buffer_load_dwordx4 v8, s[4:7], s47 offen lds
L_l3:
    v_add_f32 v61, v61, v111
    v_cvt_pk_bf16_f32 v56, v56, v57
    v_cvt_pk_bf16_f32 v58, v58, v59
    v_cvt_pk_bf16_f32 v60, v60, v61
    v_pk_max_i16 v56, v56, 0
    v_pk_max_i16 v58, v58, 0
    v_pk_max_i16 v60, v60, 0
    v_cmp_ne_u32 s[64:65], v56, v183
    v_cmp_ne_u32 s[66:67], v58, v184
    v_cmp_ne_u32 s[76:77], v60, v185
    v_lshlrev_b32 v56, 16, v240
    v_add_f32 v112, s35, v108
    v_addc_co_u32 v208, vcc, 0, v207, s[64:65]
    v_lshlrev_b32 v58, 16, v241
    v_add_f32 v113, s32, v109
    v_lshlrev_b32 v60, 16, v242
    v_addc_co_u32 v209, vcc, 0, v208, s[66:67]
    v_add_f32 v114, s32, v110
    v_and_b32 v57, 0xffff0000, v240
    v_add_f32 v115, s32, v111
    v_addc_co_u32 v210, vcc, 0, v209, s[76:77]
    v_and_b32 v59, 0xffff0000, v241
    s_cmp_le_u32 s72, 10
    s_cbranch_scc1 L_l4
    s_add_u32 m0, s33, 39040
    s_min_i32 s47, s20, s21
    s_add_u32 s20, s20, s55
    buffer_load_dwordx4 v8, s[4:7], s47 offen lds
L_l4:
    v_cvt_pk_bf16_f32 v186, v112, v113
    v_and_b32 v61, 0xffff0000, v242
    v_cvt_pk_bf16_f32 v187, v112, v114
    v_add_f32 v56, v56, v112
    v_cvt_pk_bf16_f32 v188, v112, v115
    v_add_f32 v58, v58, v112
    v_pk_max_i16 v186, v186, 0
    v_add_f32 v60, v60, v112
    v_pk_max_i16 v187, v187, 0
    v_add_f32 v57, v57, v113
    v_pk_max_i16 v188, v188, 0
    v_add_f32 v59, v59, v114
    v_add_f32 v61, v61, v115
    v_cvt_pk_bf16_f32 v56, v56, v57
    v_cvt_pk_bf16_f32 v58, v58, v59
    v_cvt_pk_bf16_f32 v60, v60, v61
    v_pk_max_i16 v56, v56, 0
    v_pk_max_i16 v58, v58, 0
    v_pk_max_i16 v60, v60, 0
    v_cmp_ne_u32 s[78:79], v56, v186
    v_cmp_ne_u32 s[0:1], v58, v187
    v_cmp_ne_u32 s[50:51], v60, v188
    v_addc_co_u32 v211, vcc, 0, v210, s[78:79]
    v_addc_co_u32 v212, vcc, 0, v211, s[0:1]
    v_addc_co_u32 v213, vcc, 0, v212, s[50:51]
L_Pk:
    v_mov_b32 v67, v213
    v_add_u32 v192, 0x0, v24
    v_add_u32 v193, 0x1000100, v24
    v_add_u32_dpp v67, v67, v67 row_shr:1 row_mask:0xf bank_mask:0xf bound_ctrl:0
    v_add_u32 v194, 0x2000200, v24
    v_add_u32 v195, s57, v192
    v_add_u32_dpp v67, v67, v67 row_shr:2 row_mask:0xf bank_mask:0xf bound_ctrl:0
    v_add_u32 v196, s57, v193
    v_add_u32 v197, s57, v194
    v_add_u32_dpp v67, v67, v67 row_shr:4 row_mask:0xf bank_mask:0xf bound_ctrl:0
    v_add_u32 v198, s57, v195
    v_add_u32 v199, s57, v196
    v_add_u32_dpp v67, v67, v67 row_shr:8 row_mask:0xf bank_mask:0xf bound_ctrl:0
    v_add_u32 v200, s57, v197
    s_add_u32 s49, s38, 2048
    v_add_u32_dpp v67, v67, v67 row_bcast:15 row_mask:0xa bank_mask:0xf
    v_mov_b32 v69, 163504
    v_lshrrev_b32 v82, 4, v6
    v_add_u32_dpp v67, v67, v67 row_bcast:31 row_mask:0xc bank_mask:0xf
    s_mov_b32 s39, 0
    v_readlane_b32 s37, v67, 63
    v_sub_u32 v67, v67, v213
    v_lshl_add_u32 v68, v67, 3, s49
    s_sub_u32 s32, s37, 1
    v_mov_b32 v78, s37
    s_cmpk_ge_u32 s32, 128
    s_cbranch_scc1 L_Pz
    v_lshl_add_u32 v204, v204, 3, v68
    v_lshl_add_u32 v205, v205, 3, v68
    v_lshl_add_u32 v206, v206, 3, v68
    v_lshl_add_u32 v207, v207, 3, v68
    v_lshl_add_u32 v208, v208, 3, v68
    v_lshl_add_u32 v209, v209, 3, v68
    v_lshl_add_u32 v210, v210, 3, v68
    v_lshl_add_u32 v211, v211, 3, v68
    v_lshl_add_u32 v212, v212, 3, v68
    s_cmp_le_u32 s72, 8
    s_mov_b64 exec, 1
    ds_add_rtn_u32 v78, v69, v78
    s_mov_b64 exec, s[58:59]
    s_cbranch_execz L_Pb0
    ds_write2_b32 v204, v232, v192 offset1:1
L_Pb0:
    s_mov_b64 exec, s[60:61]
    s_cbranch_execz L_Pb1
    ds_write2_b32 v205, v233, v193 offset1:1
L_Pb1:
    s_mov_b64 exec, s[62:63]
    s_cbranch_execz L_Pb2
    ds_write2_b32 v206, v234, v194 offset1:1
L_Pb2:
    s_cbranch_scc1 L_Pq
    s_mov_b64 exec, s[64:65]
    s_cbranch_execz L_Pb3
    ds_write2_b32 v207, v236, v195 offset1:1
L_Pb3:
    s_mov_b64 exec, s[66:67]
    s_cbranch_execz L_Pb4
    ds_write2_b32 v208, v237, v196 offset1:1
L_Pb4:
    s_mov_b64 exec, s[76:77]
    s_cbranch_execz L_Pb5
    ds_write2_b32 v209, v238, v197 offset1:1
L_Pb5:
    s_mov_b64 exec, s[78:79]
    s_cbranch_execz L_Pb6
    ds_write2_b32 v210, v240, v198 offset1:1
L_Pb6:
    s_mov_b64 exec, s[0:1]
    s_cbranch_execz L_Pb7
    ds_write2_b32 v211, v241, v199 offset1:1
L_Pb7:
    s_mov_b64 exec, s[50:51]
    s_cbranch_execz L_Pb8
    ds_write2_b32 v212, v242, v200 offset1:1
L_Pb8:
L_Pq:
    s_mov_b64 exec, -1
    v_min_u32 v85, s32, v82
    v_cmp_ge_u32 s[64:65], s32, v82
    v_lshl_add_u32 v83, v85, 3, s38
    ds_read_b64 v[80:81], v83 offset:2048
    v_add_u32 v82, 64, v82
    s_add_u32 s39, s39, 64
    s_mov_b32 s49, 103008
    s_mov_b32 s50, 0
    s_lshr_b32 s35, s24, 4
    v_min_u32 v10, s32, v25
    v_lshlrev_b32 v10, 2, v10
    s_cmp_eq_u32 s28, 1
    s_cbranch_scc0 L_Pa_n0
    s_call_b64 s[78:79], L_Pa_t0
L_Pa_n0:
    s_cmp_eq_u32 s28, 2
    s_cbranch_scc0 L_Pa_n1
    s_call_b64 s[78:79], L_Pa_t1
L_Pa_n1:
    s_cmp_le_u32 s72, 11
    s_cbranch_scc1 L_l5
    s_add_u32 m0, s33, 42944
    s_min_i32 s47, s20, s21
    s_add_u32 s20, s20, s55
    buffer_load_dwordx4 v8, s[4:7], s47 offen lds
L_l5:
    s_cmp_le_u32 s72, 12
    s_cbranch_scc1 L_l6
    s_add_u32 m0, s33, 46848
    s_min_i32 s47, s20, s21
    s_add_u32 s20, s20, s55
    buffer_load_dwordx4 v8, s[4:7], s47 offen lds
L_l6:
    s_cmp_le_u32 s72, 13
    s_cbranch_scc1 L_l7
    s_add_u32 m0, s33, 50752
    s_min_i32 s47, s20, s21
    s_add_u32 s20, s20, s55
    buffer_load_dwordx4 v8, s[4:7], s47 offen lds
L_l7:
    s_waitcnt lgkmcnt(0)
    v_readfirstlane_b32 s53, v78
    v_cvt_f32_ubyte2 v86, v81
    v_cvt_f32_ubyte3 v87, v81
    v_add_u32_sdwa v84, s49, v81 dst_sel:DWORD dst_unused:UNUSED_PAD src0_sel:DWORD src1_sel:WORD_0
    v_add_f32 v86, s68, v86
    v_add_f32 v87, s69, v87
    v_mov_b32 v81, s50
    v_lshlrev_b32 v61, 16, v80
    v_and_b32 v62, 0xffff0000, v80
    s_cmp_le_u32 s72, 14
    s_cbranch_scc1 L_l8
    s_add_u32 m0, s33, 54656
    s_min_i32 s47, s20, s21
    s_add_u32 s20, s20, s55
    buffer_load_dwordx4 v8, s[4:7], s47 offen lds
L_l8:
    v_add_f32 v61, v61, v86
    v_add_f32 v62, v62, v87
    v_cvt_pk_bf16_f32 v60, v61, v62
    v_pk_max_i16 v60, v60, 0
    v_pk_min_i16 v60, v60, s52
    v_alignbit_b32 v60, v60, v60, s42
    v_lshlrev_b32 v61, 16, v60
    v_and_b32 v62, 0xffff0000, v60
    v_fract_f32 v63, v61
    v_fract_f32 v64, v62
    s_cmp_le_u32 s72, 15
    s_cbranch_scc1 L_l9
    s_add_u32 m0, s33, 58560
    s_min_i32 s47, s20, s21
    s_add_u32 s20, s20, s55
    buffer_load_dwordx4 v8, s[4:7], s47 offen lds
L_l9:
    v_cvt_u32_f32 v65, v61
    v_cvt_u32_f32 v66, v62
    v_cmp_neq_f32 s[58:59], 0, v64
    v_cmp_neq_f32 s[60:61], 0, v63
    v_sub_f32 v67, 1.0, v63
    v_sub_f32 v68, 1.0, v64
    v_subrev_u32 v65, s71, v65
    v_subrev_u32 v66, s43, v66
    v_cvt_pk_bf16_f32 v61, v67, v68
    v_addc_co_u32 v74, vcc, 0, v66, s[58:59]
    s_add_u32 m0, s44, 0
    s_nop 0
    buffer_load_dwordx4 v7, s[12:15], s46 offen offset:0 lds
    v_addc_co_u32 v73, vcc, 0, v65, s[60:61]
    v_lshlrev_b32 v67, 16, v61
    v_and_b32 v68, 0xffff0000, v61
    v_mul_u32_u24 v75, 976, v65
    v_mul_f32 v69, v67, v68
    v_mul_f32 v70, v67, v64
    v_mul_f32 v71, v63, v68
    v_mul_f32 v72, v63, v64
    v_max_u32 v73, v73, v65
    v_max_u32 v61, v66, v74
    buffer_load_dwordx4 v7, s[12:15], s46 offen offset:1024 lds
    v_mad_u32_u24 v67, v66, 48, v75
    v_mad_u32_u24 v68, v74, 48, v75
    v_and_b32 v66, 12, v66
    v_and_b32 v74, 12, v74
    s_andn2_b64 s[62:63], s[60:61], s[58:59]
    v_add_lshl_u32 v67, v67, v66, 2
    v_add_lshl_u32 v68, v68, v74, 2
    v_cndmask_b32 v70, v71, v70, s[58:59]
    v_cndmask_b32 v62, 0, v174, s[62:63]
    s_and_b64 s[62:63], s[60:61], s[58:59]
    v_cndmask_b32 v71, 0, v71, s[58:59]
    s_and_b64 s[66:67], s[62:63], s[64:65]
    v_cmp_le_u32 s[60:61], s72, v73
    v_mbcnt_lo_u32_b32 v81, s66, v81
    v_cmp_lt_u32 s[58:59], 19, v61
    s_bcnt1_i32_b64 s48, s[66:67]
    v_lshl_or_b32 v58, v68, 16, v67
    v_mbcnt_hi_u32_b32 v81, s67, v81
    v_cvt_pk_bf16_f32 v57, v69, v70
    s_add_u32 s50, s50, s48
    v_cvt_pk_bf16_f32 v59, v71, v72
    v_sub_u32 v85, v85, v81
    v_and_b32 v62, 0xffff0000, v62
    v_sub_u32 v81, s32, v81
    v_cndmask_b32 v61, 0, v174, s[62:63]
    v_cndmask_b32 v85, v85, v81, s[66:67]
    v_add_u32 v56, v58, v62
    v_lshl_add_u32 v83, v85, 4, s38
    v_add_u32 v58, v58, v61
    v_add_u32 v85, s53, v85
    ds_bpermute_b32 v28, v10, v56
    v_bfe_u32 v81, v85, 1, 2
    ds_bpermute_b32 v29, v10, v57
    v_mad_u32_u24 v85, v85, 12, s35
    v_add_u32 v85, v85, v81
    s_mov_b64 exec, s[64:65]
    ds_write_b128 v83, v[56:59]
    ds_write_b16 v84, v85
    s_mov_b64 exec, -1
    s_or_b64 s[58:59], s[58:59], s[60:61]
    s_cbranch_scc1 L_Pfail
    s_add_u32 s47, s53, s37
    s_cmp_gt_u32 s47, s25
    s_cbranch_scc1 L_Pfail
    s_cmp_lt_u32 s39, s37
    s_cbranch_scc1 L_Pr2
    s_lshr_b32 s47, s32, 4
    s_cmp_lt_u32 s36, 4
    s_addc_u32 s47, s47, s50
    s_mov_b32 s39, 0
    s_cmp_lg_u32 s47, 0
    s_cbranch_scc1 L_Pgl
    s_waitcnt lgkmcnt(2)
    v_add_u32 v9, s39, v165
    v_xor_b32_sdwa v0, v28, v164 dst_sel:DWORD dst_unused:UNUSED_PAD src0_sel:WORD_0 src1_sel:DWORD
    buffer_load_dwordx4 v7, s[12:15], s46 offen offset:2048 lds
    v_min_u32 v9, s32, v9
    v_xor_b32_sdwa v2, v28, v164 dst_sel:DWORD dst_unused:UNUSED_PAD src0_sel:WORD_1 src1_sel:DWORD
    v_add_u32 v9, s53, v9
    v_xor_b32_sdwa v1, v28, v173 dst_sel:DWORD dst_unused:UNUSED_PAD src0_sel:WORD_0 src1_sel:DWORD
    s_add_u32 s39, s39, 16
    s_add_u32 m0, s45, 0
    s_nop 0
    buffer_load_dwordx4 v26, s[12:15], s46 offen offset:0 lds
    v_xor_b32_sdwa v3, v28, v173 dst_sel:DWORD dst_unused:UNUSED_PAD src0_sel:WORD_1 src1_sel:DWORD
    v_bfe_u32 v10, v9, 1, 2
    v_perm_b32 v32, v29, v29, v168
    v_mad_u32_u24 v9, v9, 12, v10
    v_perm_b32 v33, v29, v29, v169
    buffer_load_dwordx4 v26, s[12:15], s46 offen offset:1024 lds
    s_add_u32 s46, s46, 18432
    v_xor_b32_sdwa v9, v166, v9 dst_sel:DWORD dst_unused:UNUSED_PAD src0_sel:WORD_0 src1_sel:DWORD
    v_perm_b32 v34, v29, v29, v170
    v_lshl_add_u32 v9, v9, 4, s24
    v_perm_b32 v35, v29, v29, v171
    s_waitcnt vmcnt(5) lgkmcnt(0)
    s_barrier
    ds_read_b64_tr_b16 v[180:181], v0 offset:0
    ds_read_b64_tr_b16 v[182:183], v2 offset:0
    ds_read_b64_tr_b16 v[184:185], v1 offset:0
    ds_read_b64_tr_b16 v[186:187], v3 offset:0
    ds_read_b64_tr_b16 v[188:189], v0 offset:64
    ds_read_b64_tr_b16 v[190:191], v2 offset:64
    ds_read_b64_tr_b16 v[192:193], v1 offset:64
    ds_read_b64_tr_b16 v[194:195], v3 offset:64
    ds_read_b64_tr_b16 v[196:197], v0 offset:128
    ds_read_b64_tr_b16 v[198:199], v2 offset:128
    ds_read_b64_tr_b16 v[200:201], v1 offset:128
    ds_read_b64_tr_b16 v[202:203], v3 offset:128
    ds_read_b128 v[136:139], v172 offset:0
    ds_read_b128 v[144:147], v14
    s_waitcnt lgkmcnt(12)
    v_mfma_f32_16x16x32_bf16 v[56:59], v[180:183], v[32:35], 0
    s_waitcnt lgkmcnt(10)
    v_mfma_f32_16x16x32_bf16 v[60:63], v[184:187], v[32:35], 0
    s_waitcnt lgkmcnt(8)
    v_mfma_f32_16x16x32_bf16 v[64:67], v[188:191], v[32:35], 0
    s_waitcnt lgkmcnt(6)
    v_mfma_f32_16x16x32_bf16 v[68:71], v[192:195], v[32:35], 0
    s_waitcnt lgkmcnt(1)
    v_xor_b32 v136, v136, v166
    v_xor_b32 v137, v137, v166
    v_xor_b32 v138, v138, v166
    v_xor_b32 v139, v139, v166
    v_mfma_f32_16x16x32_bf16 v[72:75], v[196:199], v[32:35], 0
    v_lshlrev_b32_sdwa v116, 4, v136 dst_sel:DWORD dst_unused:UNUSED_PAD src0_sel:DWORD src1_sel:WORD_0
    v_lshlrev_b32_sdwa v117, 4, v138 dst_sel:DWORD dst_unused:UNUSED_PAD src0_sel:DWORD src1_sel:WORD_0
    v_lshlrev_b32_sdwa v118, 4, v136 dst_sel:DWORD dst_unused:UNUSED_PAD src0_sel:DWORD src1_sel:WORD_1
    v_mfma_f32_16x16x32_bf16 v[76:79], v[200:203], v[32:35], 0
    v_lshlrev_b32_sdwa v119, 4, v138 dst_sel:DWORD dst_unused:UNUSED_PAD src0_sel:DWORD src1_sel:WORD_1
    v_lshlrev_b32_sdwa v120, 4, v137 dst_sel:DWORD dst_unused:UNUSED_PAD src0_sel:DWORD src1_sel:WORD_0
    v_lshlrev_b32_sdwa v121, 4, v139 dst_sel:DWORD dst_unused:UNUSED_PAD src0_sel:DWORD src1_sel:WORD_0
    v_cvt_pk_bf16_f32 v80, v56, v57
    v_cvt_pk_bf16_f32 v81, v58, v59
    v_cvt_pk_bf16_f32 v82, v60, v61
    v_cvt_pk_bf16_f32 v83, v62, v63
    v_cvt_pk_bf16_f32 v84, v64, v65
    v_cvt_pk_bf16_f32 v85, v66, v67
    v_cvt_pk_bf16_f32 v86, v68, v69
    v_cvt_pk_bf16_f32 v87, v70, v71
    v_permlane32_swap_b32 v80, v82
    v_permlane32_swap_b32 v81, v83
    ds_write_b128 v9, v[80:83] offset:0
    v_cvt_pk_bf16_f32 v88, v72, v73
    v_cvt_pk_bf16_f32 v89, v74, v75
    v_cvt_pk_bf16_f32 v90, v76, v77
    v_cvt_pk_bf16_f32 v91, v78, v79
    v_permlane32_swap_b32 v84, v86
    v_permlane32_swap_b32 v85, v87
    ds_write_b128 v9, v[84:87] offset:64
    v_permlane32_swap_b32 v88, v90
    v_permlane32_swap_b32 v89, v91
    ds_write_b128 v9, v[88:91] offset:128
    s_waitcnt lgkmcnt(3)
    v_or3_b32 v144, v144, v145, v146
    v_or_b32 v144, v144, v147
    s_nop 0
    v_readfirstlane_b32 s54, v144
L_Pa:
    s_cmp_ge_u32 s36, 4
    s_waitcnt vmcnt(0) lgkmcnt(0)
    s_barrier
    s_cbranch_scc0 L_Pd
    ds_read_b128 v[180:183], v116 offset:0
    ds_read_b64_tr_b16 a[0:1], v4 offset:0
    ds_read_b64_tr_b16 a[2:3], v4 offset:768
    ds_read_b64_tr_b16 a[4:5], v4 offset:32
    ds_read_b64_tr_b16 a[6:7], v4 offset:800
    ds_read_b64_tr_b16 a[8:9], v5 offset:64
    ds_read_b64_tr_b16 a[10:11], v5 offset:832
    ds_read_b128 v[192:195], v117 offset:0
    ds_read_b128 v[204:207], v118 offset:0
    ds_read_b64_tr_b16 a[12:13], v4 offset:6208
    ds_read_b64_tr_b16 a[14:15], v4 offset:6976
    s_waitcnt lgkmcnt(7)
    v_mfma_f32_16x16x32_bf16 v[44:47], a[0:3], v[180:183], 0
    s_add_u32 m0, s44, 18624
    ds_read_b128 v[184:187], v116 offset:64
    s_waitcnt lgkmcnt(7)
    v_mfma_f32_16x16x32_bf16 v[48:51], a[4:7], v[180:183], 0
    buffer_load_dwordx4 v7, s[12:15], s46 offen offset:0 lds
    s_waitcnt lgkmcnt(5)
    v_mfma_f32_16x16x32_bf16 v[52:55], a[8:11], v[180:183], 0
    ds_read_b64_tr_b16 a[16:17], v4 offset:6240
    s_waitcnt lgkmcnt(5)
    v_mfma_f32_16x16x32_bf16 v[56:59], a[0:3], v[192:195], 0
    ds_read_b64_tr_b16 a[18:19], v4 offset:7008
    v_mfma_f32_16x16x32_bf16 v[60:63], a[4:7], v[192:195], 0
    ds_read_b64_tr_b16 a[20:21], v5 offset:6272
    ds_read_b64_tr_b16 a[22:23], v5 offset:7040
    v_mfma_f32_16x16x32_bf16 v[64:67], a[8:11], v[192:195], 0
    buffer_load_dwordx4 v7, s[12:15], s46 offen offset:1024 lds
    s_waitcnt lgkmcnt(7)
    v_mfma_f32_16x16x32_bf16 v[68:71], a[0:3], v[204:207], 0
    ds_read_b128 v[196:199], v117 offset:64
    v_mfma_f32_16x16x32_bf16 v[72:75], a[4:7], v[204:207], 0
    ds_read_b128 v[208:211], v118 offset:64
    ds_read_b128 v[188:191], v116 offset:128
    v_mfma_f32_16x16x32_bf16 v[76:79], a[8:11], v[204:207], 0
    ds_read_b64_tr_b16 a[24:25], v4 offset:12416
    ds_read_b64_tr_b16 a[26:27], v4 offset:13184
    s_waitcnt lgkmcnt(5)
    v_mfma_f32_16x16x32_bf16 v[52:55], a[20:23], v[184:187], v[52:55]
    buffer_load_dwordx4 v7, s[12:15], s46 offen offset:2048 lds
    v_mfma_f32_16x16x32_bf16 v[48:51], a[16:19], v[184:187], v[48:51]
    ds_read_b64_tr_b16 a[28:29], v4 offset:12448
    v_mfma_f32_16x16x32_bf16 v[44:47], a[12:15], v[184:187], v[44:47]
    s_add_u32 m0, s45, 18624
    ds_read_b64_tr_b16 a[30:31], v4 offset:13216
    ds_read_b128 v[136:139], v172 offset:256
    s_waitcnt lgkmcnt(7)
    v_mfma_f32_16x16x32_bf16 v[64:67], a[20:23], v[196:199], v[64:67]
    buffer_load_dwordx4 v26, s[12:15], s46 offen offset:0 lds
    ds_read_b64_tr_b16 a[32:33], v5 offset:12480
    v_mfma_f32_16x16x32_bf16 v[60:63], a[16:19], v[196:199], v[60:63]
    ds_read_b64_tr_b16 a[34:35], v5 offset:13248
    ds_read_b128 v[200:203], v117 offset:128
    ds_read_b128 v[212:215], v118 offset:128
    v_mfma_f32_16x16x32_bf16 v[56:59], a[12:15], v[196:199], v[56:59]
    ds_read_b128 v[216:219], v119 offset:0
    s_waitcnt lgkmcnt(7)
    v_mfma_f32_16x16x32_bf16 v[76:79], a[20:23], v[208:211], v[76:79]
    ds_read_b128 v[220:223], v119 offset:64
    v_mfma_f32_16x16x32_bf16 v[72:75], a[16:19], v[208:211], v[72:75]
    buffer_load_dwordx4 v26, s[12:15], s46 offen offset:1024 lds
    s_add_u32 s46, s46, 18432
    v_mfma_f32_16x16x32_bf16 v[68:71], a[12:15], v[208:211], v[68:71]
    ds_read_b128 v[224:227], v119 offset:128
    v_mfma_f32_16x16x32_bf16 v[44:47], a[24:27], v[188:191], v[44:47]
    s_add_u32 m0, s44, 37248
    s_waitcnt lgkmcnt(7)
    v_xor_b32 v136, v136, v166
    v_xor_b32 v137, v137, v166
    v_mfma_f32_16x16x32_bf16 v[48:51], a[28:31], v[188:191], v[48:51]
    buffer_load_dwordx4 v7, s[12:15], s46 offen offset:0 lds
    s_waitcnt lgkmcnt(5)
    v_mfma_f32_16x16x32_bf16 v[52:55], a[32:35], v[188:191], v[52:55]
    ds_read_b128 v[228:231], v120 offset:0
    v_xor_b32 v138, v138, v166
    v_xor_b32 v139, v139, v166
    s_waitcnt lgkmcnt(5)
    v_mfma_f32_16x16x32_bf16 v[56:59], a[24:27], v[200:203], v[56:59]
    ds_read_b128 v[232:235], v120 offset:64
    v_lshlrev_b32_sdwa v122, 4, v136 dst_sel:DWORD dst_unused:UNUSED_PAD src0_sel:DWORD src1_sel:WORD_0
    v_lshlrev_b32_sdwa v123, 4, v138 dst_sel:DWORD dst_unused:UNUSED_PAD src0_sel:DWORD src1_sel:WORD_0
    v_mfma_f32_16x16x32_bf16 v[60:63], a[28:31], v[200:203], v[60:63]
    ds_read_b128 v[236:239], v120 offset:128
    v_lshlrev_b32_sdwa v124, 4, v136 dst_sel:DWORD dst_unused:UNUSED_PAD src0_sel:DWORD src1_sel:WORD_1
    v_lshlrev_b32_sdwa v125, 4, v138 dst_sel:DWORD dst_unused:UNUSED_PAD src0_sel:DWORD src1_sel:WORD_1
    v_mfma_f32_16x16x32_bf16 v[64:67], a[32:35], v[200:203], v[64:67]
    buffer_load_dwordx4 v7, s[12:15], s46 offen offset:1024 lds
    s_waitcnt lgkmcnt(6)
    v_mfma_f32_16x16x32_bf16 v[68:71], a[24:27], v[212:215], v[68:71]
    ds_read_b128 v[240:243], v121 offset:0
    v_lshlrev_b32_sdwa v126, 4, v137 dst_sel:DWORD dst_unused:UNUSED_PAD src0_sel:DWORD src1_sel:WORD_0
    v_lshlrev_b32_sdwa v127, 4, v139 dst_sel:DWORD dst_unused:UNUSED_PAD src0_sel:DWORD src1_sel:WORD_0
    v_mfma_f32_16x16x32_bf16 v[72:75], a[28:31], v[212:215], v[72:75]
    ds_read_b128 v[244:247], v121 offset:64
    v_mfma_f32_16x16x32_bf16 v[76:79], a[32:35], v[212:215], v[76:79]
    s_waitcnt lgkmcnt(7)
    v_mfma_f32_16x16x32_bf16 v[80:83], a[0:3], v[216:219], 0
    ds_read_b128 v[248:251], v121 offset:128
    v_mfma_f32_16x16x32_bf16 v[84:87], a[4:7], v[216:219], 0
    buffer_load_dwordx4 v7, s[12:15], s46 offen offset:2048 lds
    v_mfma_f32_16x16x32_bf16 v[88:91], a[8:11], v[216:219], 0
    ds_read_b128 v[180:183], v122 offset:0
    s_waitcnt lgkmcnt(7)
    v_mfma_f32_16x16x32_bf16 v[88:91], a[20:23], v[220:223], v[88:91]
    v_mfma_f32_16x16x32_bf16 v[84:87], a[16:19], v[220:223], v[84:87]
    ds_read_b128 v[184:187], v122 offset:64
    s_waitcnt vmcnt(3)
    s_barrier
    s_branch L_Pa_s0
L_Pa_t0:
    s_setpc_b64 s[78:79]
L_Pa_s0:
    v_mfma_f32_16x16x32_bf16 v[80:83], a[12:15], v[220:223], v[80:83]
    s_add_u32 m0, s45, 37248
    ds_read_b64_tr_b16 a[36:37], v4 offset:18624
    v_mfma_f32_16x16x32_bf16 v[80:83], a[24:27], v[224:227], v[80:83]
    buffer_load_dwordx4 v26, s[12:15], s46 offen offset:0 lds
    v_mfma_f32_16x16x32_bf16 v[84:87], a[28:31], v[224:227], v[84:87]
    ds_read_b128 v[188:191], v122 offset:128
    ds_read_b64_tr_b16 a[38:39], v4 offset:19392
    v_mfma_f32_16x16x32_bf16 v[88:91], a[32:35], v[224:227], v[88:91]
    ds_read_b64_tr_b16 a[40:41], v4 offset:18656
    s_waitcnt lgkmcnt(7)
    v_mfma_f32_16x16x32_bf16 v[92:95], a[0:3], v[228:231], 0
    ds_read_b64_tr_b16 a[42:43], v4 offset:19424
    ds_read_b64_tr_b16 a[44:45], v5 offset:18688
    v_mfma_f32_16x16x32_bf16 v[96:99], a[4:7], v[228:231], 0
    buffer_load_dwordx4 v26, s[12:15], s46 offen offset:1024 lds
    s_add_u32 s46, s46, 18432
    v_mfma_f32_16x16x32_bf16 v[100:103], a[8:11], v[228:231], 0
    ds_read_b128 v[192:195], v123 offset:0
    ds_read_b64_tr_b16 a[46:47], v5 offset:19456
    v_mfma_f32_16x16x32_bf16 v[100:103], a[20:23], v[232:235], v[100:103]
    ds_read_b64_tr_b16 a[48:49], v4 offset:24832
    ds_read_b64_tr_b16 a[50:51], v4 offset:25600
    v_mfma_f32_16x16x32_bf16 v[96:99], a[16:19], v[232:235], v[96:99]
    ds_read_b128 v[196:199], v123 offset:64
    v_mfma_f32_16x16x32_bf16 v[92:95], a[12:15], v[232:235], v[92:95]
    ds_read_b64_tr_b16 a[52:53], v4 offset:24864
    v_mfma_f32_16x16x32_bf16 v[92:95], a[24:27], v[236:239], v[92:95]
    ds_read_b64_tr_b16 a[54:55], v4 offset:25632
    ds_read_b64_tr_b16 a[56:57], v5 offset:24896
    v_mfma_f32_16x16x32_bf16 v[96:99], a[28:31], v[236:239], v[96:99]
    ds_read_b128 v[200:203], v123 offset:128
    s_add_u32 m0, s44, 0
    v_mfma_f32_16x16x32_bf16 v[100:103], a[32:35], v[236:239], v[100:103]
    buffer_load_dwordx4 v7, s[12:15], s46 offen offset:0 lds
    ds_read_b64_tr_b16 a[58:59], v5 offset:25664
    v_mfma_f32_16x16x32_bf16 v[104:107], a[0:3], v[240:243], 0
    ds_read_b64_tr_b16 a[60:61], v4 offset:31040
    ds_read_b64_tr_b16 a[62:63], v4 offset:31808
    v_mfma_f32_16x16x32_bf16 v[108:111], a[4:7], v[240:243], 0
    ds_read_b128 v[204:207], v124 offset:0
    ds_read_b64_tr_b16 a[64:65], v4 offset:31072
    v_mfma_f32_16x16x32_bf16 v[112:115], a[8:11], v[240:243], 0
    buffer_load_dwordx4 v7, s[12:15], s46 offen offset:1024 lds
    v_mfma_f32_16x16x32_bf16 v[112:115], a[20:23], v[244:247], v[112:115]
    ds_read_b64_tr_b16 a[66:67], v4 offset:31840
    ds_read_b64_tr_b16 a[68:69], v5 offset:31104
    ds_read_b64_tr_b16 a[70:71], v5 offset:31872
    v_mfma_f32_16x16x32_bf16 v[108:111], a[16:19], v[244:247], v[108:111]
    ds_read_b128 v[208:211], v124 offset:64
    v_mfma_f32_16x16x32_bf16 v[104:107], a[12:15], v[244:247], v[104:107]
    s_waitcnt lgkmcnt(7)
    v_mfma_f32_16x16x32_bf16 v[104:107], a[24:27], v[248:251], v[104:107]
    buffer_load_dwordx4 v7, s[12:15], s46 offen offset:2048 lds
    v_mfma_f32_16x16x32_bf16 v[108:111], a[28:31], v[248:251], v[108:111]
    ds_read_b128 v[212:215], v124 offset:128
    v_mfma_f32_16x16x32_bf16 v[112:115], a[32:35], v[248:251], v[112:115]
    s_waitcnt vmcnt(3)
    s_waitcnt lgkmcnt(2)
    s_barrier
    v_mfma_f32_16x16x32_bf16 v[44:47], a[36:39], v[180:183], v[44:47]
    v_mfma_f32_16x16x32_bf16 v[48:51], a[40:43], v[180:183], v[48:51]
    ds_read_b128 v[216:219], v125 offset:0
    s_add_u32 m0, s45, 0
    v_mfma_f32_16x16x32_bf16 v[52:55], a[44:47], v[180:183], v[52:55]
    buffer_load_dwordx4 v26, s[12:15], s46 offen offset:0 lds
    v_mfma_f32_16x16x32_bf16 v[52:55], a[56:59], v[184:187], v[52:55]
    ds_read_b128 v[136:139], v172 offset:512
    ds_read_b64_tr_b16 a[72:73], v4 offset:37248
    v_mfma_f32_16x16x32_bf16 v[48:51], a[52:55], v[184:187], v[48:51]
    ds_read_b128 v[220:223], v125 offset:64
    v_mfma_f32_16x16x32_bf16 v[44:47], a[48:51], v[184:187], v[44:47]
    buffer_load_dwordx4 v26, s[12:15], s46 offen offset:1024 lds
    s_add_u32 s46, s46, 18432
    v_mfma_f32_16x16x32_bf16 v[44:47], a[60:63], v[188:191], v[44:47]
    ds_read_b64_tr_b16 a[74:75], v4 offset:38016
    v_mfma_f32_16x16x32_bf16 v[48:51], a[64:67], v[188:191], v[48:51]
    ds_read_b128 v[224:227], v125 offset:128
    v_mfma_f32_16x16x32_bf16 v[52:55], a[68:71], v[188:191], v[52:55]
    ds_read_b64_tr_b16 a[76:77], v4 offset:37280
    v_mfma_f32_16x16x32_bf16 v[56:59], a[36:39], v[192:195], v[56:59]
    ds_read_b64_tr_b16 a[78:79], v4 offset:38048
    v_mfma_f32_16x16x32_bf16 v[60:63], a[40:43], v[192:195], v[60:63]
    ds_read_b128 v[228:231], v126 offset:0
    v_mfma_f32_16x16x32_bf16 v[64:67], a[44:47], v[192:195], v[64:67]
    s_add_u32 m0, s44, 18624
    v_mfma_f32_16x16x32_bf16 v[64:67], a[56:59], v[196:199], v[64:67]
    buffer_load_dwordx4 v7, s[12:15], s46 offen offset:0 lds
    v_mfma_f32_16x16x32_bf16 v[60:63], a[52:55], v[196:199], v[60:63]
    ds_read_b128 v[232:235], v126 offset:64
    ds_read_b64_tr_b16 a[80:81], v5 offset:37312
    v_mfma_f32_16x16x32_bf16 v[56:59], a[48:51], v[196:199], v[56:59]
    s_waitcnt lgkmcnt(7)
    v_xor_b32 v136, v136, v166
    v_xor_b32 v137, v137, v166
    v_mfma_f32_16x16x32_bf16 v[56:59], a[60:63], v[200:203], v[56:59]
    v_xor_b32 v138, v138, v166
    v_xor_b32 v139, v139, v166
    v_mfma_f32_16x16x32_bf16 v[60:63], a[64:67], v[200:203], v[60:63]
    ds_read_b128 v[236:239], v126 offset:128
    v_mfma_f32_16x16x32_bf16 v[64:67], a[68:71], v[200:203], v[64:67]
    ds_read_b64_tr_b16 a[82:83], v5 offset:38080
    ds_read_b64_tr_b16 a[84:85], v4 offset:43456
    v_mfma_f32_16x16x32_bf16 v[68:71], a[36:39], v[204:207], v[68:71]
    buffer_load_dwordx4 v7, s[12:15], s46 offen offset:1024 lds
    v_mfma_f32_16x16x32_bf16 v[72:75], a[40:43], v[204:207], v[72:75]
    ds_read_b128 v[240:243], v127 offset:0
    v_mfma_f32_16x16x32_bf16 v[76:79], a[44:47], v[204:207], v[76:79]
    v_lshlrev_b32_sdwa v128, 4, v136 dst_sel:DWORD dst_unused:UNUSED_PAD src0_sel:DWORD src1_sel:WORD_0
    v_lshlrev_b32_sdwa v129, 4, v138 dst_sel:DWORD dst_unused:UNUSED_PAD src0_sel:DWORD src1_sel:WORD_0
    v_mfma_f32_16x16x32_bf16 v[76:79], a[56:59], v[208:211], v[76:79]
    v_lshlrev_b32_sdwa v130, 4, v136 dst_sel:DWORD dst_unused:UNUSED_PAD src0_sel:DWORD src1_sel:WORD_1
    v_lshlrev_b32_sdwa v131, 4, v138 dst_sel:DWORD dst_unused:UNUSED_PAD src0_sel:DWORD src1_sel:WORD_1
    v_mfma_f32_16x16x32_bf16 v[72:75], a[52:55], v[208:211], v[72:75]
    ds_read_b128 v[244:247], v127 offset:64
    v_mfma_f32_16x16x32_bf16 v[68:71], a[48:51], v[208:211], v[68:71]
    ds_read_b64_tr_b16 a[86:87], v4 offset:44224
    v_mfma_f32_16x16x32_bf16 v[68:71], a[60:63], v[212:215], v[68:71]
    buffer_load_dwordx4 v7, s[12:15], s46 offen offset:2048 lds
    v_mfma_f32_16x16x32_bf16 v[72:75], a[64:67], v[212:215], v[72:75]
    ds_read_b128 v[248:251], v127 offset:128
    v_lshlrev_b32_sdwa v132, 4, v137 dst_sel:DWORD dst_unused:UNUSED_PAD src0_sel:DWORD src1_sel:WORD_0
    v_lshlrev_b32_sdwa v133, 4, v139 dst_sel:DWORD dst_unused:UNUSED_PAD src0_sel:DWORD src1_sel:WORD_0
    v_mfma_f32_16x16x32_bf16 v[76:79], a[68:71], v[212:215], v[76:79]
    ds_read_b64_tr_b16 a[88:89], v4 offset:43488
    v_mfma_f32_16x16x32_bf16 v[80:83], a[36:39], v[216:219], v[80:83]
    ds_read_b64_tr_b16 a[90:91], v4 offset:44256
    v_mfma_f32_16x16x32_bf16 v[84:87], a[40:43], v[216:219], v[84:87]
    ds_read_b128 v[180:183], v128 offset:0
    v_mfma_f32_16x16x32_bf16 v[88:91], a[44:47], v[216:219], v[88:91]
    s_add_u32 m0, s45, 18624
    v_mfma_f32_16x16x32_bf16 v[88:91], a[56:59], v[220:223], v[88:91]
    buffer_load_dwordx4 v26, s[12:15], s46 offen offset:0 lds
    v_mfma_f32_16x16x32_bf16 v[84:87], a[52:55], v[220:223], v[84:87]
    ds_read_b128 v[184:187], v128 offset:64
    v_mfma_f32_16x16x32_bf16 v[80:83], a[48:51], v[220:223], v[80:83]
    ds_read_b64_tr_b16 a[92:93], v5 offset:43520
    s_waitcnt lgkmcnt(7)
    v_mfma_f32_16x16x32_bf16 v[80:83], a[60:63], v[224:227], v[80:83]
    ds_read_b64_tr_b16 a[94:95], v5 offset:44288
    v_mfma_f32_16x16x32_bf16 v[84:87], a[64:67], v[224:227], v[84:87]
    ds_read_b128 v[188:191], v128 offset:128
    v_mfma_f32_16x16x32_bf16 v[88:91], a[68:71], v[224:227], v[88:91]
    ds_read_b64_tr_b16 a[96:97], v4 offset:49664
    v_mfma_f32_16x16x32_bf16 v[92:95], a[36:39], v[228:231], v[92:95]
    buffer_load_dwordx4 v26, s[12:15], s46 offen offset:1024 lds
    s_add_u32 s46, s46, 18432
    v_mfma_f32_16x16x32_bf16 v[96:99], a[40:43], v[228:231], v[96:99]
    ds_read_b128 v[192:195], v129 offset:0
    v_mfma_f32_16x16x32_bf16 v[100:103], a[44:47], v[228:231], v[100:103]
    ds_read_b64_tr_b16 a[98:99], v4 offset:50432
    v_mfma_f32_16x16x32_bf16 v[100:103], a[56:59], v[232:235], v[100:103]
    ds_read_b64_tr_b16 a[100:101], v4 offset:49696
    v_mfma_f32_16x16x32_bf16 v[96:99], a[52:55], v[232:235], v[96:99]
    ds_read_b128 v[196:199], v129 offset:64
    v_mfma_f32_16x16x32_bf16 v[92:95], a[48:51], v[232:235], v[92:95]
    v_mfma_f32_16x16x32_bf16 v[92:95], a[60:63], v[236:239], v[92:95]
    ds_read_b64_tr_b16 a[102:103], v4 offset:50464
    v_mfma_f32_16x16x32_bf16 v[96:99], a[64:67], v[236:239], v[96:99]
    ds_read_b128 v[200:203], v129 offset:128
    v_mfma_f32_16x16x32_bf16 v[100:103], a[68:71], v[236:239], v[100:103]
    ds_read_b64_tr_b16 a[104:105], v5 offset:49728
    v_mfma_f32_16x16x32_bf16 v[104:107], a[36:39], v[240:243], v[104:107]
    v_mfma_f32_16x16x32_bf16 v[108:111], a[40:43], v[240:243], v[108:111]
    ds_read_b128 v[204:207], v130 offset:0
    v_mfma_f32_16x16x32_bf16 v[112:115], a[44:47], v[240:243], v[112:115]
    ds_read_b64_tr_b16 a[106:107], v5 offset:50496
    v_mfma_f32_16x16x32_bf16 v[112:115], a[56:59], v[244:247], v[112:115]
    v_mfma_f32_16x16x32_bf16 v[108:111], a[52:55], v[244:247], v[108:111]
    ds_read_b128 v[208:211], v130 offset:64
    v_mfma_f32_16x16x32_bf16 v[104:107], a[48:51], v[244:247], v[104:107]
    s_waitcnt lgkmcnt(7)
    v_mfma_f32_16x16x32_bf16 v[104:107], a[60:63], v[248:251], v[104:107]
    v_mfma_f32_16x16x32_bf16 v[108:111], a[64:67], v[248:251], v[108:111]
    ds_read_b128 v[212:215], v130 offset:128
    v_mfma_f32_16x16x32_bf16 v[112:115], a[68:71], v[248:251], v[112:115]
    s_waitcnt vmcnt(5)
    s_waitcnt lgkmcnt(2)
    s_barrier
    v_mfma_f32_16x16x32_bf16 v[44:47], a[72:75], v[180:183], v[44:47]
    v_mfma_f32_16x16x32_bf16 v[48:51], a[76:79], v[180:183], v[48:51]
    ds_read_b128 v[216:219], v131 offset:0
    v_mfma_f32_16x16x32_bf16 v[52:55], a[80:83], v[180:183], v[52:55]
    ds_read_b64_tr_b16 a[108:109], v4 offset:0
    v_mfma_f32_16x16x32_bf16 v[52:55], a[92:95], v[184:187], v[52:55]
    ds_read_b128 v[136:139], v172 offset:768
    v_mfma_f32_16x16x32_bf16 v[48:51], a[88:91], v[184:187], v[48:51]
    ds_read_b128 v[220:223], v131 offset:64
    s_add_u32 m0, s44, 37248
    v_mfma_f32_16x16x32_bf16 v[44:47], a[84:87], v[184:187], v[44:47]
    buffer_load_dwordx4 v7, s[12:15], s46 offen offset:0 lds
    v_mfma_f32_16x16x32_bf16 v[44:47], a[96:99], v[188:191], v[44:47]
    ds_read_b64_tr_b16 a[110:111], v4 offset:768
    v_mfma_f32_16x16x32_bf16 v[48:51], a[100:103], v[188:191], v[48:51]
    ds_read_b128 v[224:227], v131 offset:128
    v_mfma_f32_16x16x32_bf16 v[52:55], a[104:107], v[188:191], v[52:55]
    ds_read_b64_tr_b16 a[112:113], v4 offset:32
    v_mfma_f32_16x16x32_bf16 v[56:59], a[72:75], v[192:195], v[56:59]
    ds_read_b64_tr_b16 a[114:115], v4 offset:800
    v_mfma_f32_16x16x32_bf16 v[60:63], a[76:79], v[192:195], v[60:63]
    ds_read_b128 v[228:231], v132 offset:0
    v_mfma_f32_16x16x32_bf16 v[64:67], a[80:83], v[192:195], v[64:67]
    s_waitcnt lgkmcnt(6)
    v_xor_b32 v136, v136, v166
    v_xor_b32 v137, v137, v166
    v_mfma_f32_16x16x32_bf16 v[64:67], a[92:95], v[196:199], v[64:67]
    buffer_load_dwordx4 v7, s[12:15], s46 offen offset:1024 lds
    v_mfma_f32_16x16x32_bf16 v[60:63], a[88:91], v[196:199], v[60:63]
    ds_read_b128 v[232:235], v132 offset:64
    v_mfma_f32_16x16x32_bf16 v[56:59], a[84:87], v[196:199], v[56:59]
    v_xor_b32 v138, v138, v166
    v_xor_b32 v139, v139, v166
    v_mfma_f32_16x16x32_bf16 v[56:59], a[96:99], v[200:203], v[56:59]
    ds_read_b64_tr_b16 a[116:117], v5 offset:64
    v_mfma_f32_16x16x32_bf16 v[60:63], a[100:103], v[200:203], v[60:63]
    ds_read_b128 v[236:239], v132 offset:128
    v_mfma_f32_16x16x32_bf16 v[64:67], a[104:107], v[200:203], v[64:67]
    ds_read_b64_tr_b16 a[118:119], v5 offset:832
    ds_read_b64_tr_b16 a[120:121], v4 offset:6208
    v_mfma_f32_16x16x32_bf16 v[68:71], a[72:75], v[204:207], v[68:71]
    v_lshlrev_b32_sdwa v116, 4, v136 dst_sel:DWORD dst_unused:UNUSED_PAD src0_sel:DWORD src1_sel:WORD_0
    v_lshlrev_b32_sdwa v117, 4, v138 dst_sel:DWORD dst_unused:UNUSED_PAD src0_sel:DWORD src1_sel:WORD_0
    v_mfma_f32_16x16x32_bf16 v[72:75], a[76:79], v[204:207], v[72:75]
    ds_read_b128 v[240:243], v133 offset:0
    v_mfma_f32_16x16x32_bf16 v[76:79], a[80:83], v[204:207], v[76:79]
    buffer_load_dwordx4 v7, s[12:15], s46 offen offset:2048 lds
    v_mfma_f32_16x16x32_bf16 v[76:79], a[92:95], v[208:211], v[76:79]
    v_lshlrev_b32_sdwa v118, 4, v136 dst_sel:DWORD dst_unused:UNUSED_PAD src0_sel:DWORD src1_sel:WORD_1
    v_lshlrev_b32_sdwa v119, 4, v138 dst_sel:DWORD dst_unused:UNUSED_PAD src0_sel:DWORD src1_sel:WORD_1
    v_mfma_f32_16x16x32_bf16 v[72:75], a[88:91], v[208:211], v[72:75]
    ds_read_b128 v[244:247], v133 offset:64
    v_mfma_f32_16x16x32_bf16 v[68:71], a[84:87], v[208:211], v[68:71]
    ds_read_b64_tr_b16 a[122:123], v4 offset:6976
    v_mfma_f32_16x16x32_bf16 v[68:71], a[96:99], v[212:215], v[68:71]
    v_lshlrev_b32_sdwa v120, 4, v137 dst_sel:DWORD dst_unused:UNUSED_PAD src0_sel:DWORD src1_sel:WORD_0
    v_lshlrev_b32_sdwa v121, 4, v139 dst_sel:DWORD dst_unused:UNUSED_PAD src0_sel:DWORD src1_sel:WORD_0
    v_mfma_f32_16x16x32_bf16 v[72:75], a[100:103], v[212:215], v[72:75]
    ds_read_b128 v[248:251], v133 offset:128
    v_mfma_f32_16x16x32_bf16 v[76:79], a[104:107], v[212:215], v[76:79]
    ds_read_b64_tr_b16 a[124:125], v4 offset:6240
    v_mfma_f32_16x16x32_bf16 v[80:83], a[72:75], v[216:219], v[80:83]
    ds_read_b64_tr_b16 a[126:127], v4 offset:7008
    v_mfma_f32_16x16x32_bf16 v[84:87], a[76:79], v[216:219], v[84:87]
    ds_read_b128 v[180:183], v116 offset:0
    s_add_u32 m0, s45, 37248
    v_mfma_f32_16x16x32_bf16 v[88:91], a[80:83], v[216:219], v[88:91]
    buffer_load_dwordx4 v26, s[12:15], s46 offen offset:0 lds
    s_waitcnt lgkmcnt(7)
    v_mfma_f32_16x16x32_bf16 v[88:91], a[92:95], v[220:223], v[88:91]
    ds_read_b64_tr_b16 a[128:129], v5 offset:6272
    v_mfma_f32_16x16x32_bf16 v[84:87], a[88:91], v[220:223], v[84:87]
    ds_read_b128 v[184:187], v116 offset:64
    v_mfma_f32_16x16x32_bf16 v[80:83], a[84:87], v[220:223], v[80:83]
    ds_read_b64_tr_b16 a[130:131], v5 offset:7040
    v_mfma_f32_16x16x32_bf16 v[80:83], a[96:99], v[224:227], v[80:83]
    v_mfma_f32_16x16x32_bf16 v[84:87], a[100:103], v[224:227], v[84:87]
    ds_read_b128 v[188:191], v116 offset:128
    v_mfma_f32_16x16x32_bf16 v[88:91], a[104:107], v[224:227], v[88:91]
    ds_read_b64_tr_b16 a[132:133], v4 offset:12416
    v_mfma_f32_16x16x32_bf16 v[92:95], a[72:75], v[228:231], v[92:95]
    buffer_load_dwordx4 v26, s[12:15], s46 offen offset:1024 lds
    s_add_u32 s46, s46, 18432
    v_mfma_f32_16x16x32_bf16 v[96:99], a[76:79], v[228:231], v[96:99]
    ds_read_b128 v[192:195], v117 offset:0
    v_mfma_f32_16x16x32_bf16 v[100:103], a[80:83], v[228:231], v[100:103]
    ds_read_b64_tr_b16 a[134:135], v4 offset:13184
    v_mfma_f32_16x16x32_bf16 v[100:103], a[92:95], v[232:235], v[100:103]
    ds_read_b64_tr_b16 a[136:137], v4 offset:12448
    v_mfma_f32_16x16x32_bf16 v[96:99], a[88:91], v[232:235], v[96:99]
    ds_read_b128 v[196:199], v117 offset:64
    v_mfma_f32_16x16x32_bf16 v[92:95], a[84:87], v[232:235], v[92:95]
    v_mfma_f32_16x16x32_bf16 v[92:95], a[96:99], v[236:239], v[92:95]
    ds_read_b64_tr_b16 a[138:139], v4 offset:13216
    v_mfma_f32_16x16x32_bf16 v[96:99], a[100:103], v[236:239], v[96:99]
    ds_read_b128 v[200:203], v117 offset:128
    v_mfma_f32_16x16x32_bf16 v[100:103], a[104:107], v[236:239], v[100:103]
    ds_read_b64_tr_b16 a[140:141], v5 offset:12480
    s_waitcnt lgkmcnt(7)
    v_mfma_f32_16x16x32_bf16 v[104:107], a[72:75], v[240:243], v[104:107]
    v_mfma_f32_16x16x32_bf16 v[108:111], a[76:79], v[240:243], v[108:111]
    ds_read_b128 v[204:207], v118 offset:0
    v_mfma_f32_16x16x32_bf16 v[112:115], a[80:83], v[240:243], v[112:115]
    ds_read_b64_tr_b16 a[142:143], v5 offset:13248
    v_mfma_f32_16x16x32_bf16 v[112:115], a[92:95], v[244:247], v[112:115]
    v_mfma_f32_16x16x32_bf16 v[108:111], a[88:91], v[244:247], v[108:111]
    ds_read_b128 v[208:211], v118 offset:64
    v_mfma_f32_16x16x32_bf16 v[104:107], a[84:87], v[244:247], v[104:107]
    v_mfma_f32_16x16x32_bf16 v[104:107], a[96:99], v[248:251], v[104:107]
    v_mfma_f32_16x16x32_bf16 v[108:111], a[100:103], v[248:251], v[108:111]
    ds_read_b128 v[212:215], v118 offset:128
    v_mfma_f32_16x16x32_bf16 v[112:115], a[104:107], v[248:251], v[112:115]
    s_waitcnt vmcnt(5)
    s_waitcnt lgkmcnt(2)
    s_barrier
    v_mfma_f32_16x16x32_bf16 v[44:47], a[108:111], v[180:183], v[44:47]
    v_mfma_f32_16x16x32_bf16 v[48:51], a[112:115], v[180:183], v[48:51]
    ds_read_b128 v[216:219], v119 offset:0
    v_mfma_f32_16x16x32_bf16 v[52:55], a[116:119], v[180:183], v[52:55]
    ds_read_b64_tr_b16 a[0:1], v4 offset:18624
    v_mfma_f32_16x16x32_bf16 v[52:55], a[128:131], v[184:187], v[52:55]
    ds_read_b128 v[136:139], v172 offset:1024
    v_mfma_f32_16x16x32_bf16 v[48:51], a[124:127], v[184:187], v[48:51]
    ds_read_b128 v[220:223], v119 offset:64
    s_add_u32 m0, s44, 0
    v_mfma_f32_16x16x32_bf16 v[44:47], a[120:123], v[184:187], v[44:47]
    buffer_load_dwordx4 v7, s[12:15], s46 offen offset:0 lds
    v_mfma_f32_16x16x32_bf16 v[44:47], a[132:135], v[188:191], v[44:47]
    ds_read_b64_tr_b16 a[2:3], v4 offset:19392
    v_mfma_f32_16x16x32_bf16 v[48:51], a[136:139], v[188:191], v[48:51]
    ds_read_b128 v[224:227], v119 offset:128
    v_mfma_f32_16x16x32_bf16 v[52:55], a[140:143], v[188:191], v[52:55]
    ds_read_b64_tr_b16 a[4:5], v4 offset:18656
    v_mfma_f32_16x16x32_bf16 v[56:59], a[108:111], v[192:195], v[56:59]
    ds_read_b64_tr_b16 a[6:7], v4 offset:19424
    v_mfma_f32_16x16x32_bf16 v[60:63], a[112:115], v[192:195], v[60:63]
    ds_read_b128 v[228:231], v120 offset:0
    v_mfma_f32_16x16x32_bf16 v[64:67], a[116:119], v[192:195], v[64:67]
    s_waitcnt lgkmcnt(6)
    v_xor_b32 v136, v136, v166
    v_xor_b32 v137, v137, v166
    v_mfma_f32_16x16x32_bf16 v[64:67], a[128:131], v[196:199], v[64:67]
    buffer_load_dwordx4 v7, s[12:15], s46 offen offset:1024 lds
    v_mfma_f32_16x16x32_bf16 v[60:63], a[124:127], v[196:199], v[60:63]
    ds_read_b128 v[232:235], v120 offset:64
    v_mfma_f32_16x16x32_bf16 v[56:59], a[120:123], v[196:199], v[56:59]
    v_xor_b32 v138, v138, v166
    v_xor_b32 v139, v139, v166
    v_mfma_f32_16x16x32_bf16 v[56:59], a[132:135], v[200:203], v[56:59]
    ds_read_b64_tr_b16 a[8:9], v5 offset:18688
    v_mfma_f32_16x16x32_bf16 v[60:63], a[136:139], v[200:203], v[60:63]
    ds_read_b128 v[236:239], v120 offset:128
    v_mfma_f32_16x16x32_bf16 v[64:67], a[140:143], v[200:203], v[64:67]
    ds_read_b64_tr_b16 a[10:11], v5 offset:19456
    ds_read_b64_tr_b16 a[12:13], v4 offset:24832
    v_mfma_f32_16x16x32_bf16 v[68:71], a[108:111], v[204:207], v[68:71]
    v_lshlrev_b32_sdwa v122, 4, v136 dst_sel:DWORD dst_unused:UNUSED_PAD src0_sel:DWORD src1_sel:WORD_0
    v_lshlrev_b32_sdwa v123, 4, v138 dst_sel:DWORD dst_unused:UNUSED_PAD src0_sel:DWORD src1_sel:WORD_0
    v_mfma_f32_16x16x32_bf16 v[72:75], a[112:115], v[204:207], v[72:75]
    ds_read_b128 v[240:243], v121 offset:0
    v_mfma_f32_16x16x32_bf16 v[76:79], a[116:119], v[204:207], v[76:79]
    buffer_load_dwordx4 v7, s[12:15], s46 offen offset:2048 lds
    v_mfma_f32_16x16x32_bf16 v[76:79], a[128:131], v[208:211], v[76:79]
    v_lshlrev_b32_sdwa v124, 4, v136 dst_sel:DWORD dst_unused:UNUSED_PAD src0_sel:DWORD src1_sel:WORD_1
    v_lshlrev_b32_sdwa v125, 4, v138 dst_sel:DWORD dst_unused:UNUSED_PAD src0_sel:DWORD src1_sel:WORD_1
    v_mfma_f32_16x16x32_bf16 v[72:75], a[124:127], v[208:211], v[72:75]
    ds_read_b128 v[244:247], v121 offset:64
    v_mfma_f32_16x16x32_bf16 v[68:71], a[120:123], v[208:211], v[68:71]
    ds_read_b64_tr_b16 a[14:15], v4 offset:25600
    v_mfma_f32_16x16x32_bf16 v[68:71], a[132:135], v[212:215], v[68:71]
    v_lshlrev_b32_sdwa v126, 4, v137 dst_sel:DWORD dst_unused:UNUSED_PAD src0_sel:DWORD src1_sel:WORD_0
    v_lshlrev_b32_sdwa v127, 4, v139 dst_sel:DWORD dst_unused:UNUSED_PAD src0_sel:DWORD src1_sel:WORD_0
    v_mfma_f32_16x16x32_bf16 v[72:75], a[136:139], v[212:215], v[72:75]
    ds_read_b128 v[248:251], v121 offset:128
    v_mfma_f32_16x16x32_bf16 v[76:79], a[140:143], v[212:215], v[76:79]
    ds_read_b64_tr_b16 a[16:17], v4 offset:24864
    v_mfma_f32_16x16x32_bf16 v[80:83], a[108:111], v[216:219], v[80:83]
    ds_read_b64_tr_b16 a[18:19], v4 offset:25632
    v_mfma_f32_16x16x32_bf16 v[84:87], a[112:115], v[216:219], v[84:87]
    ds_read_b128 v[180:183], v122 offset:0
    s_add_u32 m0, s45, 0
    v_mfma_f32_16x16x32_bf16 v[88:91], a[116:119], v[216:219], v[88:91]
    buffer_load_dwordx4 v26, s[12:15], s46 offen offset:0 lds
    s_waitcnt lgkmcnt(7)
    v_mfma_f32_16x16x32_bf16 v[88:91], a[128:131], v[220:223], v[88:91]
    ds_read_b64_tr_b16 a[20:21], v5 offset:24896
    s_mul_i32 s47, s30, 6656
    v_mfma_f32_16x16x32_bf16 v[84:87], a[124:127], v[220:223], v[84:87]
    ds_read_b128 v[184:187], v122 offset:64
    v_mfma_f32_16x16x32_bf16 v[80:83], a[120:123], v[220:223], v[80:83]
    ds_read_b64_tr_b16 a[22:23], v5 offset:25664
    v_mfma_f32_16x16x32_bf16 v[80:83], a[132:135], v[224:227], v[80:83]
    v_lshrrev_b32 v38, 4, v6
    s_add_u32 s47, s47, 123744
    v_mfma_f32_16x16x32_bf16 v[84:87], a[136:139], v[224:227], v[84:87]
    ds_read_b128 v[188:191], v122 offset:128
    v_mfma_f32_16x16x32_bf16 v[88:91], a[140:143], v[224:227], v[88:91]
    ds_read_b64_tr_b16 a[24:25], v4 offset:31040
    v_mul_u32_u24 v39, 43, v38
    v_mfma_f32_16x16x32_bf16 v[92:95], a[108:111], v[228:231], v[92:95]
    buffer_load_dwordx4 v26, s[12:15], s46 offen offset:1024 lds
    s_add_u32 s46, s46, 18432
    v_mfma_f32_16x16x32_bf16 v[96:99], a[112:115], v[228:231], v[96:99]
    ds_read_b128 v[192:195], v123 offset:0
    v_add_u32 v40, 128, v38
    v_mfma_f32_16x16x32_bf16 v[100:103], a[116:119], v[228:231], v[100:103]
    ds_read_b64_tr_b16 a[26:27], v4 offset:31808
    v_mfma_f32_16x16x32_bf16 v[100:103], a[128:131], v[232:235], v[100:103]
    ds_read_b64_tr_b16 a[28:29], v4 offset:31072
    v_mfma_f32_16x16x32_bf16 v[96:99], a[124:127], v[232:235], v[96:99]
    ds_read_b128 v[196:199], v123 offset:64
    v_mfma_f32_16x16x32_bf16 v[92:95], a[120:123], v[232:235], v[92:95]
    s_lshl_b32 s48, s29, 3
    v_lshrrev_b32 v39, 9, v39
    v_mfma_f32_16x16x32_bf16 v[92:95], a[132:135], v[236:239], v[92:95]
    ds_read_b64_tr_b16 a[30:31], v4 offset:31840
    v_mfma_f32_16x16x32_bf16 v[96:99], a[136:139], v[236:239], v[96:99]
    ds_read_b128 v[200:203], v123 offset:128
    v_mfma_f32_16x16x32_bf16 v[100:103], a[140:143], v[236:239], v[100:103]
    ds_read_b64_tr_b16 a[32:33], v5 offset:31104
    s_waitcnt lgkmcnt(7)
    v_mfma_f32_16x16x32_bf16 v[104:107], a[108:111], v[240:243], v[104:107]
    v_mul_u32_u24 v41, 2731, v40
    v_mfma_f32_16x16x32_bf16 v[108:111], a[112:115], v[240:243], v[108:111]
    ds_read_b128 v[204:207], v124 offset:0
    v_mfma_f32_16x16x32_bf16 v[112:115], a[116:119], v[240:243], v[112:115]
    ds_read_b64_tr_b16 a[34:35], v5 offset:31872
    v_mfma_f32_16x16x32_bf16 v[112:115], a[128:131], v[244:247], v[112:115]
    v_mad_i32_i24 v38, v39, -12, v38
    v_lshrrev_b32 v41, 16, v41
    v_mfma_f32_16x16x32_bf16 v[108:111], a[124:127], v[244:247], v[108:111]
    ds_read_b128 v[208:211], v124 offset:64
    v_mfma_f32_16x16x32_bf16 v[104:107], a[120:123], v[244:247], v[104:107]
    v_add_u32 v39, s48, v39
    v_mfma_f32_16x16x32_bf16 v[104:107], a[132:135], v[248:251], v[104:107]
    v_mfma_f32_16x16x32_bf16 v[108:111], a[136:139], v[248:251], v[108:111]
    ds_read_b128 v[212:215], v124 offset:128
    v_mfma_f32_16x16x32_bf16 v[112:115], a[140:143], v[248:251], v[112:115]
    s_waitcnt vmcnt(5)
    s_waitcnt lgkmcnt(2)
    s_barrier
    v_mul_u32_u24 v42, 24, v41
    v_mfma_f32_16x16x32_bf16 v[44:47], a[0:3], v[180:183], v[44:47]
    v_mul_u32_u24 v22, 208, v39
    v_mfma_f32_16x16x32_bf16 v[48:51], a[4:7], v[180:183], v[48:51]
    ds_read_b128 v[216:219], v125 offset:0
    v_mfma_f32_16x16x32_bf16 v[52:55], a[8:11], v[180:183], v[52:55]
    ds_read_b64_tr_b16 a[36:37], v4 offset:37248
    v_sub_u32 v40, v40, v42
    v_mfma_f32_16x16x32_bf16 v[52:55], a[20:23], v[184:187], v[52:55]
    ds_read_b128 v[136:139], v172 offset:1280
    v_mfma_f32_16x16x32_bf16 v[48:51], a[16:19], v[184:187], v[48:51]
    ds_read_b128 v[220:223], v125 offset:64
    s_add_u32 m0, s44, 18624
    v_mfma_f32_16x16x32_bf16 v[44:47], a[12:15], v[184:187], v[44:47]
    buffer_load_dwordx4 v7, s[12:15], s46 offen offset:0 lds
    v_mfma_f32_16x16x32_bf16 v[44:47], a[24:27], v[188:191], v[44:47]
    ds_read_b64_tr_b16 a[38:39], v4 offset:38016
    v_add_u32 v41, s48, v41
    v_mfma_f32_16x16x32_bf16 v[48:51], a[28:31], v[188:191], v[48:51]
    ds_read_b128 v[224:227], v125 offset:128
    v_mul_u32_u24 v24, s2, v39
    v_mfma_f32_16x16x32_bf16 v[52:55], a[32:35], v[188:191], v[52:55]
    ds_read_b64_tr_b16 a[40:41], v4 offset:37280
    v_lshlrev_b32 v38, 4, v38
    v_mfma_f32_16x16x32_bf16 v[56:59], a[0:3], v[192:195], v[56:59]
    ds_read_b64_tr_b16 a[42:43], v4 offset:38048
    v_mfma_f32_16x16x32_bf16 v[60:63], a[4:7], v[192:195], v[60:63]
    ds_read_b128 v[228:231], v126 offset:0
    v_mfma_f32_16x16x32_bf16 v[64:67], a[8:11], v[192:195], v[64:67]
    s_waitcnt lgkmcnt(6)
    v_xor_b32 v136, v136, v166
    v_xor_b32 v137, v137, v166
    v_mfma_f32_16x16x32_bf16 v[64:67], a[20:23], v[196:199], v[64:67]
    buffer_load_dwordx4 v7, s[12:15], s46 offen offset:1024 lds
    v_mfma_f32_16x16x32_bf16 v[60:63], a[16:19], v[196:199], v[60:63]
    ds_read_b128 v[232:235], v126 offset:64
    v_mul_u32_u24 v23, 208, v41
    v_mfma_f32_16x16x32_bf16 v[56:59], a[12:15], v[196:199], v[56:59]
    v_xor_b32 v138, v138, v166
    v_xor_b32 v139, v139, v166
    v_mfma_f32_16x16x32_bf16 v[56:59], a[24:27], v[200:203], v[56:59]
    ds_read_b64_tr_b16 a[44:45], v5 offset:37312
    v_mul_u32_u24 v25, s2, v41
    v_mfma_f32_16x16x32_bf16 v[60:63], a[28:31], v[200:203], v[60:63]
    ds_read_b128 v[236:239], v126 offset:128
    v_lshlrev_b32 v40, 3, v40
    v_mfma_f32_16x16x32_bf16 v[64:67], a[32:35], v[200:203], v[64:67]
    ds_read_b64_tr_b16 a[46:47], v5 offset:38080
    ds_read_b64_tr_b16 a[48:49], v4 offset:43456
    v_mfma_f32_16x16x32_bf16 v[68:71], a[0:3], v[204:207], v[68:71]
    v_lshlrev_b32_sdwa v128, 4, v136 dst_sel:DWORD dst_unused:UNUSED_PAD src0_sel:DWORD src1_sel:WORD_0
    v_lshlrev_b32_sdwa v129, 4, v138 dst_sel:DWORD dst_unused:UNUSED_PAD src0_sel:DWORD src1_sel:WORD_0
    v_mfma_f32_16x16x32_bf16 v[72:75], a[4:7], v[204:207], v[72:75]
    ds_read_b128 v[240:243], v127 offset:0
    v_add3_u32 v22, v22, s47, v38
    v_mfma_f32_16x16x32_bf16 v[76:79], a[8:11], v[204:207], v[76:79]
    buffer_load_dwordx4 v7, s[12:15], s46 offen offset:2048 lds
    v_mfma_f32_16x16x32_bf16 v[76:79], a[20:23], v[208:211], v[76:79]
    v_lshlrev_b32_sdwa v130, 4, v136 dst_sel:DWORD dst_unused:UNUSED_PAD src0_sel:DWORD src1_sel:WORD_1
    v_lshlrev_b32_sdwa v131, 4, v138 dst_sel:DWORD dst_unused:UNUSED_PAD src0_sel:DWORD src1_sel:WORD_1
    v_mfma_f32_16x16x32_bf16 v[72:75], a[16:19], v[208:211], v[72:75]
    ds_read_b128 v[244:247], v127 offset:64
    v_add_u32 v24, v24, v38
    v_mfma_f32_16x16x32_bf16 v[68:71], a[12:15], v[208:211], v[68:71]
    ds_read_b64_tr_b16 a[50:51], v4 offset:44224
    v_add3_u32 v23, v23, s47, v40
    v_mfma_f32_16x16x32_bf16 v[68:71], a[24:27], v[212:215], v[68:71]
    v_lshlrev_b32_sdwa v132, 4, v137 dst_sel:DWORD dst_unused:UNUSED_PAD src0_sel:DWORD src1_sel:WORD_0
    v_lshlrev_b32_sdwa v133, 4, v139 dst_sel:DWORD dst_unused:UNUSED_PAD src0_sel:DWORD src1_sel:WORD_0
    v_mfma_f32_16x16x32_bf16 v[72:75], a[28:31], v[212:215], v[72:75]
    ds_read_b128 v[248:251], v127 offset:128
    v_add_u32 v25, v25, v40
    v_mfma_f32_16x16x32_bf16 v[76:79], a[32:35], v[212:215], v[76:79]
    ds_read_b64_tr_b16 a[52:53], v4 offset:43488
    v_bfe_u32 v38, v6, 4, 2
    v_mfma_f32_16x16x32_bf16 v[80:83], a[0:3], v[216:219], v[80:83]
    ds_read_b64_tr_b16 a[54:55], v4 offset:44256
    v_mfma_f32_16x16x32_bf16 v[84:87], a[4:7], v[216:219], v[84:87]
    ds_read_b128 v[180:183], v128 offset:0
    s_add_u32 m0, s45, 18624
    v_mfma_f32_16x16x32_bf16 v[88:91], a[8:11], v[216:219], v[88:91]
    buffer_load_dwordx4 v26, s[12:15], s46 offen offset:0 lds
    s_waitcnt lgkmcnt(7)
    v_mfma_f32_16x16x32_bf16 v[88:91], a[20:23], v[220:223], v[88:91]
    ds_read_b64_tr_b16 a[56:57], v5 offset:43520
    v_bfe_u32 v39, v6, 6, 2
    v_mfma_f32_16x16x32_bf16 v[84:87], a[16:19], v[220:223], v[84:87]
    ds_read_b128 v[184:187], v128 offset:64
    v_mfma_f32_16x16x32_bf16 v[80:83], a[12:15], v[220:223], v[80:83]
    ds_read_b64_tr_b16 a[58:59], v5 offset:44288
    v_mfma_f32_16x16x32_bf16 v[80:83], a[24:27], v[224:227], v[80:83]
    v_lshl_add_u32 v38, v38, 2, v39
    v_lshrrev_b32 v39, 8, v6
    v_mfma_f32_16x16x32_bf16 v[84:87], a[28:31], v[224:227], v[84:87]
    ds_read_b128 v[188:191], v128 offset:128
    v_mul_u32_u24 v38, 208, v38
    v_mfma_f32_16x16x32_bf16 v[88:91], a[32:35], v[224:227], v[88:91]
    ds_read_b64_tr_b16 a[60:61], v4 offset:49664
    v_mfma_f32_16x16x32_bf16 v[92:95], a[0:3], v[228:231], v[92:95]
    buffer_load_dwordx4 v26, s[12:15], s46 offen offset:1024 lds
    s_add_u32 s46, s46, 18432
    v_mfma_f32_16x16x32_bf16 v[96:99], a[4:7], v[228:231], v[96:99]
    ds_read_b128 v[192:195], v129 offset:0
    s_lshl4_add_u32 s49, s48, s47
    v_mfma_f32_16x16x32_bf16 v[100:103], a[8:11], v[228:231], v[100:103]
    ds_read_b64_tr_b16 a[62:63], v4 offset:50432
    v_mfma_f32_16x16x32_bf16 v[100:103], a[20:23], v[232:235], v[100:103]
    ds_read_b64_tr_b16 a[64:65], v4 offset:49696
    v_mfma_f32_16x16x32_bf16 v[96:99], a[16:19], v[232:235], v[96:99]
    ds_read_b128 v[196:199], v129 offset:64
    v_mfma_f32_16x16x32_bf16 v[92:95], a[12:15], v[232:235], v[92:95]
    v_lshl_add_u32 v38, v39, 3, v38
    s_lshl2_add_u32 s48, s48, s47
    v_mfma_f32_16x16x32_bf16 v[92:95], a[24:27], v[236:239], v[92:95]
    ds_read_b64_tr_b16 a[66:67], v4 offset:50464
    v_mfma_f32_16x16x32_bf16 v[96:99], a[28:31], v[236:239], v[96:99]
    ds_read_b128 v[200:203], v129 offset:128
    v_mfma_f32_16x16x32_bf16 v[100:103], a[32:35], v[236:239], v[100:103]
    ds_read_b64_tr_b16 a[68:69], v5 offset:49728
    s_waitcnt lgkmcnt(7)
    v_mfma_f32_16x16x32_bf16 v[104:107], a[0:3], v[240:243], v[104:107]
    v_add_u32 v20, s49, v38
    v_add_u32 v21, s48, v38
    s_branch L_Pa_s1
L_Pa_t1:
    s_setpc_b64 s[78:79]
L_Pa_s1:
    v_mfma_f32_16x16x32_bf16 v[108:111], a[4:7], v[240:243], v[108:111]
    ds_read_b128 v[204:207], v130 offset:0
    v_mfma_f32_16x16x32_bf16 v[112:115], a[8:11], v[240:243], v[112:115]
    ds_read_b64_tr_b16 a[70:71], v5 offset:50496
    v_mfma_f32_16x16x32_bf16 v[112:115], a[20:23], v[244:247], v[112:115]
    v_mfma_f32_16x16x32_bf16 v[108:111], a[16:19], v[244:247], v[108:111]
    ds_read_b128 v[208:211], v130 offset:64
    v_mfma_f32_16x16x32_bf16 v[104:107], a[12:15], v[244:247], v[104:107]
    v_mfma_f32_16x16x32_bf16 v[104:107], a[24:27], v[248:251], v[104:107]
    v_mfma_f32_16x16x32_bf16 v[108:111], a[28:31], v[248:251], v[108:111]
    ds_read_b128 v[212:215], v130 offset:128
    v_mfma_f32_16x16x32_bf16 v[112:115], a[32:35], v[248:251], v[112:115]
    s_waitcnt vmcnt(5)
    s_waitcnt lgkmcnt(2)
    s_barrier
    v_mfma_f32_16x16x32_bf16 v[44:47], a[36:39], v[180:183], v[44:47]
    ds_read_b64_tr_b16 a[72:73], v4 offset:0
    v_mfma_f32_16x16x32_bf16 v[48:51], a[40:43], v[180:183], v[48:51]
    ds_read_b128 v[216:219], v131 offset:0
    s_add_u32 m0, s44, 37248
    v_mfma_f32_16x16x32_bf16 v[52:55], a[44:47], v[180:183], v[52:55]
    buffer_load_dwordx4 v7, s[12:15], s46 offen offset:0 lds
    v_mfma_f32_16x16x32_bf16 v[52:55], a[56:59], v[184:187], v[52:55]
    ds_read_b128 v[136:139], v172 offset:1536
    ds_read_b64_tr_b16 a[74:75], v4 offset:768
    v_mfma_f32_16x16x32_bf16 v[48:51], a[52:55], v[184:187], v[48:51]
    ds_read_b128 v[220:223], v131 offset:64
    ds_read_b64_tr_b16 a[76:77], v4 offset:32
    v_mfma_f32_16x16x32_bf16 v[44:47], a[48:51], v[184:187], v[44:47]
    ds_read_b64_tr_b16 a[78:79], v4 offset:800
    v_mfma_f32_16x16x32_bf16 v[44:47], a[60:63], v[188:191], v[44:47]
    ds_read_b64_tr_b16 a[80:81], v5 offset:64
    ds_read_b64_tr_b16 a[82:83], v5 offset:832
    v_mfma_f32_16x16x32_bf16 v[48:51], a[64:67], v[188:191], v[48:51]
    ds_read_b128 v[224:227], v131 offset:128
    v_mfma_f32_16x16x32_bf16 v[52:55], a[68:71], v[188:191], v[52:55]
    buffer_load_dwordx4 v7, s[12:15], s46 offen offset:1024 lds
    v_mfma_f32_16x16x32_bf16 v[56:59], a[36:39], v[192:195], v[56:59]
    ds_read_b64_tr_b16 a[84:85], v4 offset:6208
    ds_read_b64_tr_b16 a[86:87], v4 offset:6976
    v_mfma_f32_16x16x32_bf16 v[60:63], a[40:43], v[192:195], v[60:63]
    ds_read_b128 v[228:231], v132 offset:0
    ds_read_b64_tr_b16 a[88:89], v4 offset:6240
    v_mfma_f32_16x16x32_bf16 v[64:67], a[44:47], v[192:195], v[64:67]
    s_waitcnt lgkmcnt(7)
    v_xor_b32 v136, v136, v166
    v_xor_b32 v137, v137, v166
    v_mfma_f32_16x16x32_bf16 v[64:67], a[56:59], v[196:199], v[64:67]
    buffer_load_dwordx4 v7, s[12:15], s46 offen offset:2048 lds
    v_mfma_f32_16x16x32_bf16 v[60:63], a[52:55], v[196:199], v[60:63]
    ds_read_b128 v[232:235], v132 offset:64
    ds_read_b64_tr_b16 a[90:91], v4 offset:7008
    v_mfma_f32_16x16x32_bf16 v[56:59], a[48:51], v[196:199], v[56:59]
    v_xor_b32 v138, v138, v166
    v_xor_b32 v139, v139, v166
    ds_read_b64_tr_b16 a[92:93], v5 offset:6272
    v_mfma_f32_16x16x32_bf16 v[56:59], a[60:63], v[200:203], v[56:59]
    ds_read_b64_tr_b16 a[94:95], v5 offset:7040
    ds_read_b64_tr_b16 a[96:97], v4 offset:12416
    v_mfma_f32_16x16x32_bf16 v[60:63], a[64:67], v[200:203], v[60:63]
    ds_read_b128 v[236:239], v132 offset:128
    s_add_u32 m0, s45, 37248
    v_mfma_f32_16x16x32_bf16 v[64:67], a[68:71], v[200:203], v[64:67]
    buffer_load_dwordx4 v26, s[12:15], s46 offen offset:0 lds
    ds_read_b64_tr_b16 a[98:99], v4 offset:13184
    v_mfma_f32_16x16x32_bf16 v[68:71], a[36:39], v[204:207], v[68:71]
    v_lshlrev_b32_sdwa v116, 4, v136 dst_sel:DWORD dst_unused:UNUSED_PAD src0_sel:DWORD src1_sel:WORD_0
    v_lshlrev_b32_sdwa v117, 4, v138 dst_sel:DWORD dst_unused:UNUSED_PAD src0_sel:DWORD src1_sel:WORD_0
    v_mfma_f32_16x16x32_bf16 v[72:75], a[40:43], v[204:207], v[72:75]
    ds_read_b128 v[240:243], v133 offset:0
    ds_read_b64_tr_b16 a[100:101], v4 offset:12448
    v_mfma_f32_16x16x32_bf16 v[76:79], a[44:47], v[204:207], v[76:79]
    ds_read_b64_tr_b16 a[102:103], v4 offset:13216
    ds_read_b64_tr_b16 a[104:105], v5 offset:12480
    v_mfma_f32_16x16x32_bf16 v[76:79], a[56:59], v[208:211], v[76:79]
    v_lshlrev_b32_sdwa v118, 4, v136 dst_sel:DWORD dst_unused:UNUSED_PAD src0_sel:DWORD src1_sel:WORD_1
    v_lshlrev_b32_sdwa v119, 4, v138 dst_sel:DWORD dst_unused:UNUSED_PAD src0_sel:DWORD src1_sel:WORD_1
    ds_read_b64_tr_b16 a[106:107], v5 offset:13248
    v_mfma_f32_16x16x32_bf16 v[72:75], a[52:55], v[208:211], v[72:75]
    ds_read_b128 v[244:247], v133 offset:64
    v_mfma_f32_16x16x32_bf16 v[68:71], a[48:51], v[208:211], v[68:71]
    buffer_load_dwordx4 v26, s[12:15], s46 offen offset:1024 lds
    s_add_u32 s46, s46, 18432
    v_mfma_f32_16x16x32_bf16 v[68:71], a[60:63], v[212:215], v[68:71]
    v_lshlrev_b32_sdwa v120, 4, v137 dst_sel:DWORD dst_unused:UNUSED_PAD src0_sel:DWORD src1_sel:WORD_0
    v_lshlrev_b32_sdwa v121, 4, v139 dst_sel:DWORD dst_unused:UNUSED_PAD src0_sel:DWORD src1_sel:WORD_0
    v_mfma_f32_16x16x32_bf16 v[72:75], a[64:67], v[212:215], v[72:75]
    ds_read_b128 v[248:251], v133 offset:128
    v_mfma_f32_16x16x32_bf16 v[76:79], a[68:71], v[212:215], v[76:79]
    s_waitcnt vmcnt(5)
    s_waitcnt lgkmcnt(2)
    s_barrier
    v_mfma_f32_16x16x32_bf16 v[80:83], a[36:39], v[216:219], v[80:83]
    ds_read_b128 v[136:139], v172 offset:1792
    v_mfma_f32_16x16x32_bf16 v[84:87], a[40:43], v[216:219], v[84:87]
    ds_read_b128 v[180:183], v116 offset:0
    v_mfma_f32_16x16x32_bf16 v[88:91], a[44:47], v[216:219], v[88:91]
    ds_read_b64_tr_b16 a[108:109], v4 offset:18624
    v_mfma_f32_16x16x32_bf16 v[88:91], a[56:59], v[220:223], v[88:91]
    ds_read_b64_tr_b16 a[110:111], v4 offset:19392
    v_mfma_f32_16x16x32_bf16 v[84:87], a[52:55], v[220:223], v[84:87]
    ds_read_b128 v[184:187], v116 offset:64
    s_lshl_b32 s55, s55, 1
    v_mfma_f32_16x16x32_bf16 v[80:83], a[48:51], v[220:223], v[80:83]
    ds_read_b64_tr_b16 a[112:113], v4 offset:18656
    v_mfma_f32_16x16x32_bf16 v[80:83], a[60:63], v[224:227], v[80:83]
    ds_read_b64_tr_b16 a[114:115], v4 offset:19424
    v_mfma_f32_16x16x32_bf16 v[84:87], a[64:67], v[224:227], v[84:87]
    ds_read_b128 v[188:191], v116 offset:128
    s_mul_i32 s47, s30, 8064
    v_mfma_f32_16x16x32_bf16 v[88:91], a[68:71], v[224:227], v[88:91]
    s_waitcnt lgkmcnt(7)
    v_xor_b32 v136, v136, v166
    v_xor_b32 v137, v137, v166
    v_mfma_f32_16x16x32_bf16 v[92:95], a[36:39], v[228:231], v[92:95]
    ds_read_b64_tr_b16 a[116:117], v5 offset:18688
    ds_read_b64_tr_b16 a[118:119], v5 offset:19456
    v_mfma_f32_16x16x32_bf16 v[96:99], a[40:43], v[228:231], v[96:99]
    ds_read_b128 v[192:195], v117 offset:0
    ds_read_b64_tr_b16 a[120:121], v4 offset:24832
    v_mfma_f32_16x16x32_bf16 v[100:103], a[44:47], v[228:231], v[100:103]
    v_xor_b32 v138, v138, v166
    v_xor_b32 v139, v139, v166
    v_mfma_f32_16x16x32_bf16 v[100:103], a[56:59], v[232:235], v[100:103]
    v_lshlrev_b32_sdwa v122, 4, v136 dst_sel:DWORD dst_unused:UNUSED_PAD src0_sel:DWORD src1_sel:WORD_0
    v_lshlrev_b32_sdwa v123, 4, v138 dst_sel:DWORD dst_unused:UNUSED_PAD src0_sel:DWORD src1_sel:WORD_0
    v_mfma_f32_16x16x32_bf16 v[96:99], a[52:55], v[232:235], v[96:99]
    ds_read_b128 v[196:199], v117 offset:64
    s_lshl_b32 s48, s29, 3
    v_mfma_f32_16x16x32_bf16 v[92:95], a[48:51], v[232:235], v[92:95]
    v_lshlrev_b32_sdwa v124, 4, v136 dst_sel:DWORD dst_unused:UNUSED_PAD src0_sel:DWORD src1_sel:WORD_1
    v_lshlrev_b32_sdwa v125, 4, v138 dst_sel:DWORD dst_unused:UNUSED_PAD src0_sel:DWORD src1_sel:WORD_1
    v_mfma_f32_16x16x32_bf16 v[92:95], a[60:63], v[236:239], v[92:95]
    ds_read_b64_tr_b16 a[122:123], v4 offset:25600
    v_bfe_u32 v38, v6, 4, 2
    v_mfma_f32_16x16x32_bf16 v[96:99], a[64:67], v[236:239], v[96:99]
    ds_read_b128 v[200:203], v117 offset:128
    v_lshlrev_b32_sdwa v126, 4, v137 dst_sel:DWORD dst_unused:UNUSED_PAD src0_sel:DWORD src1_sel:WORD_0
    v_lshlrev_b32_sdwa v127, 4, v139 dst_sel:DWORD dst_unused:UNUSED_PAD src0_sel:DWORD src1_sel:WORD_0
    v_mfma_f32_16x16x32_bf16 v[100:103], a[68:71], v[236:239], v[100:103]
    ds_read_b64_tr_b16 a[124:125], v4 offset:24864
    v_bfe_u32 v39, v6, 6, 2
    v_mfma_f32_16x16x32_bf16 v[104:107], a[36:39], v[240:243], v[104:107]
    ds_read_b64_tr_b16 a[126:127], v4 offset:25632
    v_lshl_add_u32 v38, v38, 2, v39
    v_mfma_f32_16x16x32_bf16 v[108:111], a[40:43], v[240:243], v[108:111]
    ds_read_b128 v[204:207], v122 offset:0
    v_mfma_f32_16x16x32_bf16 v[112:115], a[44:47], v[240:243], v[112:115]
    ds_read_b64_tr_b16 a[128:129], v5 offset:24896
    ds_read_b128 v[136:139], v172 offset:2048
    v_mfma_f32_16x16x32_bf16 v[112:115], a[56:59], v[244:247], v[112:115]
    ds_read_b64_tr_b16 a[130:131], v5 offset:25664
    s_add_u32 s47, s47, 107616
    v_mfma_f32_16x16x32_bf16 v[108:111], a[52:55], v[244:247], v[108:111]
    ds_read_b128 v[208:211], v122 offset:64
    v_mfma_f32_16x16x32_bf16 v[104:107], a[48:51], v[244:247], v[104:107]
    ds_read_b64_tr_b16 a[132:133], v4 offset:31040
    v_lshrrev_b32 v39, 8, v6
    v_mfma_f32_16x16x32_bf16 v[104:107], a[60:63], v[248:251], v[104:107]
    ds_read_b64_tr_b16 a[134:135], v4 offset:31808
    v_mfma_f32_16x16x32_bf16 v[108:111], a[64:67], v[248:251], v[108:111]
    ds_read_b128 v[212:215], v122 offset:128
    v_mfma_f32_16x16x32_bf16 v[112:115], a[68:71], v[248:251], v[112:115]
    ds_read_b64_tr_b16 a[136:137], v4 offset:31072
    v_mul_u32_u24 v17, 72, v38
    s_waitcnt lgkmcnt(7)
    v_mfma_f32_16x16x32_bf16 v[44:47], a[72:75], v[180:183], v[44:47]
    ds_read_b64_tr_b16 a[138:139], v4 offset:31840
    v_mfma_f32_16x16x32_bf16 v[48:51], a[76:79], v[180:183], v[48:51]
    ds_read_b128 v[216:219], v123 offset:0
    v_mfma_f32_16x16x32_bf16 v[52:55], a[80:83], v[180:183], v[52:55]
    ds_read_b64_tr_b16 a[140:141], v5 offset:31104
    v_mul_u32_u24 v16, s2, v38
    v_mfma_f32_16x16x32_bf16 v[52:55], a[92:95], v[184:187], v[52:55]
    ds_read_b64_tr_b16 a[142:143], v5 offset:31872
    v_mfma_f32_16x16x32_bf16 v[48:51], a[88:91], v[184:187], v[48:51]
    ds_read_b128 v[220:223], v123 offset:64
    v_mfma_f32_16x16x32_bf16 v[44:47], a[84:87], v[184:187], v[44:47]
    s_waitcnt lgkmcnt(7)
    v_xor_b32 v136, v136, v166
    v_xor_b32 v137, v137, v166
    v_mfma_f32_16x16x32_bf16 v[44:47], a[96:99], v[188:191], v[44:47]
    v_xor_b32 v138, v138, v166
    v_xor_b32 v139, v139, v166
    v_mfma_f32_16x16x32_bf16 v[48:51], a[100:103], v[188:191], v[48:51]
    ds_read_b128 v[224:227], v123 offset:128
    v_mfma_f32_16x16x32_bf16 v[52:55], a[104:107], v[188:191], v[52:55]
    s_waitcnt vmcnt(0)
    s_waitcnt lgkmcnt(2)
    s_barrier
    s_lshl2_add_u32 s49, s48, s47
    v_lshl_add_u32 v17, v39, 3, v17
    v_mfma_f32_16x16x32_bf16 v[56:59], a[72:75], v[192:195], v[56:59]
    v_lshlrev_b32_sdwa v128, 4, v136 dst_sel:DWORD dst_unused:UNUSED_PAD src0_sel:DWORD src1_sel:WORD_0
    v_lshlrev_b32_sdwa v129, 4, v138 dst_sel:DWORD dst_unused:UNUSED_PAD src0_sel:DWORD src1_sel:WORD_0
    v_mfma_f32_16x16x32_bf16 v[60:63], a[76:79], v[192:195], v[60:63]
    ds_read_b128 v[228:231], v118 offset:0
    v_and_b32 v38, 1, v39
    v_mfma_f32_16x16x32_bf16 v[64:67], a[80:83], v[192:195], v[64:67]
    v_lshlrev_b32_sdwa v130, 4, v136 dst_sel:DWORD dst_unused:UNUSED_PAD src0_sel:DWORD src1_sel:WORD_1
    v_lshlrev_b32_sdwa v131, 4, v138 dst_sel:DWORD dst_unused:UNUSED_PAD src0_sel:DWORD src1_sel:WORD_1
    v_mfma_f32_16x16x32_bf16 v[64:67], a[92:95], v[196:199], v[64:67]
    ds_read_b64_tr_b16 a[0:1], v4 offset:37248
    v_mfma_f32_16x16x32_bf16 v[60:63], a[88:91], v[196:199], v[60:63]
    ds_read_b128 v[232:235], v118 offset:64
    v_lshrrev_b32 v39, 1, v39
    v_mfma_f32_16x16x32_bf16 v[56:59], a[84:87], v[196:199], v[56:59]
    ds_read_b64_tr_b16 a[2:3], v4 offset:38016
    ds_read_b64_tr_b16 a[4:5], v4 offset:37280
    v_mfma_f32_16x16x32_bf16 v[56:59], a[96:99], v[200:203], v[56:59]
    v_lshlrev_b32_sdwa v132, 4, v137 dst_sel:DWORD dst_unused:UNUSED_PAD src0_sel:DWORD src1_sel:WORD_0
    v_lshlrev_b32_sdwa v133, 4, v139 dst_sel:DWORD dst_unused:UNUSED_PAD src0_sel:DWORD src1_sel:WORD_0
    v_mfma_f32_16x16x32_bf16 v[60:63], a[100:103], v[200:203], v[60:63]
    ds_read_b128 v[236:239], v118 offset:128
    v_add_u32 v17, s49, v17
    v_mfma_f32_16x16x32_bf16 v[64:67], a[104:107], v[200:203], v[64:67]
    ds_read_b64_tr_b16 a[6:7], v4 offset:38048
    v_mfma_f32_16x16x32_bf16 v[44:47], a[108:111], v[204:207], v[44:47]
    ds_read_b64_tr_b16 a[8:9], v5 offset:37312
    v_lshl_add_u32 v38, v38, 1, v39
    v_mfma_f32_16x16x32_bf16 v[48:51], a[112:115], v[204:207], v[48:51]
    ds_read_b128 v[240:243], v128 offset:0
    v_mfma_f32_16x16x32_bf16 v[52:55], a[116:119], v[204:207], v[52:55]
    ds_read_b64_tr_b16 a[10:11], v5 offset:38080
    v_mfma_f32_16x16x32_bf16 v[52:55], a[128:131], v[208:211], v[52:55]
    ds_read_b64_tr_b16 a[12:13], v4 offset:43456
    v_lshrrev_b32 v39, 7, v6
    v_mfma_f32_16x16x32_bf16 v[48:51], a[124:127], v[208:211], v[48:51]
    ds_read_b128 v[244:247], v128 offset:64
    v_mfma_f32_16x16x32_bf16 v[44:47], a[120:123], v[208:211], v[44:47]
    ds_read_b64_tr_b16 a[14:15], v4 offset:44224
    v_mfma_f32_16x16x32_bf16 v[44:47], a[132:135], v[212:215], v[44:47]
    ds_read_b64_tr_b16 a[16:17], v4 offset:43488
    v_add_u32 v38, s48, v38
    v_mfma_f32_16x16x32_bf16 v[48:51], a[136:139], v[212:215], v[48:51]
    ds_read_b128 v[248:251], v128 offset:128
    v_mfma_f32_16x16x32_bf16 v[52:55], a[140:143], v[212:215], v[52:55]
    ds_read_b64_tr_b16 a[18:19], v4 offset:44256
    v_mfma_f32_16x16x32_bf16 v[56:59], a[108:111], v[216:219], v[56:59]
    ds_read_b64_tr_b16 a[20:21], v5 offset:43520
    v_add_u32 v39, s48, v39
    v_mfma_f32_16x16x32_bf16 v[60:63], a[112:115], v[216:219], v[60:63]
    ds_read_b128 v[180:183], v129 offset:0
    v_mfma_f32_16x16x32_bf16 v[64:67], a[116:119], v[216:219], v[64:67]
    ds_read_b64_tr_b16 a[22:23], v5 offset:44288
    s_waitcnt lgkmcnt(7)
    v_mfma_f32_16x16x32_bf16 v[64:67], a[128:131], v[220:223], v[64:67]
    ds_read_b64_tr_b16 a[24:25], v4 offset:49664
    v_lshl_add_u32 v16, v38, 4, v16
    v_mfma_f32_16x16x32_bf16 v[60:63], a[124:127], v[220:223], v[60:63]
    ds_read_b128 v[184:187], v129 offset:64
    v_mfma_f32_16x16x32_bf16 v[56:59], a[120:123], v[220:223], v[56:59]
    ds_read_b64_tr_b16 a[26:27], v4 offset:50432
    v_bfe_u32 v38, v6, 1, 6
    v_mfma_f32_16x16x32_bf16 v[56:59], a[132:135], v[224:227], v[56:59]
    ds_read_b64_tr_b16 a[28:29], v4 offset:49696
    v_mfma_f32_16x16x32_bf16 v[60:63], a[136:139], v[224:227], v[60:63]
    ds_read_b128 v[188:191], v129 offset:128
    v_mfma_f32_16x16x32_bf16 v[64:67], a[140:143], v[224:227], v[64:67]
    ds_read_b64_tr_b16 a[30:31], v4 offset:50464
    v_mfma_f32_16x16x32_bf16 v[68:71], a[72:75], v[228:231], v[68:71]
    ds_read_b64_tr_b16 a[32:33], v5 offset:49728
    v_mfma_f32_16x16x32_bf16 v[72:75], a[76:79], v[228:231], v[72:75]
    ds_read_b128 v[192:195], v124 offset:0
    v_mfma_f32_16x16x32_bf16 v[76:79], a[80:83], v[228:231], v[76:79]
    ds_read_b64_tr_b16 a[34:35], v5 offset:50496
    v_mfma_f32_16x16x32_bf16 v[76:79], a[92:95], v[232:235], v[76:79]
    v_mul_u32_u24 v18, 72, v39
    v_mul_u32_u24 v19, s2, v39
    v_mfma_f32_16x16x32_bf16 v[72:75], a[88:91], v[232:235], v[72:75]
    ds_read_b128 v[196:199], v124 offset:64
    v_mfma_f32_16x16x32_bf16 v[68:71], a[84:87], v[232:235], v[68:71]
    v_add3_u32 v18, v18, s47, v38
    v_mfma_f32_16x16x32_bf16 v[68:71], a[96:99], v[236:239], v[68:71]
    v_mfma_f32_16x16x32_bf16 v[72:75], a[100:103], v[236:239], v[72:75]
    ds_read_b128 v[200:203], v124 offset:128
    v_mfma_f32_16x16x32_bf16 v[76:79], a[104:107], v[236:239], v[76:79]
    v_add3_u32 v19, v19, 64, v38
    v_mfma_f32_16x16x32_bf16 v[44:47], a[0:3], v[240:243], v[44:47]
    v_mfma_f32_16x16x32_bf16 v[48:51], a[4:7], v[240:243], v[48:51]
    ds_read_b128 v[204:207], v130 offset:0
    v_mfma_f32_16x16x32_bf16 v[52:55], a[8:11], v[240:243], v[52:55]
    s_mov_b32 s46, s31
    s_waitcnt lgkmcnt(7)
    v_mfma_f32_16x16x32_bf16 v[52:55], a[20:23], v[244:247], v[52:55]
    v_mfma_f32_16x16x32_bf16 v[48:51], a[16:19], v[244:247], v[48:51]
    ds_read_b128 v[208:211], v130 offset:64
    v_mfma_f32_16x16x32_bf16 v[44:47], a[12:15], v[244:247], v[44:47]
    v_mfma_f32_16x16x32_bf16 v[44:47], a[24:27], v[248:251], v[44:47]
    s_waitcnt lgkmcnt(7)
    v_mfma_f32_16x16x32_bf16 v[48:51], a[28:31], v[248:251], v[48:51]
    ds_read_b128 v[212:215], v130 offset:128
    s_waitcnt lgkmcnt(5)
    v_mfma_f32_16x16x32_bf16 v[52:55], a[32:35], v[248:251], v[52:55]
    v_mfma_f32_16x16x32_bf16 v[56:59], a[0:3], v[180:183], v[56:59]
    v_mfma_f32_16x16x32_bf16 v[60:63], a[4:7], v[180:183], v[60:63]
    ds_read_b128 v[216:219], v119 offset:0
    v_mfma_f32_16x16x32_bf16 v[64:67], a[8:11], v[180:183], v[64:67]
    v_mfma_f32_16x16x32_bf16 v[64:67], a[20:23], v[184:187], v[64:67]
    v_mfma_f32_16x16x32_bf16 v[60:63], a[16:19], v[184:187], v[60:63]
    ds_read_b128 v[220:223], v119 offset:64
    v_mfma_f32_16x16x32_bf16 v[56:59], a[12:15], v[184:187], v[56:59]
    v_cvt_pk_bf16_f32 v32, v44, v45
    v_cvt_pk_bf16_f32 v33, v46, v47
    v_mfma_f32_16x16x32_bf16 v[56:59], a[24:27], v[188:191], v[56:59]
    v_cvt_pk_bf16_f32 v34, v48, v49
    v_cvt_pk_bf16_f32 v35, v50, v51
    v_mfma_f32_16x16x32_bf16 v[60:63], a[28:31], v[188:191], v[60:63]
    ds_read_b128 v[224:227], v119 offset:128
    v_mfma_f32_16x16x32_bf16 v[64:67], a[32:35], v[188:191], v[64:67]
    v_cvt_pk_bf16_f32 v36, v52, v53
    v_cvt_pk_bf16_f32 v37, v54, v55
    v_mfma_f32_16x16x32_bf16 v[68:71], a[108:111], v[192:195], v[68:71]
    v_permlane16_swap_b32 v32, v34
    v_permlane16_swap_b32 v33, v35
    v_mfma_f32_16x16x32_bf16 v[72:75], a[112:115], v[192:195], v[72:75]
    ds_read_b128 v[228:231], v125 offset:0
    v_mfma_f32_16x16x32_bf16 v[76:79], a[116:119], v[192:195], v[76:79]
    ds_write_b64 v17, v[36:37] offset:0
    s_waitcnt lgkmcnt(7)
    v_mfma_f32_16x16x32_bf16 v[76:79], a[128:131], v[196:199], v[76:79]
    buffer_store_dwordx4 v[32:35], v16, s[16:19], s31 offen sc1
    s_add_u32 s31, s31, s55
    v_mfma_f32_16x16x32_bf16 v[72:75], a[124:127], v[196:199], v[72:75]
    ds_read_b128 v[232:235], v125 offset:64
    v_mfma_f32_16x16x32_bf16 v[68:71], a[120:123], v[196:199], v[68:71]
    v_mfma_f32_16x16x32_bf16 v[68:71], a[132:135], v[200:203], v[68:71]
    v_mfma_f32_16x16x32_bf16 v[72:75], a[136:139], v[200:203], v[72:75]
    ds_read_b128 v[236:239], v125 offset:128
    v_mfma_f32_16x16x32_bf16 v[76:79], a[140:143], v[200:203], v[76:79]
    v_mfma_f32_16x16x32_bf16 v[68:71], a[0:3], v[204:207], v[68:71]
    v_mfma_f32_16x16x32_bf16 v[72:75], a[4:7], v[204:207], v[72:75]
    ds_read_b128 v[240:243], v131 offset:0
    v_mfma_f32_16x16x32_bf16 v[76:79], a[8:11], v[204:207], v[76:79]
    s_waitcnt lgkmcnt(7)
    v_mfma_f32_16x16x32_bf16 v[76:79], a[20:23], v[208:211], v[76:79]
    v_mfma_f32_16x16x32_bf16 v[72:75], a[16:19], v[208:211], v[72:75]
    ds_read_b128 v[244:247], v131 offset:64
    v_mfma_f32_16x16x32_bf16 v[68:71], a[12:15], v[208:211], v[68:71]
    v_cvt_pk_bf16_f32 v32, v56, v57
    v_cvt_pk_bf16_f32 v33, v58, v59
    v_mfma_f32_16x16x32_bf16 v[68:71], a[24:27], v[212:215], v[68:71]
    v_cvt_pk_bf16_f32 v34, v60, v61
    v_cvt_pk_bf16_f32 v35, v62, v63
    v_mfma_f32_16x16x32_bf16 v[72:75], a[28:31], v[212:215], v[72:75]
    ds_read_b128 v[248:251], v131 offset:128
    v_mfma_f32_16x16x32_bf16 v[76:79], a[32:35], v[212:215], v[76:79]
    v_cvt_pk_bf16_f32 v36, v64, v65
    v_cvt_pk_bf16_f32 v37, v66, v67
    v_mfma_f32_16x16x32_bf16 v[80:83], a[72:75], v[216:219], v[80:83]
    v_permlane16_swap_b32 v32, v34
    v_permlane16_swap_b32 v33, v35
    v_mfma_f32_16x16x32_bf16 v[84:87], a[76:79], v[216:219], v[84:87]
    ds_read_b128 v[180:183], v120 offset:0
    v_mfma_f32_16x16x32_bf16 v[88:91], a[80:83], v[216:219], v[88:91]
    ds_write_b64 v17, v[36:37] offset:1152
    s_waitcnt lgkmcnt(7)
    v_mfma_f32_16x16x32_bf16 v[88:91], a[92:95], v[220:223], v[88:91]
    buffer_store_dwordx4 v[32:35], v16, s[16:19], s31 offen sc1
    s_add_u32 s31, s31, s55
    v_mfma_f32_16x16x32_bf16 v[84:87], a[88:91], v[220:223], v[84:87]
    ds_read_b128 v[184:187], v120 offset:64
    v_mfma_f32_16x16x32_bf16 v[80:83], a[84:87], v[220:223], v[80:83]
    v_mfma_f32_16x16x32_bf16 v[80:83], a[96:99], v[224:227], v[80:83]
    v_mfma_f32_16x16x32_bf16 v[84:87], a[100:103], v[224:227], v[84:87]
    ds_read_b128 v[188:191], v120 offset:128
    v_mfma_f32_16x16x32_bf16 v[88:91], a[104:107], v[224:227], v[88:91]
    v_mfma_f32_16x16x32_bf16 v[80:83], a[108:111], v[228:231], v[80:83]
    v_mfma_f32_16x16x32_bf16 v[84:87], a[112:115], v[228:231], v[84:87]
    ds_read_b128 v[192:195], v126 offset:0
    v_mfma_f32_16x16x32_bf16 v[88:91], a[116:119], v[228:231], v[88:91]
    s_waitcnt lgkmcnt(7)
    v_mfma_f32_16x16x32_bf16 v[88:91], a[128:131], v[232:235], v[88:91]
    v_mfma_f32_16x16x32_bf16 v[84:87], a[124:127], v[232:235], v[84:87]
    ds_read_b128 v[196:199], v126 offset:64
    v_mfma_f32_16x16x32_bf16 v[80:83], a[120:123], v[232:235], v[80:83]
    v_cvt_pk_bf16_f32 v32, v68, v69
    v_cvt_pk_bf16_f32 v33, v70, v71
    v_mfma_f32_16x16x32_bf16 v[80:83], a[132:135], v[236:239], v[80:83]
    v_cvt_pk_bf16_f32 v34, v72, v73
    v_cvt_pk_bf16_f32 v35, v74, v75
    v_mfma_f32_16x16x32_bf16 v[84:87], a[136:139], v[236:239], v[84:87]
    ds_read_b128 v[200:203], v126 offset:128
    v_mfma_f32_16x16x32_bf16 v[88:91], a[140:143], v[236:239], v[88:91]
    v_cvt_pk_bf16_f32 v36, v76, v77
    v_cvt_pk_bf16_f32 v37, v78, v79
    v_mfma_f32_16x16x32_bf16 v[80:83], a[0:3], v[240:243], v[80:83]
    v_permlane16_swap_b32 v32, v34
    v_permlane16_swap_b32 v33, v35
    v_mfma_f32_16x16x32_bf16 v[84:87], a[4:7], v[240:243], v[84:87]
    ds_read_b128 v[204:207], v132 offset:0
    v_mfma_f32_16x16x32_bf16 v[88:91], a[8:11], v[240:243], v[88:91]
    ds_write_b64 v17, v[36:37] offset:2304
    s_waitcnt lgkmcnt(7)
    v_mfma_f32_16x16x32_bf16 v[88:91], a[20:23], v[244:247], v[88:91]
    buffer_store_dwordx4 v[32:35], v16, s[16:19], s31 offen sc1
    s_add_u32 s31, s31, s55
    v_mfma_f32_16x16x32_bf16 v[84:87], a[16:19], v[244:247], v[84:87]
    ds_read_b128 v[208:211], v132 offset:64
    v_mfma_f32_16x16x32_bf16 v[80:83], a[12:15], v[244:247], v[80:83]
    v_mfma_f32_16x16x32_bf16 v[80:83], a[24:27], v[248:251], v[80:83]
    v_mfma_f32_16x16x32_bf16 v[84:87], a[28:31], v[248:251], v[84:87]
    ds_read_b128 v[212:215], v132 offset:128
    s_waitcnt lgkmcnt(2)
    s_barrier
    v_mfma_f32_16x16x32_bf16 v[88:91], a[32:35], v[248:251], v[88:91]
    ds_read_b64 v[38:39], v18 offset:0
    v_mfma_f32_16x16x32_bf16 v[92:95], a[72:75], v[180:183], v[92:95]
    ds_read_b64 v[40:41], v18 offset:1152
    v_mfma_f32_16x16x32_bf16 v[96:99], a[76:79], v[180:183], v[96:99]
    ds_read_b128 v[216:219], v121 offset:0
    v_mfma_f32_16x16x32_bf16 v[100:103], a[80:83], v[180:183], v[100:103]
    ds_read_b64 v[42:43], v18 offset:2304
    v_mfma_f32_16x16x32_bf16 v[100:103], a[92:95], v[184:187], v[100:103]
    v_mfma_f32_16x16x32_bf16 v[96:99], a[88:91], v[184:187], v[96:99]
    ds_read_b128 v[220:223], v121 offset:64
    v_mfma_f32_16x16x32_bf16 v[92:95], a[84:87], v[184:187], v[92:95]
    v_cvt_pk_bf16_f32 v32, v80, v81
    v_cvt_pk_bf16_f32 v33, v82, v83
    v_mfma_f32_16x16x32_bf16 v[92:95], a[96:99], v[188:191], v[92:95]
    v_cvt_pk_bf16_f32 v34, v84, v85
    v_cvt_pk_bf16_f32 v35, v86, v87
    v_mfma_f32_16x16x32_bf16 v[96:99], a[100:103], v[188:191], v[96:99]
    ds_read_b128 v[224:227], v121 offset:128
    v_mfma_f32_16x16x32_bf16 v[100:103], a[104:107], v[188:191], v[100:103]
    s_waitcnt lgkmcnt(5)
    buffer_store_dwordx2 v[38:39], v19, s[16:19], s46 offen sc1
    s_add_u32 s46, s46, s55
    v_mfma_f32_16x16x32_bf16 v[92:95], a[108:111], v[192:195], v[92:95]
    v_cvt_pk_bf16_f32 v36, v88, v89
    v_cvt_pk_bf16_f32 v37, v90, v91
    v_mfma_f32_16x16x32_bf16 v[96:99], a[112:115], v[192:195], v[96:99]
    ds_read_b128 v[228:231], v127 offset:0
    v_mfma_f32_16x16x32_bf16 v[100:103], a[116:119], v[192:195], v[100:103]
    v_permlane16_swap_b32 v32, v34
    v_permlane16_swap_b32 v33, v35
    v_mfma_f32_16x16x32_bf16 v[100:103], a[128:131], v[196:199], v[100:103]
    s_waitcnt lgkmcnt(5)
    buffer_store_dwordx2 v[40:41], v19, s[16:19], s46 offen sc1
    s_add_u32 s46, s46, s55
    v_mfma_f32_16x16x32_bf16 v[96:99], a[124:127], v[196:199], v[96:99]
    ds_read_b128 v[232:235], v127 offset:64
    v_mfma_f32_16x16x32_bf16 v[92:95], a[120:123], v[196:199], v[92:95]
    ds_write_b64 v17, v[36:37] offset:3456
    v_mfma_f32_16x16x32_bf16 v[92:95], a[132:135], v[200:203], v[92:95]
    buffer_store_dwordx4 v[32:35], v16, s[16:19], s31 offen sc1
    s_add_u32 s31, s31, s55
    v_mfma_f32_16x16x32_bf16 v[96:99], a[136:139], v[200:203], v[96:99]
    ds_read_b128 v[236:239], v127 offset:128
    v_mfma_f32_16x16x32_bf16 v[100:103], a[140:143], v[200:203], v[100:103]
    s_waitcnt lgkmcnt(6)
    buffer_store_dwordx2 v[42:43], v19, s[16:19], s46 offen sc1
    s_add_u32 s46, s46, s55
    v_mfma_f32_16x16x32_bf16 v[92:95], a[0:3], v[204:207], v[92:95]
    v_mfma_f32_16x16x32_bf16 v[96:99], a[4:7], v[204:207], v[96:99]
    ds_read_b128 v[240:243], v133 offset:0
    v_mfma_f32_16x16x32_bf16 v[100:103], a[8:11], v[204:207], v[100:103]
    v_mfma_f32_16x16x32_bf16 v[100:103], a[20:23], v[208:211], v[100:103]
    v_mfma_f32_16x16x32_bf16 v[96:99], a[16:19], v[208:211], v[96:99]
    ds_read_b128 v[244:247], v133 offset:64
    v_mfma_f32_16x16x32_bf16 v[92:95], a[12:15], v[208:211], v[92:95]
    v_mfma_f32_16x16x32_bf16 v[92:95], a[24:27], v[212:215], v[92:95]
    v_mfma_f32_16x16x32_bf16 v[96:99], a[28:31], v[212:215], v[96:99]
    ds_read_b128 v[248:251], v133 offset:128
    v_mfma_f32_16x16x32_bf16 v[100:103], a[32:35], v[212:215], v[100:103]
    s_cmp_eq_u32 s36, 5
    s_cbranch_scc1 L_Pe6
    v_mfma_f32_16x16x32_bf16 v[104:107], a[72:75], v[216:219], v[104:107]
    v_mfma_f32_16x16x32_bf16 v[108:111], a[76:79], v[216:219], v[108:111]
    v_mfma_f32_16x16x32_bf16 v[112:115], a[80:83], v[216:219], v[112:115]
    s_waitcnt lgkmcnt(7)
    v_mfma_f32_16x16x32_bf16 v[112:115], a[92:95], v[220:223], v[112:115]
    v_mfma_f32_16x16x32_bf16 v[108:111], a[88:91], v[220:223], v[108:111]
    v_cvt_pk_bf16_f32 v32, v92, v93
    v_cvt_pk_bf16_f32 v33, v94, v95
    v_mfma_f32_16x16x32_bf16 v[104:107], a[84:87], v[220:223], v[104:107]
    v_cvt_pk_bf16_f32 v34, v96, v97
    v_cvt_pk_bf16_f32 v35, v98, v99
    v_mfma_f32_16x16x32_bf16 v[104:107], a[96:99], v[224:227], v[104:107]
    v_cvt_pk_bf16_f32 v36, v100, v101
    v_cvt_pk_bf16_f32 v37, v102, v103
    v_mfma_f32_16x16x32_bf16 v[108:111], a[100:103], v[224:227], v[108:111]
    v_permlane16_swap_b32 v32, v34
    v_permlane16_swap_b32 v33, v35
    v_mfma_f32_16x16x32_bf16 v[112:115], a[104:107], v[224:227], v[112:115]
    ds_write_b64 v17, v[36:37] offset:4608
    s_waitcnt lgkmcnt(7)
    v_mfma_f32_16x16x32_bf16 v[104:107], a[108:111], v[228:231], v[104:107]
    buffer_store_dwordx4 v[32:35], v16, s[16:19], s31 offen sc1
    s_add_u32 s31, s31, s55
    v_mfma_f32_16x16x32_bf16 v[108:111], a[112:115], v[228:231], v[108:111]
    v_mfma_f32_16x16x32_bf16 v[112:115], a[116:119], v[228:231], v[112:115]
    s_waitcnt lgkmcnt(6)
    v_mfma_f32_16x16x32_bf16 v[112:115], a[128:131], v[232:235], v[112:115]
    v_mfma_f32_16x16x32_bf16 v[108:111], a[124:127], v[232:235], v[108:111]
    s_waitcnt lgkmcnt(0)
    s_barrier
    v_mfma_f32_16x16x32_bf16 v[104:107], a[120:123], v[232:235], v[104:107]
    ds_read_b64 v[38:39], v18 offset:3456
    v_mfma_f32_16x16x32_bf16 v[104:107], a[132:135], v[236:239], v[104:107]
    ds_read_b64 v[40:41], v18 offset:4608
    v_mfma_f32_16x16x32_bf16 v[108:111], a[136:139], v[236:239], v[108:111]
    v_mfma_f32_16x16x32_bf16 v[112:115], a[140:143], v[236:239], v[112:115]
    v_mfma_f32_16x16x32_bf16 v[104:107], a[0:3], v[240:243], v[104:107]
    v_mfma_f32_16x16x32_bf16 v[108:111], a[4:7], v[240:243], v[108:111]
    s_waitcnt lgkmcnt(1)
    buffer_store_dwordx2 v[38:39], v19, s[16:19], s46 offen sc1
    s_add_u32 s46, s46, s55
    v_mfma_f32_16x16x32_bf16 v[112:115], a[8:11], v[240:243], v[112:115]
    v_mfma_f32_16x16x32_bf16 v[112:115], a[20:23], v[244:247], v[112:115]
    v_mfma_f32_16x16x32_bf16 v[108:111], a[16:19], v[244:247], v[108:111]
    s_waitcnt lgkmcnt(0)
    buffer_store_dwordx2 v[40:41], v19, s[16:19], s46 offen sc1
    s_add_u32 s46, s46, s55
    v_mfma_f32_16x16x32_bf16 v[104:107], a[12:15], v[244:247], v[104:107]
    v_mfma_f32_16x16x32_bf16 v[104:107], a[24:27], v[248:251], v[104:107]
    v_mfma_f32_16x16x32_bf16 v[108:111], a[28:31], v[248:251], v[108:111]
    v_mfma_f32_16x16x32_bf16 v[112:115], a[32:35], v[248:251], v[112:115]
    s_cmp_lg_u32 s54, 0
    s_nop 4
    v_cvt_pk_bf16_f32 v32, v104, v105
    v_cvt_pk_bf16_f32 v33, v106, v107
    v_cvt_pk_bf16_f32 v34, v108, v109
    v_cvt_pk_bf16_f32 v35, v110, v111
    ds_write_b64 v20, v[32:33] offset:0
    v_cvt_pk_bf16_f32 v36, v112, v113
    v_cvt_pk_bf16_f32 v37, v114, v115
    ds_write_b64 v20, v[34:35] offset:32
    ds_write_b64 v21, v[36:37] offset:64
    s_waitcnt lgkmcnt(0)
    s_barrier
    ds_read_b128 v[26:29], v22 offset:0
    ds_read_b64 v[30:31], v23 offset:0
    s_waitcnt lgkmcnt(1)
    buffer_store_dwordx4 v[26:29], v24, s[16:19], s31 offen sc1
    s_waitcnt lgkmcnt(0)
    buffer_store_dwordx2 v[30:31], v25, s[16:19], s31 offen sc1
    s_cbranch_scc1 L_gS
    s_endpgm
L_Pe6:
    s_cmp_lg_u32 s54, 0
    s_nop 1
    v_cvt_pk_bf16_f32 v32, v92, v93
    v_cvt_pk_bf16_f32 v33, v94, v95
    v_cvt_pk_bf16_f32 v34, v96, v97
    v_cvt_pk_bf16_f32 v35, v98, v99
    ds_write_b64 v20, v[32:33] offset:0
    v_cvt_pk_bf16_f32 v36, v100, v101
    v_cvt_pk_bf16_f32 v37, v102, v103
    ds_write_b64 v20, v[34:35] offset:32
    ds_write_b64 v21, v[36:37] offset:64
    s_waitcnt lgkmcnt(0)
    s_barrier
    ds_read_b64 v[38:39], v18 offset:3456
    ds_read_b128 v[26:29], v22 offset:0
    ds_read_b64 v[30:31], v23 offset:0
    s_waitcnt lgkmcnt(2)
    buffer_store_dwordx2 v[38:39], v19, s[16:19], s46 offen sc1
    s_waitcnt lgkmcnt(1)
    buffer_store_dwordx4 v[26:29], v24, s[16:19], s31 offen sc1
    s_waitcnt lgkmcnt(0)
    buffer_store_dwordx2 v[30:31], v25, s[16:19], s31 offen sc1
    s_cbranch_scc1 L_gS
    s_endpgm
L_Pz:
    s_cmp_le_u32 s72, 11
    s_cbranch_scc1 L_l10
    s_add_u32 m0, s33, 42944
    s_min_i32 s47, s20, s21
    s_add_u32 s20, s20, s55
    buffer_load_dwordx4 v8, s[4:7], s47 offen lds
L_l10:
    s_cmp_le_u32 s72, 12
    s_cbranch_scc1 L_l11
    s_add_u32 m0, s33, 46848
    s_min_i32 s47, s20, s21
    s_add_u32 s20, s20, s55
    buffer_load_dwordx4 v8, s[4:7], s47 offen lds
L_l11:
    s_cmp_le_u32 s72, 13
    s_cbranch_scc1 L_l12
    s_add_u32 m0, s33, 50752
    s_min_i32 s47, s20, s21
    s_add_u32 s20, s20, s55
    buffer_load_dwordx4 v8, s[4:7], s47 offen lds
L_l12:
    s_cmp_le_u32 s72, 14
    s_cbranch_scc1 L_l13
    s_add_u32 m0, s33, 54656
    s_min_i32 s47, s20, s21
    s_add_u32 s20, s20, s55
    buffer_load_dwordx4 v8, s[4:7], s47 offen lds
L_l13:
    s_cmp_le_u32 s72, 15
    s_cbranch_scc1 L_l14
    s_add_u32 m0, s33, 58560
    s_min_i32 s47, s20, s21
    s_add_u32 s20, s20, s55
    buffer_load_dwordx4 v8, s[4:7], s47 offen lds
L_l14:
    s_add_u32 m0, s44, 0
    s_nop 0
    buffer_load_dwordx4 v7, s[12:15], s46 offen offset:0 lds
    buffer_load_dwordx4 v7, s[12:15], s46 offen offset:1024 lds
    s_cmp_eq_u32 s37, 0
    s_cbranch_scc1 L_Pn
L_Pfail:
    v_mov_b32 v12, 0xff
    ds_write_b32 v14, v12
L_Pn:
    buffer_load_dwordx4 v7, s[12:15], s46 offen offset:2048 lds
    s_add_u32 m0, s45, 0
    s_nop 0
    buffer_load_dwordx4 v26, s[12:15], s46 offen offset:0 lds
    buffer_load_dwordx4 v26, s[12:15], s46 offen offset:1024 lds
    s_add_u32 s46, s46, 18432
    s_waitcnt vmcnt(5) lgkmcnt(0)
    s_barrier
    s_cmp_ge_u32 s36, 4
    s_cbranch_scc1 L_l15
    s_add_u32 m0, s44, 18624
    s_nop 0
    buffer_load_dwordx4 v7, s[12:15], s46 offen offset:0 lds
    buffer_load_dwordx4 v7, s[12:15], s46 offen offset:1024 lds
    buffer_load_dwordx4 v7, s[12:15], s46 offen offset:2048 lds
    s_add_u32 m0, s45, 18624
    s_nop 0
    buffer_load_dwordx4 v26, s[12:15], s46 offen offset:0 lds
    buffer_load_dwordx4 v26, s[12:15], s46 offen offset:1024 lds
    s_add_u32 s46, s46, 18432
L_l15:
L_Pn2:
    ds_read_b128 v[136:139], v172 offset:0
    ds_read_b128 v[144:147], v14
    s_waitcnt lgkmcnt(0)
    v_xor_b32 v136, v136, v166
    v_xor_b32 v137, v137, v166
    v_xor_b32 v138, v138, v166
    v_xor_b32 v139, v139, v166
    v_lshlrev_b32_sdwa v116, 4, v136 dst_sel:DWORD dst_unused:UNUSED_PAD src0_sel:DWORD src1_sel:WORD_0
    v_lshlrev_b32_sdwa v117, 4, v138 dst_sel:DWORD dst_unused:UNUSED_PAD src0_sel:DWORD src1_sel:WORD_0
    v_lshlrev_b32_sdwa v118, 4, v136 dst_sel:DWORD dst_unused:UNUSED_PAD src0_sel:DWORD src1_sel:WORD_1
    v_lshlrev_b32_sdwa v119, 4, v138 dst_sel:DWORD dst_unused:UNUSED_PAD src0_sel:DWORD src1_sel:WORD_1
    v_lshlrev_b32_sdwa v120, 4, v137 dst_sel:DWORD dst_unused:UNUSED_PAD src0_sel:DWORD src1_sel:WORD_0
    v_lshlrev_b32_sdwa v121, 4, v139 dst_sel:DWORD dst_unused:UNUSED_PAD src0_sel:DWORD src1_sel:WORD_0
    v_or3_b32 v144, v144, v145, v146
    v_or_b32 v144, v144, v147
    s_nop 0
    v_readfirstlane_b32 s54, v144
    s_branch L_Pa
L_Pr2:
    v_min_u32 v85, s32, v82
    v_cmp_ge_u32 s[64:65], s32, v82
    v_lshl_add_u32 v83, v85, 3, s38
    ds_read_b64 v[80:81], v83 offset:2048
    v_add_u32 v82, 64, v82
    s_add_u32 s39, s39, 64
    s_waitcnt lgkmcnt(0)
    v_readfirstlane_b32 s53, v78
    v_cvt_f32_ubyte2 v86, v81
    v_cvt_f32_ubyte3 v87, v81
    v_add_u32_sdwa v84, s49, v81 dst_sel:DWORD dst_unused:UNUSED_PAD src0_sel:DWORD src1_sel:WORD_0
    v_add_f32 v86, s68, v86
    v_add_f32 v87, s69, v87
    v_mov_b32 v81, s50
    v_lshlrev_b32 v61, 16, v80
    v_and_b32 v62, 0xffff0000, v80
    v_add_f32 v61, v61, v86
    v_add_f32 v62, v62, v87
    v_cvt_pk_bf16_f32 v60, v61, v62
    v_pk_max_i16 v60, v60, 0
    v_pk_min_i16 v60, v60, s52
    v_alignbit_b32 v60, v60, v60, s42
    v_lshlrev_b32 v61, 16, v60
    v_and_b32 v62, 0xffff0000, v60
    v_fract_f32 v63, v61
    v_fract_f32 v64, v62
    v_cvt_u32_f32 v65, v61
    v_cvt_u32_f32 v66, v62
    v_cmp_neq_f32 s[58:59], 0, v64
    v_cmp_neq_f32 s[60:61], 0, v63
    v_sub_f32 v67, 1.0, v63
    v_sub_f32 v68, 1.0, v64
    v_subrev_u32 v65, s71, v65
    v_subrev_u32 v66, s43, v66
    v_cvt_pk_bf16_f32 v61, v67, v68
    v_addc_co_u32 v74, vcc, 0, v66, s[58:59]
    v_addc_co_u32 v73, vcc, 0, v65, s[60:61]
    v_lshlrev_b32 v67, 16, v61
    v_and_b32 v68, 0xffff0000, v61
    v_mul_u32_u24 v75, 976, v65
    v_mul_f32 v69, v67, v68
    v_mul_f32 v70, v67, v64
    v_mul_f32 v71, v63, v68
    v_mul_f32 v72, v63, v64
    v_max_u32 v73, v73, v65
    v_max_u32 v61, v66, v74
    v_mad_u32_u24 v67, v66, 48, v75
    v_mad_u32_u24 v68, v74, 48, v75
    v_and_b32 v66, 12, v66
    v_and_b32 v74, 12, v74
    s_andn2_b64 s[62:63], s[60:61], s[58:59]
    v_add_lshl_u32 v67, v67, v66, 2
    v_add_lshl_u32 v68, v68, v74, 2
    v_cndmask_b32 v70, v71, v70, s[58:59]
    v_cndmask_b32 v62, 0, v174, s[62:63]
    s_and_b64 s[62:63], s[60:61], s[58:59]
    v_cndmask_b32 v71, 0, v71, s[58:59]
    s_and_b64 s[66:67], s[62:63], s[64:65]
    v_cmp_le_u32 s[60:61], s72, v73
    v_mbcnt_lo_u32_b32 v81, s66, v81
    v_cmp_lt_u32 s[58:59], 19, v61
    s_bcnt1_i32_b64 s48, s[66:67]
    v_lshl_or_b32 v58, v68, 16, v67
    v_mbcnt_hi_u32_b32 v81, s67, v81
    v_cvt_pk_bf16_f32 v57, v69, v70
    s_add_u32 s50, s50, s48
    v_cvt_pk_bf16_f32 v59, v71, v72
    v_sub_u32 v85, v85, v81
    v_and_b32 v62, 0xffff0000, v62
    v_sub_u32 v81, s32, v81
    v_cndmask_b32 v61, 0, v174, s[62:63]
    v_cndmask_b32 v85, v85, v81, s[66:67]
    v_add_u32 v56, v58, v62
    v_lshl_add_u32 v83, v85, 4, s38
    v_add_u32 v58, v58, v61
    v_add_u32 v85, s53, v85
    v_bfe_u32 v81, v85, 1, 2
    v_mad_u32_u24 v85, v85, 12, s35
    v_add_u32 v85, v85, v81
    s_mov_b64 exec, s[64:65]
    ds_write_b128 v83, v[56:59]
    ds_write_b16 v84, v85
    s_mov_b64 exec, -1
    s_or_b64 s[58:59], s[58:59], s[60:61]
    s_cbranch_scc1 L_Pfail
    s_cmp_lt_u32 s39, s37
    s_cbranch_scc1 L_Pr2
L_Pgl:
    s_mov_b32 s39, 0
    v_add_u32 v12, s39, v25
    v_min_u32 v12, s32, v12
    v_lshl_add_u32 v12, v12, 4, s38
    ds_read_b128 v[28:31], v12
    buffer_load_dwordx4 v7, s[12:15], s46 offen offset:2048 lds
    s_add_u32 m0, s45, 0
    s_nop 0
    buffer_load_dwordx4 v26, s[12:15], s46 offen offset:0 lds
    buffer_load_dwordx4 v26, s[12:15], s46 offen offset:1024 lds
    s_add_u32 s46, s46, 18432
    s_cmp_eq_u32 s50, 0
    s_cselect_b32 s47, 15, 0
    s_sub_u32 s50, s37, s50
    s_add_u32 s50, s50, s47
    s_waitcnt lgkmcnt(0)
    v_xor_b32_sdwa v0, v28, v164 dst_sel:DWORD dst_unused:UNUSED_PAD src0_sel:WORD_0 src1_sel:DWORD
    v_xor_b32_sdwa v2, v28, v164 dst_sel:DWORD dst_unused:UNUSED_PAD src0_sel:WORD_1 src1_sel:DWORD
    v_xor_b32_sdwa v1, v28, v173 dst_sel:DWORD dst_unused:UNUSED_PAD src0_sel:WORD_0 src1_sel:DWORD
    v_xor_b32_sdwa v3, v28, v173 dst_sel:DWORD dst_unused:UNUSED_PAD src0_sel:WORD_1 src1_sel:DWORD
    v_perm_b32 v32, v29, v29, v168
    v_perm_b32 v33, v29, v29, v169
    v_perm_b32 v34, v29, v29, v170
    v_perm_b32 v35, v29, v29, v171
    s_waitcnt vmcnt(5)
    s_barrier
    ds_read_b64_tr_b16 v[180:181], v0 offset:0
    ds_read_b64_tr_b16 v[182:183], v2 offset:0
    ds_read_b64_tr_b16 v[184:185], v1 offset:0
    ds_read_b64_tr_b16 v[186:187], v3 offset:0
    ds_read_b64_tr_b16 v[188:189], v0 offset:64
    ds_read_b64_tr_b16 v[190:191], v2 offset:64
    ds_read_b64_tr_b16 v[192:193], v1 offset:64
    ds_read_b64_tr_b16 v[194:195], v3 offset:64
    ds_read_b64_tr_b16 v[196:197], v0 offset:128
    ds_read_b64_tr_b16 v[198:199], v2 offset:128
    ds_read_b64_tr_b16 v[200:201], v1 offset:128
    ds_read_b64_tr_b16 v[202:203], v3 offset:128
    s_cmp_ge_u32 s36, 4
    s_cbranch_scc1 L_l16
    s_add_u32 m0, s44, 18624
    s_nop 0
    buffer_load_dwordx4 v7, s[12:15], s46 offen offset:0 lds
    buffer_load_dwordx4 v7, s[12:15], s46 offen offset:1024 lds
    buffer_load_dwordx4 v7, s[12:15], s46 offen offset:2048 lds
    s_add_u32 m0, s45, 18624
    s_nop 0
    buffer_load_dwordx4 v26, s[12:15], s46 offen offset:0 lds
    buffer_load_dwordx4 v26, s[12:15], s46 offen offset:1024 lds
    s_add_u32 s46, s46, 18432
L_l16:
    s_and_b32 s50, s50, -16
    s_cbranch_scc0 L_Pg4
L_Pl2:
    v_add_u32 v9, s39, v165
    v_min_u32 v9, s32, v9
    v_add_u32 v9, s53, v9
    s_add_u32 s39, s39, 16
    v_bfe_u32 v10, v9, 1, 2
    v_add_u32 v12, s39, v25
    v_mad_u32_u24 v9, v9, 12, v10
    v_min_u32 v12, s32, v12
    v_xor_b32_sdwa v9, v166, v9 dst_sel:DWORD dst_unused:UNUSED_PAD src0_sel:WORD_0 src1_sel:DWORD
    v_lshl_add_u32 v12, v12, 4, s38
    v_lshl_add_u32 v9, v9, 4, s24
    ds_read_b128 v[28:31], v12
    s_waitcnt lgkmcnt(11)
    v_mfma_f32_16x16x32_bf16 v[56:59], v[180:183], v[32:35], 0
    s_waitcnt lgkmcnt(9)
    v_mfma_f32_16x16x32_bf16 v[60:63], v[184:187], v[32:35], 0
    s_waitcnt lgkmcnt(7)
    v_mfma_f32_16x16x32_bf16 v[64:67], v[188:191], v[32:35], 0
    s_waitcnt lgkmcnt(5)
    v_mfma_f32_16x16x32_bf16 v[68:71], v[192:195], v[32:35], 0
    s_waitcnt lgkmcnt(3)
    v_mfma_f32_16x16x32_bf16 v[72:75], v[196:199], v[32:35], 0
    s_waitcnt lgkmcnt(0)
    v_xor_b32_sdwa v0, v28, v164 dst_sel:DWORD dst_unused:UNUSED_PAD src0_sel:WORD_0 src1_sel:DWORD
    v_xor_b32_sdwa v2, v28, v164 dst_sel:DWORD dst_unused:UNUSED_PAD src0_sel:WORD_1 src1_sel:DWORD
    v_xor_b32_sdwa v1, v28, v173 dst_sel:DWORD dst_unused:UNUSED_PAD src0_sel:WORD_0 src1_sel:DWORD
    v_xor_b32_sdwa v3, v28, v173 dst_sel:DWORD dst_unused:UNUSED_PAD src0_sel:WORD_1 src1_sel:DWORD
    v_mfma_f32_16x16x32_bf16 v[76:79], v[200:203], v[32:35], 0
    ds_read_b64_tr_b16 v[180:181], v0 offset:0
    ds_read_b64_tr_b16 v[182:183], v2 offset:0
    ds_read_b64_tr_b16 v[184:185], v1 offset:0
    ds_read_b64_tr_b16 v[186:187], v3 offset:0
    ds_read_b64_tr_b16 v[188:189], v0 offset:64
    ds_read_b64_tr_b16 v[190:191], v2 offset:64
    v_perm_b32 v32, v29, v29, v168
    v_perm_b32 v33, v29, v29, v169
    v_perm_b32 v34, v29, v29, v170
    v_perm_b32 v35, v29, v29, v171
    ds_read_b64_tr_b16 v[192:193], v1 offset:64
    v_cvt_pk_bf16_f32 v80, v56, v57
    ds_read_b64_tr_b16 v[194:195], v3 offset:64
    v_cvt_pk_bf16_f32 v81, v58, v59
    ds_read_b64_tr_b16 v[196:197], v0 offset:128
    v_cvt_pk_bf16_f32 v82, v60, v61
    ds_read_b64_tr_b16 v[198:199], v2 offset:128
    v_cvt_pk_bf16_f32 v83, v62, v63
    ds_read_b64_tr_b16 v[200:201], v1 offset:128
    v_cvt_pk_bf16_f32 v84, v64, v65
    ds_read_b64_tr_b16 v[202:203], v3 offset:128
    v_cvt_pk_bf16_f32 v85, v66, v67
    v_cvt_pk_bf16_f32 v86, v68, v69
    v_cvt_pk_bf16_f32 v87, v70, v71
    v_permlane32_swap_b32 v80, v82
    v_permlane32_swap_b32 v81, v83
    ds_write_b128 v9, v[80:83] offset:0
    v_cvt_pk_bf16_f32 v88, v72, v73
    v_cvt_pk_bf16_f32 v89, v74, v75
    v_cvt_pk_bf16_f32 v90, v76, v77
    v_cvt_pk_bf16_f32 v91, v78, v79
    v_permlane32_swap_b32 v84, v86
    v_permlane32_swap_b32 v85, v87
    ds_write_b128 v9, v[84:87] offset:64
    v_permlane32_swap_b32 v88, v90
    v_permlane32_swap_b32 v89, v91
    ds_write_b128 v9, v[88:91] offset:128
    s_cmp_lt_u32 s39, s50
    s_cbranch_scc1 L_Pl2
    s_cmp_ge_u32 s39, s37
    s_cbranch_scc1 L_Pn2
L_Pg4:
    v_xor_b32_sdwa v40, v30, v164 dst_sel:DWORD dst_unused:UNUSED_PAD src0_sel:WORD_0 src1_sel:DWORD
    v_xor_b32_sdwa v42, v30, v164 dst_sel:DWORD dst_unused:UNUSED_PAD src0_sel:WORD_1 src1_sel:DWORD
    v_xor_b32_sdwa v41, v30, v173 dst_sel:DWORD dst_unused:UNUSED_PAD src0_sel:WORD_0 src1_sel:DWORD
    v_xor_b32_sdwa v43, v30, v173 dst_sel:DWORD dst_unused:UNUSED_PAD src0_sel:WORD_1 src1_sel:DWORD
    v_perm_b32 v36, v31, v31, v168
    v_perm_b32 v37, v31, v31, v169
    v_perm_b32 v38, v31, v31, v170
    v_perm_b32 v39, v31, v31, v171
    ds_read_b64_tr_b16 v[204:205], v40 offset:0
    ds_read_b64_tr_b16 v[206:207], v42 offset:0
    ds_read_b64_tr_b16 v[208:209], v41 offset:0
    ds_read_b64_tr_b16 v[210:211], v43 offset:0
    ds_read_b64_tr_b16 v[212:213], v40 offset:64
    ds_read_b64_tr_b16 v[214:215], v42 offset:64
    ds_read_b64_tr_b16 v[216:217], v41 offset:64
    ds_read_b64_tr_b16 v[218:219], v43 offset:64
    ds_read_b64_tr_b16 v[220:221], v40 offset:128
    ds_read_b64_tr_b16 v[222:223], v42 offset:128
    ds_read_b64_tr_b16 v[224:225], v41 offset:128
    ds_read_b64_tr_b16 v[226:227], v43 offset:128
L_Pl4:
    v_add_u32 v9, s39, v165
    v_min_u32 v9, s32, v9
    v_add_u32 v9, s53, v9
    s_add_u32 s39, s39, 16
    v_bfe_u32 v10, v9, 1, 2
    v_add_u32 v12, s39, v25
    v_mad_u32_u24 v9, v9, 12, v10
    v_min_u32 v12, s32, v12
    v_xor_b32_sdwa v9, v166, v9 dst_sel:DWORD dst_unused:UNUSED_PAD src0_sel:WORD_0 src1_sel:DWORD
    v_lshl_add_u32 v12, v12, 4, s38
    v_lshl_add_u32 v9, v9, 4, s24
    ds_read_b128 v[28:31], v12
    s_waitcnt lgkmcnt(15)
    v_mfma_f32_16x16x32_bf16 v[56:59], v[180:183], v[32:35], 0
    v_mfma_f32_16x16x32_bf16 v[60:63], v[184:187], v[32:35], 0
    v_mfma_f32_16x16x32_bf16 v[64:67], v[188:191], v[32:35], 0
    v_mfma_f32_16x16x32_bf16 v[68:71], v[192:195], v[32:35], 0
    v_mfma_f32_16x16x32_bf16 v[72:75], v[196:199], v[32:35], 0
    s_waitcnt lgkmcnt(13)
    v_mfma_f32_16x16x32_bf16 v[76:79], v[200:203], v[32:35], 0
    s_waitcnt lgkmcnt(11)
    v_mfma_f32_16x16x32_bf16 v[56:59], v[204:207], v[36:39], v[56:59]
    s_waitcnt lgkmcnt(9)
    v_mfma_f32_16x16x32_bf16 v[60:63], v[208:211], v[36:39], v[60:63]
    s_waitcnt lgkmcnt(7)
    v_mfma_f32_16x16x32_bf16 v[64:67], v[212:215], v[36:39], v[64:67]
    s_waitcnt lgkmcnt(5)
    v_mfma_f32_16x16x32_bf16 v[68:71], v[216:219], v[36:39], v[68:71]
    s_waitcnt lgkmcnt(3)
    v_mfma_f32_16x16x32_bf16 v[72:75], v[220:223], v[36:39], v[72:75]
    s_waitcnt lgkmcnt(0)
    v_xor_b32_sdwa v0, v28, v164 dst_sel:DWORD dst_unused:UNUSED_PAD src0_sel:WORD_0 src1_sel:DWORD
    v_xor_b32_sdwa v2, v28, v164 dst_sel:DWORD dst_unused:UNUSED_PAD src0_sel:WORD_1 src1_sel:DWORD
    v_xor_b32_sdwa v1, v28, v173 dst_sel:DWORD dst_unused:UNUSED_PAD src0_sel:WORD_0 src1_sel:DWORD
    v_xor_b32_sdwa v3, v28, v173 dst_sel:DWORD dst_unused:UNUSED_PAD src0_sel:WORD_1 src1_sel:DWORD
    v_mfma_f32_16x16x32_bf16 v[76:79], v[224:227], v[36:39], v[76:79]
    v_xor_b32_sdwa v40, v30, v164 dst_sel:DWORD dst_unused:UNUSED_PAD src0_sel:WORD_0 src1_sel:DWORD
    v_xor_b32_sdwa v42, v30, v164 dst_sel:DWORD dst_unused:UNUSED_PAD src0_sel:WORD_1 src1_sel:DWORD
    v_xor_b32_sdwa v41, v30, v173 dst_sel:DWORD dst_unused:UNUSED_PAD src0_sel:WORD_0 src1_sel:DWORD
    v_xor_b32_sdwa v43, v30, v173 dst_sel:DWORD dst_unused:UNUSED_PAD src0_sel:WORD_1 src1_sel:DWORD
    ds_read_b64_tr_b16 v[180:181], v0 offset:0
    ds_read_b64_tr_b16 v[182:183], v2 offset:0
    ds_read_b64_tr_b16 v[184:185], v1 offset:0
    ds_read_b64_tr_b16 v[186:187], v3 offset:0
    ds_read_b64_tr_b16 v[188:189], v0 offset:64
    ds_read_b64_tr_b16 v[190:191], v2 offset:64
    v_perm_b32 v32, v29, v29, v168
    v_perm_b32 v33, v29, v29, v169
    v_perm_b32 v34, v29, v29, v170
    v_perm_b32 v35, v29, v29, v171
    ds_read_b64_tr_b16 v[192:193], v1 offset:64
    v_cvt_pk_bf16_f32 v80, v56, v57
    ds_read_b64_tr_b16 v[194:195], v3 offset:64
    v_cvt_pk_bf16_f32 v81, v58, v59
    ds_read_b64_tr_b16 v[196:197], v0 offset:128
    v_cvt_pk_bf16_f32 v82, v60, v61
    ds_read_b64_tr_b16 v[198:199], v2 offset:128
    v_cvt_pk_bf16_f32 v83, v62, v63
    ds_read_b64_tr_b16 v[200:201], v1 offset:128
    v_cvt_pk_bf16_f32 v84, v64, v65
    ds_read_b64_tr_b16 v[202:203], v3 offset:128
    v_cvt_pk_bf16_f32 v85, v66, v67
    ds_read_b64_tr_b16 v[204:205], v40 offset:0
    v_cvt_pk_bf16_f32 v86, v68, v69
    ds_read_b64_tr_b16 v[206:207], v42 offset:0
    v_cvt_pk_bf16_f32 v87, v70, v71
    ds_read_b64_tr_b16 v[208:209], v41 offset:0
    v_permlane32_swap_b32 v80, v82
    ds_read_b64_tr_b16 v[210:211], v43 offset:0
    v_permlane32_swap_b32 v81, v83
    ds_read_b64_tr_b16 v[212:213], v40 offset:64
    ds_write_b128 v9, v[80:83] offset:0
    ds_read_b64_tr_b16 v[214:215], v42 offset:64
    v_cvt_pk_bf16_f32 v88, v72, v73
    ds_read_b64_tr_b16 v[216:217], v41 offset:64
    v_cvt_pk_bf16_f32 v89, v74, v75
    ds_read_b64_tr_b16 v[218:219], v43 offset:64
    v_cvt_pk_bf16_f32 v90, v76, v77
    ds_read_b64_tr_b16 v[220:221], v40 offset:128
    v_cvt_pk_bf16_f32 v91, v78, v79
    ds_read_b64_tr_b16 v[222:223], v42 offset:128
    v_permlane32_swap_b32 v84, v86
    ds_read_b64_tr_b16 v[224:225], v41 offset:128
    v_permlane32_swap_b32 v85, v87
    ds_read_b64_tr_b16 v[226:227], v43 offset:128
    ds_write_b128 v9, v[84:87] offset:64
    v_perm_b32 v36, v31, v31, v168
    v_permlane32_swap_b32 v88, v90
    v_perm_b32 v37, v31, v31, v169
    v_permlane32_swap_b32 v89, v91
    v_perm_b32 v38, v31, v31, v170
    ds_write_b128 v9, v[88:91] offset:128
    v_perm_b32 v39, v31, v31, v171
    s_cmp_lt_u32 s39, s37
    s_cbranch_scc1 L_Pl4
    s_branch L_Pn2
L_Pd:
    s_cmp_eq_u32 s36, 3
    s_cbranch_scc1 L_Pj3
    ds_read_b128 v[180:183], v116 offset:0
    ds_read_b64_tr_b16 a[0:1], v4 offset:0
    ds_read_b64_tr_b16 a[2:3], v4 offset:768
    ds_read_b64_tr_b16 a[4:5], v4 offset:32
    ds_read_b64_tr_b16 a[6:7], v4 offset:800
    ds_read_b64_tr_b16 a[8:9], v5 offset:64
    ds_read_b64_tr_b16 a[10:11], v5 offset:832
    ds_read_b128 v[192:195], v117 offset:0
    ds_read_b64_tr_b16 a[12:13], v4 offset:6208
    ds_read_b64_tr_b16 a[14:15], v4 offset:6976
    ds_read_b128 v[136:139], v172 offset:256
    ds_read_b128 v[184:187], v116 offset:64
    ds_read_b64_tr_b16 a[16:17], v4 offset:6240
    s_add_u32 m0, s44, 37248
    s_nop 0
    buffer_load_dwordx4 v7, s[12:15], s46 offen offset:0 lds
    ds_read_b64_tr_b16 a[18:19], v4 offset:7008
    ds_read_b64_tr_b16 a[20:21], v5 offset:6272
    ds_read_b64_tr_b16 a[22:23], v5 offset:7040
    ds_read_b128 v[196:199], v117 offset:64
    buffer_load_dwordx4 v7, s[12:15], s46 offen offset:1024 lds
    ds_read_b128 v[188:191], v116 offset:128
    ds_read_b64_tr_b16 a[24:25], v4 offset:12416
    ds_read_b64_tr_b16 a[26:27], v4 offset:13184
    ds_read_b64_tr_b16 a[28:29], v4 offset:12448
    buffer_load_dwordx4 v7, s[12:15], s46 offen offset:2048 lds
    ds_read_b64_tr_b16 a[30:31], v4 offset:13216
    ds_read_b64_tr_b16 a[32:33], v5 offset:12480
    ds_read_b64_tr_b16 a[34:35], v5 offset:13248
    ds_read_b128 v[200:203], v117 offset:128
    s_add_u32 m0, s45, 37248
    s_nop 0
    buffer_load_dwordx4 v26, s[12:15], s46 offen offset:0 lds
    s_waitcnt lgkmcnt(7)
    v_xor_b32 v136, v136, v166
    v_xor_b32 v138, v138, v166
    v_lshlrev_b32_sdwa v122, 4, v136 dst_sel:DWORD dst_unused:UNUSED_PAD src0_sel:DWORD src1_sel:WORD_0
    v_lshlrev_b32_sdwa v123, 4, v138 dst_sel:DWORD dst_unused:UNUSED_PAD src0_sel:DWORD src1_sel:WORD_0
    buffer_load_dwordx4 v26, s[12:15], s46 offen offset:1024 lds
    s_add_u32 s46, s46, 18432
    v_mfma_f32_16x16x32_bf16 v[44:47], a[0:3], v[180:183], 0
    s_waitcnt lgkmcnt(1)
    s_barrier
    v_mfma_f32_16x16x32_bf16 v[48:51], a[4:7], v[180:183], 0
    ds_read_b128 v[204:207], v122 offset:0
    s_add_u32 m0, s44, 0
    ds_read_b128 v[136:139], v172 offset:512
    v_mfma_f32_16x16x32_bf16 v[52:55], a[8:11], v[180:183], 0
    buffer_load_dwordx4 v7, s[12:15], s46 offen offset:0 lds
    ds_read_b64_tr_b16 a[36:37], v4 offset:18624
    v_mfma_f32_16x16x32_bf16 v[56:59], a[0:3], v[192:195], 0
    ds_read_b64_tr_b16 a[38:39], v4 offset:19392
    ds_read_b64_tr_b16 a[40:41], v4 offset:18656
    v_mfma_f32_16x16x32_bf16 v[60:63], a[4:7], v[192:195], 0
    ds_read_b128 v[208:211], v122 offset:64
    ds_read_b64_tr_b16 a[42:43], v4 offset:19424
    v_mfma_f32_16x16x32_bf16 v[64:67], a[8:11], v[192:195], 0
    buffer_load_dwordx4 v7, s[12:15], s46 offen offset:1024 lds
    v_mfma_f32_16x16x32_bf16 v[52:55], a[20:23], v[184:187], v[52:55]
    ds_read_b64_tr_b16 a[44:45], v5 offset:18688
    ds_read_b64_tr_b16 a[46:47], v5 offset:19456
    v_mfma_f32_16x16x32_bf16 v[48:51], a[16:19], v[184:187], v[48:51]
    ds_read_b128 v[212:215], v122 offset:128
    ds_read_b64_tr_b16 a[48:49], v4 offset:24832
    v_mfma_f32_16x16x32_bf16 v[44:47], a[12:15], v[184:187], v[44:47]
    buffer_load_dwordx4 v7, s[12:15], s46 offen offset:2048 lds
    ds_read_b64_tr_b16 a[50:51], v4 offset:25600
    v_mfma_f32_16x16x32_bf16 v[64:67], a[20:23], v[196:199], v[64:67]
    ds_read_b64_tr_b16 a[52:53], v4 offset:24864
    ds_read_b64_tr_b16 a[54:55], v4 offset:25632
    v_mfma_f32_16x16x32_bf16 v[60:63], a[16:19], v[196:199], v[60:63]
    ds_read_b128 v[216:219], v123 offset:0
    s_add_u32 m0, s45, 0
    v_mfma_f32_16x16x32_bf16 v[56:59], a[12:15], v[196:199], v[56:59]
    buffer_load_dwordx4 v26, s[12:15], s46 offen offset:0 lds
    ds_read_b64_tr_b16 a[56:57], v5 offset:24896
    ds_read_b64_tr_b16 a[58:59], v5 offset:25664
    v_mfma_f32_16x16x32_bf16 v[44:47], a[24:27], v[188:191], v[44:47]
    ds_read_b64_tr_b16 a[60:61], v4 offset:31040
    ds_read_b64_tr_b16 a[62:63], v4 offset:31808
    v_mfma_f32_16x16x32_bf16 v[48:51], a[28:31], v[188:191], v[48:51]
    ds_read_b128 v[220:223], v123 offset:64
    ds_read_b64_tr_b16 a[64:65], v4 offset:31072
    v_mfma_f32_16x16x32_bf16 v[52:55], a[32:35], v[188:191], v[52:55]
    buffer_load_dwordx4 v26, s[12:15], s46 offen offset:1024 lds
    s_add_u32 s46, s46, 18432
    s_waitcnt lgkmcnt(7)
    v_mfma_f32_16x16x32_bf16 v[56:59], a[24:27], v[200:203], v[56:59]
    ds_read_b64_tr_b16 a[66:67], v4 offset:31840
    ds_read_b64_tr_b16 a[68:69], v5 offset:31104
    ds_read_b64_tr_b16 a[70:71], v5 offset:31872
    v_mfma_f32_16x16x32_bf16 v[60:63], a[28:31], v[200:203], v[60:63]
    ds_read_b128 v[224:227], v123 offset:128
    v_xor_b32 v136, v136, v166
    v_xor_b32 v138, v138, v166
    v_lshlrev_b32_sdwa v128, 4, v136 dst_sel:DWORD dst_unused:UNUSED_PAD src0_sel:DWORD src1_sel:WORD_0
    v_lshlrev_b32_sdwa v129, 4, v138 dst_sel:DWORD dst_unused:UNUSED_PAD src0_sel:DWORD src1_sel:WORD_0
    v_mfma_f32_16x16x32_bf16 v[64:67], a[32:35], v[200:203], v[64:67]
    s_waitcnt vmcnt(5)
    s_waitcnt lgkmcnt(1)
    s_barrier
    v_mfma_f32_16x16x32_bf16 v[44:47], a[36:39], v[204:207], v[44:47]
    ds_read_b64_tr_b16 a[72:73], v4 offset:37248
    ds_read_b64_tr_b16 a[74:75], v4 offset:38016
    v_mfma_f32_16x16x32_bf16 v[48:51], a[40:43], v[204:207], v[48:51]
    ds_read_b128 v[228:231], v128 offset:0
    s_add_u32 m0, s44, 18624
    ds_read_b128 v[136:139], v172 offset:768
    v_mfma_f32_16x16x32_bf16 v[52:55], a[44:47], v[204:207], v[52:55]
    buffer_load_dwordx4 v7, s[12:15], s46 offen offset:0 lds
    v_mfma_f32_16x16x32_bf16 v[52:55], a[56:59], v[208:211], v[52:55]
    ds_read_b64_tr_b16 a[76:77], v4 offset:37280
    ds_read_b64_tr_b16 a[78:79], v4 offset:38048
    v_mfma_f32_16x16x32_bf16 v[48:51], a[52:55], v[208:211], v[48:51]
    ds_read_b128 v[232:235], v128 offset:64
    ds_read_b64_tr_b16 a[80:81], v5 offset:37312
    v_mfma_f32_16x16x32_bf16 v[44:47], a[48:51], v[208:211], v[44:47]
    buffer_load_dwordx4 v7, s[12:15], s46 offen offset:1024 lds
    v_mfma_f32_16x16x32_bf16 v[44:47], a[60:63], v[212:215], v[44:47]
    ds_read_b64_tr_b16 a[82:83], v5 offset:38080
    ds_read_b64_tr_b16 a[84:85], v4 offset:43456
    v_mfma_f32_16x16x32_bf16 v[48:51], a[64:67], v[212:215], v[48:51]
    ds_read_b128 v[236:239], v128 offset:128
    ds_read_b64_tr_b16 a[86:87], v4 offset:44224
    v_mfma_f32_16x16x32_bf16 v[52:55], a[68:71], v[212:215], v[52:55]
    buffer_load_dwordx4 v7, s[12:15], s46 offen offset:2048 lds
    ds_read_b64_tr_b16 a[88:89], v4 offset:43488
    v_mfma_f32_16x16x32_bf16 v[56:59], a[36:39], v[216:219], v[56:59]
    ds_read_b64_tr_b16 a[90:91], v4 offset:44256
    ds_read_b64_tr_b16 a[92:93], v5 offset:43520
    v_mfma_f32_16x16x32_bf16 v[60:63], a[40:43], v[216:219], v[60:63]
    ds_read_b128 v[240:243], v129 offset:0
    s_add_u32 m0, s45, 18624
    v_mfma_f32_16x16x32_bf16 v[64:67], a[44:47], v[216:219], v[64:67]
    buffer_load_dwordx4 v26, s[12:15], s46 offen offset:0 lds
    ds_read_b64_tr_b16 a[94:95], v5 offset:44288
    v_mfma_f32_16x16x32_bf16 v[64:67], a[56:59], v[220:223], v[64:67]
    ds_read_b64_tr_b16 a[96:97], v4 offset:49664
    ds_read_b64_tr_b16 a[98:99], v4 offset:50432
    v_mfma_f32_16x16x32_bf16 v[60:63], a[52:55], v[220:223], v[60:63]
    ds_read_b128 v[244:247], v129 offset:64
    ds_read_b64_tr_b16 a[100:101], v4 offset:49696
    v_mfma_f32_16x16x32_bf16 v[56:59], a[48:51], v[220:223], v[56:59]
    buffer_load_dwordx4 v26, s[12:15], s46 offen offset:1024 lds
    s_add_u32 s46, s46, 18432
    s_waitcnt lgkmcnt(7)
    v_mfma_f32_16x16x32_bf16 v[56:59], a[60:63], v[224:227], v[56:59]
    ds_read_b64_tr_b16 a[102:103], v4 offset:50464
    ds_read_b64_tr_b16 a[104:105], v5 offset:49728
    ds_read_b64_tr_b16 a[106:107], v5 offset:50496
    v_mfma_f32_16x16x32_bf16 v[60:63], a[64:67], v[224:227], v[60:63]
    ds_read_b128 v[248:251], v129 offset:128
    v_xor_b32 v136, v136, v166
    v_xor_b32 v138, v138, v166
    v_lshlrev_b32_sdwa v116, 4, v136 dst_sel:DWORD dst_unused:UNUSED_PAD src0_sel:DWORD src1_sel:WORD_0
    v_lshlrev_b32_sdwa v117, 4, v138 dst_sel:DWORD dst_unused:UNUSED_PAD src0_sel:DWORD src1_sel:WORD_0
    v_mfma_f32_16x16x32_bf16 v[64:67], a[68:71], v[224:227], v[64:67]
    s_waitcnt vmcnt(5)
    s_waitcnt lgkmcnt(1)
    s_barrier
    v_mfma_f32_16x16x32_bf16 v[44:47], a[72:75], v[228:231], v[44:47]
    ds_read_b64_tr_b16 a[108:109], v4 offset:0
    ds_read_b64_tr_b16 a[110:111], v4 offset:768
    v_mfma_f32_16x16x32_bf16 v[48:51], a[76:79], v[228:231], v[48:51]
    ds_read_b128 v[180:183], v116 offset:0
    s_add_u32 m0, s44, 37248
    ds_read_b128 v[136:139], v172 offset:1024
    v_mfma_f32_16x16x32_bf16 v[52:55], a[80:83], v[228:231], v[52:55]
    buffer_load_dwordx4 v7, s[12:15], s46 offen offset:0 lds
    v_mfma_f32_16x16x32_bf16 v[52:55], a[92:95], v[232:235], v[52:55]
    ds_read_b64_tr_b16 a[112:113], v4 offset:32
    ds_read_b64_tr_b16 a[114:115], v4 offset:800
    v_mfma_f32_16x16x32_bf16 v[48:51], a[88:91], v[232:235], v[48:51]
    ds_read_b128 v[184:187], v116 offset:64
    ds_read_b64_tr_b16 a[116:117], v5 offset:64
    v_mfma_f32_16x16x32_bf16 v[44:47], a[84:87], v[232:235], v[44:47]
    buffer_load_dwordx4 v7, s[12:15], s46 offen offset:1024 lds
    v_mfma_f32_16x16x32_bf16 v[44:47], a[96:99], v[236:239], v[44:47]
    ds_read_b64_tr_b16 a[118:119], v5 offset:832
    ds_read_b64_tr_b16 a[120:121], v4 offset:6208
    v_mfma_f32_16x16x32_bf16 v[48:51], a[100:103], v[236:239], v[48:51]
    ds_read_b128 v[188:191], v116 offset:128
    ds_read_b64_tr_b16 a[122:123], v4 offset:6976
    v_mfma_f32_16x16x32_bf16 v[52:55], a[104:107], v[236:239], v[52:55]
    buffer_load_dwordx4 v7, s[12:15], s46 offen offset:2048 lds
    ds_read_b64_tr_b16 a[124:125], v4 offset:6240
    v_mfma_f32_16x16x32_bf16 v[56:59], a[72:75], v[240:243], v[56:59]
    ds_read_b64_tr_b16 a[126:127], v4 offset:7008
    ds_read_b64_tr_b16 a[128:129], v5 offset:6272
    v_mfma_f32_16x16x32_bf16 v[60:63], a[76:79], v[240:243], v[60:63]
    ds_read_b128 v[192:195], v117 offset:0
    s_add_u32 m0, s45, 37248
    v_mfma_f32_16x16x32_bf16 v[64:67], a[80:83], v[240:243], v[64:67]
    buffer_load_dwordx4 v26, s[12:15], s46 offen offset:0 lds
    ds_read_b64_tr_b16 a[130:131], v5 offset:7040
    v_mfma_f32_16x16x32_bf16 v[64:67], a[92:95], v[244:247], v[64:67]
    ds_read_b64_tr_b16 a[132:133], v4 offset:12416
    ds_read_b64_tr_b16 a[134:135], v4 offset:13184
    v_mfma_f32_16x16x32_bf16 v[60:63], a[88:91], v[244:247], v[60:63]
    ds_read_b128 v[196:199], v117 offset:64
    ds_read_b64_tr_b16 a[136:137], v4 offset:12448
    v_mfma_f32_16x16x32_bf16 v[56:59], a[84:87], v[244:247], v[56:59]
    buffer_load_dwordx4 v26, s[12:15], s46 offen offset:1024 lds
    s_add_u32 s46, s46, 18432
    s_waitcnt lgkmcnt(7)
    v_mfma_f32_16x16x32_bf16 v[56:59], a[96:99], v[248:251], v[56:59]
    ds_read_b64_tr_b16 a[138:139], v4 offset:13216
    ds_read_b64_tr_b16 a[140:141], v5 offset:12480
    ds_read_b64_tr_b16 a[142:143], v5 offset:13248
    v_mfma_f32_16x16x32_bf16 v[60:63], a[100:103], v[248:251], v[60:63]
    ds_read_b128 v[200:203], v117 offset:128
    v_xor_b32 v136, v136, v166
    v_xor_b32 v138, v138, v166
    v_lshlrev_b32_sdwa v122, 4, v136 dst_sel:DWORD dst_unused:UNUSED_PAD src0_sel:DWORD src1_sel:WORD_0
    v_lshlrev_b32_sdwa v123, 4, v138 dst_sel:DWORD dst_unused:UNUSED_PAD src0_sel:DWORD src1_sel:WORD_0
    v_mfma_f32_16x16x32_bf16 v[64:67], a[104:107], v[248:251], v[64:67]
    s_waitcnt vmcnt(5)
    s_waitcnt lgkmcnt(1)
    s_barrier
    v_mfma_f32_16x16x32_bf16 v[44:47], a[108:111], v[180:183], v[44:47]
    ds_read_b64_tr_b16 a[0:1], v4 offset:18624
    ds_read_b64_tr_b16 a[2:3], v4 offset:19392
    v_mfma_f32_16x16x32_bf16 v[48:51], a[112:115], v[180:183], v[48:51]
    ds_read_b128 v[204:207], v122 offset:0
    s_add_u32 m0, s44, 0
    ds_read_b128 v[136:139], v172 offset:1280
    v_mfma_f32_16x16x32_bf16 v[52:55], a[116:119], v[180:183], v[52:55]
    buffer_load_dwordx4 v7, s[12:15], s46 offen offset:0 lds
    v_mfma_f32_16x16x32_bf16 v[52:55], a[128:131], v[184:187], v[52:55]
    ds_read_b64_tr_b16 a[4:5], v4 offset:18656
    ds_read_b64_tr_b16 a[6:7], v4 offset:19424
    v_mfma_f32_16x16x32_bf16 v[48:51], a[124:127], v[184:187], v[48:51]
    ds_read_b128 v[208:211], v122 offset:64
    ds_read_b64_tr_b16 a[8:9], v5 offset:18688
    v_mfma_f32_16x16x32_bf16 v[44:47], a[120:123], v[184:187], v[44:47]
    buffer_load_dwordx4 v7, s[12:15], s46 offen offset:1024 lds
    v_mfma_f32_16x16x32_bf16 v[44:47], a[132:135], v[188:191], v[44:47]
    ds_read_b64_tr_b16 a[10:11], v5 offset:19456
    ds_read_b64_tr_b16 a[12:13], v4 offset:24832
    v_mfma_f32_16x16x32_bf16 v[48:51], a[136:139], v[188:191], v[48:51]
    ds_read_b128 v[212:215], v122 offset:128
    ds_read_b64_tr_b16 a[14:15], v4 offset:25600
    v_mfma_f32_16x16x32_bf16 v[52:55], a[140:143], v[188:191], v[52:55]
    buffer_load_dwordx4 v7, s[12:15], s46 offen offset:2048 lds
    ds_read_b64_tr_b16 a[16:17], v4 offset:24864
    v_mfma_f32_16x16x32_bf16 v[56:59], a[108:111], v[192:195], v[56:59]
    ds_read_b64_tr_b16 a[18:19], v4 offset:25632
    ds_read_b64_tr_b16 a[20:21], v5 offset:24896
    v_mfma_f32_16x16x32_bf16 v[60:63], a[112:115], v[192:195], v[60:63]
    ds_read_b128 v[216:219], v123 offset:0
    s_add_u32 m0, s45, 0
    v_mfma_f32_16x16x32_bf16 v[64:67], a[116:119], v[192:195], v[64:67]
    buffer_load_dwordx4 v26, s[12:15], s46 offen offset:0 lds
    ds_read_b64_tr_b16 a[22:23], v5 offset:25664
    v_mfma_f32_16x16x32_bf16 v[64:67], a[128:131], v[196:199], v[64:67]
    ds_read_b64_tr_b16 a[24:25], v4 offset:31040
    ds_read_b64_tr_b16 a[26:27], v4 offset:31808
    v_mfma_f32_16x16x32_bf16 v[60:63], a[124:127], v[196:199], v[60:63]
    ds_read_b128 v[220:223], v123 offset:64
    ds_read_b64_tr_b16 a[28:29], v4 offset:31072
    v_mfma_f32_16x16x32_bf16 v[56:59], a[120:123], v[196:199], v[56:59]
    buffer_load_dwordx4 v26, s[12:15], s46 offen offset:1024 lds
    s_add_u32 s46, s46, 18432
    s_waitcnt lgkmcnt(7)
    v_mfma_f32_16x16x32_bf16 v[56:59], a[132:135], v[200:203], v[56:59]
    ds_read_b64_tr_b16 a[30:31], v4 offset:31840
    ds_read_b64_tr_b16 a[32:33], v5 offset:31104
    ds_read_b64_tr_b16 a[34:35], v5 offset:31872
    v_mfma_f32_16x16x32_bf16 v[60:63], a[136:139], v[200:203], v[60:63]
    ds_read_b128 v[224:227], v123 offset:128
    v_xor_b32 v136, v136, v166
    v_xor_b32 v138, v138, v166
    v_lshlrev_b32_sdwa v128, 4, v136 dst_sel:DWORD dst_unused:UNUSED_PAD src0_sel:DWORD src1_sel:WORD_0
    v_lshlrev_b32_sdwa v129, 4, v138 dst_sel:DWORD dst_unused:UNUSED_PAD src0_sel:DWORD src1_sel:WORD_0
    v_mfma_f32_16x16x32_bf16 v[64:67], a[140:143], v[200:203], v[64:67]
    s_waitcnt vmcnt(5)
    s_waitcnt lgkmcnt(1)
    s_barrier
    v_mfma_f32_16x16x32_bf16 v[44:47], a[0:3], v[204:207], v[44:47]
    ds_read_b64_tr_b16 a[36:37], v4 offset:37248
    ds_read_b64_tr_b16 a[38:39], v4 offset:38016
    v_mfma_f32_16x16x32_bf16 v[48:51], a[4:7], v[204:207], v[48:51]
    ds_read_b128 v[228:231], v128 offset:0
    s_add_u32 m0, s44, 18624
    ds_read_b128 v[136:139], v172 offset:1536
    v_mfma_f32_16x16x32_bf16 v[52:55], a[8:11], v[204:207], v[52:55]
    buffer_load_dwordx4 v7, s[12:15], s46 offen offset:0 lds
    v_mfma_f32_16x16x32_bf16 v[52:55], a[20:23], v[208:211], v[52:55]
    ds_read_b64_tr_b16 a[40:41], v4 offset:37280
    ds_read_b64_tr_b16 a[42:43], v4 offset:38048
    v_mfma_f32_16x16x32_bf16 v[48:51], a[16:19], v[208:211], v[48:51]
    ds_read_b128 v[232:235], v128 offset:64
    ds_read_b64_tr_b16 a[44:45], v5 offset:37312
    v_mfma_f32_16x16x32_bf16 v[44:47], a[12:15], v[208:211], v[44:47]
    buffer_load_dwordx4 v7, s[12:15], s46 offen offset:1024 lds
    v_mfma_f32_16x16x32_bf16 v[44:47], a[24:27], v[212:215], v[44:47]
    ds_read_b64_tr_b16 a[46:47], v5 offset:38080
    ds_read_b64_tr_b16 a[48:49], v4 offset:43456
    v_mfma_f32_16x16x32_bf16 v[48:51], a[28:31], v[212:215], v[48:51]
    ds_read_b128 v[236:239], v128 offset:128
    ds_read_b64_tr_b16 a[50:51], v4 offset:44224
    v_mfma_f32_16x16x32_bf16 v[52:55], a[32:35], v[212:215], v[52:55]
    buffer_load_dwordx4 v7, s[12:15], s46 offen offset:2048 lds
    ds_read_b64_tr_b16 a[52:53], v4 offset:43488
    v_mfma_f32_16x16x32_bf16 v[56:59], a[0:3], v[216:219], v[56:59]
    ds_read_b64_tr_b16 a[54:55], v4 offset:44256
    ds_read_b64_tr_b16 a[56:57], v5 offset:43520
    v_mfma_f32_16x16x32_bf16 v[60:63], a[4:7], v[216:219], v[60:63]
    ds_read_b128 v[240:243], v129 offset:0
    s_add_u32 m0, s45, 18624
    v_mfma_f32_16x16x32_bf16 v[64:67], a[8:11], v[216:219], v[64:67]
    buffer_load_dwordx4 v26, s[12:15], s46 offen offset:0 lds
    ds_read_b64_tr_b16 a[58:59], v5 offset:44288
    v_mfma_f32_16x16x32_bf16 v[64:67], a[20:23], v[220:223], v[64:67]
    ds_read_b64_tr_b16 a[60:61], v4 offset:49664
    ds_read_b64_tr_b16 a[62:63], v4 offset:50432
    v_mfma_f32_16x16x32_bf16 v[60:63], a[16:19], v[220:223], v[60:63]
    ds_read_b128 v[244:247], v129 offset:64
    ds_read_b64_tr_b16 a[64:65], v4 offset:49696
    v_mfma_f32_16x16x32_bf16 v[56:59], a[12:15], v[220:223], v[56:59]
    buffer_load_dwordx4 v26, s[12:15], s46 offen offset:1024 lds
    s_add_u32 s46, s46, 18432
    s_waitcnt lgkmcnt(7)
    v_mfma_f32_16x16x32_bf16 v[56:59], a[24:27], v[224:227], v[56:59]
    ds_read_b64_tr_b16 a[66:67], v4 offset:50464
    ds_read_b64_tr_b16 a[68:69], v5 offset:49728
    ds_read_b64_tr_b16 a[70:71], v5 offset:50496
    v_mfma_f32_16x16x32_bf16 v[60:63], a[28:31], v[224:227], v[60:63]
    ds_read_b128 v[248:251], v129 offset:128
    v_xor_b32 v136, v136, v166
    v_xor_b32 v138, v138, v166
    v_lshlrev_b32_sdwa v116, 4, v136 dst_sel:DWORD dst_unused:UNUSED_PAD src0_sel:DWORD src1_sel:WORD_0
    v_lshlrev_b32_sdwa v117, 4, v138 dst_sel:DWORD dst_unused:UNUSED_PAD src0_sel:DWORD src1_sel:WORD_0
    v_mfma_f32_16x16x32_bf16 v[64:67], a[32:35], v[224:227], v[64:67]
    s_waitcnt vmcnt(5)
    s_waitcnt lgkmcnt(1)
    s_barrier
    v_mfma_f32_16x16x32_bf16 v[44:47], a[36:39], v[228:231], v[44:47]
    ds_read_b64_tr_b16 a[72:73], v4 offset:0
    ds_read_b64_tr_b16 a[74:75], v4 offset:768
    v_mfma_f32_16x16x32_bf16 v[48:51], a[40:43], v[228:231], v[48:51]
    ds_read_b128 v[180:183], v116 offset:0
    s_add_u32 m0, s44, 37248
    ds_read_b128 v[136:139], v172 offset:1792
    v_mfma_f32_16x16x32_bf16 v[52:55], a[44:47], v[228:231], v[52:55]
    buffer_load_dwordx4 v7, s[12:15], s46 offen offset:0 lds
    v_mfma_f32_16x16x32_bf16 v[52:55], a[56:59], v[232:235], v[52:55]
    ds_read_b64_tr_b16 a[76:77], v4 offset:32
    ds_read_b64_tr_b16 a[78:79], v4 offset:800
    v_mfma_f32_16x16x32_bf16 v[48:51], a[52:55], v[232:235], v[48:51]
    ds_read_b128 v[184:187], v116 offset:64
    ds_read_b64_tr_b16 a[80:81], v5 offset:64
    v_mfma_f32_16x16x32_bf16 v[44:47], a[48:51], v[232:235], v[44:47]
    buffer_load_dwordx4 v7, s[12:15], s46 offen offset:1024 lds
    v_mfma_f32_16x16x32_bf16 v[44:47], a[60:63], v[236:239], v[44:47]
    ds_read_b64_tr_b16 a[82:83], v5 offset:832
    ds_read_b64_tr_b16 a[84:85], v4 offset:6208
    v_mfma_f32_16x16x32_bf16 v[48:51], a[64:67], v[236:239], v[48:51]
    ds_read_b128 v[188:191], v116 offset:128
    ds_read_b64_tr_b16 a[86:87], v4 offset:6976
    v_mfma_f32_16x16x32_bf16 v[52:55], a[68:71], v[236:239], v[52:55]
    buffer_load_dwordx4 v7, s[12:15], s46 offen offset:2048 lds
    ds_read_b64_tr_b16 a[88:89], v4 offset:6240
    v_mfma_f32_16x16x32_bf16 v[56:59], a[36:39], v[240:243], v[56:59]
    ds_read_b64_tr_b16 a[90:91], v4 offset:7008
    ds_read_b64_tr_b16 a[92:93], v5 offset:6272
    v_mfma_f32_16x16x32_bf16 v[60:63], a[40:43], v[240:243], v[60:63]
    ds_read_b128 v[192:195], v117 offset:0
    s_add_u32 m0, s45, 37248
    v_mfma_f32_16x16x32_bf16 v[64:67], a[44:47], v[240:243], v[64:67]
    buffer_load_dwordx4 v26, s[12:15], s46 offen offset:0 lds
    ds_read_b64_tr_b16 a[94:95], v5 offset:7040
    v_mfma_f32_16x16x32_bf16 v[64:67], a[56:59], v[244:247], v[64:67]
    ds_read_b64_tr_b16 a[96:97], v4 offset:12416
    ds_read_b64_tr_b16 a[98:99], v4 offset:13184
    v_mfma_f32_16x16x32_bf16 v[60:63], a[52:55], v[244:247], v[60:63]
    ds_read_b128 v[196:199], v117 offset:64
    ds_read_b64_tr_b16 a[100:101], v4 offset:12448
    v_mfma_f32_16x16x32_bf16 v[56:59], a[48:51], v[244:247], v[56:59]
    buffer_load_dwordx4 v26, s[12:15], s46 offen offset:1024 lds
    s_add_u32 s46, s46, 18432
    s_waitcnt lgkmcnt(7)
    v_mfma_f32_16x16x32_bf16 v[56:59], a[60:63], v[248:251], v[56:59]
    ds_read_b64_tr_b16 a[102:103], v4 offset:13216
    ds_read_b64_tr_b16 a[104:105], v5 offset:12480
    ds_read_b64_tr_b16 a[106:107], v5 offset:13248
    v_mfma_f32_16x16x32_bf16 v[60:63], a[64:67], v[248:251], v[60:63]
    ds_read_b128 v[200:203], v117 offset:128
    v_xor_b32 v136, v136, v166
    v_xor_b32 v138, v138, v166
    v_lshlrev_b32_sdwa v122, 4, v136 dst_sel:DWORD dst_unused:UNUSED_PAD src0_sel:DWORD src1_sel:WORD_0
    v_lshlrev_b32_sdwa v123, 4, v138 dst_sel:DWORD dst_unused:UNUSED_PAD src0_sel:DWORD src1_sel:WORD_0
    v_mfma_f32_16x16x32_bf16 v[64:67], a[68:71], v[248:251], v[64:67]
    s_waitcnt vmcnt(5)
    s_waitcnt lgkmcnt(1)
    s_barrier
    v_mfma_f32_16x16x32_bf16 v[44:47], a[72:75], v[180:183], v[44:47]
    ds_read_b64_tr_b16 a[108:109], v4 offset:18624
    v_mfma_f32_16x16x32_bf16 v[48:51], a[76:79], v[180:183], v[48:51]
    ds_read_b128 v[204:207], v122 offset:0
    ds_read_b128 v[136:139], v172 offset:2048
    v_mfma_f32_16x16x32_bf16 v[52:55], a[80:83], v[180:183], v[52:55]
    ds_read_b64_tr_b16 a[110:111], v4 offset:19392
    v_mfma_f32_16x16x32_bf16 v[52:55], a[92:95], v[184:187], v[52:55]
    ds_read_b64_tr_b16 a[112:113], v4 offset:18656
    ds_read_b64_tr_b16 a[114:115], v4 offset:19424
    v_mfma_f32_16x16x32_bf16 v[48:51], a[88:91], v[184:187], v[48:51]
    ds_read_b128 v[208:211], v122 offset:64
    v_mfma_f32_16x16x32_bf16 v[44:47], a[84:87], v[184:187], v[44:47]
    ds_read_b64_tr_b16 a[116:117], v5 offset:18688
    v_mfma_f32_16x16x32_bf16 v[44:47], a[96:99], v[188:191], v[44:47]
    ds_read_b64_tr_b16 a[118:119], v5 offset:19456
    ds_read_b64_tr_b16 a[120:121], v4 offset:24832
    v_mfma_f32_16x16x32_bf16 v[48:51], a[100:103], v[188:191], v[48:51]
    ds_read_b128 v[212:215], v122 offset:128
    v_mfma_f32_16x16x32_bf16 v[52:55], a[104:107], v[188:191], v[52:55]
    ds_read_b64_tr_b16 a[122:123], v4 offset:25600
    ds_read_b64_tr_b16 a[124:125], v4 offset:24864
    v_mfma_f32_16x16x32_bf16 v[56:59], a[72:75], v[192:195], v[56:59]
    ds_read_b64_tr_b16 a[126:127], v4 offset:25632
    ds_read_b64_tr_b16 a[128:129], v5 offset:24896
    v_mfma_f32_16x16x32_bf16 v[60:63], a[76:79], v[192:195], v[60:63]
    ds_read_b128 v[216:219], v123 offset:0
    s_waitcnt lgkmcnt(7)
    v_xor_b32 v136, v136, v166
    v_xor_b32 v138, v138, v166
    v_mfma_f32_16x16x32_bf16 v[64:67], a[80:83], v[192:195], v[64:67]
    ds_read_b64_tr_b16 a[130:131], v5 offset:25664
    v_mfma_f32_16x16x32_bf16 v[64:67], a[92:95], v[196:199], v[64:67]
    ds_read_b64_tr_b16 a[132:133], v4 offset:31040
    ds_read_b64_tr_b16 a[134:135], v4 offset:31808
    v_mfma_f32_16x16x32_bf16 v[60:63], a[88:91], v[196:199], v[60:63]
    ds_read_b128 v[220:223], v123 offset:64
    v_mfma_f32_16x16x32_bf16 v[56:59], a[84:87], v[196:199], v[56:59]
    ds_read_b64_tr_b16 a[136:137], v4 offset:31072
    v_lshlrev_b32_sdwa v128, 4, v136 dst_sel:DWORD dst_unused:UNUSED_PAD src0_sel:DWORD src1_sel:WORD_0
    v_lshlrev_b32_sdwa v129, 4, v138 dst_sel:DWORD dst_unused:UNUSED_PAD src0_sel:DWORD src1_sel:WORD_0
    v_mfma_f32_16x16x32_bf16 v[56:59], a[96:99], v[200:203], v[56:59]
    ds_read_b64_tr_b16 a[138:139], v4 offset:31840
    ds_read_b64_tr_b16 a[140:141], v5 offset:31104
    ds_read_b64_tr_b16 a[142:143], v5 offset:31872
    v_mfma_f32_16x16x32_bf16 v[60:63], a[100:103], v[200:203], v[60:63]
    ds_read_b128 v[224:227], v123 offset:128
    v_mfma_f32_16x16x32_bf16 v[64:67], a[104:107], v[200:203], v[64:67]
    s_waitcnt vmcnt(0)
    s_waitcnt lgkmcnt(1)
    s_barrier
    v_mfma_f32_16x16x32_bf16 v[44:47], a[108:111], v[204:207], v[44:47]
    ds_read_b64_tr_b16 a[0:1], v4 offset:37248
    s_lshl_b32 s55, s55, 1
    v_mfma_f32_16x16x32_bf16 v[48:51], a[112:115], v[204:207], v[48:51]
    ds_read_b128 v[228:231], v128 offset:0
    s_mul_i32 s47, s30, 6656
    v_mfma_f32_16x16x32_bf16 v[52:55], a[116:119], v[204:207], v[52:55]
    ds_read_b64_tr_b16 a[2:3], v4 offset:38016
    v_lshrrev_b32 v38, 4, v6
    s_add_u32 s47, s47, 107616
    v_mfma_f32_16x16x32_bf16 v[52:55], a[128:131], v[208:211], v[52:55]
    ds_read_b64_tr_b16 a[4:5], v4 offset:37280
    ds_read_b64_tr_b16 a[6:7], v4 offset:38048
    v_mfma_f32_16x16x32_bf16 v[48:51], a[124:127], v[208:211], v[48:51]
    ds_read_b128 v[232:235], v128 offset:64
    v_mul_u32_u24 v39, 43, v38
    v_mfma_f32_16x16x32_bf16 v[44:47], a[120:123], v[208:211], v[44:47]
    ds_read_b64_tr_b16 a[8:9], v5 offset:37312
    v_add_u32 v40, 128, v38
    s_lshl_b32 s48, s29, 3
    v_mfma_f32_16x16x32_bf16 v[44:47], a[132:135], v[212:215], v[44:47]
    ds_read_b64_tr_b16 a[10:11], v5 offset:38080
    ds_read_b64_tr_b16 a[12:13], v4 offset:43456
    v_lshrrev_b32 v39, 9, v39
    v_mfma_f32_16x16x32_bf16 v[48:51], a[136:139], v[212:215], v[48:51]
    ds_read_b128 v[236:239], v128 offset:128
    v_mul_u32_u24 v41, 2731, v40
    v_mad_i32_i24 v38, v39, -12, v38
    v_mfma_f32_16x16x32_bf16 v[52:55], a[140:143], v[212:215], v[52:55]
    ds_read_b64_tr_b16 a[14:15], v4 offset:44224
    ds_read_b64_tr_b16 a[16:17], v4 offset:43488
    v_lshrrev_b32 v41, 16, v41
    v_mfma_f32_16x16x32_bf16 v[56:59], a[108:111], v[216:219], v[56:59]
    ds_read_b64_tr_b16 a[18:19], v4 offset:44256
    ds_read_b64_tr_b16 a[20:21], v5 offset:43520
    v_mfma_f32_16x16x32_bf16 v[60:63], a[112:115], v[216:219], v[60:63]
    ds_read_b128 v[240:243], v129 offset:0
    v_add_u32 v39, s48, v39
    v_mul_u32_u24 v42, 24, v41
    v_mfma_f32_16x16x32_bf16 v[64:67], a[116:119], v[216:219], v[64:67]
    ds_read_b64_tr_b16 a[22:23], v5 offset:44288
    v_mul_u32_u24 v18, 208, v39
    v_sub_u32 v40, v40, v42
    v_mfma_f32_16x16x32_bf16 v[64:67], a[128:131], v[220:223], v[64:67]
    ds_read_b64_tr_b16 a[24:25], v4 offset:49664
    ds_read_b64_tr_b16 a[26:27], v4 offset:50432
    v_mfma_f32_16x16x32_bf16 v[60:63], a[124:127], v[220:223], v[60:63]
    ds_read_b128 v[244:247], v129 offset:64
    v_add_u32 v41, s48, v41
    v_mul_u32_u24 v20, s2, v39
    v_mfma_f32_16x16x32_bf16 v[56:59], a[120:123], v[220:223], v[56:59]
    ds_read_b64_tr_b16 a[28:29], v4 offset:49696
    v_lshlrev_b32 v38, 4, v38
    v_mul_u32_u24 v19, 208, v41
    s_waitcnt lgkmcnt(7)
    v_mfma_f32_16x16x32_bf16 v[56:59], a[132:135], v[224:227], v[56:59]
    ds_read_b64_tr_b16 a[30:31], v4 offset:50464
    ds_read_b64_tr_b16 a[32:33], v5 offset:49728
    ds_read_b64_tr_b16 a[34:35], v5 offset:50496
    v_mfma_f32_16x16x32_bf16 v[60:63], a[136:139], v[224:227], v[60:63]
    ds_read_b128 v[248:251], v129 offset:128
    v_mul_u32_u24 v21, s2, v41
    v_lshlrev_b32 v40, 3, v40
    v_mfma_f32_16x16x32_bf16 v[64:67], a[140:143], v[224:227], v[64:67]
    v_add3_u32 v18, v18, s47, v38
    v_add_u32 v20, v20, v38
    v_mfma_f32_16x16x32_bf16 v[44:47], a[0:3], v[228:231], v[44:47]
    v_add3_u32 v19, v19, s47, v40
    v_add_u32 v21, v21, v40
    v_mfma_f32_16x16x32_bf16 v[48:51], a[4:7], v[228:231], v[48:51]
    v_bfe_u32 v38, v6, 4, 2
    v_mfma_f32_16x16x32_bf16 v[52:55], a[8:11], v[228:231], v[52:55]
    v_bfe_u32 v39, v6, 6, 2
    v_lshl_add_u32 v38, v38, 2, v39
    s_waitcnt lgkmcnt(7)
    v_mfma_f32_16x16x32_bf16 v[52:55], a[20:23], v[232:235], v[52:55]
    v_lshrrev_b32 v39, 8, v6
    v_mfma_f32_16x16x32_bf16 v[48:51], a[16:19], v[232:235], v[48:51]
    v_mul_u32_u24 v38, 208, v38
    v_mfma_f32_16x16x32_bf16 v[44:47], a[12:15], v[232:235], v[44:47]
    s_lshl4_add_u32 s49, s48, s47
    v_lshl_add_u32 v38, v39, 3, v38
    s_waitcnt lgkmcnt(6)
    v_mfma_f32_16x16x32_bf16 v[44:47], a[24:27], v[236:239], v[44:47]
    s_lshl2_add_u32 s48, s48, s47
    s_waitcnt lgkmcnt(3)
    v_mfma_f32_16x16x32_bf16 v[48:51], a[28:31], v[236:239], v[48:51]
    v_add_u32 v16, s49, v38
    s_waitcnt lgkmcnt(1)
    v_mfma_f32_16x16x32_bf16 v[52:55], a[32:35], v[236:239], v[52:55]
    v_add_u32 v17, s48, v38
    s_cmp_eq_u32 s36, 1
    s_cbranch_scc1 L_Pe2
    v_mfma_f32_16x16x32_bf16 v[56:59], a[0:3], v[240:243], v[56:59]
    v_mfma_f32_16x16x32_bf16 v[60:63], a[4:7], v[240:243], v[60:63]
    v_mfma_f32_16x16x32_bf16 v[64:67], a[8:11], v[240:243], v[64:67]
    v_mfma_f32_16x16x32_bf16 v[64:67], a[20:23], v[244:247], v[64:67]
    v_cvt_pk_bf16_f32 v32, v44, v45
    v_cvt_pk_bf16_f32 v33, v46, v47
    v_mfma_f32_16x16x32_bf16 v[60:63], a[16:19], v[244:247], v[60:63]
    v_cvt_pk_bf16_f32 v34, v48, v49
    v_cvt_pk_bf16_f32 v35, v50, v51
    v_mfma_f32_16x16x32_bf16 v[56:59], a[12:15], v[244:247], v[56:59]
    v_cvt_pk_bf16_f32 v36, v52, v53
    v_cvt_pk_bf16_f32 v37, v54, v55
    s_waitcnt lgkmcnt(0)
    v_mfma_f32_16x16x32_bf16 v[56:59], a[24:27], v[248:251], v[56:59]
    ds_write_b64 v16, v[32:33] offset:0
    v_mfma_f32_16x16x32_bf16 v[60:63], a[28:31], v[248:251], v[60:63]
    ds_write_b64 v16, v[34:35] offset:32
    v_mfma_f32_16x16x32_bf16 v[64:67], a[32:35], v[248:251], v[64:67]
    ds_write_b64 v17, v[36:37] offset:64
    s_waitcnt lgkmcnt(0)
    s_barrier
    ds_read_b128 v[38:41], v18 offset:0
    ds_read_b64 v[42:43], v19 offset:0
    v_cvt_pk_bf16_f32 v32, v56, v57
    v_cvt_pk_bf16_f32 v33, v58, v59
    v_cvt_pk_bf16_f32 v34, v60, v61
    v_cvt_pk_bf16_f32 v35, v62, v63
    ds_write_b64 v16, v[32:33] offset:3328
    s_waitcnt lgkmcnt(2)
    buffer_store_dwordx4 v[38:41], v20, s[16:19], s31 offen sc1
    s_waitcnt lgkmcnt(1)
    buffer_store_dwordx2 v[42:43], v21, s[16:19], s31 offen sc1
    s_add_u32 s31, s31, s55
    s_cmp_lg_u32 s54, 0
    v_cvt_pk_bf16_f32 v36, v64, v65
    v_cvt_pk_bf16_f32 v37, v66, v67
    ds_write_b64 v16, v[34:35] offset:3360
    ds_write_b64 v17, v[36:37] offset:3392
    s_waitcnt lgkmcnt(0)
    s_barrier
    ds_read_b128 v[24:27], v18 offset:3328
    ds_read_b64 v[28:29], v19 offset:3328
    s_waitcnt lgkmcnt(1)
    buffer_store_dwordx4 v[24:27], v20, s[16:19], s31 offen sc1
    s_waitcnt lgkmcnt(0)
    buffer_store_dwordx2 v[28:29], v21, s[16:19], s31 offen sc1
    s_barrier
    s_cbranch_scc1 L_gS
    s_endpgm
L_Pe2:
    s_cmp_lg_u32 s54, 0
    v_cvt_pk_bf16_f32 v32, v44, v45
    v_cvt_pk_bf16_f32 v33, v46, v47
    v_cvt_pk_bf16_f32 v34, v48, v49
    v_cvt_pk_bf16_f32 v35, v50, v51
    ds_write_b64 v16, v[32:33] offset:0
    v_cvt_pk_bf16_f32 v36, v52, v53
    v_cvt_pk_bf16_f32 v37, v54, v55
    ds_write_b64 v16, v[34:35] offset:32
    ds_write_b64 v17, v[36:37] offset:64
    s_waitcnt lgkmcnt(0)
    s_barrier
    ds_read_b128 v[38:41], v18 offset:0
    ds_read_b64 v[42:43], v19 offset:0
    s_waitcnt lgkmcnt(1)
    buffer_store_dwordx4 v[38:41], v20, s[16:19], s31 offen sc1
    s_waitcnt lgkmcnt(0)
    buffer_store_dwordx2 v[42:43], v21, s[16:19], s31 offen sc1
    s_barrier
    s_barrier
    s_cbranch_scc1 L_gS
    s_endpgm
L_Pj3:
    ds_read_b128 v[180:183], v116 offset:0
    ds_read_b64_tr_b16 a[0:1], v4 offset:0
    ds_read_b64_tr_b16 a[2:3], v4 offset:768
    ds_read_b64_tr_b16 a[4:5], v4 offset:32
    ds_read_b64_tr_b16 a[6:7], v4 offset:800
    ds_read_b64_tr_b16 a[8:9], v5 offset:64
    ds_read_b64_tr_b16 a[10:11], v5 offset:832
    ds_read_b128 v[192:195], v117 offset:0
    ds_read_b128 v[204:207], v118 offset:0
    ds_read_b64_tr_b16 a[12:13], v4 offset:6208
    ds_read_b64_tr_b16 a[14:15], v4 offset:6976
    ds_read_b128 v[136:139], v172 offset:256
    ds_read_b128 v[184:187], v116 offset:64
    ds_read_b64_tr_b16 a[16:17], v4 offset:6240
    s_add_u32 m0, s44, 37248
    s_nop 0
    buffer_load_dwordx4 v7, s[12:15], s46 offen offset:0 lds
    ds_read_b64_tr_b16 a[18:19], v4 offset:7008
    ds_read_b64_tr_b16 a[20:21], v5 offset:6272
    ds_read_b64_tr_b16 a[22:23], v5 offset:7040
    ds_read_b128 v[196:199], v117 offset:64
    buffer_load_dwordx4 v7, s[12:15], s46 offen offset:1024 lds
    ds_read_b128 v[208:211], v118 offset:64
    ds_read_b128 v[188:191], v116 offset:128
    ds_read_b64_tr_b16 a[24:25], v4 offset:12416
    ds_read_b64_tr_b16 a[26:27], v4 offset:13184
    buffer_load_dwordx4 v7, s[12:15], s46 offen offset:2048 lds
    ds_read_b64_tr_b16 a[28:29], v4 offset:12448
    ds_read_b64_tr_b16 a[30:31], v4 offset:13216
    ds_read_b64_tr_b16 a[32:33], v5 offset:12480
    ds_read_b64_tr_b16 a[34:35], v5 offset:13248
    s_add_u32 m0, s45, 37248
    s_nop 0
    buffer_load_dwordx4 v26, s[12:15], s46 offen offset:0 lds
    ds_read_b128 v[200:203], v117 offset:128
    ds_read_b128 v[212:215], v118 offset:128
    s_waitcnt lgkmcnt(7)
    v_xor_b32 v136, v136, v166
    v_xor_b32 v138, v138, v166
    buffer_load_dwordx4 v26, s[12:15], s46 offen offset:1024 lds
    v_lshlrev_b32_sdwa v122, 4, v136 dst_sel:DWORD dst_unused:UNUSED_PAD src0_sel:DWORD src1_sel:WORD_0
    v_lshlrev_b32_sdwa v123, 4, v138 dst_sel:DWORD dst_unused:UNUSED_PAD src0_sel:DWORD src1_sel:WORD_0
    v_lshlrev_b32_sdwa v124, 4, v136 dst_sel:DWORD dst_unused:UNUSED_PAD src0_sel:DWORD src1_sel:WORD_1
    s_add_u32 s46, s46, 18432
    v_mfma_f32_16x16x32_bf16 v[44:47], a[0:3], v[180:183], 0
    s_waitcnt lgkmcnt(2)
    s_barrier
    v_mfma_f32_16x16x32_bf16 v[48:51], a[4:7], v[180:183], 0
    ds_read_b128 v[216:219], v122 offset:0
    ds_read_b128 v[136:139], v172 offset:512
    v_mfma_f32_16x16x32_bf16 v[52:55], a[8:11], v[180:183], 0
    s_add_u32 m0, s44, 0
    ds_read_b64_tr_b16 a[36:37], v4 offset:18624
    v_mfma_f32_16x16x32_bf16 v[56:59], a[0:3], v[192:195], 0
    buffer_load_dwordx4 v7, s[12:15], s46 offen offset:0 lds
    v_mfma_f32_16x16x32_bf16 v[60:63], a[4:7], v[192:195], 0
    ds_read_b128 v[220:223], v122 offset:64
    v_mfma_f32_16x16x32_bf16 v[64:67], a[8:11], v[192:195], 0
    ds_read_b64_tr_b16 a[38:39], v4 offset:19392
    v_mfma_f32_16x16x32_bf16 v[68:71], a[0:3], v[204:207], 0
    ds_read_b64_tr_b16 a[40:41], v4 offset:18656
    ds_read_b64_tr_b16 a[42:43], v4 offset:19424
    v_mfma_f32_16x16x32_bf16 v[72:75], a[4:7], v[204:207], 0
    ds_read_b128 v[224:227], v122 offset:128
    v_mfma_f32_16x16x32_bf16 v[76:79], a[8:11], v[204:207], 0
    buffer_load_dwordx4 v7, s[12:15], s46 offen offset:1024 lds
    v_mfma_f32_16x16x32_bf16 v[52:55], a[20:23], v[184:187], v[52:55]
    ds_read_b64_tr_b16 a[44:45], v5 offset:18688
    ds_read_b64_tr_b16 a[46:47], v5 offset:19456
    v_mfma_f32_16x16x32_bf16 v[48:51], a[16:19], v[184:187], v[48:51]
    ds_read_b128 v[228:231], v123 offset:0
    v_mfma_f32_16x16x32_bf16 v[44:47], a[12:15], v[184:187], v[44:47]
    ds_read_b64_tr_b16 a[48:49], v4 offset:24832
    s_waitcnt lgkmcnt(7)
    v_xor_b32 v136, v136, v166
    v_xor_b32 v138, v138, v166
    v_mfma_f32_16x16x32_bf16 v[64:67], a[20:23], v[196:199], v[64:67]
    ds_read_b64_tr_b16 a[50:51], v4 offset:25600
    ds_read_b64_tr_b16 a[52:53], v4 offset:24864
    v_mfma_f32_16x16x32_bf16 v[60:63], a[16:19], v[196:199], v[60:63]
    ds_read_b128 v[232:235], v123 offset:64
    v_mfma_f32_16x16x32_bf16 v[56:59], a[12:15], v[196:199], v[56:59]
    buffer_load_dwordx4 v7, s[12:15], s46 offen offset:2048 lds
    v_mfma_f32_16x16x32_bf16 v[76:79], a[20:23], v[208:211], v[76:79]
    ds_read_b64_tr_b16 a[54:55], v4 offset:25632
    ds_read_b64_tr_b16 a[56:57], v5 offset:24896
    v_mfma_f32_16x16x32_bf16 v[72:75], a[16:19], v[208:211], v[72:75]
    ds_read_b128 v[236:239], v123 offset:128
    s_add_u32 m0, s45, 0
    v_mfma_f32_16x16x32_bf16 v[68:71], a[12:15], v[208:211], v[68:71]
    buffer_load_dwordx4 v26, s[12:15], s46 offen offset:0 lds
    v_mfma_f32_16x16x32_bf16 v[44:47], a[24:27], v[188:191], v[44:47]
    ds_read_b64_tr_b16 a[58:59], v5 offset:25664
    ds_read_b64_tr_b16 a[60:61], v4 offset:31040
    v_mfma_f32_16x16x32_bf16 v[48:51], a[28:31], v[188:191], v[48:51]
    ds_read_b128 v[240:243], v124 offset:0
    v_lshlrev_b32_sdwa v128, 4, v136 dst_sel:DWORD dst_unused:UNUSED_PAD src0_sel:DWORD src1_sel:WORD_0
    v_lshlrev_b32_sdwa v129, 4, v138 dst_sel:DWORD dst_unused:UNUSED_PAD src0_sel:DWORD src1_sel:WORD_0
    v_mfma_f32_16x16x32_bf16 v[52:55], a[32:35], v[188:191], v[52:55]
    ds_read_b64_tr_b16 a[62:63], v4 offset:31808
    v_mfma_f32_16x16x32_bf16 v[56:59], a[24:27], v[200:203], v[56:59]
    ds_read_b64_tr_b16 a[64:65], v4 offset:31072
    ds_read_b64_tr_b16 a[66:67], v4 offset:31840
    v_mfma_f32_16x16x32_bf16 v[60:63], a[28:31], v[200:203], v[60:63]
    ds_read_b128 v[244:247], v124 offset:64
    v_mfma_f32_16x16x32_bf16 v[64:67], a[32:35], v[200:203], v[64:67]
    buffer_load_dwordx4 v26, s[12:15], s46 offen offset:1024 lds
    s_add_u32 s46, s46, 18432
    v_mfma_f32_16x16x32_bf16 v[68:71], a[24:27], v[212:215], v[68:71]
    ds_read_b64_tr_b16 a[68:69], v5 offset:31104
    ds_read_b64_tr_b16 a[70:71], v5 offset:31872
    v_mfma_f32_16x16x32_bf16 v[72:75], a[28:31], v[212:215], v[72:75]
    ds_read_b128 v[248:251], v124 offset:128
    v_lshlrev_b32_sdwa v130, 4, v136 dst_sel:DWORD dst_unused:UNUSED_PAD src0_sel:DWORD src1_sel:WORD_1
    v_mfma_f32_16x16x32_bf16 v[76:79], a[32:35], v[212:215], v[76:79]
    s_waitcnt vmcnt(5)
    s_waitcnt lgkmcnt(1)
    s_barrier
    v_mfma_f32_16x16x32_bf16 v[44:47], a[36:39], v[216:219], v[44:47]
    ds_read_b64_tr_b16 a[72:73], v4 offset:37248
    v_mfma_f32_16x16x32_bf16 v[48:51], a[40:43], v[216:219], v[48:51]
    ds_read_b128 v[180:183], v128 offset:0
    s_add_u32 m0, s44, 18624
    ds_read_b128 v[136:139], v172 offset:768
    v_mfma_f32_16x16x32_bf16 v[52:55], a[44:47], v[216:219], v[52:55]
    buffer_load_dwordx4 v7, s[12:15], s46 offen offset:0 lds
    v_mfma_f32_16x16x32_bf16 v[52:55], a[56:59], v[220:223], v[52:55]
    ds_read_b64_tr_b16 a[74:75], v4 offset:38016
    v_mfma_f32_16x16x32_bf16 v[48:51], a[52:55], v[220:223], v[48:51]
    ds_read_b128 v[184:187], v128 offset:64
    v_mfma_f32_16x16x32_bf16 v[44:47], a[48:51], v[220:223], v[44:47]
    ds_read_b64_tr_b16 a[76:77], v4 offset:37280
    v_mfma_f32_16x16x32_bf16 v[44:47], a[60:63], v[224:227], v[44:47]
    ds_read_b64_tr_b16 a[78:79], v4 offset:38048
    ds_read_b64_tr_b16 a[80:81], v5 offset:37312
    v_mfma_f32_16x16x32_bf16 v[48:51], a[64:67], v[224:227], v[48:51]
    ds_read_b128 v[188:191], v128 offset:128
    v_mfma_f32_16x16x32_bf16 v[52:55], a[68:71], v[224:227], v[52:55]
    buffer_load_dwordx4 v7, s[12:15], s46 offen offset:1024 lds
    v_mfma_f32_16x16x32_bf16 v[56:59], a[36:39], v[228:231], v[56:59]
    ds_read_b64_tr_b16 a[82:83], v5 offset:38080
    v_mfma_f32_16x16x32_bf16 v[60:63], a[40:43], v[228:231], v[60:63]
    ds_read_b128 v[192:195], v129 offset:0
    v_mfma_f32_16x16x32_bf16 v[64:67], a[44:47], v[228:231], v[64:67]
    ds_read_b64_tr_b16 a[84:85], v4 offset:43456
    ds_read_b64_tr_b16 a[86:87], v4 offset:44224
    v_mfma_f32_16x16x32_bf16 v[64:67], a[56:59], v[232:235], v[64:67]
    buffer_load_dwordx4 v7, s[12:15], s46 offen offset:2048 lds
    v_mfma_f32_16x16x32_bf16 v[60:63], a[52:55], v[232:235], v[60:63]
    ds_read_b128 v[196:199], v129 offset:64
    ds_read_b64_tr_b16 a[88:89], v4 offset:43488
    v_mfma_f32_16x16x32_bf16 v[56:59], a[48:51], v[232:235], v[56:59]
    ds_read_b64_tr_b16 a[90:91], v4 offset:44256
    s_waitcnt lgkmcnt(7)
    v_xor_b32 v136, v136, v166
    v_xor_b32 v138, v138, v166
    v_mfma_f32_16x16x32_bf16 v[56:59], a[60:63], v[236:239], v[56:59]
    ds_read_b64_tr_b16 a[92:93], v5 offset:43520
    v_mfma_f32_16x16x32_bf16 v[60:63], a[64:67], v[236:239], v[60:63]
    ds_read_b128 v[200:203], v129 offset:128
    s_add_u32 m0, s45, 18624
    v_mfma_f32_16x16x32_bf16 v[64:67], a[68:71], v[236:239], v[64:67]
    buffer_load_dwordx4 v26, s[12:15], s46 offen offset:0 lds
    v_mfma_f32_16x16x32_bf16 v[68:71], a[36:39], v[240:243], v[68:71]
    ds_read_b64_tr_b16 a[94:95], v5 offset:44288
    ds_read_b64_tr_b16 a[96:97], v4 offset:49664
    v_mfma_f32_16x16x32_bf16 v[72:75], a[40:43], v[240:243], v[72:75]
    ds_read_b128 v[204:207], v130 offset:0
    v_lshlrev_b32_sdwa v116, 4, v136 dst_sel:DWORD dst_unused:UNUSED_PAD src0_sel:DWORD src1_sel:WORD_0
    v_lshlrev_b32_sdwa v117, 4, v138 dst_sel:DWORD dst_unused:UNUSED_PAD src0_sel:DWORD src1_sel:WORD_0
    v_mfma_f32_16x16x32_bf16 v[76:79], a[44:47], v[240:243], v[76:79]
    ds_read_b64_tr_b16 a[98:99], v4 offset:50432
    v_mfma_f32_16x16x32_bf16 v[76:79], a[56:59], v[244:247], v[76:79]
    ds_read_b64_tr_b16 a[100:101], v4 offset:49696
    ds_read_b64_tr_b16 a[102:103], v4 offset:50464
    v_mfma_f32_16x16x32_bf16 v[72:75], a[52:55], v[244:247], v[72:75]
    ds_read_b128 v[208:211], v130 offset:64
    v_mfma_f32_16x16x32_bf16 v[68:71], a[48:51], v[244:247], v[68:71]
    buffer_load_dwordx4 v26, s[12:15], s46 offen offset:1024 lds
    s_add_u32 s46, s46, 18432
    v_mfma_f32_16x16x32_bf16 v[68:71], a[60:63], v[248:251], v[68:71]
    ds_read_b64_tr_b16 a[104:105], v5 offset:49728
    ds_read_b64_tr_b16 a[106:107], v5 offset:50496
    v_mfma_f32_16x16x32_bf16 v[72:75], a[64:67], v[248:251], v[72:75]
    ds_read_b128 v[212:215], v130 offset:128
    v_lshlrev_b32_sdwa v118, 4, v136 dst_sel:DWORD dst_unused:UNUSED_PAD src0_sel:DWORD src1_sel:WORD_1
    v_mfma_f32_16x16x32_bf16 v[76:79], a[68:71], v[248:251], v[76:79]
    s_waitcnt vmcnt(5)
    s_waitcnt lgkmcnt(1)
    s_barrier
    v_mfma_f32_16x16x32_bf16 v[44:47], a[72:75], v[180:183], v[44:47]
    ds_read_b64_tr_b16 a[108:109], v4 offset:0
    v_mfma_f32_16x16x32_bf16 v[48:51], a[76:79], v[180:183], v[48:51]
    ds_read_b128 v[216:219], v116 offset:0
    s_add_u32 m0, s44, 37248
    ds_read_b128 v[136:139], v172 offset:1024
    v_mfma_f32_16x16x32_bf16 v[52:55], a[80:83], v[180:183], v[52:55]
    buffer_load_dwordx4 v7, s[12:15], s46 offen offset:0 lds
    v_mfma_f32_16x16x32_bf16 v[52:55], a[92:95], v[184:187], v[52:55]
    ds_read_b64_tr_b16 a[110:111], v4 offset:768
    v_mfma_f32_16x16x32_bf16 v[48:51], a[88:91], v[184:187], v[48:51]
    ds_read_b128 v[220:223], v116 offset:64
    v_mfma_f32_16x16x32_bf16 v[44:47], a[84:87], v[184:187], v[44:47]
    ds_read_b64_tr_b16 a[112:113], v4 offset:32
    v_mfma_f32_16x16x32_bf16 v[44:47], a[96:99], v[188:191], v[44:47]
    ds_read_b64_tr_b16 a[114:115], v4 offset:800
    ds_read_b64_tr_b16 a[116:117], v5 offset:64
    v_mfma_f32_16x16x32_bf16 v[48:51], a[100:103], v[188:191], v[48:51]
    ds_read_b128 v[224:227], v116 offset:128
    v_mfma_f32_16x16x32_bf16 v[52:55], a[104:107], v[188:191], v[52:55]
    buffer_load_dwordx4 v7, s[12:15], s46 offen offset:1024 lds
    v_mfma_f32_16x16x32_bf16 v[56:59], a[72:75], v[192:195], v[56:59]
    ds_read_b64_tr_b16 a[118:119], v5 offset:832
    v_mfma_f32_16x16x32_bf16 v[60:63], a[76:79], v[192:195], v[60:63]
    ds_read_b128 v[228:231], v117 offset:0
    v_mfma_f32_16x16x32_bf16 v[64:67], a[80:83], v[192:195], v[64:67]
    ds_read_b64_tr_b16 a[120:121], v4 offset:6208
    ds_read_b64_tr_b16 a[122:123], v4 offset:6976
    v_mfma_f32_16x16x32_bf16 v[64:67], a[92:95], v[196:199], v[64:67]
    buffer_load_dwordx4 v7, s[12:15], s46 offen offset:2048 lds
    v_mfma_f32_16x16x32_bf16 v[60:63], a[88:91], v[196:199], v[60:63]
    ds_read_b128 v[232:235], v117 offset:64
    ds_read_b64_tr_b16 a[124:125], v4 offset:6240
    v_mfma_f32_16x16x32_bf16 v[56:59], a[84:87], v[196:199], v[56:59]
    ds_read_b64_tr_b16 a[126:127], v4 offset:7008
    s_waitcnt lgkmcnt(7)
    v_xor_b32 v136, v136, v166
    v_xor_b32 v138, v138, v166
    v_mfma_f32_16x16x32_bf16 v[56:59], a[96:99], v[200:203], v[56:59]
    ds_read_b64_tr_b16 a[128:129], v5 offset:6272
    v_mfma_f32_16x16x32_bf16 v[60:63], a[100:103], v[200:203], v[60:63]
    ds_read_b128 v[236:239], v117 offset:128
    s_add_u32 m0, s45, 37248
    v_mfma_f32_16x16x32_bf16 v[64:67], a[104:107], v[200:203], v[64:67]
    buffer_load_dwordx4 v26, s[12:15], s46 offen offset:0 lds
    v_mfma_f32_16x16x32_bf16 v[68:71], a[72:75], v[204:207], v[68:71]
    ds_read_b64_tr_b16 a[130:131], v5 offset:7040
    ds_read_b64_tr_b16 a[132:133], v4 offset:12416
    v_mfma_f32_16x16x32_bf16 v[72:75], a[76:79], v[204:207], v[72:75]
    ds_read_b128 v[240:243], v118 offset:0
    v_lshlrev_b32_sdwa v122, 4, v136 dst_sel:DWORD dst_unused:UNUSED_PAD src0_sel:DWORD src1_sel:WORD_0
    v_lshlrev_b32_sdwa v123, 4, v138 dst_sel:DWORD dst_unused:UNUSED_PAD src0_sel:DWORD src1_sel:WORD_0
    v_mfma_f32_16x16x32_bf16 v[76:79], a[80:83], v[204:207], v[76:79]
    ds_read_b64_tr_b16 a[134:135], v4 offset:13184
    v_mfma_f32_16x16x32_bf16 v[76:79], a[92:95], v[208:211], v[76:79]
    ds_read_b64_tr_b16 a[136:137], v4 offset:12448
    ds_read_b64_tr_b16 a[138:139], v4 offset:13216
    v_mfma_f32_16x16x32_bf16 v[72:75], a[88:91], v[208:211], v[72:75]
    ds_read_b128 v[244:247], v118 offset:64
    v_mfma_f32_16x16x32_bf16 v[68:71], a[84:87], v[208:211], v[68:71]
    buffer_load_dwordx4 v26, s[12:15], s46 offen offset:1024 lds
    s_add_u32 s46, s46, 18432
    v_mfma_f32_16x16x32_bf16 v[68:71], a[96:99], v[212:215], v[68:71]
    ds_read_b64_tr_b16 a[140:141], v5 offset:12480
    ds_read_b64_tr_b16 a[142:143], v5 offset:13248
    v_mfma_f32_16x16x32_bf16 v[72:75], a[100:103], v[212:215], v[72:75]
    ds_read_b128 v[248:251], v118 offset:128
    v_lshlrev_b32_sdwa v124, 4, v136 dst_sel:DWORD dst_unused:UNUSED_PAD src0_sel:DWORD src1_sel:WORD_1
    v_mfma_f32_16x16x32_bf16 v[76:79], a[104:107], v[212:215], v[76:79]
    s_waitcnt vmcnt(5)
    s_waitcnt lgkmcnt(1)
    s_barrier
    v_mfma_f32_16x16x32_bf16 v[44:47], a[108:111], v[216:219], v[44:47]
    ds_read_b64_tr_b16 a[0:1], v4 offset:18624
    v_mfma_f32_16x16x32_bf16 v[48:51], a[112:115], v[216:219], v[48:51]
    ds_read_b128 v[180:183], v122 offset:0
    s_add_u32 m0, s44, 0
    ds_read_b128 v[136:139], v172 offset:1280
    v_mfma_f32_16x16x32_bf16 v[52:55], a[116:119], v[216:219], v[52:55]
    buffer_load_dwordx4 v7, s[12:15], s46 offen offset:0 lds
    v_mfma_f32_16x16x32_bf16 v[52:55], a[128:131], v[220:223], v[52:55]
    ds_read_b64_tr_b16 a[2:3], v4 offset:19392
    v_mfma_f32_16x16x32_bf16 v[48:51], a[124:127], v[220:223], v[48:51]
    ds_read_b128 v[184:187], v122 offset:64
    v_mfma_f32_16x16x32_bf16 v[44:47], a[120:123], v[220:223], v[44:47]
    ds_read_b64_tr_b16 a[4:5], v4 offset:18656
    v_mfma_f32_16x16x32_bf16 v[44:47], a[132:135], v[224:227], v[44:47]
    ds_read_b64_tr_b16 a[6:7], v4 offset:19424
    ds_read_b64_tr_b16 a[8:9], v5 offset:18688
    v_mfma_f32_16x16x32_bf16 v[48:51], a[136:139], v[224:227], v[48:51]
    ds_read_b128 v[188:191], v122 offset:128
    v_mfma_f32_16x16x32_bf16 v[52:55], a[140:143], v[224:227], v[52:55]
    buffer_load_dwordx4 v7, s[12:15], s46 offen offset:1024 lds
    v_mfma_f32_16x16x32_bf16 v[56:59], a[108:111], v[228:231], v[56:59]
    ds_read_b64_tr_b16 a[10:11], v5 offset:19456
    v_mfma_f32_16x16x32_bf16 v[60:63], a[112:115], v[228:231], v[60:63]
    ds_read_b128 v[192:195], v123 offset:0
    v_mfma_f32_16x16x32_bf16 v[64:67], a[116:119], v[228:231], v[64:67]
    ds_read_b64_tr_b16 a[12:13], v4 offset:24832
    ds_read_b64_tr_b16 a[14:15], v4 offset:25600
    v_mfma_f32_16x16x32_bf16 v[64:67], a[128:131], v[232:235], v[64:67]
    buffer_load_dwordx4 v7, s[12:15], s46 offen offset:2048 lds
    v_mfma_f32_16x16x32_bf16 v[60:63], a[124:127], v[232:235], v[60:63]
    ds_read_b128 v[196:199], v123 offset:64
    ds_read_b64_tr_b16 a[16:17], v4 offset:24864
    v_mfma_f32_16x16x32_bf16 v[56:59], a[120:123], v[232:235], v[56:59]
    ds_read_b64_tr_b16 a[18:19], v4 offset:25632
    s_waitcnt lgkmcnt(7)
    v_xor_b32 v136, v136, v166
    v_xor_b32 v138, v138, v166
    v_mfma_f32_16x16x32_bf16 v[56:59], a[132:135], v[236:239], v[56:59]
    ds_read_b64_tr_b16 a[20:21], v5 offset:24896
    v_mfma_f32_16x16x32_bf16 v[60:63], a[136:139], v[236:239], v[60:63]
    ds_read_b128 v[200:203], v123 offset:128
    s_add_u32 m0, s45, 0
    v_mfma_f32_16x16x32_bf16 v[64:67], a[140:143], v[236:239], v[64:67]
    buffer_load_dwordx4 v26, s[12:15], s46 offen offset:0 lds
    v_mfma_f32_16x16x32_bf16 v[68:71], a[108:111], v[240:243], v[68:71]
    ds_read_b64_tr_b16 a[22:23], v5 offset:25664
    ds_read_b64_tr_b16 a[24:25], v4 offset:31040
    v_mfma_f32_16x16x32_bf16 v[72:75], a[112:115], v[240:243], v[72:75]
    ds_read_b128 v[204:207], v124 offset:0
    v_lshlrev_b32_sdwa v128, 4, v136 dst_sel:DWORD dst_unused:UNUSED_PAD src0_sel:DWORD src1_sel:WORD_0
    v_lshlrev_b32_sdwa v129, 4, v138 dst_sel:DWORD dst_unused:UNUSED_PAD src0_sel:DWORD src1_sel:WORD_0
    v_mfma_f32_16x16x32_bf16 v[76:79], a[116:119], v[240:243], v[76:79]
    ds_read_b64_tr_b16 a[26:27], v4 offset:31808
    v_mfma_f32_16x16x32_bf16 v[76:79], a[128:131], v[244:247], v[76:79]
    ds_read_b64_tr_b16 a[28:29], v4 offset:31072
    ds_read_b64_tr_b16 a[30:31], v4 offset:31840
    v_mfma_f32_16x16x32_bf16 v[72:75], a[124:127], v[244:247], v[72:75]
    ds_read_b128 v[208:211], v124 offset:64
    v_mfma_f32_16x16x32_bf16 v[68:71], a[120:123], v[244:247], v[68:71]
    buffer_load_dwordx4 v26, s[12:15], s46 offen offset:1024 lds
    s_add_u32 s46, s46, 18432
    v_mfma_f32_16x16x32_bf16 v[68:71], a[132:135], v[248:251], v[68:71]
    ds_read_b64_tr_b16 a[32:33], v5 offset:31104
    ds_read_b64_tr_b16 a[34:35], v5 offset:31872
    v_mfma_f32_16x16x32_bf16 v[72:75], a[136:139], v[248:251], v[72:75]
    ds_read_b128 v[212:215], v124 offset:128
    v_lshlrev_b32_sdwa v130, 4, v136 dst_sel:DWORD dst_unused:UNUSED_PAD src0_sel:DWORD src1_sel:WORD_1
    v_mfma_f32_16x16x32_bf16 v[76:79], a[140:143], v[248:251], v[76:79]
    s_waitcnt vmcnt(5)
    s_waitcnt lgkmcnt(1)
    s_barrier
    v_mfma_f32_16x16x32_bf16 v[44:47], a[0:3], v[180:183], v[44:47]
    ds_read_b64_tr_b16 a[36:37], v4 offset:37248
    v_mfma_f32_16x16x32_bf16 v[48:51], a[4:7], v[180:183], v[48:51]
    ds_read_b128 v[216:219], v128 offset:0
    s_add_u32 m0, s44, 18624
    ds_read_b128 v[136:139], v172 offset:1536
    v_mfma_f32_16x16x32_bf16 v[52:55], a[8:11], v[180:183], v[52:55]
    buffer_load_dwordx4 v7, s[12:15], s46 offen offset:0 lds
    v_mfma_f32_16x16x32_bf16 v[52:55], a[20:23], v[184:187], v[52:55]
    ds_read_b64_tr_b16 a[38:39], v4 offset:38016
    v_mfma_f32_16x16x32_bf16 v[48:51], a[16:19], v[184:187], v[48:51]
    ds_read_b128 v[220:223], v128 offset:64
    v_mfma_f32_16x16x32_bf16 v[44:47], a[12:15], v[184:187], v[44:47]
    ds_read_b64_tr_b16 a[40:41], v4 offset:37280
    v_mfma_f32_16x16x32_bf16 v[44:47], a[24:27], v[188:191], v[44:47]
    ds_read_b64_tr_b16 a[42:43], v4 offset:38048
    ds_read_b64_tr_b16 a[44:45], v5 offset:37312
    v_mfma_f32_16x16x32_bf16 v[48:51], a[28:31], v[188:191], v[48:51]
    ds_read_b128 v[224:227], v128 offset:128
    v_mfma_f32_16x16x32_bf16 v[52:55], a[32:35], v[188:191], v[52:55]
    buffer_load_dwordx4 v7, s[12:15], s46 offen offset:1024 lds
    v_mfma_f32_16x16x32_bf16 v[56:59], a[0:3], v[192:195], v[56:59]
    ds_read_b64_tr_b16 a[46:47], v5 offset:38080
    v_mfma_f32_16x16x32_bf16 v[60:63], a[4:7], v[192:195], v[60:63]
    ds_read_b128 v[228:231], v129 offset:0
    v_mfma_f32_16x16x32_bf16 v[64:67], a[8:11], v[192:195], v[64:67]
    ds_read_b64_tr_b16 a[48:49], v4 offset:43456
    ds_read_b64_tr_b16 a[50:51], v4 offset:44224
    v_mfma_f32_16x16x32_bf16 v[64:67], a[20:23], v[196:199], v[64:67]
    buffer_load_dwordx4 v7, s[12:15], s46 offen offset:2048 lds
    v_mfma_f32_16x16x32_bf16 v[60:63], a[16:19], v[196:199], v[60:63]
    ds_read_b128 v[232:235], v129 offset:64
    ds_read_b64_tr_b16 a[52:53], v4 offset:43488
    v_mfma_f32_16x16x32_bf16 v[56:59], a[12:15], v[196:199], v[56:59]
    ds_read_b64_tr_b16 a[54:55], v4 offset:44256
    s_waitcnt lgkmcnt(7)
    v_xor_b32 v136, v136, v166
    v_xor_b32 v138, v138, v166
    v_mfma_f32_16x16x32_bf16 v[56:59], a[24:27], v[200:203], v[56:59]
    ds_read_b64_tr_b16 a[56:57], v5 offset:43520
    v_mfma_f32_16x16x32_bf16 v[60:63], a[28:31], v[200:203], v[60:63]
    ds_read_b128 v[236:239], v129 offset:128
    s_add_u32 m0, s45, 18624
    v_mfma_f32_16x16x32_bf16 v[64:67], a[32:35], v[200:203], v[64:67]
    buffer_load_dwordx4 v26, s[12:15], s46 offen offset:0 lds
    v_mfma_f32_16x16x32_bf16 v[68:71], a[0:3], v[204:207], v[68:71]
    ds_read_b64_tr_b16 a[58:59], v5 offset:44288
    ds_read_b64_tr_b16 a[60:61], v4 offset:49664
    v_mfma_f32_16x16x32_bf16 v[72:75], a[4:7], v[204:207], v[72:75]
    ds_read_b128 v[240:243], v130 offset:0
    v_lshlrev_b32_sdwa v116, 4, v136 dst_sel:DWORD dst_unused:UNUSED_PAD src0_sel:DWORD src1_sel:WORD_0
    v_lshlrev_b32_sdwa v117, 4, v138 dst_sel:DWORD dst_unused:UNUSED_PAD src0_sel:DWORD src1_sel:WORD_0
    v_mfma_f32_16x16x32_bf16 v[76:79], a[8:11], v[204:207], v[76:79]
    ds_read_b64_tr_b16 a[62:63], v4 offset:50432
    v_mfma_f32_16x16x32_bf16 v[76:79], a[20:23], v[208:211], v[76:79]
    ds_read_b64_tr_b16 a[64:65], v4 offset:49696
    ds_read_b64_tr_b16 a[66:67], v4 offset:50464
    v_mfma_f32_16x16x32_bf16 v[72:75], a[16:19], v[208:211], v[72:75]
    ds_read_b128 v[244:247], v130 offset:64
    v_mfma_f32_16x16x32_bf16 v[68:71], a[12:15], v[208:211], v[68:71]
    buffer_load_dwordx4 v26, s[12:15], s46 offen offset:1024 lds
    s_add_u32 s46, s46, 18432
    v_mfma_f32_16x16x32_bf16 v[68:71], a[24:27], v[212:215], v[68:71]
    ds_read_b64_tr_b16 a[68:69], v5 offset:49728
    ds_read_b64_tr_b16 a[70:71], v5 offset:50496
    v_mfma_f32_16x16x32_bf16 v[72:75], a[28:31], v[212:215], v[72:75]
    ds_read_b128 v[248:251], v130 offset:128
    v_lshlrev_b32_sdwa v118, 4, v136 dst_sel:DWORD dst_unused:UNUSED_PAD src0_sel:DWORD src1_sel:WORD_1
    v_mfma_f32_16x16x32_bf16 v[76:79], a[32:35], v[212:215], v[76:79]
    s_waitcnt vmcnt(5)
    s_waitcnt lgkmcnt(1)
    s_barrier
    v_mfma_f32_16x16x32_bf16 v[44:47], a[36:39], v[216:219], v[44:47]
    ds_read_b64_tr_b16 a[72:73], v4 offset:0
    v_mfma_f32_16x16x32_bf16 v[48:51], a[40:43], v[216:219], v[48:51]
    ds_read_b128 v[180:183], v116 offset:0
    s_add_u32 m0, s44, 37248
    ds_read_b128 v[136:139], v172 offset:1792
    v_mfma_f32_16x16x32_bf16 v[52:55], a[44:47], v[216:219], v[52:55]
    buffer_load_dwordx4 v7, s[12:15], s46 offen offset:0 lds
    v_mfma_f32_16x16x32_bf16 v[52:55], a[56:59], v[220:223], v[52:55]
    ds_read_b64_tr_b16 a[74:75], v4 offset:768
    v_mfma_f32_16x16x32_bf16 v[48:51], a[52:55], v[220:223], v[48:51]
    ds_read_b128 v[184:187], v116 offset:64
    v_mfma_f32_16x16x32_bf16 v[44:47], a[48:51], v[220:223], v[44:47]
    ds_read_b64_tr_b16 a[76:77], v4 offset:32
    v_mfma_f32_16x16x32_bf16 v[44:47], a[60:63], v[224:227], v[44:47]
    ds_read_b64_tr_b16 a[78:79], v4 offset:800
    ds_read_b64_tr_b16 a[80:81], v5 offset:64
    v_mfma_f32_16x16x32_bf16 v[48:51], a[64:67], v[224:227], v[48:51]
    ds_read_b128 v[188:191], v116 offset:128
    v_mfma_f32_16x16x32_bf16 v[52:55], a[68:71], v[224:227], v[52:55]
    buffer_load_dwordx4 v7, s[12:15], s46 offen offset:1024 lds
    v_mfma_f32_16x16x32_bf16 v[56:59], a[36:39], v[228:231], v[56:59]
    ds_read_b64_tr_b16 a[82:83], v5 offset:832
    v_mfma_f32_16x16x32_bf16 v[60:63], a[40:43], v[228:231], v[60:63]
    ds_read_b128 v[192:195], v117 offset:0
    v_mfma_f32_16x16x32_bf16 v[64:67], a[44:47], v[228:231], v[64:67]
    ds_read_b64_tr_b16 a[84:85], v4 offset:6208
    ds_read_b64_tr_b16 a[86:87], v4 offset:6976
    v_mfma_f32_16x16x32_bf16 v[64:67], a[56:59], v[232:235], v[64:67]
    buffer_load_dwordx4 v7, s[12:15], s46 offen offset:2048 lds
    v_mfma_f32_16x16x32_bf16 v[60:63], a[52:55], v[232:235], v[60:63]
    ds_read_b128 v[196:199], v117 offset:64
    ds_read_b64_tr_b16 a[88:89], v4 offset:6240
    v_mfma_f32_16x16x32_bf16 v[56:59], a[48:51], v[232:235], v[56:59]
    ds_read_b64_tr_b16 a[90:91], v4 offset:7008
    s_waitcnt lgkmcnt(7)
    v_xor_b32 v136, v136, v166
    v_xor_b32 v138, v138, v166
    v_mfma_f32_16x16x32_bf16 v[56:59], a[60:63], v[236:239], v[56:59]
    ds_read_b64_tr_b16 a[92:93], v5 offset:6272
    v_mfma_f32_16x16x32_bf16 v[60:63], a[64:67], v[236:239], v[60:63]
    ds_read_b128 v[200:203], v117 offset:128
    s_add_u32 m0, s45, 37248
    v_mfma_f32_16x16x32_bf16 v[64:67], a[68:71], v[236:239], v[64:67]
    buffer_load_dwordx4 v26, s[12:15], s46 offen offset:0 lds
    v_mfma_f32_16x16x32_bf16 v[68:71], a[36:39], v[240:243], v[68:71]
    ds_read_b64_tr_b16 a[94:95], v5 offset:7040
    ds_read_b64_tr_b16 a[96:97], v4 offset:12416
    v_mfma_f32_16x16x32_bf16 v[72:75], a[40:43], v[240:243], v[72:75]
    ds_read_b128 v[204:207], v118 offset:0
    v_lshlrev_b32_sdwa v122, 4, v136 dst_sel:DWORD dst_unused:UNUSED_PAD src0_sel:DWORD src1_sel:WORD_0
    v_lshlrev_b32_sdwa v123, 4, v138 dst_sel:DWORD dst_unused:UNUSED_PAD src0_sel:DWORD src1_sel:WORD_0
    v_mfma_f32_16x16x32_bf16 v[76:79], a[44:47], v[240:243], v[76:79]
    ds_read_b64_tr_b16 a[98:99], v4 offset:13184
    v_mfma_f32_16x16x32_bf16 v[76:79], a[56:59], v[244:247], v[76:79]
    ds_read_b64_tr_b16 a[100:101], v4 offset:12448
    ds_read_b64_tr_b16 a[102:103], v4 offset:13216
    v_mfma_f32_16x16x32_bf16 v[72:75], a[52:55], v[244:247], v[72:75]
    ds_read_b128 v[208:211], v118 offset:64
    v_mfma_f32_16x16x32_bf16 v[68:71], a[48:51], v[244:247], v[68:71]
    buffer_load_dwordx4 v26, s[12:15], s46 offen offset:1024 lds
    s_add_u32 s46, s46, 18432
    v_mfma_f32_16x16x32_bf16 v[68:71], a[60:63], v[248:251], v[68:71]
    ds_read_b64_tr_b16 a[104:105], v5 offset:12480
    ds_read_b64_tr_b16 a[106:107], v5 offset:13248
    v_mfma_f32_16x16x32_bf16 v[72:75], a[64:67], v[248:251], v[72:75]
    ds_read_b128 v[212:215], v118 offset:128
    v_lshlrev_b32_sdwa v124, 4, v136 dst_sel:DWORD dst_unused:UNUSED_PAD src0_sel:DWORD src1_sel:WORD_1
    v_mfma_f32_16x16x32_bf16 v[76:79], a[68:71], v[248:251], v[76:79]
    s_waitcnt vmcnt(5)
    s_waitcnt lgkmcnt(1)
    s_barrier
    v_mfma_f32_16x16x32_bf16 v[44:47], a[72:75], v[180:183], v[44:47]
    ds_read_b64_tr_b16 a[108:109], v4 offset:18624
    v_mfma_f32_16x16x32_bf16 v[48:51], a[76:79], v[180:183], v[48:51]
    ds_read_b128 v[216:219], v122 offset:0
    ds_read_b128 v[136:139], v172 offset:2048
    v_mfma_f32_16x16x32_bf16 v[52:55], a[80:83], v[180:183], v[52:55]
    ds_read_b64_tr_b16 a[110:111], v4 offset:19392
    v_mfma_f32_16x16x32_bf16 v[52:55], a[92:95], v[184:187], v[52:55]
    ds_read_b64_tr_b16 a[112:113], v4 offset:18656
    v_mfma_f32_16x16x32_bf16 v[48:51], a[88:91], v[184:187], v[48:51]
    ds_read_b128 v[220:223], v122 offset:64
    v_mfma_f32_16x16x32_bf16 v[44:47], a[84:87], v[184:187], v[44:47]
    ds_read_b64_tr_b16 a[114:115], v4 offset:19424
    v_mfma_f32_16x16x32_bf16 v[44:47], a[96:99], v[188:191], v[44:47]
    ds_read_b64_tr_b16 a[116:117], v5 offset:18688
    v_mfma_f32_16x16x32_bf16 v[48:51], a[100:103], v[188:191], v[48:51]
    ds_read_b128 v[224:227], v122 offset:128
    v_mfma_f32_16x16x32_bf16 v[52:55], a[104:107], v[188:191], v[52:55]
    ds_read_b64_tr_b16 a[118:119], v5 offset:19456
    v_mfma_f32_16x16x32_bf16 v[56:59], a[72:75], v[192:195], v[56:59]
    ds_read_b64_tr_b16 a[120:121], v4 offset:24832
    v_mfma_f32_16x16x32_bf16 v[60:63], a[76:79], v[192:195], v[60:63]
    ds_read_b128 v[228:231], v123 offset:0
    v_mfma_f32_16x16x32_bf16 v[64:67], a[80:83], v[192:195], v[64:67]
    ds_read_b64_tr_b16 a[122:123], v4 offset:25600
    s_waitcnt lgkmcnt(7)
    v_xor_b32 v136, v136, v166
    v_xor_b32 v138, v138, v166
    v_mfma_f32_16x16x32_bf16 v[64:67], a[92:95], v[196:199], v[64:67]
    ds_read_b64_tr_b16 a[124:125], v4 offset:24864
    v_mfma_f32_16x16x32_bf16 v[60:63], a[88:91], v[196:199], v[60:63]
    ds_read_b128 v[232:235], v123 offset:64
    v_mfma_f32_16x16x32_bf16 v[56:59], a[84:87], v[196:199], v[56:59]
    ds_read_b64_tr_b16 a[126:127], v4 offset:25632
    v_mfma_f32_16x16x32_bf16 v[56:59], a[96:99], v[200:203], v[56:59]
    ds_read_b64_tr_b16 a[128:129], v5 offset:24896
    v_mfma_f32_16x16x32_bf16 v[60:63], a[100:103], v[200:203], v[60:63]
    ds_read_b128 v[236:239], v123 offset:128
    v_mfma_f32_16x16x32_bf16 v[64:67], a[104:107], v[200:203], v[64:67]
    ds_read_b64_tr_b16 a[130:131], v5 offset:25664
    v_lshlrev_b32_sdwa v128, 4, v136 dst_sel:DWORD dst_unused:UNUSED_PAD src0_sel:DWORD src1_sel:WORD_0
    v_lshlrev_b32_sdwa v129, 4, v138 dst_sel:DWORD dst_unused:UNUSED_PAD src0_sel:DWORD src1_sel:WORD_0
    v_mfma_f32_16x16x32_bf16 v[68:71], a[72:75], v[204:207], v[68:71]
    ds_read_b64_tr_b16 a[132:133], v4 offset:31040
    v_mfma_f32_16x16x32_bf16 v[72:75], a[76:79], v[204:207], v[72:75]
    ds_read_b128 v[240:243], v124 offset:0
    v_mfma_f32_16x16x32_bf16 v[76:79], a[80:83], v[204:207], v[76:79]
    ds_read_b64_tr_b16 a[134:135], v4 offset:31808
    v_mfma_f32_16x16x32_bf16 v[76:79], a[92:95], v[208:211], v[76:79]
    ds_read_b64_tr_b16 a[136:137], v4 offset:31072
    v_mfma_f32_16x16x32_bf16 v[72:75], a[88:91], v[208:211], v[72:75]
    ds_read_b128 v[244:247], v124 offset:64
    v_mfma_f32_16x16x32_bf16 v[68:71], a[84:87], v[208:211], v[68:71]
    ds_read_b64_tr_b16 a[138:139], v4 offset:31840
    v_lshlrev_b32_sdwa v130, 4, v136 dst_sel:DWORD dst_unused:UNUSED_PAD src0_sel:DWORD src1_sel:WORD_1
    v_mfma_f32_16x16x32_bf16 v[68:71], a[96:99], v[212:215], v[68:71]
    ds_read_b64_tr_b16 a[140:141], v5 offset:31104
    ds_read_b64_tr_b16 a[142:143], v5 offset:31872
    v_mfma_f32_16x16x32_bf16 v[72:75], a[100:103], v[212:215], v[72:75]
    ds_read_b128 v[248:251], v124 offset:128
    v_mfma_f32_16x16x32_bf16 v[76:79], a[104:107], v[212:215], v[76:79]
    s_waitcnt vmcnt(0)
    s_waitcnt lgkmcnt(1)
    s_barrier
    v_mfma_f32_16x16x32_bf16 v[44:47], a[108:111], v[216:219], v[44:47]
    ds_read_b64_tr_b16 a[0:1], v4 offset:37248
    s_lshl_b32 s55, s55, 1
    v_mfma_f32_16x16x32_bf16 v[48:51], a[112:115], v[216:219], v[48:51]
    ds_read_b128 v[180:183], v128 offset:0
    s_mul_i32 s47, s30, 6656
    v_mfma_f32_16x16x32_bf16 v[52:55], a[116:119], v[216:219], v[52:55]
    ds_read_b64_tr_b16 a[2:3], v4 offset:38016
    v_lshrrev_b32 v38, 4, v6
    v_mfma_f32_16x16x32_bf16 v[52:55], a[128:131], v[220:223], v[52:55]
    ds_read_b64_tr_b16 a[4:5], v4 offset:37280
    s_add_u32 s47, s47, 107616
    v_mfma_f32_16x16x32_bf16 v[48:51], a[124:127], v[220:223], v[48:51]
    ds_read_b128 v[184:187], v128 offset:64
    v_mul_u32_u24 v39, 43, v38
    v_mfma_f32_16x16x32_bf16 v[44:47], a[120:123], v[220:223], v[44:47]
    ds_read_b64_tr_b16 a[6:7], v4 offset:38048
    v_add_u32 v40, 128, v38
    v_mfma_f32_16x16x32_bf16 v[44:47], a[132:135], v[224:227], v[44:47]
    ds_read_b64_tr_b16 a[8:9], v5 offset:37312
    s_lshl_b32 s48, s29, 3
    v_mfma_f32_16x16x32_bf16 v[48:51], a[136:139], v[224:227], v[48:51]
    ds_read_b128 v[188:191], v128 offset:128
    v_lshrrev_b32 v39, 9, v39
    v_mfma_f32_16x16x32_bf16 v[52:55], a[140:143], v[224:227], v[52:55]
    ds_read_b64_tr_b16 a[10:11], v5 offset:38080
    v_mul_u32_u24 v41, 2731, v40
    v_mfma_f32_16x16x32_bf16 v[56:59], a[108:111], v[228:231], v[56:59]
    ds_read_b64_tr_b16 a[12:13], v4 offset:43456
    v_mad_i32_i24 v38, v39, -12, v38
    v_mfma_f32_16x16x32_bf16 v[60:63], a[112:115], v[228:231], v[60:63]
    ds_read_b128 v[192:195], v129 offset:0
    v_lshrrev_b32 v41, 16, v41
    v_mfma_f32_16x16x32_bf16 v[64:67], a[116:119], v[228:231], v[64:67]
    ds_read_b64_tr_b16 a[14:15], v4 offset:44224
    v_add_u32 v39, s48, v39
    v_mfma_f32_16x16x32_bf16 v[64:67], a[128:131], v[232:235], v[64:67]
    ds_read_b64_tr_b16 a[16:17], v4 offset:43488
    v_mul_u32_u24 v42, 24, v41
    v_mfma_f32_16x16x32_bf16 v[60:63], a[124:127], v[232:235], v[60:63]
    ds_read_b128 v[196:199], v129 offset:64
    v_mul_u32_u24 v18, 208, v39
    v_mfma_f32_16x16x32_bf16 v[56:59], a[120:123], v[232:235], v[56:59]
    ds_read_b64_tr_b16 a[18:19], v4 offset:44256
    v_sub_u32 v40, v40, v42
    v_mfma_f32_16x16x32_bf16 v[56:59], a[132:135], v[236:239], v[56:59]
    ds_read_b64_tr_b16 a[20:21], v5 offset:43520
    v_add_u32 v41, s48, v41
    v_mfma_f32_16x16x32_bf16 v[60:63], a[136:139], v[236:239], v[60:63]
    ds_read_b128 v[200:203], v129 offset:128
    v_mul_u32_u24 v20, s2, v39
    v_mfma_f32_16x16x32_bf16 v[64:67], a[140:143], v[236:239], v[64:67]
    ds_read_b64_tr_b16 a[22:23], v5 offset:44288
    v_lshlrev_b32 v38, 4, v38
    v_mfma_f32_16x16x32_bf16 v[68:71], a[108:111], v[240:243], v[68:71]
    ds_read_b64_tr_b16 a[24:25], v4 offset:49664
    v_mul_u32_u24 v19, 208, v41
    v_mfma_f32_16x16x32_bf16 v[72:75], a[112:115], v[240:243], v[72:75]
    ds_read_b128 v[204:207], v130 offset:0
    v_mul_u32_u24 v21, s2, v41
    v_mfma_f32_16x16x32_bf16 v[76:79], a[116:119], v[240:243], v[76:79]
    ds_read_b64_tr_b16 a[26:27], v4 offset:50432
    v_lshlrev_b32 v40, 3, v40
    v_mfma_f32_16x16x32_bf16 v[76:79], a[128:131], v[244:247], v[76:79]
    ds_read_b64_tr_b16 a[28:29], v4 offset:49696
    v_add3_u32 v18, v18, s47, v38
    v_mfma_f32_16x16x32_bf16 v[72:75], a[124:127], v[244:247], v[72:75]
    ds_read_b128 v[208:211], v130 offset:64
    v_add_u32 v20, v20, v38
    v_mfma_f32_16x16x32_bf16 v[68:71], a[120:123], v[244:247], v[68:71]
    ds_read_b64_tr_b16 a[30:31], v4 offset:50464
    v_add3_u32 v19, v19, s47, v40
    s_waitcnt lgkmcnt(7)
    v_mfma_f32_16x16x32_bf16 v[68:71], a[132:135], v[248:251], v[68:71]
    ds_read_b64_tr_b16 a[32:33], v5 offset:49728
    ds_read_b64_tr_b16 a[34:35], v5 offset:50496
    v_mfma_f32_16x16x32_bf16 v[72:75], a[136:139], v[248:251], v[72:75]
    ds_read_b128 v[212:215], v130 offset:128
    v_mfma_f32_16x16x32_bf16 v[76:79], a[140:143], v[248:251], v[76:79]
    v_add_u32 v21, v21, v40
    v_bfe_u32 v38, v6, 4, 2
    v_mfma_f32_16x16x32_bf16 v[44:47], a[0:3], v[180:183], v[44:47]
    v_bfe_u32 v39, v6, 6, 2
    v_lshl_add_u32 v38, v38, 2, v39
    v_mfma_f32_16x16x32_bf16 v[48:51], a[4:7], v[180:183], v[48:51]
    v_lshrrev_b32 v39, 8, v6
    v_mfma_f32_16x16x32_bf16 v[52:55], a[8:11], v[180:183], v[52:55]
    v_mul_u32_u24 v38, 208, v38
    s_waitcnt lgkmcnt(7)
    v_mfma_f32_16x16x32_bf16 v[52:55], a[20:23], v[184:187], v[52:55]
    s_lshl4_add_u32 s49, s48, s47
    v_mfma_f32_16x16x32_bf16 v[48:51], a[16:19], v[184:187], v[48:51]
    v_lshl_add_u32 v38, v39, 3, v38
    v_mfma_f32_16x16x32_bf16 v[44:47], a[12:15], v[184:187], v[44:47]
    s_lshl2_add_u32 s48, s48, s47
    s_waitcnt lgkmcnt(6)
    v_mfma_f32_16x16x32_bf16 v[44:47], a[24:27], v[188:191], v[44:47]
    v_add_u32 v16, s49, v38
    s_waitcnt lgkmcnt(3)
    v_mfma_f32_16x16x32_bf16 v[48:51], a[28:31], v[188:191], v[48:51]
    v_add_u32 v17, s48, v38
    s_waitcnt lgkmcnt(1)
    v_mfma_f32_16x16x32_bf16 v[52:55], a[32:35], v[188:191], v[52:55]
    v_mfma_f32_16x16x32_bf16 v[56:59], a[0:3], v[192:195], v[56:59]
    v_mfma_f32_16x16x32_bf16 v[60:63], a[4:7], v[192:195], v[60:63]
    v_mfma_f32_16x16x32_bf16 v[64:67], a[8:11], v[192:195], v[64:67]
    v_mfma_f32_16x16x32_bf16 v[64:67], a[20:23], v[196:199], v[64:67]
    v_cvt_pk_bf16_f32 v32, v44, v45
    v_cvt_pk_bf16_f32 v33, v46, v47
    v_mfma_f32_16x16x32_bf16 v[60:63], a[16:19], v[196:199], v[60:63]
    v_cvt_pk_bf16_f32 v34, v48, v49
    v_cvt_pk_bf16_f32 v35, v50, v51
    v_mfma_f32_16x16x32_bf16 v[56:59], a[12:15], v[196:199], v[56:59]
    v_cvt_pk_bf16_f32 v36, v52, v53
    v_cvt_pk_bf16_f32 v37, v54, v55
    v_mfma_f32_16x16x32_bf16 v[56:59], a[24:27], v[200:203], v[56:59]
    ds_write_b64 v16, v[32:33] offset:0
    v_mfma_f32_16x16x32_bf16 v[60:63], a[28:31], v[200:203], v[60:63]
    ds_write_b64 v16, v[34:35] offset:32
    v_mfma_f32_16x16x32_bf16 v[64:67], a[32:35], v[200:203], v[64:67]
    ds_write_b64 v17, v[36:37] offset:64
    v_mfma_f32_16x16x32_bf16 v[68:71], a[0:3], v[204:207], v[68:71]
    v_mfma_f32_16x16x32_bf16 v[72:75], a[4:7], v[204:207], v[72:75]
    s_waitcnt lgkmcnt(0)
    s_barrier
    ds_read_b128 v[38:41], v18 offset:0
    v_mfma_f32_16x16x32_bf16 v[76:79], a[8:11], v[204:207], v[76:79]
    ds_read_b64 v[42:43], v19 offset:0
    v_mfma_f32_16x16x32_bf16 v[76:79], a[20:23], v[208:211], v[76:79]
    v_cvt_pk_bf16_f32 v32, v56, v57
    v_cvt_pk_bf16_f32 v33, v58, v59
    v_mfma_f32_16x16x32_bf16 v[72:75], a[16:19], v[208:211], v[72:75]
    v_cvt_pk_bf16_f32 v34, v60, v61
    v_cvt_pk_bf16_f32 v35, v62, v63
    v_mfma_f32_16x16x32_bf16 v[68:71], a[12:15], v[208:211], v[68:71]
    v_cvt_pk_bf16_f32 v36, v64, v65
    v_cvt_pk_bf16_f32 v37, v66, v67
    v_mfma_f32_16x16x32_bf16 v[68:71], a[24:27], v[212:215], v[68:71]
    ds_write_b64 v16, v[32:33] offset:3328
    v_mfma_f32_16x16x32_bf16 v[72:75], a[28:31], v[212:215], v[72:75]
    ds_write_b64 v16, v[34:35] offset:3360
    v_mfma_f32_16x16x32_bf16 v[76:79], a[32:35], v[212:215], v[76:79]
    ds_write_b64 v17, v[36:37] offset:3392
    s_waitcnt lgkmcnt(4)
    buffer_store_dwordx4 v[38:41], v20, s[16:19], s31 offen sc1
    s_waitcnt lgkmcnt(3)
    buffer_store_dwordx2 v[42:43], v21, s[16:19], s31 offen sc1
    s_add_u32 s31, s31, s55
    s_waitcnt lgkmcnt(0)
    s_barrier
    ds_read_b128 v[24:27], v18 offset:3328
    ds_read_b64 v[28:29], v19 offset:3328
    v_cvt_pk_bf16_f32 v32, v68, v69
    v_cvt_pk_bf16_f32 v33, v70, v71
    v_cvt_pk_bf16_f32 v34, v72, v73
    v_cvt_pk_bf16_f32 v35, v74, v75
    ds_write_b64 v16, v[32:33] offset:0
    s_waitcnt lgkmcnt(2)
    buffer_store_dwordx4 v[24:27], v20, s[16:19], s31 offen sc1
    s_waitcnt lgkmcnt(1)
    buffer_store_dwordx2 v[28:29], v21, s[16:19], s31 offen sc1
    s_add_u32 s31, s31, s55
    s_cmp_lg_u32 s54, 0
    v_cvt_pk_bf16_f32 v36, v76, v77
    v_cvt_pk_bf16_f32 v37, v78, v79
    ds_write_b64 v16, v[34:35] offset:32
    ds_write_b64 v17, v[36:37] offset:64
    s_waitcnt lgkmcnt(0)
    s_barrier
    ds_read_b128 v[38:41], v18 offset:0
    ds_read_b64 v[42:43], v19 offset:0
    s_waitcnt lgkmcnt(1)
    buffer_store_dwordx4 v[38:41], v20, s[16:19], s31 offen sc1
    s_waitcnt lgkmcnt(0)
    buffer_store_dwordx2 v[42:43], v21, s[16:19], s31 offen sc1
    s_cbranch_scc1 L_gS
    s_endpgm
L_cold:
L_gW:
    s_waitcnt vmcnt(0) lgkmcnt(0)
    v_mbcnt_lo_u32_b32 v16, -1, 0
    v_mbcnt_hi_u32_b32 v16, -1, v16
    v_lshlrev_b32 v6, 4, v16
    v_lshrrev_b32 v17, 4, v16
    v_and_b32 v16, 15, v16
    v_and_b32 v4, 1, v17
    v_mul_u32_u24 v4, 3104, v4
    v_lshrrev_b32 v5, 1, v17
    v_lshlrev_b32 v5, 3, v5
    v_lshrrev_b32 v12, 2, v16
    v_add_u32 v5, v5, v12
    v_mul_u32_u24 v5, 192, v5
    v_and_b32 v12, 3, v16
    v_lshl_add_u32 v4, v12, 3, v4
    v_add_u32 v4, v4, v5
    s_mul_i32 s44, s28, 18624
    s_lshl_b32 s48, s29, 5
    s_add_u32 s48, s48, s44
    v_add_u32 v5, s48, v4
    s_lshl_b32 s48, s29, 7
    s_add_u32 s48, s48, s44
    v_add_u32 v4, s48, v4
    s_mov_b32 s46, 0
    s_call_b64 s[52:53], L_gD
    ds_read_b64_tr_b16 a[0:1], v4 offset:0
    ds_read_b64_tr_b16 a[2:3], v4 offset:768
    ds_read_b64_tr_b16 a[4:5], v4 offset:32
    ds_read_b64_tr_b16 a[6:7], v4 offset:800
    ds_read_b64_tr_b16 a[8:9], v5 offset:64
    ds_read_b64_tr_b16 a[10:11], v5 offset:832
    ds_read_b64_tr_b16 a[12:13], v4 offset:6208
    ds_read_b64_tr_b16 a[14:15], v4 offset:6976
    ds_read_b64_tr_b16 a[16:17], v4 offset:6240
    ds_read_b64_tr_b16 a[18:19], v4 offset:7008
    ds_read_b64_tr_b16 a[20:21], v5 offset:6272
    ds_read_b64_tr_b16 a[22:23], v5 offset:7040
    ds_read_b64_tr_b16 a[24:25], v4 offset:12416
    ds_read_b64_tr_b16 a[26:27], v4 offset:13184
    ds_read_b64_tr_b16 a[28:29], v4 offset:12448
    ds_read_b64_tr_b16 a[30:31], v4 offset:13216
    ds_read_b64_tr_b16 a[32:33], v5 offset:12480
    ds_read_b64_tr_b16 a[34:35], v5 offset:13248
    s_call_b64 s[52:53], L_gD
    ds_read_b64_tr_b16 a[36:37], v4 offset:0
    ds_read_b64_tr_b16 a[38:39], v4 offset:768
    ds_read_b64_tr_b16 a[40:41], v4 offset:32
    ds_read_b64_tr_b16 a[42:43], v4 offset:800
    ds_read_b64_tr_b16 a[44:45], v5 offset:64
    ds_read_b64_tr_b16 a[46:47], v5 offset:832
    ds_read_b64_tr_b16 a[48:49], v4 offset:6208
    ds_read_b64_tr_b16 a[50:51], v4 offset:6976
    ds_read_b64_tr_b16 a[52:53], v4 offset:6240
    ds_read_b64_tr_b16 a[54:55], v4 offset:7008
    ds_read_b64_tr_b16 a[56:57], v5 offset:6272
    ds_read_b64_tr_b16 a[58:59], v5 offset:7040
    ds_read_b64_tr_b16 a[60:61], v4 offset:12416
    ds_read_b64_tr_b16 a[62:63], v4 offset:13184
    ds_read_b64_tr_b16 a[64:65], v4 offset:12448
    ds_read_b64_tr_b16 a[66:67], v4 offset:13216
    ds_read_b64_tr_b16 a[68:69], v5 offset:12480
    ds_read_b64_tr_b16 a[70:71], v5 offset:13248
    s_call_b64 s[52:53], L_gD
    ds_read_b64_tr_b16 a[72:73], v4 offset:0
    ds_read_b64_tr_b16 a[74:75], v4 offset:768
    ds_read_b64_tr_b16 a[76:77], v4 offset:32
    ds_read_b64_tr_b16 a[78:79], v4 offset:800
    ds_read_b64_tr_b16 a[80:81], v5 offset:64
    ds_read_b64_tr_b16 a[82:83], v5 offset:832
    ds_read_b64_tr_b16 a[84:85], v4 offset:6208
    ds_read_b64_tr_b16 a[86:87], v4 offset:6976
    ds_read_b64_tr_b16 a[88:89], v4 offset:6240
    ds_read_b64_tr_b16 a[90:91], v4 offset:7008
    ds_read_b64_tr_b16 a[92:93], v5 offset:6272
    ds_read_b64_tr_b16 a[94:95], v5 offset:7040
    ds_read_b64_tr_b16 a[96:97], v4 offset:12416
    ds_read_b64_tr_b16 a[98:99], v4 offset:13184
    ds_read_b64_tr_b16 a[100:101], v4 offset:12448
    ds_read_b64_tr_b16 a[102:103], v4 offset:13216
    ds_read_b64_tr_b16 a[104:105], v5 offset:12480
    ds_read_b64_tr_b16 a[106:107], v5 offset:13248
    s_call_b64 s[52:53], L_gD
    ds_read_b64_tr_b16 a[108:109], v4 offset:0
    ds_read_b64_tr_b16 a[110:111], v4 offset:768
    ds_read_b64_tr_b16 a[112:113], v4 offset:32
    ds_read_b64_tr_b16 a[114:115], v4 offset:800
    ds_read_b64_tr_b16 a[116:117], v5 offset:64
    ds_read_b64_tr_b16 a[118:119], v5 offset:832
    ds_read_b64_tr_b16 a[120:121], v4 offset:6208
    ds_read_b64_tr_b16 a[122:123], v4 offset:6976
    ds_read_b64_tr_b16 a[124:125], v4 offset:6240
    ds_read_b64_tr_b16 a[126:127], v4 offset:7008
    ds_read_b64_tr_b16 a[128:129], v5 offset:6272
    ds_read_b64_tr_b16 a[130:131], v5 offset:7040
    ds_read_b64_tr_b16 a[132:133], v4 offset:12416
    ds_read_b64_tr_b16 a[134:135], v4 offset:13184
    ds_read_b64_tr_b16 a[136:137], v4 offset:12448
    ds_read_b64_tr_b16 a[138:139], v4 offset:13216
    ds_read_b64_tr_b16 a[140:141], v5 offset:12480
    ds_read_b64_tr_b16 a[142:143], v5 offset:13248
    s_call_b64 s[52:53], L_gD
    ds_read_b64_tr_b16 a[144:145], v4 offset:0
    ds_read_b64_tr_b16 a[146:147], v4 offset:768
    ds_read_b64_tr_b16 a[148:149], v4 offset:32
    ds_read_b64_tr_b16 a[150:151], v4 offset:800
    ds_read_b64_tr_b16 a[152:153], v5 offset:64
    ds_read_b64_tr_b16 a[154:155], v5 offset:832
    ds_read_b64_tr_b16 a[156:157], v4 offset:6208
    ds_read_b64_tr_b16 a[158:159], v4 offset:6976
    ds_read_b64_tr_b16 a[160:161], v4 offset:6240
    ds_read_b64_tr_b16 a[162:163], v4 offset:7008
    ds_read_b64_tr_b16 a[164:165], v5 offset:6272
    ds_read_b64_tr_b16 a[166:167], v5 offset:7040
    ds_read_b64_tr_b16 a[168:169], v4 offset:12416
    ds_read_b64_tr_b16 a[170:171], v4 offset:13184
    ds_read_b64_tr_b16 a[172:173], v4 offset:12448
    ds_read_b64_tr_b16 a[174:175], v4 offset:13216
    ds_read_b64_tr_b16 a[176:177], v5 offset:12480
    ds_read_b64_tr_b16 a[178:179], v5 offset:13248
    s_call_b64 s[52:53], L_gD
    ds_read_b64_tr_b16 a[180:181], v4 offset:0
    ds_read_b64_tr_b16 a[182:183], v4 offset:768
    ds_read_b64_tr_b16 a[184:185], v4 offset:32
    ds_read_b64_tr_b16 a[186:187], v4 offset:800
    ds_read_b64_tr_b16 a[188:189], v5 offset:64
    ds_read_b64_tr_b16 a[190:191], v5 offset:832
    ds_read_b64_tr_b16 a[192:193], v4 offset:6208
    ds_read_b64_tr_b16 a[194:195], v4 offset:6976
    ds_read_b64_tr_b16 a[196:197], v4 offset:6240
    ds_read_b64_tr_b16 a[198:199], v4 offset:7008
    ds_read_b64_tr_b16 a[200:201], v5 offset:6272
    ds_read_b64_tr_b16 a[202:203], v5 offset:7040
    ds_read_b64_tr_b16 a[204:205], v4 offset:12416
    ds_read_b64_tr_b16 a[206:207], v4 offset:13184
    ds_read_b64_tr_b16 a[208:209], v4 offset:12448
    ds_read_b64_tr_b16 a[210:211], v4 offset:13216
    ds_read_b64_tr_b16 a[212:213], v5 offset:12480
    ds_read_b64_tr_b16 a[214:215], v5 offset:13248
    s_call_b64 s[52:53], L_gD
    ds_read_b64_tr_b16 a[216:217], v4 offset:0
    ds_read_b64_tr_b16 a[218:219], v4 offset:768
    ds_read_b64_tr_b16 a[220:221], v4 offset:32
    ds_read_b64_tr_b16 a[222:223], v4 offset:800
    ds_read_b64_tr_b16 a[224:225], v5 offset:64
    ds_read_b64_tr_b16 a[226:227], v5 offset:832
    ds_read_b64_tr_b16 a[228:229], v4 offset:6208
    ds_read_b64_tr_b16 a[230:231], v4 offset:6976
    ds_read_b64_tr_b16 a[232:233], v4 offset:6240
    ds_read_b64_tr_b16 a[234:235], v4 offset:7008
    ds_read_b64_tr_b16 a[236:237], v5 offset:6272
    ds_read_b64_tr_b16 a[238:239], v5 offset:7040
    ds_read_b64_tr_b16 a[240:241], v4 offset:12416
    ds_read_b64_tr_b16 a[242:243], v4 offset:13184
    ds_read_b64_tr_b16 a[244:245], v4 offset:12448
    ds_read_b64_tr_b16 a[246:247], v4 offset:13216
    ds_read_b64_tr_b16 a[248:249], v5 offset:12480
    ds_read_b64_tr_b16 a[250:251], v5 offset:13248
    s_call_b64 s[52:53], L_gD
    ds_read_b64_tr_b16 a[252:253], v4 offset:0
    ds_read_b64_tr_b16 a[254:255], v4 offset:768
    ds_read_b64_tr_b16 v[188:189], v4 offset:32
    ds_read_b64_tr_b16 v[190:191], v4 offset:800
    ds_read_b64_tr_b16 v[192:193], v5 offset:64
    ds_read_b64_tr_b16 v[194:195], v5 offset:832
    ds_read_b64_tr_b16 v[196:197], v4 offset:6208
    ds_read_b64_tr_b16 v[198:199], v4 offset:6976
    ds_read_b64_tr_b16 v[200:201], v4 offset:6240
    ds_read_b64_tr_b16 v[202:203], v4 offset:7008
    ds_read_b64_tr_b16 v[204:205], v5 offset:6272
    ds_read_b64_tr_b16 v[206:207], v5 offset:7040
    ds_read_b64_tr_b16 v[208:209], v4 offset:12416
    ds_read_b64_tr_b16 v[210:211], v4 offset:13184
    ds_read_b64_tr_b16 v[212:213], v4 offset:12448
    ds_read_b64_tr_b16 v[214:215], v4 offset:13216
    ds_read_b64_tr_b16 v[216:217], v5 offset:12480
    ds_read_b64_tr_b16 v[218:219], v5 offset:13248
    s_call_b64 s[52:53], L_gD
    ds_read_b64_tr_b16 v[220:221], v4 offset:0
    ds_read_b64_tr_b16 v[222:223], v4 offset:768
    ds_read_b64_tr_b16 v[224:225], v4 offset:32
    ds_read_b64_tr_b16 v[226:227], v4 offset:800
    ds_read_b64_tr_b16 v[228:229], v5 offset:64
    ds_read_b64_tr_b16 v[230:231], v5 offset:832
    ds_read_b64_tr_b16 v[232:233], v4 offset:6208
    ds_read_b64_tr_b16 v[234:235], v4 offset:6976
    ds_read_b64_tr_b16 v[236:237], v4 offset:6240
    ds_read_b64_tr_b16 v[238:239], v4 offset:7008
    ds_read_b64_tr_b16 v[240:241], v5 offset:6272
    ds_read_b64_tr_b16 v[242:243], v5 offset:7040
    ds_read_b64_tr_b16 v[244:245], v4 offset:12416
    ds_read_b64_tr_b16 v[246:247], v4 offset:13184
    ds_read_b64_tr_b16 v[248:249], v4 offset:12448
    ds_read_b64_tr_b16 v[250:251], v4 offset:13216
    ds_read_b64_tr_b16 v[252:253], v5 offset:12480
    ds_read_b64_tr_b16 v[254:255], v5 offset:13248
    s_branch L_g0
L_gD:
    s_waitcnt lgkmcnt(0)
    s_add_u32 m0, s44, 0
    s_nop 0
    buffer_load_dwordx4 v6, s[12:15], s46 offen offset:0 lds
    buffer_load_dwordx4 v6, s[12:15], s46 offen offset:1024 lds
    buffer_load_dwordx4 v6, s[12:15], s46 offen offset:2048 lds
    s_add_u32 s46, s46, 3072
    s_add_u32 m0, s44, 3104
    s_nop 0
    buffer_load_dwordx4 v6, s[12:15], s46 offen offset:0 lds
    buffer_load_dwordx4 v6, s[12:15], s46 offen offset:1024 lds
    buffer_load_dwordx4 v6, s[12:15], s46 offen offset:2048 lds
    s_add_u32 s46, s46, 3072
    s_add_u32 m0, s44, 6208
    s_nop 0
    buffer_load_dwordx4 v6, s[12:15], s46 offen offset:0 lds
    buffer_load_dwordx4 v6, s[12:15], s46 offen offset:1024 lds
    buffer_load_dwordx4 v6, s[12:15], s46 offen offset:2048 lds
    s_add_u32 s46, s46, 3072
    s_add_u32 m0, s44, 9312
    s_nop 0
    buffer_load_dwordx4 v6, s[12:15], s46 offen offset:0 lds
    buffer_load_dwordx4 v6, s[12:15], s46 offen offset:1024 lds
    buffer_load_dwordx4 v6, s[12:15], s46 offen offset:2048 lds
    s_add_u32 s46, s46, 3072
    s_add_u32 m0, s44, 12416
    s_nop 0
    buffer_load_dwordx4 v6, s[12:15], s46 offen offset:0 lds
    buffer_load_dwordx4 v6, s[12:15], s46 offen offset:1024 lds
    buffer_load_dwordx4 v6, s[12:15], s46 offen offset:2048 lds
    s_add_u32 s46, s46, 3072
    s_add_u32 m0, s44, 15520
    s_nop 0
    buffer_load_dwordx4 v6, s[12:15], s46 offen offset:0 lds
    buffer_load_dwordx4 v6, s[12:15], s46 offen offset:1024 lds
    buffer_load_dwordx4 v6, s[12:15], s46 offen offset:2048 lds
    s_add_u32 s46, s46, 3072
    s_waitcnt vmcnt(0)
    s_setpc_b64 s[52:53]
L_gN:
    s_waitcnt vmcnt(0)
    s_barrier
    s_movk_i32 s54, 0x7f
L_g0:
    v_mbcnt_lo_u32_b32 v16, -1, 0
    v_mbcnt_hi_u32_b32 v16, -1, v16
    v_lshlrev_b32 v6, 4, v16
    v_lshrrev_b32 v17, 4, v16
    v_and_b32 v16, 15, v16
    s_bfe_u32 s56, s23, 0x10010
    s_and_b32 s59, s23, 0xff
    s_bfe_u32 s58, s23, 0x80008
    s_and_b32 s47, s22, 15
    s_bfe_u32 s57, s22, 0x40004
    s_bfe_u32 s64, s23, 0x10011
    s_cselect_b32 s48, 1, s47
    s_cselect_b32 s65, 2.0, 1.0
    s_cmp_eq_u32 s30, 0
    s_cselect_b32 s57, s47, s57
    s_cselect_b32 s47, 0, s48
    s_cselect_b32 s31, s26, s27
    s_add_u32 s58, s58, s47
    v_add_u32 v32, s59, v16
    v_mov_b32 v33, s58
    v_cvt_f32_u32 v32, v32
    v_cvt_f32_u32 v33, v33
    s_cmp_eq_u32 s56, 0
    s_cselect_b32 s60, 224, 1
    s_cselect_b32 s61, 1, 224
    s_cselect_b32 s62, s65, 0
    s_cselect_b32 s63, 0, s65
    s_cselect_b64 vcc, -1, 0
    s_lshl_b32 s60, s60, s64
    v_cndmask_b32 v19, v32, v33, vcc
    v_cndmask_b32 v20, v33, v32, vcc
    v_mul_u32_u24 v32, s61, v16
    v_mul_u32_u24 v21, 36, v32
    v_mul_u32_u24 v32, 192, v32
    v_and_b32 v18, 1, v17
    v_lshrrev_b32 v33, 1, v17
    v_lshl_add_u32 v18, v18, 1, v33
    v_lshlrev_b32 v22, 4, v18
    s_lshl_b32 s48, s29, 7
    v_add3_u32 v9, v32, s48, v22
    s_lshl_b32 s48, s29, 5
    s_add_u32 s48, s48, 64
    v_lshlrev_b32 v33, 3, v17
    v_add3_u32 v10, v32, s48, v33
    s_mul_i32 s32, s31, 3
    s_lshr_b32 s32, s32, 4
    s_mov_b32 s65, 0x435f435f
    s_bfm_b32 s47, s57, 0
    s_bitset1_b32 s47, 31
    s_and_b32 s54, s54, s47
L_gt:
    s_and_b32 s47, s54, 0xff
    s_cbranch_scc0 L_end
    s_bitcmp1_b32 s54, 0
    s_cbranch_scc0 L_gn
    buffer_load_dwordx4 v[24:27], v21, s[8:11], s32 offen offset:4
    buffer_load_dwordx4 v[28:31], v21, s[8:11], s32 offen offset:20
    buffer_load_dword v23, v21, s[8:11], s32 offen
    s_lshr_b32 s66, s54, 31
    s_mov_b32 s67, 0
    s_mov_b32 s64, 0
    s_waitcnt vmcnt(0) lgkmcnt(0)
    v_add_f32 v34, -1.0, v19
    v_add_f32 v35, -1.0, v20
    v_lshlrev_b32 v32, 16, v23
    v_and_b32 v33, 0xffff0000, v23
    v_add_f32 v32, v32, v34
    v_add_f32 v33, v33, v35
    v_cvt_pk_bf16_f32 v34, v34, v35
    v_cvt_pk_bf16_f32 v23, v32, v33
    v_cmp_ne_u32 vcc, v34, v23
    v_pk_max_i16 v23, v23, 0
    v_pk_min_i16 v23, v23, s65
    s_or_b64 s[66:67], s[66:67], vcc
    v_add_f32 v34, -1.0, v19
    v_add_f32 v35, 0.0, v20
    v_lshlrev_b32 v32, 16, v24
    v_and_b32 v33, 0xffff0000, v24
    v_add_f32 v32, v32, v34
    v_add_f32 v33, v33, v35
    v_cvt_pk_bf16_f32 v34, v34, v35
    v_cvt_pk_bf16_f32 v24, v32, v33
    v_cmp_ne_u32 vcc, v34, v24
    v_pk_max_i16 v24, v24, 0
    v_pk_min_i16 v24, v24, s65
    s_or_b64 s[66:67], s[66:67], vcc
    v_add_f32 v34, -1.0, v19
    v_add_f32 v35, 1.0, v20
    v_lshlrev_b32 v32, 16, v25
    v_and_b32 v33, 0xffff0000, v25
    v_add_f32 v32, v32, v34
    v_add_f32 v33, v33, v35
    v_cvt_pk_bf16_f32 v34, v34, v35
    v_cvt_pk_bf16_f32 v25, v32, v33
    v_cmp_ne_u32 vcc, v34, v25
    v_pk_max_i16 v25, v25, 0
    v_pk_min_i16 v25, v25, s65
    s_or_b64 s[66:67], s[66:67], vcc
    v_add_f32 v34, 0.0, v19
    v_add_f32 v35, -1.0, v20
    v_lshlrev_b32 v32, 16, v26
    v_and_b32 v33, 0xffff0000, v26
    v_add_f32 v32, v32, v34
    v_add_f32 v33, v33, v35
    v_cvt_pk_bf16_f32 v34, v34, v35
    v_cvt_pk_bf16_f32 v26, v32, v33
    v_cmp_ne_u32 vcc, v34, v26
    v_pk_max_i16 v26, v26, 0
    v_pk_min_i16 v26, v26, s65
    s_or_b64 s[66:67], s[66:67], vcc
    v_add_f32 v34, 0.0, v19
    v_add_f32 v35, 0.0, v20
    v_lshlrev_b32 v32, 16, v27
    v_and_b32 v33, 0xffff0000, v27
    v_add_f32 v32, v32, v34
    v_add_f32 v33, v33, v35
    v_cvt_pk_bf16_f32 v34, v34, v35
    v_cvt_pk_bf16_f32 v27, v32, v33
    v_cmp_ne_u32 vcc, v34, v27
    v_pk_max_i16 v27, v27, 0
    v_pk_min_i16 v27, v27, s65
    s_or_b64 s[66:67], s[66:67], vcc
    v_add_f32 v34, 0.0, v19
    v_add_f32 v35, 1.0, v20
    v_lshlrev_b32 v32, 16, v28
    v_and_b32 v33, 0xffff0000, v28
    v_add_f32 v32, v32, v34
    v_add_f32 v33, v33, v35
    v_cvt_pk_bf16_f32 v34, v34, v35
    v_cvt_pk_bf16_f32 v28, v32, v33
    v_cmp_ne_u32 vcc, v34, v28
    v_pk_max_i16 v28, v28, 0
    v_pk_min_i16 v28, v28, s65
    s_or_b64 s[66:67], s[66:67], vcc
    v_add_f32 v34, 1.0, v19
    v_add_f32 v35, -1.0, v20
    v_lshlrev_b32 v32, 16, v29
    v_and_b32 v33, 0xffff0000, v29
    v_add_f32 v32, v32, v34
    v_add_f32 v33, v33, v35
    v_cvt_pk_bf16_f32 v34, v34, v35
    v_cvt_pk_bf16_f32 v29, v32, v33
    v_cmp_ne_u32 vcc, v34, v29
    v_pk_max_i16 v29, v29, 0
    v_pk_min_i16 v29, v29, s65
    s_or_b64 s[66:67], s[66:67], vcc
    v_add_f32 v34, 1.0, v19
    v_add_f32 v35, 0.0, v20
    v_lshlrev_b32 v32, 16, v30
    v_and_b32 v33, 0xffff0000, v30
    v_add_f32 v32, v32, v34
    v_add_f32 v33, v33, v35
    v_cvt_pk_bf16_f32 v34, v34, v35
    v_cvt_pk_bf16_f32 v30, v32, v33
    v_cmp_ne_u32 vcc, v34, v30
    v_pk_max_i16 v30, v30, 0
    v_pk_min_i16 v30, v30, s65
    s_or_b64 s[66:67], s[66:67], vcc
    v_add_f32 v34, 1.0, v19
    v_add_f32 v35, 1.0, v20
    v_lshlrev_b32 v32, 16, v31
    v_and_b32 v33, 0xffff0000, v31
    v_add_f32 v32, v32, v34
    v_add_f32 v33, v33, v35
    v_cvt_pk_bf16_f32 v34, v34, v35
    v_cvt_pk_bf16_f32 v31, v32, v33
    v_cmp_ne_u32 vcc, v34, v31
    v_pk_max_i16 v31, v31, 0
    v_pk_min_i16 v31, v31, s65
    s_or_b64 s[66:67], s[66:67], vcc
    s_cbranch_scc0 L_gn
    s_movk_i32 s49, 224
    v_lshlrev_b32 v32, 16, v31
    v_and_b32 v33, 0xffff0000, v31
    v_fract_f32 v36, v32
    v_fract_f32 v37, v33
    v_cvt_u32_f32 v32, v32
    v_cvt_u32_f32 v33, v33
    v_mad_u32_u24 v40, v32, s49, v33
    v_mul_u32_u24 v40, 192, v40
    v_add_u32 v40, v40, v22
    v_or_b32 v36, v36, v37
    v_cmp_ne_u32 vcc, 0, v36
    buffer_load_dwordx4 v[176:179], v40, s[4:7], 0 offen offset:0
    buffer_load_dwordx4 v[180:183], v40, s[4:7], 0 offen offset:64
    buffer_load_dwordx4 v[184:187], v40, s[4:7], 0 offen offset:128
    s_cmp_lg_u64 vcc, 0
    s_addc_u32 s64, s64, s64
    v_lshlrev_b32 v32, 16, v30
    v_and_b32 v33, 0xffff0000, v30
    v_fract_f32 v36, v32
    v_fract_f32 v37, v33
    v_cvt_u32_f32 v32, v32
    v_cvt_u32_f32 v33, v33
    v_mad_u32_u24 v40, v32, s49, v33
    v_mul_u32_u24 v40, 192, v40
    v_add_u32 v40, v40, v22
    v_or_b32 v36, v36, v37
    v_cmp_ne_u32 vcc, 0, v36
    buffer_load_dwordx4 v[164:167], v40, s[4:7], 0 offen offset:0
    buffer_load_dwordx4 v[168:171], v40, s[4:7], 0 offen offset:64
    buffer_load_dwordx4 v[172:175], v40, s[4:7], 0 offen offset:128
    s_cmp_lg_u64 vcc, 0
    s_addc_u32 s64, s64, s64
    v_lshlrev_b32 v32, 16, v29
    v_and_b32 v33, 0xffff0000, v29
    v_fract_f32 v36, v32
    v_fract_f32 v37, v33
    v_cvt_u32_f32 v32, v32
    v_cvt_u32_f32 v33, v33
    v_mad_u32_u24 v40, v32, s49, v33
    v_mul_u32_u24 v40, 192, v40
    v_add_u32 v40, v40, v22
    v_or_b32 v36, v36, v37
    v_cmp_ne_u32 vcc, 0, v36
    buffer_load_dwordx4 v[152:155], v40, s[4:7], 0 offen offset:0
    buffer_load_dwordx4 v[156:159], v40, s[4:7], 0 offen offset:64
    buffer_load_dwordx4 v[160:163], v40, s[4:7], 0 offen offset:128
    s_cmp_lg_u64 vcc, 0
    s_addc_u32 s64, s64, s64
    v_lshlrev_b32 v32, 16, v28
    v_and_b32 v33, 0xffff0000, v28
    v_fract_f32 v36, v32
    v_fract_f32 v37, v33
    v_cvt_u32_f32 v32, v32
    v_cvt_u32_f32 v33, v33
    v_mad_u32_u24 v40, v32, s49, v33
    v_mul_u32_u24 v40, 192, v40
    v_add_u32 v40, v40, v22
    v_or_b32 v36, v36, v37
    v_cmp_ne_u32 vcc, 0, v36
    buffer_load_dwordx4 v[140:143], v40, s[4:7], 0 offen offset:0
    buffer_load_dwordx4 v[144:147], v40, s[4:7], 0 offen offset:64
    buffer_load_dwordx4 v[148:151], v40, s[4:7], 0 offen offset:128
    s_cmp_lg_u64 vcc, 0
    s_addc_u32 s64, s64, s64
    v_lshlrev_b32 v32, 16, v27
    v_and_b32 v33, 0xffff0000, v27
    v_fract_f32 v36, v32
    v_fract_f32 v37, v33
    v_cvt_u32_f32 v32, v32
    v_cvt_u32_f32 v33, v33
    v_mad_u32_u24 v40, v32, s49, v33
    v_mul_u32_u24 v40, 192, v40
    v_add_u32 v40, v40, v22
    v_or_b32 v36, v36, v37
    v_cmp_ne_u32 vcc, 0, v36
    buffer_load_dwordx4 v[128:131], v40, s[4:7], 0 offen offset:0
    buffer_load_dwordx4 v[132:135], v40, s[4:7], 0 offen offset:64
    buffer_load_dwordx4 v[136:139], v40, s[4:7], 0 offen offset:128
    s_cmp_lg_u64 vcc, 0
    s_addc_u32 s64, s64, s64
    v_lshlrev_b32 v32, 16, v26
    v_and_b32 v33, 0xffff0000, v26
    v_fract_f32 v36, v32
    v_fract_f32 v37, v33
    v_cvt_u32_f32 v32, v32
    v_cvt_u32_f32 v33, v33
    v_mad_u32_u24 v40, v32, s49, v33
    v_mul_u32_u24 v40, 192, v40
    v_add_u32 v40, v40, v22
    v_or_b32 v36, v36, v37
    v_cmp_ne_u32 vcc, 0, v36
    buffer_load_dwordx4 v[116:119], v40, s[4:7], 0 offen offset:0
    buffer_load_dwordx4 v[120:123], v40, s[4:7], 0 offen offset:64
    buffer_load_dwordx4 v[124:127], v40, s[4:7], 0 offen offset:128
    s_cmp_lg_u64 vcc, 0
    s_addc_u32 s64, s64, s64
    v_lshlrev_b32 v32, 16, v25
    v_and_b32 v33, 0xffff0000, v25
    v_fract_f32 v36, v32
    v_fract_f32 v37, v33
    v_cvt_u32_f32 v32, v32
    v_cvt_u32_f32 v33, v33
    v_mad_u32_u24 v40, v32, s49, v33
    v_mul_u32_u24 v40, 192, v40
    v_add_u32 v40, v40, v22
    v_or_b32 v36, v36, v37
    v_cmp_ne_u32 vcc, 0, v36
    buffer_load_dwordx4 v[104:107], v40, s[4:7], 0 offen offset:0
    buffer_load_dwordx4 v[108:111], v40, s[4:7], 0 offen offset:64
    buffer_load_dwordx4 v[112:115], v40, s[4:7], 0 offen offset:128
    s_cmp_lg_u64 vcc, 0
    s_addc_u32 s64, s64, s64
    v_lshlrev_b32 v32, 16, v24
    v_and_b32 v33, 0xffff0000, v24
    v_fract_f32 v36, v32
    v_fract_f32 v37, v33
    v_cvt_u32_f32 v32, v32
    v_cvt_u32_f32 v33, v33
    v_mad_u32_u24 v40, v32, s49, v33
    v_mul_u32_u24 v40, 192, v40
    v_add_u32 v40, v40, v22
    v_or_b32 v36, v36, v37
    v_cmp_ne_u32 vcc, 0, v36
    buffer_load_dwordx4 v[92:95], v40, s[4:7], 0 offen offset:0
    buffer_load_dwordx4 v[96:99], v40, s[4:7], 0 offen offset:64
    buffer_load_dwordx4 v[100:103], v40, s[4:7], 0 offen offset:128
    s_cmp_lg_u64 vcc, 0
    s_addc_u32 s64, s64, s64
    v_lshlrev_b32 v32, 16, v23
    v_and_b32 v33, 0xffff0000, v23
    v_fract_f32 v36, v32
    v_fract_f32 v37, v33
    v_cvt_u32_f32 v32, v32
    v_cvt_u32_f32 v33, v33
    v_mad_u32_u24 v40, v32, s49, v33
    v_mul_u32_u24 v40, 192, v40
    v_add_u32 v40, v40, v22
    v_or_b32 v36, v36, v37
    v_cmp_ne_u32 vcc, 0, v36
    buffer_load_dwordx4 v[80:83], v40, s[4:7], 0 offen offset:0
    buffer_load_dwordx4 v[84:87], v40, s[4:7], 0 offen offset:64
    buffer_load_dwordx4 v[88:91], v40, s[4:7], 0 offen offset:128
    s_cmp_lg_u64 vcc, 0
    s_addc_u32 s64, s64, s64
    s_bitcmp1_b32 s64, 0
    s_cbranch_scc0 L_gs0
    v_mov_b32 v43, v23
    s_call_b64 s[52:53], L_gI
    v_cvt_pk_bf16_f32 v80, v44, v45
    v_cvt_pk_bf16_f32 v81, v46, v47
    v_cvt_pk_bf16_f32 v82, v48, v49
    v_cvt_pk_bf16_f32 v83, v50, v51
    v_cvt_pk_bf16_f32 v84, v52, v53
    v_cvt_pk_bf16_f32 v85, v54, v55
    v_cvt_pk_bf16_f32 v86, v56, v57
    v_cvt_pk_bf16_f32 v87, v58, v59
    v_cvt_pk_bf16_f32 v88, v60, v61
    v_cvt_pk_bf16_f32 v89, v62, v63
    v_cvt_pk_bf16_f32 v90, v64, v65
    v_cvt_pk_bf16_f32 v91, v66, v67
L_gs0:
    s_bitcmp1_b32 s64, 1
    s_cbranch_scc0 L_gs1
    v_mov_b32 v43, v24
    s_call_b64 s[52:53], L_gI
    v_cvt_pk_bf16_f32 v92, v44, v45
    v_cvt_pk_bf16_f32 v93, v46, v47
    v_cvt_pk_bf16_f32 v94, v48, v49
    v_cvt_pk_bf16_f32 v95, v50, v51
    v_cvt_pk_bf16_f32 v96, v52, v53
    v_cvt_pk_bf16_f32 v97, v54, v55
    v_cvt_pk_bf16_f32 v98, v56, v57
    v_cvt_pk_bf16_f32 v99, v58, v59
    v_cvt_pk_bf16_f32 v100, v60, v61
    v_cvt_pk_bf16_f32 v101, v62, v63
    v_cvt_pk_bf16_f32 v102, v64, v65
    v_cvt_pk_bf16_f32 v103, v66, v67
L_gs1:
    s_bitcmp1_b32 s64, 2
    s_cbranch_scc0 L_gs2
    v_mov_b32 v43, v25
    s_call_b64 s[52:53], L_gI
    v_cvt_pk_bf16_f32 v104, v44, v45
    v_cvt_pk_bf16_f32 v105, v46, v47
    v_cvt_pk_bf16_f32 v106, v48, v49
    v_cvt_pk_bf16_f32 v107, v50, v51
    v_cvt_pk_bf16_f32 v108, v52, v53
    v_cvt_pk_bf16_f32 v109, v54, v55
    v_cvt_pk_bf16_f32 v110, v56, v57
    v_cvt_pk_bf16_f32 v111, v58, v59
    v_cvt_pk_bf16_f32 v112, v60, v61
    v_cvt_pk_bf16_f32 v113, v62, v63
    v_cvt_pk_bf16_f32 v114, v64, v65
    v_cvt_pk_bf16_f32 v115, v66, v67
L_gs2:
    s_bitcmp1_b32 s64, 3
    s_cbranch_scc0 L_gs3
    v_mov_b32 v43, v26
    s_call_b64 s[52:53], L_gI
    v_cvt_pk_bf16_f32 v116, v44, v45
    v_cvt_pk_bf16_f32 v117, v46, v47
    v_cvt_pk_bf16_f32 v118, v48, v49
    v_cvt_pk_bf16_f32 v119, v50, v51
    v_cvt_pk_bf16_f32 v120, v52, v53
    v_cvt_pk_bf16_f32 v121, v54, v55
    v_cvt_pk_bf16_f32 v122, v56, v57
    v_cvt_pk_bf16_f32 v123, v58, v59
    v_cvt_pk_bf16_f32 v124, v60, v61
    v_cvt_pk_bf16_f32 v125, v62, v63
    v_cvt_pk_bf16_f32 v126, v64, v65
    v_cvt_pk_bf16_f32 v127, v66, v67
L_gs3:
    s_bitcmp1_b32 s64, 4
    s_cbranch_scc0 L_gs4
    v_mov_b32 v43, v27
    s_call_b64 s[52:53], L_gI
    v_cvt_pk_bf16_f32 v128, v44, v45
    v_cvt_pk_bf16_f32 v129, v46, v47
    v_cvt_pk_bf16_f32 v130, v48, v49
    v_cvt_pk_bf16_f32 v131, v50, v51
    v_cvt_pk_bf16_f32 v132, v52, v53
    v_cvt_pk_bf16_f32 v133, v54, v55
    v_cvt_pk_bf16_f32 v134, v56, v57
    v_cvt_pk_bf16_f32 v135, v58, v59
    v_cvt_pk_bf16_f32 v136, v60, v61
    v_cvt_pk_bf16_f32 v137, v62, v63
    v_cvt_pk_bf16_f32 v138, v64, v65
    v_cvt_pk_bf16_f32 v139, v66, v67
L_gs4:
    s_bitcmp1_b32 s64, 5
    s_cbranch_scc0 L_gs5
    v_mov_b32 v43, v28
    s_call_b64 s[52:53], L_gI
    v_cvt_pk_bf16_f32 v140, v44, v45
    v_cvt_pk_bf16_f32 v141, v46, v47
    v_cvt_pk_bf16_f32 v142, v48, v49
    v_cvt_pk_bf16_f32 v143, v50, v51
    v_cvt_pk_bf16_f32 v144, v52, v53
    v_cvt_pk_bf16_f32 v145, v54, v55
    v_cvt_pk_bf16_f32 v146, v56, v57
    v_cvt_pk_bf16_f32 v147, v58, v59
    v_cvt_pk_bf16_f32 v148, v60, v61
    v_cvt_pk_bf16_f32 v149, v62, v63
    v_cvt_pk_bf16_f32 v150, v64, v65
    v_cvt_pk_bf16_f32 v151, v66, v67
L_gs5:
    s_bitcmp1_b32 s64, 6
    s_cbranch_scc0 L_gs6
    v_mov_b32 v43, v29
    s_call_b64 s[52:53], L_gI
    v_cvt_pk_bf16_f32 v152, v44, v45
    v_cvt_pk_bf16_f32 v153, v46, v47
    v_cvt_pk_bf16_f32 v154, v48, v49
    v_cvt_pk_bf16_f32 v155, v50, v51
    v_cvt_pk_bf16_f32 v156, v52, v53
    v_cvt_pk_bf16_f32 v157, v54, v55
    v_cvt_pk_bf16_f32 v158, v56, v57
    v_cvt_pk_bf16_f32 v159, v58, v59
    v_cvt_pk_bf16_f32 v160, v60, v61
    v_cvt_pk_bf16_f32 v161, v62, v63
    v_cvt_pk_bf16_f32 v162, v64, v65
    v_cvt_pk_bf16_f32 v163, v66, v67
L_gs6:
    s_bitcmp1_b32 s64, 7
    s_cbranch_scc0 L_gs7
    v_mov_b32 v43, v30
    s_call_b64 s[52:53], L_gI
    v_cvt_pk_bf16_f32 v164, v44, v45
    v_cvt_pk_bf16_f32 v165, v46, v47
    v_cvt_pk_bf16_f32 v166, v48, v49
    v_cvt_pk_bf16_f32 v167, v50, v51
    v_cvt_pk_bf16_f32 v168, v52, v53
    v_cvt_pk_bf16_f32 v169, v54, v55
    v_cvt_pk_bf16_f32 v170, v56, v57
    v_cvt_pk_bf16_f32 v171, v58, v59
    v_cvt_pk_bf16_f32 v172, v60, v61
    v_cvt_pk_bf16_f32 v173, v62, v63
    v_cvt_pk_bf16_f32 v174, v64, v65
    v_cvt_pk_bf16_f32 v175, v66, v67
L_gs7:
    s_bitcmp1_b32 s64, 8
    s_cbranch_scc0 L_gs8
    v_mov_b32 v43, v31
    s_call_b64 s[52:53], L_gI
    v_cvt_pk_bf16_f32 v176, v44, v45
    v_cvt_pk_bf16_f32 v177, v46, v47
    v_cvt_pk_bf16_f32 v178, v48, v49
    v_cvt_pk_bf16_f32 v179, v50, v51
    v_cvt_pk_bf16_f32 v180, v52, v53
    v_cvt_pk_bf16_f32 v181, v54, v55
    v_cvt_pk_bf16_f32 v182, v56, v57
    v_cvt_pk_bf16_f32 v183, v58, v59
    v_cvt_pk_bf16_f32 v184, v60, v61
    v_cvt_pk_bf16_f32 v185, v62, v63
    v_cvt_pk_bf16_f32 v186, v64, v65
    v_cvt_pk_bf16_f32 v187, v66, v67
L_gs8:
    s_waitcnt vmcnt(0)
    v_mfma_f32_16x16x32_bf16 v[44:47], a[0:3], v[80:83], 0
    v_mfma_f32_16x16x32_bf16 v[48:51], a[4:7], v[80:83], 0
    v_mfma_f32_16x16x32_bf16 v[52:55], a[8:11], v[80:83], 0
    v_mfma_f32_16x16x32_bf16 v[52:55], a[20:23], v[84:87], v[52:55]
    v_mfma_f32_16x16x32_bf16 v[48:51], a[16:19], v[84:87], v[48:51]
    v_mfma_f32_16x16x32_bf16 v[44:47], a[12:15], v[84:87], v[44:47]
    v_mfma_f32_16x16x32_bf16 v[44:47], a[24:27], v[88:91], v[44:47]
    v_mfma_f32_16x16x32_bf16 v[48:51], a[28:31], v[88:91], v[48:51]
    v_mfma_f32_16x16x32_bf16 v[52:55], a[32:35], v[88:91], v[52:55]
    v_mfma_f32_16x16x32_bf16 v[44:47], a[36:39], v[92:95], v[44:47]
    v_mfma_f32_16x16x32_bf16 v[48:51], a[40:43], v[92:95], v[48:51]
    v_mfma_f32_16x16x32_bf16 v[52:55], a[44:47], v[92:95], v[52:55]
    v_mfma_f32_16x16x32_bf16 v[52:55], a[56:59], v[96:99], v[52:55]
    v_mfma_f32_16x16x32_bf16 v[48:51], a[52:55], v[96:99], v[48:51]
    v_mfma_f32_16x16x32_bf16 v[44:47], a[48:51], v[96:99], v[44:47]
    v_mfma_f32_16x16x32_bf16 v[44:47], a[60:63], v[100:103], v[44:47]
    v_mfma_f32_16x16x32_bf16 v[48:51], a[64:67], v[100:103], v[48:51]
    v_mfma_f32_16x16x32_bf16 v[52:55], a[68:71], v[100:103], v[52:55]
    v_mfma_f32_16x16x32_bf16 v[44:47], a[72:75], v[104:107], v[44:47]
    v_mfma_f32_16x16x32_bf16 v[48:51], a[76:79], v[104:107], v[48:51]
    v_mfma_f32_16x16x32_bf16 v[52:55], a[80:83], v[104:107], v[52:55]
    v_mfma_f32_16x16x32_bf16 v[52:55], a[92:95], v[108:111], v[52:55]
    v_mfma_f32_16x16x32_bf16 v[48:51], a[88:91], v[108:111], v[48:51]
    v_mfma_f32_16x16x32_bf16 v[44:47], a[84:87], v[108:111], v[44:47]
    v_mfma_f32_16x16x32_bf16 v[44:47], a[96:99], v[112:115], v[44:47]
    v_mfma_f32_16x16x32_bf16 v[48:51], a[100:103], v[112:115], v[48:51]
    v_mfma_f32_16x16x32_bf16 v[52:55], a[104:107], v[112:115], v[52:55]
    v_mfma_f32_16x16x32_bf16 v[44:47], a[108:111], v[116:119], v[44:47]
    v_mfma_f32_16x16x32_bf16 v[48:51], a[112:115], v[116:119], v[48:51]
    v_mfma_f32_16x16x32_bf16 v[52:55], a[116:119], v[116:119], v[52:55]
    v_mfma_f32_16x16x32_bf16 v[52:55], a[128:131], v[120:123], v[52:55]
    v_mfma_f32_16x16x32_bf16 v[48:51], a[124:127], v[120:123], v[48:51]
    v_mfma_f32_16x16x32_bf16 v[44:47], a[120:123], v[120:123], v[44:47]
    v_mfma_f32_16x16x32_bf16 v[44:47], a[132:135], v[124:127], v[44:47]
    v_mfma_f32_16x16x32_bf16 v[48:51], a[136:139], v[124:127], v[48:51]
    v_mfma_f32_16x16x32_bf16 v[52:55], a[140:143], v[124:127], v[52:55]
    v_mfma_f32_16x16x32_bf16 v[44:47], a[144:147], v[128:131], v[44:47]
    v_mfma_f32_16x16x32_bf16 v[48:51], a[148:151], v[128:131], v[48:51]
    v_mfma_f32_16x16x32_bf16 v[52:55], a[152:155], v[128:131], v[52:55]
    v_mfma_f32_16x16x32_bf16 v[52:55], a[164:167], v[132:135], v[52:55]
    v_mfma_f32_16x16x32_bf16 v[48:51], a[160:163], v[132:135], v[48:51]
    v_mfma_f32_16x16x32_bf16 v[44:47], a[156:159], v[132:135], v[44:47]
    v_mfma_f32_16x16x32_bf16 v[44:47], a[168:171], v[136:139], v[44:47]
    v_mfma_f32_16x16x32_bf16 v[48:51], a[172:175], v[136:139], v[48:51]
    v_mfma_f32_16x16x32_bf16 v[52:55], a[176:179], v[136:139], v[52:55]
    v_mfma_f32_16x16x32_bf16 v[44:47], a[180:183], v[140:143], v[44:47]
    v_mfma_f32_16x16x32_bf16 v[48:51], a[184:187], v[140:143], v[48:51]
    v_mfma_f32_16x16x32_bf16 v[52:55], a[188:191], v[140:143], v[52:55]
    v_mfma_f32_16x16x32_bf16 v[52:55], a[200:203], v[144:147], v[52:55]
    v_mfma_f32_16x16x32_bf16 v[48:51], a[196:199], v[144:147], v[48:51]
    v_mfma_f32_16x16x32_bf16 v[44:47], a[192:195], v[144:147], v[44:47]
    v_mfma_f32_16x16x32_bf16 v[44:47], a[204:207], v[148:151], v[44:47]
    v_mfma_f32_16x16x32_bf16 v[48:51], a[208:211], v[148:151], v[48:51]
    v_mfma_f32_16x16x32_bf16 v[52:55], a[212:215], v[148:151], v[52:55]
    v_mfma_f32_16x16x32_bf16 v[44:47], a[216:219], v[152:155], v[44:47]
    v_mfma_f32_16x16x32_bf16 v[48:51], a[220:223], v[152:155], v[48:51]
    v_mfma_f32_16x16x32_bf16 v[52:55], a[224:227], v[152:155], v[52:55]
    v_mfma_f32_16x16x32_bf16 v[52:55], a[236:239], v[156:159], v[52:55]
    v_mfma_f32_16x16x32_bf16 v[48:51], a[232:235], v[156:159], v[48:51]
    v_mfma_f32_16x16x32_bf16 v[44:47], a[228:231], v[156:159], v[44:47]
    v_mfma_f32_16x16x32_bf16 v[44:47], a[240:243], v[160:163], v[44:47]
    v_mfma_f32_16x16x32_bf16 v[48:51], a[244:247], v[160:163], v[48:51]
    v_mfma_f32_16x16x32_bf16 v[52:55], a[248:251], v[160:163], v[52:55]
    v_mfma_f32_16x16x32_bf16 v[44:47], a[252:255], v[164:167], v[44:47]
    v_mfma_f32_16x16x32_bf16 v[48:51], v[188:191], v[164:167], v[48:51]
    v_mfma_f32_16x16x32_bf16 v[52:55], v[192:195], v[164:167], v[52:55]
    v_mfma_f32_16x16x32_bf16 v[52:55], v[204:207], v[168:171], v[52:55]
    v_mfma_f32_16x16x32_bf16 v[48:51], v[200:203], v[168:171], v[48:51]
    v_mfma_f32_16x16x32_bf16 v[44:47], v[196:199], v[168:171], v[44:47]
    v_mfma_f32_16x16x32_bf16 v[44:47], v[208:211], v[172:175], v[44:47]
    v_mfma_f32_16x16x32_bf16 v[48:51], v[212:215], v[172:175], v[48:51]
    v_mfma_f32_16x16x32_bf16 v[52:55], v[216:219], v[172:175], v[52:55]
    v_mfma_f32_16x16x32_bf16 v[44:47], v[220:223], v[176:179], v[44:47]
    v_mfma_f32_16x16x32_bf16 v[48:51], v[224:227], v[176:179], v[48:51]
    v_mfma_f32_16x16x32_bf16 v[52:55], v[228:231], v[176:179], v[52:55]
    v_mfma_f32_16x16x32_bf16 v[52:55], v[240:243], v[180:183], v[52:55]
    v_mfma_f32_16x16x32_bf16 v[48:51], v[236:239], v[180:183], v[48:51]
    v_mfma_f32_16x16x32_bf16 v[44:47], v[232:235], v[180:183], v[44:47]
    v_mfma_f32_16x16x32_bf16 v[44:47], v[244:247], v[184:187], v[44:47]
    v_mfma_f32_16x16x32_bf16 v[48:51], v[248:251], v[184:187], v[48:51]
    v_mfma_f32_16x16x32_bf16 v[52:55], v[252:255], v[184:187], v[52:55]
    s_nop 5
    v_cvt_pk_bf16_f32 v32, v44, v45
    v_cvt_pk_bf16_f32 v33, v46, v47
    v_cvt_pk_bf16_f32 v34, v48, v49
    v_cvt_pk_bf16_f32 v35, v50, v51
    v_cvt_pk_bf16_f32 v36, v52, v53
    v_cvt_pk_bf16_f32 v37, v54, v55
    v_permlane16_swap_b32 v32, v34
    v_permlane16_swap_b32 v33, v35
    buffer_store_dwordx4 v[32:35], v9, s[16:19], s31 offen sc1
    buffer_store_dwordx2 v[36:37], v10, s[16:19], s31 offen sc1
L_gn:
    s_ashr_i32 s54, s54, 1
    s_bitset0_b32 s54, 30
    s_mul_i32 s47, s60, 36
    s_add_u32 s32, s32, s47
    s_mul_i32 s47, s60, 192
    s_add_u32 s31, s31, s47
    v_add_f32 v19, s62, v19
    v_add_f32 v20, s63, v20
    s_branch L_gt
L_gI:
    v_lshlrev_b32 v32, 16, v43
    v_and_b32 v33, 0xffff0000, v43
    v_fract_f32 v36, v32
    v_fract_f32 v37, v33
    v_cvt_u32_f32 v32, v32
    v_cvt_u32_f32 v33, v33
    v_mad_u32_u24 v40, v32, s49, v33
    v_mul_u32_u24 v40, 192, v40
    v_add_u32 v40, v40, v22
    v_sub_f32 v38, 1.0, v36
    v_sub_f32 v39, 1.0, v37
    v_cvt_pk_bf16_f32 v32, v38, v39
    v_lshlrev_b32 v38, 16, v32
    v_and_b32 v39, 0xffff0000, v32
    v_mul_f32 v1, v38, v39
    v_mul_f32 v2, v38, v37
    v_mul_f32 v3, v36, v39
    v_mul_f32 v15, v36, v37
    v_cvt_pk_bf16_f32 v32, v1, v2
    v_cvt_pk_bf16_f32 v33, v3, v15
    v_lshlrev_b32 v1, 16, v32
    v_and_b32 v2, 0xffff0000, v32
    v_lshlrev_b32 v3, 16, v33
    v_and_b32 v15, 0xffff0000, v33
    v_cmp_neq_f32 vcc, 0, v37
    v_mov_b32 v32, 192
    v_mov_b32 v33, 43008
    v_cndmask_b32 v41, 0, v32, vcc
    v_cmp_neq_f32 vcc, 0, v36
    v_mov_b32 v44, 0
    v_mov_b32 v45, 0
    v_mov_b32 v46, 0
    v_mov_b32 v47, 0
    v_mov_b32 v48, 0
    v_mov_b32 v49, 0
    v_mov_b32 v50, 0
    v_mov_b32 v51, 0
    v_mov_b32 v52, 0
    v_mov_b32 v53, 0
    v_mov_b32 v54, 0
    v_mov_b32 v55, 0
    v_mov_b32 v56, 0
    v_mov_b32 v57, 0
    v_mov_b32 v58, 0
    v_mov_b32 v59, 0
    v_mov_b32 v60, 0
    v_mov_b32 v61, 0
    v_mov_b32 v62, 0
    v_mov_b32 v63, 0
    v_mov_b32 v64, 0
    v_mov_b32 v65, 0
    v_mov_b32 v66, 0
    v_mov_b32 v67, 0
    v_cndmask_b32 v42, 0, v33, vcc
    v_sub_u32 v42, v42, v41
    s_mov_b32 s47, 4
L_gl:
    buffer_load_dwordx4 v[68:71], v40, s[4:7], 0 offen offset:0
    buffer_load_dwordx4 v[72:75], v40, s[4:7], 0 offen offset:64
    buffer_load_dwordx4 v[76:79], v40, s[4:7], 0 offen offset:128
    v_add_u32 v40, v40, v41
    v_swap_b32 v41, v42
    s_waitcnt vmcnt(0)
    v_lshlrev_b32 v32, 16, v68
    v_and_b32 v33, 0xffff0000, v68
    v_fmac_f32 v44, v1, v32
    v_fmac_f32 v45, v1, v33
    v_lshlrev_b32 v32, 16, v69
    v_and_b32 v33, 0xffff0000, v69
    v_fmac_f32 v46, v1, v32
    v_fmac_f32 v47, v1, v33
    v_lshlrev_b32 v32, 16, v70
    v_and_b32 v33, 0xffff0000, v70
    v_fmac_f32 v48, v1, v32
    v_fmac_f32 v49, v1, v33
    v_lshlrev_b32 v32, 16, v71
    v_and_b32 v33, 0xffff0000, v71
    v_fmac_f32 v50, v1, v32
    v_fmac_f32 v51, v1, v33
    v_lshlrev_b32 v32, 16, v72
    v_and_b32 v33, 0xffff0000, v72
    v_fmac_f32 v52, v1, v32
    v_fmac_f32 v53, v1, v33
    v_lshlrev_b32 v32, 16, v73
    v_and_b32 v33, 0xffff0000, v73
    v_fmac_f32 v54, v1, v32
    v_fmac_f32 v55, v1, v33
    v_lshlrev_b32 v32, 16, v74
    v_and_b32 v33, 0xffff0000, v74
    v_fmac_f32 v56, v1, v32
    v_fmac_f32 v57, v1, v33
    v_lshlrev_b32 v32, 16, v75
    v_and_b32 v33, 0xffff0000, v75
    v_fmac_f32 v58, v1, v32
    v_fmac_f32 v59, v1, v33
    v_lshlrev_b32 v32, 16, v76
    v_and_b32 v33, 0xffff0000, v76
    v_fmac_f32 v60, v1, v32
    v_fmac_f32 v61, v1, v33
    v_lshlrev_b32 v32, 16, v77
    v_and_b32 v33, 0xffff0000, v77
    v_fmac_f32 v62, v1, v32
    v_fmac_f32 v63, v1, v33
    v_lshlrev_b32 v32, 16, v78
    v_and_b32 v33, 0xffff0000, v78
    v_fmac_f32 v64, v1, v32
    v_fmac_f32 v65, v1, v33
    v_lshlrev_b32 v32, 16, v79
    v_and_b32 v33, 0xffff0000, v79
    v_fmac_f32 v66, v1, v32
    v_fmac_f32 v67, v1, v33
    v_mov_b32 v1, v2
    v_mov_b32 v2, v3
    v_mov_b32 v3, v15
    s_sub_u32 s47, s47, 1
    s_cmp_lg_u32 s47, 0
    s_cbranch_scc1 L_gl
    s_setpc_b64 s[52:53]
.p2align 7
L_ctab:
    .long 0x0, 0x18000c0, 0x400000, 0x0
    .long 0x3100008, 0x49003d0, 0x3400300, 0x10
    .long 0x6200010, 0x7a006e0, 0x6400600, 0x20
    .long 0x9300018, 0xab009f0, 0x9400900, 0x30
    .long 0xc000c0, 0x2400180, 0x10000c0, 0x40
    .long 0x3d000c8, 0x5500490, 0x40003c0, 0x50
    .long 0x6e000d0, 0x86007a0, 0x70006c0, 0x60
    .long 0x9f000d8, 0xb700ab0, 0xa0009c0, 0x70
    .long 0x1800180, 0x3100240, 0x1c00180, 0x80
    .long 0x4900188, 0x6200550, 0x4c00480, 0x1f80
    .long 0x7a00190, 0x9300860, 0x7c00780, 0x1f90
    .long 0xab00198, 0xc000b70, 0xac00a80, 0x1fa0
    .long 0x2400240, 0x3d00310, 0x2800240, 0x1fb0
    .long 0x5500248, 0x6e00620, 0x5800540, 0x1fc0
    .long 0x8600250, 0x9f00930, 0x8800840, 0x1fd0
    .long 0xb700258, 0xcc00c00, 0xb800b40, 0x1fe0
    .long 0x200c20, 0x1a000e0, 0x480020, 0x1ff0
    .long 0x3300c28, 0x4b003f0, 0x3480320, 0x2000
    .long 0x6000c30, 0x78006c0, 0x6480620, 0x3f00
    .long 0x9100c38, 0xa9009d0, 0x9480920, 0x3f10
    .long 0xe00ce0, 0x26001a0, 0x10800e0, 0x3f20
    .long 0x3f00ce8, 0x57004b0, 0x40803e0, 0x3f30
    .long 0x6c00cf0, 0x8400780, 0x70806e0, 0x3f40
    .long 0x9d00cf8, 0xb500a90, 0xa0809e0, 0x3f50
    .long 0x1a00da0, 0x3300260, 0x1c801a0, 0x3f60
    .long 0x4b00da8, 0x6000570, 0x4c804a0, 0x3f70
    .long 0x7800db0, 0x9100840, 0x7c807a0, 0x3f80
    .long 0xa900db8, 0xc200b50, 0xac80aa0, 0x5e80
    .long 0x2600e60, 0x3f00330, 0x2880260, 0x5e90
    .long 0x5700e68, 0x6c00600, 0x5880560, 0x5ea0
    .long 0x8400e70, 0x9d00910, 0x8880860, 0x5eb0
    .long 0xb500e78, 0xce00c20, 0xb880b60, 0x5ec0
    .long 0x100600, 0x19000d0, 0x500010, 0x5ed0
    .long 0x3000608, 0x48003c0, 0x3500310, 0x5ee0
    .long 0x6300610, 0x7b006f0, 0x6500610, 0x5ef0
    .long 0x9200618, 0xaa009e0, 0x9500910, 0x5f00
    .long 0xd006c0, 0x2500190, 0x11000d0, 0x7e00
    .long 0x3c006c8, 0x5400480, 0x41003d0, 0x7e10
    .long 0x6f006d0, 0x87007b0, 0x71006d0, 0x7e20
    .long 0x9e006d8, 0xb600aa0, 0xa1009d0, 0x7e30
    .long 0x1900780, 0x3000250, 0x1d00190, 0x7e40
    .long 0x4800788, 0x6300540, 0x4d00490, 0x7e50
    .long 0x7b00790, 0x9200870, 0x7d00790, 0x7e60
    .long 0xaa00798, 0xc100b60, 0xad00a90, 0x7e70
    .long 0x2500840, 0x3c00300, 0x2900250, 0x7e80
    .long 0x5400848, 0x6f00630, 0x5900550, 0x9d80
    .long 0x8700850, 0x9e00920, 0x8900850, 0x9d90
    .long 0xb600858, 0xcd00c10, 0xb900b50, 0x9da0
    .long 0x301220, 0x1b000f0, 0x580030, 0x9db0
    .long 0x3201228, 0x4a003e0, 0x3580330, 0x9dc0
    .long 0x6101230, 0x79006d0, 0x6580630, 0x9dd0
    .long 0x9001238, 0xa8009c0, 0x9580930, 0x9de0
    .long 0xf012e0, 0x27001b0, 0x11800f0, 0x9df0
    .long 0x3e012e8, 0x56004a0, 0x41803f0, 0x9e00
    .long 0x6d012f0, 0x8500790, 0x71806f0, 0xbd00
    .long 0x9c012f8, 0xb400a80, 0xa1809f0, 0xbd10
    .long 0x1b013a0, 0x3200270, 0x1d801b0, 0xbd20
    .long 0x4a013a8, 0x6100560, 0x4d804b0, 0xbd30
    .long 0x79013b0, 0x9000850, 0x7d807b0, 0xbd40
    .long 0xa8013b8, 0xc300b40, 0xad80ab0, 0xbd50
    .long 0x2701460, 0x3e00320, 0x2980270, 0xbd60
    .long 0x5601468, 0x6d00610, 0x5980570, 0xbd70
    .long 0x8501470, 0x9c00900, 0x8980870, 0xbd80
    .long 0xb401478, 0xcf00c30, 0xb980b70, 0xbd80
    .long 0xc000000, 0x0, 0x1e401e0, 0x0
    .long 0xcc000c0, 0x20, 0x1e40208, 0x0
    .long 0x19800180, 0x40, 0x147001e4, 0x0
    .long 0x1a400240, 0x60, 0x149801e4, 0x0
    .long 0x27000310, 0x80, 0x1e401e4, 0x0
    .long 0x27c003d0, 0xa0, 0x1e401e4, 0x0
    .long 0x34800490, 0xc0, 0x1e401e4, 0x0
    .long 0x35400550, 0xe0, 0x1e401e4, 0x0
    .long 0x42000620, 0x100, 0x1e401e4, 0x0
    .long 0x42c006e0, 0x120, 0x1e401e4, 0x0
    .long 0x420007a0, 0x140, 0x1e401e4, 0x0
    .long 0x42c00860, 0x160, 0x1e401e4, 0x0
    .long 0x42000930, 0x5cd00180, 0x1e401e4, 0x0
    .long 0x42c009f0, 0x5cd001a0, 0x1e401e4, 0x0
    .long 0x42000ab0, 0x5cd001c0, 0x1e401e4, 0x3f80
    .long 0x42c00b70, 0x5cd001e8, 0x1e401e4, 0x3f800000
    .long 0xc200020, 0x5cd00008, 0x1e401e4, 0x0
    .long 0xce000e0, 0x5cd00028, 0x1e401e4, 0x0
    .long 0x19a001a0, 0x5cd00048, 0x1e401e4, 0x0
    .long 0x1a600260, 0x5cd00068, 0x1e401e4, 0x0
    .long 0x27200330, 0x5cd00088, 0x1e42700, 0x0
    .long 0x27e003f0, 0x5cd000a8, 0x1e42728, 0x0
    .long 0x34a004b0, 0x5cd000c8, 0x399001e4, 0x0
    .long 0x35600570, 0x5cd000e8, 0x39b801e4, 0x0
    .long 0x42200600, 0x12900108, 0x1e401e4, 0x0
    .long 0x42e006c0, 0x12900128, 0x1e401e4, 0x0
    .long 0x42200780, 0x12900148, 0x1e401e4, 0x0
    .long 0x42e00840, 0x12900168, 0x1e401e4, 0x0
    .long 0x42200910, 0x12900188, 0x1e401e4, 0x0
    .long 0x42e009d0, 0x129001a8, 0x1e401e4, 0x0
    .long 0x42200a90, 0x129001c8, 0x1e401e4, 0x3f80
    .long 0x42e00b50, 0x129001f0, 0x1e401e4, 0x3f800000
    .long 0xc100010, 0x12900010, 0x1e401e4, 0x0
    .long 0xcd000d0, 0x12900030, 0x1e401e4, 0x0
    .long 0x19900190, 0x12900050, 0x1e401e4, 0x0
    .long 0x1a500250, 0x12900070, 0x1e401e4, 0x0
    .long 0x27100300, 0x6f600090, 0x1e401e4, 0x0
    .long 0x27d003c0, 0x6f6000b0, 0x1e401e4, 0x0
    .long 0x34900480, 0x6f6000d0, 0x1e401e4, 0x0
    .long 0x35500540, 0x6f6000f0, 0x1e401e4, 0x0
    .long 0x42100630, 0x6f600110, 0x1e44c20, 0x0
    .long 0x42d006f0, 0x6f600130, 0x1e44c48, 0x0
    .long 0x421007b0, 0x6f600150, 0x1e401e4, 0x0
    .long 0x42d00870, 0x6f600170, 0x1e401e4, 0x0
    .long 0x42100920, 0x6f600190, 0x1e401e4, 0x0
    .long 0x42d009e0, 0x6f6001b0, 0x1e401e4, 0x0
    .long 0x42100aa0, 0x6f6001d0, 0x1e401e4, 0x3f80
    .long 0x42d00b60, 0x6f6001f8, 0x1e401e4, 0x3f800000
    .long 0xc300030, 0x25200018, 0x1e401e4, 0x0
    .long 0xcf000f0, 0x25200038, 0x1e401e4, 0x0
    .long 0x19b001b0, 0x25200058, 0x1e401e4, 0x0
    .long 0x1a700270, 0x25200078, 0x1e401e4, 0x0
    .long 0x27300320, 0x25200098, 0x1e401e4, 0x0
    .long 0x27f003e0, 0x252000b8, 0x1e401e4, 0x0
    .long 0x34b004a0, 0x252000d8, 0x1e401e4, 0x0
    .long 0x35700560, 0x252000f8, 0x1e401e4, 0x0
    .long 0x42300610, 0x25200118, 0x1e401e4, 0x0
    .long 0x42f006d0, 0x25200138, 0x1e401e4, 0x0
    .long 0x42300790, 0x25200158, 0x1e401e4, 0x0
    .long 0x42f00850, 0x25200178, 0x1e401e4, 0x0
    .long 0x42300900, 0x81f00198, 0x1e401e4, 0x0
    .long 0x42f009c0, 0x81f001b8, 0x1e401e4, 0x0
    .long 0x42300a80, 0x81f001d8, 0x1e401e4, 0x3f80
    .long 0x42f00b40, 0x81f00200, 0x1e401e4, 0x3f800000
    .long 0x0, 0x0, 0x0, 0x0
    .long 0x20, 0x4, 0x0, 0x3000000
    .long 0x8, 0x8, 0x0, 0x6000000
    .long 0x28, 0xc, 0x0, 0x0
    .long 0x0, 0x1, 0x0, 0x3000001
    .long 0x20, 0x5, 0x0, 0x6000001
    .long 0x8, 0x9, 0x0, 0x1
    .long 0x28, 0xd, 0x0, 0x3000001
    .long 0x0, 0x2, 0x0, 0x6000002
    .long 0x20, 0x6, 0x0, 0x2
    .long 0x8, 0xa, 0x0, 0x3000002
    .long 0x28, 0xe, 0x0, 0x6000002
    .long 0x0, 0x3, 0x0, 0x9000003
    .long 0x20, 0x7, 0x0, 0xc000003
    .long 0x8, 0xb, 0x0, 0xf000003
    .long 0x28, 0xf, 0x0, 0x9000003
    .long 0x0, 0x0, 0x20002, 0xc000004
    .long 0x20, 0x4, 0x20002, 0xf000004
    .long 0x8, 0x8, 0x20002, 0x9000004
    .long 0x28, 0xc, 0x20002, 0xc000004
    .long 0x0, 0x1, 0x20002, 0xf000005
    .long 0x20, 0x5, 0x20002, 0x9000005
    .long 0x8, 0x9, 0x20002, 0xc000005
    .long 0x28, 0xd, 0x20002, 0xf000005
    .long 0x0, 0x2, 0x20002, 0x80006
    .long 0x20, 0x6, 0x20002, 0x3080006
    .long 0x8, 0xa, 0x20002, 0x6080006
    .long 0x28, 0xe, 0x20002, 0x80006
    .long 0x0, 0x3, 0x20002, 0x3080007
    .long 0x20, 0x7, 0x20002, 0x6080007
    .long 0x8, 0xb, 0x20002, 0x80007
    .long 0x28, 0xf, 0x20002, 0x3080007
    .long 0x0, 0x0, 0x10001, 0x6080008
    .long 0x20, 0x4, 0x10001, 0x80008
    .long 0x8, 0x8, 0x10001, 0x3080008
    .long 0x28, 0xc, 0x10001, 0x6080008
    .long 0x0, 0x1, 0x10001, 0x9080009
    .long 0x20, 0x5, 0x10001, 0xc080009
    .long 0x8, 0x9, 0x10001, 0xf080009
    .long 0x28, 0xd, 0x10001, 0x9080009
    .long 0x0, 0x2, 0x10001, 0xc08000a
    .long 0x20, 0x6, 0x10001, 0xf08000a
    .long 0x8, 0xa, 0x10001, 0x908000a
    .long 0x28, 0xe, 0x10001, 0xc08000a
    .long 0x0, 0x3, 0x10001, 0xf08000b
    .long 0x20, 0x7, 0x10001, 0x908000b
    .long 0x8, 0xb, 0x10001, 0xc08000b
    .long 0x28, 0xf, 0x10001, 0xf08000b
    .long 0x0, 0x0, 0x30003, 0x10000c
    .long 0x20, 0x4, 0x30003, 0x310000c
    .long 0x8, 0x8, 0x30003, 0x610000c
    .long 0x28, 0xc, 0x30003, 0x10000c
    .long 0x0, 0x1, 0x30003, 0x310000d
    .long 0x20, 0x5, 0x30003, 0x610000d
    .long 0x8, 0x9, 0x30003, 0x10000d
    .long 0x28, 0xd, 0x30003, 0x310000d
    .long 0x0, 0x2, 0x30003, 0x610000e
    .long 0x20, 0x6, 0x30003, 0x10000e
    .long 0x8, 0xa, 0x30003, 0x310000e
    .long 0x28, 0xe, 0x30003, 0x610000e
    .long 0x0, 0x3, 0x30003, 0x910000f
    .long 0x20, 0x7, 0x30003, 0xc10000f
    .long 0x8, 0xb, 0x30003, 0xf10000f
    .long 0x28, 0xf, 0x30003, 0x910000f
    .long 0xc0c0100, 0xc0c0c0c, 0xc0c0302, 0xc0c0c0c
    .long 0xc0c0c0c, 0xc0c0c0c, 0xc0c0c0c, 0xc0c0c0c
    .long 0xc0c0c0c, 0xc0c0c0c, 0xc0c0c0c, 0xc0c0c0c
    .long 0xc0c0c0c, 0xc0c0c0c, 0xc0c0c0c, 0xc0c0c0c
    .long 0x1000c0c, 0xc0c0c0c, 0x3020c0c, 0xc0c0c0c
    .long 0xc0c0c0c, 0xc0c0c0c, 0xc0c0c0c, 0xc0c0c0c
    .long 0xc0c0c0c, 0xc0c0c0c, 0xc0c0c0c, 0xc0c0c0c
    .long 0xc0c0c0c, 0xc0c0c0c, 0xc0c0c0c, 0xc0c0c0c
    .long 0xc0c0c0c, 0xc0c0100, 0xc0c0c0c, 0xc0c0302
    .long 0xc0c0c0c, 0xc0c0c0c, 0xc0c0c0c, 0xc0c0c0c
    .long 0xc0c0c0c, 0xc0c0c0c, 0xc0c0c0c, 0xc0c0c0c
    .long 0xc0c0c0c, 0xc0c0c0c, 0xc0c0c0c, 0xc0c0c0c
    .long 0xc0c0c0c, 0x1000c0c, 0xc0c0c0c, 0x3020c0c
    .long 0xc0c0c0c, 0xc0c0c0c, 0xc0c0c0c, 0xc0c0c0c
    .long 0xc0c0c0c, 0xc0c0c0c, 0xc0c0c0c, 0xc0c0c0c
    .long 0xc0c0c0c, 0xc0c0c0c, 0xc0c0c0c, 0xc0c0c0c
    .long 0xc0c0c0c, 0xc0c0c0c, 0xc0c0c0c, 0xc0c0c0c
    .long 0xc0c0100, 0xc0c0c0c, 0xc0c0302, 0xc0c0c0c
    .long 0xc0c0c0c, 0xc0c0c0c, 0xc0c0c0c, 0xc0c0c0c
    .long 0xc0c0c0c, 0xc0c0c0c, 0xc0c0c0c, 0xc0c0c0c
    .long 0xc0c0c0c, 0xc0c0c0c, 0xc0c0c0c, 0xc0c0c0c
    .long 0x1000c0c, 0xc0c0c0c, 0x3020c0c, 0xc0c0c0c
    .long 0xc0c0c0c, 0xc0c0c0c, 0xc0c0c0c, 0xc0c0c0c
    .long 0xc0c0c0c, 0xc0c0c0c, 0xc0c0c0c, 0xc0c0c0c
    .long 0xc0c0c0c, 0xc0c0c0c, 0xc0c0c0c, 0xc0c0c0c
    .long 0xc0c0c0c, 0xc0c0100, 0xc0c0c0c, 0xc0c0302
    .long 0xc0c0c0c, 0xc0c0c0c, 0xc0c0c0c, 0xc0c0c0c
    .long 0xc0c0c0c, 0xc0c0c0c, 0xc0c0c0c, 0xc0c0c0c
    .long 0xc0c0c0c, 0xc0c0c0c, 0xc0c0c0c, 0xc0c0c0c
    .long 0xc0c0c0c, 0x1000c0c, 0xc0c0c0c, 0x3020c0c
    .long 0xc0c0c0c, 0xc0c0c0c, 0xc0c0c0c, 0xc0c0c0c
    .long 0xc0c0c0c, 0xc0c0c0c, 0xc0c0c0c, 0xc0c0c0c
    .long 0xc0c0c0c, 0xc0c0c0c, 0xc0c0c0c, 0xc0c0c0c
    .long 0xc0c0c0c, 0xc0c0c0c, 0xc0c0c0c, 0xc0c0c0c
    .long 0xc0c0100, 0xc0c0c0c, 0xc0c0302, 0xc0c0c0c
    .long 0xc0c0c0c, 0xc0c0c0c, 0xc0c0c0c, 0xc0c0c0c
    .long 0xc0c0c0c, 0xc0c0c0c, 0xc0c0c0c, 0xc0c0c0c
    .long 0xc0c0c0c, 0xc0c0c0c, 0xc0c0c0c, 0xc0c0c0c
    .long 0x1000c0c, 0xc0c0c0c, 0x3020c0c, 0xc0c0c0c
    .long 0xc0c0c0c, 0xc0c0c0c, 0xc0c0c0c, 0xc0c0c0c
    .long 0xc0c0c0c, 0xc0c0c0c, 0xc0c0c0c, 0xc0c0c0c
    .long 0xc0c0c0c, 0xc0c0c0c, 0xc0c0c0c, 0xc0c0c0c
    .long 0xc0c0c0c, 0xc0c0100, 0xc0c0c0c, 0xc0c0302
    .long 0xc0c0c0c, 0xc0c0c0c, 0xc0c0c0c, 0xc0c0c0c
    .long 0xc0c0c0c, 0xc0c0c0c, 0xc0c0c0c, 0xc0c0c0c
    .long 0xc0c0c0c, 0xc0c0c0c, 0xc0c0c0c, 0xc0c0c0c
    .long 0xc0c0c0c, 0x1000c0c, 0xc0c0c0c, 0x3020c0c
    .long 0xc0c0c0c, 0xc0c0c0c, 0xc0c0c0c, 0xc0c0c0c
    .long 0xc0c0c0c, 0xc0c0c0c, 0xc0c0c0c, 0xc0c0c0c
    .long 0xc0c0c0c, 0xc0c0c0c, 0xc0c0c0c, 0xc0c0c0c
    .long 0xc0c0c0c, 0xc0c0c0c, 0xc0c0c0c, 0xc0c0c0c
    .long 0xc0c0100, 0xc0c0c0c, 0xc0c0302, 0xc0c0c0c
    .long 0xc0c0c0c, 0xc0c0c0c, 0xc0c0c0c, 0xc0c0c0c
    .long 0xc0c0c0c, 0xc0c0c0c, 0xc0c0c0c, 0xc0c0c0c
    .long 0xc0c0c0c, 0xc0c0c0c, 0xc0c0c0c, 0xc0c0c0c
    .long 0x1000c0c, 0xc0c0c0c, 0x3020c0c, 0xc0c0c0c
    .long 0xc0c0c0c, 0xc0c0c0c, 0xc0c0c0c, 0xc0c0c0c
    .long 0xc0c0c0c, 0xc0c0c0c, 0xc0c0c0c, 0xc0c0c0c
    .long 0xc0c0c0c, 0xc0c0c0c, 0xc0c0c0c, 0xc0c0c0c
    .long 0xc0c0c0c, 0xc0c0100, 0xc0c0c0c, 0xc0c0302
    .long 0xc0c0c0c, 0xc0c0c0c, 0xc0c0c0c, 0xc0c0c0c
    .long 0xc0c0c0c, 0xc0c0c0c, 0xc0c0c0c, 0xc0c0c0c
    .long 0xc0c0c0c, 0xc0c0c0c, 0xc0c0c0c, 0xc0c0c0c
    .long 0xc0c0c0c, 0x1000c0c, 0xc0c0c0c, 0x3020c0c
.p2align 6
L_runtab:
    .long 0x15a800, 0x925800, 0x55, 0x2200, 0x87543021, 0x6, 0x165000, 0x199800, 0x3dff, 0x0, 0x0, 0x0, 0x0, 0x0, 0x42f00, 0xa
    .long 0x295800, 0x925800, 0x55, 0x4000, 0x87543021, 0x6, 0x2a0000, 0x2d4800, 0x3dff, 0x0, 0x0, 0x0, 0x0, 0x0, 0x7e000, 0xa
    .long 0x3d0800, 0x925800, 0x55, 0x5e00, 0x87543021, 0x6, 0x3db000, 0x40f800, 0x3e7f, 0x0, 0x0, 0x0, 0x0, 0x0, 0xb9100, 0xa
    .long 0x50b800, 0x925800, 0x55, 0x7c00, 0x87543021, 0x6, 0x516000, 0x54a800, 0x3e7f, 0x0, 0x0, 0x0, 0x0, 0x0, 0xf4200, 0xa
    .long 0x5dd800, 0x925800, 0x55, 0x9000, 0x87543021, 0x6, 0x5e8000, 0x61c800, 0x3eff, 0x0, 0x0, 0x0, 0x0, 0x0, 0x11b800, 0xa
    .long 0x6af800, 0x925800, 0x55, 0xa400, 0x87543021, 0x6, 0x6ba000, 0x6ee800, 0x3eff, 0x0, 0x0, 0x0, 0x0, 0x0, 0x142e00, 0xa
    .long 0x781800, 0x925800, 0x55, 0xb800, 0x87543021, 0x6, 0x78c000, 0x7c0800, 0x3eff, 0x0, 0x0, 0x0, 0x0, 0x0, 0x16a400, 0xa
    .long 0x853800, 0x925800, 0x55, 0xcc00, 0x87543021, 0x6, 0x85e000, 0x892800, 0x3eff, 0x0, 0x0, 0x0, 0x0, 0x0, 0x191a00, 0xa
    .long 0x1c3800, 0x925800, 0x55, 0x2c00, 0x87543021, 0x6, 0x1ce000, 0x202800, 0x3dff, 0x0, 0x0, 0x0, 0x0, 0x0, 0x56a00, 0xa
    .long 0x2fe800, 0x925800, 0x55, 0x4a00, 0x87543021, 0x6, 0x309000, 0x33d800, 0x3e7f, 0x0, 0x0, 0x0, 0x0, 0x0, 0x91b00, 0xa
    .long 0x439800, 0x925800, 0x55, 0x6800, 0x87543021, 0x6, 0x444000, 0x478800, 0x3e7f, 0x0, 0x0, 0x0, 0x0, 0x0, 0xccc00, 0xa
    .long 0x574800, 0x925800, 0x55, 0x8600, 0x87543021, 0x6, 0x57f000, 0x5b3800, 0x3eff, 0x0, 0x0, 0x0, 0x0, 0x0, 0x107d00, 0xa
    .long 0x646800, 0x925800, 0x55, 0x9a00, 0x87543021, 0x6, 0x651000, 0x685800, 0x3eff, 0x0, 0x0, 0x0, 0x0, 0x0, 0x12f300, 0xa
    .long 0x718800, 0x925800, 0x55, 0xae00, 0x87543021, 0x6, 0x723000, 0x757800, 0x3eff, 0x0, 0x0, 0x0, 0x0, 0x0, 0x156900, 0xa
    .long 0x7ea800, 0x925800, 0x55, 0xc200, 0x87543021, 0x6, 0x7f5000, 0x829800, 0x3eff, 0x0, 0x0, 0x0, 0x0, 0x0, 0x17df00, 0xa
    .long 0x8bc800, 0x925800, 0x55, 0xd600, 0x87543021, 0x6, 0x8c7000, 0x8fb800, 0x3eff, 0x0, 0x0, 0x0, 0x0, 0x0, 0x1a5500, 0xa
    .long 0x22c800, 0x925800, 0x55, 0x3600, 0x87543021, 0x6, 0x237000, 0x26b800, 0x3dff, 0x0, 0x0, 0x0, 0x0, 0x0, 0x6a500, 0xa
    .long 0x367800, 0x925800, 0x55, 0x5400, 0x87543021, 0x6, 0x372000, 0x3a6800, 0x3e7f, 0x0, 0x0, 0x0, 0x0, 0x0, 0xa5600, 0xa
    .long 0x4a2800, 0x925800, 0x55, 0x7200, 0x87543021, 0x6, 0x4ad000, 0x4e1800, 0x3e7f, 0x0, 0x0, 0x0, 0x0, 0x0, 0xe0700, 0xa
    .long 0x45c0, 0xa740, 0x55, 0x15e00, 0x85741063, 0x2, 0x4680, 0x4a40, 0x3e7f, 0x0, 0x0, 0x0, 0x0, 0x0, 0xd38, 0xa
    .long 0x5c40, 0xa740, 0x55, 0x17c00, 0x85741063, 0x2, 0x5d00, 0x60c0, 0x3e7f, 0x0, 0x0, 0x0, 0x0, 0x0, 0x1170, 0xa
    .long 0x72c0, 0xa740, 0x55, 0x19a00, 0x85741063, 0x2, 0x7380, 0x7740, 0x3eff, 0x0, 0x0, 0x0, 0x0, 0x0, 0x15a8, 0xa
    .long 0x8940, 0xa740, 0x55, 0x1b800, 0x85741063, 0x2, 0x8a00, 0x8dc0, 0x3eff, 0x0, 0x0, 0x0, 0x0, 0x0, 0x19e0, 0xa
    .long 0x9840, 0xa740, 0x55, 0x1cc00, 0x85741063, 0x2, 0x9900, 0x9cc0, 0x3eff, 0x0, 0x0, 0x0, 0x0, 0x0, 0x1cb0, 0xa
    .long 0x18c0, 0xa740, 0x55, 0x12200, 0x85741063, 0x2, 0x1980, 0x1d40, 0x3dff, 0x0, 0x0, 0x0, 0x0, 0x0, 0x4c8, 0xa
    .long 0x27c0, 0xa740, 0x55, 0x13600, 0x85741063, 0x2, 0x2880, 0x2c40, 0x3dff, 0x0, 0x0, 0x0, 0x0, 0x0, 0x798, 0xa
    .long 0x36c0, 0xa740, 0x55, 0x14a00, 0x85741063, 0x2, 0x3780, 0x3b40, 0x3e7f, 0x0, 0x0, 0x0, 0x0, 0x0, 0xa68, 0xa
    .long 0x4d40, 0xa740, 0x55, 0x16800, 0x85741063, 0x2, 0x4e00, 0x51c0, 0x3e7f, 0x0, 0x0, 0x0, 0x0, 0x0, 0xea0, 0xa
    .long 0x63c0, 0xa740, 0x55, 0x18600, 0x85741063, 0x2, 0x6480, 0x6840, 0x3eff, 0x0, 0x0, 0x0, 0x0, 0x0, 0x12d8, 0xa
    .long 0x7a40, 0xa740, 0x55, 0x1a400, 0x85741063, 0x2, 0x7b00, 0x7ec0, 0x3eff, 0x0, 0x0, 0x0, 0x0, 0x0, 0x1710, 0xa
    .long 0x90c0, 0xa740, 0x55, 0x1c200, 0x85741063, 0x2, 0x9180, 0x9540, 0x3eff, 0x0, 0x0, 0x0, 0x0, 0x0, 0x1b48, 0xa
    .long 0x9fc0, 0xa740, 0x55, 0x1d600, 0x85741063, 0x2, 0xa080, 0xa440, 0x3eff, 0x0, 0x0, 0x0, 0x0, 0x0, 0x1e18, 0xa
    .long 0x2040, 0xa740, 0x55, 0x12c00, 0x85741063, 0x2, 0x2100, 0x24c0, 0x3dff, 0x0, 0x0, 0x0, 0x0, 0x0, 0x630, 0xa
    .long 0x2f40, 0xa740, 0x55, 0x14000, 0x85741063, 0x2, 0x3000, 0x33c0, 0x3dff, 0x0, 0x0, 0x0, 0x0, 0x0, 0x900, 0xa
    .long 0x3e40, 0xa740, 0x55, 0x15400, 0x85741063, 0x2, 0x3f00, 0x42c0, 0x3e7f, 0x0, 0x0, 0x0, 0x0, 0x0, 0xbd0, 0xa
    .long 0x54c0, 0xa740, 0x55, 0x17200, 0x85741063, 0x2, 0x5580, 0x5940, 0x3e7f, 0x0, 0x0, 0x0, 0x0, 0x0, 0x1008, 0xa
    .long 0x6b40, 0xa740, 0x55, 0x19000, 0x85741063, 0x2, 0x6c00, 0x6fc0, 0x3eff, 0x0, 0x0, 0x0, 0x0, 0x0, 0x1440, 0xa
    .long 0x81c0, 0xa740, 0x55, 0x1ae00, 0x85741063, 0x2, 0x8280, 0x8640, 0x3eff, 0x0, 0x0, 0x0, 0x0, 0x0, 0x1878, 0xa
    .long 0xa80, 0xf00, 0x12, 0x1fe31000, 0x6ac0, 0x18a, 0xc00, 0xcc0, 0xbf800000, 0x41700000, 0xf4, 0xe, 0x7, 0x5b80, 0x240, 0x3
    .long 0xcc0, 0x1140, 0x12, 0x1fe31300, 0x6ac0, 0x18a, 0xe40, 0xf00, 0xbf800000, 0x41900000, 0xf4, 0x11, 0x7, 0x5b80, 0x2ac, 0x3
    .long 0xf00, 0x1440, 0x22, 0x1fe31600, 0x7a00, 0x175, 0x1080, 0x1140, 0xbf800000, 0x41a80000, 0xf4, 0x14, 0x8, 0x6ac0, 0x318, 0x4
    .long 0x1200, 0x1740, 0x22, 0x1fe31a00, 0x7a00, 0x175, 0x1380, 0x1440, 0xbf800000, 0x41c80000, 0xf4, 0x18, 0x8, 0x6ac0, 0x3a8, 0x4
    .long 0x1500, 0x1a40, 0x22, 0x1fe31e00, 0x7a00, 0x175, 0x1680, 0x1740, 0xbf800000, 0x41e80000, 0xf4, 0x1c, 0x8, 0x6ac0, 0x438, 0x4
    .long 0x4d40, 0x5700, 0x66, 0xe36810, 0xd580, 0xfb, 0xace00, 0xacec0, 0x41700000, 0x42ce0000, 0x0, 0x67, 0xe, 0xc640, 0x206a0, 0xc
    .long 0x5f40, 0x6900, 0x66, 0xe38010, 0xd580, 0xfb, 0xae000, 0xae0c0, 0x41700000, 0x42fe0000, 0x0, 0x7f, 0xe, 0xc640, 0x20a00, 0xc
    .long 0x7140, 0x7b00, 0x66, 0xe39810, 0xd580, 0xfb, 0xaf200, 0xaf2c0, 0x41700000, 0x43170000, 0x0, 0x97, 0xe, 0xc640, 0x20d60, 0xc
    .long 0x8340, 0x8d00, 0x66, 0xe3b010, 0xd580, 0xfb, 0xb0400, 0xb04c0, 0x41700000, 0x432f0000, 0x0, 0xaf, 0xe, 0xc640, 0x210c0, 0xc
    .long 0x9540, 0x9f00, 0x66, 0xe3c810, 0xd580, 0xfb, 0xb1600, 0xb16c0, 0x41700000, 0x43470000, 0x0, 0xc7, 0xe, 0xc640, 0x21420, 0xc
    .long 0x1680, 0x21c0, 0x66, 0xe32010, 0xf400, 0xd3, 0xa9800, 0xa98c0, 0x41700000, 0x41f80000, 0xf4, 0x1e, 0x10, 0xe4c0, 0x1fc80, 0xc
    .long 0x2940, 0x3300, 0x66, 0xe33810, 0xd580, 0xfb, 0xaaa00, 0xaaac0, 0x41700000, 0x425c0000, 0x0, 0x37, 0xe, 0xc640, 0x1ffe0, 0xc
    .long 0x3b40, 0x4500, 0x66, 0xe35010, 0xd580, 0xfb, 0xabc00, 0xabcc0, 0x41700000, 0x429e0000, 0x0, 0x4f, 0xe, 0xc640, 0x20340, 0xc
    .long 0x5640, 0x6000, 0x66, 0xe37410, 0xd580, 0xfb, 0xad700, 0xad7c0, 0x41700000, 0x42e60000, 0x0, 0x73, 0xe, 0xc640, 0x20850, 0xc
    .long 0x6840, 0x7200, 0x66, 0xe38c10, 0xd580, 0xfb, 0xae900, 0xae9c0, 0x41700000, 0x430b0000, 0x0, 0x8b, 0xe, 0xc640, 0x20bb0, 0xc
    .long 0x7a40, 0x8400, 0x66, 0xe3a410, 0xd580, 0xfb, 0xafb00, 0xafbc0, 0x41700000, 0x43230000, 0x0, 0xa3, 0xe, 0xc640, 0x20f10, 0xc
    .long 0x8c40, 0x9600, 0x66, 0xe3bc10, 0xd580, 0xfb, 0xb0d00, 0xb0dc0, 0x41700000, 0x433b0000, 0x0, 0xbb, 0xe, 0xc640, 0x21270, 0xc
    .long 0x9e40, 0xa740, 0x66, 0xe3d410, 0xd580, 0xfb, 0xb1f00, 0xb1fc0, 0x41700000, 0x43530000, 0x0, 0xd3, 0xe, 0xc640, 0x215d0, 0xc
    .long 0x2040, 0x2a00, 0x66, 0xe32c10, 0xd580, 0xfb, 0xaa100, 0xaa1c0, 0x41700000, 0x422c0000, 0x0, 0x2b, 0xe, 0xc640, 0x1fe30, 0xc
    .long 0x3240, 0x3c00, 0x66, 0xe34410, 0xd580, 0xfb, 0xab300, 0xab3c0, 0x41700000, 0x42860000, 0x0, 0x43, 0xe, 0xc640, 0x20190, 0xc
    .long 0x4440, 0x4e00, 0x66, 0xe35c10, 0xd580, 0xfb, 0xac500, 0xac5c0, 0x41700000, 0x42b60000, 0x0, 0x5b, 0xe, 0xc640, 0x204f0, 0xc
    .long 0xfffeb000, 0x2a000, 0x12, 0x1fe20000, 0x6ac0, 0x18a, 0x0, 0xa800, 0xbf800000, 0xbf800000, 0xf4, 0xfffffffe, 0x7, 0x5b80, 0x0, 0x3
    .long 0xa800, 0x49800, 0x12, 0x1fe20300, 0x6ac0, 0x18a, 0x1f800, 0x2a000, 0x40000000, 0xbf800000, 0xf4, 0x1, 0x7, 0x5b80, 0x5e80, 0x3
    .long 0x2a000, 0x69000, 0x12, 0x1fe20600, 0x6ac0, 0x18a, 0x3f000, 0x49800, 0x40a00000, 0xbf800000, 0xf4, 0x4, 0x7, 0x5b80, 0xbd00, 0x3
    .long 0x49800, 0x93000, 0x22, 0x1fe20900, 0x7a00, 0x175, 0x5e800, 0x69000, 0x41000000, 0xbf800000, 0xf4, 0x7, 0x8, 0x6ac0, 0x11b80, 0x4
    .long 0x73800, 0xbd000, 0x22, 0x1fe20d00, 0x7a00, 0x175, 0x88800, 0x93000, 0x41400000, 0xbf800000, 0xf4, 0xb, 0x8, 0x6ac0, 0x19980, 0x4
    .long 0x9d800, 0xe7000, 0x22, 0x1fe21100, 0x7a00, 0x175, 0xb2800, 0xbd000, 0x41800000, 0xbf800000, 0xf4, 0xf, 0x8, 0x6ac0, 0x21780, 0x4
    .long 0xc7800, 0x111000, 0x22, 0x1fe21500, 0x7a00, 0x175, 0xdc800, 0xe7000, 0x41a00000, 0xbf800000, 0xf4, 0x13, 0x8, 0x6ac0, 0x29580, 0x4
    .long 0xf1800, 0x13b000, 0x22, 0x1fe21900, 0x7a00, 0x175, 0x106800, 0x111000, 0x41c00000, 0xbf800000, 0xf4, 0x17, 0x8, 0x6ac0, 0x31380, 0x4
    .long 0x11b800, 0x16f800, 0x23, 0x1fe21d00, 0x8940, 0x161, 0x130800, 0x13b000, 0x41e00000, 0xbf800000, 0xf4, 0x1b, 0x9, 0x7a00, 0x39180, 0x5
    .long 0x5b3800, 0x63c000, 0x66, 0x1e28c20, 0xd580, 0xfb, 0x5bf800, 0x5ca000, 0x430b0000, 0x41f80000, 0x0, 0x8b, 0xe, 0xc640, 0x113e80, 0xc
    .long 0x7ab800, 0x834000, 0x66, 0xe2bc10, 0xd580, 0xfb, 0x7b6c00, 0x7c1400, 0x433b0000, 0x41700000, 0x0, 0xbb, 0xe, 0xc640, 0x172440, 0xc
    .long 0x8a7800, 0x925800, 0x66, 0x1e2d420, 0xd580, 0xfb, 0x8b3800, 0x8be000, 0x43530000, 0x41f80000, 0x0, 0xd3, 0xe, 0xc640, 0x1a1a80, 0xc
    .long 0x13b000, 0x1c3800, 0x55, 0x7e22080, 0xd580, 0xfb, 0x156000, 0x160800, 0x41f80000, 0x42fe0000, 0xf4, 0x1e, 0xe, 0xc640, 0x40200, 0xa
    .long 0x93000, 0xf1800, 0x33, 0xe21010, 0x9880, 0x14d, 0xa8c00, 0xb3400, 0x41700000, 0x41700000, 0xf4, 0xe, 0xa, 0x8940, 0x1fa40, 0x6
    .long 0x241800, 0x2ca000, 0x66, 0xe23810, 0xd580, 0xfb, 0x24cc00, 0x257400, 0x425c0000, 0x41700000, 0x0, 0x37, 0xe, 0xc640, 0x6e640, 0xc
    .long 0x33d800, 0x3c6000, 0x66, 0x1e25020, 0xd580, 0xfb, 0x349800, 0x354000, 0x429e0000, 0x41f80000, 0x0, 0x4f, 0xe, 0xc640, 0x9dc80, 0xc
    .long 0x4b7800, 0x540000, 0x66, 0xe27410, 0xd580, 0xfb, 0x4c2c00, 0x4cd400, 0x42e60000, 0x41700000, 0x0, 0x73, 0xe, 0xc640, 0xe4840, 0xc
    .long 0x631800, 0x6ba000, 0x66, 0xe29810, 0xd580, 0xfb, 0x63cc00, 0x647400, 0x43170000, 0x41700000, 0x0, 0x97, 0xe, 0xc640, 0x12b640, 0xc
    .long 0x72d800, 0x7b6000, 0x66, 0x1e2b020, 0xd580, 0xfb, 0x739800, 0x744000, 0x432f0000, 0x41f80000, 0x0, 0xaf, 0xe, 0xc640, 0x15ac80, 0xc
    .long 0x13b000, 0x1c3800, 0x55, 0x2e22030, 0xd580, 0xfb, 0x152400, 0x15cc00, 0x41f80000, 0x423c0000, 0xf4, 0x1e, 0xe, 0xc640, 0x3f6c0, 0xa
    .long 0x13b000, 0x1c3800, 0x55, 0x8e22090, 0xd580, 0xfb, 0x156c00, 0x161400, 0x41f80000, 0x430f0000, 0xf4, 0x1e, 0xe, 0xc640, 0x40440, 0xa
    .long 0xd2000, 0x15a800, 0x55, 0xe21610, 0xd580, 0xfb, 0xe7c00, 0xf2400, 0x41a80000, 0x41700000, 0xf4, 0x14, 0xe, 0xc640, 0x2b740, 0xa
    .long 0x241800, 0x2ca000, 0x66, 0x1e23820, 0xd580, 0xfb, 0x24d800, 0x258000, 0x425c0000, 0x41f80000, 0x0, 0x37, 0xe, 0xc640, 0x6e880, 0xc
    .long 0x3bb800, 0x444000, 0x66, 0xe25c10, 0xd580, 0xfb, 0x3c6c00, 0x3d1400, 0x42b60000, 0x41700000, 0x0, 0x5b, 0xe, 0xc640, 0xb5440, 0xc
    .long 0x4b7800, 0x540000, 0x66, 0x1e27420, 0xd580, 0xfb, 0x4c3800, 0x4ce000, 0x42e60000, 0x41f80000, 0x0, 0x73, 0xe, 0xc640, 0xe4a80, 0xc
    .long 0x631800, 0x6ba000, 0x66, 0x1e29820, 0xd580, 0xfb, 0x63d800, 0x648000, 0x43170000, 0x41f80000, 0x0, 0x97, 0xe, 0xc640, 0x12b880, 0xc
    .long 0x7ab800, 0x834000, 0x66, 0x1e2bc20, 0xd580, 0xfb, 0x7b7800, 0x7c2000, 0x433b0000, 0x41f80000, 0x0, 0xbb, 0xe, 0xc640, 0x172680, 0xc
    .long 0x13b000, 0x1c3800, 0x55, 0x3e22040, 0xd580, 0xfb, 0x153000, 0x15d800, 0x41f80000, 0x427c0000, 0xf4, 0x1e, 0xe, 0xc640, 0x3f900, 0xa
    .long 0x13b000, 0x1c3800, 0x55, 0x9e220a0, 0xd580, 0xfb, 0x157800, 0x162000, 0x41f80000, 0x431f0000, 0xf4, 0x1e, 0xe, 0xc640, 0x40680, 0xa
    .long 0x13b000, 0x1d8800, 0x66, 0xe22010, 0xf400, 0xd3, 0x150c00, 0x15b400, 0x41f80000, 0x41700000, 0xf4, 0x1e, 0x10, 0xe4c0, 0x3f240, 0xc
    .long 0x2bf800, 0x348000, 0x66, 0xe24410, 0xd580, 0xfb, 0x2cac00, 0x2d5400, 0x42860000, 0x41700000, 0x0, 0x43, 0xe, 0xc640, 0x86040, 0xc
    .long 0x439800, 0x4c2000, 0x66, 0xe26810, 0xd580, 0xfb, 0x444c00, 0x44f400, 0x42ce0000, 0x41700000, 0x0, 0x67, 0xe, 0xc640, 0xcce40, 0xc
    .long 0x535800, 0x5be000, 0x66, 0xe28010, 0xd580, 0xfb, 0x540c00, 0x54b400, 0x42fe0000, 0x41700000, 0x0, 0x7f, 0xe, 0xc640, 0xfc240, 0xc
    .long 0x6af800, 0x738000, 0x66, 0xe2a410, 0xd580, 0xfb, 0x6bac00, 0x6c5400, 0x43230000, 0x41700000, 0x0, 0xa3, 0xe, 0xc640, 0x143040, 0xc
    .long 0x829800, 0x8b2000, 0x66, 0xe2c810, 0xd580, 0xfb, 0x834c00, 0x83f400, 0x43470000, 0x41700000, 0x0, 0xc7, 0xe, 0xc640, 0x189e40, 0xc
    .long 0x13b000, 0x1c3800, 0x55, 0x4e22050, 0xd580, 0xfb, 0x153c00, 0x15e400, 0x41f80000, 0x429e0000, 0xf4, 0x1e, 0xe, 0xc640, 0x3fb40, 0xa
    .long 0x13b000, 0x1c3800, 0x55, 0xae220b0, 0xd580, 0xfb, 0x158400, 0x162c00, 0x41f80000, 0x432f0000, 0xf4, 0x1e, 0xe, 0xc640, 0x408c0, 0xa
    .long 0x13b000, 0x1d8800, 0x66, 0x1e22020, 0xf400, 0xd3, 0x151800, 0x15c000, 0x41f80000, 0x41f80000, 0xf4, 0x1e, 0x10, 0xe4c0, 0x3f480, 0xc
    .long 0x2bf800, 0x348000, 0x66, 0x1e24420, 0xd580, 0xfb, 0x2cb800, 0x2d6000, 0x42860000, 0x41f80000, 0x0, 0x43, 0xe, 0xc640, 0x86280, 0xc
    .long 0x3bb800, 0x444000, 0x66, 0x1e25c20, 0xd580, 0xfb, 0x3c7800, 0x3d2000, 0x42b60000, 0x41f80000, 0x0, 0x5b, 0xe, 0xc640, 0xb5680, 0xc
    .long 0x535800, 0x5be000, 0x66, 0x1e28020, 0xd580, 0xfb, 0x541800, 0x54c000, 0x42fe0000, 0x41f80000, 0x0, 0x7f, 0xe, 0xc640, 0xfc480, 0xc
    .long 0x6af800, 0x738000, 0x66, 0x1e2a420, 0xd580, 0xfb, 0x6bb800, 0x6c6000, 0x43230000, 0x41f80000, 0x0, 0xa3, 0xe, 0xc640, 0x143280, 0xc
    .long 0x829800, 0x8b2000, 0x66, 0x1e2c820, 0xd580, 0xfb, 0x835800, 0x840000, 0x43470000, 0x41f80000, 0x0, 0xc7, 0xe, 0xc640, 0x18a080, 0xc
    .long 0x13b000, 0x1c3800, 0x55, 0x5e22060, 0xd580, 0xfb, 0x154800, 0x15f000, 0x41f80000, 0x42be0000, 0xf4, 0x1e, 0xe, 0xc640, 0x3fd80, 0xa
    .long 0x13b000, 0x1c3800, 0x55, 0xbe220c0, 0xd580, 0xfb, 0x159000, 0x163800, 0x41f80000, 0x433f0000, 0xf4, 0x1e, 0xe, 0xc640, 0x40b00, 0xa
    .long 0x1c3800, 0x24c000, 0x66, 0xe22c10, 0xd580, 0xfb, 0x1cec00, 0x1d9400, 0x422c0000, 0x41700000, 0x0, 0x2b, 0xe, 0xc640, 0x56c40, 0xc
    .long 0x33d800, 0x3c6000, 0x66, 0xe25010, 0xd580, 0xfb, 0x348c00, 0x353400, 0x429e0000, 0x41700000, 0x0, 0x4f, 0xe, 0xc640, 0x9da40, 0xc
    .long 0x439800, 0x4c2000, 0x66, 0x1e26820, 0xd580, 0xfb, 0x445800, 0x450000, 0x42ce0000, 0x41f80000, 0x0, 0x67, 0xe, 0xc640, 0xcd080, 0xc
    .long 0x5b3800, 0x63c000, 0x66, 0xe28c10, 0xd580, 0xfb, 0x5bec00, 0x5c9400, 0x430b0000, 0x41700000, 0x0, 0x8b, 0xe, 0xc640, 0x113c40, 0xc
    .long 0x72d800, 0x7b6000, 0x66, 0xe2b010, 0xd580, 0xfb, 0x738c00, 0x743400, 0x432f0000, 0x41700000, 0x0, 0xaf, 0xe, 0xc640, 0x15aa40, 0xc
    .long 0x8a7800, 0x925800, 0x66, 0xe2d410, 0xd580, 0xfb, 0x8b2c00, 0x8bd400, 0x43530000, 0x41700000, 0x0, 0xd3, 0xe, 0xc640, 0x1a1840, 0xc
    .long 0x13b000, 0x1c3800, 0x55, 0x6e22070, 0xd580, 0xfb, 0x155400, 0x15fc00, 0x41f80000, 0x42de0000, 0xf4, 0x1e, 0xe, 0xc640, 0x3ffc0, 0xa
    .long 0x13b000, 0x1c3800, 0x55, 0xce220d0, 0xd580, 0xfb, 0x159c00, 0x164400, 0x41f80000, 0x434f0000, 0xf4, 0x1e, 0xe, 0xc640, 0x40d40, 0xa
    .long 0x1c3800, 0x24c000, 0x66, 0x1e22c20, 0xd580, 0xfb, 0x1cf800, 0x1da000, 0x422c0000, 0x41f80000, 0x0, 0x2b, 0xe, 0xc640, 0x56e80, 0xc
    .long 0x3fa800, 0x925800, 0x77, 0x6240, 0x3dff3e7f, 0x3dff3e7f, 0x408000, 0x451800, 0x0, 0x0, 0x0, 0x0, 0x0, 0x0, 0x0, 0x0
    .long 0x646800, 0x925800, 0x77, 0x9a60, 0x3e7f3eff, 0x3e7f3eff, 0x655800, 0x69f000, 0x0, 0x0, 0x0, 0x0, 0x0, 0x0, 0x0, 0x0
    .long 0x1ae800, 0x925800, 0x77, 0x2a80, 0x3e7f3dff, 0x3e7f3dff, 0x1bf000, 0x208800, 0x0, 0x0, 0x0, 0x0, 0x0, 0x0, 0x0, 0x0
    .long 0x3fa800, 0x925800, 0x77, 0x62a0, 0x3eff3e7f, 0x3eff3e7f, 0x40c800, 0x456000, 0x0, 0x0, 0x0, 0x0, 0x0, 0x0, 0x0, 0x0
    .long 0x6d9800, 0x925800, 0x77, 0xa880, 0x3e7f3eff, 0x3e7f3eff, 0x6ea000, 0x733800, 0x0, 0x0, 0x0, 0x0, 0x0, 0x0, 0x0, 0x0
    .long 0x241800, 0x925800, 0x77, 0x38b0, 0x3eff3dff, 0x3eff3dff, 0x254400, 0x29dc00, 0x0, 0x0, 0x0, 0x0, 0x0, 0x0, 0x0, 0x0
    .long 0x5b3800, 0x925800, 0x77, 0x8cb0, 0x3eff3eff, 0x3eff3eff, 0x5c6400, 0x60fc00, 0x0, 0x0, 0x0, 0x0, 0x0, 0x0, 0x0, 0x0
    .long 0x1ae800, 0x925800, 0x77, 0x2a30, 0x3dff3dff, 0x3dff3dff, 0x1bb400, 0x204c00, 0x0, 0x0, 0x0, 0x0, 0x0, 0x0, 0x0, 0x0
    .long 0x3fa800, 0x925800, 0x77, 0x6250, 0x3e7f3e7f, 0x3e7f3e7f, 0x408c00, 0x452400, 0x0, 0x0, 0x0, 0x0, 0x0, 0x0, 0x0, 0x0
    .long 0x6d9800, 0x925800, 0x77, 0xa830, 0x3dff3eff, 0x3dff3eff, 0x6e6400, 0x72fc00, 0x0, 0x0, 0x0, 0x0, 0x0, 0x0, 0x0, 0x0
    .long 0x1ae800, 0x925800, 0x77, 0x2a90, 0x3eff3dff, 0x3eff3dff, 0x1bfc00, 0x209400, 0x0, 0x0, 0x0, 0x0, 0x0, 0x0, 0x0, 0x0
    .long 0x48d800, 0x925800, 0x77, 0x7070, 0x3e7f3e7f, 0x3e7f3e7f, 0x49d400, 0x4e6c00, 0x0, 0x0, 0x0, 0x0, 0x0, 0x0, 0x0, 0x0
    .long 0x6d9800, 0x925800, 0x77, 0xa890, 0x3eff3eff, 0x3eff3eff, 0x6eac00, 0x734400, 0x0, 0x0, 0x0, 0x0, 0x0, 0x0, 0x0, 0x0
    .long 0x241800, 0x925800, 0x77, 0x38c0, 0x3eff3dff, 0x3eff3dff, 0x255000, 0x29e800, 0x0, 0x0, 0x0, 0x0, 0x0, 0x0, 0x0, 0x0
    .long 0x5b3800, 0x925800, 0x77, 0x8cc0, 0x3eff3eff, 0x3eff3eff, 0x5c7000, 0x610800, 0x0, 0x0, 0x0, 0x0, 0x0, 0x0, 0x0, 0x0
    .long 0x1ae800, 0x925800, 0x77, 0x2a40, 0x3dff3dff, 0x3dff3dff, 0x1bc000, 0x205800, 0x0, 0x0, 0x0, 0x0, 0x0, 0x0, 0x0, 0x0
    .long 0x3fa800, 0x925800, 0x77, 0x6260, 0x3e7f3e7f, 0x3e7f3e7f, 0x409800, 0x453000, 0x0, 0x0, 0x0, 0x0, 0x0, 0x0, 0x0, 0x0
    .long 0x6d9800, 0x925800, 0x77, 0xa840, 0x3dff3eff, 0x3dff3eff, 0x6e7000, 0x730800, 0x0, 0x0, 0x0, 0x0, 0x0, 0x0, 0x0, 0x0
    .long 0x1ae800, 0x925800, 0x77, 0x2aa0, 0x3eff3dff, 0x3eff3dff, 0x1c0800, 0x20a000, 0x0, 0x0, 0x0, 0x0, 0x0, 0x0, 0x0, 0x0
    .long 0x48d800, 0x925800, 0x77, 0x7080, 0x3e7f3e7f, 0x3e7f3e7f, 0x49e000, 0x4e7800, 0x0, 0x0, 0x0, 0x0, 0x0, 0x0, 0x0, 0x0
    .long 0x6d9800, 0x925800, 0x77, 0xa8a0, 0x3eff3eff, 0x3eff3eff, 0x6eb800, 0x735000, 0x0, 0x0, 0x0, 0x0, 0x0, 0x0, 0x0, 0x0
    .long 0x241800, 0x925800, 0x77, 0x38d0, 0x3eff3dff, 0x3eff3dff, 0x255c00, 0x29f400, 0x0, 0x0, 0x0, 0x0, 0x0, 0x0, 0x0, 0x0
    .long 0x5b3800, 0x925800, 0x77, 0x8cd0, 0x3eff3eff, 0x3eff3eff, 0x5c7c00, 0x611400, 0x0, 0x0, 0x0, 0x0, 0x0, 0x0, 0x0, 0x0
    .long 0x1ae800, 0x925800, 0x77, 0x2a50, 0x3e7f3dff, 0x3e7f3dff, 0x1bcc00, 0x206400, 0x0, 0x0, 0x0, 0x0, 0x0, 0x0, 0x0, 0x0
    .long 0x48d800, 0x925800, 0x77, 0x7030, 0x3dff3e7f, 0x3dff3e7f, 0x49a400, 0x4e3c00, 0x0, 0x0, 0x0, 0x0, 0x0, 0x0, 0x0, 0x0
    .long 0x6d9800, 0x925800, 0x77, 0xa850, 0x3e7f3eff, 0x3e7f3eff, 0x6e7c00, 0x731400, 0x0, 0x0, 0x0, 0x0, 0x0, 0x0, 0x0, 0x0
    .long 0x241800, 0x925800, 0x77, 0x3870, 0x3e7f3dff, 0x3e7f3dff, 0x251400, 0x29ac00, 0x0, 0x0, 0x0, 0x0, 0x0, 0x0, 0x0, 0x0
    .long 0x48d800, 0x925800, 0x77, 0x7090, 0x3eff3e7f, 0x3eff3e7f, 0x49ec00, 0x4e8400, 0x0, 0x0, 0x0, 0x0, 0x0, 0x0, 0x0, 0x0
    .long 0x76c800, 0x925800, 0x77, 0xb670, 0x3e7f3eff, 0x3e7f3eff, 0x77c400, 0x7c5c00, 0x0, 0x0, 0x0, 0x0, 0x0, 0x0, 0x0, 0x0
    .long 0x2d4800, 0x925800, 0x77, 0x46b0, 0x3eff3e7f, 0x3eff3e7f, 0x2e7400, 0x330c00, 0x0, 0x0, 0x0, 0x0, 0x0, 0x0, 0x0, 0x0
    .long 0x646800, 0x925800, 0x77, 0x9ab0, 0x3eff3eff, 0x3eff3eff, 0x659400, 0x6a2c00, 0x0, 0x0, 0x0, 0x0, 0x0, 0x0, 0x0, 0x0
    .long 0x1ae800, 0x925800, 0x77, 0x2a60, 0x3e7f3dff, 0x3e7f3dff, 0x1bd800, 0x207000, 0x0, 0x0, 0x0, 0x0, 0x0, 0x0, 0x0, 0x0
    .long 0x48d800, 0x925800, 0x77, 0x7040, 0x3dff3e7f, 0x3dff3e7f, 0x49b000, 0x4e4800, 0x0, 0x0, 0x0, 0x0, 0x0, 0x0, 0x0, 0x0
    .long 0x6d9800, 0x925800, 0x77, 0xa860, 0x3e7f3eff, 0x3e7f3eff, 0x6e8800, 0x732000, 0x0, 0x0, 0x0, 0x0, 0x0, 0x0, 0x0, 0x0
    .long 0x241800, 0x925800, 0x77, 0x3880, 0x3e7f3dff, 0x3e7f3dff, 0x252000, 0x29b800, 0x0, 0x0, 0x0, 0x0, 0x0, 0x0, 0x0, 0x0
    .long 0x48d800, 0x925800, 0x77, 0x70a0, 0x3eff3e7f, 0x3eff3e7f, 0x49f800, 0x4e9000, 0x0, 0x0, 0x0, 0x0, 0x0, 0x0, 0x0, 0x0
    .long 0x76c800, 0x925800, 0x77, 0xb680, 0x3e7f3eff, 0x3e7f3eff, 0x77d000, 0x7c6800, 0x0, 0x0, 0x0, 0x0, 0x0, 0x0, 0x0, 0x0
    .long 0x2d4800, 0x925800, 0x77, 0x46c0, 0x3eff3e7f, 0x3eff3e7f, 0x2e8000, 0x331800, 0x0, 0x0, 0x0, 0x0, 0x0, 0x0, 0x0, 0x0
    .long 0x646800, 0x925800, 0x77, 0x9ac0, 0x3eff3eff, 0x3eff3eff, 0x65a000, 0x6a3800, 0x0, 0x0, 0x0, 0x0, 0x0, 0x0, 0x0, 0x0
    .long 0x241800, 0x925800, 0x77, 0x3830, 0x3dff3dff, 0x3dff3dff, 0x24e400, 0x297c00, 0x0, 0x0, 0x0, 0x0, 0x0, 0x0, 0x0, 0x0
    .long 0x48d800, 0x925800, 0x77, 0x7050, 0x3e7f3e7f, 0x3e7f3e7f, 0x49bc00, 0x4e5400, 0x0, 0x0, 0x0, 0x0, 0x0, 0x0, 0x0, 0x0
    .long 0x76c800, 0x925800, 0x77, 0xb630, 0x3dff3eff, 0x3dff3eff, 0x779400, 0x7c2c00, 0x0, 0x0, 0x0, 0x0, 0x0, 0x0, 0x0, 0x0
    .long 0x241800, 0x925800, 0x77, 0x3890, 0x3eff3dff, 0x3eff3dff, 0x252c00, 0x29c400, 0x0, 0x0, 0x0, 0x0, 0x0, 0x0, 0x0, 0x0
    .long 0x520800, 0x925800, 0x77, 0x7e70, 0x3e7f3e7f, 0x3e7f3eff, 0x530400, 0x579c00, 0x0, 0x0, 0x0, 0x0, 0x0, 0x0, 0x0, 0x0
    .long 0x76c800, 0x925800, 0x77, 0xb690, 0x3eff3eff, 0x3eff3eff, 0x77dc00, 0x7c7400, 0x0, 0x0, 0x0, 0x0, 0x0, 0x0, 0x0, 0x0
    .long 0x2d4800, 0x925800, 0x77, 0x46d0, 0x3eff3e7f, 0x3eff3e7f, 0x2e8c00, 0x332400, 0x0, 0x0, 0x0, 0x0, 0x0, 0x0, 0x0, 0x0
    .long 0x646800, 0x925800, 0x77, 0x9ad0, 0x3eff3eff, 0x3eff3eff, 0x65ac00, 0x6a4400, 0x0, 0x0, 0x0, 0x0, 0x0, 0x0, 0x0, 0x0
    .long 0x241800, 0x925800, 0x77, 0x3840, 0x3dff3dff, 0x3dff3dff, 0x24f000, 0x298800, 0x0, 0x0, 0x0, 0x0, 0x0, 0x0, 0x0, 0x0
    .long 0x48d800, 0x925800, 0x77, 0x7060, 0x3e7f3e7f, 0x3e7f3e7f, 0x49c800, 0x4e6000, 0x0, 0x0, 0x0, 0x0, 0x0, 0x0, 0x0, 0x0
    .long 0x76c800, 0x925800, 0x77, 0xb640, 0x3dff3eff, 0x3dff3eff, 0x77a000, 0x7c3800, 0x0, 0x0, 0x0, 0x0, 0x0, 0x0, 0x0, 0x0
    .long 0x241800, 0x925800, 0x77, 0x38a0, 0x3eff3dff, 0x3eff3dff, 0x253800, 0x29d000, 0x0, 0x0, 0x0, 0x0, 0x0, 0x0, 0x0, 0x0
    .long 0x520800, 0x925800, 0x77, 0x7e80, 0x3e7f3e7f, 0x3e7f3eff, 0x531000, 0x57a800, 0x0, 0x0, 0x0, 0x0, 0x0, 0x0, 0x0, 0x0
    .long 0x76c800, 0x925800, 0x77, 0xb6a0, 0x3eff3eff, 0x3eff3eff, 0x77e800, 0x7c8000, 0x0, 0x0, 0x0, 0x0, 0x0, 0x0, 0x0, 0x0
    .long 0x367800, 0x925800, 0x77, 0x54b0, 0x3eff3e7f, 0x3eff3e7f, 0x37a400, 0x3c3c00, 0x0, 0x0, 0x0, 0x0, 0x0, 0x0, 0x0, 0x0
    .long 0x6d9800, 0x925800, 0x77, 0xa8b0, 0x3eff3eff, 0x3eff3eff, 0x6ec400, 0x735c00, 0x0, 0x0, 0x0, 0x0, 0x0, 0x0, 0x0, 0x0
    .long 0x241800, 0x925800, 0x77, 0x3850, 0x3e7f3dff, 0x3e7f3dff, 0x24fc00, 0x299400, 0x0, 0x0, 0x0, 0x0, 0x0, 0x0, 0x0, 0x0
    .long 0x520800, 0x925800, 0x77, 0x7e30, 0x3dff3e7f, 0x3dff3eff, 0x52d400, 0x576c00, 0x0, 0x0, 0x0, 0x0, 0x0, 0x0, 0x0, 0x0
    .long 0x76c800, 0x925800, 0x77, 0xb650, 0x3e7f3eff, 0x3e7f3eff, 0x77ac00, 0x7c4400, 0x0, 0x0, 0x0, 0x0, 0x0, 0x0, 0x0, 0x0
    .long 0x2d4800, 0x925800, 0x77, 0x4670, 0x3e7f3e7f, 0x3e7f3e7f, 0x2e4400, 0x32dc00, 0x0, 0x0, 0x0, 0x0, 0x0, 0x0, 0x0, 0x0
    .long 0x520800, 0x925800, 0x77, 0x7e90, 0x3eff3e7f, 0x3eff3eff, 0x531c00, 0x57b400, 0x0, 0x0, 0x0, 0x0, 0x0, 0x0, 0x0, 0x0
    .long 0x7ff800, 0x925800, 0x77, 0xc470, 0x3e7f3eff, 0x3e7f3eff, 0x80f400, 0x858c00, 0x0, 0x0, 0x0, 0x0, 0x0, 0x0, 0x0, 0x0
    .long 0x367800, 0x925800, 0x77, 0x54c0, 0x3eff3e7f, 0x3eff3e7f, 0x37b000, 0x3c4800, 0x0, 0x0, 0x0, 0x0, 0x0, 0x0, 0x0, 0x0
    .long 0x6d9800, 0x925800, 0x77, 0xa8c0, 0x3eff3eff, 0x3eff3eff, 0x6ed000, 0x736800, 0x0, 0x0, 0x0, 0x0, 0x0, 0x0, 0x0, 0x0
    .long 0x241800, 0x925800, 0x77, 0x3860, 0x3e7f3dff, 0x3e7f3dff, 0x250800, 0x29a000, 0x0, 0x0, 0x0, 0x0, 0x0, 0x0, 0x0, 0x0
    .long 0x520800, 0x925800, 0x77, 0x7e40, 0x3dff3e7f, 0x3dff3eff, 0x52e000, 0x577800, 0x0, 0x0, 0x0, 0x0, 0x0, 0x0, 0x0, 0x0
    .long 0x76c800, 0x925800, 0x77, 0xb660, 0x3e7f3eff, 0x3e7f3eff, 0x77b800, 0x7c5000, 0x0, 0x0, 0x0, 0x0, 0x0, 0x0, 0x0, 0x0
    .long 0x2d4800, 0x925800, 0x77, 0x4680, 0x3e7f3e7f, 0x3e7f3e7f, 0x2e5000, 0x32e800, 0x0, 0x0, 0x0, 0x0, 0x0, 0x0, 0x0, 0x0
    .long 0x520800, 0x925800, 0x77, 0x7ea0, 0x3eff3e7f, 0x3eff3eff, 0x532800, 0x57c000, 0x0, 0x0, 0x0, 0x0, 0x0, 0x0, 0x0, 0x0
    .long 0x7ff800, 0x925800, 0x77, 0xc480, 0x3e7f3eff, 0x3e7f3eff, 0x810000, 0x859800, 0x0, 0x0, 0x0, 0x0, 0x0, 0x0, 0x0, 0x0
    .long 0x367800, 0x925800, 0x77, 0x54d0, 0x3eff3e7f, 0x3eff3e7f, 0x37bc00, 0x3c5400, 0x0, 0x0, 0x0, 0x0, 0x0, 0x0, 0x0, 0x0
    .long 0x6d9800, 0x925800, 0x77, 0xa8d0, 0x3eff3eff, 0x3eff3eff, 0x6edc00, 0x737400, 0x0, 0x0, 0x0, 0x0, 0x0, 0x0, 0x0, 0x0
    .long 0x2d4800, 0x925800, 0x77, 0x4630, 0x3dff3e7f, 0x3dff3e7f, 0x2e1400, 0x32ac00, 0x0, 0x0, 0x0, 0x0, 0x0, 0x0, 0x0, 0x0
    .long 0x520800, 0x925800, 0x77, 0x7e50, 0x3e7f3e7f, 0x3e7f3eff, 0x52ec00, 0x578400, 0x0, 0x0, 0x0, 0x0, 0x0, 0x0, 0x0, 0x0
    .long 0x7ff800, 0x925800, 0x77, 0xc430, 0x3dff3eff, 0x3dff3eff, 0x80c400, 0x855c00, 0x0, 0x0, 0x0, 0x0, 0x0, 0x0, 0x0, 0x0
    .long 0x2d4800, 0x925800, 0x77, 0x4690, 0x3eff3e7f, 0x3eff3e7f, 0x2e5c00, 0x32f400, 0x0, 0x0, 0x0, 0x0, 0x0, 0x0, 0x0, 0x0
    .long 0x5b3800, 0x925800, 0x77, 0x8c70, 0x3e7f3eff, 0x3e7f3eff, 0x5c3400, 0x60cc00, 0x0, 0x0, 0x0, 0x0, 0x0, 0x0, 0x0, 0x0
    .long 0x7ff800, 0x925800, 0x77, 0xc490, 0x3eff3eff, 0x3eff3eff, 0x810c00, 0x85a400, 0x0, 0x0, 0x0, 0x0, 0x0, 0x0, 0x0, 0x0
    .long 0x3fa800, 0x925800, 0x77, 0x62b0, 0x3eff3e7f, 0x3eff3e7f, 0x40d400, 0x456c00, 0x0, 0x0, 0x0, 0x0, 0x0, 0x0, 0x0, 0x0
    .long 0x76c800, 0x925800, 0x77, 0xb6b0, 0x3eff3eff, 0x3eff3eff, 0x77f400, 0x7c8c00, 0x0, 0x0, 0x0, 0x0, 0x0, 0x0, 0x0, 0x0
    .long 0x2d4800, 0x925800, 0x77, 0x4640, 0x3dff3e7f, 0x3dff3e7f, 0x2e2000, 0x32b800, 0x0, 0x0, 0x0, 0x0, 0x0, 0x0, 0x0, 0x0
    .long 0x520800, 0x925800, 0x77, 0x7e60, 0x3e7f3e7f, 0x3e7f3eff, 0x52f800, 0x579000, 0x0, 0x0, 0x0, 0x0, 0x0, 0x0, 0x0, 0x0
    .long 0x7ff800, 0x925800, 0x77, 0xc440, 0x3dff3eff, 0x3dff3eff, 0x80d000, 0x856800, 0x0, 0x0, 0x0, 0x0, 0x0, 0x0, 0x0, 0x0
    .long 0x2d4800, 0x925800, 0x77, 0x46a0, 0x3eff3e7f, 0x3eff3e7f, 0x2e6800, 0x330000, 0x0, 0x0, 0x0, 0x0, 0x0, 0x0, 0x0, 0x0
    .long 0x5b3800, 0x925800, 0x77, 0x8c80, 0x3e7f3eff, 0x3e7f3eff, 0x5c4000, 0x60d800, 0x0, 0x0, 0x0, 0x0, 0x0, 0x0, 0x0, 0x0
    .long 0x7ff800, 0x925800, 0x77, 0xc4a0, 0x3eff3eff, 0x3eff3eff, 0x811800, 0x85b000, 0x0, 0x0, 0x0, 0x0, 0x0, 0x0, 0x0, 0x0
    .long 0x3fa800, 0x925800, 0x77, 0x62c0, 0x3eff3e7f, 0x3eff3e7f, 0x40e000, 0x457800, 0x0, 0x0, 0x0, 0x0, 0x0, 0x0, 0x0, 0x0
    .long 0x76c800, 0x925800, 0x77, 0xb6c0, 0x3eff3eff, 0x3eff3eff, 0x780000, 0x7c9800, 0x0, 0x0, 0x0, 0x0, 0x0, 0x0, 0x0, 0x0
    .long 0x2d4800, 0x925800, 0x77, 0x4650, 0x3e7f3e7f, 0x3e7f3e7f, 0x2e2c00, 0x32c400, 0x0, 0x0, 0x0, 0x0, 0x0, 0x0, 0x0, 0x0
    .long 0x5b3800, 0x925800, 0x77, 0x8c30, 0x3dff3eff, 0x3dff3eff, 0x5c0400, 0x609c00, 0x0, 0x0, 0x0, 0x0, 0x0, 0x0, 0x0, 0x0
    .long 0x7ff800, 0x925800, 0x77, 0xc450, 0x3e7f3eff, 0x3e7f3eff, 0x80dc00, 0x857400, 0x0, 0x0, 0x0, 0x0, 0x0, 0x0, 0x0, 0x0
    .long 0x367800, 0x925800, 0x77, 0x5470, 0x3e7f3e7f, 0x3e7f3e7f, 0x377400, 0x3c0c00, 0x0, 0x0, 0x0, 0x0, 0x0, 0x0, 0x0, 0x0
    .long 0x5b3800, 0x925800, 0x77, 0x8c90, 0x3eff3eff, 0x3eff3eff, 0x5c4c00, 0x60e400, 0x0, 0x0, 0x0, 0x0, 0x0, 0x0, 0x0, 0x0
    .long 0x892800, 0x925800, 0x77, 0xd270, 0x3e7f3eff, 0x3e7f3eff, 0x8a2400, 0x8ebc00, 0x0, 0x0, 0x0, 0x0, 0x0, 0x0, 0x0, 0x0
    .long 0x3fa800, 0x925800, 0x77, 0x62d0, 0x3eff3e7f, 0x3eff3e7f, 0x40ec00, 0x458400, 0x0, 0x0, 0x0, 0x0, 0x0, 0x0, 0x0, 0x0
    .long 0x76c800, 0x925800, 0x77, 0xb6d0, 0x3eff3eff, 0x3eff3eff, 0x780c00, 0x7ca400, 0x0, 0x0, 0x0, 0x0, 0x0, 0x0, 0x0, 0x0
    .long 0x2d4800, 0x925800, 0x77, 0x4660, 0x3e7f3e7f, 0x3e7f3e7f, 0x2e3800, 0x32d000, 0x0, 0x0, 0x0, 0x0, 0x0, 0x0, 0x0, 0x0
    .long 0x5b3800, 0x925800, 0x77, 0x8c40, 0x3dff3eff, 0x3dff3eff, 0x5c1000, 0x60a800, 0x0, 0x0, 0x0, 0x0, 0x0, 0x0, 0x0, 0x0
    .long 0x7ff800, 0x925800, 0x77, 0xc460, 0x3e7f3eff, 0x3e7f3eff, 0x80e800, 0x858000, 0x0, 0x0, 0x0, 0x0, 0x0, 0x0, 0x0, 0x0
    .long 0x367800, 0x925800, 0x77, 0x5480, 0x3e7f3e7f, 0x3e7f3e7f, 0x378000, 0x3c1800, 0x0, 0x0, 0x0, 0x0, 0x0, 0x0, 0x0, 0x0
    .long 0x5b3800, 0x925800, 0x77, 0x8ca0, 0x3eff3eff, 0x3eff3eff, 0x5c5800, 0x60f000, 0x0, 0x0, 0x0, 0x0, 0x0, 0x0, 0x0, 0x0
    .long 0x892800, 0x925800, 0x77, 0xd280, 0x3e7f3eff, 0x3e7f3eff, 0x8a3000, 0x8ec800, 0x0, 0x0, 0x0, 0x0, 0x0, 0x0, 0x0, 0x0
    .long 0x48d800, 0x925800, 0x77, 0x70b0, 0x3eff3e7f, 0x3eff3e7f, 0x4a0400, 0x4e9c00, 0x0, 0x0, 0x0, 0x0, 0x0, 0x0, 0x0, 0x0
    .long 0x7ff800, 0x925800, 0x77, 0xc4b0, 0x3eff3eff, 0x3eff3eff, 0x812400, 0x85bc00, 0x0, 0x0, 0x0, 0x0, 0x0, 0x0, 0x0, 0x0
    .long 0x367800, 0x925800, 0x77, 0x5430, 0x3dff3e7f, 0x3dff3e7f, 0x374400, 0x3bdc00, 0x0, 0x0, 0x0, 0x0, 0x0, 0x0, 0x0, 0x0
    .long 0x5b3800, 0x925800, 0x77, 0x8c50, 0x3e7f3eff, 0x3e7f3eff, 0x5c1c00, 0x60b400, 0x0, 0x0, 0x0, 0x0, 0x0, 0x0, 0x0, 0x0
    .long 0x892800, 0x925800, 0x77, 0xd230, 0x3dff3eff, 0x3dff3eff, 0x89f400, 0x8e8c00, 0x0, 0x0, 0x0, 0x0, 0x0, 0x0, 0x0, 0x0
    .long 0x367800, 0x925800, 0x77, 0x5490, 0x3eff3e7f, 0x3eff3e7f, 0x378c00, 0x3c2400, 0x0, 0x0, 0x0, 0x0, 0x0, 0x0, 0x0, 0x0
    .long 0x646800, 0x925800, 0x77, 0x9a70, 0x3e7f3eff, 0x3e7f3eff, 0x656400, 0x69fc00, 0x0, 0x0, 0x0, 0x0, 0x0, 0x0, 0x0, 0x0
    .long 0x892800, 0x925800, 0x77, 0xd290, 0x3eff3eff, 0x3eff3eff, 0x8a3c00, 0x8ed400, 0x0, 0x0, 0x0, 0x0, 0x0, 0x0, 0x0, 0x0
    .long 0x48d800, 0x925800, 0x77, 0x70c0, 0x3eff3e7f, 0x3eff3e7f, 0x4a1000, 0x4ea800, 0x0, 0x0, 0x0, 0x0, 0x0, 0x0, 0x0, 0x0
    .long 0x7ff800, 0x925800, 0x77, 0xc4c0, 0x3eff3eff, 0x3eff3eff, 0x813000, 0x85c800, 0x0, 0x0, 0x0, 0x0, 0x0, 0x0, 0x0, 0x0
    .long 0x367800, 0x925800, 0x77, 0x5440, 0x3dff3e7f, 0x3dff3e7f, 0x375000, 0x3be800, 0x0, 0x0, 0x0, 0x0, 0x0, 0x0, 0x0, 0x0
    .long 0x5b3800, 0x925800, 0x77, 0x8c60, 0x3e7f3eff, 0x3e7f3eff, 0x5c2800, 0x60c000, 0x0, 0x0, 0x0, 0x0, 0x0, 0x0, 0x0, 0x0
    .long 0x892800, 0x925800, 0x77, 0xd240, 0x3dff3eff, 0x3dff3eff, 0x8a0000, 0x8e9800, 0x0, 0x0, 0x0, 0x0, 0x0, 0x0, 0x0, 0x0
    .long 0x367800, 0x925800, 0x77, 0x54a0, 0x3eff3e7f, 0x3eff3e7f, 0x379800, 0x3c3000, 0x0, 0x0, 0x0, 0x0, 0x0, 0x0, 0x0, 0x0
    .long 0x646800, 0x925800, 0x77, 0x9a80, 0x3e7f3eff, 0x3e7f3eff, 0x657000, 0x6a0800, 0x0, 0x0, 0x0, 0x0, 0x0, 0x0, 0x0, 0x0
    .long 0x892800, 0x925800, 0x77, 0xd2a0, 0x3eff3eff, 0x3eff3eff, 0x8a4800, 0x8ee000, 0x0, 0x0, 0x0, 0x0, 0x0, 0x0, 0x0, 0x0
    .long 0x48d800, 0x925800, 0x77, 0x70d0, 0x3eff3e7f, 0x3eff3e7f, 0x4a1c00, 0x4eb400, 0x0, 0x0, 0x0, 0x0, 0x0, 0x0, 0x0, 0x0
    .long 0x7ff800, 0x925800, 0x77, 0xc4d0, 0x3eff3eff, 0x3eff3eff, 0x813c00, 0x85d400, 0x0, 0x0, 0x0, 0x0, 0x0, 0x0, 0x0, 0x0
    .long 0x367800, 0x925800, 0x77, 0x5450, 0x3e7f3e7f, 0x3e7f3e7f, 0x375c00, 0x3bf400, 0x0, 0x0, 0x0, 0x0, 0x0, 0x0, 0x0, 0x0
    .long 0x646800, 0x925800, 0x77, 0x9a30, 0x3dff3eff, 0x3dff3eff, 0x653400, 0x69cc00, 0x0, 0x0, 0x0, 0x0, 0x0, 0x0, 0x0, 0x0
    .long 0x892800, 0x925800, 0x77, 0xd250, 0x3e7f3eff, 0x3e7f3eff, 0x8a0c00, 0x8ea400, 0x0, 0x0, 0x0, 0x0, 0x0, 0x0, 0x0, 0x0
    .long 0x3fa800, 0x925800, 0x77, 0x6270, 0x3e7f3e7f, 0x3e7f3e7f, 0x40a400, 0x453c00, 0x0, 0x0, 0x0, 0x0, 0x0, 0x0, 0x0, 0x0
    .long 0x646800, 0x925800, 0x77, 0x9a90, 0x3eff3eff, 0x3eff3eff, 0x657c00, 0x6a1400, 0x0, 0x0, 0x0, 0x0, 0x0, 0x0, 0x0, 0x0
    .long 0x1ae800, 0x925800, 0x77, 0x2ab0, 0x3eff3dff, 0x3eff3dff, 0x1c1400, 0x20ac00, 0x0, 0x0, 0x0, 0x0, 0x0, 0x0, 0x0, 0x0
    .long 0x520800, 0x925800, 0x77, 0x7eb0, 0x3eff3e7f, 0x3eff3eff, 0x533400, 0x57cc00, 0x0, 0x0, 0x0, 0x0, 0x0, 0x0, 0x0, 0x0
    .long 0x892800, 0x925800, 0x77, 0xd2b0, 0x3eff3eff, 0x3eff3eff, 0x8a5400, 0x8eec00, 0x0, 0x0, 0x0, 0x0, 0x0, 0x0, 0x0, 0x0
    .long 0x367800, 0x925800, 0x77, 0x5460, 0x3e7f3e7f, 0x3e7f3e7f, 0x376800, 0x3c0000, 0x0, 0x0, 0x0, 0x0, 0x0, 0x0, 0x0, 0x0
    .long 0x646800, 0x925800, 0x77, 0x9a40, 0x3dff3eff, 0x3dff3eff, 0x654000, 0x69d800, 0x0, 0x0, 0x0, 0x0, 0x0, 0x0, 0x0, 0x0
    .long 0x892800, 0x925800, 0x77, 0xd260, 0x3e7f3eff, 0x3e7f3eff, 0x8a1800, 0x8eb000, 0x0, 0x0, 0x0, 0x0, 0x0, 0x0, 0x0, 0x0
    .long 0x3fa800, 0x925800, 0x77, 0x6280, 0x3e7f3e7f, 0x3e7f3e7f, 0x40b000, 0x454800, 0x0, 0x0, 0x0, 0x0, 0x0, 0x0, 0x0, 0x0
    .long 0x646800, 0x925800, 0x77, 0x9aa0, 0x3eff3eff, 0x3eff3eff, 0x658800, 0x6a2000, 0x0, 0x0, 0x0, 0x0, 0x0, 0x0, 0x0, 0x0
    .long 0x1ae800, 0x925800, 0x77, 0x2ac0, 0x3eff3dff, 0x3eff3dff, 0x1c2000, 0x20b800, 0x0, 0x0, 0x0, 0x0, 0x0, 0x0, 0x0, 0x0
    .long 0x520800, 0x925800, 0x77, 0x7ec0, 0x3eff3e7f, 0x3eff3eff, 0x534000, 0x57d800, 0x0, 0x0, 0x0, 0x0, 0x0, 0x0, 0x0, 0x0
    .long 0x892800, 0x925800, 0x77, 0xd2c0, 0x3eff3eff, 0x3eff3eff, 0x8a6000, 0x8ef800, 0x0, 0x0, 0x0, 0x0, 0x0, 0x0, 0x0, 0x0
    .long 0x3fa800, 0x925800, 0x77, 0x6230, 0x3dff3e7f, 0x3dff3e7f, 0x407400, 0x450c00, 0x0, 0x0, 0x0, 0x0, 0x0, 0x0, 0x0, 0x0
    .long 0x646800, 0x925800, 0x77, 0x9a50, 0x3e7f3eff, 0x3e7f3eff, 0x654c00, 0x69e400, 0x0, 0x0, 0x0, 0x0, 0x0, 0x0, 0x0, 0x0
    .long 0x1ae800, 0x925800, 0x77, 0x2a70, 0x3e7f3dff, 0x3e7f3dff, 0x1be400, 0x207c00, 0x0, 0x0, 0x0, 0x0, 0x0, 0x0, 0x0, 0x0
    .long 0x3fa800, 0x925800, 0x77, 0x6290, 0x3eff3e7f, 0x3eff3e7f, 0x40bc00, 0x455400, 0x0, 0x0, 0x0, 0x0, 0x0, 0x0, 0x0, 0x0
    .long 0x6d9800, 0x925800, 0x77, 0xa870, 0x3e7f3eff, 0x3e7f3eff, 0x6e9400, 0x732c00, 0x0, 0x0, 0x0, 0x0, 0x0, 0x0, 0x0, 0x0
    .long 0x1ae800, 0x925800, 0x77, 0x2ad0, 0x3eff3dff, 0x3eff3dff, 0x1c2c00, 0x20c400, 0x0, 0x0, 0x0, 0x0, 0x0, 0x0, 0x0, 0x0
    .long 0x520800, 0x925800, 0x77, 0x7ed0, 0x3eff3e7f, 0x3eff3eff, 0x534c00, 0x57e400, 0x0, 0x0, 0x0, 0x0, 0x0, 0x0, 0x0, 0x0
    .long 0x892800, 0x925800, 0x77, 0xd2d0, 0x3eff3eff, 0x3eff3eff, 0x8a6c00, 0x8f0400, 0x0, 0x0, 0x0, 0x0, 0x0, 0x0, 0x0, 0x0
.section .rodata,"a"
.p2align 6
.amdhsa_kernel standalone__deformable_dcnv1__vision_kernel
  .amdhsa_next_free_vgpr 512
  .amdhsa_next_free_sgpr 102
  .amdhsa_accum_offset 256
  .amdhsa_group_segment_fixed_size 0
  .amdhsa_kernarg_size 48
  .amdhsa_user_sgpr_count 2
  .amdhsa_user_sgpr_kernarg_segment_ptr 1
  .amdhsa_system_sgpr_workgroup_id_x 1
  .amdhsa_float_denorm_mode_32 3
.end_amdhsa_kernel
```
